```python
import torch

def _softmax(x, axis=-1):
    return torch.softmax(x, dim=axis)
def _gelu(x):
    return torch.nn.functional.gelu(x, approximate="tanh")
def _silu(x):
    return torch.nn.functional.silu(x)
def _sigmoid(x):
    return torch.sigmoid(x)
def _layernorm(x, axis=-1, eps=1e-5):
    m = x.mean(dim=axis, keepdim=True)
    v = x.var(dim=axis, keepdim=True, unbiased=False)
    return (x - m) / torch.sqrt(v + eps)
def _scatter_add(tgt, idx, src, axis=0):
    return tgt.clone().index_add_(axis, idx, src)
def _segment_sum(src, seg, n):
    out = torch.zeros((n,) + src.shape[1:], dtype=src.dtype)
    return out.index_add_(0, seg, src)
def _pad(x, pw):
    flat = tuple(v for pair in reversed(pw) for v in pair)
    return torch.nn.functional.pad(x, flat)

kernel_name = 'gated_mix__sliding_local_dilated__moe_arch_mod__prompt'

def setup_inputs():

    _w = (lambda a: (lambda t: t.to(torch.bfloat16) if t.is_floating_point() else t)(torch.as_tensor(a)))
    def _A_setup():
        B, S, D = 1, 2048, 640
        return {
            "x": _w((lambda *s: torch.randn(*s, dtype=torch.bfloat16) * 0.05)(B, S, D)),
            "wqkv": _w((lambda *s: torch.randn(*s, dtype=torch.bfloat16) * 0.8)(D, 3 * D)),
            "wo": _w((lambda *s: torch.randn(*s, dtype=torch.bfloat16) * 0.05)(D, D)),
        }
    _A_in = _A_setup()

    def _B_setup():
        B, S, D, F, C = 1, 2048, 640, 1728, 2
        return {
            "x": _w((lambda *s: torch.randn(*s, dtype=torch.bfloat16) * 0.05)(B, S, D)),
            "w_r": _w((lambda *s: torch.randn(*s, dtype=torch.bfloat16) * 1.6)(D)),
            "w_gate": _w((lambda *s: torch.randn(*s, dtype=torch.bfloat16) * 0.4)(D, F)),
            "w_up": _w((lambda *s: torch.randn(*s, dtype=torch.bfloat16) * 0.4)(D, F)),
            "w_down": _w((lambda *s: torch.randn(*s, dtype=torch.bfloat16) * 0.4)(F, D)),
        }
    _B_in = _B_setup()

    return {
        "A_x": _A_in["x"],
        "A_wqkv": _A_in["wqkv"],
        "A_wo": _A_in["wo"],
        "B_x": _B_in["x"],
        "B_w_r": _B_in["w_r"],
        "B_w_gate": _B_in["w_gate"],
        "B_w_up": _B_in["w_up"],
        "B_w_down": _B_in["w_down"],
        "gate_w": _w((lambda *s: torch.randn(*s, dtype=torch.bfloat16) * 0.05)(640) * 16.0),
    }

def reference(A_x, A_wqkv, A_wo, B_x, B_w_r, B_w_gate, B_w_up, B_w_down, gate_w):
    def _A_ref(x, wqkv, wo):
        B, S, D = x.shape
        H = 32; Dh = D // H
        W, dil = 8, 2
        qkv = (lambda x, *d: x.permute(*d))((x @ wqkv).reshape(B, S, 3, H, Dh), 2, 0, 3, 1, 4)
        q, k, v = qkv[0], qkv[1], qkv[2]
        scale = Dh ** -0.5
        pos = torch.arange(S)
        off = torch.arange(W) * dil
        idx = pos[:, None] - off[None, :]
        mask = idx >= 0
        idx_c = torch.where(mask, idx, 0).reshape(-1)
        kg = k[:, :, idx_c, :].reshape(B, H, S, W, Dh)
        vg = v[:, :, idx_c, :].reshape(B, H, S, W, Dh)
        logits = torch.einsum("bhsd,bhswd->bhsw", q, kg) * scale
        logits = torch.where(mask[None, None, :, :], logits, -1e9)
        attn = _softmax(logits, axis=-1)
        o = torch.einsum("bhsw,bhswd->bhsd", attn, vg)
        return (lambda x, *d: x.permute(*d))(o, 0, 2, 1, 3).reshape(B, S, D) @ wo

    def _B_ref(x, w_r, w_gate, w_up, w_down):
        B, S, D = x.shape
        C = 2
        r = x @ w_r
        idx = torch.argsort(-r, axis=-1)[:, :C]
        idx_e = (lambda x, n, axis: torch.repeat_interleave(x, n, dim=axis))(idx.reshape(B, C, 1), D, axis=2)
        x_sel = (lambda x, i, axis: torch.take_along_dim(x, i, dim=axis))(x, idx_e, axis=1)
        g = _silu(x_sel @ w_gate)
        u = x_sel @ w_up
        y = (g * u) @ w_down
        r_sel = _sigmoid((lambda x, i, axis: torch.take_along_dim(x, i, dim=axis))(r, idx, axis=1))
        y = y * r_sel.reshape(B, C, 1)
        b_off = (torch.arange(B) * S).reshape(B, 1)
        flat_idx = (idx + b_off).reshape(B * C)
        zero = (x * 0.0).reshape(B * S, D)
        upd = _scatter_add(zero, flat_idx, y.reshape(B * C, D), axis=0)
        return x + upd.reshape(B, S, D)

    x = A_x
    g = _sigmoid((x * gate_w).sum(-1, keepdims=True))
    a = _A_ref(x, A_wqkv, A_wo)
    b = _B_ref(x, B_w_r, B_w_gate, B_w_up, B_w_down)
    return g * a + (1 - g) * b
```

```asm
; @launch grid=(256,1,1) block=(512,1,1) lds=163840
.amdgcn_target "amdgcn-amd-amdhsa--gfx950"
.text
.p2align 12
.p2align 8
.globl gated_mix__sliding_local_dilated__moe_arch_mod__prompt_kernel
.type gated_mix__sliding_local_dilated__moe_arch_mod__prompt_kernel,@function
gated_mix__sliding_local_dilated__moe_arch_mod__prompt_kernel:
    s_cmp_ge_u32 s2, 256
    s_cbranch_scc1 K_EXIT
    s_load_dwordx2 s[12:13], s[0:1], 0
    s_load_dwordx2 s[16:17], s[0:1], 8
    v_readfirstlane_b32 s30, v0
    s_load_dwordx4 s[8:11], s[0:1], 80
    s_load_dwordx2 s[24:25], s[0:1], 16
    s_load_dwordx2 s[6:7], s[0:1], 72
    s_and_b32 s28, s2, 7
    v_and_b32 v1, 63, v0
    s_mov_b32 s14, 0x280000
    s_mov_b32 s15, 0x20000
    s_lshr_b32 s30, s30, 6
    s_cmp_lt_u32 s2, 64
    s_cbranch_scc1 K_SLOW
    s_cmp_lt_u32 s30, 4
    s_cbranch_scc1 K_FAST
K_SLOW:
    s_getpc_b64 s[38:39]
K_PC:
    s_bfe_u32 s3, s2, 0x30003
    s_mul_i32 s3, s3, ((K_CODE_END-gated_mix__sliding_local_dilated__moe_arch_mod__prompt_kernel+1023)/1024)
    s_sub_u32 s38, s38, K_PC-gated_mix__sliding_local_dilated__moe_arch_mod__prompt_kernel
    s_subb_u32 s39, s39, 0
    v_subrev_u32 v3, 256, v0
    v_add_u32 v2, s3, v3
    v_lshlrev_b32 v2, 7, v2
    v_min_u32 v2, K_CODE_END-gated_mix__sliding_local_dilated__moe_arch_mod__prompt_kernel-4, v2
    v_cmp_gt_u32 vcc, ((K_CODE_END-gated_mix__sliding_local_dilated__moe_arch_mod__prompt_kernel+1023)/1024), v3
    s_and_saveexec_b64 s[4:5], vcc
    s_cbranch_execz K_NOPF
    global_load_dword v6, v2, s[38:39]
K_NOPF:
    s_mov_b64 exec, -1
    v_mov_b32 v2, 0
    v_mov_b32 v3, 158752
    ds_write2_b32 v3, v2, v2 offset0:0 offset1:1
    ds_write2_b32 v3, v2, v2 offset0:2 offset1:3
    ds_write2_b32 v3, v2, v2 offset0:4 offset1:5
    s_mov_b32 s43, 1
    s_branch K_COMMON
K_FAST:
    s_lshr_b32 s32, s2, 1
    s_and_b32 s32, s32, 28
    v_lshrrev_b32 v3, 4, v1
    s_lshr_b32 s59, 0x82931560, s32
    s_and_b32 s59, s59, 15
    v_and_b32 v4, 7, v1
    s_lshr_b32 s3, s2, 6
    s_lshl2_add_u32 s59, s3, s59
    v_lshrrev_b32 v2, 3, v1
    s_add_u32 s59, s59, s28
    s_mul_i32 s33, s59, 205
    v_xor_b32 v4, v4, v3
    s_lshr_b32 s33, s33, 11
    s_mul_i32 s33, s33, 10
    v_mul_u32_u24 v2, 1280, v2
    s_sub_u32 s59, s59, s33
    s_lshr_b32 s53, s28, 1
    v_lshl_add_u32 v44, v4, 4, v2
    s_mul_i32 s53, s53, 675840
    s_mul_i32 s3, s3, 225280
    v_xor_b32 v45, 64, v44
    s_add_u32 s53, s53, s3
    s_mul_i32 s54, s30, 61440
    s_add_u32 s53, s53, s54
    s_sub_u32 s53, s53, 245760
    s_mul_i32 s55, s30, 6144
    s_add_u32 s55, s55, 40960
    s_lshl_b32 s57, s59, 7
    s_add_u32 s57, s57, s53
    s_waitcnt lgkmcnt(0)
    s_add_u32 m0, s55, 0
    s_max_i32 s60, s57, 0
    buffer_load_dwordx4 v44, s[12:15], s60 offen lds
    s_add_u32 s60, s57, 10240
    s_add_u32 m0, s55, 1024
    s_max_i32 s60, s60, 0
    buffer_load_dwordx4 v45, s[12:15], s60 offen lds
    s_add_u32 m0, s55, 2048
    s_add_u32 s60, s57, 20480
    buffer_load_dwordx4 v44, s[12:15], s60 offen lds
    s_add_u32 m0, s55, 3072
    s_add_u32 s60, s57, 30720
    buffer_load_dwordx4 v45, s[12:15], s60 offen lds
    s_add_u32 m0, s55, 4096
    s_add_u32 s60, s57, 40960
    buffer_load_dwordx4 v44, s[12:15], s60 offen lds
    s_add_u32 m0, s55, 5120
    s_add_u32 s60, s57, 51200
    buffer_load_dwordx4 v45, s[12:15], s60 offen lds
    v_lshlrev_b32 v2, 1, v3
    s_lshr_b32 s32, 0x64317520, s32
    v_sub_u32 v2, v1, v2
    s_and_b32 s32, s32, 7
    v_and_b32 v2, 15, v2
    s_and_b32 s3, s28, 1
    v_mul_u32_u24 v3, 3840, v3
    s_lshl3_add_u32 s32, s3, s32
    v_mul_u32_u24 v4, 13, v2
    s_mul_i32 s3, s32, 80
    v_lshrrev_b32 v4, 6, v4
    s_add_u32 s54, s54, s3
    v_mul_u32_u24 v4, 1200, v4
    s_lshl_b32 s56, s30, 12
    v_lshl_add_u32 v4, v2, 4, v4
    s_add_u32 s56, s56, 65536
    v_add_u32 v5, 1, v2
    s_mov_b32 s18, 0x258000
    v_and_b32 v5, 16, v5
    s_mov_b32 s19, 0x20000
    v_lshl_add_u32 v4, v5, 24, v4
    v_add_u32 v46, v3, v4
    s_mul_i32 s58, s59, 245760
    s_add_u32 s58, s58, s54
    s_add_u32 s59, s59, 1
    s_cmp_eq_u32 s59, 10
    s_cselect_b32 s59, 0, s59
    s_add_u32 m0, s56, 0
    s_add_u32 s60, s58, 0
    buffer_load_dwordx4 v46, s[16:19], s60 offen lds
    s_add_u32 m0, s56, 1024
    s_add_u32 s60, s58, 15360
    buffer_load_dwordx4 v46, s[16:19], s60 offen lds
    v_xor_b32 v2, 8, v2
    v_mul_u32_u24 v4, 13, v2
    v_lshrrev_b32 v4, 6, v4
    v_mul_u32_u24 v4, 1200, v4
    v_lshl_add_u32 v4, v2, 4, v4
    v_add_u32 v5, 1, v2
    v_and_b32 v5, 16, v5
    v_lshl_add_u32 v4, v5, 24, v4
    v_add_u32 v47, v3, v4
    s_add_u32 m0, s56, 2048
    s_add_u32 s60, s58, 30720
    buffer_load_dwordx4 v47, s[16:19], s60 offen lds
    s_add_u32 m0, s56, 3072
    s_add_u32 s60, s58, 46080
    buffer_load_dwordx4 v47, s[16:19], s60 offen lds
    s_mov_b32 s3, 40960
    s_cmp_ge_u32 s55, 81920
    s_cselect_b32 s60, -81920, s3
    s_add_u32 s55, s55, s60
    s_add_u32 s56, s56, s60
    s_lshl_b32 s57, s59, 7
    s_add_u32 s57, s57, s53
    s_mul_i32 s58, s59, 245760
    s_add_u32 s58, s58, s54
    s_add_u32 s59, s59, 1
    s_cmp_eq_u32 s59, 10
    s_cselect_b32 s59, 0, s59
    s_add_u32 m0, s56, 0
    s_add_u32 s60, s58, 0
    buffer_load_dwordx4 v46, s[16:19], s60 offen lds
    s_add_u32 m0, s55, 0
    s_max_i32 s60, s57, 0
    buffer_load_dwordx4 v44, s[12:15], s60 offen lds
    s_add_u32 m0, s56, 1024
    s_add_u32 s60, s58, 15360
    buffer_load_dwordx4 v46, s[16:19], s60 offen lds
    s_add_u32 s60, s57, 10240
    s_add_u32 m0, s55, 1024
    s_max_i32 s60, s60, 0
    buffer_load_dwordx4 v45, s[12:15], s60 offen lds
    s_add_u32 m0, s55, 2048
    s_add_u32 s60, s57, 20480
    buffer_load_dwordx4 v44, s[12:15], s60 offen lds
    s_mov_b32 s52, s30
    s_mov_b32 s43, 0
K_COMMON:
    v_mov_b32 v7, 0
    s_lshr_b32 s29, s2, 3
    s_xor_b32 s30, s30, 4
    s_mov_b32 s26, 0xc8000
    s_mov_b32 s27, 0x20000
    s_lshr_b32 s34, s29, 3
    s_lshl_b32 s34, s34, 2
    s_and_b32 s3, s29, 3
    s_add_u32 s34, s34, s3
    s_add_u32 s34, s34, 4
    s_bitcmp1_b32 s29, 2
    s_cselect_b32 s34, -1, s34
    s_cmp_lt_u32 s29, 8
    s_cselect_b32 s34, s29, s34
    s_lshl_b32 s40, s28, 1
    s_cmp_ge_u32 s34, 10
    s_addc_u32 s40, s40, 0
    s_sub_u32 s41, s34, 10
    s_cmp_ge_u32 s34, 10
    s_cselect_b32 s41, s41, s34
    s_mul_i32 s42, s28, 20
    s_add_u32 s42, s42, s34
    s_and_b32 s42, s42, 255
    s_lshl_b32 s42, s42, 8
    s_add_u32 s42, s42, 524288
    s_cmp_lt_u32 s29, 8
    s_cbranch_scc1 K_AUX
    s_lshr_b32 s31, s28, 1
    s_mul_i32 s31, s31, 3
    s_lshr_b32 s3, s29, 3
    s_add_u32 s31, s31, s3
    s_sub_u32 s31, s31, 1
    s_and_b32 s35, s29, 3
    s_and_b32 s3, s29, 4
    s_lshl_b32 s3, s3, 1
    s_add_u32 s35, s35, s3
    s_and_b32 s3, s28, 1
    s_lshl_b32 s3, s3, 2
    s_add_u32 s35, s35, s3
    v_and_b32 v8, 15, v1
    v_lshrrev_b32 v9, 4, v1
    v_bfe_u32 v10, v1, 2, 2
    v_and_b32 v11, 3, v1
    s_waitcnt lgkmcnt(0)
    s_add_u32 s20, s10, 0x100000
    s_addc_u32 s21, s11, 0
    s_mov_b32 s22, 0x280000
    s_mov_b32 s23, 0x20000
    s_and_b32 s3, s30, 3
    s_mul_i32 s3, s3, 3
    s_lshr_b32 s33, s30, 2
    s_lshl1_add_u32 s3, s33, s3
    s_mul_i32 s44, s31, 11
    s_add_u32 s44, s44, s3
    s_mul_i32 s3, s3, 4352
    s_add_u32 s3, s3, 81920
    v_mul_u32_u24 v13, 272, v8
    v_lshl_add_u32 v12, v9, 3, v13
    v_add_u32 v12, s3, v12
    v_add3_u32 v13, v13, 32, s3
    v_cmp_eq_u32 vcc, 0, v9
    v_add_u32 v2, 208, v13
    v_add_u32 v3, 0, v13
    v_add_u32 v4, 40, v13
    v_cndmask_b32 v19, v2, v3, vcc
    v_cndmask_b32 v20, v2, v4, vcc
    v_lshl_add_u32 v14, v9, 2, v10
    v_mul_u32_u24 v14, 272, v14
    v_add_u32 v5, s3, v14
    v_lshl_add_u32 v14, v11, 3, v5
    v_add_u32 v2, 240, v5
    v_add_u32 v3, 192, v5
    v_add_u32 v4, 232, v5
    v_cmp_eq_u32 vcc, 0, v11
    s_nop 1
    v_cndmask_b32 v21, v2, v3, vcc
    v_cmp_eq_u32 vcc, 1, v11
    s_nop 1
    v_cndmask_b32 v22, v2, v4, vcc
    v_cmp_eq_u32 vcc, 2, v11
    s_nop 1
    v_cndmask_b32 v23, v2, v3, vcc
    v_cmp_eq_u32 vcc, 3, v11
    s_nop 1
    v_cndmask_b32 v24, v2, v4, vcc
    s_lshl_b32 s3, s35, 10
    v_lshl_add_u32 v15, v1, 4, s3
    s_lshl_b32 s3, s35, 8
    s_add_u32 s3, s3, 16384
    v_lshl_add_u32 v16, v8, 4, s3
    v_and_b32 v2, 1, v9
    v_lshl_add_u32 v16, v2, 3, v16
    s_cmp_lt_u32 s30, 4
    s_cselect_b32 s3, 0, 0x800000
    s_add_u32 s3, s3, 20480
    v_lshrrev_b32 v2, 1, v9
    v_mad_u32_u24 v16, v2, s3, v16
    s_mul_i32 s50, s44, 20480
    s_add_u32 s51, s50, 20480
    v_mov_b32 v17, 0xf149f2ca
    v_lshlrev_b32 v2, 2, v9
    v_sub_u32 v2, v8, v2
    s_cmp_eq_u32 s44, 0
    s_cselect_b32 s3, 0xf149f2ca, 0
    v_subrev_u32 v3, 0, v2
    v_and_b32 v4, 0x80000001, v3
    v_cmp_eq_u32 vcc, 0, v4
    s_nop 1
    v_cndmask_b32 v32, v17, 0, vcc
    v_cmp_eq_u32 vcc, 0x80000000, v4
    s_nop 1
    v_cndmask_b32 v28, v17, 0, vcc
    v_add_f32 v36, s3, v28
    v_subrev_u32 v3, 1, v2
    v_and_b32 v4, 0x80000001, v3
    v_cmp_eq_u32 vcc, 0, v4
    s_nop 1
    v_cndmask_b32 v33, v17, 0, vcc
    v_cmp_eq_u32 vcc, 0x80000000, v4
    s_nop 1
    v_cndmask_b32 v29, v17, 0, vcc
    v_add_f32 v37, s3, v29
    v_subrev_u32 v3, 2, v2
    v_and_b32 v4, 0x80000001, v3
    v_cmp_eq_u32 vcc, 0, v4
    s_nop 1
    v_cndmask_b32 v34, v17, 0, vcc
    v_cmp_eq_u32 vcc, 0x80000000, v4
    s_nop 1
    v_cndmask_b32 v30, v17, 0, vcc
    v_add_f32 v38, s3, v30
    v_subrev_u32 v3, 3, v2
    v_and_b32 v4, 0x80000001, v3
    v_cmp_eq_u32 vcc, 0, v4
    s_nop 1
    v_cndmask_b32 v35, v17, 0, vcc
    v_cmp_eq_u32 vcc, 0x80000000, v4
    s_nop 1
    v_cndmask_b32 v31, v17, 0, vcc
    v_add_f32 v39, s3, v31
    v_mov_b32 v3, 0x0c0c0c0c
    v_mov_b32 v4, 0xc0c0100
    v_cmp_eq_u32 vcc, 0, v28
    v_mov_b32 v5, 0x1000c0c
    s_nop 0
    v_cndmask_b32 v3, v3, v4, vcc
    v_cmp_eq_u32 vcc, 0, v29
    s_nop 1
    v_cndmask_b32 v40, v3, v5, vcc
    v_mov_b32 v3, 0x0c0c0c0c
    v_mov_b32 v4, 0xc0c0302
    v_cmp_eq_u32 vcc, 0, v30
    v_mov_b32 v5, 0x3020c0c
    s_nop 0
    v_cndmask_b32 v3, v3, v4, vcc
    v_cmp_eq_u32 vcc, 0, v31
    s_nop 1
    v_cndmask_b32 v41, v3, v5, vcc
    v_mov_b32 v3, 0x0c0c0c0c
    v_mov_b32 v4, 0xc0c0100
    v_cmp_eq_u32 vcc, 0, v32
    v_mov_b32 v5, 0x1000c0c
    s_nop 0
    v_cndmask_b32 v3, v3, v4, vcc
    v_cmp_eq_u32 vcc, 0, v33
    s_nop 1
    v_cndmask_b32 v42, v3, v5, vcc
    v_mov_b32 v3, 0x0c0c0c0c
    v_mov_b32 v4, 0xc0c0302
    v_cmp_eq_u32 vcc, 0, v34
    v_mov_b32 v5, 0x3020c0c
    s_nop 0
    v_cndmask_b32 v3, v3, v4, vcc
    v_cmp_eq_u32 vcc, 0, v35
    s_nop 1
    v_cndmask_b32 v43, v3, v5, vcc
    s_mov_b32 s46, 0x3fb8aa3b
    s_mov_b32 s47, s46
    s_mov_b32 s48, 0x3e64f92e
    s_mov_b32 s49, s48
    s_cmp_eq_u32 s43, 1
    s_cbranch_scc1 K_CONS
    s_mul_i32 s3, s31, 11
    s_add_u32 s33, s3, 10
    s_lshr_b32 s3, s3, 3
    s_lshr_b32 s33, s33, 3
    s_min_u32 s33, s33, 15
    s_sub_u32 s33, s33, s3
    s_add_u32 s33, s33, 1
    s_mul_i32 s33, s33, 10
    s_bfm_b32 s36, s33, 0
    v_mul_u32_u24 v2, 205, v1
    v_lshrrev_b32 v2, 11, v2
    v_add_u32 v2, s3, v2
    v_mul_u32_u24 v2, 1496, v2
    v_lshrrev_b32 v2, 11, v2
    v_sub_u32 v2, s31, v2
    v_and_b32 v2, 1, v2
    v_lshlrev_b32 v2, 6, v2
    v_lshl_add_u32 v2, v1, 8, v2
    s_mul_i32 s3, s3, 2560
    s_lshl_b32 s33, s35, 2
    s_add_u32 s3, s3, s33
    s_add_u32 s3, s3, 524288
    v_add_u32 v18, s3, v2
    v_lshrrev_b32 v2, 3, v1
    v_mul_u32_u24 v2, 1280, v2
    v_lshrrev_b32 v3, 4, v1
    v_lshlrev_b32 v3, 1, v3
    v_and_b32 v4, 7, v1
    v_xor_b32 v3, v3, v4
    v_lshl_add_u32 v2, v3, 4, v2
    s_lshl_b32 s33, s41, 7
    v_add_u32 v17, s33, v2
    s_mov_b32 s61, 9
    s_mov_b32 s3, 40960
K_LOOP:
    s_waitcnt vmcnt(5)
    s_barrier
    s_add_u32 m0, s56, 2048
    s_add_u32 s60, s58, 30720
    buffer_load_dwordx4 v47, s[16:19], s60 offen lds
    s_add_u32 m0, s55, 3072
    s_add_u32 s60, s57, 30720
    buffer_load_dwordx4 v45, s[12:15], s60 offen lds
    s_add_u32 m0, s56, 3072
    s_add_u32 s60, s58, 46080
    buffer_load_dwordx4 v47, s[16:19], s60 offen lds
    s_add_u32 m0, s55, 4096
    s_add_u32 s60, s57, 40960
    buffer_load_dwordx4 v44, s[12:15], s60 offen lds
    s_add_u32 m0, s55, 5120
    s_add_u32 s60, s57, 51200
    buffer_load_dwordx4 v45, s[12:15], s60 offen lds
    s_sub_u32 s61, s61, 1
    s_cmp_eq_u32 s61, 0
    s_cbranch_scc1 K_LOOPX
    s_cmp_ge_u32 s55, 81920
    s_cselect_b32 s60, -81920, s3
    s_add_u32 s55, s55, s60
    s_add_u32 s56, s56, s60
    s_lshl_b32 s57, s59, 7
    s_add_u32 s57, s57, s53
    s_mul_i32 s58, s59, 245760
    s_add_u32 s58, s58, s54
    s_add_u32 s59, s59, 1
    s_cmp_eq_u32 s59, 10
    s_cselect_b32 s59, 0, s59
    s_add_u32 m0, s56, 0
    s_add_u32 s60, s58, 0
    buffer_load_dwordx4 v46, s[16:19], s60 offen lds
    s_add_u32 m0, s55, 0
    s_max_i32 s60, s57, 0
    buffer_load_dwordx4 v44, s[12:15], s60 offen lds
    s_add_u32 m0, s56, 1024
    s_add_u32 s60, s58, 15360
    buffer_load_dwordx4 v46, s[16:19], s60 offen lds
    s_add_u32 s60, s57, 10240
    s_add_u32 m0, s55, 1024
    s_max_i32 s60, s60, 0
    buffer_load_dwordx4 v45, s[12:15], s60 offen lds
    s_add_u32 m0, s55, 2048
    s_add_u32 s60, s57, 20480
    buffer_load_dwordx4 v44, s[12:15], s60 offen lds
    s_branch K_LOOP
K_LOOPX:
    v_mov_b32 v2, 192
    s_waitcnt vmcnt(0)
    s_barrier
    s_cmp_lt_u32 s30, 6
    s_cbranch_scc1 K_NOSMP
    global_load_dword v7, v2, s[8:9] sc1
K_NOSMP:
    s_cmp_eq_u32 s34, -1
    s_cbranch_scc1 K_JOIN_S
    s_lshl_b32 s57, s52, 2
    s_lshr_b32 s57, 0x7520, s57
    s_and_b32 s57, s57, 7
    s_mul_i32 s57, s57, 51200
    s_mul_i32 s58, s52, 5120
    s_add_u32 s3, s57, 0
    s_add_u32 m0, s58, 0
    s_nop 0
    buffer_load_dwordx4 v17, s[24:27], s3 offen lds
    s_add_u32 s3, s57, 10240
    s_add_u32 m0, s58, 1024
    s_nop 0
    buffer_load_dwordx4 v17, s[24:27], s3 offen lds
    s_add_u32 s3, s57, 20480
    s_add_u32 m0, s58, 2048
    s_nop 0
    buffer_load_dwordx4 v17, s[24:27], s3 offen lds
    s_add_u32 s3, s57, 30720
    s_add_u32 m0, s58, 3072
    s_nop 0
    buffer_load_dwordx4 v17, s[24:27], s3 offen lds
    s_add_u32 s3, s57, 40960
    s_add_u32 m0, s58, 4096
    s_nop 0
    buffer_load_dwordx4 v17, s[24:27], s3 offen lds
    s_add_u32 s3, s57, 409600
    s_add_u32 m0, s58, 20480
    s_nop 0
    buffer_load_dwordx4 v17, s[24:27], s3 offen lds
    s_add_u32 s3, s57, 419840
    s_add_u32 m0, s58, 21504
    s_nop 0
    buffer_load_dwordx4 v17, s[24:27], s3 offen lds
    s_add_u32 s3, s57, 430080
    s_add_u32 m0, s58, 22528
    s_nop 0
    buffer_load_dwordx4 v17, s[24:27], s3 offen lds
    s_add_u32 s3, s57, 440320
    s_add_u32 m0, s58, 23552
    s_nop 0
    buffer_load_dwordx4 v17, s[24:27], s3 offen lds
    s_add_u32 s3, s57, 450560
    s_add_u32 m0, s58, 24576
    s_nop 0
    buffer_load_dwordx4 v17, s[24:27], s3 offen lds
    s_branch K_JOIN_S
.p2align 12
K_CONS:
    s_lshr_b32 s52, s30, 1
    s_and_b32 s53, s30, 1
    v_lshrrev_b32 v2, 1, v8
    v_xor_b32 v2, v2, v9
    v_lshlrev_b32 v2, 4, v2
    v_lshl_add_u32 v2, v8, 7, v2
    s_mul_i32 s3, s52, 12288
    v_add_u32 v44, s3, v2
    v_xor_b32 v45, 64, v44
    v_add_u32 v46, 81920, v44
    v_add_u32 v47, 81920, v45
    v_and_b32 v2, 1, v9
    v_lshl_or_b32 v2, v2, 2, v10
    v_lshl_add_u32 v3, v9, 3, v10
    v_lshlrev_b32 v3, 8, v3
    v_lshl_add_u32 v3, v11, 3, v3
    v_add_u32 v3, 24576, v3
    s_lshl_b32 s3, s53, 2
    v_add_u32 v2, s3, v2
    v_add_u32 v4, 0, v2
    v_and_b32 v4, 7, v4
    v_lshl_add_u32 v48, v4, 5, v3
    v_add_u32 v52, 81920, v48
    v_add_u32 v4, 1, v2
    v_and_b32 v4, 7, v4
    v_lshl_add_u32 v49, v4, 5, v3
    v_add_u32 v53, 81920, v49
    v_add_u32 v4, 2, v2
    v_and_b32 v4, 7, v4
    v_lshl_add_u32 v50, v4, 5, v3
    v_add_u32 v54, 81920, v50
    v_add_u32 v4, 3, v2
    v_and_b32 v4, 7, v4
    v_lshl_add_u32 v51, v4, 5, v3
    v_add_u32 v55, 81920, v51
    v_mul_u32_u24 v56, 272, v8
    v_lshl_add_u32 v56, v9, 3, v56
    s_mul_i32 s3, s52, 26112
    s_lshl_b32 s33, s53, 7
    s_add_u32 s3, s3, s33
    s_add_u32 s3, s3, 81920
    v_add_u32 v56, s3, v56
    v_mov_b64 v[60:61], 0
    v_mov_b64 v[62:63], 0
    v_mov_b64 v[64:65], 0
    v_mov_b64 v[66:67], 0
    v_mov_b64 v[68:69], 0
    v_mov_b64 v[70:71], 0
    v_mov_b64 v[72:73], 0
    v_mov_b64 v[74:75], 0
    v_mov_b64 v[76:77], 0
    v_mov_b64 v[78:79], 0
    v_mov_b64 v[80:81], 0
    v_mov_b64 v[82:83], 0
    v_mov_b64 v[84:85], 0
    v_mov_b64 v[86:87], 0
    v_mov_b64 v[88:89], 0
    v_mov_b64 v[90:91], 0
    v_mov_b64 v[92:93], 0
    v_mov_b64 v[94:95], 0
    v_mov_b64 v[96:97], 0
    v_mov_b64 v[98:99], 0
    v_mov_b64 v[100:101], 0
    v_mov_b64 v[102:103], 0
    v_mov_b64 v[104:105], 0
    v_mov_b64 v[106:107], 0
    v_mov_b64 v[108:109], 0
    v_mov_b64 v[110:111], 0
    v_mov_b64 v[112:113], 0
    v_mov_b64 v[114:115], 0
    v_mov_b64 v[116:117], 0
    v_mov_b64 v[118:119], 0
    v_mov_b64 v[120:121], 0
    v_mov_b64 v[122:123], 0
    v_mov_b64 v[124:125], 0
    v_mov_b64 v[126:127], 0
    v_mov_b64 v[128:129], 0
    v_mov_b64 v[130:131], 0
    v_mov_b64 v[132:133], 0
    v_mov_b64 v[134:135], 0
    v_mov_b64 v[136:137], 0
    v_mov_b64 v[138:139], 0
    v_mov_b64 v[140:141], 0
    v_mov_b64 v[142:143], 0
    v_mov_b64 v[144:145], 0
    v_mov_b64 v[146:147], 0
    v_mov_b64 v[148:149], 0
    v_mov_b64 v[150:151], 0
    v_mov_b64 v[152:153], 0
    v_mov_b64 v[154:155], 0
    s_mov_b32 s54, 3
    s_cmp_lg_u32 s30, 0
    s_cbranch_scc1 K_WARMM0
    s_call_b64 s[38:39], WP_attd
    s_call_b64 s[38:39], WP_p2g
    s_branch K_WARMMX
K_WARMM0:
    s_cmp_lg_u32 s30, 1
    s_cbranch_scc1 K_WARMM1
    s_call_b64 s[38:39], WP_atts
    s_call_b64 s[38:39], WP_early
    s_branch K_WARMMX
K_WARMM1:
    s_cmp_lg_u32 s30, 2
    s_cbranch_scc1 K_WARMM2
    s_call_b64 s[38:39], WP_help
    s_call_b64 s[38:39], WP_flags
    s_branch K_WARMMX
K_WARMM2:
    s_call_b64 s[38:39], WP_spin
K_WARMMX:
    s_setprio 2
    s_barrier
    ds_read_b64_tr_b16 v[204:205], v48 offset:40960
    ds_read_b64_tr_b16 v[206:207], v48 offset:41984
    ds_read_b128 v[156:159], v44 offset:40960
    ds_read_b64_tr_b16 v[208:209], v49 offset:40960
    ds_read_b64_tr_b16 v[210:211], v49 offset:41984
    ds_read_b128 v[160:163], v44 offset:43008
    ds_read_b64_tr_b16 v[212:213], v50 offset:40960
    ds_read_b64_tr_b16 v[214:215], v50 offset:41984
    ds_read_b128 v[164:167], v44 offset:45056
    ds_read_b64_tr_b16 v[216:217], v51 offset:40960
    ds_read_b64_tr_b16 v[218:219], v51 offset:41984
    ds_read_b128 v[168:171], v44 offset:47104
    ds_read_b128 v[172:175], v44 offset:49152
    ds_read_b128 v[176:179], v44 offset:51200
K_CLOOP:
    s_waitcnt lgkmcnt(0)
    v_mfma_f32_16x16x32_bf16 v[60:63], v[204:207], v[156:159], v[60:63]
    ds_read_b64_tr_b16 v[220:221], v48 offset:49152
    v_mfma_f32_16x16x32_bf16 v[64:67], v[208:211], v[156:159], v[64:67]
    ds_read_b64_tr_b16 v[222:223], v48 offset:50176
    v_mfma_f32_16x16x32_bf16 v[68:71], v[212:215], v[156:159], v[68:71]
    ds_read_b128 v[180:183], v45 offset:40960
    v_mfma_f32_16x16x32_bf16 v[72:75], v[216:219], v[156:159], v[72:75]
    ds_read_b64_tr_b16 v[224:225], v49 offset:49152
    v_mfma_f32_16x16x32_bf16 v[88:91], v[216:219], v[160:163], v[88:91]
    ds_read_b64_tr_b16 v[226:227], v49 offset:50176
    v_mfma_f32_16x16x32_bf16 v[84:87], v[212:215], v[160:163], v[84:87]
    ds_read_b128 v[184:187], v45 offset:43008
    v_mfma_f32_16x16x32_bf16 v[80:83], v[208:211], v[160:163], v[80:83]
    ds_read_b64_tr_b16 v[228:229], v50 offset:49152
    v_mfma_f32_16x16x32_bf16 v[76:79], v[204:207], v[160:163], v[76:79]
    ds_read_b64_tr_b16 v[230:231], v50 offset:50176
    v_mfma_f32_16x16x32_bf16 v[92:95], v[204:207], v[164:167], v[92:95]
    ds_read_b128 v[188:191], v45 offset:45056
    v_mfma_f32_16x16x32_bf16 v[96:99], v[208:211], v[164:167], v[96:99]
    ds_read_b64_tr_b16 v[232:233], v51 offset:49152
    v_mfma_f32_16x16x32_bf16 v[100:103], v[212:215], v[164:167], v[100:103]
    ds_read_b64_tr_b16 v[234:235], v51 offset:50176
    v_mfma_f32_16x16x32_bf16 v[104:107], v[216:219], v[164:167], v[104:107]
    ds_read_b128 v[192:195], v45 offset:47104
    v_mfma_f32_16x16x32_bf16 v[120:123], v[216:219], v[168:171], v[120:123]
    ds_read_b128 v[196:199], v45 offset:49152
    v_mfma_f32_16x16x32_bf16 v[116:119], v[212:215], v[168:171], v[116:119]
    ds_read_b128 v[200:203], v45 offset:51200
    v_mfma_f32_16x16x32_bf16 v[112:115], v[208:211], v[168:171], v[112:115]
    v_mfma_f32_16x16x32_bf16 v[108:111], v[204:207], v[168:171], v[108:111]
    v_mfma_f32_16x16x32_bf16 v[124:127], v[204:207], v[172:175], v[124:127]
    v_mfma_f32_16x16x32_bf16 v[128:131], v[208:211], v[172:175], v[128:131]
    v_mfma_f32_16x16x32_bf16 v[132:135], v[212:215], v[172:175], v[132:135]
    v_mfma_f32_16x16x32_bf16 v[136:139], v[216:219], v[172:175], v[136:139]
    v_mfma_f32_16x16x32_bf16 v[152:155], v[216:219], v[176:179], v[152:155]
    v_mfma_f32_16x16x32_bf16 v[148:151], v[212:215], v[176:179], v[148:151]
    v_mfma_f32_16x16x32_bf16 v[144:147], v[208:211], v[176:179], v[144:147]
    v_mfma_f32_16x16x32_bf16 v[140:143], v[204:207], v[176:179], v[140:143]
    s_waitcnt lgkmcnt(0)
    s_barrier
    v_mfma_f32_16x16x32_bf16 v[60:63], v[220:223], v[180:183], v[60:63]
    ds_read_b64_tr_b16 v[204:205], v52 offset:0
    v_mfma_f32_16x16x32_bf16 v[64:67], v[224:227], v[180:183], v[64:67]
    ds_read_b64_tr_b16 v[206:207], v52 offset:1024
    v_mfma_f32_16x16x32_bf16 v[68:71], v[228:231], v[180:183], v[68:71]
    ds_read_b128 v[156:159], v46 offset:0
    v_mfma_f32_16x16x32_bf16 v[72:75], v[232:235], v[180:183], v[72:75]
    ds_read_b64_tr_b16 v[208:209], v53 offset:0
    v_mfma_f32_16x16x32_bf16 v[88:91], v[232:235], v[184:187], v[88:91]
    ds_read_b64_tr_b16 v[210:211], v53 offset:1024
    v_mfma_f32_16x16x32_bf16 v[84:87], v[228:231], v[184:187], v[84:87]
    ds_read_b128 v[160:163], v46 offset:2048
    v_mfma_f32_16x16x32_bf16 v[80:83], v[224:227], v[184:187], v[80:83]
    ds_read_b64_tr_b16 v[212:213], v54 offset:0
    v_mfma_f32_16x16x32_bf16 v[76:79], v[220:223], v[184:187], v[76:79]
    ds_read_b64_tr_b16 v[214:215], v54 offset:1024
    v_mfma_f32_16x16x32_bf16 v[92:95], v[220:223], v[188:191], v[92:95]
    ds_read_b128 v[164:167], v46 offset:4096
    v_mfma_f32_16x16x32_bf16 v[96:99], v[224:227], v[188:191], v[96:99]
    ds_read_b64_tr_b16 v[216:217], v55 offset:0
    v_mfma_f32_16x16x32_bf16 v[100:103], v[228:231], v[188:191], v[100:103]
    ds_read_b64_tr_b16 v[218:219], v55 offset:1024
    v_mfma_f32_16x16x32_bf16 v[104:107], v[232:235], v[188:191], v[104:107]
    ds_read_b128 v[168:171], v46 offset:6144
    v_mfma_f32_16x16x32_bf16 v[120:123], v[232:235], v[192:195], v[120:123]
    ds_read_b128 v[172:175], v46 offset:8192
    v_mfma_f32_16x16x32_bf16 v[116:119], v[228:231], v[192:195], v[116:119]
    ds_read_b128 v[176:179], v46 offset:10240
    v_mfma_f32_16x16x32_bf16 v[112:115], v[224:227], v[192:195], v[112:115]
    v_mfma_f32_16x16x32_bf16 v[108:111], v[220:223], v[192:195], v[108:111]
    v_mfma_f32_16x16x32_bf16 v[124:127], v[220:223], v[196:199], v[124:127]
    v_mfma_f32_16x16x32_bf16 v[128:131], v[224:227], v[196:199], v[128:131]
    v_mfma_f32_16x16x32_bf16 v[132:135], v[228:231], v[196:199], v[132:135]
    v_mfma_f32_16x16x32_bf16 v[136:139], v[232:235], v[196:199], v[136:139]
    v_mfma_f32_16x16x32_bf16 v[152:155], v[232:235], v[200:203], v[152:155]
    v_mfma_f32_16x16x32_bf16 v[148:151], v[228:231], v[200:203], v[148:151]
    v_mfma_f32_16x16x32_bf16 v[144:147], v[224:227], v[200:203], v[144:147]
    v_mfma_f32_16x16x32_bf16 v[140:143], v[220:223], v[200:203], v[140:143]
    s_waitcnt lgkmcnt(0)
    v_mfma_f32_16x16x32_bf16 v[60:63], v[204:207], v[156:159], v[60:63]
    ds_read_b64_tr_b16 v[220:221], v52 offset:8192
    v_mfma_f32_16x16x32_bf16 v[64:67], v[208:211], v[156:159], v[64:67]
    ds_read_b64_tr_b16 v[222:223], v52 offset:9216
    v_mfma_f32_16x16x32_bf16 v[68:71], v[212:215], v[156:159], v[68:71]
    ds_read_b128 v[180:183], v47 offset:0
    v_mfma_f32_16x16x32_bf16 v[72:75], v[216:219], v[156:159], v[72:75]
    ds_read_b64_tr_b16 v[224:225], v53 offset:8192
    v_mfma_f32_16x16x32_bf16 v[88:91], v[216:219], v[160:163], v[88:91]
    ds_read_b64_tr_b16 v[226:227], v53 offset:9216
    v_mfma_f32_16x16x32_bf16 v[84:87], v[212:215], v[160:163], v[84:87]
    ds_read_b128 v[184:187], v47 offset:2048
    v_mfma_f32_16x16x32_bf16 v[80:83], v[208:211], v[160:163], v[80:83]
    ds_read_b64_tr_b16 v[228:229], v54 offset:8192
    v_mfma_f32_16x16x32_bf16 v[76:79], v[204:207], v[160:163], v[76:79]
    ds_read_b64_tr_b16 v[230:231], v54 offset:9216
    v_mfma_f32_16x16x32_bf16 v[92:95], v[204:207], v[164:167], v[92:95]
    ds_read_b128 v[188:191], v47 offset:4096
    v_mfma_f32_16x16x32_bf16 v[96:99], v[208:211], v[164:167], v[96:99]
    ds_read_b64_tr_b16 v[232:233], v55 offset:8192
    v_mfma_f32_16x16x32_bf16 v[100:103], v[212:215], v[164:167], v[100:103]
    ds_read_b64_tr_b16 v[234:235], v55 offset:9216
    v_mfma_f32_16x16x32_bf16 v[104:107], v[216:219], v[164:167], v[104:107]
    ds_read_b128 v[192:195], v47 offset:6144
    v_mfma_f32_16x16x32_bf16 v[120:123], v[216:219], v[168:171], v[120:123]
    ds_read_b128 v[196:199], v47 offset:8192
    v_mfma_f32_16x16x32_bf16 v[116:119], v[212:215], v[168:171], v[116:119]
    ds_read_b128 v[200:203], v47 offset:10240
    v_mfma_f32_16x16x32_bf16 v[112:115], v[208:211], v[168:171], v[112:115]
    v_mfma_f32_16x16x32_bf16 v[108:111], v[204:207], v[168:171], v[108:111]
    v_mfma_f32_16x16x32_bf16 v[124:127], v[204:207], v[172:175], v[124:127]
    v_mfma_f32_16x16x32_bf16 v[128:131], v[208:211], v[172:175], v[128:131]
    v_mfma_f32_16x16x32_bf16 v[132:135], v[212:215], v[172:175], v[132:135]
    v_mfma_f32_16x16x32_bf16 v[136:139], v[216:219], v[172:175], v[136:139]
    v_mfma_f32_16x16x32_bf16 v[152:155], v[216:219], v[176:179], v[152:155]
    v_mfma_f32_16x16x32_bf16 v[148:151], v[212:215], v[176:179], v[148:151]
    v_mfma_f32_16x16x32_bf16 v[144:147], v[208:211], v[176:179], v[144:147]
    v_mfma_f32_16x16x32_bf16 v[140:143], v[204:207], v[176:179], v[140:143]
    s_waitcnt lgkmcnt(0)
    s_barrier
    v_mfma_f32_16x16x32_bf16 v[60:63], v[220:223], v[180:183], v[60:63]
    ds_read_b64_tr_b16 v[204:205], v48 offset:0
    v_mfma_f32_16x16x32_bf16 v[64:67], v[224:227], v[180:183], v[64:67]
    ds_read_b64_tr_b16 v[206:207], v48 offset:1024
    v_mfma_f32_16x16x32_bf16 v[68:71], v[228:231], v[180:183], v[68:71]
    ds_read_b128 v[156:159], v44 offset:0
    v_mfma_f32_16x16x32_bf16 v[72:75], v[232:235], v[180:183], v[72:75]
    ds_read_b64_tr_b16 v[208:209], v49 offset:0
    v_mfma_f32_16x16x32_bf16 v[88:91], v[232:235], v[184:187], v[88:91]
    ds_read_b64_tr_b16 v[210:211], v49 offset:1024
    v_mfma_f32_16x16x32_bf16 v[84:87], v[228:231], v[184:187], v[84:87]
    ds_read_b128 v[160:163], v44 offset:2048
    v_mfma_f32_16x16x32_bf16 v[80:83], v[224:227], v[184:187], v[80:83]
    ds_read_b64_tr_b16 v[212:213], v50 offset:0
    v_mfma_f32_16x16x32_bf16 v[76:79], v[220:223], v[184:187], v[76:79]
    ds_read_b64_tr_b16 v[214:215], v50 offset:1024
    v_mfma_f32_16x16x32_bf16 v[92:95], v[220:223], v[188:191], v[92:95]
    ds_read_b128 v[164:167], v44 offset:4096
    v_mfma_f32_16x16x32_bf16 v[96:99], v[224:227], v[188:191], v[96:99]
    ds_read_b64_tr_b16 v[216:217], v51 offset:0
    v_mfma_f32_16x16x32_bf16 v[100:103], v[228:231], v[188:191], v[100:103]
    ds_read_b64_tr_b16 v[218:219], v51 offset:1024
    v_mfma_f32_16x16x32_bf16 v[104:107], v[232:235], v[188:191], v[104:107]
    ds_read_b128 v[168:171], v44 offset:6144
    v_mfma_f32_16x16x32_bf16 v[120:123], v[232:235], v[192:195], v[120:123]
    ds_read_b128 v[172:175], v44 offset:8192
    v_mfma_f32_16x16x32_bf16 v[116:119], v[228:231], v[192:195], v[116:119]
    ds_read_b128 v[176:179], v44 offset:10240
    v_mfma_f32_16x16x32_bf16 v[112:115], v[224:227], v[192:195], v[112:115]
    v_mfma_f32_16x16x32_bf16 v[108:111], v[220:223], v[192:195], v[108:111]
    v_mfma_f32_16x16x32_bf16 v[124:127], v[220:223], v[196:199], v[124:127]
    v_mfma_f32_16x16x32_bf16 v[128:131], v[224:227], v[196:199], v[128:131]
    v_mfma_f32_16x16x32_bf16 v[132:135], v[228:231], v[196:199], v[132:135]
    v_mfma_f32_16x16x32_bf16 v[136:139], v[232:235], v[196:199], v[136:139]
    v_mfma_f32_16x16x32_bf16 v[152:155], v[232:235], v[200:203], v[152:155]
    v_mfma_f32_16x16x32_bf16 v[148:151], v[228:231], v[200:203], v[148:151]
    v_mfma_f32_16x16x32_bf16 v[144:147], v[224:227], v[200:203], v[144:147]
    v_mfma_f32_16x16x32_bf16 v[140:143], v[220:223], v[200:203], v[140:143]
    s_waitcnt lgkmcnt(0)
    v_mfma_f32_16x16x32_bf16 v[60:63], v[204:207], v[156:159], v[60:63]
    ds_read_b64_tr_b16 v[220:221], v48 offset:8192
    v_mfma_f32_16x16x32_bf16 v[64:67], v[208:211], v[156:159], v[64:67]
    ds_read_b64_tr_b16 v[222:223], v48 offset:9216
    v_mfma_f32_16x16x32_bf16 v[68:71], v[212:215], v[156:159], v[68:71]
    ds_read_b128 v[180:183], v45 offset:0
    v_mfma_f32_16x16x32_bf16 v[72:75], v[216:219], v[156:159], v[72:75]
    ds_read_b64_tr_b16 v[224:225], v49 offset:8192
    v_mfma_f32_16x16x32_bf16 v[88:91], v[216:219], v[160:163], v[88:91]
    ds_read_b64_tr_b16 v[226:227], v49 offset:9216
    v_mfma_f32_16x16x32_bf16 v[84:87], v[212:215], v[160:163], v[84:87]
    ds_read_b128 v[184:187], v45 offset:2048
    v_mfma_f32_16x16x32_bf16 v[80:83], v[208:211], v[160:163], v[80:83]
    ds_read_b64_tr_b16 v[228:229], v50 offset:8192
    v_mfma_f32_16x16x32_bf16 v[76:79], v[204:207], v[160:163], v[76:79]
    ds_read_b64_tr_b16 v[230:231], v50 offset:9216
    v_mfma_f32_16x16x32_bf16 v[92:95], v[204:207], v[164:167], v[92:95]
    ds_read_b128 v[188:191], v45 offset:4096
    v_mfma_f32_16x16x32_bf16 v[96:99], v[208:211], v[164:167], v[96:99]
    ds_read_b64_tr_b16 v[232:233], v51 offset:8192
    v_mfma_f32_16x16x32_bf16 v[100:103], v[212:215], v[164:167], v[100:103]
    ds_read_b64_tr_b16 v[234:235], v51 offset:9216
    v_mfma_f32_16x16x32_bf16 v[104:107], v[216:219], v[164:167], v[104:107]
    ds_read_b128 v[192:195], v45 offset:6144
    v_mfma_f32_16x16x32_bf16 v[120:123], v[216:219], v[168:171], v[120:123]
    ds_read_b128 v[196:199], v45 offset:8192
    v_mfma_f32_16x16x32_bf16 v[116:119], v[212:215], v[168:171], v[116:119]
    ds_read_b128 v[200:203], v45 offset:10240
    v_mfma_f32_16x16x32_bf16 v[112:115], v[208:211], v[168:171], v[112:115]
    v_mfma_f32_16x16x32_bf16 v[108:111], v[204:207], v[168:171], v[108:111]
    v_mfma_f32_16x16x32_bf16 v[124:127], v[204:207], v[172:175], v[124:127]
    v_mfma_f32_16x16x32_bf16 v[128:131], v[208:211], v[172:175], v[128:131]
    v_mfma_f32_16x16x32_bf16 v[132:135], v[212:215], v[172:175], v[132:135]
    v_mfma_f32_16x16x32_bf16 v[136:139], v[216:219], v[172:175], v[136:139]
    v_mfma_f32_16x16x32_bf16 v[152:155], v[216:219], v[176:179], v[152:155]
    v_mfma_f32_16x16x32_bf16 v[148:151], v[212:215], v[176:179], v[148:151]
    v_mfma_f32_16x16x32_bf16 v[144:147], v[208:211], v[176:179], v[144:147]
    v_mfma_f32_16x16x32_bf16 v[140:143], v[204:207], v[176:179], v[140:143]
    s_waitcnt lgkmcnt(0)
    s_barrier
    v_mfma_f32_16x16x32_bf16 v[60:63], v[220:223], v[180:183], v[60:63]
    ds_read_b64_tr_b16 v[204:205], v48 offset:40960
    v_mfma_f32_16x16x32_bf16 v[64:67], v[224:227], v[180:183], v[64:67]
    ds_read_b64_tr_b16 v[206:207], v48 offset:41984
    v_mfma_f32_16x16x32_bf16 v[68:71], v[228:231], v[180:183], v[68:71]
    ds_read_b128 v[156:159], v44 offset:40960
    v_mfma_f32_16x16x32_bf16 v[72:75], v[232:235], v[180:183], v[72:75]
    ds_read_b64_tr_b16 v[208:209], v49 offset:40960
    v_mfma_f32_16x16x32_bf16 v[88:91], v[232:235], v[184:187], v[88:91]
    ds_read_b64_tr_b16 v[210:211], v49 offset:41984
    v_mfma_f32_16x16x32_bf16 v[84:87], v[228:231], v[184:187], v[84:87]
    ds_read_b128 v[160:163], v44 offset:43008
    v_mfma_f32_16x16x32_bf16 v[80:83], v[224:227], v[184:187], v[80:83]
    ds_read_b64_tr_b16 v[212:213], v50 offset:40960
    v_mfma_f32_16x16x32_bf16 v[76:79], v[220:223], v[184:187], v[76:79]
    ds_read_b64_tr_b16 v[214:215], v50 offset:41984
    v_mfma_f32_16x16x32_bf16 v[92:95], v[220:223], v[188:191], v[92:95]
    ds_read_b128 v[164:167], v44 offset:45056
    v_mfma_f32_16x16x32_bf16 v[96:99], v[224:227], v[188:191], v[96:99]
    ds_read_b64_tr_b16 v[216:217], v51 offset:40960
    v_mfma_f32_16x16x32_bf16 v[100:103], v[228:231], v[188:191], v[100:103]
    ds_read_b64_tr_b16 v[218:219], v51 offset:41984
    v_mfma_f32_16x16x32_bf16 v[104:107], v[232:235], v[188:191], v[104:107]
    ds_read_b128 v[168:171], v44 offset:47104
    v_mfma_f32_16x16x32_bf16 v[120:123], v[232:235], v[192:195], v[120:123]
    ds_read_b128 v[172:175], v44 offset:49152
    v_mfma_f32_16x16x32_bf16 v[116:119], v[228:231], v[192:195], v[116:119]
    ds_read_b128 v[176:179], v44 offset:51200
    v_mfma_f32_16x16x32_bf16 v[112:115], v[224:227], v[192:195], v[112:115]
    s_sub_u32 s54, s54, 1
    v_mfma_f32_16x16x32_bf16 v[108:111], v[220:223], v[192:195], v[108:111]
    s_cmp_lg_u32 s54, 0
    v_mfma_f32_16x16x32_bf16 v[124:127], v[220:223], v[196:199], v[124:127]
    v_mfma_f32_16x16x32_bf16 v[128:131], v[224:227], v[196:199], v[128:131]
    v_mfma_f32_16x16x32_bf16 v[132:135], v[228:231], v[196:199], v[132:135]
    v_mfma_f32_16x16x32_bf16 v[136:139], v[232:235], v[196:199], v[136:139]
    v_mfma_f32_16x16x32_bf16 v[152:155], v[232:235], v[200:203], v[152:155]
    v_mfma_f32_16x16x32_bf16 v[148:151], v[228:231], v[200:203], v[148:151]
    v_mfma_f32_16x16x32_bf16 v[144:147], v[224:227], v[200:203], v[144:147]
    v_mfma_f32_16x16x32_bf16 v[140:143], v[220:223], v[200:203], v[140:143]
    s_cbranch_scc1 K_CLOOP
    s_waitcnt lgkmcnt(0)
    v_mfma_f32_16x16x32_bf16 v[60:63], v[204:207], v[156:159], v[60:63]
    ds_read_b64_tr_b16 v[220:221], v48 offset:49152
    v_mfma_f32_16x16x32_bf16 v[64:67], v[208:211], v[156:159], v[64:67]
    ds_read_b64_tr_b16 v[222:223], v48 offset:50176
    v_mfma_f32_16x16x32_bf16 v[68:71], v[212:215], v[156:159], v[68:71]
    ds_read_b128 v[180:183], v45 offset:40960
    v_mfma_f32_16x16x32_bf16 v[72:75], v[216:219], v[156:159], v[72:75]
    ds_read_b64_tr_b16 v[224:225], v49 offset:49152
    v_mfma_f32_16x16x32_bf16 v[76:79], v[204:207], v[160:163], v[76:79]
    ds_read_b64_tr_b16 v[226:227], v49 offset:50176
    v_mfma_f32_16x16x32_bf16 v[80:83], v[208:211], v[160:163], v[80:83]
    ds_read_b128 v[184:187], v45 offset:43008
    v_mfma_f32_16x16x32_bf16 v[84:87], v[212:215], v[160:163], v[84:87]
    ds_read_b64_tr_b16 v[228:229], v50 offset:49152
    v_mfma_f32_16x16x32_bf16 v[88:91], v[216:219], v[160:163], v[88:91]
    ds_read_b64_tr_b16 v[230:231], v50 offset:50176
    v_mfma_f32_16x16x32_bf16 v[92:95], v[204:207], v[164:167], v[92:95]
    ds_read_b128 v[188:191], v45 offset:45056
    v_mfma_f32_16x16x32_bf16 v[96:99], v[208:211], v[164:167], v[96:99]
    ds_read_b64_tr_b16 v[232:233], v51 offset:49152
    v_mfma_f32_16x16x32_bf16 v[100:103], v[212:215], v[164:167], v[100:103]
    ds_read_b64_tr_b16 v[234:235], v51 offset:50176
    v_mfma_f32_16x16x32_bf16 v[104:107], v[216:219], v[164:167], v[104:107]
    ds_read_b128 v[192:195], v45 offset:47104
    v_mfma_f32_16x16x32_bf16 v[108:111], v[204:207], v[168:171], v[108:111]
    ds_read_b128 v[196:199], v45 offset:49152
    v_mfma_f32_16x16x32_bf16 v[112:115], v[208:211], v[168:171], v[112:115]
    ds_read_b128 v[200:203], v45 offset:51200
    v_mfma_f32_16x16x32_bf16 v[116:119], v[212:215], v[168:171], v[116:119]
    v_mfma_f32_16x16x32_bf16 v[120:123], v[216:219], v[168:171], v[120:123]
    s_waitcnt lgkmcnt(0)
    v_mfma_f32_16x16x32_bf16 v[60:63], v[220:223], v[180:183], v[60:63]
    v_mfma_f32_16x16x32_bf16 v[64:67], v[224:227], v[180:183], v[64:67]
    v_mfma_f32_16x16x32_bf16 v[68:71], v[228:231], v[180:183], v[68:71]
    v_mfma_f32_16x16x32_bf16 v[72:75], v[232:235], v[180:183], v[72:75]
    v_mfma_f32_16x16x32_bf16 v[76:79], v[220:223], v[184:187], v[76:79]
    v_mfma_f32_16x16x32_bf16 v[80:83], v[224:227], v[184:187], v[80:83]
    v_mfma_f32_16x16x32_bf16 v[84:87], v[228:231], v[184:187], v[84:87]
    v_mfma_f32_16x16x32_bf16 v[88:91], v[232:235], v[184:187], v[88:91]
    v_mfma_f32_16x16x32_bf16 v[92:95], v[220:223], v[188:191], v[92:95]
    v_cvt_pk_bf16_f32 v236, v60, v61
    v_cvt_pk_bf16_f32 v237, v62, v63
    ds_write_b64 v56, v[236:237] offset:0
    v_mfma_f32_16x16x32_bf16 v[96:99], v[224:227], v[188:191], v[96:99]
    v_cvt_pk_bf16_f32 v238, v64, v65
    v_cvt_pk_bf16_f32 v239, v66, v67
    ds_write_b64 v56, v[238:239] offset:32
    v_mfma_f32_16x16x32_bf16 v[100:103], v[228:231], v[188:191], v[100:103]
    v_cvt_pk_bf16_f32 v240, v68, v69
    v_cvt_pk_bf16_f32 v241, v70, v71
    ds_write_b64 v56, v[240:241] offset:64
    v_mfma_f32_16x16x32_bf16 v[104:107], v[232:235], v[188:191], v[104:107]
    v_cvt_pk_bf16_f32 v242, v72, v73
    v_cvt_pk_bf16_f32 v243, v74, v75
    ds_write_b64 v56, v[242:243] offset:96
    v_mfma_f32_16x16x32_bf16 v[108:111], v[220:223], v[192:195], v[108:111]
    v_cvt_pk_bf16_f32 v236, v76, v77
    v_cvt_pk_bf16_f32 v237, v78, v79
    ds_write_b64 v56, v[236:237] offset:4352
    v_mfma_f32_16x16x32_bf16 v[112:115], v[224:227], v[192:195], v[112:115]
    v_cvt_pk_bf16_f32 v238, v80, v81
    v_cvt_pk_bf16_f32 v239, v82, v83
    ds_write_b64 v56, v[238:239] offset:4384
    v_mfma_f32_16x16x32_bf16 v[116:119], v[228:231], v[192:195], v[116:119]
    v_cvt_pk_bf16_f32 v240, v84, v85
    v_cvt_pk_bf16_f32 v241, v86, v87
    ds_write_b64 v56, v[240:241] offset:4416
    v_mfma_f32_16x16x32_bf16 v[120:123], v[232:235], v[192:195], v[120:123]
    v_cvt_pk_bf16_f32 v242, v88, v89
    v_cvt_pk_bf16_f32 v243, v90, v91
    ds_write_b64 v56, v[242:243] offset:4448
    v_mfma_f32_16x16x32_bf16 v[124:127], v[204:207], v[172:175], v[124:127]
    v_cvt_pk_bf16_f32 v236, v92, v93
    v_cvt_pk_bf16_f32 v237, v94, v95
    ds_write_b64 v56, v[236:237] offset:8704
    v_mfma_f32_16x16x32_bf16 v[128:131], v[208:211], v[172:175], v[128:131]
    v_cvt_pk_bf16_f32 v238, v96, v97
    v_cvt_pk_bf16_f32 v239, v98, v99
    ds_write_b64 v56, v[238:239] offset:8736
    v_mfma_f32_16x16x32_bf16 v[132:135], v[212:215], v[172:175], v[132:135]
    v_cvt_pk_bf16_f32 v240, v100, v101
    v_cvt_pk_bf16_f32 v241, v102, v103
    ds_write_b64 v56, v[240:241] offset:8768
    v_mfma_f32_16x16x32_bf16 v[136:139], v[216:219], v[172:175], v[136:139]
    v_cvt_pk_bf16_f32 v242, v104, v105
    v_cvt_pk_bf16_f32 v243, v106, v107
    ds_write_b64 v56, v[242:243] offset:8800
    v_mfma_f32_16x16x32_bf16 v[124:127], v[220:223], v[196:199], v[124:127]
    v_cvt_pk_bf16_f32 v236, v108, v109
    v_cvt_pk_bf16_f32 v237, v110, v111
    ds_write_b64 v56, v[236:237] offset:13056
    v_mfma_f32_16x16x32_bf16 v[128:131], v[224:227], v[196:199], v[128:131]
    v_cvt_pk_bf16_f32 v238, v112, v113
    v_cvt_pk_bf16_f32 v239, v114, v115
    ds_write_b64 v56, v[238:239] offset:13088
    v_mfma_f32_16x16x32_bf16 v[132:135], v[228:231], v[196:199], v[132:135]
    v_cvt_pk_bf16_f32 v240, v116, v117
    v_cvt_pk_bf16_f32 v241, v118, v119
    ds_write_b64 v56, v[240:241] offset:13120
    v_mfma_f32_16x16x32_bf16 v[136:139], v[232:235], v[196:199], v[136:139]
    v_cvt_pk_bf16_f32 v242, v120, v121
    v_cvt_pk_bf16_f32 v243, v122, v123
    ds_write_b64 v56, v[242:243] offset:13152
    v_mfma_f32_16x16x32_bf16 v[140:143], v[204:207], v[176:179], v[140:143]
    v_cvt_pk_bf16_f32 v236, v124, v125
    v_cvt_pk_bf16_f32 v237, v126, v127
    ds_write_b64 v56, v[236:237] offset:17408
    v_mfma_f32_16x16x32_bf16 v[144:147], v[208:211], v[176:179], v[144:147]
    v_cvt_pk_bf16_f32 v238, v128, v129
    v_cvt_pk_bf16_f32 v239, v130, v131
    ds_write_b64 v56, v[238:239] offset:17440
    v_mfma_f32_16x16x32_bf16 v[148:151], v[212:215], v[176:179], v[148:151]
    v_cvt_pk_bf16_f32 v240, v132, v133
    v_cvt_pk_bf16_f32 v241, v134, v135
    ds_write_b64 v56, v[240:241] offset:17472
    v_mfma_f32_16x16x32_bf16 v[152:155], v[216:219], v[176:179], v[152:155]
    v_cvt_pk_bf16_f32 v242, v136, v137
    v_cvt_pk_bf16_f32 v243, v138, v139
    ds_write_b64 v56, v[242:243] offset:17504
    v_mfma_f32_16x16x32_bf16 v[140:143], v[220:223], v[200:203], v[140:143]
    v_mfma_f32_16x16x32_bf16 v[144:147], v[224:227], v[200:203], v[144:147]
    v_mfma_f32_16x16x32_bf16 v[148:151], v[228:231], v[200:203], v[148:151]
    v_mfma_f32_16x16x32_bf16 v[152:155], v[232:235], v[200:203], v[152:155]
    s_nop 7
    v_cvt_pk_bf16_f32 v236, v140, v141
    v_cvt_pk_bf16_f32 v237, v142, v143
    ds_write_b64 v56, v[236:237] offset:21760
    v_cvt_pk_bf16_f32 v238, v144, v145
    v_cvt_pk_bf16_f32 v239, v146, v147
    ds_write_b64 v56, v[238:239] offset:21792
    v_cvt_pk_bf16_f32 v240, v148, v149
    v_cvt_pk_bf16_f32 v241, v150, v151
    ds_write_b64 v56, v[240:241] offset:21824
    v_cvt_pk_bf16_f32 v242, v152, v153
    v_cvt_pk_bf16_f32 v243, v154, v155
    ds_write_b64 v56, v[242:243] offset:21856
    s_setprio 0
    s_branch WS_attd
.p2align 12
WP_attd:
    s_setpc_b64 s[38:39]
WS_attd:
    s_waitcnt vmcnt(0) lgkmcnt(0)
    s_barrier
    ds_read_b64 v[60:61], v12 offset:80
    ds_read_b64 v[62:63], v13 offset:80
    ds_read_b64 v[44:45], v12 offset:4352
    ds_read_b64 v[46:47], v19 offset:4352
    ds_read_b64 v[64:65], v12 offset:4432
    ds_read_b64 v[66:67], v13 offset:4432
    ds_read_b64 v[72:73], v12 offset:120
    ds_read_b64 v[74:75], v13 offset:120
    ds_read_b64 v[48:49], v12 offset:4392
    ds_read_b64 v[50:51], v20 offset:4352
    ds_read_b64 v[76:77], v12 offset:4472
    ds_read_b64 v[78:79], v13 offset:4472
    ds_read_b64 v[52:53], v12 offset:8704
    ds_read_b64 v[54:55], v19 offset:8704
    ds_read_b64 v[68:69], v12 offset:8784
    ds_read_b64 v[70:71], v13 offset:8784
    s_waitcnt lgkmcnt(10)
    v_mfma_f32_16x16x32_bf16 v[116:119], v[60:63], v[44:47], v[36:39]
    v_mfma_f32_16x16x32_bf16 v[120:123], v[64:67], v[44:47], v[32:35]
    ds_read_b64 v[56:57], v12 offset:8744
    ds_read_b64 v[58:59], v20 offset:8704
    ds_read_b64 v[80:81], v12 offset:8824
    ds_read_b64 v[82:83], v13 offset:8824
    s_waitcnt lgkmcnt(8)
    v_mfma_f32_16x16x32_bf16 v[124:127], v[72:75], v[48:51], v[36:39]
    v_mfma_f32_16x16x32_bf16 v[128:131], v[76:79], v[48:51], v[32:35]
    s_waitcnt lgkmcnt(4)
    v_mfma_f32_16x16x32_bf16 v[132:135], v[64:67], v[52:55], v[28:31]
    v_mfma_f32_16x16x32_bf16 v[136:139], v[68:71], v[52:55], v[32:35]
    s_waitcnt lgkmcnt(0)
    v_mfma_f32_16x16x32_bf16 v[140:143], v[76:79], v[56:59], v[28:31]
    v_mfma_f32_16x16x32_bf16 v[144:147], v[80:83], v[56:59], v[32:35]
    ds_read_b64_tr_b16 v[84:85], v14 offset:160
    ds_read_b64_tr_b16 v[86:87], v14 offset:4512
    ds_read_b64_tr_b16 v[100:101], v21 offset:0
    ds_read_b64_tr_b16 v[102:103], v21 offset:4352
    v_max3_f32 v184, v116, v117, v120
    ds_read_b64_tr_b16 v[92:93], v14 offset:200
    v_max3_f32 v185, v118, v119, v122
    ds_read_b64_tr_b16 v[94:95], v14 offset:4552
    v_max_f32 v184, v184, v121
    ds_read_b64_tr_b16 v[104:105], v22 offset:0
    v_max_f32 v185, v185, v123
    ds_read_b64_tr_b16 v[106:107], v22 offset:4352
    v_max3_f32 v186, v124, v125, v128
    ds_read_b64_tr_b16 v[88:89], v14 offset:8864
    v_max3_f32 v187, v126, v127, v130
    ds_read_b64_tr_b16 v[108:109], v23 offset:4352
    v_max_f32 v186, v186, v129
    ds_read_b64_tr_b16 v[110:111], v23 offset:8704
    v_max_f32 v187, v187, v131
    ds_read_b64_tr_b16 v[96:97], v14 offset:8904
    v_max3_f32 v188, v132, v133, v136
    ds_read_b64_tr_b16 v[112:113], v24 offset:4352
    v_max3_f32 v189, v134, v135, v138
    ds_read_b64_tr_b16 v[114:115], v24 offset:8704
    v_max_f32 v188, v188, v137
    v_max_f32 v189, v189, v139
    v_max3_f32 v190, v140, v141, v144
    v_max3_f32 v191, v142, v143, v146
    v_max_f32 v190, v190, v145
    v_max_f32 v191, v191, v147
    v_cvt_pk_bf16_f32 v192, v184, v185
    v_cvt_pk_bf16_f32 v193, v186, v187
    v_cvt_pk_bf16_f32 v194, v188, v189
    v_cvt_pk_bf16_f32 v195, v190, v191
    v_lshlrev_b32 v184, 16, v192
    v_and_b32 v185, 0xffff0000, v192
    v_lshlrev_b32 v186, 16, v193
    v_and_b32 v187, 0xffff0000, v193
    v_lshlrev_b32 v188, 16, v194
    v_and_b32 v189, 0xffff0000, v194
    v_lshlrev_b32 v190, 16, v195
    v_and_b32 v191, 0xffff0000, v195
    v_pk_mul_f32 v[184:185], v[184:185], s[48:49]
    v_pk_mul_f32 v[186:187], v[186:187], s[48:49]
    v_pk_mul_f32 v[188:189], v[188:189], s[48:49]
    v_pk_mul_f32 v[190:191], v[190:191], s[48:49]
    v_cvt_pk_bf16_f32 v192, v184, v185
    v_cvt_pk_bf16_f32 v193, v186, v187
    v_cvt_pk_bf16_f32 v194, v188, v189
    v_cvt_pk_bf16_f32 v195, v190, v191
    v_permlane16_swap_b32 v192, v193
    s_nop 0
    v_permlane16_swap_b32 v194, v195
    s_nop 1
    v_permlane32_swap_b32 v192, v194
    v_permlane32_swap_b32 v193, v195
    v_lshlrev_b32 v184, 16, v192
    v_and_b32 v185, 0xffff0000, v192
    v_lshlrev_b32 v188, 16, v194
    v_and_b32 v189, 0xffff0000, v194
    v_lshlrev_b32 v186, 16, v193
    v_and_b32 v187, 0xffff0000, v193
    v_lshlrev_b32 v190, 16, v195
    v_and_b32 v191, 0xffff0000, v195
    v_max3_f32 v196, v184, v185, v188
    v_max3_f32 v197, v189, v186, v187
    v_max3_f32 v196, v196, v190, v191
    v_max_f32 v196, v196, v197
    v_mul_f32 v196, s46, v196
    v_pk_fma_f32 v[184:185], v[184:185], s[46:47], v[196:197] op_sel_hi:[1,1,0] neg_lo:[0,0,1] neg_hi:[0,0,1]
    v_pk_fma_f32 v[186:187], v[186:187], s[46:47], v[196:197] op_sel_hi:[1,1,0] neg_lo:[0,0,1] neg_hi:[0,0,1]
    v_pk_fma_f32 v[188:189], v[188:189], s[46:47], v[196:197] op_sel_hi:[1,1,0] neg_lo:[0,0,1] neg_hi:[0,0,1]
    v_pk_fma_f32 v[190:191], v[190:191], s[46:47], v[196:197] op_sel_hi:[1,1,0] neg_lo:[0,0,1] neg_hi:[0,0,1]
    v_exp_f32 v184, v184
    v_exp_f32 v185, v185
    v_exp_f32 v186, v186
    v_exp_f32 v187, v187
    v_exp_f32 v188, v188
    v_exp_f32 v189, v189
    v_exp_f32 v190, v190
    v_exp_f32 v191, v191
    v_pk_add_f32 v[200:201], v[184:185], v[186:187]
    v_pk_add_f32 v[202:203], v[188:189], v[190:191]
    v_pk_add_f32 v[200:201], v[200:201], v[202:203]
    v_add_f32 v200, v200, v201
    v_rcp_f32 v200, v200
    s_waitcnt lgkmcnt(0)
    v_pk_mul_f32 v[184:185], v[184:185], v[200:201] op_sel_hi:[1,0]
    v_pk_mul_f32 v[186:187], v[186:187], v[200:201] op_sel_hi:[1,0]
    v_pk_mul_f32 v[188:189], v[188:189], v[200:201] op_sel_hi:[1,0]
    v_pk_mul_f32 v[190:191], v[190:191], v[200:201] op_sel_hi:[1,0]
    v_cvt_pk_bf16_f32 v192, v184, v185
    v_cvt_pk_bf16_f32 v194, v188, v189
    v_cvt_pk_bf16_f32 v193, v186, v187
    v_cvt_pk_bf16_f32 v195, v190, v191
    v_permlane32_swap_b32 v192, v194
    s_nop 0
    v_permlane32_swap_b32 v193, v195
    s_nop 1
    v_permlane16_swap_b32 v192, v193
    v_permlane16_swap_b32 v194, v195
    v_perm_b32 v148, v192, v192, v40
    v_perm_b32 v149, v192, v192, v41
    v_perm_b32 v150, v192, v192, v42
    v_perm_b32 v151, v192, v192, v43
    v_perm_b32 v152, v193, v193, v40
    v_perm_b32 v153, v193, v193, v41
    v_perm_b32 v154, v193, v193, v42
    v_perm_b32 v155, v193, v193, v43
    v_mfma_f32_16x16x32_bf16 v[164:167], v[84:87], v[148:151], 0
    v_mfma_f32_16x16x32_bf16 v[180:183], v[100:103], v[148:151], 0
    v_perm_b32 v156, v194, v194, v40
    v_perm_b32 v157, v194, v194, v41
    v_perm_b32 v158, v194, v194, v42
    v_perm_b32 v159, v194, v194, v43
    v_mfma_f32_16x16x32_bf16 v[168:171], v[92:95], v[152:155], 0
    v_mfma_f32_16x16x32_bf16 v[180:183], v[104:107], v[152:155], v[180:183]
    v_perm_b32 v160, v195, v195, v40
    v_perm_b32 v161, v195, v195, v41
    v_perm_b32 v162, v195, v195, v42
    v_perm_b32 v163, v195, v195, v43
    v_mfma_f32_16x16x32_bf16 v[172:175], v[86:89], v[156:159], 0
    v_mfma_f32_16x16x32_bf16 v[180:183], v[108:111], v[156:159], v[180:183]
    v_mfma_f32_16x16x32_bf16 v[176:179], v[94:97], v[160:163], 0
    v_mfma_f32_16x16x32_bf16 v[180:183], v[112:115], v[160:163], v[180:183]
    v_cvt_pk_bf16_f32 v204, v164, v165
    v_cvt_pk_bf16_f32 v205, v166, v167
    v_cvt_pk_bf16_f32 v206, v168, v169
    v_cvt_pk_bf16_f32 v207, v170, v171
    buffer_store_dwordx4 v[204:207], v15, s[20:23], s50 offen sc1
    v_cvt_pk_bf16_f32 v208, v172, v173
    v_cvt_pk_bf16_f32 v209, v174, v175
    v_cvt_pk_bf16_f32 v210, v176, v177
    v_cvt_pk_bf16_f32 v211, v178, v179
    buffer_store_dwordx4 v[208:211], v15, s[20:23], s51 offen sc1
    v_cvt_pk_bf16_f32 v196, v180, v181
    v_cvt_pk_bf16_f32 v197, v182, v183
    buffer_store_dwordx2 v[196:197], v16, s[20:23], s50 offen sc1
    s_cmp_lg_u32 s34, -1
    s_cbranch_scc1 K_P2_EARLY
    s_waitcnt vmcnt(0)
    s_barrier
    s_branch K_END
WP_atts:
    s_setpc_b64 s[38:39]
K_JOIN_S:
    s_setprio 0
    s_barrier
    s_cmp_eq_u32 s30, 7
    s_cbranch_scc1 K_FLAG
    ds_read_b64 v[52:53], v12 offset:80
    ds_read_b64 v[54:55], v13 offset:80
    ds_read_b64 v[44:45], v12 offset:4352
    ds_read_b64 v[46:47], v19 offset:4352
    ds_read_b64 v[56:57], v12 offset:4432
    ds_read_b64 v[58:59], v13 offset:4432
    ds_read_b64 v[60:61], v12 offset:120
    ds_read_b64 v[62:63], v13 offset:120
    ds_read_b64 v[48:49], v12 offset:4392
    ds_read_b64 v[50:51], v20 offset:4352
    ds_read_b64 v[64:65], v12 offset:4472
    ds_read_b64 v[66:67], v13 offset:4472
    s_waitcnt lgkmcnt(6)
    v_mfma_f32_16x16x32_bf16 v[84:87], v[52:55], v[44:47], v[36:39]
    v_mfma_f32_16x16x32_bf16 v[88:91], v[56:59], v[44:47], v[32:35]
    s_waitcnt lgkmcnt(0)
    v_mfma_f32_16x16x32_bf16 v[92:95], v[60:63], v[48:51], v[36:39]
    v_mfma_f32_16x16x32_bf16 v[96:99], v[64:67], v[48:51], v[32:35]
    ds_read_b64_tr_b16 v[68:69], v14 offset:160
    ds_read_b64_tr_b16 v[70:71], v14 offset:4512
    ds_read_b64_tr_b16 v[76:77], v21 offset:0
    ds_read_b64_tr_b16 v[78:79], v21 offset:4352
    ds_read_b64_tr_b16 v[72:73], v14 offset:200
    ds_read_b64_tr_b16 v[74:75], v14 offset:4552
    ds_read_b64_tr_b16 v[80:81], v22 offset:0
    ds_read_b64_tr_b16 v[82:83], v22 offset:4352
    v_max3_f32 v120, v84, v85, v88
    v_max3_f32 v121, v86, v87, v90
    v_max_f32 v120, v120, v89
    v_max_f32 v121, v121, v91
    v_max3_f32 v122, v92, v93, v96
    v_max3_f32 v123, v94, v95, v98
    v_max_f32 v122, v122, v97
    v_max_f32 v123, v123, v99
    v_cvt_pk_bf16_f32 v124, v120, v121
    v_cvt_pk_bf16_f32 v125, v122, v123
    v_lshlrev_b32 v120, 16, v124
    v_and_b32 v121, 0xffff0000, v124
    v_lshlrev_b32 v122, 16, v125
    v_and_b32 v123, 0xffff0000, v125
    v_pk_mul_f32 v[120:121], v[120:121], s[48:49]
    v_pk_mul_f32 v[122:123], v[122:123], s[48:49]
    v_cvt_pk_bf16_f32 v124, v120, v121
    v_cvt_pk_bf16_f32 v125, v122, v123
    s_nop 1
    v_permlane16_swap_b32 v124, v125
    v_lshlrev_b32 v120, 16, v124
    v_and_b32 v121, 0xffff0000, v124
    v_lshlrev_b32 v122, 16, v125
    v_and_b32 v123, 0xffff0000, v125
    v_max3_f32 v126, v120, v121, v122
    v_max_f32 v126, v126, v123
    v_mov_b32 v127, v126
    s_nop 1
    v_permlane32_swap_b32 v126, v127
    v_max_f32 v126, v126, v127
    v_mul_f32 v126, s46, v126
    v_pk_fma_f32 v[120:121], v[120:121], s[46:47], v[126:127] op_sel_hi:[1,1,0] neg_lo:[0,0,1] neg_hi:[0,0,1]
    v_pk_fma_f32 v[122:123], v[122:123], s[46:47], v[126:127] op_sel_hi:[1,1,0] neg_lo:[0,0,1] neg_hi:[0,0,1]
    v_exp_f32 v120, v120
    v_exp_f32 v121, v121
    v_exp_f32 v122, v122
    v_exp_f32 v123, v123
    s_nop 0
    v_pk_add_f32 v[128:129], v[120:121], v[122:123]
    v_add_f32 v128, v128, v129
    v_mov_b32 v129, v128
    s_nop 1
    v_permlane32_swap_b32 v128, v129
    v_add_f32 v128, v128, v129
    v_rcp_f32 v128, v128
    s_waitcnt lgkmcnt(0)
    v_pk_mul_f32 v[120:121], v[120:121], v[128:129] op_sel_hi:[1,0]
    v_pk_mul_f32 v[122:123], v[122:123], v[128:129] op_sel_hi:[1,0]
    v_cvt_pk_bf16_f32 v124, v120, v121
    v_cvt_pk_bf16_f32 v125, v122, v123
    s_nop 1
    v_permlane16_swap_b32 v124, v125
    v_perm_b32 v100, v124, v124, v40
    v_perm_b32 v101, v124, v124, v41
    v_perm_b32 v102, v124, v124, v42
    v_perm_b32 v103, v124, v124, v43
    v_perm_b32 v104, v125, v125, v40
    v_perm_b32 v105, v125, v125, v41
    v_perm_b32 v106, v125, v125, v42
    v_perm_b32 v107, v125, v125, v43
    v_mfma_f32_16x16x32_bf16 v[108:111], v[68:71], v[100:103], 0
    v_mfma_f32_16x16x32_bf16 v[116:119], v[76:79], v[100:103], 0
    v_mfma_f32_16x16x32_bf16 v[112:115], v[72:75], v[104:107], 0
    v_mfma_f32_16x16x32_bf16 v[116:119], v[80:83], v[104:107], v[116:119]
    s_nop 4
    v_cvt_pk_bf16_f32 v132, v108, v109
    v_cvt_pk_bf16_f32 v133, v110, v111
    v_cvt_pk_bf16_f32 v134, v112, v113
    v_cvt_pk_bf16_f32 v135, v114, v115
    buffer_store_dwordx4 v[132:135], v15, s[20:23], s50 offen sc1
    v_cvt_pk_bf16_f32 v126, v116, v117
    v_cvt_pk_bf16_f32 v127, v118, v119
    buffer_store_dwordx2 v[126:127], v16, s[20:23], s50 offen sc1
    s_cmp_eq_u32 s34, -1
    s_cbranch_scc1 K_NOFL
    s_cmp_lg_u32 s30, 6
    s_cbranch_scc1 K_NOFL
    s_waitcnt vmcnt(12)
    v_mov_b32 v4, 192
    s_mov_b32 s3, 131072
K_ZPOLL2:
    v_readfirstlane_b32 s33, v7
    s_nop 3
    s_sub_u32 s3, s3, 1
    s_cselect_b32 s33, 1, s33
    s_cmp_lg_u32 s33, 0
    s_cbranch_scc1 K_ZOK2
    global_load_dword v7, v4, s[8:9] sc1
    s_waitcnt vmcnt(0)
    s_branch K_ZPOLL2
K_ZOK2:
    v_min_u32 v2, 23, v1
    v_lshl_add_u32 v2, v2, 2, s42
    global_load_dword v7, v2, s[10:11] offset:128 sc1
    s_branch K_NOFL
K_FLAG:
    s_waitcnt vmcnt(0)
    v_mov_b32 v4, 192
    s_mov_b32 s3, 131072
K_ZPOLL0:
    v_readfirstlane_b32 s33, v7
    s_nop 3
    s_sub_u32 s3, s3, 1
    s_cselect_b32 s33, 1, s33
    s_cmp_lg_u32 s33, 0
    s_cbranch_scc1 K_ZOK0
    global_load_dword v7, v4, s[8:9] sc1
    s_waitcnt vmcnt(0)
    s_branch K_ZPOLL0
K_ZOK0:
    v_mov_b32 v3, 1
    s_mov_b32 exec_lo, s36
    s_mov_b32 exec_hi, 0
    s_setprio 3
    s_barrier
    global_store_dword v18, v3, s[10:11] sc1
    s_setprio 0
    s_mov_b64 exec, -1
    s_branch K_FLAGGED
K_NOFL:
    s_waitcnt vmcnt(0)
    s_barrier
K_FLAGGED:
    s_cmp_eq_u32 s34, -1
    s_cbranch_scc1 K_END
    s_cmp_ge_u32 s30, 6
    s_cbranch_scc1 K_P2_HELP
    s_sub_u32 s44, s30, 4
    s_lshl_b32 s50, s44, 2
    s_lshr_b32 s50, 0x6431, s50
    s_and_b32 s50, s50, 7
    s_mul_i32 s50, s50, 51200
    s_mul_i32 s51, s44, 5120
    s_add_u32 s3, s50, 0
    s_add_u32 m0, s51, 40960
    s_waitcnt vmcnt(13)
    buffer_load_dwordx4 v17, s[24:27], s3 offen lds
    s_add_u32 s3, s50, 10240
    s_add_u32 m0, s51, 41984
    s_waitcnt vmcnt(13)
    buffer_load_dwordx4 v17, s[24:27], s3 offen lds
    s_add_u32 s3, s50, 20480
    s_add_u32 m0, s51, 43008
    s_waitcnt vmcnt(13)
    buffer_load_dwordx4 v17, s[24:27], s3 offen lds
    s_add_u32 s3, s50, 30720
    s_add_u32 m0, s51, 44032
    s_waitcnt vmcnt(13)
    buffer_load_dwordx4 v17, s[24:27], s3 offen lds
    s_add_u32 s3, s50, 40960
    s_add_u32 m0, s51, 45056
    s_waitcnt vmcnt(13)
    buffer_load_dwordx4 v17, s[24:27], s3 offen lds
    s_add_u32 s3, s50, 409600
    s_add_u32 m0, s51, 61440
    s_waitcnt vmcnt(13)
    buffer_load_dwordx4 v17, s[24:27], s3 offen lds
    s_add_u32 s3, s50, 419840
    s_add_u32 m0, s51, 62464
    s_waitcnt vmcnt(13)
    buffer_load_dwordx4 v17, s[24:27], s3 offen lds
    s_add_u32 s3, s50, 430080
    s_add_u32 m0, s51, 63488
    s_waitcnt vmcnt(13)
    buffer_load_dwordx4 v17, s[24:27], s3 offen lds
    s_add_u32 s3, s50, 440320
    s_add_u32 m0, s51, 64512
    s_waitcnt vmcnt(13)
    buffer_load_dwordx4 v17, s[24:27], s3 offen lds
    s_add_u32 s3, s50, 450560
    s_add_u32 m0, s51, 65536
    s_waitcnt vmcnt(13)
    buffer_load_dwordx4 v17, s[24:27], s3 offen lds
    s_add_u32 s44, s44, 2
    s_lshl_b32 s50, s44, 2
    s_lshr_b32 s50, 0x6431, s50
    s_and_b32 s50, s50, 7
    s_mul_i32 s50, s50, 51200
    s_mul_i32 s51, s44, 5120
    s_add_u32 s3, s50, 0
    s_add_u32 m0, s51, 40960
    s_waitcnt vmcnt(13)
    buffer_load_dwordx4 v17, s[24:27], s3 offen lds
    s_add_u32 s3, s50, 10240
    s_add_u32 m0, s51, 41984
    s_waitcnt vmcnt(13)
    buffer_load_dwordx4 v17, s[24:27], s3 offen lds
    s_add_u32 s3, s50, 20480
    s_add_u32 m0, s51, 43008
    s_waitcnt vmcnt(13)
    buffer_load_dwordx4 v17, s[24:27], s3 offen lds
    s_add_u32 s3, s50, 30720
    s_add_u32 m0, s51, 44032
    s_waitcnt vmcnt(13)
    buffer_load_dwordx4 v17, s[24:27], s3 offen lds
    s_add_u32 s3, s50, 40960
    s_add_u32 m0, s51, 45056
    s_waitcnt vmcnt(13)
    buffer_load_dwordx4 v17, s[24:27], s3 offen lds
    s_add_u32 s3, s50, 409600
    s_add_u32 m0, s51, 61440
    s_waitcnt vmcnt(13)
    buffer_load_dwordx4 v17, s[24:27], s3 offen lds
    s_add_u32 s3, s50, 419840
    s_add_u32 m0, s51, 62464
    s_waitcnt vmcnt(13)
    buffer_load_dwordx4 v17, s[24:27], s3 offen lds
    s_add_u32 s3, s50, 430080
    s_add_u32 m0, s51, 63488
    s_waitcnt vmcnt(13)
    buffer_load_dwordx4 v17, s[24:27], s3 offen lds
    s_add_u32 s3, s50, 440320
    s_add_u32 m0, s51, 64512
    s_waitcnt vmcnt(13)
    buffer_load_dwordx4 v17, s[24:27], s3 offen lds
    s_add_u32 s3, s50, 450560
    s_add_u32 m0, s51, 65536
    s_waitcnt vmcnt(13)
    buffer_load_dwordx4 v17, s[24:27], s3 offen lds
    v_mov_b32 v2, 158720
    v_mov_b32 v3, 2
    s_waitcnt vmcnt(0)
    s_mov_b64 exec, 1
    ds_add_u32 v2, v3 offset:44
    s_mov_b64 exec, -1
    s_branch K_P2_HELP
WP_early:
    s_setpc_b64 s[38:39]
K_P2_EARLY:
    s_lshl_b32 s54, s40, 7
    v_lshrrev_b32 v8, 3, v1
    v_lshrrev_b32 v9, 4, v1
    v_mov_b32 v15, 158720
    s_lshl_b32 s53, s40, 3
    s_add_u32 s53, s53, s30
    s_mul_i32 s3, s53, 20480
    s_lshl_b32 s33, s41, 7
    s_add_u32 s3, s3, s33
    v_and_b32 v2, 7, v1
    v_lshlrev_b32 v2, 4, v2
    v_mul_u32_u24 v4, 1280, v8
    v_add3_u32 v10, v2, v4, s3
    s_lshl_b32 s3, s53, 6
    v_lshl_add_u32 v11, v8, 2, s3
    s_mov_b32 s55, 10240
    s_add_u32 s20, s10, 0x100000
    s_addc_u32 s21, s11, 0
    s_mov_b32 s22, 0x280000
    s_mov_b32 s23, 0x20000
    s_add_u32 s16, s10, 0x1000
    s_addc_u32 s17, s11, 0
    s_mov_b32 s18, 0x2000
    s_mov_b32 s19, 0x20000
    s_mov_b32 s48, s6
    s_mov_b32 s49, s7
    s_mov_b32 s50, 0x280000
    s_mov_b32 s51, 0x20000
    v_mul_u32_u24 v3, 144, v8
    v_add_u32 v3, v2, v3
    s_mul_i32 s3, s30, 2304
    s_add_u32 s3, s3, 140288
    v_add_u32 v14, s3, v3
    v_bfe_u32 v50, v1, 2, 2
    v_and_b32 v51, 3, v1
    s_add_u32 s3, s53, s30
    s_mul_i32 s3, s3, 20480
    v_lshl_add_u32 v54, v1, 4, s3
    v_add_u32 v55, 20480, v54
    v_lshl_add_u32 v2, v9, 2, v50
    v_bfe_u32 v3, v2, 1, 2
    v_lshlrev_b32 v2, 7, v2
    v_lshl_add_u32 v2, v51, 3, v2
    v_xor_b32 v4, 0, v3
    v_lshl_add_u32 v56, v4, 5, v2
    v_add_u32 v60, 40960, v56
    v_xor_b32 v4, 1, v3
    v_lshl_add_u32 v57, v4, 5, v2
    v_add_u32 v61, 40960, v57
    v_xor_b32 v4, 2, v3
    v_lshl_add_u32 v58, v4, 5, v2
    v_add_u32 v62, 40960, v58
    v_xor_b32 v4, 3, v3
    v_lshl_add_u32 v59, v4, 5, v2
    v_add_u32 v63, 40960, v59
    v_lshrrev_b32 v3, 1, v50
    v_mul_u32_u24 v2, 40, v9
    v_add3_u32 v2, v2, 16, v50
    v_lshlrev_b32 v2, 7, v2
    v_lshl_add_u32 v2, v51, 3, v2
    v_xor_b32 v4, 0, v3
    v_lshl_add_u32 v64, v4, 5, v2
    v_xor_b32 v4, 1, v3
    v_lshl_add_u32 v65, v4, 5, v2
    v_xor_b32 v4, 2, v3
    v_lshl_add_u32 v66, v4, 5, v2
    v_xor_b32 v4, 3, v3
    v_lshl_add_u32 v67, v4, 5, v2
    v_and_b32 v2, 15, v1
    v_mul_u32_u24 v2, 144, v2
    v_lshl_add_u32 v2, v9, 3, v2
    s_mul_i32 s3, s30, 4608
    s_add_u32 s3, s3, 140288
    v_add_u32 v52, s3, v2
    s_mov_b32 s67, 0
    s_mov_b32 s68, 4096
    s_mov_b32 s69, 8192
    s_mov_b32 s70, 12288
    s_mov_b32 s71, 16384
    s_waitcnt vmcnt(0)
    s_barrier
    s_cmp_lt_u32 s29, 8
    s_cbranch_scc1 K_P2_AUXW0
K_P2_GEMM:
    s_setprio 2
    s_lshl_b32 s3, s40, 3
    s_mul_i32 s33, s3, 187
    s_lshr_b32 s33, s33, 11
    s_add_u32 s33, s33, 1
    s_mul_i32 s33, s33, 11
    s_add_u32 s3, s53, s30
    s_cmp_ge_u32 s3, s33
    s_cselect_b32 s59, 16, 0
    s_add_u32 s3, s3, 1
    s_cmp_ge_u32 s3, s33
    s_cselect_b32 s61, 16, 0
    s_mov_b32 s58, 0
    ds_read_b64_tr_b16 v[148:149], v56 offset:0
    ds_read_b64_tr_b16 v[150:151], v58 offset:2560
    ds_read_b64_tr_b16 v[152:153], v57 offset:0
    ds_read_b64_tr_b16 v[154:155], v59 offset:2560
    ds_read_b64_tr_b16 v[156:157], v58 offset:0
    ds_read_b64_tr_b16 v[158:159], v56 offset:2560
    ds_read_b64_tr_b16 v[160:161], v59 offset:0
    ds_read_b64_tr_b16 v[162:163], v57 offset:2560
    ds_read_b64_tr_b16 v[164:165], v56 offset:20480
    ds_read_b64_tr_b16 v[166:167], v58 offset:23040
    ds_read_b64_tr_b16 v[168:169], v57 offset:20480
    ds_read_b64_tr_b16 v[170:171], v59 offset:23040
    ds_read_b64_tr_b16 v[172:173], v58 offset:20480
    ds_read_b64_tr_b16 v[174:175], v56 offset:23040
    ds_read_b64_tr_b16 v[176:177], v59 offset:20480
    ds_read_b64_tr_b16 v[178:179], v57 offset:23040
    ds_read_b64_tr_b16 v[180:181], v56 offset:5120
    ds_read_b64_tr_b16 v[182:183], v58 offset:7680
    ds_read_b64_tr_b16 v[184:185], v57 offset:5120
    ds_read_b64_tr_b16 v[186:187], v59 offset:7680
    ds_read_b64_tr_b16 v[188:189], v58 offset:5120
    ds_read_b64_tr_b16 v[190:191], v56 offset:7680
    ds_read_b64_tr_b16 v[192:193], v59 offset:5120
    ds_read_b64_tr_b16 v[194:195], v57 offset:7680
    s_branch WS_p2g
.p2align 12
WP_p2g:
    s_setpc_b64 s[38:39]
WS_p2g:
    s_andn2_b32 s33, 1, s58
    s_cbranch_scc1 K_SP0
K_SPR0:
    buffer_load_dwordx4 v[68:71], v54, s[20:23], s67 offen offset:0 sc1
    buffer_load_dwordx4 v[72:75], v55, s[20:23], s67 offen offset:0 sc1
    s_andn2_b32 s33, 16, s58
    s_cbranch_scc1 K_SP1
K_SPR1:
    buffer_load_dwordx4 v[76:79], v54, s[20:23], s68 offen offset:0 sc1
    buffer_load_dwordx4 v[80:83], v55, s[20:23], s68 offen offset:0 sc1
    s_andn2_b32 s33, 2, s58
    s_cbranch_scc1 K_SP2
K_SPR2:
    buffer_load_dwordx4 v[84:87], v54, s[20:23], s67 offen offset:1024 sc1
    buffer_load_dwordx4 v[88:91], v55, s[20:23], s67 offen offset:1024 sc1
    s_andn2_b32 s33, 32, s58
    s_cbranch_scc1 K_SP3
K_SPR3:
    buffer_load_dwordx4 v[92:95], v54, s[20:23], s68 offen offset:1024 sc1
    buffer_load_dwordx4 v[96:99], v55, s[20:23], s68 offen offset:1024 sc1
    s_andn2_b32 s33, 4, s58
    s_cbranch_scc1 K_SP4
K_SPR4:
    buffer_load_dwordx4 v[100:103], v54, s[20:23], s67 offen offset:2048 sc1
    buffer_load_dwordx4 v[104:107], v55, s[20:23], s67 offen offset:2048 sc1
    ds_read_b64_tr_b16 v[196:197], v56 offset:25600
    ds_read_b64_tr_b16 v[198:199], v58 offset:28160
    ds_read_b64_tr_b16 v[200:201], v57 offset:25600
    ds_read_b64_tr_b16 v[202:203], v59 offset:28160
    ds_read_b64_tr_b16 v[204:205], v58 offset:25600
    ds_read_b64_tr_b16 v[206:207], v56 offset:28160
    ds_read_b64_tr_b16 v[208:209], v59 offset:25600
    ds_read_b64_tr_b16 v[210:211], v57 offset:28160
    ds_read_b64_tr_b16 v[212:213], v56 offset:10240
    ds_read_b64_tr_b16 v[214:215], v58 offset:12800
    ds_read_b64_tr_b16 v[216:217], v57 offset:10240
    ds_read_b64_tr_b16 v[218:219], v59 offset:12800
    ds_read_b64_tr_b16 v[220:221], v58 offset:10240
    ds_read_b64_tr_b16 v[222:223], v56 offset:12800
    ds_read_b64_tr_b16 v[224:225], v59 offset:10240
    ds_read_b64_tr_b16 v[226:227], v57 offset:12800
    s_waitcnt vmcnt(8)
    s_waitcnt lgkmcnt(15)
    v_mfma_f32_16x16x32_bf16 v[116:119], v[148:151], v[68:71], 0
    v_mfma_f32_16x16x32_bf16 v[132:135], v[148:151], v[72:75], 0
    v_mfma_f32_16x16x32_bf16 v[120:123], v[152:155], v[68:71], 0
    v_mfma_f32_16x16x32_bf16 v[136:139], v[152:155], v[72:75], 0
    v_mfma_f32_16x16x32_bf16 v[124:127], v[156:159], v[68:71], 0
    v_mfma_f32_16x16x32_bf16 v[140:143], v[156:159], v[72:75], 0
    v_mfma_f32_16x16x32_bf16 v[128:131], v[160:163], v[68:71], 0
    v_mfma_f32_16x16x32_bf16 v[144:147], v[160:163], v[72:75], 0
    s_andn2_b32 s33, 64, s58
    s_cbranch_scc1 K_SP5
K_SPR5:
    buffer_load_dwordx4 v[108:111], v54, s[20:23], s68 offen offset:2048 sc1
    buffer_load_dwordx4 v[112:115], v55, s[20:23], s68 offen offset:2048 sc1
    s_waitcnt vmcnt(8)
    v_mfma_f32_16x16x32_bf16 v[116:119], v[164:167], v[76:79], v[116:119]
    ds_read_b64_tr_b16 v[148:149], v56 offset:30720
    v_mfma_f32_16x16x32_bf16 v[132:135], v[164:167], v[80:83], v[132:135]
    ds_read_b64_tr_b16 v[150:151], v58 offset:33280
    v_mfma_f32_16x16x32_bf16 v[120:123], v[168:171], v[76:79], v[120:123]
    ds_read_b64_tr_b16 v[152:153], v57 offset:30720
    v_mfma_f32_16x16x32_bf16 v[136:139], v[168:171], v[80:83], v[136:139]
    ds_read_b64_tr_b16 v[154:155], v59 offset:33280
    v_mfma_f32_16x16x32_bf16 v[124:127], v[172:175], v[76:79], v[124:127]
    ds_read_b64_tr_b16 v[156:157], v58 offset:30720
    v_mfma_f32_16x16x32_bf16 v[140:143], v[172:175], v[80:83], v[140:143]
    ds_read_b64_tr_b16 v[158:159], v56 offset:33280
    v_mfma_f32_16x16x32_bf16 v[128:131], v[176:179], v[76:79], v[128:131]
    ds_read_b64_tr_b16 v[160:161], v59 offset:30720
    v_mfma_f32_16x16x32_bf16 v[144:147], v[176:179], v[80:83], v[144:147]
    ds_read_b64_tr_b16 v[162:163], v57 offset:33280
    s_andn2_b32 s33, 8, s58
    s_cbranch_scc1 K_SP6
K_SPR6:
    buffer_load_dwordx4 v[68:71], v54, s[20:23], s67 offen offset:3072 sc1
    buffer_load_dwordx4 v[72:75], v55, s[20:23], s67 offen offset:3072 sc1
    s_waitcnt vmcnt(8)
    v_mfma_f32_16x16x32_bf16 v[116:119], v[180:183], v[84:87], v[116:119]
    ds_read_b64_tr_b16 v[164:165], v56 offset:15360
    v_mfma_f32_16x16x32_bf16 v[132:135], v[180:183], v[88:91], v[132:135]
    ds_read_b64_tr_b16 v[166:167], v58 offset:17920
    v_mfma_f32_16x16x32_bf16 v[120:123], v[184:187], v[84:87], v[120:123]
    ds_read_b64_tr_b16 v[168:169], v57 offset:15360
    v_mfma_f32_16x16x32_bf16 v[136:139], v[184:187], v[88:91], v[136:139]
    ds_read_b64_tr_b16 v[170:171], v59 offset:17920
    v_mfma_f32_16x16x32_bf16 v[124:127], v[188:191], v[84:87], v[124:127]
    ds_read_b64_tr_b16 v[172:173], v58 offset:15360
    v_mfma_f32_16x16x32_bf16 v[140:143], v[188:191], v[88:91], v[140:143]
    ds_read_b64_tr_b16 v[174:175], v56 offset:17920
    v_mfma_f32_16x16x32_bf16 v[128:131], v[192:195], v[84:87], v[128:131]
    ds_read_b64_tr_b16 v[176:177], v59 offset:15360
    v_mfma_f32_16x16x32_bf16 v[144:147], v[192:195], v[88:91], v[144:147]
    ds_read_b64_tr_b16 v[178:179], v57 offset:17920
    s_andn2_b32 s33, 128, s58
    s_cbranch_scc1 K_SP7
K_SPR7:
    buffer_load_dwordx4 v[76:79], v54, s[20:23], s68 offen offset:3072 sc1
    buffer_load_dwordx4 v[80:83], v55, s[20:23], s68 offen offset:3072 sc1
    s_waitcnt vmcnt(8)
    s_waitcnt lgkmcnt(15)
    v_mfma_f32_16x16x32_bf16 v[116:119], v[196:199], v[92:95], v[116:119]
    ds_read_b64_tr_b16 v[180:181], v56 offset:35840
    v_mfma_f32_16x16x32_bf16 v[132:135], v[196:199], v[96:99], v[132:135]
    ds_read_b64_tr_b16 v[182:183], v58 offset:38400
    v_mfma_f32_16x16x32_bf16 v[120:123], v[200:203], v[92:95], v[120:123]
    ds_read_b64_tr_b16 v[184:185], v57 offset:35840
    v_mfma_f32_16x16x32_bf16 v[136:139], v[200:203], v[96:99], v[136:139]
    ds_read_b64_tr_b16 v[186:187], v59 offset:38400
    v_mfma_f32_16x16x32_bf16 v[124:127], v[204:207], v[92:95], v[124:127]
    ds_read_b64_tr_b16 v[188:189], v58 offset:35840
    v_mfma_f32_16x16x32_bf16 v[140:143], v[204:207], v[96:99], v[140:143]
    ds_read_b64_tr_b16 v[190:191], v56 offset:38400
    v_mfma_f32_16x16x32_bf16 v[128:131], v[208:211], v[92:95], v[128:131]
    ds_read_b64_tr_b16 v[192:193], v59 offset:35840
    v_mfma_f32_16x16x32_bf16 v[144:147], v[208:211], v[96:99], v[144:147]
    ds_read_b64_tr_b16 v[194:195], v57 offset:38400
    s_andn2_b32 s33, 15, s58
    s_cbranch_scc1 K_SP8
K_SPR8:
    buffer_load_dwordx4 v[84:87], v54, s[20:23], s71 offen offset:0 sc1
    buffer_load_dwordx4 v[88:91], v55, s[20:23], s71 offen offset:0 sc1
    s_waitcnt vmcnt(8)
    v_mfma_f32_16x16x32_bf16 v[116:119], v[212:215], v[100:103], v[116:119]
    ds_read_b64_tr_b16 v[196:197], v64 offset:0
    v_mfma_f32_16x16x32_bf16 v[132:135], v[212:215], v[104:107], v[132:135]
    ds_read_b64_tr_b16 v[198:199], v66 offset:2560
    v_mfma_f32_16x16x32_bf16 v[120:123], v[216:219], v[100:103], v[120:123]
    ds_read_b64_tr_b16 v[200:201], v65 offset:0
    v_mfma_f32_16x16x32_bf16 v[136:139], v[216:219], v[104:107], v[136:139]
    ds_read_b64_tr_b16 v[202:203], v67 offset:2560
    v_mfma_f32_16x16x32_bf16 v[124:127], v[220:223], v[100:103], v[124:127]
    ds_read_b64_tr_b16 v[204:205], v66 offset:0
    v_mfma_f32_16x16x32_bf16 v[140:143], v[220:223], v[104:107], v[140:143]
    ds_read_b64_tr_b16 v[206:207], v64 offset:2560
    v_mfma_f32_16x16x32_bf16 v[128:131], v[224:227], v[100:103], v[128:131]
    ds_read_b64_tr_b16 v[208:209], v67 offset:0
    v_mfma_f32_16x16x32_bf16 v[144:147], v[224:227], v[104:107], v[144:147]
    ds_read_b64_tr_b16 v[210:211], v65 offset:2560
    s_andn2_b32 s33, 240, s58
    s_cbranch_scc1 K_SP9
K_SPR9:
    buffer_load_dwordx4 v[92:95], v54, s[20:23], s71 offen offset:1024 sc1
    buffer_load_dwordx4 v[96:99], v55, s[20:23], s71 offen offset:1024 sc1
    s_waitcnt vmcnt(8)
    s_waitcnt lgkmcnt(15)
    v_mfma_f32_16x16x32_bf16 v[116:119], v[148:151], v[108:111], v[116:119]
    ds_read_b64_tr_b16 v[212:213], v64 offset:20480
    v_mfma_f32_16x16x32_bf16 v[132:135], v[148:151], v[112:115], v[132:135]
    ds_read_b64_tr_b16 v[214:215], v66 offset:23040
    v_mfma_f32_16x16x32_bf16 v[120:123], v[152:155], v[108:111], v[120:123]
    ds_read_b64_tr_b16 v[216:217], v65 offset:20480
    v_mfma_f32_16x16x32_bf16 v[136:139], v[152:155], v[112:115], v[136:139]
    ds_read_b64_tr_b16 v[218:219], v67 offset:23040
    v_mfma_f32_16x16x32_bf16 v[124:127], v[156:159], v[108:111], v[124:127]
    ds_read_b64_tr_b16 v[220:221], v66 offset:20480
    v_mfma_f32_16x16x32_bf16 v[140:143], v[156:159], v[112:115], v[140:143]
    ds_read_b64_tr_b16 v[222:223], v64 offset:23040
    v_mfma_f32_16x16x32_bf16 v[128:131], v[160:163], v[108:111], v[128:131]
    ds_read_b64_tr_b16 v[224:225], v67 offset:20480
    v_mfma_f32_16x16x32_bf16 v[144:147], v[160:163], v[112:115], v[144:147]
    ds_read_b64_tr_b16 v[226:227], v65 offset:23040
    s_andn2_b32 s33, 256, s58
    s_cbranch_scc1 K_SP10
K_SPR10:
    buffer_load_dwordx4 v[100:103], v54, s[20:23], s69 offen offset:0 sc1
    buffer_load_dwordx4 v[104:107], v55, s[20:23], s69 offen offset:0 sc1
    s_mov_b32 s3, 1048576
K_P2_GS:
    ds_read_b32 v2, v15 offset:40
    s_sub_u32 s3, s3, 1
    s_waitcnt lgkmcnt(0)
    v_readfirstlane_b32 s33, v2
    s_nop 3
    s_cselect_b32 s33, 1, s33
    s_cmp_lt_u32 s33, 1
    s_cbranch_scc1 K_P2_GS
    buffer_load_dwordx4 v[16:19], v10, s[12:15], 0 offen
    buffer_load_dwordx4 v[20:23], v10, s[12:15], s55 offen
    buffer_load_dword v24, v11, s[16:19], 0 offen sc1
    buffer_load_dword v25, v11, s[16:19], 0 offen offset:32 sc1
    ds_read_b128 v[28:31], v15
    s_mov_b32 s3, 1048576
K_P2_GW:
    ds_read_b32 v2, v15 offset:44
    s_sub_u32 s3, s3, 1
    s_waitcnt lgkmcnt(0)
    v_readfirstlane_b32 s33, v2
    s_nop 3
    s_cselect_b32 s33, 4, s33
    s_cmp_lt_u32 s33, 4
    s_cbranch_scc1 K_P2_GW
    s_waitcnt vmcnt(12)
    v_mfma_f32_16x16x32_bf16 v[116:119], v[164:167], v[68:71], v[116:119]
    ds_read_b64_tr_b16 v[148:149], v60 offset:0
    v_mfma_f32_16x16x32_bf16 v[132:135], v[164:167], v[72:75], v[132:135]
    ds_read_b64_tr_b16 v[150:151], v62 offset:2560
    v_mfma_f32_16x16x32_bf16 v[120:123], v[168:171], v[68:71], v[120:123]
    ds_read_b64_tr_b16 v[152:153], v61 offset:0
    v_mfma_f32_16x16x32_bf16 v[136:139], v[168:171], v[72:75], v[136:139]
    ds_read_b64_tr_b16 v[154:155], v63 offset:2560
    v_mfma_f32_16x16x32_bf16 v[124:127], v[172:175], v[68:71], v[124:127]
    ds_read_b64_tr_b16 v[156:157], v62 offset:0
    v_mfma_f32_16x16x32_bf16 v[140:143], v[172:175], v[72:75], v[140:143]
    ds_read_b64_tr_b16 v[158:159], v60 offset:2560
    v_mfma_f32_16x16x32_bf16 v[128:131], v[176:179], v[68:71], v[128:131]
    ds_read_b64_tr_b16 v[160:161], v63 offset:0
    v_mfma_f32_16x16x32_bf16 v[144:147], v[176:179], v[72:75], v[144:147]
    ds_read_b64_tr_b16 v[162:163], v61 offset:2560
    s_andn2_b32 s33, 4096, s58
    s_cbranch_scc1 K_SP11
K_SPR11:
    buffer_load_dwordx4 v[108:111], v54, s[20:23], s70 offen offset:0 sc1
    buffer_load_dwordx4 v[112:115], v55, s[20:23], s70 offen offset:0 sc1
    s_waitcnt vmcnt(12)
    v_mfma_f32_16x16x32_bf16 v[116:119], v[180:183], v[76:79], v[116:119]
    ds_read_b64_tr_b16 v[164:165], v60 offset:20480
    v_mfma_f32_16x16x32_bf16 v[132:135], v[180:183], v[80:83], v[132:135]
    ds_read_b64_tr_b16 v[166:167], v62 offset:23040
    v_mfma_f32_16x16x32_bf16 v[120:123], v[184:187], v[76:79], v[120:123]
    ds_read_b64_tr_b16 v[168:169], v61 offset:20480
    v_mfma_f32_16x16x32_bf16 v[136:139], v[184:187], v[80:83], v[136:139]
    ds_read_b64_tr_b16 v[170:171], v63 offset:23040
    v_mfma_f32_16x16x32_bf16 v[124:127], v[188:191], v[76:79], v[124:127]
    ds_read_b64_tr_b16 v[172:173], v62 offset:20480
    v_mfma_f32_16x16x32_bf16 v[140:143], v[188:191], v[80:83], v[140:143]
    ds_read_b64_tr_b16 v[174:175], v60 offset:23040
    v_mfma_f32_16x16x32_bf16 v[128:131], v[192:195], v[76:79], v[128:131]
    ds_read_b64_tr_b16 v[176:177], v63 offset:20480
    v_mfma_f32_16x16x32_bf16 v[144:147], v[192:195], v[80:83], v[144:147]
    ds_read_b64_tr_b16 v[178:179], v61 offset:23040
    s_andn2_b32 s33, 512, s58
    s_cbranch_scc1 K_SP12
K_SPR12:
    buffer_load_dwordx4 v[68:71], v54, s[20:23], s69 offen offset:1024 sc1
    buffer_load_dwordx4 v[72:75], v55, s[20:23], s69 offen offset:1024 sc1
    s_waitcnt vmcnt(12)
    v_mfma_f32_16x16x32_bf16 v[116:119], v[196:199], v[84:87], v[116:119]
    ds_read_b64_tr_b16 v[180:181], v60 offset:5120
    v_mfma_f32_16x16x32_bf16 v[132:135], v[196:199], v[88:91], v[132:135]
    ds_read_b64_tr_b16 v[182:183], v62 offset:7680
    v_mfma_f32_16x16x32_bf16 v[120:123], v[200:203], v[84:87], v[120:123]
    ds_read_b64_tr_b16 v[184:185], v61 offset:5120
    v_mfma_f32_16x16x32_bf16 v[136:139], v[200:203], v[88:91], v[136:139]
    ds_read_b64_tr_b16 v[186:187], v63 offset:7680
    v_mfma_f32_16x16x32_bf16 v[124:127], v[204:207], v[84:87], v[124:127]
    ds_read_b64_tr_b16 v[188:189], v62 offset:5120
    v_mfma_f32_16x16x32_bf16 v[140:143], v[204:207], v[88:91], v[140:143]
    ds_read_b64_tr_b16 v[190:191], v60 offset:7680
    v_mfma_f32_16x16x32_bf16 v[128:131], v[208:211], v[84:87], v[128:131]
    ds_read_b64_tr_b16 v[192:193], v63 offset:5120
    v_mfma_f32_16x16x32_bf16 v[144:147], v[208:211], v[88:91], v[144:147]
    ds_read_b64_tr_b16 v[194:195], v61 offset:7680
    s_andn2_b32 s33, 8192, s58
    s_cbranch_scc1 K_SP13
K_SPR13:
    buffer_load_dwordx4 v[76:79], v54, s[20:23], s70 offen offset:1024 sc1
    buffer_load_dwordx4 v[80:83], v55, s[20:23], s70 offen offset:1024 sc1
    s_waitcnt vmcnt(12)
    v_mfma_f32_16x16x32_bf16 v[116:119], v[212:215], v[92:95], v[116:119]
    ds_read_b64_tr_b16 v[196:197], v60 offset:25600
    v_mfma_f32_16x16x32_bf16 v[132:135], v[212:215], v[96:99], v[132:135]
    ds_read_b64_tr_b16 v[198:199], v62 offset:28160
    v_mfma_f32_16x16x32_bf16 v[120:123], v[216:219], v[92:95], v[120:123]
    ds_read_b64_tr_b16 v[200:201], v61 offset:25600
    v_mfma_f32_16x16x32_bf16 v[136:139], v[216:219], v[96:99], v[136:139]
    ds_read_b64_tr_b16 v[202:203], v63 offset:28160
    v_mfma_f32_16x16x32_bf16 v[124:127], v[220:223], v[92:95], v[124:127]
    ds_read_b64_tr_b16 v[204:205], v62 offset:25600
    v_mfma_f32_16x16x32_bf16 v[140:143], v[220:223], v[96:99], v[140:143]
    ds_read_b64_tr_b16 v[206:207], v60 offset:28160
    v_mfma_f32_16x16x32_bf16 v[128:131], v[224:227], v[92:95], v[128:131]
    ds_read_b64_tr_b16 v[208:209], v63 offset:25600
    v_mfma_f32_16x16x32_bf16 v[144:147], v[224:227], v[96:99], v[144:147]
    ds_read_b64_tr_b16 v[210:211], v61 offset:28160
    s_andn2_b32 s33, 1024, s58
    s_cbranch_scc1 K_SP14
K_SPR14:
    buffer_load_dwordx4 v[84:87], v54, s[20:23], s69 offen offset:2048 sc1
    buffer_load_dwordx4 v[88:91], v55, s[20:23], s69 offen offset:2048 sc1
    s_waitcnt vmcnt(12)
    s_waitcnt lgkmcnt(15)
    v_mfma_f32_16x16x32_bf16 v[116:119], v[148:151], v[100:103], v[116:119]
    ds_read_b64_tr_b16 v[212:213], v60 offset:10240
    v_mfma_f32_16x16x32_bf16 v[132:135], v[148:151], v[104:107], v[132:135]
    ds_read_b64_tr_b16 v[214:215], v62 offset:12800
    v_mfma_f32_16x16x32_bf16 v[120:123], v[152:155], v[100:103], v[120:123]
    ds_read_b64_tr_b16 v[216:217], v61 offset:10240
    v_mfma_f32_16x16x32_bf16 v[136:139], v[152:155], v[104:107], v[136:139]
    ds_read_b64_tr_b16 v[218:219], v63 offset:12800
    v_mfma_f32_16x16x32_bf16 v[124:127], v[156:159], v[100:103], v[124:127]
    ds_read_b64_tr_b16 v[220:221], v62 offset:10240
    v_mfma_f32_16x16x32_bf16 v[140:143], v[156:159], v[104:107], v[140:143]
    ds_read_b64_tr_b16 v[222:223], v60 offset:12800
    v_mfma_f32_16x16x32_bf16 v[128:131], v[160:163], v[100:103], v[128:131]
    ds_read_b64_tr_b16 v[224:225], v63 offset:10240
    v_mfma_f32_16x16x32_bf16 v[144:147], v[160:163], v[104:107], v[144:147]
    ds_read_b64_tr_b16 v[226:227], v61 offset:12800
    s_andn2_b32 s33, 16384, s58
    s_cbranch_scc1 K_SP15
K_SPR15:
    buffer_load_dwordx4 v[92:95], v54, s[20:23], s70 offen offset:2048 sc1
    buffer_load_dwordx4 v[96:99], v55, s[20:23], s70 offen offset:2048 sc1
    s_waitcnt vmcnt(8)
    v_mfma_f32_16x16x32_bf16 v[116:119], v[164:167], v[108:111], v[116:119]
    ds_read_b64_tr_b16 v[148:149], v60 offset:30720
    v_sub_f32 v48, 1.0, v24
    v_mfma_f32_16x16x32_bf16 v[132:135], v[164:167], v[112:115], v[132:135]
    ds_read_b64_tr_b16 v[150:151], v62 offset:33280
    v_cvt_pk_bf16_f32 v48, v48, v48
    v_mfma_f32_16x16x32_bf16 v[120:123], v[168:171], v[108:111], v[120:123]
    ds_read_b64_tr_b16 v[152:153], v61 offset:30720
    v_lshlrev_b32 v48, 16, v48
    v_mfma_f32_16x16x32_bf16 v[136:139], v[168:171], v[112:115], v[136:139]
    ds_read_b64_tr_b16 v[154:155], v63 offset:33280
    v_sub_f32 v49, 1.0, v25
    v_mfma_f32_16x16x32_bf16 v[124:127], v[172:175], v[108:111], v[124:127]
    ds_read_b64_tr_b16 v[156:157], v62 offset:30720
    v_cvt_pk_bf16_f32 v49, v49, v49
    v_mfma_f32_16x16x32_bf16 v[140:143], v[172:175], v[112:115], v[140:143]
    ds_read_b64_tr_b16 v[158:159], v60 offset:33280
    v_lshlrev_b32 v49, 16, v49
    v_mfma_f32_16x16x32_bf16 v[128:131], v[176:179], v[108:111], v[128:131]
    ds_read_b64_tr_b16 v[160:161], v63 offset:30720
    v_lshlrev_b32 v32, 16, v16
    v_mfma_f32_16x16x32_bf16 v[144:147], v[176:179], v[112:115], v[144:147]
    ds_read_b64_tr_b16 v[162:163], v61 offset:33280
    v_and_b32 v33, 0xffff0000, v16
    s_andn2_b32 s33, 2048, s58
    s_cbranch_scc1 K_SP16
K_SPR16:
    buffer_load_dwordx4 v[100:103], v54, s[20:23], s69 offen offset:3072 sc1
    buffer_load_dwordx4 v[104:107], v55, s[20:23], s69 offen offset:3072 sc1
    s_waitcnt vmcnt(8)
    s_waitcnt lgkmcnt(15)
    v_mfma_f32_16x16x32_bf16 v[116:119], v[180:183], v[68:71], v[116:119]
    ds_read_b64_tr_b16 v[164:165], v60 offset:15360
    v_lshlrev_b32 v34, 16, v17
    v_mfma_f32_16x16x32_bf16 v[132:135], v[180:183], v[72:75], v[132:135]
    ds_read_b64_tr_b16 v[166:167], v62 offset:17920
    v_and_b32 v35, 0xffff0000, v17
    v_mfma_f32_16x16x32_bf16 v[120:123], v[184:187], v[68:71], v[120:123]
    ds_read_b64_tr_b16 v[168:169], v61 offset:15360
    v_lshlrev_b32 v36, 16, v18
    v_mfma_f32_16x16x32_bf16 v[136:139], v[184:187], v[72:75], v[136:139]
    ds_read_b64_tr_b16 v[170:171], v63 offset:17920
    v_and_b32 v37, 0xffff0000, v18
    v_mfma_f32_16x16x32_bf16 v[124:127], v[188:191], v[68:71], v[124:127]
    ds_read_b64_tr_b16 v[172:173], v62 offset:15360
    v_lshlrev_b32 v38, 16, v19
    v_mfma_f32_16x16x32_bf16 v[140:143], v[188:191], v[72:75], v[140:143]
    ds_read_b64_tr_b16 v[174:175], v60 offset:17920
    v_and_b32 v39, 0xffff0000, v19
    v_mfma_f32_16x16x32_bf16 v[128:131], v[192:195], v[68:71], v[128:131]
    ds_read_b64_tr_b16 v[176:177], v63 offset:15360
    v_lshlrev_b32 v40, 16, v20
    v_mfma_f32_16x16x32_bf16 v[144:147], v[192:195], v[72:75], v[144:147]
    ds_read_b64_tr_b16 v[178:179], v61 offset:17920
    v_and_b32 v41, 0xffff0000, v20
    s_andn2_b32 s33, 32768, s58
    s_cbranch_scc1 K_SP17
K_SPR17:
    buffer_load_dwordx4 v[108:111], v54, s[20:23], s70 offen offset:3072 sc1
    buffer_load_dwordx4 v[112:115], v55, s[20:23], s70 offen offset:3072 sc1
    s_waitcnt vmcnt(8)
    v_mfma_f32_16x16x32_bf16 v[116:119], v[196:199], v[76:79], v[116:119]
    ds_read_b64_tr_b16 v[180:181], v60 offset:35840
    v_lshlrev_b32 v42, 16, v21
    v_mfma_f32_16x16x32_bf16 v[132:135], v[196:199], v[80:83], v[132:135]
    ds_read_b64_tr_b16 v[182:183], v62 offset:38400
    v_and_b32 v43, 0xffff0000, v21
    v_mfma_f32_16x16x32_bf16 v[120:123], v[200:203], v[76:79], v[120:123]
    ds_read_b64_tr_b16 v[184:185], v61 offset:35840
    v_lshlrev_b32 v44, 16, v22
    v_mfma_f32_16x16x32_bf16 v[136:139], v[200:203], v[80:83], v[136:139]
    ds_read_b64_tr_b16 v[186:187], v63 offset:38400
    v_and_b32 v45, 0xffff0000, v22
    v_mfma_f32_16x16x32_bf16 v[124:127], v[204:207], v[76:79], v[124:127]
    ds_read_b64_tr_b16 v[188:189], v62 offset:35840
    v_lshlrev_b32 v46, 16, v23
    v_mfma_f32_16x16x32_bf16 v[140:143], v[204:207], v[80:83], v[140:143]
    ds_read_b64_tr_b16 v[190:191], v60 offset:38400
    v_and_b32 v47, 0xffff0000, v23
    v_mfma_f32_16x16x32_bf16 v[128:131], v[208:211], v[76:79], v[128:131]
    ds_read_b64_tr_b16 v[192:193], v63 offset:35840
    v_mul_f32 v32, v32, v48
    v_mfma_f32_16x16x32_bf16 v[144:147], v[208:211], v[80:83], v[144:147]
    ds_read_b64_tr_b16 v[194:195], v61 offset:38400
    v_mul_f32 v33, v33, v48
    s_andn2_b32 s33, 3840, s58
    s_cbranch_scc1 K_SP18
K_SPR18:
    buffer_load_dwordx4 v[68:71], v54, s[20:23], s71 offen offset:2048 sc1
    buffer_load_dwordx4 v[72:75], v55, s[20:23], s71 offen offset:2048 sc1
    s_waitcnt vmcnt(8)
    s_waitcnt lgkmcnt(15)
    v_mfma_f32_16x16x32_bf16 v[116:119], v[212:215], v[84:87], v[116:119]
    ds_read_b64_tr_b16 v[196:197], v64 offset:40960
    v_mul_f32 v34, v34, v48
    v_mfma_f32_16x16x32_bf16 v[132:135], v[212:215], v[88:91], v[132:135]
    ds_read_b64_tr_b16 v[198:199], v66 offset:43520
    v_mul_f32 v35, v35, v48
    v_mfma_f32_16x16x32_bf16 v[120:123], v[216:219], v[84:87], v[120:123]
    ds_read_b64_tr_b16 v[200:201], v65 offset:40960
    v_mul_f32 v36, v36, v48
    v_mfma_f32_16x16x32_bf16 v[136:139], v[216:219], v[88:91], v[136:139]
    ds_read_b64_tr_b16 v[202:203], v67 offset:43520
    v_mul_f32 v37, v37, v48
    v_mfma_f32_16x16x32_bf16 v[124:127], v[220:223], v[84:87], v[124:127]
    ds_read_b64_tr_b16 v[204:205], v66 offset:40960
    v_mul_f32 v38, v38, v48
    v_mfma_f32_16x16x32_bf16 v[140:143], v[220:223], v[88:91], v[140:143]
    ds_read_b64_tr_b16 v[206:207], v64 offset:43520
    v_mul_f32 v39, v39, v48
    v_mfma_f32_16x16x32_bf16 v[128:131], v[224:227], v[84:87], v[128:131]
    ds_read_b64_tr_b16 v[208:209], v67 offset:40960
    v_mul_f32 v40, v40, v49
    v_mfma_f32_16x16x32_bf16 v[144:147], v[224:227], v[88:91], v[144:147]
    ds_read_b64_tr_b16 v[210:211], v65 offset:43520
    v_mul_f32 v41, v41, v49
    s_andn2_b32 s33, 61440, s58
    s_cbranch_scc1 K_SP19
K_SPR19:
    buffer_load_dwordx4 v[76:79], v54, s[20:23], s71 offen offset:3072 sc1
    buffer_load_dwordx4 v[80:83], v55, s[20:23], s71 offen offset:3072 sc1
    s_waitcnt vmcnt(8)
    v_mfma_f32_16x16x32_bf16 v[116:119], v[148:151], v[92:95], v[116:119]
    ds_read_b64_tr_b16 v[212:213], v64 offset:61440
    v_mul_f32 v42, v42, v49
    v_mfma_f32_16x16x32_bf16 v[132:135], v[148:151], v[96:99], v[132:135]
    ds_read_b64_tr_b16 v[214:215], v66 offset:64000
    v_mul_f32 v43, v43, v49
    v_mfma_f32_16x16x32_bf16 v[120:123], v[152:155], v[92:95], v[120:123]
    ds_read_b64_tr_b16 v[216:217], v65 offset:61440
    v_mul_f32 v44, v44, v49
    v_mfma_f32_16x16x32_bf16 v[136:139], v[152:155], v[96:99], v[136:139]
    ds_read_b64_tr_b16 v[218:219], v67 offset:64000
    v_mul_f32 v45, v45, v49
    v_mfma_f32_16x16x32_bf16 v[124:127], v[156:159], v[92:95], v[124:127]
    ds_read_b64_tr_b16 v[220:221], v66 offset:61440
    v_mul_f32 v46, v46, v49
    v_mfma_f32_16x16x32_bf16 v[140:143], v[156:159], v[96:99], v[140:143]
    ds_read_b64_tr_b16 v[222:223], v64 offset:64000
    v_mul_f32 v47, v47, v49
    v_mfma_f32_16x16x32_bf16 v[128:131], v[160:163], v[92:95], v[128:131]
    ds_read_b64_tr_b16 v[224:225], v67 offset:61440
    v_mfma_f32_16x16x32_bf16 v[144:147], v[160:163], v[96:99], v[144:147]
    ds_read_b64_tr_b16 v[226:227], v65 offset:64000
    s_waitcnt vmcnt(6)
    s_waitcnt lgkmcnt(15)
    v_mfma_f32_16x16x32_bf16 v[116:119], v[164:167], v[100:103], v[116:119]
    v_mfma_f32_16x16x32_bf16 v[132:135], v[164:167], v[104:107], v[132:135]
    v_mfma_f32_16x16x32_bf16 v[120:123], v[168:171], v[100:103], v[120:123]
    v_mfma_f32_16x16x32_bf16 v[136:139], v[168:171], v[104:107], v[136:139]
    v_mfma_f32_16x16x32_bf16 v[124:127], v[172:175], v[100:103], v[124:127]
    v_mfma_f32_16x16x32_bf16 v[140:143], v[172:175], v[104:107], v[140:143]
    v_mfma_f32_16x16x32_bf16 v[128:131], v[176:179], v[100:103], v[128:131]
    v_mfma_f32_16x16x32_bf16 v[144:147], v[176:179], v[104:107], v[144:147]
    s_waitcnt vmcnt(4)
    v_mfma_f32_16x16x32_bf16 v[116:119], v[180:183], v[108:111], v[116:119]
    v_mfma_f32_16x16x32_bf16 v[132:135], v[180:183], v[112:115], v[132:135]
    v_mfma_f32_16x16x32_bf16 v[120:123], v[184:187], v[108:111], v[120:123]
    v_mfma_f32_16x16x32_bf16 v[136:139], v[184:187], v[112:115], v[136:139]
    v_mfma_f32_16x16x32_bf16 v[124:127], v[188:191], v[108:111], v[124:127]
    v_mfma_f32_16x16x32_bf16 v[140:143], v[188:191], v[112:115], v[140:143]
    v_mfma_f32_16x16x32_bf16 v[128:131], v[192:195], v[108:111], v[128:131]
    v_mfma_f32_16x16x32_bf16 v[144:147], v[192:195], v[112:115], v[144:147]
    s_waitcnt vmcnt(2)
    s_waitcnt lgkmcnt(14)
    v_mfma_f32_16x16x32_bf16 v[116:119], v[196:199], v[68:71], v[116:119]
    v_mfma_f32_16x16x32_bf16 v[132:135], v[196:199], v[72:75], v[132:135]
    s_waitcnt lgkmcnt(12)
    v_mfma_f32_16x16x32_bf16 v[120:123], v[200:203], v[68:71], v[120:123]
    v_mfma_f32_16x16x32_bf16 v[136:139], v[200:203], v[72:75], v[136:139]
    s_waitcnt lgkmcnt(10)
    v_mfma_f32_16x16x32_bf16 v[124:127], v[204:207], v[68:71], v[124:127]
    v_mfma_f32_16x16x32_bf16 v[140:143], v[204:207], v[72:75], v[140:143]
    s_waitcnt lgkmcnt(8)
    v_mfma_f32_16x16x32_bf16 v[128:131], v[208:211], v[68:71], v[128:131]
    v_mfma_f32_16x16x32_bf16 v[144:147], v[208:211], v[72:75], v[144:147]
    s_waitcnt vmcnt(0)
    s_waitcnt lgkmcnt(6)
    v_mfma_f32_16x16x32_bf16 v[116:119], v[212:215], v[76:79], v[116:119]
    v_mfma_f32_16x16x32_bf16 v[132:135], v[212:215], v[80:83], v[132:135]
    s_waitcnt lgkmcnt(4)
    v_mfma_f32_16x16x32_bf16 v[120:123], v[216:219], v[76:79], v[120:123]
    v_mfma_f32_16x16x32_bf16 v[136:139], v[216:219], v[80:83], v[136:139]
    s_waitcnt lgkmcnt(2)
    v_mfma_f32_16x16x32_bf16 v[124:127], v[220:223], v[76:79], v[124:127]
    v_mfma_f32_16x16x32_bf16 v[140:143], v[220:223], v[80:83], v[140:143]
    s_waitcnt lgkmcnt(0)
    v_mfma_f32_16x16x32_bf16 v[128:131], v[224:227], v[76:79], v[128:131]
    v_mfma_f32_16x16x32_bf16 v[144:147], v[224:227], v[80:83], v[144:147]
    s_nop 3
    v_cvt_pk_bf16_f32 v148, v116, v117
    v_cvt_pk_bf16_f32 v149, v118, v119
    ds_write_b64 v52, v[148:149] offset:0
    v_cvt_pk_bf16_f32 v164, v132, v133
    v_cvt_pk_bf16_f32 v165, v134, v135
    ds_write_b64 v52, v[164:165] offset:2304
    v_cvt_pk_bf16_f32 v152, v120, v121
    v_cvt_pk_bf16_f32 v153, v122, v123
    ds_write_b64 v52, v[152:153] offset:32
    v_cvt_pk_bf16_f32 v168, v136, v137
    v_cvt_pk_bf16_f32 v169, v138, v139
    ds_write_b64 v52, v[168:169] offset:2336
    v_cvt_pk_bf16_f32 v156, v124, v125
    v_cvt_pk_bf16_f32 v157, v126, v127
    ds_write_b64 v52, v[156:157] offset:64
    v_cvt_pk_bf16_f32 v172, v140, v141
    v_cvt_pk_bf16_f32 v173, v142, v143
    ds_write_b64 v52, v[172:173] offset:2368
    v_cvt_pk_bf16_f32 v160, v128, v129
    v_cvt_pk_bf16_f32 v161, v130, v131
    ds_write_b64 v52, v[160:161] offset:96
    v_cvt_pk_bf16_f32 v176, v144, v145
    v_cvt_pk_bf16_f32 v177, v146, v147
    ds_write_b64 v52, v[176:177] offset:2400
K_P2_E2:
    s_waitcnt lgkmcnt(0)
    v_readfirstlane_b32 s56, v28
    v_readfirstlane_b32 s57, v29
    s_lshl_b32 s72, s53, 4
    s_barrier
    ds_read_b128 v[52:55], v14
    ds_read_b128 v[56:59], v14 offset:1152
    s_sub_u32 s3, s56, s72
    s_cmp_lt_u32 s3, 16
    s_cbranch_scc1 K_YROW0
K_NOY0:
    s_sub_u32 s3, s57, s72
    s_cmp_lt_u32 s3, 16
    s_cbranch_scc1 K_YROW1
K_NOY1:
    s_waitcnt lgkmcnt(1)
    v_lshlrev_b32 v72, 16, v52
    v_and_b32 v73, 0xffff0000, v52
    v_fma_f32 v72, v72, v24, v32
    v_fma_f32 v73, v73, v24, v33
    v_cvt_pk_bf16_f32 v52, v72, v73
    v_lshlrev_b32 v74, 16, v53
    v_and_b32 v75, 0xffff0000, v53
    v_fma_f32 v74, v74, v24, v34
    v_fma_f32 v75, v75, v24, v35
    v_cvt_pk_bf16_f32 v53, v74, v75
    v_lshlrev_b32 v72, 16, v54
    v_and_b32 v73, 0xffff0000, v54
    v_fma_f32 v72, v72, v24, v36
    v_fma_f32 v73, v73, v24, v37
    v_cvt_pk_bf16_f32 v54, v72, v73
    v_lshlrev_b32 v74, 16, v55
    v_and_b32 v75, 0xffff0000, v55
    v_fma_f32 v74, v74, v24, v38
    v_fma_f32 v75, v75, v24, v39
    v_cvt_pk_bf16_f32 v55, v74, v75
    buffer_store_dwordx4 v[52:55], v10, s[48:51], 0 offen sc1
    s_waitcnt lgkmcnt(0)
    v_lshlrev_b32 v72, 16, v56
    v_and_b32 v73, 0xffff0000, v56
    v_fma_f32 v72, v72, v25, v40
    v_fma_f32 v73, v73, v25, v41
    v_cvt_pk_bf16_f32 v56, v72, v73
    v_lshlrev_b32 v74, 16, v57
    v_and_b32 v75, 0xffff0000, v57
    v_fma_f32 v74, v74, v25, v42
    v_fma_f32 v75, v75, v25, v43
    v_cvt_pk_bf16_f32 v57, v74, v75
    v_lshlrev_b32 v72, 16, v58
    v_and_b32 v73, 0xffff0000, v58
    v_fma_f32 v72, v72, v25, v44
    v_fma_f32 v73, v73, v25, v45
    v_cvt_pk_bf16_f32 v58, v72, v73
    v_lshlrev_b32 v74, 16, v59
    v_and_b32 v75, 0xffff0000, v59
    v_fma_f32 v74, v74, v25, v46
    v_fma_f32 v75, v75, v25, v47
    v_cvt_pk_bf16_f32 v59, v74, v75
    buffer_store_dwordx4 v[56:59], v10, s[48:51], s55 offen sc1
K_END:
K_EXIT:
    s_endpgm
K_YROW0:
    v_and_b32 v2, 7, v1
    v_lshlrev_b32 v2, 5, v2
    v_add_u32 v2, 158976, v2
    ds_read_b128 v[60:63], v2
    ds_read_b128 v[64:67], v2 offset:16
    s_and_b32 s33, s3, 7
    v_cmp_eq_u32 vcc, s33, v8
    s_cmp_ge_u32 s3, 8
    s_cbranch_scc1 K_YR1_0
    s_waitcnt lgkmcnt(0)
    v_lshlrev_b32 v68, 16, v16
    v_add_f32 v68, v68, v60
    v_cvt_pk_bf16_f32 v68, v68, v68
    v_lshlrev_b32 v68, 16, v68
    v_mul_f32 v68, v68, v48
    v_cndmask_b32 v32, v32, v68, vcc
    v_and_b32 v69, 0xffff0000, v16
    v_add_f32 v69, v69, v61
    v_cvt_pk_bf16_f32 v69, v69, v69
    v_lshlrev_b32 v69, 16, v69
    v_mul_f32 v69, v69, v48
    v_cndmask_b32 v33, v33, v69, vcc
    v_lshlrev_b32 v70, 16, v17
    v_add_f32 v70, v70, v62
    v_cvt_pk_bf16_f32 v70, v70, v70
    v_lshlrev_b32 v70, 16, v70
    v_mul_f32 v70, v70, v48
    v_cndmask_b32 v34, v34, v70, vcc
    v_and_b32 v71, 0xffff0000, v17
    v_add_f32 v71, v71, v63
    v_cvt_pk_bf16_f32 v71, v71, v71
    v_lshlrev_b32 v71, 16, v71
    v_mul_f32 v71, v71, v48
    v_cndmask_b32 v35, v35, v71, vcc
    v_lshlrev_b32 v68, 16, v18
    v_add_f32 v68, v68, v64
    v_cvt_pk_bf16_f32 v68, v68, v68
    v_lshlrev_b32 v68, 16, v68
    v_mul_f32 v68, v68, v48
    v_cndmask_b32 v36, v36, v68, vcc
    v_and_b32 v69, 0xffff0000, v18
    v_add_f32 v69, v69, v65
    v_cvt_pk_bf16_f32 v69, v69, v69
    v_lshlrev_b32 v69, 16, v69
    v_mul_f32 v69, v69, v48
    v_cndmask_b32 v37, v37, v69, vcc
    v_lshlrev_b32 v70, 16, v19
    v_add_f32 v70, v70, v66
    v_cvt_pk_bf16_f32 v70, v70, v70
    v_lshlrev_b32 v70, 16, v70
    v_mul_f32 v70, v70, v48
    v_cndmask_b32 v38, v38, v70, vcc
    v_and_b32 v71, 0xffff0000, v19
    v_add_f32 v71, v71, v67
    v_cvt_pk_bf16_f32 v71, v71, v71
    v_lshlrev_b32 v71, 16, v71
    v_mul_f32 v71, v71, v48
    v_cndmask_b32 v39, v39, v71, vcc
    s_branch K_NOY0
K_YR1_0:
    s_waitcnt lgkmcnt(0)
    v_lshlrev_b32 v68, 16, v20
    v_add_f32 v68, v68, v60
    v_cvt_pk_bf16_f32 v68, v68, v68
    v_lshlrev_b32 v68, 16, v68
    v_mul_f32 v68, v68, v49
    v_cndmask_b32 v40, v40, v68, vcc
    v_and_b32 v69, 0xffff0000, v20
    v_add_f32 v69, v69, v61
    v_cvt_pk_bf16_f32 v69, v69, v69
    v_lshlrev_b32 v69, 16, v69
    v_mul_f32 v69, v69, v49
    v_cndmask_b32 v41, v41, v69, vcc
    v_lshlrev_b32 v70, 16, v21
    v_add_f32 v70, v70, v62
    v_cvt_pk_bf16_f32 v70, v70, v70
    v_lshlrev_b32 v70, 16, v70
    v_mul_f32 v70, v70, v49
    v_cndmask_b32 v42, v42, v70, vcc
    v_and_b32 v71, 0xffff0000, v21
    v_add_f32 v71, v71, v63
    v_cvt_pk_bf16_f32 v71, v71, v71
    v_lshlrev_b32 v71, 16, v71
    v_mul_f32 v71, v71, v49
    v_cndmask_b32 v43, v43, v71, vcc
    v_lshlrev_b32 v68, 16, v22
    v_add_f32 v68, v68, v64
    v_cvt_pk_bf16_f32 v68, v68, v68
    v_lshlrev_b32 v68, 16, v68
    v_mul_f32 v68, v68, v49
    v_cndmask_b32 v44, v44, v68, vcc
    v_and_b32 v69, 0xffff0000, v22
    v_add_f32 v69, v69, v65
    v_cvt_pk_bf16_f32 v69, v69, v69
    v_lshlrev_b32 v69, 16, v69
    v_mul_f32 v69, v69, v49
    v_cndmask_b32 v45, v45, v69, vcc
    v_lshlrev_b32 v70, 16, v23
    v_add_f32 v70, v70, v66
    v_cvt_pk_bf16_f32 v70, v70, v70
    v_lshlrev_b32 v70, 16, v70
    v_mul_f32 v70, v70, v49
    v_cndmask_b32 v46, v46, v70, vcc
    v_and_b32 v71, 0xffff0000, v23
    v_add_f32 v71, v71, v67
    v_cvt_pk_bf16_f32 v71, v71, v71
    v_lshlrev_b32 v71, 16, v71
    v_mul_f32 v71, v71, v49
    v_cndmask_b32 v47, v47, v71, vcc
    s_branch K_NOY0
K_YROW1:
    v_and_b32 v2, 7, v1
    v_lshlrev_b32 v2, 5, v2
    v_add_u32 v2, 159232, v2
    ds_read_b128 v[60:63], v2
    ds_read_b128 v[64:67], v2 offset:16
    s_and_b32 s33, s3, 7
    v_cmp_eq_u32 vcc, s33, v8
    s_cmp_ge_u32 s3, 8
    s_cbranch_scc1 K_YR1_1
    s_waitcnt lgkmcnt(0)
    v_lshlrev_b32 v68, 16, v16
    v_add_f32 v68, v68, v60
    v_cvt_pk_bf16_f32 v68, v68, v68
    v_lshlrev_b32 v68, 16, v68
    v_mul_f32 v68, v68, v48
    v_cndmask_b32 v32, v32, v68, vcc
    v_and_b32 v69, 0xffff0000, v16
    v_add_f32 v69, v69, v61
    v_cvt_pk_bf16_f32 v69, v69, v69
    v_lshlrev_b32 v69, 16, v69
    v_mul_f32 v69, v69, v48
    v_cndmask_b32 v33, v33, v69, vcc
    v_lshlrev_b32 v70, 16, v17
    v_add_f32 v70, v70, v62
    v_cvt_pk_bf16_f32 v70, v70, v70
    v_lshlrev_b32 v70, 16, v70
    v_mul_f32 v70, v70, v48
    v_cndmask_b32 v34, v34, v70, vcc
    v_and_b32 v71, 0xffff0000, v17
    v_add_f32 v71, v71, v63
    v_cvt_pk_bf16_f32 v71, v71, v71
    v_lshlrev_b32 v71, 16, v71
    v_mul_f32 v71, v71, v48
    v_cndmask_b32 v35, v35, v71, vcc
    v_lshlrev_b32 v68, 16, v18
    v_add_f32 v68, v68, v64
    v_cvt_pk_bf16_f32 v68, v68, v68
    v_lshlrev_b32 v68, 16, v68
    v_mul_f32 v68, v68, v48
    v_cndmask_b32 v36, v36, v68, vcc
    v_and_b32 v69, 0xffff0000, v18
    v_add_f32 v69, v69, v65
    v_cvt_pk_bf16_f32 v69, v69, v69
    v_lshlrev_b32 v69, 16, v69
    v_mul_f32 v69, v69, v48
    v_cndmask_b32 v37, v37, v69, vcc
    v_lshlrev_b32 v70, 16, v19
    v_add_f32 v70, v70, v66
    v_cvt_pk_bf16_f32 v70, v70, v70
    v_lshlrev_b32 v70, 16, v70
    v_mul_f32 v70, v70, v48
    v_cndmask_b32 v38, v38, v70, vcc
    v_and_b32 v71, 0xffff0000, v19
    v_add_f32 v71, v71, v67
    v_cvt_pk_bf16_f32 v71, v71, v71
    v_lshlrev_b32 v71, 16, v71
    v_mul_f32 v71, v71, v48
    v_cndmask_b32 v39, v39, v71, vcc
    s_branch K_NOY1
K_YR1_1:
    s_waitcnt lgkmcnt(0)
    v_lshlrev_b32 v68, 16, v20
    v_add_f32 v68, v68, v60
    v_cvt_pk_bf16_f32 v68, v68, v68
    v_lshlrev_b32 v68, 16, v68
    v_mul_f32 v68, v68, v49
    v_cndmask_b32 v40, v40, v68, vcc
    v_and_b32 v69, 0xffff0000, v20
    v_add_f32 v69, v69, v61
    v_cvt_pk_bf16_f32 v69, v69, v69
    v_lshlrev_b32 v69, 16, v69
    v_mul_f32 v69, v69, v49
    v_cndmask_b32 v41, v41, v69, vcc
    v_lshlrev_b32 v70, 16, v21
    v_add_f32 v70, v70, v62
    v_cvt_pk_bf16_f32 v70, v70, v70
    v_lshlrev_b32 v70, 16, v70
    v_mul_f32 v70, v70, v49
    v_cndmask_b32 v42, v42, v70, vcc
    v_and_b32 v71, 0xffff0000, v21
    v_add_f32 v71, v71, v63
    v_cvt_pk_bf16_f32 v71, v71, v71
    v_lshlrev_b32 v71, 16, v71
    v_mul_f32 v71, v71, v49
    v_cndmask_b32 v43, v43, v71, vcc
    v_lshlrev_b32 v68, 16, v22
    v_add_f32 v68, v68, v64
    v_cvt_pk_bf16_f32 v68, v68, v68
    v_lshlrev_b32 v68, 16, v68
    v_mul_f32 v68, v68, v49
    v_cndmask_b32 v44, v44, v68, vcc
    v_and_b32 v69, 0xffff0000, v22
    v_add_f32 v69, v69, v65
    v_cvt_pk_bf16_f32 v69, v69, v69
    v_lshlrev_b32 v69, 16, v69
    v_mul_f32 v69, v69, v49
    v_cndmask_b32 v45, v45, v69, vcc
    v_lshlrev_b32 v70, 16, v23
    v_add_f32 v70, v70, v66
    v_cvt_pk_bf16_f32 v70, v70, v70
    v_lshlrev_b32 v70, 16, v70
    v_mul_f32 v70, v70, v49
    v_cndmask_b32 v46, v46, v70, vcc
    v_and_b32 v71, 0xffff0000, v23
    v_add_f32 v71, v71, v67
    v_cvt_pk_bf16_f32 v71, v71, v71
    v_lshlrev_b32 v71, 16, v71
    v_mul_f32 v71, v71, v49
    v_cndmask_b32 v47, v47, v71, vcc
    s_branch K_NOY1
WP_spin:
    s_setpc_b64 s[38:39]
K_SP0:
    ds_read_b32 v2, v15 offset:32
    s_waitcnt lgkmcnt(0)
    v_readfirstlane_b32 s33, v2
    s_nop 3
    s_lshr_b32 s58, s33, s59
    s_lshr_b32 s33, s33, s61
    s_and_b32 s58, s58, s33
    s_andn2_b32 s33, 1, s58
    s_cbranch_scc1 K_SP0
    s_branch K_SPR0
K_SP1:
    ds_read_b32 v2, v15 offset:32
    s_waitcnt lgkmcnt(0)
    v_readfirstlane_b32 s33, v2
    s_nop 3
    s_lshr_b32 s58, s33, s59
    s_lshr_b32 s33, s33, s61
    s_and_b32 s58, s58, s33
    s_andn2_b32 s33, 16, s58
    s_cbranch_scc1 K_SP1
    s_branch K_SPR1
K_SP2:
    ds_read_b32 v2, v15 offset:32
    s_waitcnt lgkmcnt(0)
    v_readfirstlane_b32 s33, v2
    s_nop 3
    s_lshr_b32 s58, s33, s59
    s_lshr_b32 s33, s33, s61
    s_and_b32 s58, s58, s33
    s_andn2_b32 s33, 2, s58
    s_cbranch_scc1 K_SP2
    s_branch K_SPR2
K_SP3:
    ds_read_b32 v2, v15 offset:32
    s_waitcnt lgkmcnt(0)
    v_readfirstlane_b32 s33, v2
    s_nop 3
    s_lshr_b32 s58, s33, s59
    s_lshr_b32 s33, s33, s61
    s_and_b32 s58, s58, s33
    s_andn2_b32 s33, 32, s58
    s_cbranch_scc1 K_SP3
    s_branch K_SPR3
K_SP4:
    ds_read_b32 v2, v15 offset:32
    s_waitcnt lgkmcnt(0)
    v_readfirstlane_b32 s33, v2
    s_nop 3
    s_lshr_b32 s58, s33, s59
    s_lshr_b32 s33, s33, s61
    s_and_b32 s58, s58, s33
    s_andn2_b32 s33, 4, s58
    s_cbranch_scc1 K_SP4
    s_branch K_SPR4
K_SP5:
    ds_read_b32 v2, v15 offset:32
    s_waitcnt lgkmcnt(0)
    v_readfirstlane_b32 s33, v2
    s_nop 3
    s_lshr_b32 s58, s33, s59
    s_lshr_b32 s33, s33, s61
    s_and_b32 s58, s58, s33
    s_andn2_b32 s33, 64, s58
    s_cbranch_scc1 K_SP5
    s_branch K_SPR5
K_SP6:
    ds_read_b32 v2, v15 offset:32
    s_waitcnt lgkmcnt(0)
    v_readfirstlane_b32 s33, v2
    s_nop 3
    s_lshr_b32 s58, s33, s59
    s_lshr_b32 s33, s33, s61
    s_and_b32 s58, s58, s33
    s_andn2_b32 s33, 8, s58
    s_cbranch_scc1 K_SP6
    s_branch K_SPR6
K_SP7:
    ds_read_b32 v2, v15 offset:32
    s_waitcnt lgkmcnt(0)
    v_readfirstlane_b32 s33, v2
    s_nop 3
    s_lshr_b32 s58, s33, s59
    s_lshr_b32 s33, s33, s61
    s_and_b32 s58, s58, s33
    s_andn2_b32 s33, 128, s58
    s_cbranch_scc1 K_SP7
    s_branch K_SPR7
K_SP8:
    ds_read_b32 v2, v15 offset:32
    s_waitcnt lgkmcnt(0)
    v_readfirstlane_b32 s33, v2
    s_nop 3
    s_lshr_b32 s58, s33, s59
    s_lshr_b32 s33, s33, s61
    s_and_b32 s58, s58, s33
    s_andn2_b32 s33, 15, s58
    s_cbranch_scc1 K_SP8
    s_branch K_SPR8
K_SP9:
    ds_read_b32 v2, v15 offset:32
    s_waitcnt lgkmcnt(0)
    v_readfirstlane_b32 s33, v2
    s_nop 3
    s_lshr_b32 s58, s33, s59
    s_lshr_b32 s33, s33, s61
    s_and_b32 s58, s58, s33
    s_andn2_b32 s33, 240, s58
    s_cbranch_scc1 K_SP9
    s_branch K_SPR9
K_SP10:
    ds_read_b32 v2, v15 offset:32
    s_waitcnt lgkmcnt(0)
    v_readfirstlane_b32 s33, v2
    s_nop 3
    s_lshr_b32 s58, s33, s59
    s_lshr_b32 s33, s33, s61
    s_and_b32 s58, s58, s33
    s_andn2_b32 s33, 256, s58
    s_cbranch_scc1 K_SP10
    s_branch K_SPR10
K_SP11:
    ds_read_b32 v2, v15 offset:32
    s_waitcnt lgkmcnt(0)
    v_readfirstlane_b32 s33, v2
    s_nop 3
    s_lshr_b32 s58, s33, s59
    s_lshr_b32 s33, s33, s61
    s_and_b32 s58, s58, s33
    s_andn2_b32 s33, 4096, s58
    s_cbranch_scc1 K_SP11
    s_branch K_SPR11
K_SP12:
    ds_read_b32 v2, v15 offset:32
    s_waitcnt lgkmcnt(0)
    v_readfirstlane_b32 s33, v2
    s_nop 3
    s_lshr_b32 s58, s33, s59
    s_lshr_b32 s33, s33, s61
    s_and_b32 s58, s58, s33
    s_andn2_b32 s33, 512, s58
    s_cbranch_scc1 K_SP12
    s_branch K_SPR12
K_SP13:
    ds_read_b32 v2, v15 offset:32
    s_waitcnt lgkmcnt(0)
    v_readfirstlane_b32 s33, v2
    s_nop 3
    s_lshr_b32 s58, s33, s59
    s_lshr_b32 s33, s33, s61
    s_and_b32 s58, s58, s33
    s_andn2_b32 s33, 8192, s58
    s_cbranch_scc1 K_SP13
    s_branch K_SPR13
K_SP14:
    ds_read_b32 v2, v15 offset:32
    s_waitcnt lgkmcnt(0)
    v_readfirstlane_b32 s33, v2
    s_nop 3
    s_lshr_b32 s58, s33, s59
    s_lshr_b32 s33, s33, s61
    s_and_b32 s58, s58, s33
    s_andn2_b32 s33, 1024, s58
    s_cbranch_scc1 K_SP14
    s_branch K_SPR14
K_SP15:
    ds_read_b32 v2, v15 offset:32
    s_waitcnt lgkmcnt(0)
    v_readfirstlane_b32 s33, v2
    s_nop 3
    s_lshr_b32 s58, s33, s59
    s_lshr_b32 s33, s33, s61
    s_and_b32 s58, s58, s33
    s_andn2_b32 s33, 16384, s58
    s_cbranch_scc1 K_SP15
    s_branch K_SPR15
K_SP16:
    ds_read_b32 v2, v15 offset:32
    s_waitcnt lgkmcnt(0)
    v_readfirstlane_b32 s33, v2
    s_nop 3
    s_lshr_b32 s58, s33, s59
    s_lshr_b32 s33, s33, s61
    s_and_b32 s58, s58, s33
    s_andn2_b32 s33, 2048, s58
    s_cbranch_scc1 K_SP16
    s_branch K_SPR16
K_SP17:
    ds_read_b32 v2, v15 offset:32
    s_waitcnt lgkmcnt(0)
    v_readfirstlane_b32 s33, v2
    s_nop 3
    s_lshr_b32 s58, s33, s59
    s_lshr_b32 s33, s33, s61
    s_and_b32 s58, s58, s33
    s_andn2_b32 s33, 32768, s58
    s_cbranch_scc1 K_SP17
    s_branch K_SPR17
K_SP18:
    ds_read_b32 v2, v15 offset:32
    s_waitcnt lgkmcnt(0)
    v_readfirstlane_b32 s33, v2
    s_nop 3
    s_lshr_b32 s58, s33, s59
    s_lshr_b32 s33, s33, s61
    s_and_b32 s58, s58, s33
    s_andn2_b32 s33, 3840, s58
    s_cbranch_scc1 K_SP18
    s_branch K_SPR18
K_SP19:
    ds_read_b32 v2, v15 offset:32
    s_waitcnt lgkmcnt(0)
    v_readfirstlane_b32 s33, v2
    s_nop 3
    s_lshr_b32 s58, s33, s59
    s_lshr_b32 s33, s33, s61
    s_and_b32 s58, s58, s33
    s_andn2_b32 s33, 61440, s58
    s_cbranch_scc1 K_SP19
    s_branch K_SPR19
K_P2:
    s_cmp_ge_u32 s30, 4
    s_cbranch_scc1 K_P2_HELP
    s_lshl_b32 s54, s40, 7
    v_lshrrev_b32 v8, 3, v1
    v_lshrrev_b32 v9, 4, v1
    v_mov_b32 v15, 158720
    s_lshl_b32 s53, s40, 3
    s_add_u32 s53, s53, s30
    s_mul_i32 s3, s53, 20480
    s_lshl_b32 s33, s41, 7
    s_add_u32 s3, s3, s33
    v_and_b32 v2, 7, v1
    v_lshlrev_b32 v2, 4, v2
    v_mul_u32_u24 v4, 1280, v8
    v_add3_u32 v10, v2, v4, s3
    s_lshl_b32 s3, s53, 6
    v_lshl_add_u32 v11, v8, 2, s3
    s_mov_b32 s55, 10240
    s_add_u32 s20, s10, 0x100000
    s_addc_u32 s21, s11, 0
    s_mov_b32 s22, 0x280000
    s_mov_b32 s23, 0x20000
    s_add_u32 s16, s10, 0x1000
    s_addc_u32 s17, s11, 0
    s_mov_b32 s18, 0x2000
    s_mov_b32 s19, 0x20000
    s_mov_b32 s48, s6
    s_mov_b32 s49, s7
    s_mov_b32 s50, 0x280000
    s_mov_b32 s51, 0x20000
    v_mul_u32_u24 v3, 144, v8
    v_add_u32 v3, v2, v3
    s_mul_i32 s3, s30, 2304
    s_add_u32 s3, s3, 140288
    v_add_u32 v14, s3, v3
    v_bfe_u32 v50, v1, 2, 2
    v_and_b32 v51, 3, v1
    s_add_u32 s3, s53, s30
    s_mul_i32 s3, s3, 20480
    v_lshl_add_u32 v54, v1, 4, s3
    v_add_u32 v55, 20480, v54
    v_lshl_add_u32 v2, v9, 2, v50
    v_bfe_u32 v3, v2, 1, 2
    v_lshlrev_b32 v2, 7, v2
    v_lshl_add_u32 v2, v51, 3, v2
    v_xor_b32 v4, 0, v3
    v_lshl_add_u32 v56, v4, 5, v2
    v_add_u32 v60, 40960, v56
    v_xor_b32 v4, 1, v3
    v_lshl_add_u32 v57, v4, 5, v2
    v_add_u32 v61, 40960, v57
    v_xor_b32 v4, 2, v3
    v_lshl_add_u32 v58, v4, 5, v2
    v_add_u32 v62, 40960, v58
    v_xor_b32 v4, 3, v3
    v_lshl_add_u32 v59, v4, 5, v2
    v_add_u32 v63, 40960, v59
    v_lshrrev_b32 v3, 1, v50
    v_mul_u32_u24 v2, 40, v9
    v_add3_u32 v2, v2, 16, v50
    v_lshlrev_b32 v2, 7, v2
    v_lshl_add_u32 v2, v51, 3, v2
    v_xor_b32 v4, 0, v3
    v_lshl_add_u32 v64, v4, 5, v2
    v_xor_b32 v4, 1, v3
    v_lshl_add_u32 v65, v4, 5, v2
    v_xor_b32 v4, 2, v3
    v_lshl_add_u32 v66, v4, 5, v2
    v_xor_b32 v4, 3, v3
    v_lshl_add_u32 v67, v4, 5, v2
    v_and_b32 v2, 15, v1
    v_mul_u32_u24 v2, 144, v2
    v_lshl_add_u32 v2, v9, 3, v2
    s_mul_i32 s3, s30, 4608
    s_add_u32 s3, s3, 140288
    v_add_u32 v52, s3, v2
    s_mov_b32 s67, 0
    s_mov_b32 s68, 4096
    s_mov_b32 s69, 8192
    s_mov_b32 s70, 12288
    s_mov_b32 s71, 16384
    s_branch K_P2_AUXW
K_P2_AUXW0:
K_P2_AUXW:
    v_lshrrev_b32 v2, 3, v1
    v_mul_u32_u24 v2, 1280, v2
    v_lshrrev_b32 v3, 4, v1
    v_lshlrev_b32 v3, 1, v3
    v_and_b32 v4, 7, v1
    v_xor_b32 v3, v3, v4
    v_lshl_add_u32 v2, v3, 4, v2
    s_lshl_b32 s33, s41, 7
    v_add_u32 v53, s33, v2
    s_lshl_b32 s60, s30, 2
    s_lshr_b32 s60, 0x7520, s60
    s_and_b32 s60, s60, 7
    s_mul_i32 s60, s60, 51200
    s_mul_i32 s61, s30, 5120
    s_add_u32 s52, s60, 0
    s_add_u32 m0, s61, 0
    s_waitcnt vmcnt(5)
    buffer_load_dwordx4 v53, s[24:27], s52 offen lds
    s_add_u32 s52, s60, 10240
    s_add_u32 m0, s61, 1024
    s_waitcnt vmcnt(5)
    buffer_load_dwordx4 v53, s[24:27], s52 offen lds
    s_add_u32 s52, s60, 20480
    s_add_u32 m0, s61, 2048
    s_waitcnt vmcnt(5)
    buffer_load_dwordx4 v53, s[24:27], s52 offen lds
    s_add_u32 s52, s60, 30720
    s_add_u32 m0, s61, 3072
    s_waitcnt vmcnt(5)
    buffer_load_dwordx4 v53, s[24:27], s52 offen lds
    s_add_u32 s52, s60, 40960
    s_add_u32 m0, s61, 4096
    s_waitcnt vmcnt(5)
    buffer_load_dwordx4 v53, s[24:27], s52 offen lds
    s_add_u32 s52, s60, 409600
    s_add_u32 m0, s61, 20480
    s_waitcnt vmcnt(5)
    buffer_load_dwordx4 v53, s[24:27], s52 offen lds
    s_add_u32 s52, s60, 419840
    s_add_u32 m0, s61, 21504
    s_waitcnt vmcnt(5)
    buffer_load_dwordx4 v53, s[24:27], s52 offen lds
    s_add_u32 s52, s60, 430080
    s_add_u32 m0, s61, 22528
    s_waitcnt vmcnt(5)
    buffer_load_dwordx4 v53, s[24:27], s52 offen lds
    s_add_u32 s52, s60, 440320
    s_add_u32 m0, s61, 23552
    s_waitcnt vmcnt(5)
    buffer_load_dwordx4 v53, s[24:27], s52 offen lds
    s_add_u32 s52, s60, 450560
    s_add_u32 m0, s61, 24576
    s_waitcnt vmcnt(5)
    buffer_load_dwordx4 v53, s[24:27], s52 offen lds
    s_lshl_b32 s60, s30, 2
    s_lshr_b32 s60, 0x6431, s60
    s_and_b32 s60, s60, 7
    s_mul_i32 s60, s60, 51200
    s_mul_i32 s61, s30, 5120
    s_add_u32 s52, s60, 0
    s_add_u32 m0, s61, 40960
    s_waitcnt vmcnt(5)
    buffer_load_dwordx4 v53, s[24:27], s52 offen lds
    s_add_u32 s52, s60, 10240
    s_add_u32 m0, s61, 41984
    s_waitcnt vmcnt(5)
    buffer_load_dwordx4 v53, s[24:27], s52 offen lds
    s_add_u32 s52, s60, 20480
    s_add_u32 m0, s61, 43008
    s_waitcnt vmcnt(5)
    buffer_load_dwordx4 v53, s[24:27], s52 offen lds
    s_add_u32 s52, s60, 30720
    s_add_u32 m0, s61, 44032
    s_waitcnt vmcnt(5)
    buffer_load_dwordx4 v53, s[24:27], s52 offen lds
    s_add_u32 s52, s60, 40960
    s_add_u32 m0, s61, 45056
    s_waitcnt vmcnt(5)
    buffer_load_dwordx4 v53, s[24:27], s52 offen lds
    s_add_u32 s52, s60, 409600
    s_add_u32 m0, s61, 61440
    s_waitcnt vmcnt(5)
    buffer_load_dwordx4 v53, s[24:27], s52 offen lds
    s_add_u32 s52, s60, 419840
    s_add_u32 m0, s61, 62464
    s_waitcnt vmcnt(5)
    buffer_load_dwordx4 v53, s[24:27], s52 offen lds
    s_add_u32 s52, s60, 430080
    s_add_u32 m0, s61, 63488
    s_waitcnt vmcnt(5)
    buffer_load_dwordx4 v53, s[24:27], s52 offen lds
    s_add_u32 s52, s60, 440320
    s_add_u32 m0, s61, 64512
    s_waitcnt vmcnt(5)
    buffer_load_dwordx4 v53, s[24:27], s52 offen lds
    s_add_u32 s52, s60, 450560
    s_add_u32 m0, s61, 65536
    s_waitcnt vmcnt(5)
    buffer_load_dwordx4 v53, s[24:27], s52 offen lds
    v_mov_b32 v3, 1
    s_waitcnt vmcnt(0)
    s_mov_b64 exec, 1
    ds_add_u32 v15, v3 offset:44
    s_mov_b64 exec, -1
    s_mov_b32 s3, 1048576
K_P2_GWA:
    ds_read_b32 v2, v15 offset:44
    s_sub_u32 s3, s3, 1
    s_waitcnt lgkmcnt(0)
    v_readfirstlane_b32 s33, v2
    s_nop 3
    s_cselect_b32 s33, 4, s33
    s_cmp_lt_u32 s33, 4
    s_cbranch_scc1 K_P2_GWA
    s_branch K_P2_GEMM
.p2align 12
WP_help:
    s_setpc_b64 s[38:39]
K_P2_HELP:
    s_setprio 3
    s_lshl_b32 s53, s40, 3
    s_mul_i32 s60, s53, 187
    s_lshr_b32 s60, s60, 11
    s_add_u32 s3, s53, 7
    s_mul_i32 s61, s3, 187
    s_lshr_b32 s61, s61, 11
    s_sub_u32 s61, s61, s60
    s_lshl_b32 s61, s61, 4
    s_or_b32 s61, s61, 15
    v_and_b32 v12, s61, v1
    v_lshl_add_u32 v12, v12, 2, s42
    s_cmp_lg_u32 s30, 7
    s_cbranch_scc1 K_P2_N7
    v_mov_b32 v4, 192
    s_mov_b32 s3, 131072
K_ZPOLL1:
    v_readfirstlane_b32 s33, v7
    s_nop 3
    s_sub_u32 s3, s3, 1
    s_cselect_b32 s33, 1, s33
    s_cmp_lg_u32 s33, 0
    s_cbranch_scc1 K_ZOK1
    global_load_dword v7, v4, s[8:9] sc1
    s_waitcnt vmcnt(0)
    s_branch K_ZPOLL1
K_ZOK1:
    global_load_dword v7, v12, s[10:11] sc1
K_P2_N7:
    s_lshl_b32 s54, s40, 7
    v_lshrrev_b32 v8, 3, v1
    v_lshrrev_b32 v9, 4, v1
    v_mov_b32 v15, 158720
    s_lshl_b32 s53, s40, 3
    s_add_u32 s53, s53, s30
    s_mul_i32 s3, s53, 20480
    s_lshl_b32 s33, s41, 7
    s_add_u32 s3, s3, s33
    v_and_b32 v2, 7, v1
    v_lshlrev_b32 v2, 4, v2
    v_mul_u32_u24 v4, 1280, v8
    v_add3_u32 v10, v2, v4, s3
    s_lshl_b32 s3, s53, 6
    v_lshl_add_u32 v11, v8, 2, s3
    s_mov_b32 s55, 10240
    s_add_u32 s20, s10, 0x100000
    s_addc_u32 s21, s11, 0
    s_mov_b32 s22, 0x280000
    s_mov_b32 s23, 0x20000
    s_add_u32 s16, s10, 0x1000
    s_addc_u32 s17, s11, 0
    s_mov_b32 s18, 0x2000
    s_mov_b32 s19, 0x20000
    s_mov_b32 s48, s6
    s_mov_b32 s49, s7
    s_mov_b32 s50, 0x280000
    s_mov_b32 s51, 0x20000
    v_mul_u32_u24 v3, 144, v8
    v_add_u32 v3, v2, v3
    s_mul_i32 s3, s30, 2304
    s_add_u32 s3, s3, 140288
    v_add_u32 v14, s3, v3
    s_add_u32 s44, s10, 0x10000
    s_addc_u32 s45, s11, 0
    s_mov_b32 s46, 0x43800
    s_mov_b32 s47, 0x20000
    v_mov_b32 v112, 1
    s_cmp_eq_u32 s30, 7
    s_cbranch_scc1 K_P2_FLAGS
    buffer_load_dwordx4 v[16:19], v10, s[12:15], 0 offen
    buffer_load_dwordx4 v[20:23], v10, s[12:15], s55 offen
    s_cmp_lg_u32 s30, 6
    s_cbranch_scc1 K_P2_HW
    s_mov_b32 s3, 131072
K_P2_DPOLL:
    v_cmp_eq_u32 vcc, 0, v7
    s_cbranch_vccz K_P2_DOK
    s_cmp_eq_u32 s3, 131072
    s_cbranch_scc1 K_P2_DNS
    s_sleep 12
K_P2_DNS:
    v_min_u32 v13, 23, v1
    v_lshl_add_u32 v13, v13, 2, s42
    global_load_dword v7, v13, s[10:11] offset:128 sc1
    s_sub_u32 s3, s3, 1
    s_waitcnt vmcnt(0)
    s_cmp_lg_u32 s3, 0
    s_cbranch_scc1 K_P2_DPOLL
K_P2_DOK:
    v_cmp_gt_u32 vcc, 16, v1
    s_nop 1
    v_cndmask_b32 v2, 0, v7, vcc
    s_nop 1
    v_max_u32_dpp v3, v2, v2 quad_perm:[1,0,3,2] row_mask:0xf bank_mask:0xf
    s_nop 1
    v_max_u32_dpp v3, v3, v3 quad_perm:[2,3,0,1] row_mask:0xf bank_mask:0xf
    s_nop 1
    v_max_u32_dpp v3, v3, v3 row_half_mirror row_mask:0xf bank_mask:0xf
    s_nop 1
    v_max_u32_dpp v3, v3, v3 row_mirror row_mask:0xf bank_mask:0xf
    s_nop 1
    v_readlane_b32 s60, v3, 0
    v_readlane_b32 s64, v3, 16
    v_readlane_b32 s65, v3, 32
    v_readlane_b32 s66, v3, 48
    s_nop 3
    s_max_u32 s60, s60, s64
    s_max_u32 s65, s65, s66
    s_max_u32 s60, s60, s65
    v_cmp_ne_u32 vcc, s60, v2
    s_nop 1
    v_cndmask_b32 v2, 0, v2, vcc
    s_nop 1
    v_max_u32_dpp v3, v2, v2 quad_perm:[1,0,3,2] row_mask:0xf bank_mask:0xf
    s_nop 1
    v_max_u32_dpp v3, v3, v3 quad_perm:[2,3,0,1] row_mask:0xf bank_mask:0xf
    s_nop 1
    v_max_u32_dpp v3, v3, v3 row_half_mirror row_mask:0xf bank_mask:0xf
    s_nop 1
    v_max_u32_dpp v3, v3, v3 row_mirror row_mask:0xf bank_mask:0xf
    s_nop 1
    v_readlane_b32 s61, v3, 0
    v_readlane_b32 s64, v3, 16
    v_readlane_b32 s65, v3, 32
    v_readlane_b32 s66, v3, 48
    s_nop 3
    s_max_u32 s61, s61, s64
    s_max_u32 s65, s65, s66
    s_max_u32 s61, s61, s65
    s_and_b32 s3, s60, 0x7ff
    s_sub_u32 s3, 2047, s3
    v_mov_b32 v52, s3
    v_mov_b32 v4, s60
    v_and_b32 v4, 0xffff0000, v4
    v_ashrrev_i32 v5, 31, v4
    v_not_b32 v5, v5
    v_or_b32 v5, 0x80000000, v5
    v_xor_b32 v4, v4, v5
    v_and_b32 v4, 0xffff0000, v4
    v_mul_f32 v5, 0xbfb8aa3b, v4
    v_exp_f32 v5, v5
    s_nop 0
    v_add_f32 v5, 1.0, v5
    v_rcp_f32 v4, v5
    s_nop 0
    v_cvt_pk_bf16_f32 v54, v4, v4
    v_lshlrev_b32 v54, 16, v54
    s_and_b32 s3, s61, 0x7ff
    s_sub_u32 s3, 2047, s3
    v_mov_b32 v53, s3
    v_mov_b32 v4, s61
    v_and_b32 v4, 0xffff0000, v4
    v_ashrrev_i32 v5, 31, v4
    v_not_b32 v5, v5
    v_or_b32 v5, 0x80000000, v5
    v_xor_b32 v4, v4, v5
    v_and_b32 v4, 0xffff0000, v4
    v_mul_f32 v5, 0xbfb8aa3b, v4
    v_exp_f32 v5, v5
    s_nop 0
    v_add_f32 v5, 1.0, v5
    v_rcp_f32 v4, v5
    s_nop 0
    v_cvt_pk_bf16_f32 v55, v4, v4
    v_lshlrev_b32 v55, 16, v55
    ds_write_b128 v15, v[52:55]
    ds_write_b32 v15, v112 offset:40
K_P2_HW:
    s_mov_b32 s3, 1048576
K_P2_GS2:
    ds_read_b32 v2, v15 offset:40
    s_sleep 1
    s_sub_u32 s3, s3, 1
    s_waitcnt lgkmcnt(0)
    v_readfirstlane_b32 s33, v2
    s_nop 3
    s_cselect_b32 s33, 1, s33
    s_cmp_lt_u32 s33, 1
    s_cbranch_scc1 K_P2_GS2
    buffer_load_dword v24, v11, s[16:19], 0 offen sc1
    buffer_load_dword v25, v11, s[16:19], 0 offen offset:32 sc1
    ds_read_b128 v[28:31], v15
    s_cmp_eq_u32 s30, 6
    s_cbranch_scc1 K_P2_E
    s_waitcnt lgkmcnt(0)
    s_cmp_eq_u32 s30, 4
    s_cselect_b64 vcc, -1, 0
    s_nop 1
    v_cndmask_b32 v2, v29, v28, vcc
    v_cndmask_b32 v5, v31, v30, vcc
    s_nop 0
    v_readfirstlane_b32 s60, v2
    s_nop 3
    s_sub_u32 s3, s60, s54
    s_cmp_lt_u32 s3, 128
    s_cbranch_scc0 K_P2_E
    v_min_u32 v3, 53, v1
    v_lshlrev_b32 v3, 5, v3
    v_add_u32 v3, 565248, v3
    s_mov_b32 s3, 1048576
K_P2_GY:
    ds_read_b32 v2, v15 offset:32
    s_sleep 1
    s_sub_u32 s3, s3, 1
    s_waitcnt lgkmcnt(0)
    v_readfirstlane_b32 s33, v2
    s_nop 3
    s_cselect_b32 s33, 16777216, s33
    s_cmp_lt_u32 s33, 16777216
    s_cbranch_scc1 K_P2_GY
    s_mov_b32 s3, 131072
K_P2_YPOLL:
    global_load_dwordx4 v[52:55], v3, s[10:11] sc1
    s_sub_u32 s3, s3, 1
    s_waitcnt vmcnt(0)
    v_and_b32 v2, v52, v53
    v_and_b32 v2, v2, v54
    v_and_b32 v2, v2, v55
    v_cmp_ne_u32 vcc, 1, v2
    s_cbranch_vccz K_P2_YGO
    s_sleep 8
    s_cmp_lg_u32 s3, 0
    s_cbranch_scc1 K_P2_YPOLL
K_P2_YGO:
    v_and_b32 v2, 15, v1
    v_lshlrev_b32 v2, 4, v2
    v_mul_u32_u24 v4, 5120, v9
    s_sub_u32 s61, s30, 4
    s_mul_i32 s33, s61, 2560
    s_lshl_b32 s3, s41, 8
    s_add_u32 s3, s3, s33
    v_add3_u32 v3, v2, v4, s3
    s_mov_b32 s52, 0
    buffer_load_dwordx4 v[56:59], v3, s[44:47], s52 offen sc1
    s_mov_b32 s52, 20480
    buffer_load_dwordx4 v[60:63], v3, s[44:47], s52 offen sc1
    s_mov_b32 s52, 40960
    buffer_load_dwordx4 v[64:67], v3, s[44:47], s52 offen sc1
    s_mov_b32 s52, 61440
    buffer_load_dwordx4 v[68:71], v3, s[44:47], s52 offen sc1
    s_mov_b32 s52, 81920
    buffer_load_dwordx4 v[72:75], v3, s[44:47], s52 offen sc1
    s_mov_b32 s52, 102400
    buffer_load_dwordx4 v[76:79], v3, s[44:47], s52 offen sc1
    s_mov_b32 s52, 122880
    buffer_load_dwordx4 v[80:83], v3, s[44:47], s52 offen sc1
    s_mov_b32 s52, 143360
    buffer_load_dwordx4 v[84:87], v3, s[44:47], s52 offen sc1
    s_mov_b32 s52, 163840
    buffer_load_dwordx4 v[88:91], v3, s[44:47], s52 offen sc1
    s_mov_b32 s52, 184320
    buffer_load_dwordx4 v[92:95], v3, s[44:47], s52 offen sc1
    s_mov_b32 s52, 204800
    buffer_load_dwordx4 v[96:99], v3, s[44:47], s52 offen sc1
    s_mov_b32 s52, 225280
    buffer_load_dwordx4 v[100:103], v3, s[44:47], s52 offen sc1
    s_mov_b32 s52, 245760
    buffer_load_dwordx4 v[104:107], v3, s[44:47], s52 offen sc1
    s_mov_b32 s52, 266240
    buffer_load_dwordx4 v[108:111], v3, s[44:47], s52 offen sc1
    s_waitcnt vmcnt(12)
    v_add_f32 v52, v56, v60
    v_add_f32 v53, v57, v61
    v_add_f32 v54, v58, v62
    v_add_f32 v55, v59, v63
    s_waitcnt vmcnt(11)
    v_add_f32 v52, v52, v64
    v_add_f32 v53, v53, v65
    v_add_f32 v54, v54, v66
    v_add_f32 v55, v55, v67
    s_waitcnt vmcnt(10)
    v_add_f32 v52, v52, v68
    v_add_f32 v53, v53, v69
    v_add_f32 v54, v54, v70
    v_add_f32 v55, v55, v71
    s_waitcnt vmcnt(9)
    v_add_f32 v52, v52, v72
    v_add_f32 v53, v53, v73
    v_add_f32 v54, v54, v74
    v_add_f32 v55, v55, v75
    s_waitcnt vmcnt(8)
    v_add_f32 v52, v52, v76
    v_add_f32 v53, v53, v77
    v_add_f32 v54, v54, v78
    v_add_f32 v55, v55, v79
    s_waitcnt vmcnt(7)
    v_add_f32 v52, v52, v80
    v_add_f32 v53, v53, v81
    v_add_f32 v54, v54, v82
    v_add_f32 v55, v55, v83
    s_waitcnt vmcnt(6)
    v_add_f32 v52, v52, v84
    v_add_f32 v53, v53, v85
    v_add_f32 v54, v54, v86
    v_add_f32 v55, v55, v87
    s_waitcnt vmcnt(5)
    v_add_f32 v52, v52, v88
    v_add_f32 v53, v53, v89
    v_add_f32 v54, v54, v90
    v_add_f32 v55, v55, v91
    s_waitcnt vmcnt(4)
    v_add_f32 v52, v52, v92
    v_add_f32 v53, v53, v93
    v_add_f32 v54, v54, v94
    v_add_f32 v55, v55, v95
    s_waitcnt vmcnt(3)
    v_add_f32 v52, v52, v96
    v_add_f32 v53, v53, v97
    v_add_f32 v54, v54, v98
    v_add_f32 v55, v55, v99
    s_waitcnt vmcnt(2)
    v_add_f32 v52, v52, v100
    v_add_f32 v53, v53, v101
    v_add_f32 v54, v54, v102
    v_add_f32 v55, v55, v103
    s_waitcnt vmcnt(1)
    v_add_f32 v52, v52, v104
    v_add_f32 v53, v53, v105
    v_add_f32 v54, v54, v106
    v_add_f32 v55, v55, v107
    s_waitcnt vmcnt(0)
    v_add_f32 v52, v52, v108
    v_add_f32 v53, v53, v109
    v_add_f32 v54, v54, v110
    v_add_f32 v55, v55, v111
    v_mov_b32 v56, v52
    v_mov_b32 v57, v53
    v_mov_b32 v58, v54
    v_mov_b32 v59, v55
    s_nop 0
    v_permlane16_swap_b32 v52, v56
    v_permlane16_swap_b32 v53, v57
    v_permlane16_swap_b32 v54, v58
    v_permlane16_swap_b32 v55, v59
    v_add_f32 v52, v52, v56
    v_add_f32 v53, v53, v57
    v_add_f32 v54, v54, v58
    v_add_f32 v55, v55, v59
    v_mov_b32 v56, v52
    v_mov_b32 v57, v53
    v_mov_b32 v58, v54
    v_mov_b32 v59, v55
    s_nop 0
    v_permlane32_swap_b32 v52, v56
    v_permlane32_swap_b32 v53, v57
    v_permlane32_swap_b32 v54, v58
    v_permlane32_swap_b32 v55, v59
    v_add_f32 v52, v52, v56
    v_add_f32 v53, v53, v57
    v_add_f32 v54, v54, v58
    v_add_f32 v55, v55, v59
    v_cvt_pk_bf16_f32 v52, v52, v52
    v_lshlrev_b32 v52, 16, v52
    v_mul_f32 v52, v5, v52
    v_cvt_pk_bf16_f32 v52, v52, v52
    v_lshlrev_b32 v52, 16, v52
    v_cvt_pk_bf16_f32 v53, v53, v53
    v_lshlrev_b32 v53, 16, v53
    v_mul_f32 v53, v5, v53
    v_cvt_pk_bf16_f32 v53, v53, v53
    v_lshlrev_b32 v53, 16, v53
    v_cvt_pk_bf16_f32 v54, v54, v54
    v_lshlrev_b32 v54, 16, v54
    v_mul_f32 v54, v5, v54
    v_cvt_pk_bf16_f32 v54, v54, v54
    v_lshlrev_b32 v54, 16, v54
    v_cvt_pk_bf16_f32 v55, v55, v55
    v_lshlrev_b32 v55, 16, v55
    v_mul_f32 v55, v5, v55
    v_cvt_pk_bf16_f32 v55, v55, v55
    v_lshlrev_b32 v55, 16, v55
    s_lshl_b32 s3, s61, 8
    s_add_u32 s3, s3, 158976
    v_add_u32 v2, s3, v2
    ds_write_b128 v2, v[52:55]
    s_branch K_P2_E
WP_flags:
    s_setpc_b64 s[38:39]
K_P2_FLAGS:
    s_mov_b32 exec_hi, 0
    s_waitcnt vmcnt(0)
    s_mov_b32 s3, 131072
K_P2_FCHK:
    v_cmp_eq_u32 vcc, 1, v7
    s_nop 1
    v_mov_b32 v2, vcc_lo
    ds_write_b32 v15, v2 offset:32
    s_cmp_eq_u32 vcc_lo, -1
    s_cbranch_scc1 K_P2_FGO
    s_cmp_lg_u32 vcc_lo, 0
    s_cbranch_scc1 K_P2_FS
    s_sleep 16
K_P2_FS:
    s_sleep 6
    global_load_dword v7, v12, s[10:11] sc1
    s_sub_u32 s3, s3, 1
    s_waitcnt vmcnt(0)
    s_cbranch_scc0 K_P2_FCHK
    v_mov_b32 v2, -1
    ds_write_b32 v15, v2 offset:32
K_P2_FGO:
    s_mov_b64 exec, -1
    buffer_load_dwordx4 v[16:19], v10, s[12:15], 0 offen
    buffer_load_dwordx4 v[20:23], v10, s[12:15], s55 offen
    s_mov_b32 s3, 1048576
K_P2_GS3:
    ds_read_b32 v2, v15 offset:40
    s_sleep 1
    s_sub_u32 s3, s3, 1
    s_waitcnt lgkmcnt(0)
    v_readfirstlane_b32 s33, v2
    s_nop 3
    s_cselect_b32 s33, 1, s33
    s_cmp_lt_u32 s33, 1
    s_cbranch_scc1 K_P2_GS3
    buffer_load_dword v24, v11, s[16:19], 0 offen sc1
    buffer_load_dword v25, v11, s[16:19], 0 offen offset:32 sc1
    ds_read_b128 v[28:31], v15
K_P2_E:
    s_setprio 0
    s_waitcnt vmcnt(0)
    v_sub_f32 v48, 1.0, v24
    v_cvt_pk_bf16_f32 v48, v48, v48
    v_lshlrev_b32 v48, 16, v48
    v_sub_f32 v49, 1.0, v25
    v_cvt_pk_bf16_f32 v49, v49, v49
    v_lshlrev_b32 v49, 16, v49
    v_lshlrev_b32 v32, 16, v16
    v_and_b32 v33, 0xffff0000, v16
    v_lshlrev_b32 v34, 16, v17
    v_and_b32 v35, 0xffff0000, v17
    v_lshlrev_b32 v36, 16, v18
    v_and_b32 v37, 0xffff0000, v18
    v_lshlrev_b32 v38, 16, v19
    v_and_b32 v39, 0xffff0000, v19
    v_lshlrev_b32 v40, 16, v20
    v_and_b32 v41, 0xffff0000, v20
    v_lshlrev_b32 v42, 16, v21
    v_and_b32 v43, 0xffff0000, v21
    v_lshlrev_b32 v44, 16, v22
    v_and_b32 v45, 0xffff0000, v22
    v_lshlrev_b32 v46, 16, v23
    v_and_b32 v47, 0xffff0000, v23
    v_mul_f32 v32, v32, v48
    v_mul_f32 v33, v33, v48
    v_mul_f32 v34, v34, v48
    v_mul_f32 v35, v35, v48
    v_mul_f32 v36, v36, v48
    v_mul_f32 v37, v37, v48
    v_mul_f32 v38, v38, v48
    v_mul_f32 v39, v39, v48
    v_mul_f32 v40, v40, v49
    v_mul_f32 v41, v41, v49
    v_mul_f32 v42, v42, v49
    v_mul_f32 v43, v43, v49
    v_mul_f32 v44, v44, v49
    v_mul_f32 v45, v45, v49
    v_mul_f32 v46, v46, v49
    v_mul_f32 v47, v47, v49
    s_branch K_P2_E2
.p2align 12
K_AUX:
    s_load_dwordx8 s[48:55], s[0:1], 32
    s_load_dwordx2 s[56:57], s[0:1], 64
    s_mov_b32 s36, 4
    s_mul_i32 s44, s28, 7
    s_add_u32 s44, s44, s29
    s_sub_u32 s44, s44, 1
    s_cmp_lt_u32 s44, 54
    s_cselect_b32 s44, s44, 63
    s_cmp_eq_u32 s29, 0
    s_cselect_b32 s44, 63, s44
    s_lshl_b32 s3, s28, 8
    s_lshl_b32 s72, s30, 5
    s_add_u32 s3, s3, s72
    v_lshrrev_b32 v8, 3, v1
    v_add_u32 v8, s3, v8
    v_and_b32 v10, 7, v1
    v_lshlrev_b32 v10, 4, v10
    v_mul_u32_u24 v9, 1280, v8
    v_add_u32 v9, v9, v10
    s_waitcnt lgkmcnt(0)
    s_mov_b32 s16, s48
    s_mov_b32 s17, s49
    s_mov_b32 s18, 0x500
    s_mov_b32 s19, 0x20000
    s_mov_b32 s20, s56
    s_mov_b32 s21, s57
    s_mov_b32 s22, 0x500
    s_mov_b32 s23, 0x20000
    s_cmp_lg_u32 s2, 63
    s_cbranch_scc1 K_AUX_NOZ
    s_add_u32 s60, s10, 0x80000
    s_addc_u32 s61, s11, 0
    s_mov_b32 s62, 0xa800
    s_mov_b32 s63, 0x20000
    v_lshlrev_b32 v2, 4, v0
    v_mov_b32 v12, 0
    v_mov_b32 v13, 0
    v_mov_b32 v14, 0
    v_mov_b32 v15, 0
    s_mov_b32 s3, 0
    buffer_store_dwordx4 v[12:15], v2, s[60:63], s3 offen sc1
    s_mov_b32 s3, 8192
    buffer_store_dwordx4 v[12:15], v2, s[60:63], s3 offen sc1
    s_mov_b32 s3, 16384
    buffer_store_dwordx4 v[12:15], v2, s[60:63], s3 offen sc1
    s_mov_b32 s3, 24576
    buffer_store_dwordx4 v[12:15], v2, s[60:63], s3 offen sc1
    s_mov_b32 s3, 32768
    buffer_store_dwordx4 v[12:15], v2, s[60:63], s3 offen sc1
    s_mov_b32 s3, 40960
    buffer_store_dwordx4 v[12:15], v2, s[60:63], s3 offen sc1
    v_mov_b32 v2, 192
    v_mov_b32 v3, 1
    s_waitcnt vmcnt(0)
    s_barrier
    s_cmp_lg_u32 s30, 0
    s_cbranch_scc1 K_AUX_NOZ
    s_mov_b64 exec, 1
    global_store_dword v2, v3, s[8:9] sc1
    s_mov_b64 exec, -1
K_AUX_NOZ:
    s_cmp_lg_u32 s29, 0
    s_cbranch_scc1 K_AUX_FFN0
    v_lshlrev_b32 v2, 4, v1
    s_cmp_ge_u32 s30, 2
    s_cbranch_scc1 K_AUX_R1
    s_cmp_eq_u32 s30, 1
    s_cbranch_scc1 K_AUX_R0
    s_mov_b32 m0, 126016
    s_nop 0
    buffer_load_dwordx4 v2, s[16:19], 0 offen lds
    buffer_load_dwordx4 v2, s[16:19], 0 offen offset:1024 lds
    s_branch K_AUX_R1
K_AUX_R0:
    s_mov_b32 m0, 128064
    s_nop 0
    buffer_load_dwordx4 v2, s[20:23], 0 offen lds
    buffer_load_dwordx4 v2, s[20:23], 0 offen offset:1024 lds
K_AUX_R1:
    s_mov_b32 s72, 10240
    s_mov_b32 s73, 20480
    s_mov_b32 s74, 30720
    v_add_u32 v10, 126016, v10
    buffer_load_dwordx4 v[12:15], v9, s[12:15], 0 offen offset:0
    buffer_load_dwordx4 v[16:19], v9, s[12:15], s72 offen offset:0
    buffer_load_dwordx4 v[20:23], v9, s[12:15], s73 offen offset:0
    buffer_load_dwordx4 v[24:27], v9, s[12:15], s74 offen offset:0
    buffer_load_dwordx4 v[28:31], v9, s[12:15], 0 offen offset:128
    buffer_load_dwordx4 v[32:35], v9, s[12:15], s72 offen offset:128
    buffer_load_dwordx4 v[36:39], v9, s[12:15], s73 offen offset:128
    buffer_load_dwordx4 v[40:43], v9, s[12:15], s74 offen offset:128
    s_waitcnt vmcnt(8)
    s_barrier
    buffer_load_dwordx4 v[44:47], v9, s[12:15], 0 offen offset:256
    buffer_load_dwordx4 v[48:51], v9, s[12:15], s72 offen offset:256
    buffer_load_dwordx4 v[52:55], v9, s[12:15], s73 offen offset:256
    buffer_load_dwordx4 v[56:59], v9, s[12:15], s74 offen offset:256
    buffer_load_dwordx4 v[60:63], v9, s[12:15], 0 offen offset:384
    buffer_load_dwordx4 v[64:67], v9, s[12:15], s72 offen offset:384
    buffer_load_dwordx4 v[68:71], v9, s[12:15], s73 offen offset:384
    buffer_load_dwordx4 v[72:75], v9, s[12:15], s74 offen offset:384
    buffer_load_dwordx4 v[76:79], v9, s[12:15], 0 offen offset:512
    buffer_load_dwordx4 v[80:83], v9, s[12:15], s72 offen offset:512
    buffer_load_dwordx4 v[84:87], v9, s[12:15], s73 offen offset:512
    buffer_load_dwordx4 v[88:91], v9, s[12:15], s74 offen offset:512
    buffer_load_dwordx4 v[92:95], v9, s[12:15], 0 offen offset:640
    buffer_load_dwordx4 v[96:99], v9, s[12:15], s72 offen offset:640
    buffer_load_dwordx4 v[100:103], v9, s[12:15], s73 offen offset:640
    buffer_load_dwordx4 v[104:107], v9, s[12:15], s74 offen offset:640
    buffer_load_dwordx4 v[108:111], v9, s[12:15], 0 offen offset:768
    buffer_load_dwordx4 v[112:115], v9, s[12:15], s72 offen offset:768
    buffer_load_dwordx4 v[116:119], v9, s[12:15], s73 offen offset:768
    buffer_load_dwordx4 v[120:123], v9, s[12:15], s74 offen offset:768
    buffer_load_dwordx4 v[124:127], v9, s[12:15], 0 offen offset:896
    buffer_load_dwordx4 v[128:131], v9, s[12:15], s72 offen offset:896
    buffer_load_dwordx4 v[132:135], v9, s[12:15], s73 offen offset:896
    buffer_load_dwordx4 v[136:139], v9, s[12:15], s74 offen offset:896
    buffer_load_dwordx4 v[140:143], v9, s[12:15], 0 offen offset:1024
    buffer_load_dwordx4 v[144:147], v9, s[12:15], s72 offen offset:1024
    buffer_load_dwordx4 v[148:151], v9, s[12:15], s73 offen offset:1024
    buffer_load_dwordx4 v[152:155], v9, s[12:15], s74 offen offset:1024
    buffer_load_dwordx4 v[156:159], v9, s[12:15], 0 offen offset:1152
    buffer_load_dwordx4 v[160:163], v9, s[12:15], s72 offen offset:1152
    buffer_load_dwordx4 v[164:167], v9, s[12:15], s73 offen offset:1152
    buffer_load_dwordx4 v[168:171], v9, s[12:15], s74 offen offset:1152
    v_mov_b32 v2, 192
    global_load_dword v7, v2, s[8:9] sc1
    v_mov_b32 v188, 0
    v_mov_b32 v192, 0
    v_mov_b32 v189, 0
    v_mov_b32 v193, 0
    v_mov_b32 v190, 0
    v_mov_b32 v194, 0
    v_mov_b32 v191, 0
    v_mov_b32 v195, 0
    ds_read_b128 v[172:175], v10 offset:0
    ds_read_b128 v[176:179], v10 offset:128
    s_waitcnt vmcnt(37) lgkmcnt(1)
    v_dot2c_f32_bf16 v188, v12, v172
    v_dot2c_f32_bf16 v189, v16, v172
    v_dot2c_f32_bf16 v190, v20, v172
    v_dot2c_f32_bf16 v191, v24, v172
    v_dot2c_f32_bf16 v188, v13, v173
    v_dot2c_f32_bf16 v189, v17, v173
    v_dot2c_f32_bf16 v190, v21, v173
    v_dot2c_f32_bf16 v191, v25, v173
    v_dot2c_f32_bf16 v188, v14, v174
    v_dot2c_f32_bf16 v189, v18, v174
    v_dot2c_f32_bf16 v190, v22, v174
    v_dot2c_f32_bf16 v191, v26, v174
    v_dot2c_f32_bf16 v188, v15, v175
    v_dot2c_f32_bf16 v189, v19, v175
    v_dot2c_f32_bf16 v190, v23, v175
    v_dot2c_f32_bf16 v191, v27, v175
    ds_read_b128 v[172:175], v10 offset:256
    s_waitcnt vmcnt(33) lgkmcnt(1)
    v_dot2c_f32_bf16 v188, v28, v176
    v_dot2c_f32_bf16 v189, v32, v176
    v_dot2c_f32_bf16 v190, v36, v176
    v_dot2c_f32_bf16 v191, v40, v176
    v_dot2c_f32_bf16 v188, v29, v177
    v_dot2c_f32_bf16 v189, v33, v177
    v_dot2c_f32_bf16 v190, v37, v177
    v_dot2c_f32_bf16 v191, v41, v177
    v_dot2c_f32_bf16 v188, v30, v178
    v_dot2c_f32_bf16 v189, v34, v178
    v_dot2c_f32_bf16 v190, v38, v178
    v_dot2c_f32_bf16 v191, v42, v178
    v_dot2c_f32_bf16 v188, v31, v179
    v_dot2c_f32_bf16 v189, v35, v179
    v_dot2c_f32_bf16 v190, v39, v179
    v_dot2c_f32_bf16 v191, v43, v179
    ds_read_b128 v[176:179], v10 offset:384
    s_waitcnt vmcnt(29) lgkmcnt(1)
    v_dot2c_f32_bf16 v188, v44, v172
    v_dot2c_f32_bf16 v189, v48, v172
    v_dot2c_f32_bf16 v190, v52, v172
    v_dot2c_f32_bf16 v191, v56, v172
    v_dot2c_f32_bf16 v188, v45, v173
    v_dot2c_f32_bf16 v189, v49, v173
    v_dot2c_f32_bf16 v190, v53, v173
    v_dot2c_f32_bf16 v191, v57, v173
    v_dot2c_f32_bf16 v188, v46, v174
    v_dot2c_f32_bf16 v189, v50, v174
    v_dot2c_f32_bf16 v190, v54, v174
    v_dot2c_f32_bf16 v191, v58, v174
    v_dot2c_f32_bf16 v188, v47, v175
    v_dot2c_f32_bf16 v189, v51, v175
    v_dot2c_f32_bf16 v190, v55, v175
    v_dot2c_f32_bf16 v191, v59, v175
    ds_read_b128 v[172:175], v10 offset:512
    s_waitcnt vmcnt(25) lgkmcnt(1)
    v_dot2c_f32_bf16 v188, v60, v176
    v_dot2c_f32_bf16 v189, v64, v176
    v_dot2c_f32_bf16 v190, v68, v176
    v_dot2c_f32_bf16 v191, v72, v176
    v_dot2c_f32_bf16 v188, v61, v177
    v_dot2c_f32_bf16 v189, v65, v177
    v_dot2c_f32_bf16 v190, v69, v177
    v_dot2c_f32_bf16 v191, v73, v177
    v_dot2c_f32_bf16 v188, v62, v178
    v_dot2c_f32_bf16 v189, v66, v178
    v_dot2c_f32_bf16 v190, v70, v178
    v_dot2c_f32_bf16 v191, v74, v178
    v_dot2c_f32_bf16 v188, v63, v179
    v_dot2c_f32_bf16 v189, v67, v179
    v_dot2c_f32_bf16 v190, v71, v179
    v_dot2c_f32_bf16 v191, v75, v179
    ds_read_b128 v[176:179], v10 offset:640
    s_waitcnt vmcnt(21) lgkmcnt(1)
    v_dot2c_f32_bf16 v188, v76, v172
    v_dot2c_f32_bf16 v189, v80, v172
    v_dot2c_f32_bf16 v190, v84, v172
    v_dot2c_f32_bf16 v191, v88, v172
    v_dot2c_f32_bf16 v188, v77, v173
    v_dot2c_f32_bf16 v189, v81, v173
    v_dot2c_f32_bf16 v190, v85, v173
    v_dot2c_f32_bf16 v191, v89, v173
    v_dot2c_f32_bf16 v188, v78, v174
    v_dot2c_f32_bf16 v189, v82, v174
    v_dot2c_f32_bf16 v190, v86, v174
    v_dot2c_f32_bf16 v191, v90, v174
    v_dot2c_f32_bf16 v188, v79, v175
    v_dot2c_f32_bf16 v189, v83, v175
    v_dot2c_f32_bf16 v190, v87, v175
    v_dot2c_f32_bf16 v191, v91, v175
    ds_read_b128 v[172:175], v10 offset:768
    s_waitcnt vmcnt(17) lgkmcnt(1)
    v_dot2c_f32_bf16 v188, v92, v176
    v_dot2c_f32_bf16 v189, v96, v176
    v_dot2c_f32_bf16 v190, v100, v176
    v_dot2c_f32_bf16 v191, v104, v176
    v_dot2c_f32_bf16 v188, v93, v177
    v_dot2c_f32_bf16 v189, v97, v177
    v_dot2c_f32_bf16 v190, v101, v177
    v_dot2c_f32_bf16 v191, v105, v177
    v_dot2c_f32_bf16 v188, v94, v178
    v_dot2c_f32_bf16 v189, v98, v178
    v_dot2c_f32_bf16 v190, v102, v178
    v_dot2c_f32_bf16 v191, v106, v178
    v_dot2c_f32_bf16 v188, v95, v179
    v_dot2c_f32_bf16 v189, v99, v179
    v_dot2c_f32_bf16 v190, v103, v179
    v_dot2c_f32_bf16 v191, v107, v179
    ds_read_b128 v[176:179], v10 offset:896
    s_waitcnt vmcnt(13) lgkmcnt(1)
    v_dot2c_f32_bf16 v188, v108, v172
    v_dot2c_f32_bf16 v189, v112, v172
    v_dot2c_f32_bf16 v190, v116, v172
    v_dot2c_f32_bf16 v191, v120, v172
    v_dot2c_f32_bf16 v188, v109, v173
    v_dot2c_f32_bf16 v189, v113, v173
    v_dot2c_f32_bf16 v190, v117, v173
    v_dot2c_f32_bf16 v191, v121, v173
    v_dot2c_f32_bf16 v188, v110, v174
    v_dot2c_f32_bf16 v189, v114, v174
    v_dot2c_f32_bf16 v190, v118, v174
    v_dot2c_f32_bf16 v191, v122, v174
    v_dot2c_f32_bf16 v188, v111, v175
    v_dot2c_f32_bf16 v189, v115, v175
    v_dot2c_f32_bf16 v190, v119, v175
    v_dot2c_f32_bf16 v191, v123, v175
    ds_read_b128 v[172:175], v10 offset:1024
    s_waitcnt vmcnt(9) lgkmcnt(1)
    v_dot2c_f32_bf16 v188, v124, v176
    v_dot2c_f32_bf16 v189, v128, v176
    v_dot2c_f32_bf16 v190, v132, v176
    v_dot2c_f32_bf16 v191, v136, v176
    v_dot2c_f32_bf16 v188, v125, v177
    v_dot2c_f32_bf16 v189, v129, v177
    v_dot2c_f32_bf16 v190, v133, v177
    v_dot2c_f32_bf16 v191, v137, v177
    v_dot2c_f32_bf16 v188, v126, v178
    v_dot2c_f32_bf16 v189, v130, v178
    v_dot2c_f32_bf16 v190, v134, v178
    v_dot2c_f32_bf16 v191, v138, v178
    v_dot2c_f32_bf16 v188, v127, v179
    v_dot2c_f32_bf16 v189, v131, v179
    v_dot2c_f32_bf16 v190, v135, v179
    v_dot2c_f32_bf16 v191, v139, v179
    ds_read_b128 v[176:179], v10 offset:1152
    s_waitcnt vmcnt(5) lgkmcnt(1)
    v_dot2c_f32_bf16 v188, v140, v172
    v_dot2c_f32_bf16 v189, v144, v172
    v_dot2c_f32_bf16 v190, v148, v172
    v_dot2c_f32_bf16 v191, v152, v172
    v_dot2c_f32_bf16 v188, v141, v173
    v_dot2c_f32_bf16 v189, v145, v173
    v_dot2c_f32_bf16 v190, v149, v173
    v_dot2c_f32_bf16 v191, v153, v173
    v_dot2c_f32_bf16 v188, v142, v174
    v_dot2c_f32_bf16 v189, v146, v174
    v_dot2c_f32_bf16 v190, v150, v174
    v_dot2c_f32_bf16 v191, v154, v174
    v_dot2c_f32_bf16 v188, v143, v175
    v_dot2c_f32_bf16 v189, v147, v175
    v_dot2c_f32_bf16 v190, v151, v175
    v_dot2c_f32_bf16 v191, v155, v175
    s_waitcnt vmcnt(0) lgkmcnt(0)
    v_dot2c_f32_bf16 v188, v156, v176
    v_dot2c_f32_bf16 v189, v160, v176
    v_dot2c_f32_bf16 v190, v164, v176
    v_dot2c_f32_bf16 v191, v168, v176
    v_dot2c_f32_bf16 v188, v157, v177
    v_dot2c_f32_bf16 v189, v161, v177
    v_dot2c_f32_bf16 v190, v165, v177
    v_dot2c_f32_bf16 v191, v169, v177
    v_dot2c_f32_bf16 v188, v158, v178
    v_dot2c_f32_bf16 v189, v162, v178
    v_dot2c_f32_bf16 v190, v166, v178
    v_dot2c_f32_bf16 v191, v170, v178
    v_dot2c_f32_bf16 v188, v159, v179
    v_dot2c_f32_bf16 v189, v163, v179
    v_dot2c_f32_bf16 v190, v167, v179
    v_dot2c_f32_bf16 v191, v171, v179
    s_nop 2
    v_add_f32_dpp v188, v188, v188 quad_perm:[1,0,3,2] row_mask:0xf bank_mask:0xf
    v_add_f32_dpp v189, v189, v189 quad_perm:[1,0,3,2] row_mask:0xf bank_mask:0xf
    v_add_f32_dpp v190, v190, v190 quad_perm:[1,0,3,2] row_mask:0xf bank_mask:0xf
    v_add_f32_dpp v191, v191, v191 quad_perm:[1,0,3,2] row_mask:0xf bank_mask:0xf
    v_add_f32_dpp v188, v188, v188 quad_perm:[2,3,0,1] row_mask:0xf bank_mask:0xf
    v_add_f32_dpp v189, v189, v189 quad_perm:[2,3,0,1] row_mask:0xf bank_mask:0xf
    v_add_f32_dpp v190, v190, v190 quad_perm:[2,3,0,1] row_mask:0xf bank_mask:0xf
    v_add_f32_dpp v191, v191, v191 quad_perm:[2,3,0,1] row_mask:0xf bank_mask:0xf
    v_add_f32_dpp v188, v188, v188 row_half_mirror row_mask:0xf bank_mask:0xf
    v_add_f32_dpp v189, v189, v189 row_half_mirror row_mask:0xf bank_mask:0xf
    v_add_f32_dpp v190, v190, v190 row_half_mirror row_mask:0xf bank_mask:0xf
    v_add_f32_dpp v191, v191, v191 row_half_mirror row_mask:0xf bank_mask:0xf
    v_and_b32 v180, 255, v8
    v_lshlrev_b32 v180, 2, v180
    v_add_u32 v180, 122880, v180
    v_cvt_pk_bf16_f32 v2, v188, v188
    v_lshlrev_b32 v2, 16, v2
    v_ashrrev_i32 v3, 31, v2
    v_or_b32 v3, 0x80000000, v3
    v_xor_b32 v2, v2, v3
    v_and_b32 v2, 0xffff0000, v2
    v_sub_u32 v3, 0x87ff, v8
    v_or_b32 v188, v2, v3
    ds_write_b32 v180, v188 offset:0
    v_cvt_pk_bf16_f32 v2, v189, v189
    v_lshlrev_b32 v2, 16, v2
    v_ashrrev_i32 v3, 31, v2
    v_or_b32 v3, 0x80000000, v3
    v_xor_b32 v2, v2, v3
    v_and_b32 v2, 0xffff0000, v2
    v_sub_u32 v3, 0x87f7, v8
    v_or_b32 v189, v2, v3
    ds_write_b32 v180, v189 offset:32
    v_cvt_pk_bf16_f32 v2, v190, v190
    v_lshlrev_b32 v2, 16, v2
    v_ashrrev_i32 v3, 31, v2
    v_or_b32 v3, 0x80000000, v3
    v_xor_b32 v2, v2, v3
    v_and_b32 v2, 0xffff0000, v2
    v_sub_u32 v3, 0x87ef, v8
    v_or_b32 v190, v2, v3
    ds_write_b32 v180, v190 offset:64
    v_cvt_pk_bf16_f32 v2, v191, v191
    v_lshlrev_b32 v2, 16, v2
    v_ashrrev_i32 v3, 31, v2
    v_or_b32 v3, 0x80000000, v3
    v_xor_b32 v2, v2, v3
    v_and_b32 v2, 0xffff0000, v2
    v_sub_u32 v3, 0x87e7, v8
    v_or_b32 v191, v2, v3
    ds_write_b32 v180, v191 offset:96
    s_waitcnt lgkmcnt(0)
    s_barrier
    s_cmp_lg_u32 s30, 0
    s_cbranch_scc1 K_AUX_G0
    s_setprio 3
    v_lshlrev_b32 v3, 4, v1
    v_add_u32 v3, 122880, v3
    ds_read_b128 v[196:199], v3
    s_waitcnt lgkmcnt(0)
    v_max_u32 v2, v196, v197
    v_min_u32 v3, v196, v197
    v_max_u32 v4, v198, v199
    v_min_u32 v5, v198, v199
    v_max_u32 v3, v3, v5
    v_min_u32 v5, v2, v4
    v_max_u32 v2, v2, v4
    v_max_u32 v4, v3, v5
    s_nop 1
    v_max_u32_dpp v3, v2, v2 quad_perm:[1,0,3,2] row_mask:0xf bank_mask:0xf
    s_nop 1
    v_max_u32_dpp v3, v3, v3 quad_perm:[2,3,0,1] row_mask:0xf bank_mask:0xf
    s_nop 1
    v_max_u32_dpp v3, v3, v3 row_half_mirror row_mask:0xf bank_mask:0xf
    s_nop 1
    v_max_u32_dpp v3, v3, v3 row_mirror row_mask:0xf bank_mask:0xf
    s_nop 1
    v_readlane_b32 s74, v3, 0
    v_readlane_b32 s76, v3, 16
    v_readlane_b32 s77, v3, 32
    v_readlane_b32 s78, v3, 48
    s_nop 3
    s_max_u32 s74, s74, s76
    s_max_u32 s77, s77, s78
    s_max_u32 s74, s74, s77
    v_cmp_ne_u32 vcc, s74, v2
    s_nop 1
    v_cndmask_b32 v2, v4, v2, vcc
    s_nop 1
    v_max_u32_dpp v3, v2, v2 quad_perm:[1,0,3,2] row_mask:0xf bank_mask:0xf
    s_nop 1
    v_max_u32_dpp v3, v3, v3 quad_perm:[2,3,0,1] row_mask:0xf bank_mask:0xf
    s_nop 1
    v_max_u32_dpp v3, v3, v3 row_half_mirror row_mask:0xf bank_mask:0xf
    s_nop 1
    v_max_u32_dpp v3, v3, v3 row_mirror row_mask:0xf bank_mask:0xf
    s_nop 1
    v_readlane_b32 s75, v3, 0
    v_readlane_b32 s76, v3, 16
    v_readlane_b32 s77, v3, 32
    v_readlane_b32 s78, v3, 48
    s_nop 3
    s_max_u32 s75, s75, s76
    s_max_u32 s77, s77, s78
    s_max_u32 s75, s75, s77
    v_mov_b32 v196, s74
    v_mov_b32 v197, s75
    v_mov_b32 v4, 192
    s_mov_b32 s3, 131072
K_ZPOLL3:
    v_readfirstlane_b32 s33, v7
    s_nop 3
    s_sub_u32 s3, s3, 1
    s_cselect_b32 s33, 1, s33
    s_cmp_lg_u32 s33, 0
    s_cbranch_scc1 K_ZOK3
    global_load_dword v7, v4, s[8:9] sc1
    s_waitcnt vmcnt(0)
    s_branch K_ZPOLL3
K_ZOK3:
    s_add_u32 s64, s10, 0x80000
    s_addc_u32 s65, s11, 0
    s_mov_b32 s66, 0xa000
    s_mov_b32 s67, 0x20000
    s_lshl_b32 s3, s28, 3
    v_lshl_add_u32 v3, v1, 8, s3
    s_mov_b32 s3, 0
    buffer_store_dwordx2 v[196:197], v3, s[64:67], s3 offen offset:128 sc1
    s_mov_b32 s3, 16384
    buffer_store_dwordx2 v[196:197], v3, s[64:67], s3 offen offset:128 sc1
    s_mov_b32 s3, 32768
    buffer_store_dwordx2 v[196:197], v3, s[64:67], s3 offen offset:128 sc1
    s_setprio 0
K_AUX_G0:
    ds_read_b128 v[172:175], v10 offset:2048
    ds_read_b128 v[176:179], v10 offset:2176
    s_waitcnt lgkmcnt(1)
    v_dot2c_f32_bf16 v192, v12, v172
    v_dot2c_f32_bf16 v193, v16, v172
    v_dot2c_f32_bf16 v194, v20, v172
    v_dot2c_f32_bf16 v195, v24, v172
    v_dot2c_f32_bf16 v192, v13, v173
    v_dot2c_f32_bf16 v193, v17, v173
    v_dot2c_f32_bf16 v194, v21, v173
    v_dot2c_f32_bf16 v195, v25, v173
    v_dot2c_f32_bf16 v192, v14, v174
    v_dot2c_f32_bf16 v193, v18, v174
    v_dot2c_f32_bf16 v194, v22, v174
    v_dot2c_f32_bf16 v195, v26, v174
    v_dot2c_f32_bf16 v192, v15, v175
    v_dot2c_f32_bf16 v193, v19, v175
    v_dot2c_f32_bf16 v194, v23, v175
    v_dot2c_f32_bf16 v195, v27, v175
    ds_read_b128 v[172:175], v10 offset:2304
    s_waitcnt lgkmcnt(1)
    v_dot2c_f32_bf16 v192, v28, v176
    v_dot2c_f32_bf16 v193, v32, v176
    v_dot2c_f32_bf16 v194, v36, v176
    v_dot2c_f32_bf16 v195, v40, v176
    v_dot2c_f32_bf16 v192, v29, v177
    v_dot2c_f32_bf16 v193, v33, v177
    v_dot2c_f32_bf16 v194, v37, v177
    v_dot2c_f32_bf16 v195, v41, v177
    v_dot2c_f32_bf16 v192, v30, v178
    v_dot2c_f32_bf16 v193, v34, v178
    v_dot2c_f32_bf16 v194, v38, v178
    v_dot2c_f32_bf16 v195, v42, v178
    v_dot2c_f32_bf16 v192, v31, v179
    v_dot2c_f32_bf16 v193, v35, v179
    v_dot2c_f32_bf16 v194, v39, v179
    v_dot2c_f32_bf16 v195, v43, v179
    ds_read_b128 v[176:179], v10 offset:2432
    s_waitcnt lgkmcnt(1)
    v_dot2c_f32_bf16 v192, v44, v172
    v_dot2c_f32_bf16 v193, v48, v172
    v_dot2c_f32_bf16 v194, v52, v172
    v_dot2c_f32_bf16 v195, v56, v172
    v_dot2c_f32_bf16 v192, v45, v173
    v_dot2c_f32_bf16 v193, v49, v173
    v_dot2c_f32_bf16 v194, v53, v173
    v_dot2c_f32_bf16 v195, v57, v173
    v_dot2c_f32_bf16 v192, v46, v174
    v_dot2c_f32_bf16 v193, v50, v174
    v_dot2c_f32_bf16 v194, v54, v174
    v_dot2c_f32_bf16 v195, v58, v174
    v_dot2c_f32_bf16 v192, v47, v175
    v_dot2c_f32_bf16 v193, v51, v175
    v_dot2c_f32_bf16 v194, v55, v175
    v_dot2c_f32_bf16 v195, v59, v175
    ds_read_b128 v[172:175], v10 offset:2560
    s_waitcnt lgkmcnt(1)
    v_dot2c_f32_bf16 v192, v60, v176
    v_dot2c_f32_bf16 v193, v64, v176
    v_dot2c_f32_bf16 v194, v68, v176
    v_dot2c_f32_bf16 v195, v72, v176
    v_dot2c_f32_bf16 v192, v61, v177
    v_dot2c_f32_bf16 v193, v65, v177
    v_dot2c_f32_bf16 v194, v69, v177
    v_dot2c_f32_bf16 v195, v73, v177
    v_dot2c_f32_bf16 v192, v62, v178
    v_dot2c_f32_bf16 v193, v66, v178
    v_dot2c_f32_bf16 v194, v70, v178
    v_dot2c_f32_bf16 v195, v74, v178
    v_dot2c_f32_bf16 v192, v63, v179
    v_dot2c_f32_bf16 v193, v67, v179
    v_dot2c_f32_bf16 v194, v71, v179
    v_dot2c_f32_bf16 v195, v75, v179
    ds_read_b128 v[176:179], v10 offset:2688
    s_waitcnt lgkmcnt(1)
    v_dot2c_f32_bf16 v192, v76, v172
    v_dot2c_f32_bf16 v193, v80, v172
    v_dot2c_f32_bf16 v194, v84, v172
    v_dot2c_f32_bf16 v195, v88, v172
    v_dot2c_f32_bf16 v192, v77, v173
    v_dot2c_f32_bf16 v193, v81, v173
    v_dot2c_f32_bf16 v194, v85, v173
    v_dot2c_f32_bf16 v195, v89, v173
    v_dot2c_f32_bf16 v192, v78, v174
    v_dot2c_f32_bf16 v193, v82, v174
    v_dot2c_f32_bf16 v194, v86, v174
    v_dot2c_f32_bf16 v195, v90, v174
    v_dot2c_f32_bf16 v192, v79, v175
    v_dot2c_f32_bf16 v193, v83, v175
    v_dot2c_f32_bf16 v194, v87, v175
    v_dot2c_f32_bf16 v195, v91, v175
    ds_read_b128 v[172:175], v10 offset:2816
    s_waitcnt lgkmcnt(1)
    v_dot2c_f32_bf16 v192, v92, v176
    v_dot2c_f32_bf16 v193, v96, v176
    v_dot2c_f32_bf16 v194, v100, v176
    v_dot2c_f32_bf16 v195, v104, v176
    v_dot2c_f32_bf16 v192, v93, v177
    v_dot2c_f32_bf16 v193, v97, v177
    v_dot2c_f32_bf16 v194, v101, v177
    v_dot2c_f32_bf16 v195, v105, v177
    v_dot2c_f32_bf16 v192, v94, v178
    v_dot2c_f32_bf16 v193, v98, v178
    v_dot2c_f32_bf16 v194, v102, v178
    v_dot2c_f32_bf16 v195, v106, v178
    v_dot2c_f32_bf16 v192, v95, v179
    v_dot2c_f32_bf16 v193, v99, v179
    v_dot2c_f32_bf16 v194, v103, v179
    v_dot2c_f32_bf16 v195, v107, v179
    ds_read_b128 v[176:179], v10 offset:2944
    s_waitcnt lgkmcnt(1)
    v_dot2c_f32_bf16 v192, v108, v172
    v_dot2c_f32_bf16 v193, v112, v172
    v_dot2c_f32_bf16 v194, v116, v172
    v_dot2c_f32_bf16 v195, v120, v172
    v_dot2c_f32_bf16 v192, v109, v173
    v_dot2c_f32_bf16 v193, v113, v173
    v_dot2c_f32_bf16 v194, v117, v173
    v_dot2c_f32_bf16 v195, v121, v173
    v_dot2c_f32_bf16 v192, v110, v174
    v_dot2c_f32_bf16 v193, v114, v174
    v_dot2c_f32_bf16 v194, v118, v174
    v_dot2c_f32_bf16 v195, v122, v174
    v_dot2c_f32_bf16 v192, v111, v175
    v_dot2c_f32_bf16 v193, v115, v175
    v_dot2c_f32_bf16 v194, v119, v175
    v_dot2c_f32_bf16 v195, v123, v175
    ds_read_b128 v[172:175], v10 offset:3072
    s_waitcnt lgkmcnt(1)
    v_dot2c_f32_bf16 v192, v124, v176
    v_dot2c_f32_bf16 v193, v128, v176
    v_dot2c_f32_bf16 v194, v132, v176
    v_dot2c_f32_bf16 v195, v136, v176
    v_dot2c_f32_bf16 v192, v125, v177
    v_dot2c_f32_bf16 v193, v129, v177
    v_dot2c_f32_bf16 v194, v133, v177
    v_dot2c_f32_bf16 v195, v137, v177
    v_dot2c_f32_bf16 v192, v126, v178
    v_dot2c_f32_bf16 v193, v130, v178
    v_dot2c_f32_bf16 v194, v134, v178
    v_dot2c_f32_bf16 v195, v138, v178
    v_dot2c_f32_bf16 v192, v127, v179
    v_dot2c_f32_bf16 v193, v131, v179
    v_dot2c_f32_bf16 v194, v135, v179
    v_dot2c_f32_bf16 v195, v139, v179
    ds_read_b128 v[176:179], v10 offset:3200
    s_waitcnt lgkmcnt(1)
    v_dot2c_f32_bf16 v192, v140, v172
    v_dot2c_f32_bf16 v193, v144, v172
    v_dot2c_f32_bf16 v194, v148, v172
    v_dot2c_f32_bf16 v195, v152, v172
    v_dot2c_f32_bf16 v192, v141, v173
    v_dot2c_f32_bf16 v193, v145, v173
    v_dot2c_f32_bf16 v194, v149, v173
    v_dot2c_f32_bf16 v195, v153, v173
    v_dot2c_f32_bf16 v192, v142, v174
    v_dot2c_f32_bf16 v193, v146, v174
    v_dot2c_f32_bf16 v194, v150, v174
    v_dot2c_f32_bf16 v195, v154, v174
    v_dot2c_f32_bf16 v192, v143, v175
    v_dot2c_f32_bf16 v193, v147, v175
    v_dot2c_f32_bf16 v194, v151, v175
    v_dot2c_f32_bf16 v195, v155, v175
    s_waitcnt lgkmcnt(0)
    v_dot2c_f32_bf16 v192, v156, v176
    v_dot2c_f32_bf16 v193, v160, v176
    v_dot2c_f32_bf16 v194, v164, v176
    v_dot2c_f32_bf16 v195, v168, v176
    v_dot2c_f32_bf16 v192, v157, v177
    v_dot2c_f32_bf16 v193, v161, v177
    v_dot2c_f32_bf16 v194, v165, v177
    v_dot2c_f32_bf16 v195, v169, v177
    v_dot2c_f32_bf16 v192, v158, v178
    v_dot2c_f32_bf16 v193, v162, v178
    v_dot2c_f32_bf16 v194, v166, v178
    v_dot2c_f32_bf16 v195, v170, v178
    v_dot2c_f32_bf16 v192, v159, v179
    v_dot2c_f32_bf16 v193, v163, v179
    v_dot2c_f32_bf16 v194, v167, v179
    v_dot2c_f32_bf16 v195, v171, v179
    s_nop 2
    v_add_f32_dpp v192, v192, v192 quad_perm:[1,0,3,2] row_mask:0xf bank_mask:0xf
    v_add_f32_dpp v193, v193, v193 quad_perm:[1,0,3,2] row_mask:0xf bank_mask:0xf
    v_add_f32_dpp v194, v194, v194 quad_perm:[1,0,3,2] row_mask:0xf bank_mask:0xf
    v_add_f32_dpp v195, v195, v195 quad_perm:[1,0,3,2] row_mask:0xf bank_mask:0xf
    v_add_f32_dpp v192, v192, v192 quad_perm:[2,3,0,1] row_mask:0xf bank_mask:0xf
    v_add_f32_dpp v193, v193, v193 quad_perm:[2,3,0,1] row_mask:0xf bank_mask:0xf
    v_add_f32_dpp v194, v194, v194 quad_perm:[2,3,0,1] row_mask:0xf bank_mask:0xf
    v_add_f32_dpp v195, v195, v195 quad_perm:[2,3,0,1] row_mask:0xf bank_mask:0xf
    v_add_f32_dpp v192, v192, v192 row_half_mirror row_mask:0xf bank_mask:0xf
    v_add_f32_dpp v193, v193, v193 row_half_mirror row_mask:0xf bank_mask:0xf
    v_add_f32_dpp v194, v194, v194 row_half_mirror row_mask:0xf bank_mask:0xf
    v_add_f32_dpp v195, v195, v195 row_half_mirror row_mask:0xf bank_mask:0xf
    ds_write_b32 v180, v192 offset:1088
    ds_write_b32 v180, v193 offset:1120
    ds_write_b32 v180, v194 offset:1152
    ds_write_b32 v180, v195 offset:1184
    s_waitcnt lgkmcnt(0)
    s_barrier
    s_cmp_lg_u32 s30, 5
    s_cbranch_scc1 K_AUX_FFN0
    s_add_u32 s60, s10, 0x1000
    s_addc_u32 s61, s11, 0
    s_mov_b32 s62, 0x2000
    s_mov_b32 s63, 0x20000
    v_lshlrev_b32 v3, 4, v1
    v_add_u32 v4, 123968, v3
    ds_read_b128 v[196:199], v4
    s_waitcnt lgkmcnt(0)
    v_cvt_pk_bf16_f32 v196, v196, v196
    v_lshlrev_b32 v196, 16, v196
    v_mul_f32 v5, 0xbfb8aa3b, v196
    v_exp_f32 v5, v5
    s_nop 0
    v_add_f32 v5, 1.0, v5
    v_rcp_f32 v196, v5
    s_nop 0
    v_cvt_pk_bf16_f32 v196, v196, v196
    v_lshlrev_b32 v196, 16, v196
    v_cvt_pk_bf16_f32 v197, v197, v197
    v_lshlrev_b32 v197, 16, v197
    v_mul_f32 v5, 0xbfb8aa3b, v197
    v_exp_f32 v5, v5
    s_nop 0
    v_add_f32 v5, 1.0, v5
    v_rcp_f32 v197, v5
    s_nop 0
    v_cvt_pk_bf16_f32 v197, v197, v197
    v_lshlrev_b32 v197, 16, v197
    v_cvt_pk_bf16_f32 v198, v198, v198
    v_lshlrev_b32 v198, 16, v198
    v_mul_f32 v5, 0xbfb8aa3b, v198
    v_exp_f32 v5, v5
    s_nop 0
    v_add_f32 v5, 1.0, v5
    v_rcp_f32 v198, v5
    s_nop 0
    v_cvt_pk_bf16_f32 v198, v198, v198
    v_lshlrev_b32 v198, 16, v198
    v_cvt_pk_bf16_f32 v199, v199, v199
    v_lshlrev_b32 v199, 16, v199
    v_mul_f32 v5, 0xbfb8aa3b, v199
    v_exp_f32 v5, v5
    s_nop 0
    v_add_f32 v5, 1.0, v5
    v_rcp_f32 v199, v5
    s_nop 0
    v_cvt_pk_bf16_f32 v199, v199, v199
    v_lshlrev_b32 v199, 16, v199
    s_lshl_b32 s3, s28, 10
    buffer_store_dwordx4 v[196:199], v3, s[60:63], s3 offen sc1
    v_mov_b32 v4, 192
    s_mov_b32 s3, 131072
K_ZPOLL4:
    v_readfirstlane_b32 s33, v7
    s_nop 3
    s_sub_u32 s3, s3, 1
    s_cselect_b32 s33, 1, s33
    s_cmp_lg_u32 s33, 0
    s_cbranch_scc1 K_ZOK4
    global_load_dword v7, v4, s[8:9] sc1
    s_waitcnt vmcnt(0)
    s_branch K_ZPOLL4
K_ZOK4:
    s_add_u32 s64, s10, 0x80000
    s_addc_u32 s65, s11, 0
    s_mov_b32 s66, 0xa000
    s_mov_b32 s67, 0x20000
    s_lshl_b32 s3, s28, 2
    v_lshl_add_u32 v2, v1, 8, s3
    v_mov_b32 v3, 1
    s_waitcnt vmcnt(0)
    s_mov_b32 s3, 0
    buffer_store_dword v3, v2, s[64:67], s3 offen offset:192 sc1
    s_mov_b32 s3, 16384
    buffer_store_dword v3, v2, s[64:67], s3 offen offset:192 sc1
    s_mov_b32 s3, 32768
    buffer_store_dword v3, v2, s[64:67], s3 offen offset:192 sc1
K_AUX_FFN0:
    s_cmp_lg_u32 s44, 63
    s_cbranch_scc1 K_AUX_FFN1
    s_cmp_eq_u32 s29, 0
    s_cbranch_scc1 K_AUX_NB
    s_barrier
K_AUX_NB:
    s_cmp_lg_u32 s30, 6
    s_cbranch_scc1 K_P2
    v_mov_b32 v4, 192
    s_mov_b32 s3, 131072
K_ZPOLL6:
    v_readfirstlane_b32 s33, v7
    s_nop 3
    s_sub_u32 s3, s3, 1
    s_cselect_b32 s33, 1, s33
    s_cmp_lg_u32 s33, 0
    s_cbranch_scc1 K_ZOK6
    global_load_dword v7, v4, s[8:9] sc1
    s_waitcnt vmcnt(0)
    s_branch K_ZPOLL6
K_ZOK6:
    v_mov_b32 v7, 0
    s_branch K_P2
.p2align 12
K_AUX_FFN1:
    s_mov_b32 s60, s50
    s_mov_b32 s61, s51
    s_mov_b32 s62, 0x21c000
    s_mov_b32 s63, 0x20000
    s_mov_b32 s64, s52
    s_mov_b32 s65, s53
    s_mov_b32 s66, 0x21c000
    s_mov_b32 s67, 0x20000
    v_lshrrev_b32 v2, 2, v1
    v_mul_u32_u24 v200, 3456, v2
    v_and_b32 v2, 3, v1
    v_lshl_add_u32 v200, v2, 4, v200
    s_mul_i32 s3, s30, 276480
    s_lshl_b32 s72, s44, 6
    s_add_u32 s3, s3, s72
    v_add_u32 v200, s3, v200
    s_mul_i32 s73, s30, 5120
    s_mov_b32 s72, 0
    s_add_u32 m0, s73, 0
    s_nop 0
    buffer_load_dwordx4 v200, s[60:63], s72 offen  lds
    s_add_u32 m0, s73, 40960
    s_nop 0
    buffer_load_dwordx4 v200, s[64:67], s72 offen  lds
    s_mov_b32 s72, 55296
    s_add_u32 m0, s73, 1024
    s_nop 0
    buffer_load_dwordx4 v200, s[60:63], s72 offen  lds
    s_add_u32 m0, s73, 41984
    s_nop 0
    buffer_load_dwordx4 v200, s[64:67], s72 offen  lds
    s_mov_b32 s72, 110592
    s_add_u32 m0, s73, 2048
    s_nop 0
    buffer_load_dwordx4 v200, s[60:63], s72 offen  lds
    s_add_u32 m0, s73, 43008
    s_nop 0
    buffer_load_dwordx4 v200, s[64:67], s72 offen  lds
    s_mov_b32 s72, 165888
    s_add_u32 m0, s73, 3072
    s_nop 0
    buffer_load_dwordx4 v200, s[60:63], s72 offen  lds
    s_add_u32 m0, s73, 44032
    s_nop 0
    buffer_load_dwordx4 v200, s[64:67], s72 offen  lds
    s_mov_b32 s72, 221184
    s_add_u32 m0, s73, 4096
    s_nop 0
    buffer_load_dwordx4 v200, s[60:63], s72 offen  lds
    s_add_u32 m0, s73, 45056
    s_nop 0
    buffer_load_dwordx4 v200, s[64:67], s72 offen  lds
    s_add_u32 s64, s10, 0x10000
    s_addc_u32 s65, s11, 0
    s_mov_b32 s66, 0x43800
    s_mov_b32 s67, 0x20000
    s_cmp_ge_u32 s30, 4
    s_cbranch_scc1 K_FFN_C
    s_mul_i32 s3, s44, 5120
    s_mul_i32 s72, s30, 1280
    s_add_u32 s3, s3, s72
    v_lshlrev_b32 v2, 4, v1
    buffer_store_dwordx4 v[12:15], v2, s[64:67], s3 offen sc1
    s_mov_b64 exec, 0xffff
    buffer_store_dwordx4 v[12:15], v2, s[64:67], s3 offen offset:1024 sc1
    s_mov_b64 exec, -1
    s_sub_u32 s3, s29, 1
    s_mul_i32 s3, s3, 92
    s_mul_i32 s72, s30, 23
    s_add_u32 s3, s3, s72
    v_lshrrev_b32 v2, 1, v1
    v_add_u32 v2, s3, v2
    v_mul_u32_u24 v2, 1280, v2
    v_and_b32 v3, 1, v1
    v_lshl_add_u32 v2, v3, 7, v2
    s_mov_b32 exec_hi, 0x3fff
    buffer_load_dword v6, v2, s[24:27], 0 offen offset:1024
    s_mov_b32 exec_lo, 0x55555555
    s_mov_b32 exec_hi, 0x1555
    buffer_load_dword v6, v2, s[24:27], 0 offen
    s_mov_b64 exec, -1
    s_waitcnt vmcnt(4)
    s_barrier
    s_branch K_P2_EARLY
K_FFN_C:
    s_mov_b32 s68, s54
    s_mov_b32 s69, s55
    s_mov_b32 s70, 0x21c000
    s_mov_b32 s71, 0x20000
    s_sub_u32 s73, s30, 4
    s_mul_i32 s3, s44, 40960
    s_mul_i32 s73, s73, 10240
    s_add_u32 s3, s3, s73
    v_lshl_add_u32 v201, v1, 4, s3
    v_lshrrev_b32 v202, 4, v1
    v_bfe_u32 v2, v1, 2, 2
    v_lshl_add_u32 v2, v202, 3, v2
    v_and_b32 v3, 3, v1
    v_lshlrev_b32 v3, 3, v3
    v_lshl_add_u32 v203, v2, 6, v3
    s_bfe_u32 s3, s30, 0x10001
    s_mul_i32 s3, s3, 40960
    s_and_b32 s72, s30, 1
    s_lshl_b32 s72, s72, 5
    s_add_u32 s3, s3, s72
    s_add_u32 s3, s3, 0
    v_add_u32 v203, s3, v203
    v_mul_u32_u24 v204, 1280, v2
    s_and_b32 s3, s30, 3
    s_mul_i32 s3, s3, 320
    s_add_u32 s3, s3, 81920
    v_add3_u32 v204, v204, v3, s3
    v_mov_b32 v205, 123904
    v_mov_b32 v206, 158720
    s_mov_b32 s72, 0
    s_add_u32 m0, s73, 81920
    s_nop 0
    buffer_load_dwordx4 v201, s[68:71], s72 offen  lds
    s_mov_b32 s72, 1024
    s_add_u32 m0, s73, 82944
    s_nop 0
    buffer_load_dwordx4 v201, s[68:71], s72 offen  lds
    s_mov_b32 s72, 2048
    s_add_u32 m0, s73, 83968
    s_nop 0
    buffer_load_dwordx4 v201, s[68:71], s72 offen  lds
    s_mov_b32 s72, 3072
    s_add_u32 m0, s73, 84992
    s_nop 0
    buffer_load_dwordx4 v201, s[68:71], s72 offen  lds
    s_mov_b32 s72, 4096
    s_add_u32 m0, s73, 86016
    s_nop 0
    buffer_load_dwordx4 v201, s[68:71], s72 offen  lds
    s_mov_b32 s72, 5120
    s_add_u32 m0, s73, 87040
    s_nop 0
    buffer_load_dwordx4 v201, s[68:71], s72 offen  lds
    s_mov_b32 s72, 6144
    s_add_u32 m0, s73, 88064
    s_nop 0
    buffer_load_dwordx4 v201, s[68:71], s72 offen  lds
    s_mov_b32 s72, 7168
    s_add_u32 m0, s73, 89088
    s_nop 0
    buffer_load_dwordx4 v201, s[68:71], s72 offen  lds
    s_mov_b32 s72, 8192
    s_add_u32 m0, s73, 90112
    s_nop 0
    buffer_load_dwordx4 v201, s[68:71], s72 offen  lds
    s_mov_b32 s72, 9216
    s_add_u32 m0, s73, 91136
    s_nop 0
    buffer_load_dwordx4 v201, s[68:71], s72 offen  lds
    s_waitcnt vmcnt(10)
    s_barrier
    ds_read_b64_tr_b16 v[12:13], v203 offset:0
    ds_read_b64_tr_b16 v[14:15], v203 offset:256
    ds_read_b64_tr_b16 v[16:17], v203 offset:2048
    ds_read_b64_tr_b16 v[18:19], v203 offset:2304
    ds_read_b64_tr_b16 v[20:21], v203 offset:4096
    ds_read_b64_tr_b16 v[22:23], v203 offset:4352
    ds_read_b64_tr_b16 v[24:25], v203 offset:6144
    ds_read_b64_tr_b16 v[26:27], v203 offset:6400
    ds_read_b64_tr_b16 v[28:29], v203 offset:8192
    ds_read_b64_tr_b16 v[30:31], v203 offset:8448
    ds_read_b64_tr_b16 v[32:33], v203 offset:10240
    ds_read_b64_tr_b16 v[34:35], v203 offset:10496
    ds_read_b64_tr_b16 v[36:37], v203 offset:12288
    ds_read_b64_tr_b16 v[38:39], v203 offset:12544
    ds_read_b64_tr_b16 v[40:41], v203 offset:14336
    ds_read_b64_tr_b16 v[42:43], v203 offset:14592
    ds_read_b64_tr_b16 v[44:45], v203 offset:16384
    ds_read_b64_tr_b16 v[46:47], v203 offset:16640
    ds_read_b64_tr_b16 v[48:49], v203 offset:18432
    ds_read_b64_tr_b16 v[50:51], v203 offset:18688
    ds_read_b64_tr_b16 v[52:53], v203 offset:20480
    ds_read_b64_tr_b16 v[54:55], v203 offset:20736
    ds_read_b64_tr_b16 v[56:57], v203 offset:22528
    ds_read_b64_tr_b16 v[58:59], v203 offset:22784
    ds_read_b64_tr_b16 v[60:61], v203 offset:24576
    ds_read_b64_tr_b16 v[62:63], v203 offset:24832
    ds_read_b64_tr_b16 v[64:65], v203 offset:26624
    ds_read_b64_tr_b16 v[66:67], v203 offset:26880
    ds_read_b64_tr_b16 v[68:69], v203 offset:28672
    ds_read_b64_tr_b16 v[70:71], v203 offset:28928
    ds_read_b64_tr_b16 v[72:73], v203 offset:30720
    ds_read_b64_tr_b16 v[74:75], v203 offset:30976
    ds_read_b64_tr_b16 v[76:77], v203 offset:32768
    ds_read_b64_tr_b16 v[78:79], v203 offset:33024
    ds_read_b64_tr_b16 v[80:81], v203 offset:34816
    ds_read_b64_tr_b16 v[82:83], v203 offset:35072
    ds_read_b64_tr_b16 v[84:85], v203 offset:36864
    ds_read_b64_tr_b16 v[86:87], v203 offset:37120
    ds_read_b64_tr_b16 v[88:89], v203 offset:38912
    ds_read_b64_tr_b16 v[90:91], v203 offset:39168
    s_setprio 3
    s_waitcnt lgkmcnt(0)
    s_barrier
    s_cmp_lg_u32 s30, 7
    s_cbranch_scc1 K_AUX_POLLED
    v_mov_b32 v4, 192
    s_mov_b32 s3, 131072
K_ZPOLL5:
    v_readfirstlane_b32 s33, v7
    s_nop 3
    s_sub_u32 s3, s3, 1
    s_cselect_b32 s33, 1, s33
    s_cmp_lg_u32 s33, 0
    s_cbranch_scc1 K_ZOK5
    global_load_dword v7, v4, s[8:9] sc1
    s_waitcnt vmcnt(0)
    s_branch K_ZPOLL5
K_ZOK5:
    v_and_b32 v3, 15, v1
    v_lshl_add_u32 v3, v3, 2, s42
    s_mov_b32 s3, 131072
K_AUX_POLL:
    global_load_dword v2, v3, s[10:11] offset:128 sc1
    s_waitcnt vmcnt(0)
    v_cmp_eq_u32 vcc, 0, v2
    s_cbranch_vccz K_AUX_GOT
    s_sleep 6
    s_sub_u32 s3, s3, 1
    s_cmp_lg_u32 s3, 0
    s_cbranch_scc1 K_AUX_POLL
K_AUX_GOT:
    s_nop 1
    v_max_u32_dpp v3, v2, v2 quad_perm:[1,0,3,2] row_mask:0xf bank_mask:0xf
    s_nop 1
    v_max_u32_dpp v3, v3, v3 quad_perm:[2,3,0,1] row_mask:0xf bank_mask:0xf
    s_nop 1
    v_max_u32_dpp v3, v3, v3 row_half_mirror row_mask:0xf bank_mask:0xf
    s_nop 1
    v_max_u32_dpp v3, v3, v3 row_mirror row_mask:0xf bank_mask:0xf
    s_nop 1
    v_readlane_b32 s74, v3, 0
    v_readlane_b32 s76, v3, 16
    v_readlane_b32 s77, v3, 32
    v_readlane_b32 s78, v3, 48
    s_nop 3
    s_max_u32 s74, s74, s76
    s_max_u32 s77, s77, s78
    s_max_u32 s74, s74, s77
    v_cmp_ne_u32 vcc, s74, v2
    s_nop 1
    v_cndmask_b32 v2, 0, v2, vcc
    s_nop 1
    v_max_u32_dpp v3, v2, v2 quad_perm:[1,0,3,2] row_mask:0xf bank_mask:0xf
    s_nop 1
    v_max_u32_dpp v3, v3, v3 quad_perm:[2,3,0,1] row_mask:0xf bank_mask:0xf
    s_nop 1
    v_max_u32_dpp v3, v3, v3 row_half_mirror row_mask:0xf bank_mask:0xf
    s_nop 1
    v_max_u32_dpp v3, v3, v3 row_mirror row_mask:0xf bank_mask:0xf
    s_nop 1
    v_readlane_b32 s75, v3, 0
    v_readlane_b32 s76, v3, 16
    v_readlane_b32 s77, v3, 32
    v_readlane_b32 s78, v3, 48
    s_nop 3
    s_max_u32 s75, s75, s76
    s_max_u32 s77, s77, s78
    s_max_u32 s75, s75, s77
    v_mov_b32 v196, s74
    v_mov_b32 v197, s75
    v_mov_b32 v3, 1
    ds_write_b64 v205, v[196:197]
    ds_write_b32 v206, v3 offset:48
K_AUX_POLLED:
    s_mov_b32 s3, 1048576
K_FGK:
    ds_read_b32 v2, v206 offset:48
    s_sleep 1
    s_sub_u32 s3, s3, 1
    s_waitcnt lgkmcnt(0)
    v_readfirstlane_b32 s33, v2
    s_nop 3
    s_cselect_b32 s33, 1, s33
    s_cmp_lt_u32 s33, 1
    s_cbranch_scc1 K_FGK
    ds_read_b64 v[196:197], v205
    v_and_b32 v2, 1, v1
    v_cmp_eq_u32 vcc, 1, v2
    s_waitcnt lgkmcnt(0)
    v_cndmask_b32 v4, v196, v197, vcc
    v_and_b32 v3, 0x7ff, v4
    v_sub_u32 v3, 2047, v3
    v_mul_u32_u24 v9, 1280, v3
    v_lshl_add_u32 v9, v202, 4, v9
    s_mov_b32 exec_lo, 0x00030003
    s_mov_b32 exec_hi, 0x00030003
    buffer_load_dwordx4 v[92:95], v9, s[12:15], 0 offen offset:0
    buffer_load_dwordx4 v[96:99], v9, s[12:15], 0 offen offset:64
    buffer_load_dwordx4 v[100:103], v9, s[12:15], 0 offen offset:128
    buffer_load_dwordx4 v[104:107], v9, s[12:15], 0 offen offset:192
    buffer_load_dwordx4 v[108:111], v9, s[12:15], 0 offen offset:256
    buffer_load_dwordx4 v[112:115], v9, s[12:15], 0 offen offset:320
    buffer_load_dwordx4 v[116:119], v9, s[12:15], 0 offen offset:384
    buffer_load_dwordx4 v[120:123], v9, s[12:15], 0 offen offset:448
    buffer_load_dwordx4 v[124:127], v9, s[12:15], 0 offen offset:512
    buffer_load_dwordx4 v[128:131], v9, s[12:15], 0 offen offset:576
    buffer_load_dwordx4 v[132:135], v9, s[12:15], 0 offen offset:640
    buffer_load_dwordx4 v[136:139], v9, s[12:15], 0 offen offset:704
    buffer_load_dwordx4 v[140:143], v9, s[12:15], 0 offen offset:768
    buffer_load_dwordx4 v[144:147], v9, s[12:15], 0 offen offset:832
    buffer_load_dwordx4 v[148:151], v9, s[12:15], 0 offen offset:896
    buffer_load_dwordx4 v[152:155], v9, s[12:15], 0 offen offset:960
    buffer_load_dwordx4 v[156:159], v9, s[12:15], 0 offen offset:1024
    buffer_load_dwordx4 v[160:163], v9, s[12:15], 0 offen offset:1088
    buffer_load_dwordx4 v[164:167], v9, s[12:15], 0 offen offset:1152
    buffer_load_dwordx4 v[168:171], v9, s[12:15], 0 offen offset:1216
    s_mov_b64 exec, -1
    v_and_b32 v2, 1, v1
    v_lshlrev_b32 v216, 6, v2
    v_lshl_add_u32 v216, v202, 4, v216
    s_and_b32 s3, s30, 3
    s_lshl_b32 s3, s3, 7
    v_add3_u32 v217, v216, s3, v205
    v_add_u32 v216, 64, v217
    v_add_u32 v217, 1088, v217
    v_lshrrev_b32 v2, 5, v1
    v_bfe_u32 v3, v1, 4, 1
    v_lshl_add_u32 v3, v3, 1, v2
    v_lshlrev_b32 v3, 6, v3
    v_and_b32 v4, 15, v1
    v_lshl_add_u32 v3, v4, 2, v3
    v_add_u32 v218, 123968, v3
    v_lshlrev_b32 v4, 1, v1
    s_add_u32 s3, s3, 124992
    v_add_u32 v219, s3, v4
    v_and_b32 v2, 1, v1
    v_mul_u32_u24 v2, 2560, v2
    v_lshl_add_u32 v220, v202, 4, v2
    s_mul_i32 s3, s44, 5120
    s_and_b32 s72, s30, 3
    s_mul_i32 s72, s72, 640
    s_add_u32 s72, s72, s3
    v_mov_b32 v3, 1
    s_waitcnt vmcnt(16)
    v_mfma_f32_16x16x32_bf16 v[208:211], v[12:15], v[92:95], 0
    v_mfma_f32_16x16x32_bf16 v[212:215], v[16:19], v[96:99], 0
    v_mfma_f32_16x16x32_bf16 v[208:211], v[20:23], v[100:103], v[208:211]
    v_mfma_f32_16x16x32_bf16 v[212:215], v[24:27], v[104:107], v[212:215]
    s_waitcnt vmcnt(12)
    v_mfma_f32_16x16x32_bf16 v[208:211], v[28:31], v[108:111], v[208:211]
    v_mfma_f32_16x16x32_bf16 v[212:215], v[32:35], v[112:115], v[212:215]
    v_mfma_f32_16x16x32_bf16 v[208:211], v[36:39], v[116:119], v[208:211]
    v_mfma_f32_16x16x32_bf16 v[212:215], v[40:43], v[120:123], v[212:215]
    s_waitcnt vmcnt(8)
    v_mfma_f32_16x16x32_bf16 v[208:211], v[44:47], v[124:127], v[208:211]
    v_mfma_f32_16x16x32_bf16 v[212:215], v[48:51], v[128:131], v[212:215]
    v_mfma_f32_16x16x32_bf16 v[208:211], v[52:55], v[132:135], v[208:211]
    v_mfma_f32_16x16x32_bf16 v[212:215], v[56:59], v[136:139], v[212:215]
    s_waitcnt vmcnt(4)
    v_mfma_f32_16x16x32_bf16 v[208:211], v[60:63], v[140:143], v[208:211]
    v_mfma_f32_16x16x32_bf16 v[212:215], v[64:67], v[144:147], v[212:215]
    v_mfma_f32_16x16x32_bf16 v[208:211], v[68:71], v[148:151], v[208:211]
    v_mfma_f32_16x16x32_bf16 v[212:215], v[72:75], v[152:155], v[212:215]
    s_waitcnt vmcnt(0)
    v_mfma_f32_16x16x32_bf16 v[208:211], v[76:79], v[156:159], v[208:211]
    v_mfma_f32_16x16x32_bf16 v[212:215], v[80:83], v[160:163], v[212:215]
    v_mfma_f32_16x16x32_bf16 v[208:211], v[84:87], v[164:167], v[208:211]
    v_mfma_f32_16x16x32_bf16 v[212:215], v[88:91], v[168:171], v[212:215]
    s_nop 7
    v_add_f32 v208, v208, v212
    v_add_f32 v209, v209, v213
    v_add_f32 v210, v210, v214
    v_add_f32 v211, v211, v215
    s_mov_b32 exec_lo, 0x00030003
    s_mov_b32 exec_hi, 0x00030003
    ds_write_b128 v216, v[208:211]
    s_mov_b64 exec, 1
    ds_add_u32 v206, v3 offset:52
    s_mov_b64 exec, -1
    s_cmp_lg_u32 s30, 6
    s_cbranch_scc1 K_NOS6B
    v_min_u32 v4, 23, v1
    v_lshl_add_u32 v4, v4, 2, s42
    global_load_dword v7, v4, s[10:11] offset:128 sc1
K_NOS6B:
    s_mov_b32 s3, 1048576
K_FGP:
    ds_read_b32 v2, v206 offset:52
    s_sleep 1
    s_sub_u32 s3, s3, 1
    s_waitcnt lgkmcnt(0)
    v_readfirstlane_b32 s33, v2
    s_nop 3
    s_cselect_b32 s33, 4, s33
    s_cmp_lt_u32 s33, 4
    s_cbranch_scc1 K_FGP
    ds_read_b32 v224, v218
    ds_read_b32 v226, v218 offset:256
    ds_read_b64_tr_b16 v[12:13], v204 offset:0
    ds_read_b64_tr_b16 v[14:15], v204 offset:5120
    ds_read_b64_tr_b16 v[16:17], v204 offset:32
    ds_read_b64_tr_b16 v[18:19], v204 offset:5152
    ds_read_b64_tr_b16 v[20:21], v204 offset:64
    ds_read_b64_tr_b16 v[22:23], v204 offset:5184
    ds_read_b64_tr_b16 v[24:25], v204 offset:96
    ds_read_b64_tr_b16 v[26:27], v204 offset:5216
    ds_read_b64_tr_b16 v[28:29], v204 offset:128
    ds_read_b64_tr_b16 v[30:31], v204 offset:5248
    ds_read_b64_tr_b16 v[32:33], v204 offset:160
    ds_read_b64_tr_b16 v[34:35], v204 offset:5280
    ds_read_b64_tr_b16 v[36:37], v204 offset:192
    ds_read_b64_tr_b16 v[38:39], v204 offset:5312
    s_waitcnt lgkmcnt(14)
    v_cvt_pk_bf16_f32 v224, v224, v224
    v_lshlrev_b32 v224, 16, v224
    v_cvt_pk_bf16_f32 v226, v226, v226
    v_lshlrev_b32 v226, 16, v226
    v_mul_f32 v225, 0xbfb8aa3b, v224
    v_exp_f32 v225, v225
    s_nop 0
    v_add_f32 v225, 1.0, v225
    v_rcp_f32 v225, v225
    s_nop 0
    v_mul_f32 v224, v224, v225
    v_cvt_pk_bf16_f32 v224, v224, v224
    v_lshlrev_b32 v224, 16, v224
    v_mul_f32 v224, v224, v226
    v_cvt_pk_bf16_f32 v224, v224, v224
    ds_write_b16 v219, v224
    s_waitcnt lgkmcnt(0)
    ds_read_b128 v[224:227], v217
    ds_read_b64_tr_b16 v[40:41], v204 offset:224
    ds_read_b64_tr_b16 v[42:43], v204 offset:5344
    ds_read_b64_tr_b16 v[44:45], v204 offset:256
    ds_read_b64_tr_b16 v[46:47], v204 offset:5376
    ds_read_b64_tr_b16 v[48:49], v204 offset:288
    ds_read_b64_tr_b16 v[50:51], v204 offset:5408
    s_waitcnt lgkmcnt(6)
    v_mfma_f32_16x16x32_bf16 v[92:95], v[12:15], v[224:227], 0
    v_mfma_f32_16x16x32_bf16 v[96:99], v[16:19], v[224:227], 0
    v_mfma_f32_16x16x32_bf16 v[100:103], v[20:23], v[224:227], 0
    v_mfma_f32_16x16x32_bf16 v[104:107], v[24:27], v[224:227], 0
    v_mfma_f32_16x16x32_bf16 v[108:111], v[28:31], v[224:227], 0
    v_mfma_f32_16x16x32_bf16 v[112:115], v[32:35], v[224:227], 0
    v_mfma_f32_16x16x32_bf16 v[116:119], v[36:39], v[224:227], 0
    s_waitcnt lgkmcnt(4)
    v_mfma_f32_16x16x32_bf16 v[120:123], v[40:43], v[224:227], 0
    s_waitcnt lgkmcnt(2)
    v_mfma_f32_16x16x32_bf16 v[124:127], v[44:47], v[224:227], 0
    s_waitcnt lgkmcnt(0)
    v_mfma_f32_16x16x32_bf16 v[128:131], v[48:51], v[224:227], 0
    s_mov_b32 exec_lo, 0x00030003
    s_mov_b32 exec_hi, 0x00030003
    buffer_store_dwordx4 v[92:95], v220, s[64:67], s72 offen offset:0 sc1
    buffer_store_dwordx4 v[96:99], v220, s[64:67], s72 offen offset:64 sc1
    buffer_store_dwordx4 v[100:103], v220, s[64:67], s72 offen offset:128 sc1
    buffer_store_dwordx4 v[104:107], v220, s[64:67], s72 offen offset:192 sc1
    buffer_store_dwordx4 v[108:111], v220, s[64:67], s72 offen offset:256 sc1
    buffer_store_dwordx4 v[112:115], v220, s[64:67], s72 offen offset:320 sc1
    buffer_store_dwordx4 v[116:119], v220, s[64:67], s72 offen offset:384 sc1
    buffer_store_dwordx4 v[120:123], v220, s[64:67], s72 offen offset:448 sc1
    buffer_store_dwordx4 v[124:127], v220, s[64:67], s72 offen offset:512 sc1
    buffer_store_dwordx4 v[128:131], v220, s[64:67], s72 offen offset:576 sc1
    s_mov_b64 exec, -1
    s_lshl_b32 s3, s44, 3
    s_add_u32 s3, s3, s30
    s_lshl_b32 s3, s3, 2
    s_add_u32 s3, s3, 565232
    v_mov_b32 v2, s3
    v_mov_b32 v3, 1
    s_waitcnt vmcnt(0)
    s_mov_b64 exec, 1
    global_store_dword v2, v3, s[10:11] sc1
    s_mov_b64 exec, -1
    s_branch K_P2
K_CODE_END:
.section .rodata,"a"
.p2align 6
.amdhsa_kernel gated_mix__sliding_local_dilated__moe_arch_mod__prompt_kernel
  .amdhsa_next_free_vgpr 248
  .amdhsa_next_free_sgpr 79
  .amdhsa_accum_offset 248
  .amdhsa_group_segment_fixed_size 0
  .amdhsa_kernarg_size 96
  .amdhsa_user_sgpr_count 2
  .amdhsa_user_sgpr_kernarg_segment_ptr 1
  .amdhsa_system_sgpr_workgroup_id_x 1
.end_amdhsa_kernel
```

```asm
; @launch grid=(256,1,1) block=(512,1,1) lds=163840
.amdgcn_target "amdgcn-amd-amdhsa--gfx950"
.text
.p2align 12
.p2align 8
.globl gated_mix__sliding_local_dilated__moe_arch_mod__prompt_kernel
.type gated_mix__sliding_local_dilated__moe_arch_mod__prompt_kernel,@function
gated_mix__sliding_local_dilated__moe_arch_mod__prompt_kernel:
    s_cmp_ge_u32 s2, 256
    s_cbranch_scc1 K_EXIT
    s_load_dwordx2 s[12:13], s[0:1], 0
    s_load_dwordx2 s[16:17], s[0:1], 8
    v_readfirstlane_b32 s30, v0
    s_load_dwordx4 s[8:11], s[0:1], 80
    s_load_dwordx2 s[24:25], s[0:1], 16
    s_load_dwordx2 s[6:7], s[0:1], 72
    s_and_b32 s28, s2, 7
    v_and_b32 v1, 63, v0
    s_mov_b32 s14, 0x280000
    s_mov_b32 s15, 0x20000
    s_lshr_b32 s30, s30, 6
    s_cmp_lt_u32 s2, 64
    s_cbranch_scc1 K_SLOW
    s_cmp_lt_u32 s30, 4
    s_cbranch_scc1 K_FAST
K_SLOW:
    s_getpc_b64 s[38:39]
K_PC:
    s_bfe_u32 s3, s2, 0x30003
    s_mul_i32 s3, s3, ((K_CODE_END-gated_mix__sliding_local_dilated__moe_arch_mod__prompt_kernel+1023)/1024)
    s_sub_u32 s38, s38, K_PC-gated_mix__sliding_local_dilated__moe_arch_mod__prompt_kernel
    s_subb_u32 s39, s39, 0
    v_subrev_u32 v3, 256, v0
    v_add_u32 v2, s3, v3
    v_lshlrev_b32 v2, 7, v2
    v_min_u32 v2, K_CODE_END-gated_mix__sliding_local_dilated__moe_arch_mod__prompt_kernel-4, v2
    v_cmp_gt_u32 vcc, ((K_CODE_END-gated_mix__sliding_local_dilated__moe_arch_mod__prompt_kernel+1023)/1024), v3
    s_and_saveexec_b64 s[4:5], vcc
    s_cbranch_execz K_NOPF
    global_load_dword v6, v2, s[38:39]
K_NOPF:
    s_mov_b64 exec, -1
    v_mov_b32 v2, 0
    v_mov_b32 v3, 158752
    ds_write2_b32 v3, v2, v2 offset0:0 offset1:1
    ds_write2_b32 v3, v2, v2 offset0:2 offset1:3
    ds_write2_b32 v3, v2, v2 offset0:4 offset1:5
    ds_write2_b32 v3, v2, v2 offset0:6 offset1:7
    s_mov_b32 s43, 1
    s_lshl_b32 s3, s30, 8
    s_add_u32 s3, s3, s2
    s_lshr_b32 s3, s3, 3
    s_cmp_lg_u32 s3, 160
    s_cbranch_scc1 K_COMMON
    s_mul_i32 s3, s2, 6144
    s_add_u32 s3, s3, 527360
    v_lshl_add_u32 v6, v1, 4, s3
    v_mov_b64 v[28:29], 0
    v_mov_b64 v[30:31], 0
    s_waitcnt lgkmcnt(0)
    global_store_dwordx4 v6, v[28:31], s[10:11] offset:-3072 sc1
    global_store_dwordx4 v6, v[28:31], s[10:11] offset:-2048 sc1
    global_store_dwordx4 v6, v[28:31], s[10:11] offset:-1024 sc1
    global_store_dwordx4 v6, v[28:31], s[10:11] offset:0 sc1
    global_store_dwordx4 v6, v[28:31], s[10:11] offset:1024 sc1
    global_store_dwordx4 v6, v[28:31], s[10:11] offset:2048 sc1
    s_lshl_b32 s3, s2, 2
    v_mov_b32 v2, s3
    v_mov_b32 v3, 1
    s_mov_b64 exec, 1
    s_waitcnt vmcnt(0)
    global_store_dword v2, v3, s[8:9] offset:192 sc1
    s_mov_b64 exec, -1
    s_branch K_COMMON
K_FAST:
    s_lshr_b32 s32, s2, 1
    s_and_b32 s32, s32, 28
    v_lshrrev_b32 v3, 4, v1
    s_lshr_b32 s59, 0x82931560, s32
    s_and_b32 s59, s59, 15
    v_and_b32 v4, 7, v1
    s_lshr_b32 s3, s2, 6
    s_lshl2_add_u32 s59, s3, s59
    v_lshrrev_b32 v2, 3, v1
    s_add_u32 s59, s59, s28
    s_mul_i32 s33, s59, 205
    v_xor_b32 v4, v4, v3
    s_lshr_b32 s33, s33, 11
    s_mul_i32 s33, s33, 10
    v_mul_u32_u24 v2, 1280, v2
    s_sub_u32 s59, s59, s33
    s_lshr_b32 s53, s28, 1
    v_lshl_add_u32 v44, v4, 4, v2
    s_mul_i32 s53, s53, 675840
    s_mul_i32 s3, s3, 225280
    v_xor_b32 v45, 64, v44
    s_add_u32 s53, s53, s3
    s_mul_i32 s54, s30, 61440
    s_add_u32 s53, s53, s54
    s_sub_u32 s53, s53, 245760
    s_mul_i32 s55, s30, 6144
    s_add_u32 s55, s55, 40960
    s_lshl_b32 s57, s59, 7
    s_add_u32 s57, s57, s53
    s_waitcnt lgkmcnt(0)
    s_add_u32 m0, s55, 0
    s_max_i32 s60, s57, 0
    buffer_load_dwordx4 v44, s[12:15], s60 offen lds
    s_add_u32 s60, s57, 10240
    s_add_u32 m0, s55, 1024
    s_max_i32 s60, s60, 0
    buffer_load_dwordx4 v45, s[12:15], s60 offen lds
    s_add_u32 m0, s55, 2048
    s_add_u32 s60, s57, 20480
    buffer_load_dwordx4 v44, s[12:15], s60 offen lds
    s_add_u32 m0, s55, 3072
    s_add_u32 s60, s57, 30720
    buffer_load_dwordx4 v45, s[12:15], s60 offen lds
    s_add_u32 m0, s55, 4096
    s_add_u32 s60, s57, 40960
    buffer_load_dwordx4 v44, s[12:15], s60 offen lds
    s_add_u32 m0, s55, 5120
    s_add_u32 s60, s57, 51200
    buffer_load_dwordx4 v45, s[12:15], s60 offen lds
    v_lshlrev_b32 v2, 1, v3
    s_lshr_b32 s32, 0x64317520, s32
    v_sub_u32 v2, v1, v2
    s_and_b32 s32, s32, 7
    v_and_b32 v2, 15, v2
    s_and_b32 s3, s28, 1
    v_mul_u32_u24 v3, 3840, v3
    s_lshl3_add_u32 s32, s3, s32
    v_mul_u32_u24 v4, 13, v2
    s_mul_i32 s3, s32, 80
    v_lshrrev_b32 v4, 6, v4
    s_add_u32 s54, s54, s3
    v_mul_u32_u24 v4, 1200, v4
    s_lshl_b32 s56, s30, 12
    v_lshl_add_u32 v4, v2, 4, v4
    s_add_u32 s56, s56, 65536
    v_add_u32 v5, 1, v2
    s_mov_b32 s18, 0x258000
    v_and_b32 v5, 16, v5
    s_mov_b32 s19, 0x20000
    v_lshl_add_u32 v4, v5, 24, v4
    v_add_u32 v46, v3, v4
    s_mul_i32 s58, s59, 245760
    s_add_u32 s58, s58, s54
    s_add_u32 s59, s59, 1
    s_cmp_eq_u32 s59, 10
    s_cselect_b32 s59, 0, s59
    s_add_u32 m0, s56, 0
    s_add_u32 s60, s58, 0
    buffer_load_dwordx4 v46, s[16:19], s60 offen lds
    s_add_u32 m0, s56, 1024
    s_add_u32 s60, s58, 15360
    buffer_load_dwordx4 v46, s[16:19], s60 offen lds
    v_xor_b32 v2, 8, v2
    v_mul_u32_u24 v4, 13, v2
    v_lshrrev_b32 v4, 6, v4
    v_mul_u32_u24 v4, 1200, v4
    v_lshl_add_u32 v4, v2, 4, v4
    v_add_u32 v5, 1, v2
    v_and_b32 v5, 16, v5
    v_lshl_add_u32 v4, v5, 24, v4
    v_add_u32 v47, v3, v4
    s_add_u32 m0, s56, 2048
    s_add_u32 s60, s58, 30720
    buffer_load_dwordx4 v47, s[16:19], s60 offen lds
    s_add_u32 m0, s56, 3072
    s_add_u32 s60, s58, 46080
    buffer_load_dwordx4 v47, s[16:19], s60 offen lds
    s_mov_b32 s3, 40960
    s_cmp_ge_u32 s55, 81920
    s_cselect_b32 s60, -81920, s3
    s_add_u32 s55, s55, s60
    s_add_u32 s56, s56, s60
    s_lshl_b32 s57, s59, 7
    s_add_u32 s57, s57, s53
    s_mul_i32 s58, s59, 245760
    s_add_u32 s58, s58, s54
    s_add_u32 s59, s59, 1
    s_cmp_eq_u32 s59, 10
    s_cselect_b32 s59, 0, s59
    s_add_u32 m0, s56, 0
    s_add_u32 s60, s58, 0
    buffer_load_dwordx4 v46, s[16:19], s60 offen lds
    s_add_u32 m0, s55, 0
    s_max_i32 s60, s57, 0
    buffer_load_dwordx4 v44, s[12:15], s60 offen lds
    s_add_u32 m0, s56, 1024
    s_add_u32 s60, s58, 15360
    buffer_load_dwordx4 v46, s[16:19], s60 offen lds
    s_add_u32 s60, s57, 10240
    s_add_u32 m0, s55, 1024
    s_max_i32 s60, s60, 0
    buffer_load_dwordx4 v45, s[12:15], s60 offen lds
    s_add_u32 m0, s55, 2048
    s_add_u32 s60, s57, 20480
    buffer_load_dwordx4 v44, s[12:15], s60 offen lds
    s_mov_b32 s52, s30
    s_mov_b32 s43, 0
K_COMMON:
    v_mov_b32 v7, 0
    s_lshr_b32 s29, s2, 3
    s_xor_b32 s30, s30, 4
    s_mov_b32 s26, 0xc8000
    s_mov_b32 s27, 0x20000
    s_lshr_b32 s34, s29, 3
    s_lshl_b32 s34, s34, 2
    s_and_b32 s3, s29, 3
    s_add_u32 s34, s34, s3
    s_add_u32 s34, s34, 4
    s_bitcmp1_b32 s29, 2
    s_cselect_b32 s34, -1, s34
    s_cmp_lt_u32 s29, 8
    s_cselect_b32 s34, s29, s34
    s_lshl_b32 s40, s28, 1
    s_cmp_ge_u32 s34, 10
    s_addc_u32 s40, s40, 0
    s_sub_u32 s41, s34, 10
    s_cmp_ge_u32 s34, 10
    s_cselect_b32 s41, s41, s34
    s_mul_i32 s42, s28, 20
    s_add_u32 s42, s42, s34
    s_and_b32 s42, s42, 255
    s_lshl_b32 s42, s42, 8
    s_add_u32 s42, s42, 524288
    s_cmp_lt_u32 s29, 8
    s_cbranch_scc1 K_AUX
    s_lshr_b32 s31, s28, 1
    s_mul_i32 s31, s31, 3
    s_lshr_b32 s3, s29, 3
    s_add_u32 s31, s31, s3
    s_sub_u32 s31, s31, 1
    s_and_b32 s35, s29, 3
    s_and_b32 s3, s29, 4
    s_lshl_b32 s3, s3, 1
    s_add_u32 s35, s35, s3
    s_and_b32 s3, s28, 1
    s_lshl_b32 s3, s3, 2
    s_add_u32 s35, s35, s3
    v_and_b32 v8, 15, v1
    v_lshrrev_b32 v9, 4, v1
    v_bfe_u32 v10, v1, 2, 2
    v_and_b32 v11, 3, v1
    s_waitcnt lgkmcnt(0)
    s_add_u32 s20, s10, 0x100000
    s_addc_u32 s21, s11, 0
    s_mov_b32 s22, 0x280000
    s_mov_b32 s23, 0x20000
    s_and_b32 s3, s30, 3
    s_mul_i32 s3, s3, 3
    s_lshr_b32 s33, s30, 2
    s_lshl1_add_u32 s3, s33, s3
    s_mul_i32 s44, s31, 11
    s_add_u32 s44, s44, s3
    s_mul_i32 s3, s3, 4352
    s_add_u32 s3, s3, 81920
    v_mul_u32_u24 v13, 272, v8
    v_lshl_add_u32 v12, v9, 3, v13
    v_add_u32 v12, s3, v12
    v_add3_u32 v13, v13, 32, s3
    v_cmp_eq_u32 vcc, 0, v9
    v_add_u32 v2, 208, v13
    v_add_u32 v3, 0, v13
    v_add_u32 v4, 40, v13
    v_cndmask_b32 v19, v2, v3, vcc
    v_cndmask_b32 v20, v2, v4, vcc
    v_lshl_add_u32 v14, v9, 2, v10
    v_mul_u32_u24 v14, 272, v14
    v_add_u32 v5, s3, v14
    v_lshl_add_u32 v14, v11, 3, v5
    v_add_u32 v2, 240, v5
    v_add_u32 v3, 192, v5
    v_add_u32 v4, 232, v5
    v_cmp_eq_u32 vcc, 0, v11
    s_nop 1
    v_cndmask_b32 v21, v2, v3, vcc
    v_cmp_eq_u32 vcc, 1, v11
    s_nop 1
    v_cndmask_b32 v22, v2, v4, vcc
    v_cmp_eq_u32 vcc, 2, v11
    s_nop 1
    v_cndmask_b32 v23, v2, v3, vcc
    v_cmp_eq_u32 vcc, 3, v11
    s_nop 1
    v_cndmask_b32 v24, v2, v4, vcc
    s_lshl_b32 s3, s35, 10
    v_lshl_add_u32 v15, v1, 4, s3
    s_lshl_b32 s3, s35, 8
    s_add_u32 s3, s3, 16384
    v_lshl_add_u32 v16, v8, 4, s3
    v_and_b32 v2, 1, v9
    v_lshl_add_u32 v16, v2, 3, v16
    s_cmp_lt_u32 s30, 4
    s_cselect_b32 s3, 0, 0x800000
    s_add_u32 s3, s3, 20480
    v_lshrrev_b32 v2, 1, v9
    v_mad_u32_u24 v16, v2, s3, v16
    s_mul_i32 s50, s44, 20480
    s_add_u32 s51, s50, 20480
    v_mov_b32 v17, 0xf149f2ca
    v_lshlrev_b32 v2, 2, v9
    v_sub_u32 v2, v8, v2
    s_cmp_eq_u32 s44, 0
    s_cselect_b32 s3, 0xf149f2ca, 0
    v_subrev_u32 v3, 0, v2
    v_and_b32 v4, 0x80000001, v3
    v_cmp_eq_u32 vcc, 0, v4
    s_nop 1
    v_cndmask_b32 v32, v17, 0, vcc
    v_cmp_eq_u32 vcc, 0x80000000, v4
    s_nop 1
    v_cndmask_b32 v28, v17, 0, vcc
    v_add_f32 v36, s3, v28
    v_subrev_u32 v3, 1, v2
    v_and_b32 v4, 0x80000001, v3
    v_cmp_eq_u32 vcc, 0, v4
    s_nop 1
    v_cndmask_b32 v33, v17, 0, vcc
    v_cmp_eq_u32 vcc, 0x80000000, v4
    s_nop 1
    v_cndmask_b32 v29, v17, 0, vcc
    v_add_f32 v37, s3, v29
    v_subrev_u32 v3, 2, v2
    v_and_b32 v4, 0x80000001, v3
    v_cmp_eq_u32 vcc, 0, v4
    s_nop 1
    v_cndmask_b32 v34, v17, 0, vcc
    v_cmp_eq_u32 vcc, 0x80000000, v4
    s_nop 1
    v_cndmask_b32 v30, v17, 0, vcc
    v_add_f32 v38, s3, v30
    v_subrev_u32 v3, 3, v2
    v_and_b32 v4, 0x80000001, v3
    v_cmp_eq_u32 vcc, 0, v4
    s_nop 1
    v_cndmask_b32 v35, v17, 0, vcc
    v_cmp_eq_u32 vcc, 0x80000000, v4
    s_nop 1
    v_cndmask_b32 v31, v17, 0, vcc
    v_add_f32 v39, s3, v31
    v_mov_b32 v3, 0x0c0c0c0c
    v_mov_b32 v4, 0xc0c0100
    v_cmp_eq_u32 vcc, 0, v28
    v_mov_b32 v5, 0x1000c0c
    s_nop 0
    v_cndmask_b32 v3, v3, v4, vcc
    v_cmp_eq_u32 vcc, 0, v29
    s_nop 1
    v_cndmask_b32 v40, v3, v5, vcc
    v_mov_b32 v3, 0x0c0c0c0c
    v_mov_b32 v4, 0xc0c0302
    v_cmp_eq_u32 vcc, 0, v30
    v_mov_b32 v5, 0x3020c0c
    s_nop 0
    v_cndmask_b32 v3, v3, v4, vcc
    v_cmp_eq_u32 vcc, 0, v31
    s_nop 1
    v_cndmask_b32 v41, v3, v5, vcc
    v_mov_b32 v3, 0x0c0c0c0c
    v_mov_b32 v4, 0xc0c0100
    v_cmp_eq_u32 vcc, 0, v32
    v_mov_b32 v5, 0x1000c0c
    s_nop 0
    v_cndmask_b32 v3, v3, v4, vcc
    v_cmp_eq_u32 vcc, 0, v33
    s_nop 1
    v_cndmask_b32 v42, v3, v5, vcc
    v_mov_b32 v3, 0x0c0c0c0c
    v_mov_b32 v4, 0xc0c0302
    v_cmp_eq_u32 vcc, 0, v34
    v_mov_b32 v5, 0x3020c0c
    s_nop 0
    v_cndmask_b32 v3, v3, v4, vcc
    v_cmp_eq_u32 vcc, 0, v35
    s_nop 1
    v_cndmask_b32 v43, v3, v5, vcc
    s_mov_b32 s46, 0x3fb8aa3b
    s_mov_b32 s47, s46
    s_mov_b32 s48, 0x3e64f92e
    s_mov_b32 s49, s48
    s_cmp_eq_u32 s43, 1
    s_cbranch_scc1 K_CONS
    s_mul_i32 s3, s31, 11
    s_add_u32 s33, s3, 10
    s_lshr_b32 s3, s3, 3
    s_lshr_b32 s33, s33, 3
    s_min_u32 s33, s33, 15
    s_sub_u32 s33, s33, s3
    s_add_u32 s33, s33, 1
    s_mul_i32 s33, s33, 10
    s_bfm_b32 s36, s33, 0
    v_mul_u32_u24 v2, 205, v1
    v_lshrrev_b32 v2, 11, v2
    v_add_u32 v2, s3, v2
    v_mul_u32_u24 v2, 1496, v2
    v_lshrrev_b32 v2, 11, v2
    v_sub_u32 v2, s31, v2
    v_and_b32 v2, 1, v2
    v_lshlrev_b32 v2, 6, v2
    v_lshl_add_u32 v2, v1, 8, v2
    s_mul_i32 s3, s3, 2560
    s_lshl_b32 s33, s35, 2
    s_add_u32 s3, s3, s33
    s_add_u32 s3, s3, 524288
    v_add_u32 v18, s3, v2
    v_lshrrev_b32 v2, 3, v1
    v_mul_u32_u24 v2, 1280, v2
    v_lshrrev_b32 v3, 4, v1
    v_lshlrev_b32 v3, 1, v3
    v_and_b32 v4, 7, v1
    v_xor_b32 v3, v3, v4
    v_lshl_add_u32 v2, v3, 4, v2
    s_lshl_b32 s33, s41, 7
    v_add_u32 v17, s33, v2
    s_mov_b32 s61, 9
    s_mov_b32 s3, 40960
K_LOOP:
    s_waitcnt vmcnt(5)
    s_barrier
    s_add_u32 m0, s56, 2048
    s_add_u32 s60, s58, 30720
    buffer_load_dwordx4 v47, s[16:19], s60 offen lds
    s_add_u32 m0, s55, 3072
    s_add_u32 s60, s57, 30720
    buffer_load_dwordx4 v45, s[12:15], s60 offen lds
    s_add_u32 m0, s56, 3072
    s_add_u32 s60, s58, 46080
    buffer_load_dwordx4 v47, s[16:19], s60 offen lds
    s_add_u32 m0, s55, 4096
    s_add_u32 s60, s57, 40960
    buffer_load_dwordx4 v44, s[12:15], s60 offen lds
    s_add_u32 m0, s55, 5120
    s_add_u32 s60, s57, 51200
    buffer_load_dwordx4 v45, s[12:15], s60 offen lds
    s_sub_u32 s61, s61, 1
    s_cmp_eq_u32 s61, 0
    s_cbranch_scc1 K_LOOPX
    s_cmp_ge_u32 s55, 81920
    s_cselect_b32 s60, -81920, s3
    s_add_u32 s55, s55, s60
    s_add_u32 s56, s56, s60
    s_lshl_b32 s57, s59, 7
    s_add_u32 s57, s57, s53
    s_mul_i32 s58, s59, 245760
    s_add_u32 s58, s58, s54
    s_add_u32 s59, s59, 1
    s_cmp_eq_u32 s59, 10
    s_cselect_b32 s59, 0, s59
    s_add_u32 m0, s56, 0
    s_add_u32 s60, s58, 0
    buffer_load_dwordx4 v46, s[16:19], s60 offen lds
    s_add_u32 m0, s55, 0
    s_max_i32 s60, s57, 0
    buffer_load_dwordx4 v44, s[12:15], s60 offen lds
    s_add_u32 m0, s56, 1024
    s_add_u32 s60, s58, 15360
    buffer_load_dwordx4 v46, s[16:19], s60 offen lds
    s_add_u32 s60, s57, 10240
    s_add_u32 m0, s55, 1024
    s_max_i32 s60, s60, 0
    buffer_load_dwordx4 v45, s[12:15], s60 offen lds
    s_add_u32 m0, s55, 2048
    s_add_u32 s60, s57, 20480
    buffer_load_dwordx4 v44, s[12:15], s60 offen lds
    s_branch K_LOOP
K_LOOPX:
    v_and_b32 v2, 7, v1
    v_lshlrev_b32 v2, 2, v2
    s_waitcnt vmcnt(0)
    s_barrier
    s_cmp_lt_u32 s30, 6
    s_cbranch_scc1 K_NOSMP
    global_load_dword v7, v2, s[8:9] offset:192 sc1
K_NOSMP:
    s_cmp_eq_u32 s34, -1
    s_cbranch_scc1 K_JOIN_S
    s_lshl_b32 s57, s52, 2
    s_lshr_b32 s57, 0x7520, s57
    s_and_b32 s57, s57, 7
    s_mul_i32 s57, s57, 51200
    s_mul_i32 s58, s52, 5120
    s_add_u32 s3, s57, 0
    s_add_u32 m0, s58, 0
    s_nop 0
    buffer_load_dwordx4 v17, s[24:27], s3 offen lds
    s_add_u32 s3, s57, 10240
    s_add_u32 m0, s58, 1024
    s_nop 0
    buffer_load_dwordx4 v17, s[24:27], s3 offen lds
    s_add_u32 s3, s57, 20480
    s_add_u32 m0, s58, 2048
    s_nop 0
    buffer_load_dwordx4 v17, s[24:27], s3 offen lds
    s_add_u32 s3, s57, 30720
    s_add_u32 m0, s58, 3072
    s_nop 0
    buffer_load_dwordx4 v17, s[24:27], s3 offen lds
    s_add_u32 s3, s57, 40960
    s_add_u32 m0, s58, 4096
    s_nop 0
    buffer_load_dwordx4 v17, s[24:27], s3 offen lds
    s_add_u32 s3, s57, 409600
    s_add_u32 m0, s58, 20480
    s_nop 0
    buffer_load_dwordx4 v17, s[24:27], s3 offen lds
    s_add_u32 s3, s57, 419840
    s_add_u32 m0, s58, 21504
    s_nop 0
    buffer_load_dwordx4 v17, s[24:27], s3 offen lds
    s_add_u32 s3, s57, 430080
    s_add_u32 m0, s58, 22528
    s_nop 0
    buffer_load_dwordx4 v17, s[24:27], s3 offen lds
    s_add_u32 s3, s57, 440320
    s_add_u32 m0, s58, 23552
    s_nop 0
    buffer_load_dwordx4 v17, s[24:27], s3 offen lds
    s_add_u32 s3, s57, 450560
    s_add_u32 m0, s58, 24576
    s_nop 0
    buffer_load_dwordx4 v17, s[24:27], s3 offen lds
    s_branch K_JOIN_S
.p2align 12
K_CONS:
    s_lshr_b32 s52, s30, 1
    s_and_b32 s53, s30, 1
    v_lshrrev_b32 v2, 1, v8
    v_xor_b32 v2, v2, v9
    v_lshlrev_b32 v2, 4, v2
    v_lshl_add_u32 v2, v8, 7, v2
    s_mul_i32 s3, s52, 12288
    v_add_u32 v44, s3, v2
    v_xor_b32 v45, 64, v44
    v_add_u32 v46, 81920, v44
    v_add_u32 v47, 81920, v45
    v_and_b32 v2, 1, v9
    v_lshl_or_b32 v2, v2, 2, v10
    v_lshl_add_u32 v3, v9, 3, v10
    v_lshlrev_b32 v3, 8, v3
    v_lshl_add_u32 v3, v11, 3, v3
    v_add_u32 v3, 24576, v3
    s_lshl_b32 s3, s53, 2
    v_add_u32 v2, s3, v2
    v_add_u32 v4, 0, v2
    v_and_b32 v4, 7, v4
    v_lshl_add_u32 v48, v4, 5, v3
    v_add_u32 v52, 81920, v48
    v_add_u32 v4, 1, v2
    v_and_b32 v4, 7, v4
    v_lshl_add_u32 v49, v4, 5, v3
    v_add_u32 v53, 81920, v49
    v_add_u32 v4, 2, v2
    v_and_b32 v4, 7, v4
    v_lshl_add_u32 v50, v4, 5, v3
    v_add_u32 v54, 81920, v50
    v_add_u32 v4, 3, v2
    v_and_b32 v4, 7, v4
    v_lshl_add_u32 v51, v4, 5, v3
    v_add_u32 v55, 81920, v51
    v_mul_u32_u24 v56, 272, v8
    v_lshl_add_u32 v56, v9, 3, v56
    s_mul_i32 s3, s52, 26112
    s_lshl_b32 s33, s53, 7
    s_add_u32 s3, s3, s33
    s_add_u32 s3, s3, 81920
    v_add_u32 v56, s3, v56
    v_mov_b64 v[60:61], 0
    v_mov_b64 v[62:63], 0
    v_mov_b64 v[64:65], 0
    v_mov_b64 v[66:67], 0
    v_mov_b64 v[68:69], 0
    v_mov_b64 v[70:71], 0
    v_mov_b64 v[72:73], 0
    v_mov_b64 v[74:75], 0
    v_mov_b64 v[76:77], 0
    v_mov_b64 v[78:79], 0
    v_mov_b64 v[80:81], 0
    v_mov_b64 v[82:83], 0
    v_mov_b64 v[84:85], 0
    v_mov_b64 v[86:87], 0
    v_mov_b64 v[88:89], 0
    v_mov_b64 v[90:91], 0
    v_mov_b64 v[92:93], 0
    v_mov_b64 v[94:95], 0
    v_mov_b64 v[96:97], 0
    v_mov_b64 v[98:99], 0
    v_mov_b64 v[100:101], 0
    v_mov_b64 v[102:103], 0
    v_mov_b64 v[104:105], 0
    v_mov_b64 v[106:107], 0
    v_mov_b64 v[108:109], 0
    v_mov_b64 v[110:111], 0
    v_mov_b64 v[112:113], 0
    v_mov_b64 v[114:115], 0
    v_mov_b64 v[116:117], 0
    v_mov_b64 v[118:119], 0
    v_mov_b64 v[120:121], 0
    v_mov_b64 v[122:123], 0
    v_mov_b64 v[124:125], 0
    v_mov_b64 v[126:127], 0
    v_mov_b64 v[128:129], 0
    v_mov_b64 v[130:131], 0
    v_mov_b64 v[132:133], 0
    v_mov_b64 v[134:135], 0
    v_mov_b64 v[136:137], 0
    v_mov_b64 v[138:139], 0
    v_mov_b64 v[140:141], 0
    v_mov_b64 v[142:143], 0
    v_mov_b64 v[144:145], 0
    v_mov_b64 v[146:147], 0
    v_mov_b64 v[148:149], 0
    v_mov_b64 v[150:151], 0
    v_mov_b64 v[152:153], 0
    v_mov_b64 v[154:155], 0
    s_mov_b32 s54, 3
    s_cmp_lg_u32 s30, 0
    s_cbranch_scc1 K_WARMM0
    s_call_b64 s[38:39], WP_attd
    s_call_b64 s[38:39], WP_p2g
    s_branch K_WARMMX
K_WARMM0:
    s_cmp_lg_u32 s30, 1
    s_cbranch_scc1 K_WARMM1
    s_call_b64 s[38:39], WP_atts
    s_call_b64 s[38:39], WP_early
    s_branch K_WARMMX
K_WARMM1:
    s_cmp_lg_u32 s30, 2
    s_cbranch_scc1 K_WARMM2
    s_call_b64 s[38:39], WP_help
    s_call_b64 s[38:39], WP_flags
    s_branch K_WARMMX
K_WARMM2:
    s_call_b64 s[38:39], WP_spin
K_WARMMX:
    s_setprio 2
    s_barrier
    ds_read_b64_tr_b16 v[204:205], v48 offset:40960
    ds_read_b64_tr_b16 v[206:207], v48 offset:41984
    ds_read_b128 v[156:159], v44 offset:40960
    ds_read_b64_tr_b16 v[208:209], v49 offset:40960
    ds_read_b64_tr_b16 v[210:211], v49 offset:41984
    ds_read_b128 v[160:163], v44 offset:43008
    ds_read_b64_tr_b16 v[212:213], v50 offset:40960
    ds_read_b64_tr_b16 v[214:215], v50 offset:41984
    ds_read_b128 v[164:167], v44 offset:45056
    ds_read_b64_tr_b16 v[216:217], v51 offset:40960
    ds_read_b64_tr_b16 v[218:219], v51 offset:41984
    ds_read_b128 v[168:171], v44 offset:47104
    ds_read_b128 v[172:175], v44 offset:49152
    ds_read_b128 v[176:179], v44 offset:51200
K_CLOOP:
    s_waitcnt lgkmcnt(0)
    v_mfma_f32_16x16x32_bf16 v[60:63], v[204:207], v[156:159], v[60:63]
    ds_read_b64_tr_b16 v[220:221], v48 offset:49152
    v_mfma_f32_16x16x32_bf16 v[64:67], v[208:211], v[156:159], v[64:67]
    ds_read_b64_tr_b16 v[222:223], v48 offset:50176
    v_mfma_f32_16x16x32_bf16 v[68:71], v[212:215], v[156:159], v[68:71]
    ds_read_b128 v[180:183], v45 offset:40960
    v_mfma_f32_16x16x32_bf16 v[72:75], v[216:219], v[156:159], v[72:75]
    ds_read_b64_tr_b16 v[224:225], v49 offset:49152
    v_mfma_f32_16x16x32_bf16 v[88:91], v[216:219], v[160:163], v[88:91]
    ds_read_b64_tr_b16 v[226:227], v49 offset:50176
    v_mfma_f32_16x16x32_bf16 v[84:87], v[212:215], v[160:163], v[84:87]
    ds_read_b128 v[184:187], v45 offset:43008
    v_mfma_f32_16x16x32_bf16 v[80:83], v[208:211], v[160:163], v[80:83]
    ds_read_b64_tr_b16 v[228:229], v50 offset:49152
    v_mfma_f32_16x16x32_bf16 v[76:79], v[204:207], v[160:163], v[76:79]
    ds_read_b64_tr_b16 v[230:231], v50 offset:50176
    v_mfma_f32_16x16x32_bf16 v[92:95], v[204:207], v[164:167], v[92:95]
    ds_read_b128 v[188:191], v45 offset:45056
    v_mfma_f32_16x16x32_bf16 v[96:99], v[208:211], v[164:167], v[96:99]
    ds_read_b64_tr_b16 v[232:233], v51 offset:49152
    v_mfma_f32_16x16x32_bf16 v[100:103], v[212:215], v[164:167], v[100:103]
    ds_read_b64_tr_b16 v[234:235], v51 offset:50176
    v_mfma_f32_16x16x32_bf16 v[104:107], v[216:219], v[164:167], v[104:107]
    ds_read_b128 v[192:195], v45 offset:47104
    v_mfma_f32_16x16x32_bf16 v[120:123], v[216:219], v[168:171], v[120:123]
    ds_read_b128 v[196:199], v45 offset:49152
    v_mfma_f32_16x16x32_bf16 v[116:119], v[212:215], v[168:171], v[116:119]
    ds_read_b128 v[200:203], v45 offset:51200
    v_mfma_f32_16x16x32_bf16 v[112:115], v[208:211], v[168:171], v[112:115]
    v_mfma_f32_16x16x32_bf16 v[108:111], v[204:207], v[168:171], v[108:111]
    v_mfma_f32_16x16x32_bf16 v[124:127], v[204:207], v[172:175], v[124:127]
    v_mfma_f32_16x16x32_bf16 v[128:131], v[208:211], v[172:175], v[128:131]
    v_mfma_f32_16x16x32_bf16 v[132:135], v[212:215], v[172:175], v[132:135]
    v_mfma_f32_16x16x32_bf16 v[136:139], v[216:219], v[172:175], v[136:139]
    v_mfma_f32_16x16x32_bf16 v[152:155], v[216:219], v[176:179], v[152:155]
    v_mfma_f32_16x16x32_bf16 v[148:151], v[212:215], v[176:179], v[148:151]
    v_mfma_f32_16x16x32_bf16 v[144:147], v[208:211], v[176:179], v[144:147]
    v_mfma_f32_16x16x32_bf16 v[140:143], v[204:207], v[176:179], v[140:143]
    s_waitcnt lgkmcnt(0)
    s_barrier
    v_mfma_f32_16x16x32_bf16 v[60:63], v[220:223], v[180:183], v[60:63]
    ds_read_b64_tr_b16 v[204:205], v52 offset:0
    v_mfma_f32_16x16x32_bf16 v[64:67], v[224:227], v[180:183], v[64:67]
    ds_read_b64_tr_b16 v[206:207], v52 offset:1024
    v_mfma_f32_16x16x32_bf16 v[68:71], v[228:231], v[180:183], v[68:71]
    ds_read_b128 v[156:159], v46 offset:0
    v_mfma_f32_16x16x32_bf16 v[72:75], v[232:235], v[180:183], v[72:75]
    ds_read_b64_tr_b16 v[208:209], v53 offset:0
    v_mfma_f32_16x16x32_bf16 v[88:91], v[232:235], v[184:187], v[88:91]
    ds_read_b64_tr_b16 v[210:211], v53 offset:1024
    v_mfma_f32_16x16x32_bf16 v[84:87], v[228:231], v[184:187], v[84:87]
    ds_read_b128 v[160:163], v46 offset:2048
    v_mfma_f32_16x16x32_bf16 v[80:83], v[224:227], v[184:187], v[80:83]
    ds_read_b64_tr_b16 v[212:213], v54 offset:0
    v_mfma_f32_16x16x32_bf16 v[76:79], v[220:223], v[184:187], v[76:79]
    ds_read_b64_tr_b16 v[214:215], v54 offset:1024
    v_mfma_f32_16x16x32_bf16 v[92:95], v[220:223], v[188:191], v[92:95]
    ds_read_b128 v[164:167], v46 offset:4096
    v_mfma_f32_16x16x32_bf16 v[96:99], v[224:227], v[188:191], v[96:99]
    ds_read_b64_tr_b16 v[216:217], v55 offset:0
    v_mfma_f32_16x16x32_bf16 v[100:103], v[228:231], v[188:191], v[100:103]
    ds_read_b64_tr_b16 v[218:219], v55 offset:1024
    v_mfma_f32_16x16x32_bf16 v[104:107], v[232:235], v[188:191], v[104:107]
    ds_read_b128 v[168:171], v46 offset:6144
    v_mfma_f32_16x16x32_bf16 v[120:123], v[232:235], v[192:195], v[120:123]
    ds_read_b128 v[172:175], v46 offset:8192
    v_mfma_f32_16x16x32_bf16 v[116:119], v[228:231], v[192:195], v[116:119]
    ds_read_b128 v[176:179], v46 offset:10240
    v_mfma_f32_16x16x32_bf16 v[112:115], v[224:227], v[192:195], v[112:115]
    v_mfma_f32_16x16x32_bf16 v[108:111], v[220:223], v[192:195], v[108:111]
    v_mfma_f32_16x16x32_bf16 v[124:127], v[220:223], v[196:199], v[124:127]
    v_mfma_f32_16x16x32_bf16 v[128:131], v[224:227], v[196:199], v[128:131]
    v_mfma_f32_16x16x32_bf16 v[132:135], v[228:231], v[196:199], v[132:135]
    v_mfma_f32_16x16x32_bf16 v[136:139], v[232:235], v[196:199], v[136:139]
    v_mfma_f32_16x16x32_bf16 v[152:155], v[232:235], v[200:203], v[152:155]
    v_mfma_f32_16x16x32_bf16 v[148:151], v[228:231], v[200:203], v[148:151]
    v_mfma_f32_16x16x32_bf16 v[144:147], v[224:227], v[200:203], v[144:147]
    v_mfma_f32_16x16x32_bf16 v[140:143], v[220:223], v[200:203], v[140:143]
    s_waitcnt lgkmcnt(0)
    v_mfma_f32_16x16x32_bf16 v[60:63], v[204:207], v[156:159], v[60:63]
    ds_read_b64_tr_b16 v[220:221], v52 offset:8192
    v_mfma_f32_16x16x32_bf16 v[64:67], v[208:211], v[156:159], v[64:67]
    ds_read_b64_tr_b16 v[222:223], v52 offset:9216
    v_mfma_f32_16x16x32_bf16 v[68:71], v[212:215], v[156:159], v[68:71]
    ds_read_b128 v[180:183], v47 offset:0
    v_mfma_f32_16x16x32_bf16 v[72:75], v[216:219], v[156:159], v[72:75]
    ds_read_b64_tr_b16 v[224:225], v53 offset:8192
    v_mfma_f32_16x16x32_bf16 v[88:91], v[216:219], v[160:163], v[88:91]
    ds_read_b64_tr_b16 v[226:227], v53 offset:9216
    v_mfma_f32_16x16x32_bf16 v[84:87], v[212:215], v[160:163], v[84:87]
    ds_read_b128 v[184:187], v47 offset:2048
    v_mfma_f32_16x16x32_bf16 v[80:83], v[208:211], v[160:163], v[80:83]
    ds_read_b64_tr_b16 v[228:229], v54 offset:8192
    v_mfma_f32_16x16x32_bf16 v[76:79], v[204:207], v[160:163], v[76:79]
    ds_read_b64_tr_b16 v[230:231], v54 offset:9216
    v_mfma_f32_16x16x32_bf16 v[92:95], v[204:207], v[164:167], v[92:95]
    ds_read_b128 v[188:191], v47 offset:4096
    v_mfma_f32_16x16x32_bf16 v[96:99], v[208:211], v[164:167], v[96:99]
    ds_read_b64_tr_b16 v[232:233], v55 offset:8192
    v_mfma_f32_16x16x32_bf16 v[100:103], v[212:215], v[164:167], v[100:103]
    ds_read_b64_tr_b16 v[234:235], v55 offset:9216
    v_mfma_f32_16x16x32_bf16 v[104:107], v[216:219], v[164:167], v[104:107]
    ds_read_b128 v[192:195], v47 offset:6144
    v_mfma_f32_16x16x32_bf16 v[120:123], v[216:219], v[168:171], v[120:123]
    ds_read_b128 v[196:199], v47 offset:8192
    v_mfma_f32_16x16x32_bf16 v[116:119], v[212:215], v[168:171], v[116:119]
    ds_read_b128 v[200:203], v47 offset:10240
    v_mfma_f32_16x16x32_bf16 v[112:115], v[208:211], v[168:171], v[112:115]
    v_mfma_f32_16x16x32_bf16 v[108:111], v[204:207], v[168:171], v[108:111]
    v_mfma_f32_16x16x32_bf16 v[124:127], v[204:207], v[172:175], v[124:127]
    v_mfma_f32_16x16x32_bf16 v[128:131], v[208:211], v[172:175], v[128:131]
    v_mfma_f32_16x16x32_bf16 v[132:135], v[212:215], v[172:175], v[132:135]
    v_mfma_f32_16x16x32_bf16 v[136:139], v[216:219], v[172:175], v[136:139]
    v_mfma_f32_16x16x32_bf16 v[152:155], v[216:219], v[176:179], v[152:155]
    v_mfma_f32_16x16x32_bf16 v[148:151], v[212:215], v[176:179], v[148:151]
    v_mfma_f32_16x16x32_bf16 v[144:147], v[208:211], v[176:179], v[144:147]
    v_mfma_f32_16x16x32_bf16 v[140:143], v[204:207], v[176:179], v[140:143]
    s_waitcnt lgkmcnt(0)
    s_barrier
    v_mfma_f32_16x16x32_bf16 v[60:63], v[220:223], v[180:183], v[60:63]
    ds_read_b64_tr_b16 v[204:205], v48 offset:0
    v_mfma_f32_16x16x32_bf16 v[64:67], v[224:227], v[180:183], v[64:67]
    ds_read_b64_tr_b16 v[206:207], v48 offset:1024
    v_mfma_f32_16x16x32_bf16 v[68:71], v[228:231], v[180:183], v[68:71]
    ds_read_b128 v[156:159], v44 offset:0
    v_mfma_f32_16x16x32_bf16 v[72:75], v[232:235], v[180:183], v[72:75]
    ds_read_b64_tr_b16 v[208:209], v49 offset:0
    v_mfma_f32_16x16x32_bf16 v[88:91], v[232:235], v[184:187], v[88:91]
    ds_read_b64_tr_b16 v[210:211], v49 offset:1024
    v_mfma_f32_16x16x32_bf16 v[84:87], v[228:231], v[184:187], v[84:87]
    ds_read_b128 v[160:163], v44 offset:2048
    v_mfma_f32_16x16x32_bf16 v[80:83], v[224:227], v[184:187], v[80:83]
    ds_read_b64_tr_b16 v[212:213], v50 offset:0
    v_mfma_f32_16x16x32_bf16 v[76:79], v[220:223], v[184:187], v[76:79]
    ds_read_b64_tr_b16 v[214:215], v50 offset:1024
    v_mfma_f32_16x16x32_bf16 v[92:95], v[220:223], v[188:191], v[92:95]
    ds_read_b128 v[164:167], v44 offset:4096
    v_mfma_f32_16x16x32_bf16 v[96:99], v[224:227], v[188:191], v[96:99]
    ds_read_b64_tr_b16 v[216:217], v51 offset:0
    v_mfma_f32_16x16x32_bf16 v[100:103], v[228:231], v[188:191], v[100:103]
    ds_read_b64_tr_b16 v[218:219], v51 offset:1024
    v_mfma_f32_16x16x32_bf16 v[104:107], v[232:235], v[188:191], v[104:107]
    ds_read_b128 v[168:171], v44 offset:6144
    v_mfma_f32_16x16x32_bf16 v[120:123], v[232:235], v[192:195], v[120:123]
    ds_read_b128 v[172:175], v44 offset:8192
    v_mfma_f32_16x16x32_bf16 v[116:119], v[228:231], v[192:195], v[116:119]
    ds_read_b128 v[176:179], v44 offset:10240
    v_mfma_f32_16x16x32_bf16 v[112:115], v[224:227], v[192:195], v[112:115]
    v_mfma_f32_16x16x32_bf16 v[108:111], v[220:223], v[192:195], v[108:111]
    v_mfma_f32_16x16x32_bf16 v[124:127], v[220:223], v[196:199], v[124:127]
    v_mfma_f32_16x16x32_bf16 v[128:131], v[224:227], v[196:199], v[128:131]
    v_mfma_f32_16x16x32_bf16 v[132:135], v[228:231], v[196:199], v[132:135]
    v_mfma_f32_16x16x32_bf16 v[136:139], v[232:235], v[196:199], v[136:139]
    v_mfma_f32_16x16x32_bf16 v[152:155], v[232:235], v[200:203], v[152:155]
    v_mfma_f32_16x16x32_bf16 v[148:151], v[228:231], v[200:203], v[148:151]
    v_mfma_f32_16x16x32_bf16 v[144:147], v[224:227], v[200:203], v[144:147]
    v_mfma_f32_16x16x32_bf16 v[140:143], v[220:223], v[200:203], v[140:143]
    s_waitcnt lgkmcnt(0)
    v_mfma_f32_16x16x32_bf16 v[60:63], v[204:207], v[156:159], v[60:63]
    ds_read_b64_tr_b16 v[220:221], v48 offset:8192
    v_mfma_f32_16x16x32_bf16 v[64:67], v[208:211], v[156:159], v[64:67]
    ds_read_b64_tr_b16 v[222:223], v48 offset:9216
    v_mfma_f32_16x16x32_bf16 v[68:71], v[212:215], v[156:159], v[68:71]
    ds_read_b128 v[180:183], v45 offset:0
    v_mfma_f32_16x16x32_bf16 v[72:75], v[216:219], v[156:159], v[72:75]
    ds_read_b64_tr_b16 v[224:225], v49 offset:8192
    v_mfma_f32_16x16x32_bf16 v[88:91], v[216:219], v[160:163], v[88:91]
    ds_read_b64_tr_b16 v[226:227], v49 offset:9216
    v_mfma_f32_16x16x32_bf16 v[84:87], v[212:215], v[160:163], v[84:87]
    ds_read_b128 v[184:187], v45 offset:2048
    v_mfma_f32_16x16x32_bf16 v[80:83], v[208:211], v[160:163], v[80:83]
    ds_read_b64_tr_b16 v[228:229], v50 offset:8192
    v_mfma_f32_16x16x32_bf16 v[76:79], v[204:207], v[160:163], v[76:79]
    ds_read_b64_tr_b16 v[230:231], v50 offset:9216
    v_mfma_f32_16x16x32_bf16 v[92:95], v[204:207], v[164:167], v[92:95]
    ds_read_b128 v[188:191], v45 offset:4096
    v_mfma_f32_16x16x32_bf16 v[96:99], v[208:211], v[164:167], v[96:99]
    ds_read_b64_tr_b16 v[232:233], v51 offset:8192
    v_mfma_f32_16x16x32_bf16 v[100:103], v[212:215], v[164:167], v[100:103]
    ds_read_b64_tr_b16 v[234:235], v51 offset:9216
    v_mfma_f32_16x16x32_bf16 v[104:107], v[216:219], v[164:167], v[104:107]
    ds_read_b128 v[192:195], v45 offset:6144
    v_mfma_f32_16x16x32_bf16 v[120:123], v[216:219], v[168:171], v[120:123]
    ds_read_b128 v[196:199], v45 offset:8192
    v_mfma_f32_16x16x32_bf16 v[116:119], v[212:215], v[168:171], v[116:119]
    ds_read_b128 v[200:203], v45 offset:10240
    v_mfma_f32_16x16x32_bf16 v[112:115], v[208:211], v[168:171], v[112:115]
    v_mfma_f32_16x16x32_bf16 v[108:111], v[204:207], v[168:171], v[108:111]
    v_mfma_f32_16x16x32_bf16 v[124:127], v[204:207], v[172:175], v[124:127]
    v_mfma_f32_16x16x32_bf16 v[128:131], v[208:211], v[172:175], v[128:131]
    v_mfma_f32_16x16x32_bf16 v[132:135], v[212:215], v[172:175], v[132:135]
    v_mfma_f32_16x16x32_bf16 v[136:139], v[216:219], v[172:175], v[136:139]
    v_mfma_f32_16x16x32_bf16 v[152:155], v[216:219], v[176:179], v[152:155]
    v_mfma_f32_16x16x32_bf16 v[148:151], v[212:215], v[176:179], v[148:151]
    v_mfma_f32_16x16x32_bf16 v[144:147], v[208:211], v[176:179], v[144:147]
    v_mfma_f32_16x16x32_bf16 v[140:143], v[204:207], v[176:179], v[140:143]
    s_waitcnt lgkmcnt(0)
    s_barrier
    v_mfma_f32_16x16x32_bf16 v[60:63], v[220:223], v[180:183], v[60:63]
    ds_read_b64_tr_b16 v[204:205], v48 offset:40960
    v_mfma_f32_16x16x32_bf16 v[64:67], v[224:227], v[180:183], v[64:67]
    ds_read_b64_tr_b16 v[206:207], v48 offset:41984
    v_mfma_f32_16x16x32_bf16 v[68:71], v[228:231], v[180:183], v[68:71]
    ds_read_b128 v[156:159], v44 offset:40960
    v_mfma_f32_16x16x32_bf16 v[72:75], v[232:235], v[180:183], v[72:75]
    ds_read_b64_tr_b16 v[208:209], v49 offset:40960
    v_mfma_f32_16x16x32_bf16 v[88:91], v[232:235], v[184:187], v[88:91]
    ds_read_b64_tr_b16 v[210:211], v49 offset:41984
    v_mfma_f32_16x16x32_bf16 v[84:87], v[228:231], v[184:187], v[84:87]
    ds_read_b128 v[160:163], v44 offset:43008
    v_mfma_f32_16x16x32_bf16 v[80:83], v[224:227], v[184:187], v[80:83]
    ds_read_b64_tr_b16 v[212:213], v50 offset:40960
    v_mfma_f32_16x16x32_bf16 v[76:79], v[220:223], v[184:187], v[76:79]
    ds_read_b64_tr_b16 v[214:215], v50 offset:41984
    v_mfma_f32_16x16x32_bf16 v[92:95], v[220:223], v[188:191], v[92:95]
    ds_read_b128 v[164:167], v44 offset:45056
    v_mfma_f32_16x16x32_bf16 v[96:99], v[224:227], v[188:191], v[96:99]
    ds_read_b64_tr_b16 v[216:217], v51 offset:40960
    v_mfma_f32_16x16x32_bf16 v[100:103], v[228:231], v[188:191], v[100:103]
    ds_read_b64_tr_b16 v[218:219], v51 offset:41984
    v_mfma_f32_16x16x32_bf16 v[104:107], v[232:235], v[188:191], v[104:107]
    ds_read_b128 v[168:171], v44 offset:47104
    v_mfma_f32_16x16x32_bf16 v[120:123], v[232:235], v[192:195], v[120:123]
    ds_read_b128 v[172:175], v44 offset:49152
    v_mfma_f32_16x16x32_bf16 v[116:119], v[228:231], v[192:195], v[116:119]
    ds_read_b128 v[176:179], v44 offset:51200
    v_mfma_f32_16x16x32_bf16 v[112:115], v[224:227], v[192:195], v[112:115]
    s_sub_u32 s54, s54, 1
    v_mfma_f32_16x16x32_bf16 v[108:111], v[220:223], v[192:195], v[108:111]
    s_cmp_lg_u32 s54, 0
    v_mfma_f32_16x16x32_bf16 v[124:127], v[220:223], v[196:199], v[124:127]
    v_mfma_f32_16x16x32_bf16 v[128:131], v[224:227], v[196:199], v[128:131]
    v_mfma_f32_16x16x32_bf16 v[132:135], v[228:231], v[196:199], v[132:135]
    v_mfma_f32_16x16x32_bf16 v[136:139], v[232:235], v[196:199], v[136:139]
    v_mfma_f32_16x16x32_bf16 v[152:155], v[232:235], v[200:203], v[152:155]
    v_mfma_f32_16x16x32_bf16 v[148:151], v[228:231], v[200:203], v[148:151]
    v_mfma_f32_16x16x32_bf16 v[144:147], v[224:227], v[200:203], v[144:147]
    v_mfma_f32_16x16x32_bf16 v[140:143], v[220:223], v[200:203], v[140:143]
    s_cbranch_scc1 K_CLOOP
    s_waitcnt lgkmcnt(0)
    v_mfma_f32_16x16x32_bf16 v[60:63], v[204:207], v[156:159], v[60:63]
    ds_read_b64_tr_b16 v[220:221], v48 offset:49152
    v_mfma_f32_16x16x32_bf16 v[64:67], v[208:211], v[156:159], v[64:67]
    ds_read_b64_tr_b16 v[222:223], v48 offset:50176
    v_mfma_f32_16x16x32_bf16 v[68:71], v[212:215], v[156:159], v[68:71]
    ds_read_b128 v[180:183], v45 offset:40960
    v_mfma_f32_16x16x32_bf16 v[72:75], v[216:219], v[156:159], v[72:75]
    ds_read_b64_tr_b16 v[224:225], v49 offset:49152
    v_mfma_f32_16x16x32_bf16 v[76:79], v[204:207], v[160:163], v[76:79]
    ds_read_b64_tr_b16 v[226:227], v49 offset:50176
    v_mfma_f32_16x16x32_bf16 v[80:83], v[208:211], v[160:163], v[80:83]
    ds_read_b128 v[184:187], v45 offset:43008
    v_mfma_f32_16x16x32_bf16 v[84:87], v[212:215], v[160:163], v[84:87]
    ds_read_b64_tr_b16 v[228:229], v50 offset:49152
    v_mfma_f32_16x16x32_bf16 v[88:91], v[216:219], v[160:163], v[88:91]
    ds_read_b64_tr_b16 v[230:231], v50 offset:50176
    v_mfma_f32_16x16x32_bf16 v[92:95], v[204:207], v[164:167], v[92:95]
    ds_read_b128 v[188:191], v45 offset:45056
    v_mfma_f32_16x16x32_bf16 v[96:99], v[208:211], v[164:167], v[96:99]
    ds_read_b64_tr_b16 v[232:233], v51 offset:49152
    v_mfma_f32_16x16x32_bf16 v[100:103], v[212:215], v[164:167], v[100:103]
    ds_read_b64_tr_b16 v[234:235], v51 offset:50176
    v_mfma_f32_16x16x32_bf16 v[104:107], v[216:219], v[164:167], v[104:107]
    ds_read_b128 v[192:195], v45 offset:47104
    v_mfma_f32_16x16x32_bf16 v[108:111], v[204:207], v[168:171], v[108:111]
    ds_read_b128 v[196:199], v45 offset:49152
    v_mfma_f32_16x16x32_bf16 v[112:115], v[208:211], v[168:171], v[112:115]
    ds_read_b128 v[200:203], v45 offset:51200
    v_mfma_f32_16x16x32_bf16 v[116:119], v[212:215], v[168:171], v[116:119]
    v_mfma_f32_16x16x32_bf16 v[120:123], v[216:219], v[168:171], v[120:123]
    s_waitcnt lgkmcnt(0)
    v_mfma_f32_16x16x32_bf16 v[60:63], v[220:223], v[180:183], v[60:63]
    v_mfma_f32_16x16x32_bf16 v[64:67], v[224:227], v[180:183], v[64:67]
    v_mfma_f32_16x16x32_bf16 v[68:71], v[228:231], v[180:183], v[68:71]
    v_mfma_f32_16x16x32_bf16 v[72:75], v[232:235], v[180:183], v[72:75]
    v_mfma_f32_16x16x32_bf16 v[76:79], v[220:223], v[184:187], v[76:79]
    v_mfma_f32_16x16x32_bf16 v[80:83], v[224:227], v[184:187], v[80:83]
    v_mfma_f32_16x16x32_bf16 v[84:87], v[228:231], v[184:187], v[84:87]
    v_mfma_f32_16x16x32_bf16 v[88:91], v[232:235], v[184:187], v[88:91]
    v_mfma_f32_16x16x32_bf16 v[92:95], v[220:223], v[188:191], v[92:95]
    v_cvt_pk_bf16_f32 v236, v60, v61
    v_cvt_pk_bf16_f32 v237, v62, v63
    ds_write_b64 v56, v[236:237] offset:0
    v_mfma_f32_16x16x32_bf16 v[96:99], v[224:227], v[188:191], v[96:99]
    v_cvt_pk_bf16_f32 v238, v64, v65
    v_cvt_pk_bf16_f32 v239, v66, v67
    ds_write_b64 v56, v[238:239] offset:32
    v_mfma_f32_16x16x32_bf16 v[100:103], v[228:231], v[188:191], v[100:103]
    v_cvt_pk_bf16_f32 v240, v68, v69
    v_cvt_pk_bf16_f32 v241, v70, v71
    ds_write_b64 v56, v[240:241] offset:64
    v_mfma_f32_16x16x32_bf16 v[104:107], v[232:235], v[188:191], v[104:107]
    v_cvt_pk_bf16_f32 v242, v72, v73
    v_cvt_pk_bf16_f32 v243, v74, v75
    ds_write_b64 v56, v[242:243] offset:96
    v_mfma_f32_16x16x32_bf16 v[108:111], v[220:223], v[192:195], v[108:111]
    v_cvt_pk_bf16_f32 v236, v76, v77
    v_cvt_pk_bf16_f32 v237, v78, v79
    ds_write_b64 v56, v[236:237] offset:4352
    v_mfma_f32_16x16x32_bf16 v[112:115], v[224:227], v[192:195], v[112:115]
    v_cvt_pk_bf16_f32 v238, v80, v81
    v_cvt_pk_bf16_f32 v239, v82, v83
    ds_write_b64 v56, v[238:239] offset:4384
    v_mfma_f32_16x16x32_bf16 v[116:119], v[228:231], v[192:195], v[116:119]
    v_cvt_pk_bf16_f32 v240, v84, v85
    v_cvt_pk_bf16_f32 v241, v86, v87
    ds_write_b64 v56, v[240:241] offset:4416
    v_mfma_f32_16x16x32_bf16 v[120:123], v[232:235], v[192:195], v[120:123]
    v_cvt_pk_bf16_f32 v242, v88, v89
    v_cvt_pk_bf16_f32 v243, v90, v91
    ds_write_b64 v56, v[242:243] offset:4448
    v_mfma_f32_16x16x32_bf16 v[124:127], v[204:207], v[172:175], v[124:127]
    v_cvt_pk_bf16_f32 v236, v92, v93
    v_cvt_pk_bf16_f32 v237, v94, v95
    ds_write_b64 v56, v[236:237] offset:8704
    v_mfma_f32_16x16x32_bf16 v[128:131], v[208:211], v[172:175], v[128:131]
    v_cvt_pk_bf16_f32 v238, v96, v97
    v_cvt_pk_bf16_f32 v239, v98, v99
    ds_write_b64 v56, v[238:239] offset:8736
    v_mfma_f32_16x16x32_bf16 v[132:135], v[212:215], v[172:175], v[132:135]
    v_cvt_pk_bf16_f32 v240, v100, v101
    v_cvt_pk_bf16_f32 v241, v102, v103
    ds_write_b64 v56, v[240:241] offset:8768
    v_mfma_f32_16x16x32_bf16 v[136:139], v[216:219], v[172:175], v[136:139]
    v_cvt_pk_bf16_f32 v242, v104, v105
    v_cvt_pk_bf16_f32 v243, v106, v107
    ds_write_b64 v56, v[242:243] offset:8800
    v_mfma_f32_16x16x32_bf16 v[124:127], v[220:223], v[196:199], v[124:127]
    v_cvt_pk_bf16_f32 v236, v108, v109
    v_cvt_pk_bf16_f32 v237, v110, v111
    ds_write_b64 v56, v[236:237] offset:13056
    v_mfma_f32_16x16x32_bf16 v[128:131], v[224:227], v[196:199], v[128:131]
    v_cvt_pk_bf16_f32 v238, v112, v113
    v_cvt_pk_bf16_f32 v239, v114, v115
    ds_write_b64 v56, v[238:239] offset:13088
    v_mfma_f32_16x16x32_bf16 v[132:135], v[228:231], v[196:199], v[132:135]
    v_cvt_pk_bf16_f32 v240, v116, v117
    v_cvt_pk_bf16_f32 v241, v118, v119
    ds_write_b64 v56, v[240:241] offset:13120
    v_mfma_f32_16x16x32_bf16 v[136:139], v[232:235], v[196:199], v[136:139]
    v_cvt_pk_bf16_f32 v242, v120, v121
    v_cvt_pk_bf16_f32 v243, v122, v123
    ds_write_b64 v56, v[242:243] offset:13152
    v_mfma_f32_16x16x32_bf16 v[140:143], v[204:207], v[176:179], v[140:143]
    v_cvt_pk_bf16_f32 v236, v124, v125
    v_cvt_pk_bf16_f32 v237, v126, v127
    ds_write_b64 v56, v[236:237] offset:17408
    v_mfma_f32_16x16x32_bf16 v[144:147], v[208:211], v[176:179], v[144:147]
    v_cvt_pk_bf16_f32 v238, v128, v129
    v_cvt_pk_bf16_f32 v239, v130, v131
    ds_write_b64 v56, v[238:239] offset:17440
    v_mfma_f32_16x16x32_bf16 v[148:151], v[212:215], v[176:179], v[148:151]
    v_cvt_pk_bf16_f32 v240, v132, v133
    v_cvt_pk_bf16_f32 v241, v134, v135
    ds_write_b64 v56, v[240:241] offset:17472
    v_mfma_f32_16x16x32_bf16 v[152:155], v[216:219], v[176:179], v[152:155]
    v_cvt_pk_bf16_f32 v242, v136, v137
    v_cvt_pk_bf16_f32 v243, v138, v139
    ds_write_b64 v56, v[242:243] offset:17504
    v_mfma_f32_16x16x32_bf16 v[140:143], v[220:223], v[200:203], v[140:143]
    v_mfma_f32_16x16x32_bf16 v[144:147], v[224:227], v[200:203], v[144:147]
    v_mfma_f32_16x16x32_bf16 v[148:151], v[228:231], v[200:203], v[148:151]
    v_mfma_f32_16x16x32_bf16 v[152:155], v[232:235], v[200:203], v[152:155]
    s_nop 7
    v_cvt_pk_bf16_f32 v236, v140, v141
    v_cvt_pk_bf16_f32 v237, v142, v143
    ds_write_b64 v56, v[236:237] offset:21760
    v_cvt_pk_bf16_f32 v238, v144, v145
    v_cvt_pk_bf16_f32 v239, v146, v147
    ds_write_b64 v56, v[238:239] offset:21792
    v_cvt_pk_bf16_f32 v240, v148, v149
    v_cvt_pk_bf16_f32 v241, v150, v151
    ds_write_b64 v56, v[240:241] offset:21824
    v_cvt_pk_bf16_f32 v242, v152, v153
    v_cvt_pk_bf16_f32 v243, v154, v155
    ds_write_b64 v56, v[242:243] offset:21856
    s_setprio 0
    s_branch WS_attd
.p2align 12
WP_attd:
    s_setpc_b64 s[38:39]
WS_attd:
    s_waitcnt vmcnt(0) lgkmcnt(0)
    s_barrier
    ds_read_b64 v[60:61], v12 offset:80
    ds_read_b64 v[62:63], v13 offset:80
    ds_read_b64 v[44:45], v12 offset:4352
    ds_read_b64 v[46:47], v19 offset:4352
    ds_read_b64 v[64:65], v12 offset:4432
    ds_read_b64 v[66:67], v13 offset:4432
    ds_read_b64 v[72:73], v12 offset:120
    ds_read_b64 v[74:75], v13 offset:120
    ds_read_b64 v[48:49], v12 offset:4392
    ds_read_b64 v[50:51], v20 offset:4352
    ds_read_b64 v[76:77], v12 offset:4472
    ds_read_b64 v[78:79], v13 offset:4472
    ds_read_b64 v[52:53], v12 offset:8704
    ds_read_b64 v[54:55], v19 offset:8704
    ds_read_b64 v[68:69], v12 offset:8784
    ds_read_b64 v[70:71], v13 offset:8784
    s_waitcnt lgkmcnt(10)
    v_mfma_f32_16x16x32_bf16 v[116:119], v[60:63], v[44:47], v[36:39]
    v_mfma_f32_16x16x32_bf16 v[120:123], v[64:67], v[44:47], v[32:35]
    ds_read_b64 v[56:57], v12 offset:8744
    ds_read_b64 v[58:59], v20 offset:8704
    ds_read_b64 v[80:81], v12 offset:8824
    ds_read_b64 v[82:83], v13 offset:8824
    s_waitcnt lgkmcnt(8)
    v_mfma_f32_16x16x32_bf16 v[124:127], v[72:75], v[48:51], v[36:39]
    v_mfma_f32_16x16x32_bf16 v[128:131], v[76:79], v[48:51], v[32:35]
    s_waitcnt lgkmcnt(4)
    v_mfma_f32_16x16x32_bf16 v[132:135], v[64:67], v[52:55], v[28:31]
    v_mfma_f32_16x16x32_bf16 v[136:139], v[68:71], v[52:55], v[32:35]
    s_waitcnt lgkmcnt(0)
    v_mfma_f32_16x16x32_bf16 v[140:143], v[76:79], v[56:59], v[28:31]
    v_mfma_f32_16x16x32_bf16 v[144:147], v[80:83], v[56:59], v[32:35]
    ds_read_b64_tr_b16 v[84:85], v14 offset:160
    ds_read_b64_tr_b16 v[86:87], v14 offset:4512
    ds_read_b64_tr_b16 v[100:101], v21 offset:0
    ds_read_b64_tr_b16 v[102:103], v21 offset:4352
    v_max3_f32 v184, v116, v117, v120
    ds_read_b64_tr_b16 v[92:93], v14 offset:200
    v_max3_f32 v185, v118, v119, v122
    ds_read_b64_tr_b16 v[94:95], v14 offset:4552
    v_max_f32 v184, v184, v121
    ds_read_b64_tr_b16 v[104:105], v22 offset:0
    v_max_f32 v185, v185, v123
    ds_read_b64_tr_b16 v[106:107], v22 offset:4352
    v_max3_f32 v186, v124, v125, v128
    ds_read_b64_tr_b16 v[88:89], v14 offset:8864
    v_max3_f32 v187, v126, v127, v130
    ds_read_b64_tr_b16 v[108:109], v23 offset:4352
    v_max_f32 v186, v186, v129
    ds_read_b64_tr_b16 v[110:111], v23 offset:8704
    v_max_f32 v187, v187, v131
    ds_read_b64_tr_b16 v[96:97], v14 offset:8904
    v_max3_f32 v188, v132, v133, v136
    ds_read_b64_tr_b16 v[112:113], v24 offset:4352
    v_max3_f32 v189, v134, v135, v138
    ds_read_b64_tr_b16 v[114:115], v24 offset:8704
    v_max_f32 v188, v188, v137
    v_max_f32 v189, v189, v139
    v_max3_f32 v190, v140, v141, v144
    v_max3_f32 v191, v142, v143, v146
    v_max_f32 v190, v190, v145
    v_max_f32 v191, v191, v147
    v_cvt_pk_bf16_f32 v192, v184, v185
    v_cvt_pk_bf16_f32 v193, v186, v187
    v_cvt_pk_bf16_f32 v194, v188, v189
    v_cvt_pk_bf16_f32 v195, v190, v191
    v_lshlrev_b32 v184, 16, v192
    v_and_b32 v185, 0xffff0000, v192
    v_lshlrev_b32 v186, 16, v193
    v_and_b32 v187, 0xffff0000, v193
    v_lshlrev_b32 v188, 16, v194
    v_and_b32 v189, 0xffff0000, v194
    v_lshlrev_b32 v190, 16, v195
    v_and_b32 v191, 0xffff0000, v195
    v_pk_mul_f32 v[184:185], v[184:185], s[48:49]
    v_pk_mul_f32 v[186:187], v[186:187], s[48:49]
    v_pk_mul_f32 v[188:189], v[188:189], s[48:49]
    v_pk_mul_f32 v[190:191], v[190:191], s[48:49]
    v_cvt_pk_bf16_f32 v192, v184, v185
    v_cvt_pk_bf16_f32 v193, v186, v187
    v_cvt_pk_bf16_f32 v194, v188, v189
    v_cvt_pk_bf16_f32 v195, v190, v191
    v_permlane16_swap_b32 v192, v193
    s_nop 0
    v_permlane16_swap_b32 v194, v195
    s_nop 1
    v_permlane32_swap_b32 v192, v194
    v_permlane32_swap_b32 v193, v195
    v_lshlrev_b32 v184, 16, v192
    v_and_b32 v185, 0xffff0000, v192
    v_lshlrev_b32 v188, 16, v194
    v_and_b32 v189, 0xffff0000, v194
    v_lshlrev_b32 v186, 16, v193
    v_and_b32 v187, 0xffff0000, v193
    v_lshlrev_b32 v190, 16, v195
    v_and_b32 v191, 0xffff0000, v195
    v_max3_f32 v196, v184, v185, v188
    v_max3_f32 v197, v189, v186, v187
    v_max3_f32 v196, v196, v190, v191
    v_max_f32 v196, v196, v197
    v_mul_f32 v196, s46, v196
    v_pk_fma_f32 v[184:185], v[184:185], s[46:47], v[196:197] op_sel_hi:[1,1,0] neg_lo:[0,0,1] neg_hi:[0,0,1]
    v_pk_fma_f32 v[186:187], v[186:187], s[46:47], v[196:197] op_sel_hi:[1,1,0] neg_lo:[0,0,1] neg_hi:[0,0,1]
    v_pk_fma_f32 v[188:189], v[188:189], s[46:47], v[196:197] op_sel_hi:[1,1,0] neg_lo:[0,0,1] neg_hi:[0,0,1]
    v_pk_fma_f32 v[190:191], v[190:191], s[46:47], v[196:197] op_sel_hi:[1,1,0] neg_lo:[0,0,1] neg_hi:[0,0,1]
    v_exp_f32 v184, v184
    v_exp_f32 v185, v185
    v_exp_f32 v186, v186
    v_exp_f32 v187, v187
    v_exp_f32 v188, v188
    v_exp_f32 v189, v189
    v_exp_f32 v190, v190
    v_exp_f32 v191, v191
    v_pk_add_f32 v[200:201], v[184:185], v[186:187]
    v_pk_add_f32 v[202:203], v[188:189], v[190:191]
    v_pk_add_f32 v[200:201], v[200:201], v[202:203]
    v_add_f32 v200, v200, v201
    v_rcp_f32 v200, v200
    s_waitcnt lgkmcnt(0)
    v_pk_mul_f32 v[184:185], v[184:185], v[200:201] op_sel_hi:[1,0]
    v_pk_mul_f32 v[186:187], v[186:187], v[200:201] op_sel_hi:[1,0]
    v_pk_mul_f32 v[188:189], v[188:189], v[200:201] op_sel_hi:[1,0]
    v_pk_mul_f32 v[190:191], v[190:191], v[200:201] op_sel_hi:[1,0]
    v_cvt_pk_bf16_f32 v192, v184, v185
    v_cvt_pk_bf16_f32 v194, v188, v189
    v_cvt_pk_bf16_f32 v193, v186, v187
    v_cvt_pk_bf16_f32 v195, v190, v191
    v_permlane32_swap_b32 v192, v194
    s_nop 0
    v_permlane32_swap_b32 v193, v195
    s_nop 1
    v_permlane16_swap_b32 v192, v193
    v_permlane16_swap_b32 v194, v195
    v_perm_b32 v148, v192, v192, v40
    v_perm_b32 v149, v192, v192, v41
    v_perm_b32 v150, v192, v192, v42
    v_perm_b32 v151, v192, v192, v43
    v_perm_b32 v152, v193, v193, v40
    v_perm_b32 v153, v193, v193, v41
    v_perm_b32 v154, v193, v193, v42
    v_perm_b32 v155, v193, v193, v43
    v_mfma_f32_16x16x32_bf16 v[164:167], v[84:87], v[148:151], 0
    v_mfma_f32_16x16x32_bf16 v[180:183], v[100:103], v[148:151], 0
    v_perm_b32 v156, v194, v194, v40
    v_perm_b32 v157, v194, v194, v41
    v_perm_b32 v158, v194, v194, v42
    v_perm_b32 v159, v194, v194, v43
    v_mfma_f32_16x16x32_bf16 v[168:171], v[92:95], v[152:155], 0
    v_mfma_f32_16x16x32_bf16 v[180:183], v[104:107], v[152:155], v[180:183]
    v_perm_b32 v160, v195, v195, v40
    v_perm_b32 v161, v195, v195, v41
    v_perm_b32 v162, v195, v195, v42
    v_perm_b32 v163, v195, v195, v43
    v_mfma_f32_16x16x32_bf16 v[172:175], v[86:89], v[156:159], 0
    v_mfma_f32_16x16x32_bf16 v[180:183], v[108:111], v[156:159], v[180:183]
    v_mfma_f32_16x16x32_bf16 v[176:179], v[94:97], v[160:163], 0
    v_mfma_f32_16x16x32_bf16 v[180:183], v[112:115], v[160:163], v[180:183]
    v_cvt_pk_bf16_f32 v204, v164, v165
    v_cvt_pk_bf16_f32 v205, v166, v167
    v_cvt_pk_bf16_f32 v206, v168, v169
    v_cvt_pk_bf16_f32 v207, v170, v171
    buffer_store_dwordx4 v[204:207], v15, s[20:23], s50 offen sc1
    v_cvt_pk_bf16_f32 v208, v172, v173
    v_cvt_pk_bf16_f32 v209, v174, v175
    v_cvt_pk_bf16_f32 v210, v176, v177
    v_cvt_pk_bf16_f32 v211, v178, v179
    buffer_store_dwordx4 v[208:211], v15, s[20:23], s51 offen sc1
    v_cvt_pk_bf16_f32 v196, v180, v181
    v_cvt_pk_bf16_f32 v197, v182, v183
    buffer_store_dwordx2 v[196:197], v16, s[20:23], s50 offen sc1
    s_cmp_lg_u32 s34, -1
    s_cbranch_scc1 K_P2_EARLY
    s_waitcnt vmcnt(0)
    s_barrier
    s_branch K_END
WP_atts:
    s_setpc_b64 s[38:39]
K_JOIN_S:
    s_setprio 0
    s_barrier
    s_cmp_eq_u32 s30, 7
    s_cbranch_scc1 K_FLAG
    ds_read_b64 v[52:53], v12 offset:80
    ds_read_b64 v[54:55], v13 offset:80
    ds_read_b64 v[44:45], v12 offset:4352
    ds_read_b64 v[46:47], v19 offset:4352
    ds_read_b64 v[56:57], v12 offset:4432
    ds_read_b64 v[58:59], v13 offset:4432
    ds_read_b64 v[60:61], v12 offset:120
    ds_read_b64 v[62:63], v13 offset:120
    ds_read_b64 v[48:49], v12 offset:4392
    ds_read_b64 v[50:51], v20 offset:4352
    ds_read_b64 v[64:65], v12 offset:4472
    ds_read_b64 v[66:67], v13 offset:4472
    s_waitcnt lgkmcnt(6)
    v_mfma_f32_16x16x32_bf16 v[84:87], v[52:55], v[44:47], v[36:39]
    v_mfma_f32_16x16x32_bf16 v[88:91], v[56:59], v[44:47], v[32:35]
    s_waitcnt lgkmcnt(0)
    v_mfma_f32_16x16x32_bf16 v[92:95], v[60:63], v[48:51], v[36:39]
    v_mfma_f32_16x16x32_bf16 v[96:99], v[64:67], v[48:51], v[32:35]
    ds_read_b64_tr_b16 v[68:69], v14 offset:160
    ds_read_b64_tr_b16 v[70:71], v14 offset:4512
    ds_read_b64_tr_b16 v[76:77], v21 offset:0
    ds_read_b64_tr_b16 v[78:79], v21 offset:4352
    ds_read_b64_tr_b16 v[72:73], v14 offset:200
    ds_read_b64_tr_b16 v[74:75], v14 offset:4552
    ds_read_b64_tr_b16 v[80:81], v22 offset:0
    ds_read_b64_tr_b16 v[82:83], v22 offset:4352
    v_max3_f32 v120, v84, v85, v88
    v_max3_f32 v121, v86, v87, v90
    v_max_f32 v120, v120, v89
    v_max_f32 v121, v121, v91
    v_max3_f32 v122, v92, v93, v96
    v_max3_f32 v123, v94, v95, v98
    v_max_f32 v122, v122, v97
    v_max_f32 v123, v123, v99
    v_cvt_pk_bf16_f32 v124, v120, v121
    v_cvt_pk_bf16_f32 v125, v122, v123
    v_lshlrev_b32 v120, 16, v124
    v_and_b32 v121, 0xffff0000, v124
    v_lshlrev_b32 v122, 16, v125
    v_and_b32 v123, 0xffff0000, v125
    v_pk_mul_f32 v[120:121], v[120:121], s[48:49]
    v_pk_mul_f32 v[122:123], v[122:123], s[48:49]
    v_cvt_pk_bf16_f32 v124, v120, v121
    v_cvt_pk_bf16_f32 v125, v122, v123
    s_nop 1
    v_permlane16_swap_b32 v124, v125
    v_lshlrev_b32 v120, 16, v124
    v_and_b32 v121, 0xffff0000, v124
    v_lshlrev_b32 v122, 16, v125
    v_and_b32 v123, 0xffff0000, v125
    v_max3_f32 v126, v120, v121, v122
    v_max_f32 v126, v126, v123
    v_mov_b32 v127, v126
    s_nop 1
    v_permlane32_swap_b32 v126, v127
    v_max_f32 v126, v126, v127
    v_mul_f32 v126, s46, v126
    v_pk_fma_f32 v[120:121], v[120:121], s[46:47], v[126:127] op_sel_hi:[1,1,0] neg_lo:[0,0,1] neg_hi:[0,0,1]
    v_pk_fma_f32 v[122:123], v[122:123], s[46:47], v[126:127] op_sel_hi:[1,1,0] neg_lo:[0,0,1] neg_hi:[0,0,1]
    v_exp_f32 v120, v120
    v_exp_f32 v121, v121
    v_exp_f32 v122, v122
    v_exp_f32 v123, v123
    s_nop 0
    v_pk_add_f32 v[128:129], v[120:121], v[122:123]
    v_add_f32 v128, v128, v129
    v_mov_b32 v129, v128
    s_nop 1
    v_permlane32_swap_b32 v128, v129
    v_add_f32 v128, v128, v129
    v_rcp_f32 v128, v128
    s_waitcnt lgkmcnt(0)
    v_pk_mul_f32 v[120:121], v[120:121], v[128:129] op_sel_hi:[1,0]
    v_pk_mul_f32 v[122:123], v[122:123], v[128:129] op_sel_hi:[1,0]
    v_cvt_pk_bf16_f32 v124, v120, v121
    v_cvt_pk_bf16_f32 v125, v122, v123
    s_nop 1
    v_permlane16_swap_b32 v124, v125
    v_perm_b32 v100, v124, v124, v40
    v_perm_b32 v101, v124, v124, v41
    v_perm_b32 v102, v124, v124, v42
    v_perm_b32 v103, v124, v124, v43
    v_perm_b32 v104, v125, v125, v40
    v_perm_b32 v105, v125, v125, v41
    v_perm_b32 v106, v125, v125, v42
    v_perm_b32 v107, v125, v125, v43
    v_mfma_f32_16x16x32_bf16 v[108:111], v[68:71], v[100:103], 0
    v_mfma_f32_16x16x32_bf16 v[116:119], v[76:79], v[100:103], 0
    v_mfma_f32_16x16x32_bf16 v[112:115], v[72:75], v[104:107], 0
    v_mfma_f32_16x16x32_bf16 v[116:119], v[80:83], v[104:107], v[116:119]
    s_nop 4
    v_cvt_pk_bf16_f32 v132, v108, v109
    v_cvt_pk_bf16_f32 v133, v110, v111
    v_cvt_pk_bf16_f32 v134, v112, v113
    v_cvt_pk_bf16_f32 v135, v114, v115
    buffer_store_dwordx4 v[132:135], v15, s[20:23], s50 offen sc1
    v_cvt_pk_bf16_f32 v126, v116, v117
    v_cvt_pk_bf16_f32 v127, v118, v119
    buffer_store_dwordx2 v[126:127], v16, s[20:23], s50 offen sc1
    s_cmp_eq_u32 s34, -1
    s_cbranch_scc1 K_NOFL
    s_cmp_lg_u32 s30, 6
    s_cbranch_scc1 K_NOFL
    s_waitcnt vmcnt(12)
    v_and_b32 v4, 7, v1
    v_lshlrev_b32 v4, 2, v4
    s_mov_b32 s3, 131072
K_ZPOLL2:
    v_cmp_eq_u32 vcc, 0, v7
    s_cbranch_vccz K_ZOK2
    s_sub_u32 s3, s3, 1
    s_cbranch_scc1 K_ZOK2
    global_load_dword v7, v4, s[8:9] offset:192 sc1
    s_waitcnt vmcnt(0)
    s_branch K_ZPOLL2
K_ZOK2:
    v_and_b32 v2, 1, v1
    v_lshl_add_u32 v2, v2, 2, s42
    global_load_dword v7, v2, s[10:11] offset:128 sc1
    s_branch K_NOFL
K_FLAG:
    s_waitcnt vmcnt(0)
    v_and_b32 v4, 7, v1
    v_lshlrev_b32 v4, 2, v4
    s_mov_b32 s3, 131072
K_ZPOLL0:
    v_cmp_eq_u32 vcc, 0, v7
    s_cbranch_vccz K_ZOK0
    s_sub_u32 s3, s3, 1
    s_cbranch_scc1 K_ZOK0
    global_load_dword v7, v4, s[8:9] offset:192 sc1
    s_waitcnt vmcnt(0)
    s_branch K_ZPOLL0
K_ZOK0:
    v_mov_b32 v3, 1
    s_mov_b32 exec_lo, s36
    s_mov_b32 exec_hi, 0
    s_setprio 3
    s_barrier
    global_store_dword v18, v3, s[10:11] sc1
    s_setprio 0
    s_mov_b64 exec, -1
    s_branch K_FLAGGED
K_NOFL:
    s_waitcnt vmcnt(0)
    s_barrier
K_FLAGGED:
    s_cmp_eq_u32 s34, -1
    s_cbranch_scc1 K_END
    s_cmp_ge_u32 s30, 6
    s_cbranch_scc1 K_P2_HELP
    s_sub_u32 s44, s30, 4
    s_lshl_b32 s50, s44, 2
    s_lshr_b32 s50, 0x6431, s50
    s_and_b32 s50, s50, 7
    s_mul_i32 s50, s50, 51200
    s_mul_i32 s51, s44, 5120
    s_add_u32 s3, s50, 0
    s_add_u32 m0, s51, 40960
    s_waitcnt vmcnt(13)
    buffer_load_dwordx4 v17, s[24:27], s3 offen lds
    s_add_u32 s3, s50, 10240
    s_add_u32 m0, s51, 41984
    s_waitcnt vmcnt(13)
    buffer_load_dwordx4 v17, s[24:27], s3 offen lds
    s_add_u32 s3, s50, 20480
    s_add_u32 m0, s51, 43008
    s_waitcnt vmcnt(13)
    buffer_load_dwordx4 v17, s[24:27], s3 offen lds
    s_add_u32 s3, s50, 30720
    s_add_u32 m0, s51, 44032
    s_waitcnt vmcnt(13)
    buffer_load_dwordx4 v17, s[24:27], s3 offen lds
    s_add_u32 s3, s50, 40960
    s_add_u32 m0, s51, 45056
    s_waitcnt vmcnt(13)
    buffer_load_dwordx4 v17, s[24:27], s3 offen lds
    s_add_u32 s3, s50, 409600
    s_add_u32 m0, s51, 61440
    s_waitcnt vmcnt(13)
    buffer_load_dwordx4 v17, s[24:27], s3 offen lds
    s_add_u32 s3, s50, 419840
    s_add_u32 m0, s51, 62464
    s_waitcnt vmcnt(13)
    buffer_load_dwordx4 v17, s[24:27], s3 offen lds
    s_add_u32 s3, s50, 430080
    s_add_u32 m0, s51, 63488
    s_waitcnt vmcnt(13)
    buffer_load_dwordx4 v17, s[24:27], s3 offen lds
    s_add_u32 s3, s50, 440320
    s_add_u32 m0, s51, 64512
    s_waitcnt vmcnt(13)
    buffer_load_dwordx4 v17, s[24:27], s3 offen lds
    s_add_u32 s3, s50, 450560
    s_add_u32 m0, s51, 65536
    s_waitcnt vmcnt(13)
    buffer_load_dwordx4 v17, s[24:27], s3 offen lds
    s_add_u32 s44, s44, 2
    s_lshl_b32 s50, s44, 2
    s_lshr_b32 s50, 0x6431, s50
    s_and_b32 s50, s50, 7
    s_mul_i32 s50, s50, 51200
    s_mul_i32 s51, s44, 5120
    s_add_u32 s3, s50, 0
    s_add_u32 m0, s51, 40960
    s_waitcnt vmcnt(13)
    buffer_load_dwordx4 v17, s[24:27], s3 offen lds
    s_add_u32 s3, s50, 10240
    s_add_u32 m0, s51, 41984
    s_waitcnt vmcnt(13)
    buffer_load_dwordx4 v17, s[24:27], s3 offen lds
    s_add_u32 s3, s50, 20480
    s_add_u32 m0, s51, 43008
    s_waitcnt vmcnt(13)
    buffer_load_dwordx4 v17, s[24:27], s3 offen lds
    s_add_u32 s3, s50, 30720
    s_add_u32 m0, s51, 44032
    s_waitcnt vmcnt(13)
    buffer_load_dwordx4 v17, s[24:27], s3 offen lds
    s_add_u32 s3, s50, 40960
    s_add_u32 m0, s51, 45056
    s_waitcnt vmcnt(13)
    buffer_load_dwordx4 v17, s[24:27], s3 offen lds
    s_add_u32 s3, s50, 409600
    s_add_u32 m0, s51, 61440
    s_waitcnt vmcnt(13)
    buffer_load_dwordx4 v17, s[24:27], s3 offen lds
    s_add_u32 s3, s50, 419840
    s_add_u32 m0, s51, 62464
    s_waitcnt vmcnt(13)
    buffer_load_dwordx4 v17, s[24:27], s3 offen lds
    s_add_u32 s3, s50, 430080
    s_add_u32 m0, s51, 63488
    s_waitcnt vmcnt(13)
    buffer_load_dwordx4 v17, s[24:27], s3 offen lds
    s_add_u32 s3, s50, 440320
    s_add_u32 m0, s51, 64512
    s_waitcnt vmcnt(13)
    buffer_load_dwordx4 v17, s[24:27], s3 offen lds
    s_add_u32 s3, s50, 450560
    s_add_u32 m0, s51, 65536
    s_waitcnt vmcnt(13)
    buffer_load_dwordx4 v17, s[24:27], s3 offen lds
    v_mov_b32 v2, 158720
    v_mov_b32 v3, 2
    s_waitcnt vmcnt(0)
    s_mov_b64 exec, 1
    ds_add_u32 v2, v3 offset:44
    s_mov_b64 exec, -1
    s_branch K_P2_HELP
WP_early:
    s_setpc_b64 s[38:39]
K_P2_EARLY:
    s_lshl_b32 s54, s40, 7
    v_lshrrev_b32 v8, 3, v1
    v_lshrrev_b32 v9, 4, v1
    v_mov_b32 v15, 158720
    s_lshl_b32 s53, s40, 3
    s_add_u32 s53, s53, s30
    s_mul_i32 s3, s53, 20480
    s_lshl_b32 s33, s41, 7
    s_add_u32 s3, s3, s33
    v_and_b32 v2, 7, v1
    v_lshlrev_b32 v2, 4, v2
    v_mul_u32_u24 v4, 1280, v8
    v_add3_u32 v10, v2, v4, s3
    s_lshl_b32 s3, s53, 6
    v_lshl_add_u32 v11, v8, 2, s3
    s_mov_b32 s55, 10240
    s_add_u32 s20, s10, 0x100000
    s_addc_u32 s21, s11, 0
    s_mov_b32 s22, 0x280000
    s_mov_b32 s23, 0x20000
    s_add_u32 s16, s10, 0x1000
    s_addc_u32 s17, s11, 0
    s_mov_b32 s18, 0x2000
    s_mov_b32 s19, 0x20000
    s_mov_b32 s48, s6
    s_mov_b32 s49, s7
    s_mov_b32 s50, 0x280000
    s_mov_b32 s51, 0x20000
    v_mul_u32_u24 v3, 144, v8
    v_add_u32 v3, v2, v3
    s_mul_i32 s3, s30, 2304
    s_add_u32 s3, s3, 140288
    v_add_u32 v14, s3, v3
    v_bfe_u32 v50, v1, 2, 2
    v_and_b32 v51, 3, v1
    s_add_u32 s3, s53, s30
    s_mul_i32 s3, s3, 20480
    v_lshl_add_u32 v54, v1, 4, s3
    v_add_u32 v55, 20480, v54
    v_lshl_add_u32 v2, v9, 2, v50
    v_bfe_u32 v3, v2, 1, 2
    v_lshlrev_b32 v2, 7, v2
    v_lshl_add_u32 v2, v51, 3, v2
    v_xor_b32 v4, 0, v3
    v_lshl_add_u32 v56, v4, 5, v2
    v_add_u32 v60, 40960, v56
    v_xor_b32 v4, 1, v3
    v_lshl_add_u32 v57, v4, 5, v2
    v_add_u32 v61, 40960, v57
    v_xor_b32 v4, 2, v3
    v_lshl_add_u32 v58, v4, 5, v2
    v_add_u32 v62, 40960, v58
    v_xor_b32 v4, 3, v3
    v_lshl_add_u32 v59, v4, 5, v2
    v_add_u32 v63, 40960, v59
    v_lshrrev_b32 v3, 1, v50
    v_mul_u32_u24 v2, 40, v9
    v_add3_u32 v2, v2, 16, v50
    v_lshlrev_b32 v2, 7, v2
    v_lshl_add_u32 v2, v51, 3, v2
    v_xor_b32 v4, 0, v3
    v_lshl_add_u32 v64, v4, 5, v2
    v_xor_b32 v4, 1, v3
    v_lshl_add_u32 v65, v4, 5, v2
    v_xor_b32 v4, 2, v3
    v_lshl_add_u32 v66, v4, 5, v2
    v_xor_b32 v4, 3, v3
    v_lshl_add_u32 v67, v4, 5, v2
    v_and_b32 v2, 15, v1
    v_mul_u32_u24 v2, 144, v2
    v_lshl_add_u32 v2, v9, 3, v2
    s_mul_i32 s3, s30, 4608
    s_add_u32 s3, s3, 140288
    v_add_u32 v52, s3, v2
    s_mov_b32 s67, 0
    s_mov_b32 s68, 4096
    s_mov_b32 s69, 8192
    s_mov_b32 s70, 12288
    s_mov_b32 s71, 16384
    s_waitcnt vmcnt(0)
    s_barrier
K_P2_GEMM:
    s_setprio 2
    s_lshl_b32 s3, s40, 3
    s_mul_i32 s33, s3, 187
    s_lshr_b32 s33, s33, 11
    s_add_u32 s33, s33, 1
    s_mul_i32 s33, s33, 11
    s_add_u32 s3, s53, s30
    s_cmp_ge_u32 s3, s33
    s_cselect_b32 s59, 16, 0
    s_add_u32 s3, s3, 1
    s_cmp_ge_u32 s3, s33
    s_cselect_b32 s61, 16, 0
    s_mov_b32 s58, 0
    ds_read_b64_tr_b16 v[148:149], v56 offset:0
    ds_read_b64_tr_b16 v[150:151], v58 offset:2560
    ds_read_b64_tr_b16 v[152:153], v57 offset:0
    ds_read_b64_tr_b16 v[154:155], v59 offset:2560
    ds_read_b64_tr_b16 v[156:157], v58 offset:0
    ds_read_b64_tr_b16 v[158:159], v56 offset:2560
    ds_read_b64_tr_b16 v[160:161], v59 offset:0
    ds_read_b64_tr_b16 v[162:163], v57 offset:2560
    ds_read_b64_tr_b16 v[164:165], v56 offset:20480
    ds_read_b64_tr_b16 v[166:167], v58 offset:23040
    ds_read_b64_tr_b16 v[168:169], v57 offset:20480
    ds_read_b64_tr_b16 v[170:171], v59 offset:23040
    ds_read_b64_tr_b16 v[172:173], v58 offset:20480
    ds_read_b64_tr_b16 v[174:175], v56 offset:23040
    ds_read_b64_tr_b16 v[176:177], v59 offset:20480
    ds_read_b64_tr_b16 v[178:179], v57 offset:23040
    ds_read_b64_tr_b16 v[180:181], v56 offset:5120
    ds_read_b64_tr_b16 v[182:183], v58 offset:7680
    ds_read_b64_tr_b16 v[184:185], v57 offset:5120
    ds_read_b64_tr_b16 v[186:187], v59 offset:7680
    ds_read_b64_tr_b16 v[188:189], v58 offset:5120
    ds_read_b64_tr_b16 v[190:191], v56 offset:7680
    ds_read_b64_tr_b16 v[192:193], v59 offset:5120
    ds_read_b64_tr_b16 v[194:195], v57 offset:7680
    s_branch WS_p2g
.p2align 12
WP_p2g:
    s_setpc_b64 s[38:39]
WS_p2g:
    s_andn2_b32 s33, 1, s58
    s_cbranch_scc1 K_SP0
K_SPR0:
    buffer_load_dwordx4 v[68:71], v54, s[20:23], s67 offen offset:0 sc1
    buffer_load_dwordx4 v[72:75], v55, s[20:23], s67 offen offset:0 sc1
    s_andn2_b32 s33, 16, s58
    s_cbranch_scc1 K_SP1
K_SPR1:
    buffer_load_dwordx4 v[76:79], v54, s[20:23], s68 offen offset:0 sc1
    buffer_load_dwordx4 v[80:83], v55, s[20:23], s68 offen offset:0 sc1
    s_andn2_b32 s33, 2, s58
    s_cbranch_scc1 K_SP2
K_SPR2:
    buffer_load_dwordx4 v[84:87], v54, s[20:23], s67 offen offset:1024 sc1
    buffer_load_dwordx4 v[88:91], v55, s[20:23], s67 offen offset:1024 sc1
    s_andn2_b32 s33, 32, s58
    s_cbranch_scc1 K_SP3
K_SPR3:
    buffer_load_dwordx4 v[92:95], v54, s[20:23], s68 offen offset:1024 sc1
    buffer_load_dwordx4 v[96:99], v55, s[20:23], s68 offen offset:1024 sc1
    s_andn2_b32 s33, 4, s58
    s_cbranch_scc1 K_SP4
K_SPR4:
    buffer_load_dwordx4 v[100:103], v54, s[20:23], s67 offen offset:2048 sc1
    buffer_load_dwordx4 v[104:107], v55, s[20:23], s67 offen offset:2048 sc1
    ds_read_b64_tr_b16 v[196:197], v56 offset:25600
    ds_read_b64_tr_b16 v[198:199], v58 offset:28160
    ds_read_b64_tr_b16 v[200:201], v57 offset:25600
    ds_read_b64_tr_b16 v[202:203], v59 offset:28160
    ds_read_b64_tr_b16 v[204:205], v58 offset:25600
    ds_read_b64_tr_b16 v[206:207], v56 offset:28160
    ds_read_b64_tr_b16 v[208:209], v59 offset:25600
    ds_read_b64_tr_b16 v[210:211], v57 offset:28160
    ds_read_b64_tr_b16 v[212:213], v56 offset:10240
    ds_read_b64_tr_b16 v[214:215], v58 offset:12800
    ds_read_b64_tr_b16 v[216:217], v57 offset:10240
    ds_read_b64_tr_b16 v[218:219], v59 offset:12800
    ds_read_b64_tr_b16 v[220:221], v58 offset:10240
    ds_read_b64_tr_b16 v[222:223], v56 offset:12800
    ds_read_b64_tr_b16 v[224:225], v59 offset:10240
    ds_read_b64_tr_b16 v[226:227], v57 offset:12800
    s_waitcnt vmcnt(8)
    s_waitcnt lgkmcnt(15)
    v_mfma_f32_16x16x32_bf16 v[116:119], v[148:151], v[68:71], 0
    v_mfma_f32_16x16x32_bf16 v[132:135], v[148:151], v[72:75], 0
    v_mfma_f32_16x16x32_bf16 v[120:123], v[152:155], v[68:71], 0
    v_mfma_f32_16x16x32_bf16 v[136:139], v[152:155], v[72:75], 0
    v_mfma_f32_16x16x32_bf16 v[124:127], v[156:159], v[68:71], 0
    v_mfma_f32_16x16x32_bf16 v[140:143], v[156:159], v[72:75], 0
    v_mfma_f32_16x16x32_bf16 v[128:131], v[160:163], v[68:71], 0
    v_mfma_f32_16x16x32_bf16 v[144:147], v[160:163], v[72:75], 0
    s_andn2_b32 s33, 64, s58
    s_cbranch_scc1 K_SP5
K_SPR5:
    buffer_load_dwordx4 v[108:111], v54, s[20:23], s68 offen offset:2048 sc1
    buffer_load_dwordx4 v[112:115], v55, s[20:23], s68 offen offset:2048 sc1
    s_waitcnt vmcnt(8)
    v_mfma_f32_16x16x32_bf16 v[116:119], v[164:167], v[76:79], v[116:119]
    ds_read_b64_tr_b16 v[148:149], v56 offset:30720
    v_mfma_f32_16x16x32_bf16 v[132:135], v[164:167], v[80:83], v[132:135]
    ds_read_b64_tr_b16 v[150:151], v58 offset:33280
    v_mfma_f32_16x16x32_bf16 v[120:123], v[168:171], v[76:79], v[120:123]
    ds_read_b64_tr_b16 v[152:153], v57 offset:30720
    v_mfma_f32_16x16x32_bf16 v[136:139], v[168:171], v[80:83], v[136:139]
    ds_read_b64_tr_b16 v[154:155], v59 offset:33280
    v_mfma_f32_16x16x32_bf16 v[124:127], v[172:175], v[76:79], v[124:127]
    ds_read_b64_tr_b16 v[156:157], v58 offset:30720
    v_mfma_f32_16x16x32_bf16 v[140:143], v[172:175], v[80:83], v[140:143]
    ds_read_b64_tr_b16 v[158:159], v56 offset:33280
    v_mfma_f32_16x16x32_bf16 v[128:131], v[176:179], v[76:79], v[128:131]
    ds_read_b64_tr_b16 v[160:161], v59 offset:30720
    v_mfma_f32_16x16x32_bf16 v[144:147], v[176:179], v[80:83], v[144:147]
    ds_read_b64_tr_b16 v[162:163], v57 offset:33280
    s_andn2_b32 s33, 8, s58
    s_cbranch_scc1 K_SP6
K_SPR6:
    buffer_load_dwordx4 v[68:71], v54, s[20:23], s67 offen offset:3072 sc1
    buffer_load_dwordx4 v[72:75], v55, s[20:23], s67 offen offset:3072 sc1
    s_waitcnt vmcnt(8)
    v_mfma_f32_16x16x32_bf16 v[116:119], v[180:183], v[84:87], v[116:119]
    ds_read_b64_tr_b16 v[164:165], v56 offset:15360
    v_mfma_f32_16x16x32_bf16 v[132:135], v[180:183], v[88:91], v[132:135]
    ds_read_b64_tr_b16 v[166:167], v58 offset:17920
    v_mfma_f32_16x16x32_bf16 v[120:123], v[184:187], v[84:87], v[120:123]
    ds_read_b64_tr_b16 v[168:169], v57 offset:15360
    v_mfma_f32_16x16x32_bf16 v[136:139], v[184:187], v[88:91], v[136:139]
    ds_read_b64_tr_b16 v[170:171], v59 offset:17920
    v_mfma_f32_16x16x32_bf16 v[124:127], v[188:191], v[84:87], v[124:127]
    ds_read_b64_tr_b16 v[172:173], v58 offset:15360
    v_mfma_f32_16x16x32_bf16 v[140:143], v[188:191], v[88:91], v[140:143]
    ds_read_b64_tr_b16 v[174:175], v56 offset:17920
    v_mfma_f32_16x16x32_bf16 v[128:131], v[192:195], v[84:87], v[128:131]
    ds_read_b64_tr_b16 v[176:177], v59 offset:15360
    v_mfma_f32_16x16x32_bf16 v[144:147], v[192:195], v[88:91], v[144:147]
    ds_read_b64_tr_b16 v[178:179], v57 offset:17920
    s_andn2_b32 s33, 128, s58
    s_cbranch_scc1 K_SP7
K_SPR7:
    buffer_load_dwordx4 v[76:79], v54, s[20:23], s68 offen offset:3072 sc1
    buffer_load_dwordx4 v[80:83], v55, s[20:23], s68 offen offset:3072 sc1
    s_waitcnt vmcnt(8)
    s_waitcnt lgkmcnt(15)
    v_mfma_f32_16x16x32_bf16 v[116:119], v[196:199], v[92:95], v[116:119]
    ds_read_b64_tr_b16 v[180:181], v56 offset:35840
    v_mfma_f32_16x16x32_bf16 v[132:135], v[196:199], v[96:99], v[132:135]
    ds_read_b64_tr_b16 v[182:183], v58 offset:38400
    v_mfma_f32_16x16x32_bf16 v[120:123], v[200:203], v[92:95], v[120:123]
    ds_read_b64_tr_b16 v[184:185], v57 offset:35840
    v_mfma_f32_16x16x32_bf16 v[136:139], v[200:203], v[96:99], v[136:139]
    ds_read_b64_tr_b16 v[186:187], v59 offset:38400
    v_mfma_f32_16x16x32_bf16 v[124:127], v[204:207], v[92:95], v[124:127]
    ds_read_b64_tr_b16 v[188:189], v58 offset:35840
    v_mfma_f32_16x16x32_bf16 v[140:143], v[204:207], v[96:99], v[140:143]
    ds_read_b64_tr_b16 v[190:191], v56 offset:38400
    v_mfma_f32_16x16x32_bf16 v[128:131], v[208:211], v[92:95], v[128:131]
    ds_read_b64_tr_b16 v[192:193], v59 offset:35840
    v_mfma_f32_16x16x32_bf16 v[144:147], v[208:211], v[96:99], v[144:147]
    ds_read_b64_tr_b16 v[194:195], v57 offset:38400
    s_andn2_b32 s33, 15, s58
    s_cbranch_scc1 K_SP8
K_SPR8:
    buffer_load_dwordx4 v[84:87], v54, s[20:23], s71 offen offset:0 sc1
    buffer_load_dwordx4 v[88:91], v55, s[20:23], s71 offen offset:0 sc1
    s_waitcnt vmcnt(8)
    v_mfma_f32_16x16x32_bf16 v[116:119], v[212:215], v[100:103], v[116:119]
    ds_read_b64_tr_b16 v[196:197], v64 offset:0
    v_mfma_f32_16x16x32_bf16 v[132:135], v[212:215], v[104:107], v[132:135]
    ds_read_b64_tr_b16 v[198:199], v66 offset:2560
    v_mfma_f32_16x16x32_bf16 v[120:123], v[216:219], v[100:103], v[120:123]
    ds_read_b64_tr_b16 v[200:201], v65 offset:0
    v_mfma_f32_16x16x32_bf16 v[136:139], v[216:219], v[104:107], v[136:139]
    ds_read_b64_tr_b16 v[202:203], v67 offset:2560
    v_mfma_f32_16x16x32_bf16 v[124:127], v[220:223], v[100:103], v[124:127]
    ds_read_b64_tr_b16 v[204:205], v66 offset:0
    v_mfma_f32_16x16x32_bf16 v[140:143], v[220:223], v[104:107], v[140:143]
    ds_read_b64_tr_b16 v[206:207], v64 offset:2560
    v_mfma_f32_16x16x32_bf16 v[128:131], v[224:227], v[100:103], v[128:131]
    ds_read_b64_tr_b16 v[208:209], v67 offset:0
    v_mfma_f32_16x16x32_bf16 v[144:147], v[224:227], v[104:107], v[144:147]
    ds_read_b64_tr_b16 v[210:211], v65 offset:2560
    s_andn2_b32 s33, 240, s58
    s_cbranch_scc1 K_SP9
K_SPR9:
    buffer_load_dwordx4 v[92:95], v54, s[20:23], s71 offen offset:1024 sc1
    buffer_load_dwordx4 v[96:99], v55, s[20:23], s71 offen offset:1024 sc1
    s_waitcnt vmcnt(8)
    s_waitcnt lgkmcnt(15)
    v_mfma_f32_16x16x32_bf16 v[116:119], v[148:151], v[108:111], v[116:119]
    ds_read_b64_tr_b16 v[212:213], v64 offset:20480
    v_mfma_f32_16x16x32_bf16 v[132:135], v[148:151], v[112:115], v[132:135]
    ds_read_b64_tr_b16 v[214:215], v66 offset:23040
    v_mfma_f32_16x16x32_bf16 v[120:123], v[152:155], v[108:111], v[120:123]
    ds_read_b64_tr_b16 v[216:217], v65 offset:20480
    v_mfma_f32_16x16x32_bf16 v[136:139], v[152:155], v[112:115], v[136:139]
    ds_read_b64_tr_b16 v[218:219], v67 offset:23040
    v_mfma_f32_16x16x32_bf16 v[124:127], v[156:159], v[108:111], v[124:127]
    ds_read_b64_tr_b16 v[220:221], v66 offset:20480
    v_mfma_f32_16x16x32_bf16 v[140:143], v[156:159], v[112:115], v[140:143]
    ds_read_b64_tr_b16 v[222:223], v64 offset:23040
    v_mfma_f32_16x16x32_bf16 v[128:131], v[160:163], v[108:111], v[128:131]
    ds_read_b64_tr_b16 v[224:225], v67 offset:20480
    v_mfma_f32_16x16x32_bf16 v[144:147], v[160:163], v[112:115], v[144:147]
    ds_read_b64_tr_b16 v[226:227], v65 offset:23040
    s_andn2_b32 s33, 256, s58
    s_cbranch_scc1 K_SP10
K_SPR10:
    buffer_load_dwordx4 v[100:103], v54, s[20:23], s69 offen offset:0 sc1
    buffer_load_dwordx4 v[104:107], v55, s[20:23], s69 offen offset:0 sc1
    s_mov_b32 s3, 1048576
K_P2_GS:
    ds_read_b32 v2, v15 offset:40
    s_sub_u32 s3, s3, 1
    s_waitcnt lgkmcnt(0)
    v_readfirstlane_b32 s33, v2
    s_nop 3
    s_cselect_b32 s33, 1, s33
    s_cmp_lt_u32 s33, 1
    s_cbranch_scc1 K_P2_GS
    buffer_load_dwordx4 v[16:19], v10, s[12:15], 0 offen
    buffer_load_dwordx4 v[20:23], v10, s[12:15], s55 offen
    buffer_load_dword v24, v11, s[16:19], 0 offen sc1
    buffer_load_dword v25, v11, s[16:19], 0 offen offset:32 sc1
    ds_read_b128 v[28:31], v15
    s_mov_b32 s3, 1048576
K_P2_GW:
    ds_read_b32 v2, v15 offset:44
    s_sub_u32 s3, s3, 1
    s_waitcnt lgkmcnt(0)
    v_readfirstlane_b32 s33, v2
    s_nop 3
    s_cselect_b32 s33, 4, s33
    s_cmp_lt_u32 s33, 4
    s_cbranch_scc1 K_P2_GW
    s_waitcnt vmcnt(12)
    v_mfma_f32_16x16x32_bf16 v[116:119], v[164:167], v[68:71], v[116:119]
    ds_read_b64_tr_b16 v[148:149], v60 offset:0
    v_mfma_f32_16x16x32_bf16 v[132:135], v[164:167], v[72:75], v[132:135]
    ds_read_b64_tr_b16 v[150:151], v62 offset:2560
    v_mfma_f32_16x16x32_bf16 v[120:123], v[168:171], v[68:71], v[120:123]
    ds_read_b64_tr_b16 v[152:153], v61 offset:0
    v_mfma_f32_16x16x32_bf16 v[136:139], v[168:171], v[72:75], v[136:139]
    ds_read_b64_tr_b16 v[154:155], v63 offset:2560
    v_mfma_f32_16x16x32_bf16 v[124:127], v[172:175], v[68:71], v[124:127]
    ds_read_b64_tr_b16 v[156:157], v62 offset:0
    v_mfma_f32_16x16x32_bf16 v[140:143], v[172:175], v[72:75], v[140:143]
    ds_read_b64_tr_b16 v[158:159], v60 offset:2560
    v_mfma_f32_16x16x32_bf16 v[128:131], v[176:179], v[68:71], v[128:131]
    ds_read_b64_tr_b16 v[160:161], v63 offset:0
    v_mfma_f32_16x16x32_bf16 v[144:147], v[176:179], v[72:75], v[144:147]
    ds_read_b64_tr_b16 v[162:163], v61 offset:2560
    s_andn2_b32 s33, 4096, s58
    s_cbranch_scc1 K_SP11
K_SPR11:
    buffer_load_dwordx4 v[108:111], v54, s[20:23], s70 offen offset:0 sc1
    buffer_load_dwordx4 v[112:115], v55, s[20:23], s70 offen offset:0 sc1
    s_waitcnt vmcnt(12)
    v_mfma_f32_16x16x32_bf16 v[116:119], v[180:183], v[76:79], v[116:119]
    ds_read_b64_tr_b16 v[164:165], v60 offset:20480
    v_mfma_f32_16x16x32_bf16 v[132:135], v[180:183], v[80:83], v[132:135]
    ds_read_b64_tr_b16 v[166:167], v62 offset:23040
    v_mfma_f32_16x16x32_bf16 v[120:123], v[184:187], v[76:79], v[120:123]
    ds_read_b64_tr_b16 v[168:169], v61 offset:20480
    v_mfma_f32_16x16x32_bf16 v[136:139], v[184:187], v[80:83], v[136:139]
    ds_read_b64_tr_b16 v[170:171], v63 offset:23040
    v_mfma_f32_16x16x32_bf16 v[124:127], v[188:191], v[76:79], v[124:127]
    ds_read_b64_tr_b16 v[172:173], v62 offset:20480
    v_mfma_f32_16x16x32_bf16 v[140:143], v[188:191], v[80:83], v[140:143]
    ds_read_b64_tr_b16 v[174:175], v60 offset:23040
    v_mfma_f32_16x16x32_bf16 v[128:131], v[192:195], v[76:79], v[128:131]
    ds_read_b64_tr_b16 v[176:177], v63 offset:20480
    v_mfma_f32_16x16x32_bf16 v[144:147], v[192:195], v[80:83], v[144:147]
    ds_read_b64_tr_b16 v[178:179], v61 offset:23040
    s_andn2_b32 s33, 512, s58
    s_cbranch_scc1 K_SP12
K_SPR12:
    buffer_load_dwordx4 v[68:71], v54, s[20:23], s69 offen offset:1024 sc1
    buffer_load_dwordx4 v[72:75], v55, s[20:23], s69 offen offset:1024 sc1
    s_waitcnt vmcnt(12)
    v_mfma_f32_16x16x32_bf16 v[116:119], v[196:199], v[84:87], v[116:119]
    ds_read_b64_tr_b16 v[180:181], v60 offset:5120
    v_mfma_f32_16x16x32_bf16 v[132:135], v[196:199], v[88:91], v[132:135]
    ds_read_b64_tr_b16 v[182:183], v62 offset:7680
    v_mfma_f32_16x16x32_bf16 v[120:123], v[200:203], v[84:87], v[120:123]
    ds_read_b64_tr_b16 v[184:185], v61 offset:5120
    v_mfma_f32_16x16x32_bf16 v[136:139], v[200:203], v[88:91], v[136:139]
    ds_read_b64_tr_b16 v[186:187], v63 offset:7680
    v_mfma_f32_16x16x32_bf16 v[124:127], v[204:207], v[84:87], v[124:127]
    ds_read_b64_tr_b16 v[188:189], v62 offset:5120
    v_mfma_f32_16x16x32_bf16 v[140:143], v[204:207], v[88:91], v[140:143]
    ds_read_b64_tr_b16 v[190:191], v60 offset:7680
    v_mfma_f32_16x16x32_bf16 v[128:131], v[208:211], v[84:87], v[128:131]
    ds_read_b64_tr_b16 v[192:193], v63 offset:5120
    v_mfma_f32_16x16x32_bf16 v[144:147], v[208:211], v[88:91], v[144:147]
    ds_read_b64_tr_b16 v[194:195], v61 offset:7680
    s_andn2_b32 s33, 8192, s58
    s_cbranch_scc1 K_SP13
K_SPR13:
    buffer_load_dwordx4 v[76:79], v54, s[20:23], s70 offen offset:1024 sc1
    buffer_load_dwordx4 v[80:83], v55, s[20:23], s70 offen offset:1024 sc1
    s_waitcnt vmcnt(12)
    v_mfma_f32_16x16x32_bf16 v[116:119], v[212:215], v[92:95], v[116:119]
    ds_read_b64_tr_b16 v[196:197], v60 offset:25600
    v_mfma_f32_16x16x32_bf16 v[132:135], v[212:215], v[96:99], v[132:135]
    ds_read_b64_tr_b16 v[198:199], v62 offset:28160
    v_mfma_f32_16x16x32_bf16 v[120:123], v[216:219], v[92:95], v[120:123]
    ds_read_b64_tr_b16 v[200:201], v61 offset:25600
    v_mfma_f32_16x16x32_bf16 v[136:139], v[216:219], v[96:99], v[136:139]
    ds_read_b64_tr_b16 v[202:203], v63 offset:28160
    v_mfma_f32_16x16x32_bf16 v[124:127], v[220:223], v[92:95], v[124:127]
    ds_read_b64_tr_b16 v[204:205], v62 offset:25600
    v_mfma_f32_16x16x32_bf16 v[140:143], v[220:223], v[96:99], v[140:143]
    ds_read_b64_tr_b16 v[206:207], v60 offset:28160
    v_mfma_f32_16x16x32_bf16 v[128:131], v[224:227], v[92:95], v[128:131]
    ds_read_b64_tr_b16 v[208:209], v63 offset:25600
    v_mfma_f32_16x16x32_bf16 v[144:147], v[224:227], v[96:99], v[144:147]
    ds_read_b64_tr_b16 v[210:211], v61 offset:28160
    s_andn2_b32 s33, 1024, s58
    s_cbranch_scc1 K_SP14
K_SPR14:
    buffer_load_dwordx4 v[84:87], v54, s[20:23], s69 offen offset:2048 sc1
    buffer_load_dwordx4 v[88:91], v55, s[20:23], s69 offen offset:2048 sc1
    s_waitcnt vmcnt(12)
    s_waitcnt lgkmcnt(15)
    v_mfma_f32_16x16x32_bf16 v[116:119], v[148:151], v[100:103], v[116:119]
    ds_read_b64_tr_b16 v[212:213], v60 offset:10240
    v_mfma_f32_16x16x32_bf16 v[132:135], v[148:151], v[104:107], v[132:135]
    ds_read_b64_tr_b16 v[214:215], v62 offset:12800
    v_mfma_f32_16x16x32_bf16 v[120:123], v[152:155], v[100:103], v[120:123]
    ds_read_b64_tr_b16 v[216:217], v61 offset:10240
    v_mfma_f32_16x16x32_bf16 v[136:139], v[152:155], v[104:107], v[136:139]
    ds_read_b64_tr_b16 v[218:219], v63 offset:12800
    v_mfma_f32_16x16x32_bf16 v[124:127], v[156:159], v[100:103], v[124:127]
    ds_read_b64_tr_b16 v[220:221], v62 offset:10240
    v_mfma_f32_16x16x32_bf16 v[140:143], v[156:159], v[104:107], v[140:143]
    ds_read_b64_tr_b16 v[222:223], v60 offset:12800
    v_mfma_f32_16x16x32_bf16 v[128:131], v[160:163], v[100:103], v[128:131]
    ds_read_b64_tr_b16 v[224:225], v63 offset:10240
    v_mfma_f32_16x16x32_bf16 v[144:147], v[160:163], v[104:107], v[144:147]
    ds_read_b64_tr_b16 v[226:227], v61 offset:12800
    s_andn2_b32 s33, 16384, s58
    s_cbranch_scc1 K_SP15
K_SPR15:
    buffer_load_dwordx4 v[92:95], v54, s[20:23], s70 offen offset:2048 sc1
    buffer_load_dwordx4 v[96:99], v55, s[20:23], s70 offen offset:2048 sc1
    s_waitcnt vmcnt(8)
    v_mfma_f32_16x16x32_bf16 v[116:119], v[164:167], v[108:111], v[116:119]
    ds_read_b64_tr_b16 v[148:149], v60 offset:30720
    v_sub_f32 v48, 1.0, v24
    v_mfma_f32_16x16x32_bf16 v[132:135], v[164:167], v[112:115], v[132:135]
    ds_read_b64_tr_b16 v[150:151], v62 offset:33280
    v_cvt_pk_bf16_f32 v48, v48, v48
    v_mfma_f32_16x16x32_bf16 v[120:123], v[168:171], v[108:111], v[120:123]
    ds_read_b64_tr_b16 v[152:153], v61 offset:30720
    v_lshlrev_b32 v48, 16, v48
    v_mfma_f32_16x16x32_bf16 v[136:139], v[168:171], v[112:115], v[136:139]
    ds_read_b64_tr_b16 v[154:155], v63 offset:33280
    v_sub_f32 v49, 1.0, v25
    v_mfma_f32_16x16x32_bf16 v[124:127], v[172:175], v[108:111], v[124:127]
    ds_read_b64_tr_b16 v[156:157], v62 offset:30720
    v_cvt_pk_bf16_f32 v49, v49, v49
    v_mfma_f32_16x16x32_bf16 v[140:143], v[172:175], v[112:115], v[140:143]
    ds_read_b64_tr_b16 v[158:159], v60 offset:33280
    v_lshlrev_b32 v49, 16, v49
    v_mfma_f32_16x16x32_bf16 v[128:131], v[176:179], v[108:111], v[128:131]
    ds_read_b64_tr_b16 v[160:161], v63 offset:30720
    v_lshlrev_b32 v32, 16, v16
    v_mfma_f32_16x16x32_bf16 v[144:147], v[176:179], v[112:115], v[144:147]
    ds_read_b64_tr_b16 v[162:163], v61 offset:33280
    v_and_b32 v33, 0xffff0000, v16
    s_andn2_b32 s33, 2048, s58
    s_cbranch_scc1 K_SP16
K_SPR16:
    buffer_load_dwordx4 v[100:103], v54, s[20:23], s69 offen offset:3072 sc1
    buffer_load_dwordx4 v[104:107], v55, s[20:23], s69 offen offset:3072 sc1
    s_waitcnt vmcnt(8)
    s_waitcnt lgkmcnt(15)
    v_mfma_f32_16x16x32_bf16 v[116:119], v[180:183], v[68:71], v[116:119]
    ds_read_b64_tr_b16 v[164:165], v60 offset:15360
    v_lshlrev_b32 v34, 16, v17
    v_mfma_f32_16x16x32_bf16 v[132:135], v[180:183], v[72:75], v[132:135]
    ds_read_b64_tr_b16 v[166:167], v62 offset:17920
    v_and_b32 v35, 0xffff0000, v17
    v_mfma_f32_16x16x32_bf16 v[120:123], v[184:187], v[68:71], v[120:123]
    ds_read_b64_tr_b16 v[168:169], v61 offset:15360
    v_lshlrev_b32 v36, 16, v18
    v_mfma_f32_16x16x32_bf16 v[136:139], v[184:187], v[72:75], v[136:139]
    ds_read_b64_tr_b16 v[170:171], v63 offset:17920
    v_and_b32 v37, 0xffff0000, v18
    v_mfma_f32_16x16x32_bf16 v[124:127], v[188:191], v[68:71], v[124:127]
    ds_read_b64_tr_b16 v[172:173], v62 offset:15360
    v_lshlrev_b32 v38, 16, v19
    v_mfma_f32_16x16x32_bf16 v[140:143], v[188:191], v[72:75], v[140:143]
    ds_read_b64_tr_b16 v[174:175], v60 offset:17920
    v_and_b32 v39, 0xffff0000, v19
    v_mfma_f32_16x16x32_bf16 v[128:131], v[192:195], v[68:71], v[128:131]
    ds_read_b64_tr_b16 v[176:177], v63 offset:15360
    v_lshlrev_b32 v40, 16, v20
    v_mfma_f32_16x16x32_bf16 v[144:147], v[192:195], v[72:75], v[144:147]
    ds_read_b64_tr_b16 v[178:179], v61 offset:17920
    v_and_b32 v41, 0xffff0000, v20
    s_andn2_b32 s33, 32768, s58
    s_cbranch_scc1 K_SP17
K_SPR17:
    buffer_load_dwordx4 v[108:111], v54, s[20:23], s70 offen offset:3072 sc1
    buffer_load_dwordx4 v[112:115], v55, s[20:23], s70 offen offset:3072 sc1
    s_waitcnt vmcnt(8)
    v_mfma_f32_16x16x32_bf16 v[116:119], v[196:199], v[76:79], v[116:119]
    ds_read_b64_tr_b16 v[180:181], v60 offset:35840
    v_lshlrev_b32 v42, 16, v21
    v_mfma_f32_16x16x32_bf16 v[132:135], v[196:199], v[80:83], v[132:135]
    ds_read_b64_tr_b16 v[182:183], v62 offset:38400
    v_and_b32 v43, 0xffff0000, v21
    v_mfma_f32_16x16x32_bf16 v[120:123], v[200:203], v[76:79], v[120:123]
    ds_read_b64_tr_b16 v[184:185], v61 offset:35840
    v_lshlrev_b32 v44, 16, v22
    v_mfma_f32_16x16x32_bf16 v[136:139], v[200:203], v[80:83], v[136:139]
    ds_read_b64_tr_b16 v[186:187], v63 offset:38400
    v_and_b32 v45, 0xffff0000, v22
    v_mfma_f32_16x16x32_bf16 v[124:127], v[204:207], v[76:79], v[124:127]
    ds_read_b64_tr_b16 v[188:189], v62 offset:35840
    v_lshlrev_b32 v46, 16, v23
    v_mfma_f32_16x16x32_bf16 v[140:143], v[204:207], v[80:83], v[140:143]
    ds_read_b64_tr_b16 v[190:191], v60 offset:38400
    v_and_b32 v47, 0xffff0000, v23
    v_mfma_f32_16x16x32_bf16 v[128:131], v[208:211], v[76:79], v[128:131]
    ds_read_b64_tr_b16 v[192:193], v63 offset:35840
    v_mul_f32 v32, v32, v48
    v_mfma_f32_16x16x32_bf16 v[144:147], v[208:211], v[80:83], v[144:147]
    ds_read_b64_tr_b16 v[194:195], v61 offset:38400
    v_mul_f32 v33, v33, v48
    s_andn2_b32 s33, 3840, s58
    s_cbranch_scc1 K_SP18
K_SPR18:
    buffer_load_dwordx4 v[68:71], v54, s[20:23], s71 offen offset:2048 sc1
    buffer_load_dwordx4 v[72:75], v55, s[20:23], s71 offen offset:2048 sc1
    s_waitcnt vmcnt(8)
    s_waitcnt lgkmcnt(15)
    v_mfma_f32_16x16x32_bf16 v[116:119], v[212:215], v[84:87], v[116:119]
    ds_read_b64_tr_b16 v[196:197], v64 offset:40960
    v_mul_f32 v34, v34, v48
    v_mfma_f32_16x16x32_bf16 v[132:135], v[212:215], v[88:91], v[132:135]
    ds_read_b64_tr_b16 v[198:199], v66 offset:43520
    v_mul_f32 v35, v35, v48
    v_mfma_f32_16x16x32_bf16 v[120:123], v[216:219], v[84:87], v[120:123]
    ds_read_b64_tr_b16 v[200:201], v65 offset:40960
    v_mul_f32 v36, v36, v48
    v_mfma_f32_16x16x32_bf16 v[136:139], v[216:219], v[88:91], v[136:139]
    ds_read_b64_tr_b16 v[202:203], v67 offset:43520
    v_mul_f32 v37, v37, v48
    v_mfma_f32_16x16x32_bf16 v[124:127], v[220:223], v[84:87], v[124:127]
    ds_read_b64_tr_b16 v[204:205], v66 offset:40960
    v_mul_f32 v38, v38, v48
    v_mfma_f32_16x16x32_bf16 v[140:143], v[220:223], v[88:91], v[140:143]
    ds_read_b64_tr_b16 v[206:207], v64 offset:43520
    v_mul_f32 v39, v39, v48
    v_mfma_f32_16x16x32_bf16 v[128:131], v[224:227], v[84:87], v[128:131]
    ds_read_b64_tr_b16 v[208:209], v67 offset:40960
    v_mul_f32 v40, v40, v49
    v_mfma_f32_16x16x32_bf16 v[144:147], v[224:227], v[88:91], v[144:147]
    ds_read_b64_tr_b16 v[210:211], v65 offset:43520
    v_mul_f32 v41, v41, v49
    s_andn2_b32 s33, 61440, s58
    s_cbranch_scc1 K_SP19
K_SPR19:
    buffer_load_dwordx4 v[76:79], v54, s[20:23], s71 offen offset:3072 sc1
    buffer_load_dwordx4 v[80:83], v55, s[20:23], s71 offen offset:3072 sc1
    s_waitcnt vmcnt(8)
    v_mfma_f32_16x16x32_bf16 v[116:119], v[148:151], v[92:95], v[116:119]
    ds_read_b64_tr_b16 v[212:213], v64 offset:61440
    v_mul_f32 v42, v42, v49
    v_mfma_f32_16x16x32_bf16 v[132:135], v[148:151], v[96:99], v[132:135]
    ds_read_b64_tr_b16 v[214:215], v66 offset:64000
    v_mul_f32 v43, v43, v49
    v_mfma_f32_16x16x32_bf16 v[120:123], v[152:155], v[92:95], v[120:123]
    ds_read_b64_tr_b16 v[216:217], v65 offset:61440
    v_mul_f32 v44, v44, v49
    v_mfma_f32_16x16x32_bf16 v[136:139], v[152:155], v[96:99], v[136:139]
    ds_read_b64_tr_b16 v[218:219], v67 offset:64000
    v_mul_f32 v45, v45, v49
    v_mfma_f32_16x16x32_bf16 v[124:127], v[156:159], v[92:95], v[124:127]
    ds_read_b64_tr_b16 v[220:221], v66 offset:61440
    v_mul_f32 v46, v46, v49
    v_mfma_f32_16x16x32_bf16 v[140:143], v[156:159], v[96:99], v[140:143]
    ds_read_b64_tr_b16 v[222:223], v64 offset:64000
    v_mul_f32 v47, v47, v49
    v_mfma_f32_16x16x32_bf16 v[128:131], v[160:163], v[92:95], v[128:131]
    ds_read_b64_tr_b16 v[224:225], v67 offset:61440
    v_mfma_f32_16x16x32_bf16 v[144:147], v[160:163], v[96:99], v[144:147]
    ds_read_b64_tr_b16 v[226:227], v65 offset:64000
    s_waitcnt vmcnt(6)
    s_waitcnt lgkmcnt(15)
    v_mfma_f32_16x16x32_bf16 v[116:119], v[164:167], v[100:103], v[116:119]
    v_mfma_f32_16x16x32_bf16 v[132:135], v[164:167], v[104:107], v[132:135]
    v_mfma_f32_16x16x32_bf16 v[120:123], v[168:171], v[100:103], v[120:123]
    v_mfma_f32_16x16x32_bf16 v[136:139], v[168:171], v[104:107], v[136:139]
    v_mfma_f32_16x16x32_bf16 v[124:127], v[172:175], v[100:103], v[124:127]
    v_mfma_f32_16x16x32_bf16 v[140:143], v[172:175], v[104:107], v[140:143]
    v_mfma_f32_16x16x32_bf16 v[128:131], v[176:179], v[100:103], v[128:131]
    v_mfma_f32_16x16x32_bf16 v[144:147], v[176:179], v[104:107], v[144:147]
    s_waitcnt vmcnt(4)
    v_mfma_f32_16x16x32_bf16 v[116:119], v[180:183], v[108:111], v[116:119]
    v_mfma_f32_16x16x32_bf16 v[132:135], v[180:183], v[112:115], v[132:135]
    v_mfma_f32_16x16x32_bf16 v[120:123], v[184:187], v[108:111], v[120:123]
    v_mfma_f32_16x16x32_bf16 v[136:139], v[184:187], v[112:115], v[136:139]
    v_mfma_f32_16x16x32_bf16 v[124:127], v[188:191], v[108:111], v[124:127]
    v_mfma_f32_16x16x32_bf16 v[140:143], v[188:191], v[112:115], v[140:143]
    v_mfma_f32_16x16x32_bf16 v[128:131], v[192:195], v[108:111], v[128:131]
    v_mfma_f32_16x16x32_bf16 v[144:147], v[192:195], v[112:115], v[144:147]
    s_waitcnt vmcnt(2)
    s_waitcnt lgkmcnt(14)
    v_mfma_f32_16x16x32_bf16 v[116:119], v[196:199], v[68:71], v[116:119]
    v_mfma_f32_16x16x32_bf16 v[132:135], v[196:199], v[72:75], v[132:135]
    s_waitcnt lgkmcnt(12)
    v_mfma_f32_16x16x32_bf16 v[120:123], v[200:203], v[68:71], v[120:123]
    v_mfma_f32_16x16x32_bf16 v[136:139], v[200:203], v[72:75], v[136:139]
    s_waitcnt lgkmcnt(10)
    v_mfma_f32_16x16x32_bf16 v[124:127], v[204:207], v[68:71], v[124:127]
    v_mfma_f32_16x16x32_bf16 v[140:143], v[204:207], v[72:75], v[140:143]
    s_waitcnt lgkmcnt(8)
    v_mfma_f32_16x16x32_bf16 v[128:131], v[208:211], v[68:71], v[128:131]
    v_mfma_f32_16x16x32_bf16 v[144:147], v[208:211], v[72:75], v[144:147]
    s_waitcnt vmcnt(0)
    s_waitcnt lgkmcnt(6)
    v_mfma_f32_16x16x32_bf16 v[116:119], v[212:215], v[76:79], v[116:119]
    v_mfma_f32_16x16x32_bf16 v[132:135], v[212:215], v[80:83], v[132:135]
    s_waitcnt lgkmcnt(4)
    v_mfma_f32_16x16x32_bf16 v[120:123], v[216:219], v[76:79], v[120:123]
    v_mfma_f32_16x16x32_bf16 v[136:139], v[216:219], v[80:83], v[136:139]
    s_waitcnt lgkmcnt(2)
    v_mfma_f32_16x16x32_bf16 v[124:127], v[220:223], v[76:79], v[124:127]
    v_mfma_f32_16x16x32_bf16 v[140:143], v[220:223], v[80:83], v[140:143]
    s_waitcnt lgkmcnt(0)
    v_mfma_f32_16x16x32_bf16 v[128:131], v[224:227], v[76:79], v[128:131]
    v_mfma_f32_16x16x32_bf16 v[144:147], v[224:227], v[80:83], v[144:147]
    s_nop 3
    v_cvt_pk_bf16_f32 v148, v116, v117
    v_cvt_pk_bf16_f32 v149, v118, v119
    ds_write_b64 v52, v[148:149] offset:0
    v_cvt_pk_bf16_f32 v164, v132, v133
    v_cvt_pk_bf16_f32 v165, v134, v135
    ds_write_b64 v52, v[164:165] offset:2304
    v_cvt_pk_bf16_f32 v152, v120, v121
    v_cvt_pk_bf16_f32 v153, v122, v123
    ds_write_b64 v52, v[152:153] offset:32
    v_cvt_pk_bf16_f32 v168, v136, v137
    v_cvt_pk_bf16_f32 v169, v138, v139
    ds_write_b64 v52, v[168:169] offset:2336
    v_cvt_pk_bf16_f32 v156, v124, v125
    v_cvt_pk_bf16_f32 v157, v126, v127
    ds_write_b64 v52, v[156:157] offset:64
    v_cvt_pk_bf16_f32 v172, v140, v141
    v_cvt_pk_bf16_f32 v173, v142, v143
    ds_write_b64 v52, v[172:173] offset:2368
    v_cvt_pk_bf16_f32 v160, v128, v129
    v_cvt_pk_bf16_f32 v161, v130, v131
    ds_write_b64 v52, v[160:161] offset:96
    v_cvt_pk_bf16_f32 v176, v144, v145
    v_cvt_pk_bf16_f32 v177, v146, v147
    ds_write_b64 v52, v[176:177] offset:2400
K_P2_E2:
    s_waitcnt lgkmcnt(0)
    v_readfirstlane_b32 s56, v28
    v_readfirstlane_b32 s57, v29
    s_lshl_b32 s72, s53, 4
    s_barrier
    ds_read_b128 v[52:55], v14
    ds_read_b128 v[56:59], v14 offset:1152
    s_sub_u32 s3, s56, s72
    s_cmp_lt_u32 s3, 16
    s_cbranch_scc1 K_YROW0
K_NOY0:
    s_sub_u32 s3, s57, s72
    s_cmp_lt_u32 s3, 16
    s_cbranch_scc1 K_YROW1
K_NOY1:
    s_waitcnt lgkmcnt(1)
    v_lshlrev_b32 v72, 16, v52
    v_and_b32 v73, 0xffff0000, v52
    v_fma_f32 v72, v72, v24, v32
    v_fma_f32 v73, v73, v24, v33
    v_cvt_pk_bf16_f32 v52, v72, v73
    v_lshlrev_b32 v74, 16, v53
    v_and_b32 v75, 0xffff0000, v53
    v_fma_f32 v74, v74, v24, v34
    v_fma_f32 v75, v75, v24, v35
    v_cvt_pk_bf16_f32 v53, v74, v75
    v_lshlrev_b32 v72, 16, v54
    v_and_b32 v73, 0xffff0000, v54
    v_fma_f32 v72, v72, v24, v36
    v_fma_f32 v73, v73, v24, v37
    v_cvt_pk_bf16_f32 v54, v72, v73
    v_lshlrev_b32 v74, 16, v55
    v_and_b32 v75, 0xffff0000, v55
    v_fma_f32 v74, v74, v24, v38
    v_fma_f32 v75, v75, v24, v39
    v_cvt_pk_bf16_f32 v55, v74, v75
    buffer_store_dwordx4 v[52:55], v10, s[48:51], 0 offen sc1
    s_waitcnt lgkmcnt(0)
    v_lshlrev_b32 v72, 16, v56
    v_and_b32 v73, 0xffff0000, v56
    v_fma_f32 v72, v72, v25, v40
    v_fma_f32 v73, v73, v25, v41
    v_cvt_pk_bf16_f32 v56, v72, v73
    v_lshlrev_b32 v74, 16, v57
    v_and_b32 v75, 0xffff0000, v57
    v_fma_f32 v74, v74, v25, v42
    v_fma_f32 v75, v75, v25, v43
    v_cvt_pk_bf16_f32 v57, v74, v75
    v_lshlrev_b32 v72, 16, v58
    v_and_b32 v73, 0xffff0000, v58
    v_fma_f32 v72, v72, v25, v44
    v_fma_f32 v73, v73, v25, v45
    v_cvt_pk_bf16_f32 v58, v72, v73
    v_lshlrev_b32 v74, 16, v59
    v_and_b32 v75, 0xffff0000, v59
    v_fma_f32 v74, v74, v25, v46
    v_fma_f32 v75, v75, v25, v47
    v_cvt_pk_bf16_f32 v59, v74, v75
    buffer_store_dwordx4 v[56:59], v10, s[48:51], s55 offen sc1
K_END:
K_EXIT:
    s_endpgm
K_YROW0:
    v_and_b32 v2, 7, v1
    v_lshlrev_b32 v2, 5, v2
    v_add_u32 v2, 158976, v2
    ds_read_b128 v[60:63], v2
    ds_read_b128 v[64:67], v2 offset:16
    s_and_b32 s33, s3, 7
    v_cmp_eq_u32 vcc, s33, v8
    s_cmp_ge_u32 s3, 8
    s_cbranch_scc1 K_YR1_0
    s_waitcnt lgkmcnt(0)
    v_lshlrev_b32 v68, 16, v16
    v_add_f32 v68, v68, v60
    v_cvt_pk_bf16_f32 v68, v68, v68
    v_lshlrev_b32 v68, 16, v68
    v_mul_f32 v68, v68, v48
    v_cndmask_b32 v32, v32, v68, vcc
    v_and_b32 v69, 0xffff0000, v16
    v_add_f32 v69, v69, v61
    v_cvt_pk_bf16_f32 v69, v69, v69
    v_lshlrev_b32 v69, 16, v69
    v_mul_f32 v69, v69, v48
    v_cndmask_b32 v33, v33, v69, vcc
    v_lshlrev_b32 v70, 16, v17
    v_add_f32 v70, v70, v62
    v_cvt_pk_bf16_f32 v70, v70, v70
    v_lshlrev_b32 v70, 16, v70
    v_mul_f32 v70, v70, v48
    v_cndmask_b32 v34, v34, v70, vcc
    v_and_b32 v71, 0xffff0000, v17
    v_add_f32 v71, v71, v63
    v_cvt_pk_bf16_f32 v71, v71, v71
    v_lshlrev_b32 v71, 16, v71
    v_mul_f32 v71, v71, v48
    v_cndmask_b32 v35, v35, v71, vcc
    v_lshlrev_b32 v68, 16, v18
    v_add_f32 v68, v68, v64
    v_cvt_pk_bf16_f32 v68, v68, v68
    v_lshlrev_b32 v68, 16, v68
    v_mul_f32 v68, v68, v48
    v_cndmask_b32 v36, v36, v68, vcc
    v_and_b32 v69, 0xffff0000, v18
    v_add_f32 v69, v69, v65
    v_cvt_pk_bf16_f32 v69, v69, v69
    v_lshlrev_b32 v69, 16, v69
    v_mul_f32 v69, v69, v48
    v_cndmask_b32 v37, v37, v69, vcc
    v_lshlrev_b32 v70, 16, v19
    v_add_f32 v70, v70, v66
    v_cvt_pk_bf16_f32 v70, v70, v70
    v_lshlrev_b32 v70, 16, v70
    v_mul_f32 v70, v70, v48
    v_cndmask_b32 v38, v38, v70, vcc
    v_and_b32 v71, 0xffff0000, v19
    v_add_f32 v71, v71, v67
    v_cvt_pk_bf16_f32 v71, v71, v71
    v_lshlrev_b32 v71, 16, v71
    v_mul_f32 v71, v71, v48
    v_cndmask_b32 v39, v39, v71, vcc
    s_branch K_NOY0
K_YR1_0:
    s_waitcnt lgkmcnt(0)
    v_lshlrev_b32 v68, 16, v20
    v_add_f32 v68, v68, v60
    v_cvt_pk_bf16_f32 v68, v68, v68
    v_lshlrev_b32 v68, 16, v68
    v_mul_f32 v68, v68, v49
    v_cndmask_b32 v40, v40, v68, vcc
    v_and_b32 v69, 0xffff0000, v20
    v_add_f32 v69, v69, v61
    v_cvt_pk_bf16_f32 v69, v69, v69
    v_lshlrev_b32 v69, 16, v69
    v_mul_f32 v69, v69, v49
    v_cndmask_b32 v41, v41, v69, vcc
    v_lshlrev_b32 v70, 16, v21
    v_add_f32 v70, v70, v62
    v_cvt_pk_bf16_f32 v70, v70, v70
    v_lshlrev_b32 v70, 16, v70
    v_mul_f32 v70, v70, v49
    v_cndmask_b32 v42, v42, v70, vcc
    v_and_b32 v71, 0xffff0000, v21
    v_add_f32 v71, v71, v63
    v_cvt_pk_bf16_f32 v71, v71, v71
    v_lshlrev_b32 v71, 16, v71
    v_mul_f32 v71, v71, v49
    v_cndmask_b32 v43, v43, v71, vcc
    v_lshlrev_b32 v68, 16, v22
    v_add_f32 v68, v68, v64
    v_cvt_pk_bf16_f32 v68, v68, v68
    v_lshlrev_b32 v68, 16, v68
    v_mul_f32 v68, v68, v49
    v_cndmask_b32 v44, v44, v68, vcc
    v_and_b32 v69, 0xffff0000, v22
    v_add_f32 v69, v69, v65
    v_cvt_pk_bf16_f32 v69, v69, v69
    v_lshlrev_b32 v69, 16, v69
    v_mul_f32 v69, v69, v49
    v_cndmask_b32 v45, v45, v69, vcc
    v_lshlrev_b32 v70, 16, v23
    v_add_f32 v70, v70, v66
    v_cvt_pk_bf16_f32 v70, v70, v70
    v_lshlrev_b32 v70, 16, v70
    v_mul_f32 v70, v70, v49
    v_cndmask_b32 v46, v46, v70, vcc
    v_and_b32 v71, 0xffff0000, v23
    v_add_f32 v71, v71, v67
    v_cvt_pk_bf16_f32 v71, v71, v71
    v_lshlrev_b32 v71, 16, v71
    v_mul_f32 v71, v71, v49
    v_cndmask_b32 v47, v47, v71, vcc
    s_branch K_NOY0
K_YROW1:
    v_and_b32 v2, 7, v1
    v_lshlrev_b32 v2, 5, v2
    v_add_u32 v2, 159232, v2
    ds_read_b128 v[60:63], v2
    ds_read_b128 v[64:67], v2 offset:16
    s_and_b32 s33, s3, 7
    v_cmp_eq_u32 vcc, s33, v8
    s_cmp_ge_u32 s3, 8
    s_cbranch_scc1 K_YR1_1
    s_waitcnt lgkmcnt(0)
    v_lshlrev_b32 v68, 16, v16
    v_add_f32 v68, v68, v60
    v_cvt_pk_bf16_f32 v68, v68, v68
    v_lshlrev_b32 v68, 16, v68
    v_mul_f32 v68, v68, v48
    v_cndmask_b32 v32, v32, v68, vcc
    v_and_b32 v69, 0xffff0000, v16
    v_add_f32 v69, v69, v61
    v_cvt_pk_bf16_f32 v69, v69, v69
    v_lshlrev_b32 v69, 16, v69
    v_mul_f32 v69, v69, v48
    v_cndmask_b32 v33, v33, v69, vcc
    v_lshlrev_b32 v70, 16, v17
    v_add_f32 v70, v70, v62
    v_cvt_pk_bf16_f32 v70, v70, v70
    v_lshlrev_b32 v70, 16, v70
    v_mul_f32 v70, v70, v48
    v_cndmask_b32 v34, v34, v70, vcc
    v_and_b32 v71, 0xffff0000, v17
    v_add_f32 v71, v71, v63
    v_cvt_pk_bf16_f32 v71, v71, v71
    v_lshlrev_b32 v71, 16, v71
    v_mul_f32 v71, v71, v48
    v_cndmask_b32 v35, v35, v71, vcc
    v_lshlrev_b32 v68, 16, v18
    v_add_f32 v68, v68, v64
    v_cvt_pk_bf16_f32 v68, v68, v68
    v_lshlrev_b32 v68, 16, v68
    v_mul_f32 v68, v68, v48
    v_cndmask_b32 v36, v36, v68, vcc
    v_and_b32 v69, 0xffff0000, v18
    v_add_f32 v69, v69, v65
    v_cvt_pk_bf16_f32 v69, v69, v69
    v_lshlrev_b32 v69, 16, v69
    v_mul_f32 v69, v69, v48
    v_cndmask_b32 v37, v37, v69, vcc
    v_lshlrev_b32 v70, 16, v19
    v_add_f32 v70, v70, v66
    v_cvt_pk_bf16_f32 v70, v70, v70
    v_lshlrev_b32 v70, 16, v70
    v_mul_f32 v70, v70, v48
    v_cndmask_b32 v38, v38, v70, vcc
    v_and_b32 v71, 0xffff0000, v19
    v_add_f32 v71, v71, v67
    v_cvt_pk_bf16_f32 v71, v71, v71
    v_lshlrev_b32 v71, 16, v71
    v_mul_f32 v71, v71, v48
    v_cndmask_b32 v39, v39, v71, vcc
    s_branch K_NOY1
K_YR1_1:
    s_waitcnt lgkmcnt(0)
    v_lshlrev_b32 v68, 16, v20
    v_add_f32 v68, v68, v60
    v_cvt_pk_bf16_f32 v68, v68, v68
    v_lshlrev_b32 v68, 16, v68
    v_mul_f32 v68, v68, v49
    v_cndmask_b32 v40, v40, v68, vcc
    v_and_b32 v69, 0xffff0000, v20
    v_add_f32 v69, v69, v61
    v_cvt_pk_bf16_f32 v69, v69, v69
    v_lshlrev_b32 v69, 16, v69
    v_mul_f32 v69, v69, v49
    v_cndmask_b32 v41, v41, v69, vcc
    v_lshlrev_b32 v70, 16, v21
    v_add_f32 v70, v70, v62
    v_cvt_pk_bf16_f32 v70, v70, v70
    v_lshlrev_b32 v70, 16, v70
    v_mul_f32 v70, v70, v49
    v_cndmask_b32 v42, v42, v70, vcc
    v_and_b32 v71, 0xffff0000, v21
    v_add_f32 v71, v71, v63
    v_cvt_pk_bf16_f32 v71, v71, v71
    v_lshlrev_b32 v71, 16, v71
    v_mul_f32 v71, v71, v49
    v_cndmask_b32 v43, v43, v71, vcc
    v_lshlrev_b32 v68, 16, v22
    v_add_f32 v68, v68, v64
    v_cvt_pk_bf16_f32 v68, v68, v68
    v_lshlrev_b32 v68, 16, v68
    v_mul_f32 v68, v68, v49
    v_cndmask_b32 v44, v44, v68, vcc
    v_and_b32 v69, 0xffff0000, v22
    v_add_f32 v69, v69, v65
    v_cvt_pk_bf16_f32 v69, v69, v69
    v_lshlrev_b32 v69, 16, v69
    v_mul_f32 v69, v69, v49
    v_cndmask_b32 v45, v45, v69, vcc
    v_lshlrev_b32 v70, 16, v23
    v_add_f32 v70, v70, v66
    v_cvt_pk_bf16_f32 v70, v70, v70
    v_lshlrev_b32 v70, 16, v70
    v_mul_f32 v70, v70, v49
    v_cndmask_b32 v46, v46, v70, vcc
    v_and_b32 v71, 0xffff0000, v23
    v_add_f32 v71, v71, v67
    v_cvt_pk_bf16_f32 v71, v71, v71
    v_lshlrev_b32 v71, 16, v71
    v_mul_f32 v71, v71, v49
    v_cndmask_b32 v47, v47, v71, vcc
    s_branch K_NOY1
WP_spin:
    s_setpc_b64 s[38:39]
K_SP0:
    ds_read_b32 v2, v15 offset:32
    s_waitcnt lgkmcnt(0)
    v_readfirstlane_b32 s33, v2
    s_nop 3
    s_lshr_b32 s58, s33, s59
    s_lshr_b32 s33, s33, s61
    s_and_b32 s58, s58, s33
    s_andn2_b32 s33, 1, s58
    s_cbranch_scc1 K_SP0
    s_branch K_SPR0
K_SP1:
    ds_read_b32 v2, v15 offset:32
    s_waitcnt lgkmcnt(0)
    v_readfirstlane_b32 s33, v2
    s_nop 3
    s_lshr_b32 s58, s33, s59
    s_lshr_b32 s33, s33, s61
    s_and_b32 s58, s58, s33
    s_andn2_b32 s33, 16, s58
    s_cbranch_scc1 K_SP1
    s_branch K_SPR1
K_SP2:
    ds_read_b32 v2, v15 offset:32
    s_waitcnt lgkmcnt(0)
    v_readfirstlane_b32 s33, v2
    s_nop 3
    s_lshr_b32 s58, s33, s59
    s_lshr_b32 s33, s33, s61
    s_and_b32 s58, s58, s33
    s_andn2_b32 s33, 2, s58
    s_cbranch_scc1 K_SP2
    s_branch K_SPR2
K_SP3:
    ds_read_b32 v2, v15 offset:32
    s_waitcnt lgkmcnt(0)
    v_readfirstlane_b32 s33, v2
    s_nop 3
    s_lshr_b32 s58, s33, s59
    s_lshr_b32 s33, s33, s61
    s_and_b32 s58, s58, s33
    s_andn2_b32 s33, 32, s58
    s_cbranch_scc1 K_SP3
    s_branch K_SPR3
K_SP4:
    ds_read_b32 v2, v15 offset:32
    s_waitcnt lgkmcnt(0)
    v_readfirstlane_b32 s33, v2
    s_nop 3
    s_lshr_b32 s58, s33, s59
    s_lshr_b32 s33, s33, s61
    s_and_b32 s58, s58, s33
    s_andn2_b32 s33, 4, s58
    s_cbranch_scc1 K_SP4
    s_branch K_SPR4
K_SP5:
    ds_read_b32 v2, v15 offset:32
    s_waitcnt lgkmcnt(0)
    v_readfirstlane_b32 s33, v2
    s_nop 3
    s_lshr_b32 s58, s33, s59
    s_lshr_b32 s33, s33, s61
    s_and_b32 s58, s58, s33
    s_andn2_b32 s33, 64, s58
    s_cbranch_scc1 K_SP5
    s_branch K_SPR5
K_SP6:
    ds_read_b32 v2, v15 offset:32
    s_waitcnt lgkmcnt(0)
    v_readfirstlane_b32 s33, v2
    s_nop 3
    s_lshr_b32 s58, s33, s59
    s_lshr_b32 s33, s33, s61
    s_and_b32 s58, s58, s33
    s_andn2_b32 s33, 8, s58
    s_cbranch_scc1 K_SP6
    s_branch K_SPR6
K_SP7:
    ds_read_b32 v2, v15 offset:32
    s_waitcnt lgkmcnt(0)
    v_readfirstlane_b32 s33, v2
    s_nop 3
    s_lshr_b32 s58, s33, s59
    s_lshr_b32 s33, s33, s61
    s_and_b32 s58, s58, s33
    s_andn2_b32 s33, 128, s58
    s_cbranch_scc1 K_SP7
    s_branch K_SPR7
K_SP8:
    ds_read_b32 v2, v15 offset:32
    s_waitcnt lgkmcnt(0)
    v_readfirstlane_b32 s33, v2
    s_nop 3
    s_lshr_b32 s58, s33, s59
    s_lshr_b32 s33, s33, s61
    s_and_b32 s58, s58, s33
    s_andn2_b32 s33, 15, s58
    s_cbranch_scc1 K_SP8
    s_branch K_SPR8
K_SP9:
    ds_read_b32 v2, v15 offset:32
    s_waitcnt lgkmcnt(0)
    v_readfirstlane_b32 s33, v2
    s_nop 3
    s_lshr_b32 s58, s33, s59
    s_lshr_b32 s33, s33, s61
    s_and_b32 s58, s58, s33
    s_andn2_b32 s33, 240, s58
    s_cbranch_scc1 K_SP9
    s_branch K_SPR9
K_SP10:
    ds_read_b32 v2, v15 offset:32
    s_waitcnt lgkmcnt(0)
    v_readfirstlane_b32 s33, v2
    s_nop 3
    s_lshr_b32 s58, s33, s59
    s_lshr_b32 s33, s33, s61
    s_and_b32 s58, s58, s33
    s_andn2_b32 s33, 256, s58
    s_cbranch_scc1 K_SP10
    s_branch K_SPR10
K_SP11:
    ds_read_b32 v2, v15 offset:32
    s_waitcnt lgkmcnt(0)
    v_readfirstlane_b32 s33, v2
    s_nop 3
    s_lshr_b32 s58, s33, s59
    s_lshr_b32 s33, s33, s61
    s_and_b32 s58, s58, s33
    s_andn2_b32 s33, 4096, s58
    s_cbranch_scc1 K_SP11
    s_branch K_SPR11
K_SP12:
    ds_read_b32 v2, v15 offset:32
    s_waitcnt lgkmcnt(0)
    v_readfirstlane_b32 s33, v2
    s_nop 3
    s_lshr_b32 s58, s33, s59
    s_lshr_b32 s33, s33, s61
    s_and_b32 s58, s58, s33
    s_andn2_b32 s33, 512, s58
    s_cbranch_scc1 K_SP12
    s_branch K_SPR12
K_SP13:
    ds_read_b32 v2, v15 offset:32
    s_waitcnt lgkmcnt(0)
    v_readfirstlane_b32 s33, v2
    s_nop 3
    s_lshr_b32 s58, s33, s59
    s_lshr_b32 s33, s33, s61
    s_and_b32 s58, s58, s33
    s_andn2_b32 s33, 8192, s58
    s_cbranch_scc1 K_SP13
    s_branch K_SPR13
K_SP14:
    ds_read_b32 v2, v15 offset:32
    s_waitcnt lgkmcnt(0)
    v_readfirstlane_b32 s33, v2
    s_nop 3
    s_lshr_b32 s58, s33, s59
    s_lshr_b32 s33, s33, s61
    s_and_b32 s58, s58, s33
    s_andn2_b32 s33, 1024, s58
    s_cbranch_scc1 K_SP14
    s_branch K_SPR14
K_SP15:
    ds_read_b32 v2, v15 offset:32
    s_waitcnt lgkmcnt(0)
    v_readfirstlane_b32 s33, v2
    s_nop 3
    s_lshr_b32 s58, s33, s59
    s_lshr_b32 s33, s33, s61
    s_and_b32 s58, s58, s33
    s_andn2_b32 s33, 16384, s58
    s_cbranch_scc1 K_SP15
    s_branch K_SPR15
K_SP16:
    ds_read_b32 v2, v15 offset:32
    s_waitcnt lgkmcnt(0)
    v_readfirstlane_b32 s33, v2
    s_nop 3
    s_lshr_b32 s58, s33, s59
    s_lshr_b32 s33, s33, s61
    s_and_b32 s58, s58, s33
    s_andn2_b32 s33, 2048, s58
    s_cbranch_scc1 K_SP16
    s_branch K_SPR16
K_SP17:
    ds_read_b32 v2, v15 offset:32
    s_waitcnt lgkmcnt(0)
    v_readfirstlane_b32 s33, v2
    s_nop 3
    s_lshr_b32 s58, s33, s59
    s_lshr_b32 s33, s33, s61
    s_and_b32 s58, s58, s33
    s_andn2_b32 s33, 32768, s58
    s_cbranch_scc1 K_SP17
    s_branch K_SPR17
K_SP18:
    ds_read_b32 v2, v15 offset:32
    s_waitcnt lgkmcnt(0)
    v_readfirstlane_b32 s33, v2
    s_nop 3
    s_lshr_b32 s58, s33, s59
    s_lshr_b32 s33, s33, s61
    s_and_b32 s58, s58, s33
    s_andn2_b32 s33, 3840, s58
    s_cbranch_scc1 K_SP18
    s_branch K_SPR18
K_SP19:
    ds_read_b32 v2, v15 offset:32
    s_waitcnt lgkmcnt(0)
    v_readfirstlane_b32 s33, v2
    s_nop 3
    s_lshr_b32 s58, s33, s59
    s_lshr_b32 s33, s33, s61
    s_and_b32 s58, s58, s33
    s_andn2_b32 s33, 61440, s58
    s_cbranch_scc1 K_SP19
    s_branch K_SPR19
WP_gen:
    s_setpc_b64 s[38:39]
K_P2:
    s_cmp_ge_u32 s30, 4
    s_cbranch_scc1 K_P2_HELP
    s_lshl_b32 s54, s40, 7
    v_lshrrev_b32 v8, 3, v1
    v_lshrrev_b32 v9, 4, v1
    v_mov_b32 v15, 158720
    s_lshl_b32 s53, s40, 3
    s_add_u32 s53, s53, s30
    s_mul_i32 s3, s53, 20480
    s_lshl_b32 s33, s41, 7
    s_add_u32 s3, s3, s33
    v_and_b32 v2, 7, v1
    v_lshlrev_b32 v2, 4, v2
    v_mul_u32_u24 v4, 1280, v8
    v_add3_u32 v10, v2, v4, s3
    s_lshl_b32 s3, s53, 6
    v_lshl_add_u32 v11, v8, 2, s3
    s_mov_b32 s55, 10240
    s_add_u32 s20, s10, 0x100000
    s_addc_u32 s21, s11, 0
    s_mov_b32 s22, 0x280000
    s_mov_b32 s23, 0x20000
    s_add_u32 s16, s10, 0x1000
    s_addc_u32 s17, s11, 0
    s_mov_b32 s18, 0x2000
    s_mov_b32 s19, 0x20000
    s_mov_b32 s48, s6
    s_mov_b32 s49, s7
    s_mov_b32 s50, 0x280000
    s_mov_b32 s51, 0x20000
    v_mul_u32_u24 v3, 144, v8
    v_add_u32 v3, v2, v3
    s_mul_i32 s3, s30, 2304
    s_add_u32 s3, s3, 140288
    v_add_u32 v14, s3, v3
    v_bfe_u32 v50, v1, 2, 2
    v_and_b32 v51, 3, v1
    s_add_u32 s3, s53, s30
    s_mul_i32 s3, s3, 20480
    v_lshl_add_u32 v54, v1, 4, s3
    v_add_u32 v55, 20480, v54
    v_lshl_add_u32 v2, v9, 2, v50
    v_bfe_u32 v3, v2, 1, 2
    v_lshlrev_b32 v2, 7, v2
    v_lshl_add_u32 v2, v51, 3, v2
    v_xor_b32 v4, 0, v3
    v_lshl_add_u32 v56, v4, 5, v2
    v_add_u32 v60, 40960, v56
    v_xor_b32 v4, 1, v3
    v_lshl_add_u32 v57, v4, 5, v2
    v_add_u32 v61, 40960, v57
    v_xor_b32 v4, 2, v3
    v_lshl_add_u32 v58, v4, 5, v2
    v_add_u32 v62, 40960, v58
    v_xor_b32 v4, 3, v3
    v_lshl_add_u32 v59, v4, 5, v2
    v_add_u32 v63, 40960, v59
    v_lshrrev_b32 v3, 1, v50
    v_mul_u32_u24 v2, 40, v9
    v_add3_u32 v2, v2, 16, v50
    v_lshlrev_b32 v2, 7, v2
    v_lshl_add_u32 v2, v51, 3, v2
    v_xor_b32 v4, 0, v3
    v_lshl_add_u32 v64, v4, 5, v2
    v_xor_b32 v4, 1, v3
    v_lshl_add_u32 v65, v4, 5, v2
    v_xor_b32 v4, 2, v3
    v_lshl_add_u32 v66, v4, 5, v2
    v_xor_b32 v4, 3, v3
    v_lshl_add_u32 v67, v4, 5, v2
    v_and_b32 v2, 15, v1
    v_mul_u32_u24 v2, 144, v2
    v_lshl_add_u32 v2, v9, 3, v2
    s_mul_i32 s3, s30, 4608
    s_add_u32 s3, s3, 140288
    v_add_u32 v52, s3, v2
    s_mov_b32 s67, 0
    s_mov_b32 s68, 4096
    s_mov_b32 s69, 8192
    s_mov_b32 s70, 12288
    s_mov_b32 s71, 16384
    s_cmp_eq_u32 s30, 0
    s_cbranch_scc1 K_P2_AUXW
    v_lshrrev_b32 v2, 3, v1
    v_mul_u32_u24 v2, 1280, v2
    v_lshrrev_b32 v3, 4, v1
    v_lshlrev_b32 v3, 1, v3
    v_and_b32 v4, 7, v1
    v_xor_b32 v3, v3, v4
    v_lshl_add_u32 v2, v3, 4, v2
    s_lshl_b32 s33, s41, 7
    v_add_u32 v53, s33, v2
    s_mov_b32 s64, 0xfda87520
    s_mov_b32 s65, 0xecb96431
    s_sub_u32 s60, s30, 1
K_P2_WS:
    s_lshl_b32 s3, s60, 2
    s_lshr_b64 s[4:5], s[64:65], s3
    s_and_b32 s4, s4, 15
    s_mul_i32 s4, s4, 51200
    s_mul_i32 s61, s60, 5120
    s_add_u32 s52, s4, 0
    s_add_u32 m0, s61, 0
    s_waitcnt vmcnt(11)
    buffer_load_dwordx4 v53, s[24:27], s52 offen lds
    s_add_u32 s52, s4, 10240
    s_add_u32 m0, s61, 1024
    s_waitcnt vmcnt(11)
    buffer_load_dwordx4 v53, s[24:27], s52 offen lds
    s_add_u32 s52, s4, 20480
    s_add_u32 m0, s61, 2048
    s_waitcnt vmcnt(11)
    buffer_load_dwordx4 v53, s[24:27], s52 offen lds
    s_add_u32 s52, s4, 30720
    s_add_u32 m0, s61, 3072
    s_waitcnt vmcnt(11)
    buffer_load_dwordx4 v53, s[24:27], s52 offen lds
    s_add_u32 s52, s4, 40960
    s_add_u32 m0, s61, 4096
    s_waitcnt vmcnt(11)
    buffer_load_dwordx4 v53, s[24:27], s52 offen lds
    s_cmp_ge_u32 s60, 3
    s_cbranch_scc1 K_P2_WS1
    v_mov_b32 v3, 1
    s_waitcnt vmcnt(5)
    s_mov_b64 exec, 1
    ds_add_u32 v15, v3 offset:52
    s_mov_b64 exec, -1
K_P2_WS1:
    s_add_u32 s60, s60, 3
    s_cmp_lt_u32 s60, 16
    s_cbranch_scc1 K_P2_WS
K_P2_AUXW:
    v_mov_b32 v3, 1
    s_waitcnt vmcnt(0)
    s_mov_b64 exec, 1
    ds_add_u32 v15, v3 offset:44
    s_mov_b64 exec, -1
    s_mov_b32 s3, 1048576
K_P2_GWA:
    ds_read_b32 v2, v15 offset:44
    s_sub_u32 s3, s3, 1
    s_waitcnt lgkmcnt(0)
    v_readfirstlane_b32 s33, v2
    s_nop 3
    s_cselect_b32 s33, 4, s33
    s_cmp_lt_u32 s33, 4
    s_cbranch_scc1 K_P2_GWA
    s_branch K_P2_GEMM
.p2align 12
WP_help:
    s_setpc_b64 s[38:39]
K_P2_HELP:
    s_setprio 3
    s_lshl_b32 s53, s40, 3
    s_mul_i32 s60, s53, 187
    s_lshr_b32 s60, s60, 11
    s_add_u32 s3, s53, 7
    s_mul_i32 s61, s3, 187
    s_lshr_b32 s61, s61, 11
    s_sub_u32 s61, s61, s60
    s_lshl_b32 s61, s61, 4
    s_or_b32 s61, s61, 15
    v_and_b32 v12, s61, v1
    v_lshl_add_u32 v12, v12, 2, s42
    s_cmp_lg_u32 s30, 7
    s_cbranch_scc1 K_P2_N7
    v_and_b32 v4, 7, v1
    v_lshlrev_b32 v4, 2, v4
    s_mov_b32 s3, 131072
K_ZPOLL1:
    v_cmp_eq_u32 vcc, 0, v7
    s_cbranch_vccz K_ZOK1
    s_sub_u32 s3, s3, 1
    s_cbranch_scc1 K_ZOK1
    global_load_dword v7, v4, s[8:9] offset:192 sc1
    s_waitcnt vmcnt(0)
    s_branch K_ZPOLL1
K_ZOK1:
    global_load_dword v7, v12, s[10:11] sc1
K_P2_N7:
    s_lshl_b32 s54, s40, 7
    v_lshrrev_b32 v8, 3, v1
    v_lshrrev_b32 v9, 4, v1
    v_mov_b32 v15, 158720
    s_lshl_b32 s53, s40, 3
    s_add_u32 s53, s53, s30
    s_mul_i32 s3, s53, 20480
    s_lshl_b32 s33, s41, 7
    s_add_u32 s3, s3, s33
    v_and_b32 v2, 7, v1
    v_lshlrev_b32 v2, 4, v2
    v_mul_u32_u24 v4, 1280, v8
    v_add3_u32 v10, v2, v4, s3
    s_lshl_b32 s3, s53, 6
    v_lshl_add_u32 v11, v8, 2, s3
    s_mov_b32 s55, 10240
    s_add_u32 s20, s10, 0x100000
    s_addc_u32 s21, s11, 0
    s_mov_b32 s22, 0x280000
    s_mov_b32 s23, 0x20000
    s_add_u32 s16, s10, 0x1000
    s_addc_u32 s17, s11, 0
    s_mov_b32 s18, 0x2000
    s_mov_b32 s19, 0x20000
    s_mov_b32 s48, s6
    s_mov_b32 s49, s7
    s_mov_b32 s50, 0x280000
    s_mov_b32 s51, 0x20000
    v_mul_u32_u24 v3, 144, v8
    v_add_u32 v3, v2, v3
    s_mul_i32 s3, s30, 2304
    s_add_u32 s3, s3, 140288
    v_add_u32 v14, s3, v3
    s_add_u32 s44, s10, 0x10000
    s_addc_u32 s45, s11, 0
    s_mov_b32 s46, 0x43800
    s_mov_b32 s47, 0x20000
    v_mov_b32 v112, 1
    s_cmp_eq_u32 s30, 7
    s_cbranch_scc1 K_P2_FLAGS
    buffer_load_dwordx4 v[16:19], v10, s[12:15], 0 offen
    buffer_load_dwordx4 v[20:23], v10, s[12:15], s55 offen
    s_cmp_lg_u32 s30, 6
    s_cbranch_scc1 K_P2_HW
    s_mov_b32 s3, 131072
K_P2_DPOLL:
    v_cmp_eq_u32 vcc, 0, v7
    s_cbranch_vccz K_P2_DOK
    s_cmp_eq_u32 s3, 131072
    s_cbranch_scc1 K_P2_DNS
    s_sleep 12
K_P2_DNS:
    v_and_b32 v13, 1, v1
    v_lshl_add_u32 v13, v13, 2, s42
    global_load_dword v7, v13, s[10:11] offset:128 sc1
    s_sub_u32 s3, s3, 1
    s_waitcnt vmcnt(0)
    s_cmp_lg_u32 s3, 0
    s_cbranch_scc1 K_P2_DPOLL
K_P2_DOK:
    v_readlane_b32 s60, v7, 0
    v_readlane_b32 s61, v7, 1
    s_nop 3
    s_and_b32 s3, s60, 0x7ff
    s_sub_u32 s3, 2047, s3
    v_mov_b32 v52, s3
    v_mov_b32 v4, s60
    v_and_b32 v4, 0xffff0000, v4
    v_ashrrev_i32 v5, 31, v4
    v_not_b32 v5, v5
    v_or_b32 v5, 0x80000000, v5
    v_xor_b32 v4, v4, v5
    v_and_b32 v4, 0xffff0000, v4
    v_mul_f32 v5, 0xbfb8aa3b, v4
    v_exp_f32 v5, v5
    s_nop 0
    v_add_f32 v5, 1.0, v5
    v_rcp_f32 v4, v5
    s_nop 0
    v_cvt_pk_bf16_f32 v54, v4, v4
    v_lshlrev_b32 v54, 16, v54
    s_and_b32 s3, s61, 0x7ff
    s_sub_u32 s3, 2047, s3
    v_mov_b32 v53, s3
    v_mov_b32 v4, s61
    v_and_b32 v4, 0xffff0000, v4
    v_ashrrev_i32 v5, 31, v4
    v_not_b32 v5, v5
    v_or_b32 v5, 0x80000000, v5
    v_xor_b32 v4, v4, v5
    v_and_b32 v4, 0xffff0000, v4
    v_mul_f32 v5, 0xbfb8aa3b, v4
    v_exp_f32 v5, v5
    s_nop 0
    v_add_f32 v5, 1.0, v5
    v_rcp_f32 v4, v5
    s_nop 0
    v_cvt_pk_bf16_f32 v55, v4, v4
    v_lshlrev_b32 v55, 16, v55
    ds_write_b128 v15, v[52:55]
    ds_write_b32 v15, v112 offset:40
K_P2_HW:
    s_mov_b32 s3, 1048576
K_P2_GS2:
    ds_read_b32 v2, v15 offset:40
    s_sleep 1
    s_sub_u32 s3, s3, 1
    s_waitcnt lgkmcnt(0)
    v_readfirstlane_b32 s33, v2
    s_nop 3
    s_cselect_b32 s33, 1, s33
    s_cmp_lt_u32 s33, 1
    s_cbranch_scc1 K_P2_GS2
    buffer_load_dword v24, v11, s[16:19], 0 offen sc1
    buffer_load_dword v25, v11, s[16:19], 0 offen offset:32 sc1
    ds_read_b128 v[28:31], v15
    s_cmp_eq_u32 s30, 6
    s_cbranch_scc1 K_P2_E
    s_waitcnt lgkmcnt(0)
    s_cmp_eq_u32 s30, 4
    s_cselect_b64 vcc, -1, 0
    s_nop 1
    v_cndmask_b32 v2, v29, v28, vcc
    v_cndmask_b32 v5, v31, v30, vcc
    s_nop 0
    v_readfirstlane_b32 s60, v2
    s_nop 3
    s_sub_u32 s3, s60, s54
    s_cmp_lt_u32 s3, 128
    s_cbranch_scc0 K_P2_E
    v_min_u32 v3, 53, v1
    v_lshlrev_b32 v3, 5, v3
    v_add_u32 v3, 565248, v3
    s_mov_b32 s3, 1048576
K_P2_GY:
    ds_read_b32 v2, v15 offset:32
    s_sleep 1
    s_sub_u32 s3, s3, 1
    s_waitcnt lgkmcnt(0)
    v_readfirstlane_b32 s33, v2
    s_nop 3
    s_cselect_b32 s33, 16777216, s33
    s_cmp_lt_u32 s33, 16777216
    s_cbranch_scc1 K_P2_GY
    s_mov_b32 s3, 131072
K_P2_YPOLL:
    global_load_dwordx4 v[52:55], v3, s[10:11] sc1
    s_sub_u32 s3, s3, 1
    s_waitcnt vmcnt(0)
    v_and_b32 v2, v52, v53
    v_and_b32 v2, v2, v54
    v_and_b32 v2, v2, v55
    v_cmp_ne_u32 vcc, 1, v2
    s_cbranch_vccz K_P2_YGO
    s_sleep 8
    s_cmp_lg_u32 s3, 0
    s_cbranch_scc1 K_P2_YPOLL
K_P2_YGO:
    v_and_b32 v2, 15, v1
    v_lshlrev_b32 v2, 4, v2
    v_mul_u32_u24 v4, 5120, v9
    s_sub_u32 s61, s30, 4
    s_mul_i32 s33, s61, 2560
    s_lshl_b32 s3, s41, 8
    s_add_u32 s3, s3, s33
    v_add3_u32 v3, v2, v4, s3
    s_mov_b32 s52, 0
    buffer_load_dwordx4 v[56:59], v3, s[44:47], s52 offen sc1
    s_mov_b32 s52, 20480
    buffer_load_dwordx4 v[60:63], v3, s[44:47], s52 offen sc1
    s_mov_b32 s52, 40960
    buffer_load_dwordx4 v[64:67], v3, s[44:47], s52 offen sc1
    s_mov_b32 s52, 61440
    buffer_load_dwordx4 v[68:71], v3, s[44:47], s52 offen sc1
    s_mov_b32 s52, 81920
    buffer_load_dwordx4 v[72:75], v3, s[44:47], s52 offen sc1
    s_mov_b32 s52, 102400
    buffer_load_dwordx4 v[76:79], v3, s[44:47], s52 offen sc1
    s_mov_b32 s52, 122880
    buffer_load_dwordx4 v[80:83], v3, s[44:47], s52 offen sc1
    s_mov_b32 s52, 143360
    buffer_load_dwordx4 v[84:87], v3, s[44:47], s52 offen sc1
    s_mov_b32 s52, 163840
    buffer_load_dwordx4 v[88:91], v3, s[44:47], s52 offen sc1
    s_mov_b32 s52, 184320
    buffer_load_dwordx4 v[92:95], v3, s[44:47], s52 offen sc1
    s_mov_b32 s52, 204800
    buffer_load_dwordx4 v[96:99], v3, s[44:47], s52 offen sc1
    s_mov_b32 s52, 225280
    buffer_load_dwordx4 v[100:103], v3, s[44:47], s52 offen sc1
    s_mov_b32 s52, 245760
    buffer_load_dwordx4 v[104:107], v3, s[44:47], s52 offen sc1
    s_mov_b32 s52, 266240
    buffer_load_dwordx4 v[108:111], v3, s[44:47], s52 offen sc1
    s_waitcnt vmcnt(12)
    v_add_f32 v52, v56, v60
    v_add_f32 v53, v57, v61
    v_add_f32 v54, v58, v62
    v_add_f32 v55, v59, v63
    s_waitcnt vmcnt(11)
    v_add_f32 v52, v52, v64
    v_add_f32 v53, v53, v65
    v_add_f32 v54, v54, v66
    v_add_f32 v55, v55, v67
    s_waitcnt vmcnt(10)
    v_add_f32 v52, v52, v68
    v_add_f32 v53, v53, v69
    v_add_f32 v54, v54, v70
    v_add_f32 v55, v55, v71
    s_waitcnt vmcnt(9)
    v_add_f32 v52, v52, v72
    v_add_f32 v53, v53, v73
    v_add_f32 v54, v54, v74
    v_add_f32 v55, v55, v75
    s_waitcnt vmcnt(8)
    v_add_f32 v52, v52, v76
    v_add_f32 v53, v53, v77
    v_add_f32 v54, v54, v78
    v_add_f32 v55, v55, v79
    s_waitcnt vmcnt(7)
    v_add_f32 v52, v52, v80
    v_add_f32 v53, v53, v81
    v_add_f32 v54, v54, v82
    v_add_f32 v55, v55, v83
    s_waitcnt vmcnt(6)
    v_add_f32 v52, v52, v84
    v_add_f32 v53, v53, v85
    v_add_f32 v54, v54, v86
    v_add_f32 v55, v55, v87
    s_waitcnt vmcnt(5)
    v_add_f32 v52, v52, v88
    v_add_f32 v53, v53, v89
    v_add_f32 v54, v54, v90
    v_add_f32 v55, v55, v91
    s_waitcnt vmcnt(4)
    v_add_f32 v52, v52, v92
    v_add_f32 v53, v53, v93
    v_add_f32 v54, v54, v94
    v_add_f32 v55, v55, v95
    s_waitcnt vmcnt(3)
    v_add_f32 v52, v52, v96
    v_add_f32 v53, v53, v97
    v_add_f32 v54, v54, v98
    v_add_f32 v55, v55, v99
    s_waitcnt vmcnt(2)
    v_add_f32 v52, v52, v100
    v_add_f32 v53, v53, v101
    v_add_f32 v54, v54, v102
    v_add_f32 v55, v55, v103
    s_waitcnt vmcnt(1)
    v_add_f32 v52, v52, v104
    v_add_f32 v53, v53, v105
    v_add_f32 v54, v54, v106
    v_add_f32 v55, v55, v107
    s_waitcnt vmcnt(0)
    v_add_f32 v52, v52, v108
    v_add_f32 v53, v53, v109
    v_add_f32 v54, v54, v110
    v_add_f32 v55, v55, v111
    v_mov_b32 v56, v52
    v_mov_b32 v57, v53
    v_mov_b32 v58, v54
    v_mov_b32 v59, v55
    s_nop 0
    v_permlane16_swap_b32 v52, v56
    v_permlane16_swap_b32 v53, v57
    v_permlane16_swap_b32 v54, v58
    v_permlane16_swap_b32 v55, v59
    v_add_f32 v52, v52, v56
    v_add_f32 v53, v53, v57
    v_add_f32 v54, v54, v58
    v_add_f32 v55, v55, v59
    v_mov_b32 v56, v52
    v_mov_b32 v57, v53
    v_mov_b32 v58, v54
    v_mov_b32 v59, v55
    s_nop 0
    v_permlane32_swap_b32 v52, v56
    v_permlane32_swap_b32 v53, v57
    v_permlane32_swap_b32 v54, v58
    v_permlane32_swap_b32 v55, v59
    v_add_f32 v52, v52, v56
    v_add_f32 v53, v53, v57
    v_add_f32 v54, v54, v58
    v_add_f32 v55, v55, v59
    v_cvt_pk_bf16_f32 v52, v52, v52
    v_lshlrev_b32 v52, 16, v52
    v_mul_f32 v52, v5, v52
    v_cvt_pk_bf16_f32 v52, v52, v52
    v_lshlrev_b32 v52, 16, v52
    v_cvt_pk_bf16_f32 v53, v53, v53
    v_lshlrev_b32 v53, 16, v53
    v_mul_f32 v53, v5, v53
    v_cvt_pk_bf16_f32 v53, v53, v53
    v_lshlrev_b32 v53, 16, v53
    v_cvt_pk_bf16_f32 v54, v54, v54
    v_lshlrev_b32 v54, 16, v54
    v_mul_f32 v54, v5, v54
    v_cvt_pk_bf16_f32 v54, v54, v54
    v_lshlrev_b32 v54, 16, v54
    v_cvt_pk_bf16_f32 v55, v55, v55
    v_lshlrev_b32 v55, 16, v55
    v_mul_f32 v55, v5, v55
    v_cvt_pk_bf16_f32 v55, v55, v55
    v_lshlrev_b32 v55, 16, v55
    s_lshl_b32 s3, s61, 8
    s_add_u32 s3, s3, 158976
    v_add_u32 v2, s3, v2
    ds_write_b128 v2, v[52:55]
    s_branch K_P2_E
WP_flags:
    s_setpc_b64 s[38:39]
K_P2_FLAGS:
    s_mov_b32 exec_hi, 0
    s_waitcnt vmcnt(0)
    s_mov_b32 s3, 131072
K_P2_FCHK:
    v_cmp_eq_u32 vcc, 1, v7
    s_nop 1
    v_mov_b32 v2, vcc_lo
    ds_write_b32 v15, v2 offset:32
    s_cmp_eq_u32 vcc_lo, -1
    s_cbranch_scc1 K_P2_FGO
    s_cmp_lg_u32 vcc_lo, 0
    s_cbranch_scc1 K_P2_FS
    s_sleep 16
K_P2_FS:
    s_sleep 6
    global_load_dword v7, v12, s[10:11] sc1
    s_sub_u32 s3, s3, 1
    s_waitcnt vmcnt(0)
    s_cbranch_scc0 K_P2_FCHK
    v_mov_b32 v2, -1
    ds_write_b32 v15, v2 offset:32
K_P2_FGO:
    s_mov_b64 exec, -1
    buffer_load_dwordx4 v[16:19], v10, s[12:15], 0 offen
    buffer_load_dwordx4 v[20:23], v10, s[12:15], s55 offen
    s_mov_b32 s3, 1048576
K_P2_GS3:
    ds_read_b32 v2, v15 offset:40
    s_sleep 1
    s_sub_u32 s3, s3, 1
    s_waitcnt lgkmcnt(0)
    v_readfirstlane_b32 s33, v2
    s_nop 3
    s_cselect_b32 s33, 1, s33
    s_cmp_lt_u32 s33, 1
    s_cbranch_scc1 K_P2_GS3
    buffer_load_dword v24, v11, s[16:19], 0 offen sc1
    buffer_load_dword v25, v11, s[16:19], 0 offen offset:32 sc1
    ds_read_b128 v[28:31], v15
K_P2_E:
    s_setprio 0
    s_waitcnt vmcnt(0)
    v_sub_f32 v48, 1.0, v24
    v_cvt_pk_bf16_f32 v48, v48, v48
    v_lshlrev_b32 v48, 16, v48
    v_sub_f32 v49, 1.0, v25
    v_cvt_pk_bf16_f32 v49, v49, v49
    v_lshlrev_b32 v49, 16, v49
    v_lshlrev_b32 v32, 16, v16
    v_and_b32 v33, 0xffff0000, v16
    v_lshlrev_b32 v34, 16, v17
    v_and_b32 v35, 0xffff0000, v17
    v_lshlrev_b32 v36, 16, v18
    v_and_b32 v37, 0xffff0000, v18
    v_lshlrev_b32 v38, 16, v19
    v_and_b32 v39, 0xffff0000, v19
    v_lshlrev_b32 v40, 16, v20
    v_and_b32 v41, 0xffff0000, v20
    v_lshlrev_b32 v42, 16, v21
    v_and_b32 v43, 0xffff0000, v21
    v_lshlrev_b32 v44, 16, v22
    v_and_b32 v45, 0xffff0000, v22
    v_lshlrev_b32 v46, 16, v23
    v_and_b32 v47, 0xffff0000, v23
    v_mul_f32 v32, v32, v48
    v_mul_f32 v33, v33, v48
    v_mul_f32 v34, v34, v48
    v_mul_f32 v35, v35, v48
    v_mul_f32 v36, v36, v48
    v_mul_f32 v37, v37, v48
    v_mul_f32 v38, v38, v48
    v_mul_f32 v39, v39, v48
    v_mul_f32 v40, v40, v49
    v_mul_f32 v41, v41, v49
    v_mul_f32 v42, v42, v49
    v_mul_f32 v43, v43, v49
    v_mul_f32 v44, v44, v49
    v_mul_f32 v45, v45, v49
    v_mul_f32 v46, v46, v49
    v_mul_f32 v47, v47, v49
    s_branch K_P2_E2
.p2align 12
K_AUX:
    s_load_dwordx8 s[48:55], s[0:1], 32
    s_load_dwordx2 s[56:57], s[0:1], 64
    s_mul_i32 s44, s28, 7
    s_add_u32 s44, s44, s29
    s_sub_u32 s44, s44, 1
    s_cmp_lt_u32 s44, 54
    s_cselect_b32 s44, s44, 63
    s_cmp_eq_u32 s29, 0
    s_cselect_b32 s44, 63, s44
    s_lshl_b32 s74, s28, 8
    s_lshl_b32 s3, s29, 5
    s_add_u32 s74, s74, s3
    v_mov_b32 v11, 158720
    v_mov_b32 v12, 1
    s_cmp_lt_u32 s30, 4
    s_cbranch_scc1 K_AUX_LO
    s_lshl_b32 s3, s30, 3
    s_add_u32 s3, s3, s74
    s_sub_u32 s3, s3, 32
    v_lshrrev_b32 v8, 3, v1
    v_add_u32 v8, s3, v8
    v_and_b32 v10, 7, v1
    v_lshlrev_b32 v10, 4, v10
    v_mul_u32_u24 v9, 1280, v8
    v_add_u32 v9, v9, v10
    s_waitcnt lgkmcnt(0)
    buffer_load_dwordx4 v[16:19], v9, s[12:15], 0 offen offset:0
    buffer_load_dwordx4 v[20:23], v9, s[12:15], 0 offen offset:128
    buffer_load_dwordx4 v[24:27], v9, s[12:15], 0 offen offset:256
    buffer_load_dwordx4 v[28:31], v9, s[12:15], 0 offen offset:384
    buffer_load_dwordx4 v[32:35], v9, s[12:15], 0 offen offset:512
    buffer_load_dwordx4 v[36:39], v9, s[12:15], 0 offen offset:640
    buffer_load_dwordx4 v[40:43], v9, s[12:15], 0 offen offset:768
    buffer_load_dwordx4 v[44:47], v9, s[12:15], 0 offen offset:896
    buffer_load_dwordx4 v[48:51], v9, s[12:15], 0 offen offset:1024
    buffer_load_dwordx4 v[52:55], v9, s[12:15], 0 offen offset:1152
    s_mov_b32 s16, s48
    s_mov_b32 s17, s49
    s_mov_b32 s18, 0x500
    s_mov_b32 s19, 0x20000
    s_mov_b32 s20, s56
    s_mov_b32 s21, s57
    s_mov_b32 s22, 0x500
    s_mov_b32 s23, 0x20000
    buffer_load_dwordx4 v[56:59], v10, s[16:19], 0 offen offset:0
    buffer_load_dwordx4 v[60:63], v10, s[16:19], 0 offen offset:128
    buffer_load_dwordx4 v[64:67], v10, s[16:19], 0 offen offset:256
    buffer_load_dwordx4 v[68:71], v10, s[16:19], 0 offen offset:384
    buffer_load_dwordx4 v[72:75], v10, s[16:19], 0 offen offset:512
    buffer_load_dwordx4 v[76:79], v10, s[16:19], 0 offen offset:640
    buffer_load_dwordx4 v[80:83], v10, s[16:19], 0 offen offset:768
    buffer_load_dwordx4 v[84:87], v10, s[16:19], 0 offen offset:896
    buffer_load_dwordx4 v[88:91], v10, s[16:19], 0 offen offset:1024
    buffer_load_dwordx4 v[92:95], v10, s[16:19], 0 offen offset:1152
    buffer_load_dwordx4 v[96:99], v10, s[20:23], 0 offen offset:0
    buffer_load_dwordx4 v[100:103], v10, s[20:23], 0 offen offset:128
    buffer_load_dwordx4 v[104:107], v10, s[20:23], 0 offen offset:256
    buffer_load_dwordx4 v[108:111], v10, s[20:23], 0 offen offset:384
    buffer_load_dwordx4 v[112:115], v10, s[20:23], 0 offen offset:512
    buffer_load_dwordx4 v[116:119], v10, s[20:23], 0 offen offset:640
    buffer_load_dwordx4 v[120:123], v10, s[20:23], 0 offen offset:768
    buffer_load_dwordx4 v[124:127], v10, s[20:23], 0 offen offset:896
    buffer_load_dwordx4 v[128:131], v10, s[20:23], 0 offen offset:1024
    buffer_load_dwordx4 v[132:135], v10, s[20:23], 0 offen offset:1152
    s_barrier
    v_mov_b32 v180, 0
    v_mov_b32 v181, 0
    v_mov_b32 v182, 0
    v_mov_b32 v183, 0
    v_and_b32 v9, 31, v8
    v_lshlrev_b32 v9, 2, v9
    v_add_u32 v9, 122880, v9
    v_sub_u32 v4, 0x87ff, v8
    s_setprio 2
    s_waitcnt vmcnt(10)
    v_dot2c_f32_bf16 v180, v16, v56
    v_dot2c_f32_bf16 v181, v17, v57
    v_dot2c_f32_bf16 v180, v18, v58
    v_dot2c_f32_bf16 v181, v19, v59
    v_dot2c_f32_bf16 v180, v20, v60
    v_dot2c_f32_bf16 v181, v21, v61
    v_dot2c_f32_bf16 v180, v22, v62
    v_dot2c_f32_bf16 v181, v23, v63
    v_dot2c_f32_bf16 v180, v24, v64
    v_dot2c_f32_bf16 v181, v25, v65
    v_dot2c_f32_bf16 v180, v26, v66
    v_dot2c_f32_bf16 v181, v27, v67
    v_dot2c_f32_bf16 v180, v28, v68
    v_dot2c_f32_bf16 v181, v29, v69
    v_dot2c_f32_bf16 v180, v30, v70
    v_dot2c_f32_bf16 v181, v31, v71
    v_dot2c_f32_bf16 v180, v32, v72
    v_dot2c_f32_bf16 v181, v33, v73
    v_dot2c_f32_bf16 v180, v34, v74
    v_dot2c_f32_bf16 v181, v35, v75
    v_dot2c_f32_bf16 v180, v36, v76
    v_dot2c_f32_bf16 v181, v37, v77
    v_dot2c_f32_bf16 v180, v38, v78
    v_dot2c_f32_bf16 v181, v39, v79
    v_dot2c_f32_bf16 v180, v40, v80
    v_dot2c_f32_bf16 v181, v41, v81
    v_dot2c_f32_bf16 v180, v42, v82
    v_dot2c_f32_bf16 v181, v43, v83
    v_dot2c_f32_bf16 v180, v44, v84
    v_dot2c_f32_bf16 v181, v45, v85
    v_dot2c_f32_bf16 v180, v46, v86
    v_dot2c_f32_bf16 v181, v47, v87
    v_dot2c_f32_bf16 v180, v48, v88
    v_dot2c_f32_bf16 v181, v49, v89
    v_dot2c_f32_bf16 v180, v50, v90
    v_dot2c_f32_bf16 v181, v51, v91
    v_dot2c_f32_bf16 v180, v52, v92
    v_dot2c_f32_bf16 v181, v53, v93
    v_dot2c_f32_bf16 v180, v54, v94
    v_dot2c_f32_bf16 v181, v55, v95
    s_waitcnt vmcnt(0)
    v_dot2c_f32_bf16 v182, v16, v96
    v_dot2c_f32_bf16 v183, v17, v97
    v_dot2c_f32_bf16 v182, v18, v98
    v_dot2c_f32_bf16 v183, v19, v99
    v_dot2c_f32_bf16 v182, v20, v100
    v_dot2c_f32_bf16 v183, v21, v101
    v_dot2c_f32_bf16 v182, v22, v102
    v_dot2c_f32_bf16 v183, v23, v103
    v_dot2c_f32_bf16 v182, v24, v104
    v_dot2c_f32_bf16 v183, v25, v105
    v_dot2c_f32_bf16 v182, v26, v106
    v_dot2c_f32_bf16 v183, v27, v107
    v_dot2c_f32_bf16 v182, v28, v108
    v_dot2c_f32_bf16 v183, v29, v109
    v_dot2c_f32_bf16 v182, v30, v110
    v_dot2c_f32_bf16 v183, v31, v111
    v_dot2c_f32_bf16 v182, v32, v112
    v_dot2c_f32_bf16 v183, v33, v113
    v_dot2c_f32_bf16 v182, v34, v114
    v_dot2c_f32_bf16 v183, v35, v115
    v_dot2c_f32_bf16 v182, v36, v116
    v_dot2c_f32_bf16 v183, v37, v117
    v_dot2c_f32_bf16 v182, v38, v118
    v_dot2c_f32_bf16 v183, v39, v119
    v_dot2c_f32_bf16 v182, v40, v120
    v_dot2c_f32_bf16 v183, v41, v121
    v_dot2c_f32_bf16 v182, v42, v122
    v_dot2c_f32_bf16 v183, v43, v123
    v_dot2c_f32_bf16 v182, v44, v124
    v_dot2c_f32_bf16 v183, v45, v125
    v_dot2c_f32_bf16 v182, v46, v126
    v_dot2c_f32_bf16 v183, v47, v127
    v_dot2c_f32_bf16 v182, v48, v128
    v_dot2c_f32_bf16 v183, v49, v129
    v_dot2c_f32_bf16 v182, v50, v130
    v_dot2c_f32_bf16 v183, v51, v131
    v_dot2c_f32_bf16 v182, v52, v132
    v_dot2c_f32_bf16 v183, v53, v133
    v_dot2c_f32_bf16 v182, v54, v134
    v_dot2c_f32_bf16 v183, v55, v135
    s_nop 2
    v_add_f32 v180, v180, v181
    v_add_f32 v182, v182, v183
    s_nop 0
    v_add_f32_dpp v180, v180, v180 quad_perm:[1,0,3,2] row_mask:0xf bank_mask:0xf
    v_add_f32_dpp v182, v182, v182 quad_perm:[1,0,3,2] row_mask:0xf bank_mask:0xf
    s_nop 0
    v_add_f32_dpp v180, v180, v180 quad_perm:[2,3,0,1] row_mask:0xf bank_mask:0xf
    v_add_f32_dpp v182, v182, v182 quad_perm:[2,3,0,1] row_mask:0xf bank_mask:0xf
    s_nop 0
    v_add_f32_dpp v180, v180, v180 row_half_mirror row_mask:0xf bank_mask:0xf
    v_add_f32_dpp v182, v182, v182 row_half_mirror row_mask:0xf bank_mask:0xf
    v_cvt_pk_bf16_f32 v2, v180, v180
    v_lshlrev_b32 v2, 16, v2
    v_ashrrev_i32 v3, 31, v2
    v_or_b32 v3, 0x80000000, v3
    v_xor_b32 v2, v2, v3
    v_and_b32 v2, 0xffff0000, v2
    v_or_b32 v2, v2, v4
    ds_write2_b32 v9, v2, v182 offset0:0 offset1:32
    s_mov_b64 exec, 1
    ds_add_u32 v11, v12 offset:36
    s_mov_b64 exec, -1
    s_setprio 0
    s_cmp_lg_u32 s44, 63
    s_cbranch_scc1 K_FFN_C
    s_cmp_lg_u32 s30, 6
    s_cbranch_scc1 K_P2
    v_and_b32 v4, 7, v1
    v_lshlrev_b32 v4, 2, v4
    s_mov_b32 s3, 131072
K_ZPOLL6:
    v_cmp_eq_u32 vcc, 0, v7
    s_cbranch_vccz K_ZOK6
    s_sub_u32 s3, s3, 1
    s_cbranch_scc1 K_ZOK6
    global_load_dword v7, v4, s[8:9] offset:192 sc1
    s_waitcnt vmcnt(0)
    s_branch K_ZPOLL6
K_ZOK6:
    v_mov_b32 v7, 0
    s_branch K_P2
K_AUX_LO:
    s_waitcnt lgkmcnt(0)
    s_cmp_eq_u32 s30, 0
    s_cbranch_scc1 K_AUX_PUB
    s_cmp_eq_u32 s44, 63
    s_cbranch_scc1 K_AUX_NOF
    s_and_b32 s3, s44, 1
    s_cmp_eq_u32 s3, 0
    s_cselect_b64 s[60:61], s[50:51], s[52:53]
    s_cselect_b64 s[64:65], s[52:53], s[50:51]
    s_cselect_b32 s75, 0, 40960
    s_mov_b32 s62, 0x21c000
    s_mov_b32 s63, 0x20000
    s_mov_b32 s66, 0x21c000
    s_mov_b32 s67, 0x20000
    v_lshrrev_b32 v2, 2, v1
    v_mul_u32_u24 v184, 3456, v2
    v_and_b32 v2, 3, v1
    v_lshl_add_u32 v184, v2, 4, v184
    s_lshl_b32 s72, s44, 6
    v_add_u32 v184, s72, v184
    s_sub_u32 s74, s30, 1
K_FSA0:
    s_lshl_b32 s73, s74, 10
    s_mul_i32 s72, s74, 55296
    s_add_u32 m0, s73, s75
    s_waitcnt vmcnt(5)
    buffer_load_dwordx4 v184, s[60:63], s72 offen lds
    s_add_u32 s74, s74, 3
    s_cmp_lt_u32 s74, 18
    s_cbranch_scc1 K_FSA0
    s_barrier
K_FSA:
    s_lshl_b32 s73, s74, 10
    s_mul_i32 s72, s74, 55296
    s_add_u32 m0, s73, s75
    s_waitcnt vmcnt(5)
    buffer_load_dwordx4 v184, s[60:63], s72 offen lds
    s_add_u32 s74, s74, 3
    s_cmp_lt_u32 s74, 40
    s_cbranch_scc1 K_FSA
    s_sub_u32 s74, s74, 40
    s_xor_b32 s75, s75, 40960
    s_mov_b32 s68, s54
    s_mov_b32 s69, s55
    s_mov_b32 s70, 0x21c000
    s_mov_b32 s71, 0x20000
    s_mul_i32 s3, s44, 40960
    v_lshl_add_u32 v185, v1, 4, s3
K_FSB:
    s_lshl_b32 s73, s74, 10
    s_mul_i32 s72, s74, 55296
    s_add_u32 m0, s73, s75
    s_waitcnt vmcnt(5)
    buffer_load_dwordx4 v184, s[64:67], s72 offen lds
    s_add_u32 s74, s74, 3
    s_cmp_lt_u32 s74, 40
    s_cbranch_scc1 K_FSB
    s_sub_u32 s74, s74, 40
    s_mov_b32 s75, 81920
K_FSD0:
    s_lshl_b32 s73, s74, 10
    s_mul_i32 s72, s74, 1024
    s_add_u32 m0, s73, s75
    s_waitcnt vmcnt(5)
    buffer_load_dwordx4 v185, s[68:71], s72 offen lds
    s_add_u32 s74, s74, 3
    s_cmp_lt_u32 s74, 18
    s_cbranch_scc1 K_FSD0
    s_waitcnt vmcnt(6)
    s_mov_b64 exec, 1
    ds_add_u32 v11, v12 offset:56
    s_mov_b64 exec, -1
K_FSD:
    s_lshl_b32 s73, s74, 10
    s_mul_i32 s72, s74, 1024
    s_add_u32 m0, s73, s75
    s_waitcnt vmcnt(5)
    buffer_load_dwordx4 v185, s[68:71], s72 offen lds
    s_add_u32 s74, s74, 3
    s_cmp_lt_u32 s74, 40
    s_cbranch_scc1 K_FSD
    s_mul_i32 s3, s29, 96
    s_lshl_b32 s72, s30, 5
    s_add_u32 s3, s3, s72
    s_sub_u32 s3, s3, 128
    v_lshrrev_b32 v2, 1, v1
    v_add_u32 v2, s3, v2
    v_mul_u32_u24 v2, 1280, v2
    v_and_b32 v3, 1, v1
    v_lshl_add_u32 v2, v3, 7, v2
    buffer_load_dword v6, v2, s[24:27], 0 offen offset:1024
K_AUX_WR:
    s_mov_b32 s3, 1048576
K_FGR:
    ds_read_b32 v2, v11 offset:60
    s_sleep 2
    s_sub_u32 s3, s3, 1
    s_waitcnt lgkmcnt(0)
    v_readfirstlane_b32 s33, v2
    s_nop 3
    s_cselect_b32 s33, 4, s33
    s_cmp_lt_u32 s33, 4
    s_cbranch_scc1 K_FGR
    s_branch K_P2
K_AUX_NOF:
    s_cmp_lg_u32 s2, 63
    s_cbranch_scc1 K_AUX_NOZ
    s_cmp_lg_u32 s30, 1
    s_cbranch_scc1 K_AUX_NOZ
    s_add_u32 s60, s10, 0x80000
    s_addc_u32 s61, s11, 0
    s_mov_b32 s62, 0xc000
    s_mov_b32 s63, 0x20000
    s_barrier
    s_mov_b32 s3, 1048576
K_FGZ:
    ds_read_b32 v2, v11 offset:36
    s_sleep 2
    s_sub_u32 s3, s3, 1
    s_waitcnt lgkmcnt(0)
    v_readfirstlane_b32 s33, v2
    s_nop 3
    s_cselect_b32 s33, 4, s33
    s_cmp_lt_u32 s33, 4
    s_cbranch_scc1 K_FGZ
    v_and_b32 v4, 7, v1
    v_lshlrev_b32 v4, 2, v4
    s_mov_b32 s3, 131072
K_ZPOLL4:
    v_cmp_eq_u32 vcc, 0, v7
    s_cbranch_vccz K_ZOK4
    s_sub_u32 s3, s3, 1
    s_cbranch_scc1 K_ZOK4
    global_load_dword v7, v4, s[8:9] offset:192 sc1
    s_waitcnt vmcnt(0)
    s_branch K_ZPOLL4
K_ZOK4:
    v_lshlrev_b32 v4, 3, v1
    s_mov_b32 s72, 43008
    s_mov_b32 s3, 131072
    s_setprio 3
K_AGG_POLL:
    buffer_load_dwordx2 v[176:177], v4, s[60:63], s72 offen sc1
    s_waitcnt vmcnt(0)
    v_min_u32 v2, v176, v177
    v_cmp_eq_u32 vcc, 0, v2
    s_cbranch_vccz K_AGG_GOT
    s_sleep 2
    s_sub_u32 s3, s3, 1
    s_cmp_lg_u32 s3, 0
    s_cbranch_scc1 K_AGG_POLL
K_AGG_GOT:
    s_nop 1
    v_max_u32_dpp v3, v176, v176 quad_perm:[1,0,3,2] row_mask:0xf bank_mask:0xf
    s_nop 1
    v_max_u32_dpp v3, v3, v3 quad_perm:[2,3,0,1] row_mask:0xf bank_mask:0xf
    s_nop 1
    v_max_u32_dpp v3, v3, v3 row_half_mirror row_mask:0xf bank_mask:0xf
    s_nop 1
    v_max_u32_dpp v3, v3, v3 row_mirror row_mask:0xf bank_mask:0xf
    s_nop 1
    v_readlane_b32 s74, v3, 0
    v_readlane_b32 s76, v3, 16
    v_readlane_b32 s77, v3, 32
    v_readlane_b32 s78, v3, 48
    s_nop 3
    s_max_u32 s74, s74, s76
    s_max_u32 s77, s77, s78
    s_max_u32 s74, s74, s77
    v_cmp_ne_u32 vcc, s74, v176
    s_nop 1
    v_cndmask_b32 v2, v177, v176, vcc
    s_nop 1
    v_max_u32_dpp v3, v2, v2 quad_perm:[1,0,3,2] row_mask:0xf bank_mask:0xf
    s_nop 1
    v_max_u32_dpp v3, v3, v3 quad_perm:[2,3,0,1] row_mask:0xf bank_mask:0xf
    s_nop 1
    v_max_u32_dpp v3, v3, v3 row_half_mirror row_mask:0xf bank_mask:0xf
    s_nop 1
    v_max_u32_dpp v3, v3, v3 row_mirror row_mask:0xf bank_mask:0xf
    s_nop 1
    v_readlane_b32 s75, v3, 0
    v_readlane_b32 s76, v3, 16
    v_readlane_b32 s77, v3, 32
    v_readlane_b32 s78, v3, 48
    s_nop 3
    s_max_u32 s75, s75, s76
    s_max_u32 s77, s77, s78
    s_max_u32 s75, s75, s77
    v_mov_b32 v176, s74
    v_mov_b32 v177, s75
    s_mov_b32 s62, 40960
    v_lshlrev_b32 v3, 8, v1
    s_mov_b32 s3, 0
    buffer_store_dwordx2 v[176:177], v3, s[60:63], s3 offen offset:128 sc1
    s_mov_b32 s3, 16384
    buffer_store_dwordx2 v[176:177], v3, s[60:63], s3 offen offset:128 sc1
    s_mov_b32 s3, 32768
    buffer_store_dwordx2 v[176:177], v3, s[60:63], s3 offen offset:128 sc1
    s_setprio 0
    s_branch K_AUX_NOK
K_AUX_NOZ:
    s_barrier
K_AUX_NOK:
    s_mov_b32 s3, 1048576
K_FGWD:
    ds_read_b32 v2, v11 offset:48
    s_sleep 4
    s_sub_u32 s3, s3, 1
    s_waitcnt lgkmcnt(0)
    v_readfirstlane_b32 s33, v2
    s_nop 3
    s_cselect_b32 s33, 1, s33
    s_cmp_lt_u32 s33, 1
    s_cbranch_scc1 K_FGWD
    s_branch K_P2
K_AUX_PUB:
    s_add_u32 s60, s10, 0x1000
    s_addc_u32 s61, s11, 0
    s_mov_b32 s62, 0x2000
    s_mov_b32 s63, 0x20000
    v_and_b32 v3, 31, v1
    v_lshlrev_b32 v9, 2, v3
    v_add_u32 v10, 122880, v9
    s_lshl_b32 s72, s74, 2
    s_lshl_b32 s3, s2, 3
    s_add_u32 s3, s3, 567296
    v_mov_b32 v8, s3
    v_and_b32 v5, 7, v1
    v_lshlrev_b32 v5, 2, v5
    s_barrier
    s_setprio 3
    s_mov_b32 s3, 1048576
K_FGRT:
    ds_read_b32 v2, v11 offset:36
    s_sleep 0
    s_sub_u32 s3, s3, 1
    s_waitcnt lgkmcnt(0)
    v_readfirstlane_b32 s33, v2
    s_nop 3
    s_cselect_b32 s33, 4, s33
    s_cmp_lt_u32 s33, 4
    s_cbranch_scc1 K_FGRT
    ds_read2_b32 v[176:177], v10 offset0:0 offset1:32
    global_load_dword v7, v5, s[8:9] offset:192 sc1
    s_waitcnt lgkmcnt(0)
    v_cvt_pk_bf16_f32 v177, v177, v177
    v_lshlrev_b32 v177, 16, v177
    v_mul_f32 v5, 0xbfb8aa3b, v177
    v_exp_f32 v5, v5
    s_nop 0
    v_add_f32 v5, 1.0, v5
    v_rcp_f32 v177, v5
    s_nop 0
    v_cvt_pk_bf16_f32 v177, v177, v177
    v_lshlrev_b32 v177, 16, v177
    s_mov_b32 exec_hi, 0
    buffer_store_dword v177, v9, s[60:63], s72 offen sc1
    s_mov_b64 exec, -1
    s_nop 1
    v_max_u32_dpp v3, v176, v176 quad_perm:[1,0,3,2] row_mask:0xf bank_mask:0xf
    s_nop 1
    v_max_u32_dpp v3, v3, v3 quad_perm:[2,3,0,1] row_mask:0xf bank_mask:0xf
    s_nop 1
    v_max_u32_dpp v3, v3, v3 row_half_mirror row_mask:0xf bank_mask:0xf
    s_nop 1
    v_max_u32_dpp v3, v3, v3 row_mirror row_mask:0xf bank_mask:0xf
    s_nop 1
    v_readlane_b32 s74, v3, 0
    v_readlane_b32 s76, v3, 16
    v_readlane_b32 s77, v3, 32
    v_readlane_b32 s78, v3, 48
    s_nop 3
    s_max_u32 s74, s74, s76
    s_max_u32 s77, s77, s78
    s_max_u32 s74, s74, s77
    v_cmp_ne_u32 vcc, s74, v176
    s_nop 1
    v_cndmask_b32 v176, 0, v176, vcc
    s_nop 1
    v_max_u32_dpp v3, v176, v176 quad_perm:[1,0,3,2] row_mask:0xf bank_mask:0xf
    s_nop 1
    v_max_u32_dpp v3, v3, v3 quad_perm:[2,3,0,1] row_mask:0xf bank_mask:0xf
    s_nop 1
    v_max_u32_dpp v3, v3, v3 row_half_mirror row_mask:0xf bank_mask:0xf
    s_nop 1
    v_max_u32_dpp v3, v3, v3 row_mirror row_mask:0xf bank_mask:0xf
    s_nop 1
    v_readlane_b32 s75, v3, 0
    v_readlane_b32 s76, v3, 16
    v_readlane_b32 s77, v3, 32
    v_readlane_b32 s78, v3, 48
    s_nop 3
    s_max_u32 s75, s75, s76
    s_max_u32 s77, s77, s78
    s_max_u32 s75, s75, s77
    v_mov_b32 v176, s74
    v_mov_b32 v177, s75
    s_waitcnt vmcnt(0)
    v_and_b32 v4, 7, v1
    v_lshlrev_b32 v4, 2, v4
    s_mov_b32 s3, 131072
K_ZPOLL3:
    v_cmp_eq_u32 vcc, 0, v7
    s_cbranch_vccz K_ZOK3
    s_sub_u32 s3, s3, 1
    s_cbranch_scc1 K_ZOK3
    global_load_dword v7, v4, s[8:9] offset:192 sc1
    s_waitcnt vmcnt(0)
    s_branch K_ZPOLL3
K_ZOK3:
    s_mov_b64 exec, 1
    global_store_dwordx2 v8, v[176:177], s[10:11] sc1
    s_mov_b64 exec, -1
    v_and_b32 v3, 1, v1
    v_lshl_add_u32 v3, v3, 2, s42
    v_lshlrev_b32 v9, 4, v1
    s_mov_b32 s3, 131072
K_AUX_POLL:
    s_sleep 6
    global_load_dword v2, v3, s[10:11] offset:128 sc1
    s_waitcnt vmcnt(0)
    v_cmp_eq_u32 vcc, 0, v2
    s_cbranch_vccz K_AUX_GOT
    s_sub_u32 s3, s3, 1
    s_cmp_lg_u32 s3, 0
    s_cbranch_scc1 K_AUX_POLL
K_AUX_GOT:
    v_readlane_b32 s74, v2, 0
    v_readlane_b32 s75, v2, 1
    s_nop 3
    s_and_b32 s74, s74, 0x7ff
    s_sub_u32 s74, 2047, s74
    s_mul_i32 s74, s74, 1280
    s_mov_b32 m0, 125184
    s_nop 0
    buffer_load_dwordx4 v9, s[12:15], s74 offen lds
    s_mov_b64 exec, 0xffff
    buffer_load_dwordx4 v9, s[12:15], s74 offen offset:1024 lds
    s_mov_b64 exec, -1
    s_and_b32 s75, s75, 0x7ff
    s_sub_u32 s75, 2047, s75
    s_mul_i32 s75, s75, 1280
    s_mov_b32 m0, 126528
    s_nop 0
    buffer_load_dwordx4 v9, s[12:15], s75 offen lds
    s_mov_b64 exec, 0xffff
    buffer_load_dwordx4 v9, s[12:15], s75 offen offset:1024 lds
    s_mov_b64 exec, -1
    s_waitcnt vmcnt(0)
    ds_write_b32 v11, v12 offset:48
    s_setprio 0
    s_branch K_P2
.p2align 12
K_FFN_C:
    s_add_u32 s64, s10, 0x10000
    s_addc_u32 s65, s11, 0
    s_mov_b32 s66, 0x43800
    s_mov_b32 s67, 0x20000
    v_lshrrev_b32 v186, 4, v1
    v_bfe_u32 v2, v1, 2, 2
    v_lshl_add_u32 v2, v186, 3, v2
    v_and_b32 v3, 3, v1
    v_lshlrev_b32 v3, 3, v3
    v_lshl_add_u32 v187, v2, 6, v3
    s_bfe_u32 s3, s30, 0x10001
    s_mul_i32 s3, s3, 40960
    s_and_b32 s72, s30, 1
    s_lshl_b32 s72, s72, 5
    s_add_u32 s3, s3, s72
    s_add_u32 s3, s3, 0
    v_add_u32 v187, s3, v187
    v_mul_u32_u24 v188, 1280, v2
    s_and_b32 s3, s30, 3
    s_mul_i32 s3, s3, 320
    s_add_u32 s3, s3, 81920
    v_add3_u32 v188, v188, v3, s3
    v_and_b32 v2, 1, v1
    v_mul_u32_u24 v189, 1344, v2
    v_lshl_add_u32 v189, v186, 4, v189
    v_add_u32 v189, 125184, v189
    v_lshlrev_b32 v200, 6, v2
    v_lshl_add_u32 v200, v186, 4, v200
    s_and_b32 s3, s30, 3
    s_lshl_b32 s3, s3, 7
    v_add_u32 v201, s3, v200
    v_add_u32 v200, 123136, v201
    v_add_u32 v201, 124160, v201
    v_lshrrev_b32 v2, 5, v1
    v_bfe_u32 v3, v1, 4, 1
    v_lshl_add_u32 v3, v3, 1, v2
    v_lshlrev_b32 v3, 6, v3
    v_and_b32 v4, 15, v1
    v_lshl_add_u32 v3, v4, 2, v3
    v_add_u32 v202, 123136, v3
    v_lshlrev_b32 v4, 1, v1
    s_add_u32 s3, s3, 124160
    v_add_u32 v203, s3, v4
    v_and_b32 v2, 1, v1
    v_mul_u32_u24 v2, 2560, v2
    v_lshl_add_u32 v204, v186, 4, v2
    s_mul_i32 s3, s44, 5120
    s_and_b32 s72, s30, 3
    s_mul_i32 s72, s72, 640
    s_add_u32 s72, s72, s3
    v_lshlrev_b32 v2, 4, v1
    s_mov_b32 exec_hi, 0xff
    buffer_store_dwordx4 v[16:19], v2, s[64:67], s72 offen sc1
    buffer_store_dwordx4 v[16:19], v2, s[64:67], s72 offen offset:2560 sc1
    s_mov_b64 exec, -1
    s_cmp_lg_u32 s30, 4
    s_cbranch_scc1 K_WARMA0
    s_call_b64 s[38:39], WP_p2g
    s_branch K_WARMAX
K_WARMA0:
    s_cmp_lg_u32 s30, 5
    s_cbranch_scc1 K_WARMA1
    s_call_b64 s[38:39], WP_gen
    s_branch K_WARMAX
K_WARMA1:
    s_cmp_lg_u32 s30, 6
    s_cbranch_scc1 K_WARMA2
    s_call_b64 s[38:39], WP_help
    s_call_b64 s[38:39], WP_flags
    s_branch K_WARMAX
K_WARMA2:
    s_call_b64 s[38:39], WP_spin
K_WARMAX:
    s_mov_b32 s3, 1048576
K_FGD:
    ds_read_b32 v2, v11 offset:56
    s_sleep 2
    s_sub_u32 s3, s3, 1
    s_waitcnt lgkmcnt(0)
    v_readfirstlane_b32 s33, v2
    s_nop 3
    s_cselect_b32 s33, 3, s33
    s_cmp_lt_u32 s33, 3
    s_cbranch_scc1 K_FGD
    s_setprio 3
    ds_read_b64_tr_b16 v[16:17], v187 offset:0
    ds_read_b64_tr_b16 v[18:19], v187 offset:256
    ds_read_b64_tr_b16 v[20:21], v187 offset:2048
    ds_read_b64_tr_b16 v[22:23], v187 offset:2304
    ds_read_b64_tr_b16 v[24:25], v187 offset:4096
    ds_read_b64_tr_b16 v[26:27], v187 offset:4352
    ds_read_b64_tr_b16 v[28:29], v187 offset:6144
    ds_read_b64_tr_b16 v[30:31], v187 offset:6400
    ds_read_b64_tr_b16 v[32:33], v187 offset:8192
    ds_read_b64_tr_b16 v[34:35], v187 offset:8448
    ds_read_b64_tr_b16 v[36:37], v187 offset:10240
    ds_read_b64_tr_b16 v[38:39], v187 offset:10496
    ds_read_b64_tr_b16 v[40:41], v187 offset:12288
    ds_read_b64_tr_b16 v[42:43], v187 offset:12544
    ds_read_b64_tr_b16 v[44:45], v187 offset:14336
    ds_read_b64_tr_b16 v[46:47], v187 offset:14592
    ds_read_b64_tr_b16 v[48:49], v187 offset:16384
    ds_read_b64_tr_b16 v[50:51], v187 offset:16640
    ds_read_b64_tr_b16 v[52:53], v187 offset:18432
    ds_read_b64_tr_b16 v[54:55], v187 offset:18688
    ds_read_b64_tr_b16 v[56:57], v187 offset:20480
    ds_read_b64_tr_b16 v[58:59], v187 offset:20736
    ds_read_b64_tr_b16 v[60:61], v187 offset:22528
    ds_read_b64_tr_b16 v[62:63], v187 offset:22784
    ds_read_b64_tr_b16 v[64:65], v187 offset:24576
    ds_read_b64_tr_b16 v[66:67], v187 offset:24832
    ds_read_b64_tr_b16 v[68:69], v187 offset:26624
    ds_read_b64_tr_b16 v[70:71], v187 offset:26880
    ds_read_b64_tr_b16 v[72:73], v187 offset:28672
    ds_read_b64_tr_b16 v[74:75], v187 offset:28928
    ds_read_b64_tr_b16 v[76:77], v187 offset:30720
    ds_read_b64_tr_b16 v[78:79], v187 offset:30976
    ds_read_b64_tr_b16 v[80:81], v187 offset:32768
    ds_read_b64_tr_b16 v[82:83], v187 offset:33024
    ds_read_b64_tr_b16 v[84:85], v187 offset:34816
    ds_read_b64_tr_b16 v[86:87], v187 offset:35072
    ds_read_b64_tr_b16 v[88:89], v187 offset:36864
    ds_read_b64_tr_b16 v[90:91], v187 offset:37120
    ds_read_b64_tr_b16 v[92:93], v187 offset:38912
    ds_read_b64_tr_b16 v[94:95], v187 offset:39168
    s_waitcnt vmcnt(0) lgkmcnt(0)
    s_mov_b64 exec, 1
    ds_add_u32 v11, v12 offset:60
    s_mov_b64 exec, -1
    s_mov_b32 s3, 1048576
K_FGK:
    ds_read_b32 v2, v11 offset:48
    s_sleep 1
    s_sub_u32 s3, s3, 1
    s_waitcnt lgkmcnt(0)
    v_readfirstlane_b32 s33, v2
    s_nop 3
    s_cselect_b32 s33, 1, s33
    s_cmp_lt_u32 s33, 1
    s_cbranch_scc1 K_FGK
    ds_read_b128 v[96:99], v189 offset:0
    ds_read_b128 v[100:103], v189 offset:64
    ds_read_b128 v[104:107], v189 offset:128
    ds_read_b128 v[108:111], v189 offset:192
    ds_read_b128 v[112:115], v189 offset:256
    ds_read_b128 v[116:119], v189 offset:320
    ds_read_b128 v[120:123], v189 offset:384
    ds_read_b128 v[124:127], v189 offset:448
    ds_read_b128 v[128:131], v189 offset:512
    s_waitcnt lgkmcnt(8)
    v_mfma_f32_16x16x32_bf16 v[192:195], v[16:19], v[96:99], 0
    ds_read_b128 v[132:135], v189 offset:576
    s_waitcnt lgkmcnt(8)
    v_mfma_f32_16x16x32_bf16 v[196:199], v[20:23], v[100:103], 0
    ds_read_b128 v[136:139], v189 offset:640
    s_waitcnt lgkmcnt(8)
    v_mfma_f32_16x16x32_bf16 v[192:195], v[24:27], v[104:107], v[192:195]
    ds_read_b128 v[140:143], v189 offset:704
    s_waitcnt lgkmcnt(8)
    v_mfma_f32_16x16x32_bf16 v[196:199], v[28:31], v[108:111], v[196:199]
    ds_read_b128 v[144:147], v189 offset:768
    s_waitcnt lgkmcnt(8)
    v_mfma_f32_16x16x32_bf16 v[192:195], v[32:35], v[112:115], v[192:195]
    ds_read_b128 v[148:151], v189 offset:832
    s_waitcnt lgkmcnt(8)
    v_mfma_f32_16x16x32_bf16 v[196:199], v[36:39], v[116:119], v[196:199]
    ds_read_b128 v[152:155], v189 offset:896
    s_waitcnt lgkmcnt(8)
    v_mfma_f32_16x16x32_bf16 v[192:195], v[40:43], v[120:123], v[192:195]
    ds_read_b128 v[156:159], v189 offset:960
    s_waitcnt lgkmcnt(8)
    v_mfma_f32_16x16x32_bf16 v[196:199], v[44:47], v[124:127], v[196:199]
    ds_read_b128 v[160:163], v189 offset:1024
    s_waitcnt lgkmcnt(8)
    v_mfma_f32_16x16x32_bf16 v[192:195], v[48:51], v[128:131], v[192:195]
    ds_read_b128 v[164:167], v189 offset:1088
    s_waitcnt lgkmcnt(8)
    v_mfma_f32_16x16x32_bf16 v[196:199], v[52:55], v[132:135], v[196:199]
    ds_read_b128 v[168:171], v189 offset:1152
    s_waitcnt lgkmcnt(8)
    v_mfma_f32_16x16x32_bf16 v[192:195], v[56:59], v[136:139], v[192:195]
    ds_read_b128 v[172:175], v189 offset:1216
    s_waitcnt lgkmcnt(8)
    v_mfma_f32_16x16x32_bf16 v[196:199], v[60:63], v[140:143], v[196:199]
    s_waitcnt lgkmcnt(7)
    v_mfma_f32_16x16x32_bf16 v[192:195], v[64:67], v[144:147], v[192:195]
    s_waitcnt lgkmcnt(6)
    v_mfma_f32_16x16x32_bf16 v[196:199], v[68:71], v[148:151], v[196:199]
    s_waitcnt lgkmcnt(5)
    v_mfma_f32_16x16x32_bf16 v[192:195], v[72:75], v[152:155], v[192:195]
    s_waitcnt lgkmcnt(4)
    v_mfma_f32_16x16x32_bf16 v[196:199], v[76:79], v[156:159], v[196:199]
    s_waitcnt lgkmcnt(3)
    v_mfma_f32_16x16x32_bf16 v[192:195], v[80:83], v[160:163], v[192:195]
    s_waitcnt lgkmcnt(2)
    v_mfma_f32_16x16x32_bf16 v[196:199], v[84:87], v[164:167], v[196:199]
    s_waitcnt lgkmcnt(1)
    v_mfma_f32_16x16x32_bf16 v[192:195], v[88:91], v[168:171], v[192:195]
    s_waitcnt lgkmcnt(0)
    v_mfma_f32_16x16x32_bf16 v[196:199], v[92:95], v[172:175], v[196:199]
    v_mov_b32 v7, 1
    s_nop 6
    v_add_f32 v192, v192, v196
    v_add_f32 v193, v193, v197
    v_add_f32 v194, v194, v198
    v_add_f32 v195, v195, v199
    s_mov_b32 exec_lo, 0x00030003
    s_mov_b32 exec_hi, 0x00030003
    ds_write_b128 v200, v[192:195]
    s_mov_b64 exec, 1
    ds_add_u32 v11, v12 offset:52
    s_mov_b64 exec, -1
    s_cmp_lg_u32 s30, 6
    s_cbranch_scc1 K_NOS6B
    v_and_b32 v4, 1, v1
    v_lshl_add_u32 v4, v4, 2, s42
    global_load_dword v7, v4, s[10:11] offset:128 sc1
K_NOS6B:
    s_mov_b32 s3, 1048576
K_FGP:
    ds_read_b32 v2, v11 offset:52
    s_sleep 1
    s_sub_u32 s3, s3, 1
    s_waitcnt lgkmcnt(0)
    v_readfirstlane_b32 s33, v2
    s_nop 3
    s_cselect_b32 s33, 7, s33
    s_cmp_lt_u32 s33, 7
    s_cbranch_scc1 K_FGP
    ds_read_b32 v208, v202
    ds_read_b32 v210, v202 offset:256
    ds_read_b64_tr_b16 v[16:17], v188 offset:0
    ds_read_b64_tr_b16 v[18:19], v188 offset:5120
    ds_read_b64_tr_b16 v[20:21], v188 offset:32
    ds_read_b64_tr_b16 v[22:23], v188 offset:5152
    ds_read_b64_tr_b16 v[24:25], v188 offset:64
    ds_read_b64_tr_b16 v[26:27], v188 offset:5184
    ds_read_b64_tr_b16 v[28:29], v188 offset:96
    ds_read_b64_tr_b16 v[30:31], v188 offset:5216
    ds_read_b64_tr_b16 v[32:33], v188 offset:128
    ds_read_b64_tr_b16 v[34:35], v188 offset:5248
    ds_read_b64_tr_b16 v[36:37], v188 offset:160
    ds_read_b64_tr_b16 v[38:39], v188 offset:5280
    ds_read_b64_tr_b16 v[40:41], v188 offset:192
    ds_read_b64_tr_b16 v[42:43], v188 offset:5312
    s_waitcnt lgkmcnt(14)
    v_cvt_pk_bf16_f32 v208, v208, v208
    v_lshlrev_b32 v208, 16, v208
    v_cvt_pk_bf16_f32 v210, v210, v210
    v_lshlrev_b32 v210, 16, v210
    v_mul_f32 v209, 0xbfb8aa3b, v208
    v_exp_f32 v209, v209
    s_nop 0
    v_add_f32 v209, 1.0, v209
    v_rcp_f32 v209, v209
    s_nop 0
    v_mul_f32 v208, v208, v209
    v_cvt_pk_bf16_f32 v208, v208, v208
    v_lshlrev_b32 v208, 16, v208
    v_mul_f32 v208, v208, v210
    v_cvt_pk_bf16_f32 v208, v208, v208
    ds_write_b16 v203, v208
    s_waitcnt lgkmcnt(0)
    ds_read_b128 v[208:211], v201
    ds_read_b64_tr_b16 v[44:45], v188 offset:224
    ds_read_b64_tr_b16 v[46:47], v188 offset:5344
    ds_read_b64_tr_b16 v[48:49], v188 offset:256
    ds_read_b64_tr_b16 v[50:51], v188 offset:5376
    ds_read_b64_tr_b16 v[52:53], v188 offset:288
    ds_read_b64_tr_b16 v[54:55], v188 offset:5408
    s_waitcnt lgkmcnt(6)
    v_mfma_f32_16x16x32_bf16 v[96:99], v[16:19], v[208:211], 0
    v_mfma_f32_16x16x32_bf16 v[100:103], v[20:23], v[208:211], 0
    v_mfma_f32_16x16x32_bf16 v[104:107], v[24:27], v[208:211], 0
    v_mfma_f32_16x16x32_bf16 v[108:111], v[28:31], v[208:211], 0
    v_mfma_f32_16x16x32_bf16 v[112:115], v[32:35], v[208:211], 0
    v_mfma_f32_16x16x32_bf16 v[116:119], v[36:39], v[208:211], 0
    v_mfma_f32_16x16x32_bf16 v[120:123], v[40:43], v[208:211], 0
    s_waitcnt lgkmcnt(4)
    v_mfma_f32_16x16x32_bf16 v[124:127], v[44:47], v[208:211], 0
    s_waitcnt lgkmcnt(2)
    v_mfma_f32_16x16x32_bf16 v[128:131], v[48:51], v[208:211], 0
    s_waitcnt lgkmcnt(0)
    v_mfma_f32_16x16x32_bf16 v[132:135], v[52:55], v[208:211], 0
    s_mov_b32 exec_lo, 0x00030003
    s_mov_b32 exec_hi, 0x00030003
    buffer_store_dwordx4 v[96:99], v204, s[64:67], s72 offen offset:0 sc1
    buffer_store_dwordx4 v[100:103], v204, s[64:67], s72 offen offset:64 sc1
    buffer_store_dwordx4 v[104:107], v204, s[64:67], s72 offen offset:128 sc1
    buffer_store_dwordx4 v[108:111], v204, s[64:67], s72 offen offset:192 sc1
    buffer_store_dwordx4 v[112:115], v204, s[64:67], s72 offen offset:256 sc1
    buffer_store_dwordx4 v[116:119], v204, s[64:67], s72 offen offset:320 sc1
    buffer_store_dwordx4 v[120:123], v204, s[64:67], s72 offen offset:384 sc1
    buffer_store_dwordx4 v[124:127], v204, s[64:67], s72 offen offset:448 sc1
    buffer_store_dwordx4 v[128:131], v204, s[64:67], s72 offen offset:512 sc1
    buffer_store_dwordx4 v[132:135], v204, s[64:67], s72 offen offset:576 sc1
    s_mov_b64 exec, -1
    s_lshl_b32 s3, s44, 3
    s_add_u32 s3, s3, s30
    s_lshl_b32 s3, s3, 2
    s_add_u32 s3, s3, 565232
    v_mov_b32 v2, s3
    v_mov_b32 v3, 1
    s_waitcnt vmcnt(0)
    s_mov_b64 exec, 1
    global_store_dword v2, v3, s[10:11] sc1
    s_mov_b64 exec, -1
    s_branch K_P2
K_CODE_END:
.section .rodata,"a"
.p2align 6
.amdhsa_kernel gated_mix__sliding_local_dilated__moe_arch_mod__prompt_kernel
  .amdhsa_next_free_vgpr 248
  .amdhsa_next_free_sgpr 79
  .amdhsa_accum_offset 248
  .amdhsa_group_segment_fixed_size 0
  .amdhsa_kernarg_size 96
  .amdhsa_user_sgpr_count 2
  .amdhsa_user_sgpr_kernarg_segment_ptr 1
  .amdhsa_system_sgpr_workgroup_id_x 1
.end_amdhsa_kernel
```

```asm
; @launch grid=(256,1,1) block=(512,1,1) lds=163840
.amdgcn_target "amdgcn-amd-amdhsa--gfx950"
.text
.p2align 12
.p2align 8
.globl gated_mix__sliding_local_dilated__moe_arch_mod__prompt_kernel
.type gated_mix__sliding_local_dilated__moe_arch_mod__prompt_kernel,@function
gated_mix__sliding_local_dilated__moe_arch_mod__prompt_kernel:
    s_cmp_ge_u32 s2, 256
    s_cbranch_scc1 K_EXIT
    s_load_dwordx2 s[12:13], s[0:1], 0
    s_load_dwordx2 s[16:17], s[0:1], 8
    v_readfirstlane_b32 s30, v0
    s_load_dwordx4 s[8:11], s[0:1], 80
    s_load_dwordx2 s[24:25], s[0:1], 16
    s_load_dwordx2 s[6:7], s[0:1], 72
    s_and_b32 s28, s2, 7
    v_and_b32 v1, 63, v0
    s_mov_b32 s14, 0x280000
    s_mov_b32 s15, 0x20000
    s_lshr_b32 s30, s30, 6
    s_cmp_lt_u32 s2, 64
    s_cbranch_scc1 K_SLOW
    s_cmp_lt_u32 s30, 4
    s_cbranch_scc1 K_FAST
K_SLOW:
    s_getpc_b64 s[38:39]
K_PC:
    s_bfe_u32 s3, s2, 0x30003
    s_mul_i32 s3, s3, ((K_CODE_END-gated_mix__sliding_local_dilated__moe_arch_mod__prompt_kernel+1023)/1024)
    s_sub_u32 s38, s38, K_PC-gated_mix__sliding_local_dilated__moe_arch_mod__prompt_kernel
    s_subb_u32 s39, s39, 0
    v_subrev_u32 v3, 256, v0
    v_add_u32 v2, s3, v3
    v_lshlrev_b32 v2, 7, v2
    v_min_u32 v2, K_CODE_END-gated_mix__sliding_local_dilated__moe_arch_mod__prompt_kernel-4, v2
    v_cmp_gt_u32 vcc, ((K_CODE_END-gated_mix__sliding_local_dilated__moe_arch_mod__prompt_kernel+1023)/1024), v3
    s_and_saveexec_b64 s[4:5], vcc
    s_cbranch_execz K_NOPF
    global_load_dword v6, v2, s[38:39]
K_NOPF:
    s_mov_b64 exec, -1
    v_mov_b32 v2, 0
    v_mov_b32 v3, 158752
    ds_write2_b32 v3, v2, v2 offset0:0 offset1:1
    ds_write2_b32 v3, v2, v2 offset0:2 offset1:3
    ds_write2_b32 v3, v2, v2 offset0:4 offset1:5
    ds_write2_b32 v3, v2, v2 offset0:6 offset1:7
    ds_write2_b32 v3, v2, v2 offset0:8 offset1:9
    s_mov_b32 s43, 1
    s_lshl_b32 s3, s30, 8
    s_add_u32 s3, s3, s2
    s_lshr_b32 s3, s3, 3
    s_cmp_lg_u32 s3, 160
    s_cbranch_scc1 K_COMMON
    s_mul_i32 s3, s2, 6144
    s_add_u32 s3, s3, 527360
    v_lshl_add_u32 v6, v1, 4, s3
    v_mov_b64 v[28:29], 0
    v_mov_b64 v[30:31], 0
    s_waitcnt lgkmcnt(0)
    global_store_dwordx4 v6, v[28:31], s[10:11] offset:-3072 sc1
    global_store_dwordx4 v6, v[28:31], s[10:11] offset:-2048 sc1
    global_store_dwordx4 v6, v[28:31], s[10:11] offset:-1024 sc1
    global_store_dwordx4 v6, v[28:31], s[10:11] offset:0 sc1
    global_store_dwordx4 v6, v[28:31], s[10:11] offset:1024 sc1
    global_store_dwordx4 v6, v[28:31], s[10:11] offset:2048 sc1
    s_lshl_b32 s3, s2, 2
    v_mov_b32 v2, s3
    v_mov_b32 v3, 1
    s_mov_b64 exec, 1
    s_waitcnt vmcnt(0)
    global_store_dword v2, v3, s[8:9] offset:192 sc1
    s_mov_b64 exec, -1
    s_branch K_COMMON
K_FAST:
    s_lshr_b32 s32, s2, 1
    s_and_b32 s32, s32, 28
    v_lshrrev_b32 v3, 4, v1
    s_lshr_b32 s59, 0x82931560, s32
    s_and_b32 s59, s59, 15
    v_and_b32 v4, 7, v1
    s_lshr_b32 s3, s2, 6
    s_lshl2_add_u32 s59, s3, s59
    v_lshrrev_b32 v2, 3, v1
    s_add_u32 s59, s59, s28
    s_mul_i32 s33, s59, 205
    v_xor_b32 v4, v4, v3
    s_lshr_b32 s33, s33, 11
    s_mul_i32 s33, s33, 10
    v_mul_u32_u24 v2, 1280, v2
    s_sub_u32 s59, s59, s33
    s_lshr_b32 s53, s28, 1
    v_lshl_add_u32 v44, v4, 4, v2
    s_mul_i32 s53, s53, 675840
    s_mul_i32 s3, s3, 225280
    v_xor_b32 v45, 64, v44
    s_add_u32 s53, s53, s3
    s_mul_i32 s54, s30, 61440
    s_add_u32 s53, s53, s54
    s_sub_u32 s53, s53, 245760
    s_mul_i32 s55, s30, 6144
    s_add_u32 s55, s55, 40960
    s_lshl_b32 s57, s59, 7
    s_add_u32 s57, s57, s53
    s_waitcnt lgkmcnt(0)
    s_add_u32 m0, s55, 0
    s_max_i32 s60, s57, 0
    buffer_load_dwordx4 v44, s[12:15], s60 offen lds
    s_add_u32 s60, s57, 10240
    s_add_u32 m0, s55, 1024
    s_max_i32 s60, s60, 0
    buffer_load_dwordx4 v45, s[12:15], s60 offen lds
    s_add_u32 m0, s55, 2048
    s_add_u32 s60, s57, 20480
    buffer_load_dwordx4 v44, s[12:15], s60 offen lds
    s_add_u32 m0, s55, 3072
    s_add_u32 s60, s57, 30720
    buffer_load_dwordx4 v45, s[12:15], s60 offen lds
    s_add_u32 m0, s55, 4096
    s_add_u32 s60, s57, 40960
    buffer_load_dwordx4 v44, s[12:15], s60 offen lds
    s_add_u32 m0, s55, 5120
    s_add_u32 s60, s57, 51200
    buffer_load_dwordx4 v45, s[12:15], s60 offen lds
    v_lshlrev_b32 v2, 1, v3
    s_lshr_b32 s32, 0x64317520, s32
    v_sub_u32 v2, v1, v2
    s_and_b32 s32, s32, 7
    v_and_b32 v2, 15, v2
    s_and_b32 s3, s28, 1
    v_mul_u32_u24 v3, 3840, v3
    s_lshl3_add_u32 s32, s3, s32
    v_mul_u32_u24 v4, 13, v2
    s_mul_i32 s3, s32, 80
    v_lshrrev_b32 v4, 6, v4
    s_add_u32 s54, s54, s3
    v_mul_u32_u24 v4, 1200, v4
    s_lshl_b32 s56, s30, 12
    v_lshl_add_u32 v4, v2, 4, v4
    s_add_u32 s56, s56, 65536
    v_add_u32 v5, 1, v2
    s_mov_b32 s18, 0x258000
    v_and_b32 v5, 16, v5
    s_mov_b32 s19, 0x20000
    v_lshl_add_u32 v4, v5, 24, v4
    v_add_u32 v46, v3, v4
    s_mul_i32 s58, s59, 245760
    s_add_u32 s58, s58, s54
    s_add_u32 s59, s59, 1
    s_cmp_eq_u32 s59, 10
    s_cselect_b32 s59, 0, s59
    s_add_u32 m0, s56, 0
    s_add_u32 s60, s58, 0
    buffer_load_dwordx4 v46, s[16:19], s60 offen lds
    s_add_u32 m0, s56, 1024
    s_add_u32 s60, s58, 15360
    buffer_load_dwordx4 v46, s[16:19], s60 offen lds
    v_xor_b32 v2, 8, v2
    v_mul_u32_u24 v4, 13, v2
    v_lshrrev_b32 v4, 6, v4
    v_mul_u32_u24 v4, 1200, v4
    v_lshl_add_u32 v4, v2, 4, v4
    v_add_u32 v5, 1, v2
    v_and_b32 v5, 16, v5
    v_lshl_add_u32 v4, v5, 24, v4
    v_add_u32 v47, v3, v4
    s_add_u32 m0, s56, 2048
    s_add_u32 s60, s58, 30720
    buffer_load_dwordx4 v47, s[16:19], s60 offen lds
    s_add_u32 m0, s56, 3072
    s_add_u32 s60, s58, 46080
    buffer_load_dwordx4 v47, s[16:19], s60 offen lds
    s_mov_b32 s3, 40960
    s_cmp_ge_u32 s55, 81920
    s_cselect_b32 s60, -81920, s3
    s_add_u32 s55, s55, s60
    s_add_u32 s56, s56, s60
    s_lshl_b32 s57, s59, 7
    s_add_u32 s57, s57, s53
    s_mul_i32 s58, s59, 245760
    s_add_u32 s58, s58, s54
    s_add_u32 s59, s59, 1
    s_cmp_eq_u32 s59, 10
    s_cselect_b32 s59, 0, s59
    s_add_u32 m0, s56, 0
    s_add_u32 s60, s58, 0
    buffer_load_dwordx4 v46, s[16:19], s60 offen lds
    s_add_u32 m0, s55, 0
    s_max_i32 s60, s57, 0
    buffer_load_dwordx4 v44, s[12:15], s60 offen lds
    s_add_u32 m0, s56, 1024
    s_add_u32 s60, s58, 15360
    buffer_load_dwordx4 v46, s[16:19], s60 offen lds
    s_add_u32 s60, s57, 10240
    s_add_u32 m0, s55, 1024
    s_max_i32 s60, s60, 0
    buffer_load_dwordx4 v45, s[12:15], s60 offen lds
    s_add_u32 m0, s55, 2048
    s_add_u32 s60, s57, 20480
    buffer_load_dwordx4 v44, s[12:15], s60 offen lds
    s_mov_b32 s52, s30
    s_mov_b32 s43, 0
K_COMMON:
    v_mov_b32 v7, 0
    s_lshr_b32 s29, s2, 3
    s_xor_b32 s30, s30, 4
    s_mov_b32 s26, 0xc8000
    s_mov_b32 s27, 0x20000
    s_lshr_b32 s34, s29, 3
    s_lshl_b32 s34, s34, 2
    s_and_b32 s3, s29, 3
    s_add_u32 s34, s34, s3
    s_add_u32 s34, s34, 4
    s_bitcmp1_b32 s29, 2
    s_cselect_b32 s34, -1, s34
    s_cmp_lt_u32 s29, 8
    s_cselect_b32 s34, s29, s34
    s_lshl_b32 s40, s28, 1
    s_cmp_ge_u32 s34, 10
    s_addc_u32 s40, s40, 0
    s_sub_u32 s41, s34, 10
    s_cmp_ge_u32 s34, 10
    s_cselect_b32 s41, s41, s34
    s_mul_i32 s42, s28, 20
    s_add_u32 s42, s42, s34
    s_and_b32 s42, s42, 255
    s_lshl_b32 s42, s42, 8
    s_add_u32 s42, s42, 524288
    s_cmp_lt_u32 s29, 8
    s_cbranch_scc1 K_AUX
    s_lshr_b32 s31, s28, 1
    s_mul_i32 s31, s31, 3
    s_lshr_b32 s3, s29, 3
    s_add_u32 s31, s31, s3
    s_sub_u32 s31, s31, 1
    s_and_b32 s35, s29, 3
    s_and_b32 s3, s29, 4
    s_lshl_b32 s3, s3, 1
    s_add_u32 s35, s35, s3
    s_and_b32 s3, s28, 1
    s_lshl_b32 s3, s3, 2
    s_add_u32 s35, s35, s3
    v_and_b32 v9, 15, v1
    v_lshrrev_b32 v10, 4, v1
    v_bfe_u32 v11, v1, 2, 2
    v_and_b32 v12, 3, v1
    s_waitcnt lgkmcnt(0)
    s_add_u32 s20, s10, 0x100000
    s_addc_u32 s21, s11, 0
    s_mov_b32 s22, 0x280000
    s_mov_b32 s23, 0x20000
    s_and_b32 s3, s30, 3
    s_mul_i32 s3, s3, 3
    s_lshr_b32 s33, s30, 2
    s_lshl1_add_u32 s3, s33, s3
    s_mul_i32 s44, s31, 11
    s_add_u32 s44, s44, s3
    s_mul_i32 s3, s3, 4352
    s_add_u32 s3, s3, 81920
    v_mul_u32_u24 v14, 272, v9
    v_lshl_add_u32 v13, v10, 3, v14
    v_add_u32 v13, s3, v13
    v_add3_u32 v14, v14, 32, s3
    v_cmp_eq_u32 vcc, 0, v10
    v_add_u32 v2, 208, v14
    v_add_u32 v3, 0, v14
    v_add_u32 v4, 40, v14
    v_cndmask_b32 v19, v2, v3, vcc
    v_cndmask_b32 v20, v2, v4, vcc
    v_lshl_add_u32 v15, v10, 2, v11
    v_mul_u32_u24 v15, 272, v15
    v_add_u32 v5, s3, v15
    v_lshl_add_u32 v15, v12, 3, v5
    v_add_u32 v2, 240, v5
    v_add_u32 v3, 192, v5
    v_add_u32 v4, 232, v5
    v_cmp_eq_u32 vcc, 0, v12
    s_nop 1
    v_cndmask_b32 v21, v2, v3, vcc
    v_cmp_eq_u32 vcc, 1, v12
    s_nop 1
    v_cndmask_b32 v22, v2, v4, vcc
    v_cmp_eq_u32 vcc, 2, v12
    s_nop 1
    v_cndmask_b32 v23, v2, v3, vcc
    v_cmp_eq_u32 vcc, 3, v12
    s_nop 1
    v_cndmask_b32 v24, v2, v4, vcc
    s_lshl_b32 s3, s35, 10
    v_lshl_add_u32 v16, v1, 4, s3
    s_lshl_b32 s3, s35, 8
    s_add_u32 s3, s3, 16384
    v_lshl_add_u32 v17, v9, 4, s3
    v_and_b32 v2, 1, v10
    v_lshl_add_u32 v17, v2, 3, v17
    s_cmp_lt_u32 s30, 4
    s_cselect_b32 s3, 0, 0x800000
    s_add_u32 s3, s3, 20480
    v_lshrrev_b32 v2, 1, v10
    v_mad_u32_u24 v17, v2, s3, v17
    s_mul_i32 s50, s44, 20480
    s_add_u32 s51, s50, 20480
    v_mov_b32 v18, 0xf149f2ca
    v_lshlrev_b32 v2, 2, v10
    v_sub_u32 v2, v9, v2
    s_cmp_eq_u32 s44, 0
    s_cselect_b32 s3, 0xf149f2ca, 0
    v_subrev_u32 v3, 0, v2
    v_and_b32 v4, 0x80000001, v3
    v_cmp_eq_u32 vcc, 0, v4
    s_nop 1
    v_cndmask_b32 v32, v18, 0, vcc
    v_cmp_eq_u32 vcc, 0x80000000, v4
    s_nop 1
    v_cndmask_b32 v28, v18, 0, vcc
    v_add_f32 v36, s3, v28
    v_subrev_u32 v3, 1, v2
    v_and_b32 v4, 0x80000001, v3
    v_cmp_eq_u32 vcc, 0, v4
    s_nop 1
    v_cndmask_b32 v33, v18, 0, vcc
    v_cmp_eq_u32 vcc, 0x80000000, v4
    s_nop 1
    v_cndmask_b32 v29, v18, 0, vcc
    v_add_f32 v37, s3, v29
    v_subrev_u32 v3, 2, v2
    v_and_b32 v4, 0x80000001, v3
    v_cmp_eq_u32 vcc, 0, v4
    s_nop 1
    v_cndmask_b32 v34, v18, 0, vcc
    v_cmp_eq_u32 vcc, 0x80000000, v4
    s_nop 1
    v_cndmask_b32 v30, v18, 0, vcc
    v_add_f32 v38, s3, v30
    v_subrev_u32 v3, 3, v2
    v_and_b32 v4, 0x80000001, v3
    v_cmp_eq_u32 vcc, 0, v4
    s_nop 1
    v_cndmask_b32 v35, v18, 0, vcc
    v_cmp_eq_u32 vcc, 0x80000000, v4
    s_nop 1
    v_cndmask_b32 v31, v18, 0, vcc
    v_add_f32 v39, s3, v31
    v_mov_b32 v3, 0x0c0c0c0c
    v_mov_b32 v4, 0xc0c0100
    v_cmp_eq_u32 vcc, 0, v28
    v_mov_b32 v5, 0x1000c0c
    s_nop 0
    v_cndmask_b32 v3, v3, v4, vcc
    v_cmp_eq_u32 vcc, 0, v29
    s_nop 1
    v_cndmask_b32 v40, v3, v5, vcc
    v_mov_b32 v3, 0x0c0c0c0c
    v_mov_b32 v4, 0xc0c0302
    v_cmp_eq_u32 vcc, 0, v30
    v_mov_b32 v5, 0x3020c0c
    s_nop 0
    v_cndmask_b32 v3, v3, v4, vcc
    v_cmp_eq_u32 vcc, 0, v31
    s_nop 1
    v_cndmask_b32 v41, v3, v5, vcc
    v_mov_b32 v3, 0x0c0c0c0c
    v_mov_b32 v4, 0xc0c0100
    v_cmp_eq_u32 vcc, 0, v32
    v_mov_b32 v5, 0x1000c0c
    s_nop 0
    v_cndmask_b32 v3, v3, v4, vcc
    v_cmp_eq_u32 vcc, 0, v33
    s_nop 1
    v_cndmask_b32 v42, v3, v5, vcc
    v_mov_b32 v3, 0x0c0c0c0c
    v_mov_b32 v4, 0xc0c0302
    v_cmp_eq_u32 vcc, 0, v34
    v_mov_b32 v5, 0x3020c0c
    s_nop 0
    v_cndmask_b32 v3, v3, v4, vcc
    v_cmp_eq_u32 vcc, 0, v35
    s_nop 1
    v_cndmask_b32 v43, v3, v5, vcc
    s_mov_b32 s46, 0x3fb8aa3b
    s_mov_b32 s47, s46
    s_mov_b32 s48, 0x3e64f92e
    s_mov_b32 s49, s48
    s_mul_i32 s3, s31, 11
    s_add_u32 s33, s3, 10
    s_lshr_b32 s3, s3, 3
    s_lshr_b32 s33, s33, 3
    s_min_u32 s33, s33, 15
    s_sub_u32 s33, s33, s3
    s_add_u32 s33, s33, 1
    s_mul_i32 s33, s33, 10
    s_bfm_b32 s36, s33, 0
    v_mul_u32_u24 v2, 205, v1
    v_lshrrev_b32 v2, 11, v2
    v_add_u32 v2, s3, v2
    v_mul_u32_u24 v2, 1496, v2
    v_lshrrev_b32 v2, 11, v2
    v_sub_u32 v2, s31, v2
    v_and_b32 v2, 1, v2
    v_lshlrev_b32 v2, 6, v2
    v_lshl_add_u32 v2, v1, 8, v2
    s_mul_i32 s3, s3, 2560
    s_lshl_b32 s33, s35, 2
    s_add_u32 s3, s3, s33
    s_add_u32 s3, s3, 524288
    v_add_u32 v8, s3, v2
    s_cmp_eq_u32 s43, 1
    s_cbranch_scc1 K_CONS
    v_lshrrev_b32 v2, 3, v1
    v_mul_u32_u24 v2, 1280, v2
    v_lshrrev_b32 v3, 4, v1
    v_lshlrev_b32 v3, 1, v3
    v_and_b32 v4, 7, v1
    v_xor_b32 v3, v3, v4
    v_lshl_add_u32 v2, v3, 4, v2
    s_lshl_b32 s33, s41, 7
    v_add_u32 v18, s33, v2
    s_mov_b32 s61, 9
    s_mov_b32 s3, 40960
K_LOOP0:
    s_waitcnt vmcnt(5)
    s_barrier
    s_add_u32 m0, s56, 2048
    s_add_u32 s60, s58, 30720
    buffer_load_dwordx4 v47, s[16:19], s60 offen lds
    s_add_u32 m0, s55, 3072
    s_add_u32 s60, s57, 30720
    buffer_load_dwordx4 v45, s[12:15], s60 offen lds
    s_add_u32 m0, s56, 3072
    s_add_u32 s60, s58, 46080
    buffer_load_dwordx4 v47, s[16:19], s60 offen lds
    s_add_u32 m0, s55, 4096
    s_add_u32 s60, s57, 40960
    buffer_load_dwordx4 v44, s[12:15], s60 offen lds
    s_add_u32 m0, s55, 5120
    s_add_u32 s60, s57, 51200
    buffer_load_dwordx4 v45, s[12:15], s60 offen lds
    s_sub_u32 s61, s61, 1
    s_cmp_eq_u32 s61, 0
    s_cbranch_scc1 K_LOOPX
    s_cmp_ge_u32 s55, 81920
    s_cselect_b32 s60, -81920, s3
    s_add_u32 s55, s55, s60
    s_add_u32 s56, s56, s60
    s_lshl_b32 s57, s59, 7
    s_add_u32 s57, s57, s53
    s_mul_i32 s58, s59, 245760
    s_add_u32 s58, s58, s54
    s_add_u32 s59, s59, 1
    s_cmp_eq_u32 s59, 10
    s_cselect_b32 s59, 0, s59
    s_add_u32 m0, s56, 0
    s_add_u32 s60, s58, 0
    buffer_load_dwordx4 v46, s[16:19], s60 offen lds
    s_add_u32 m0, s55, 0
    s_max_i32 s60, s57, 0
    buffer_load_dwordx4 v44, s[12:15], s60 offen lds
    s_add_u32 m0, s56, 1024
    s_add_u32 s60, s58, 15360
    buffer_load_dwordx4 v46, s[16:19], s60 offen lds
    s_add_u32 s60, s57, 10240
    s_add_u32 m0, s55, 1024
    s_max_i32 s60, s60, 0
    buffer_load_dwordx4 v45, s[12:15], s60 offen lds
    s_add_u32 m0, s55, 2048
    s_add_u32 s60, s57, 20480
    buffer_load_dwordx4 v44, s[12:15], s60 offen lds
    s_branch K_LOOP0
K_LOOPX:
    v_and_b32 v2, 7, v1
    v_lshlrev_b32 v2, 2, v2
    s_waitcnt vmcnt(0)
    s_barrier
    s_cmp_lt_u32 s30, 6
    s_cbranch_scc1 K_NOSMP
    global_load_dword v7, v2, s[8:9] offset:192 sc1
K_NOSMP:
    s_cmp_eq_u32 s34, -1
    s_cbranch_scc1 K_JOIN_S
    s_cmp_lg_u32 s30, 7
    s_cbranch_scc1 K_WOE
    s_barrier
K_WOE:
    s_lshl_b32 s57, s52, 2
    s_lshr_b32 s57, 0x7520, s57
    s_and_b32 s57, s57, 7
    s_mul_i32 s57, s57, 51200
    s_mul_i32 s58, s52, 5120
    s_add_u32 s3, s57, 0
    s_add_u32 m0, s58, 0
    s_nop 0
    buffer_load_dwordx4 v18, s[24:27], s3 offen lds
    s_add_u32 s3, s57, 10240
    s_add_u32 m0, s58, 1024
    s_nop 0
    buffer_load_dwordx4 v18, s[24:27], s3 offen lds
    s_add_u32 s3, s57, 20480
    s_add_u32 m0, s58, 2048
    s_nop 0
    buffer_load_dwordx4 v18, s[24:27], s3 offen lds
    s_add_u32 s3, s57, 30720
    s_add_u32 m0, s58, 3072
    s_nop 0
    buffer_load_dwordx4 v18, s[24:27], s3 offen lds
    s_add_u32 s3, s57, 40960
    s_add_u32 m0, s58, 4096
    s_nop 0
    buffer_load_dwordx4 v18, s[24:27], s3 offen lds
    s_add_u32 s3, s57, 409600
    s_add_u32 m0, s58, 20480
    s_nop 0
    buffer_load_dwordx4 v18, s[24:27], s3 offen lds
    s_add_u32 s3, s57, 419840
    s_add_u32 m0, s58, 21504
    s_nop 0
    buffer_load_dwordx4 v18, s[24:27], s3 offen lds
    s_add_u32 s3, s57, 430080
    s_add_u32 m0, s58, 22528
    s_nop 0
    buffer_load_dwordx4 v18, s[24:27], s3 offen lds
    s_add_u32 s3, s57, 440320
    s_add_u32 m0, s58, 23552
    s_nop 0
    buffer_load_dwordx4 v18, s[24:27], s3 offen lds
    s_add_u32 s3, s57, 450560
    s_add_u32 m0, s58, 24576
    s_nop 0
    buffer_load_dwordx4 v18, s[24:27], s3 offen lds
    s_cmp_lg_u32 s30, 7
    s_cbranch_scc1 K_JOIN_S
    s_mov_b32 s52, 0
K_XD:
    s_lshl_b32 s57, s40, 3
    s_lshl1_add_u32 s57, s52, s57
    s_mul_i32 s57, s57, 20480
    s_lshl_b32 s33, s41, 7
    s_add_u32 s57, s57, s33
    s_lshl_b32 s33, s52, 12
    s_add_u32 m0, s33, 140288
    s_add_u32 s3, s57, 0
    buffer_load_dwordx4 v44, s[12:15], s3 offen lds
    s_add_u32 m0, s33, 141312
    s_add_u32 s3, s57, 10240
    buffer_load_dwordx4 v45, s[12:15], s3 offen lds
    s_add_u32 m0, s33, 142336
    s_add_u32 s3, s57, 20480
    buffer_load_dwordx4 v44, s[12:15], s3 offen lds
    s_add_u32 m0, s33, 143360
    s_add_u32 s3, s57, 30720
    buffer_load_dwordx4 v45, s[12:15], s3 offen lds
    s_add_u32 s52, s52, 1
    s_cmp_lt_u32 s52, 4
    s_cbranch_scc1 K_XD
    s_branch K_W7
.p2align 12
K_CONS:
    s_lshr_b32 s52, s30, 1
    s_and_b32 s53, s30, 1
    v_lshrrev_b32 v2, 1, v9
    v_xor_b32 v2, v2, v10
    v_lshlrev_b32 v2, 4, v2
    v_lshl_add_u32 v2, v9, 7, v2
    s_mul_i32 s3, s52, 12288
    v_add_u32 v44, s3, v2
    v_xor_b32 v45, 64, v44
    v_add_u32 v46, 81920, v44
    v_add_u32 v47, 81920, v45
    v_and_b32 v2, 1, v10
    v_lshl_or_b32 v2, v2, 2, v11
    v_lshl_add_u32 v3, v10, 3, v11
    v_lshlrev_b32 v3, 8, v3
    v_lshl_add_u32 v3, v12, 3, v3
    v_add_u32 v3, 24576, v3
    s_lshl_b32 s3, s53, 2
    v_add_u32 v2, s3, v2
    v_add_u32 v4, 0, v2
    v_and_b32 v4, 7, v4
    v_lshl_add_u32 v48, v4, 5, v3
    v_add_u32 v52, 81920, v48
    v_add_u32 v4, 1, v2
    v_and_b32 v4, 7, v4
    v_lshl_add_u32 v49, v4, 5, v3
    v_add_u32 v53, 81920, v49
    v_add_u32 v4, 2, v2
    v_and_b32 v4, 7, v4
    v_lshl_add_u32 v50, v4, 5, v3
    v_add_u32 v54, 81920, v50
    v_add_u32 v4, 3, v2
    v_and_b32 v4, 7, v4
    v_lshl_add_u32 v51, v4, 5, v3
    v_add_u32 v55, 81920, v51
    v_mul_u32_u24 v56, 272, v9
    v_lshl_add_u32 v56, v10, 3, v56
    s_mul_i32 s3, s52, 26112
    s_lshl_b32 s33, s53, 7
    s_add_u32 s3, s3, s33
    s_add_u32 s3, s3, 81920
    v_add_u32 v56, s3, v56
    v_mov_b64 v[60:61], 0
    v_mov_b64 v[62:63], 0
    v_mov_b64 v[64:65], 0
    v_mov_b64 v[66:67], 0
    v_mov_b64 v[68:69], 0
    v_mov_b64 v[70:71], 0
    v_mov_b64 v[72:73], 0
    v_mov_b64 v[74:75], 0
    v_mov_b64 v[76:77], 0
    v_mov_b64 v[78:79], 0
    v_mov_b64 v[80:81], 0
    v_mov_b64 v[82:83], 0
    v_mov_b64 v[84:85], 0
    v_mov_b64 v[86:87], 0
    v_mov_b64 v[88:89], 0
    v_mov_b64 v[90:91], 0
    v_mov_b64 v[92:93], 0
    v_mov_b64 v[94:95], 0
    v_mov_b64 v[96:97], 0
    v_mov_b64 v[98:99], 0
    v_mov_b64 v[100:101], 0
    v_mov_b64 v[102:103], 0
    v_mov_b64 v[104:105], 0
    v_mov_b64 v[106:107], 0
    v_mov_b64 v[108:109], 0
    v_mov_b64 v[110:111], 0
    v_mov_b64 v[112:113], 0
    v_mov_b64 v[114:115], 0
    v_mov_b64 v[116:117], 0
    v_mov_b64 v[118:119], 0
    v_mov_b64 v[120:121], 0
    v_mov_b64 v[122:123], 0
    v_mov_b64 v[124:125], 0
    v_mov_b64 v[126:127], 0
    v_mov_b64 v[128:129], 0
    v_mov_b64 v[130:131], 0
    v_mov_b64 v[132:133], 0
    v_mov_b64 v[134:135], 0
    v_mov_b64 v[136:137], 0
    v_mov_b64 v[138:139], 0
    v_mov_b64 v[140:141], 0
    v_mov_b64 v[142:143], 0
    v_mov_b64 v[144:145], 0
    v_mov_b64 v[146:147], 0
    v_mov_b64 v[148:149], 0
    v_mov_b64 v[150:151], 0
    v_mov_b64 v[152:153], 0
    v_mov_b64 v[154:155], 0
    s_mov_b32 s54, 3
    s_cmp_lg_u32 s30, 0
    s_cbranch_scc1 K_WARMM0
    s_call_b64 s[38:39], WP_attd
    s_call_b64 s[38:39], WP_p2g
    s_branch K_WARMMX
K_WARMM0:
    s_cmp_lg_u32 s30, 1
    s_cbranch_scc1 K_WARMM1
    s_call_b64 s[38:39], WP_atts
    s_call_b64 s[38:39], WP_early
    s_branch K_WARMMX
K_WARMM1:
    s_cmp_lg_u32 s30, 2
    s_cbranch_scc1 K_WARMM2
    s_call_b64 s[38:39], WP_help
    s_call_b64 s[38:39], WP_flags
    s_branch K_WARMMX
K_WARMM2:
    s_call_b64 s[38:39], WP_spin
K_WARMMX:
    s_setprio 2
    s_barrier
    ds_read_b64_tr_b16 v[204:205], v48 offset:40960
    ds_read_b64_tr_b16 v[206:207], v48 offset:41984
    ds_read_b128 v[156:159], v44 offset:40960
    ds_read_b64_tr_b16 v[208:209], v49 offset:40960
    ds_read_b64_tr_b16 v[210:211], v49 offset:41984
    ds_read_b128 v[160:163], v44 offset:43008
    ds_read_b64_tr_b16 v[212:213], v50 offset:40960
    ds_read_b64_tr_b16 v[214:215], v50 offset:41984
    ds_read_b128 v[164:167], v44 offset:45056
    ds_read_b64_tr_b16 v[216:217], v51 offset:40960
    ds_read_b64_tr_b16 v[218:219], v51 offset:41984
    ds_read_b128 v[168:171], v44 offset:47104
    ds_read_b128 v[172:175], v44 offset:49152
    ds_read_b128 v[176:179], v44 offset:51200
K_CLOOP:
    s_waitcnt lgkmcnt(0)
    v_mfma_f32_16x16x32_bf16 v[60:63], v[204:207], v[156:159], v[60:63]
    ds_read_b64_tr_b16 v[220:221], v48 offset:49152
    v_mfma_f32_16x16x32_bf16 v[64:67], v[208:211], v[156:159], v[64:67]
    ds_read_b64_tr_b16 v[222:223], v48 offset:50176
    v_mfma_f32_16x16x32_bf16 v[68:71], v[212:215], v[156:159], v[68:71]
    ds_read_b128 v[180:183], v45 offset:40960
    v_mfma_f32_16x16x32_bf16 v[72:75], v[216:219], v[156:159], v[72:75]
    ds_read_b64_tr_b16 v[224:225], v49 offset:49152
    v_mfma_f32_16x16x32_bf16 v[88:91], v[216:219], v[160:163], v[88:91]
    ds_read_b64_tr_b16 v[226:227], v49 offset:50176
    v_mfma_f32_16x16x32_bf16 v[84:87], v[212:215], v[160:163], v[84:87]
    ds_read_b128 v[184:187], v45 offset:43008
    v_mfma_f32_16x16x32_bf16 v[80:83], v[208:211], v[160:163], v[80:83]
    ds_read_b64_tr_b16 v[228:229], v50 offset:49152
    v_mfma_f32_16x16x32_bf16 v[76:79], v[204:207], v[160:163], v[76:79]
    ds_read_b64_tr_b16 v[230:231], v50 offset:50176
    v_mfma_f32_16x16x32_bf16 v[92:95], v[204:207], v[164:167], v[92:95]
    ds_read_b128 v[188:191], v45 offset:45056
    v_mfma_f32_16x16x32_bf16 v[96:99], v[208:211], v[164:167], v[96:99]
    ds_read_b64_tr_b16 v[232:233], v51 offset:49152
    v_mfma_f32_16x16x32_bf16 v[100:103], v[212:215], v[164:167], v[100:103]
    ds_read_b64_tr_b16 v[234:235], v51 offset:50176
    v_mfma_f32_16x16x32_bf16 v[104:107], v[216:219], v[164:167], v[104:107]
    ds_read_b128 v[192:195], v45 offset:47104
    v_mfma_f32_16x16x32_bf16 v[120:123], v[216:219], v[168:171], v[120:123]
    ds_read_b128 v[196:199], v45 offset:49152
    v_mfma_f32_16x16x32_bf16 v[116:119], v[212:215], v[168:171], v[116:119]
    ds_read_b128 v[200:203], v45 offset:51200
    v_mfma_f32_16x16x32_bf16 v[112:115], v[208:211], v[168:171], v[112:115]
    v_mfma_f32_16x16x32_bf16 v[108:111], v[204:207], v[168:171], v[108:111]
    v_mfma_f32_16x16x32_bf16 v[124:127], v[204:207], v[172:175], v[124:127]
    v_mfma_f32_16x16x32_bf16 v[128:131], v[208:211], v[172:175], v[128:131]
    v_mfma_f32_16x16x32_bf16 v[132:135], v[212:215], v[172:175], v[132:135]
    v_mfma_f32_16x16x32_bf16 v[136:139], v[216:219], v[172:175], v[136:139]
    v_mfma_f32_16x16x32_bf16 v[152:155], v[216:219], v[176:179], v[152:155]
    v_mfma_f32_16x16x32_bf16 v[148:151], v[212:215], v[176:179], v[148:151]
    v_mfma_f32_16x16x32_bf16 v[144:147], v[208:211], v[176:179], v[144:147]
    v_mfma_f32_16x16x32_bf16 v[140:143], v[204:207], v[176:179], v[140:143]
    s_waitcnt lgkmcnt(0)
    s_barrier
    v_mfma_f32_16x16x32_bf16 v[60:63], v[220:223], v[180:183], v[60:63]
    ds_read_b64_tr_b16 v[204:205], v52 offset:0
    v_mfma_f32_16x16x32_bf16 v[64:67], v[224:227], v[180:183], v[64:67]
    ds_read_b64_tr_b16 v[206:207], v52 offset:1024
    v_mfma_f32_16x16x32_bf16 v[68:71], v[228:231], v[180:183], v[68:71]
    ds_read_b128 v[156:159], v46 offset:0
    v_mfma_f32_16x16x32_bf16 v[72:75], v[232:235], v[180:183], v[72:75]
    ds_read_b64_tr_b16 v[208:209], v53 offset:0
    v_mfma_f32_16x16x32_bf16 v[88:91], v[232:235], v[184:187], v[88:91]
    ds_read_b64_tr_b16 v[210:211], v53 offset:1024
    v_mfma_f32_16x16x32_bf16 v[84:87], v[228:231], v[184:187], v[84:87]
    ds_read_b128 v[160:163], v46 offset:2048
    v_mfma_f32_16x16x32_bf16 v[80:83], v[224:227], v[184:187], v[80:83]
    ds_read_b64_tr_b16 v[212:213], v54 offset:0
    v_mfma_f32_16x16x32_bf16 v[76:79], v[220:223], v[184:187], v[76:79]
    ds_read_b64_tr_b16 v[214:215], v54 offset:1024
    v_mfma_f32_16x16x32_bf16 v[92:95], v[220:223], v[188:191], v[92:95]
    ds_read_b128 v[164:167], v46 offset:4096
    v_mfma_f32_16x16x32_bf16 v[96:99], v[224:227], v[188:191], v[96:99]
    ds_read_b64_tr_b16 v[216:217], v55 offset:0
    v_mfma_f32_16x16x32_bf16 v[100:103], v[228:231], v[188:191], v[100:103]
    ds_read_b64_tr_b16 v[218:219], v55 offset:1024
    v_mfma_f32_16x16x32_bf16 v[104:107], v[232:235], v[188:191], v[104:107]
    ds_read_b128 v[168:171], v46 offset:6144
    v_mfma_f32_16x16x32_bf16 v[120:123], v[232:235], v[192:195], v[120:123]
    ds_read_b128 v[172:175], v46 offset:8192
    v_mfma_f32_16x16x32_bf16 v[116:119], v[228:231], v[192:195], v[116:119]
    ds_read_b128 v[176:179], v46 offset:10240
    v_mfma_f32_16x16x32_bf16 v[112:115], v[224:227], v[192:195], v[112:115]
    v_mfma_f32_16x16x32_bf16 v[108:111], v[220:223], v[192:195], v[108:111]
    v_mfma_f32_16x16x32_bf16 v[124:127], v[220:223], v[196:199], v[124:127]
    v_mfma_f32_16x16x32_bf16 v[128:131], v[224:227], v[196:199], v[128:131]
    v_mfma_f32_16x16x32_bf16 v[132:135], v[228:231], v[196:199], v[132:135]
    v_mfma_f32_16x16x32_bf16 v[136:139], v[232:235], v[196:199], v[136:139]
    v_mfma_f32_16x16x32_bf16 v[152:155], v[232:235], v[200:203], v[152:155]
    v_mfma_f32_16x16x32_bf16 v[148:151], v[228:231], v[200:203], v[148:151]
    v_mfma_f32_16x16x32_bf16 v[144:147], v[224:227], v[200:203], v[144:147]
    v_mfma_f32_16x16x32_bf16 v[140:143], v[220:223], v[200:203], v[140:143]
    s_waitcnt lgkmcnt(0)
    v_mfma_f32_16x16x32_bf16 v[60:63], v[204:207], v[156:159], v[60:63]
    ds_read_b64_tr_b16 v[220:221], v52 offset:8192
    v_mfma_f32_16x16x32_bf16 v[64:67], v[208:211], v[156:159], v[64:67]
    ds_read_b64_tr_b16 v[222:223], v52 offset:9216
    v_mfma_f32_16x16x32_bf16 v[68:71], v[212:215], v[156:159], v[68:71]
    ds_read_b128 v[180:183], v47 offset:0
    v_mfma_f32_16x16x32_bf16 v[72:75], v[216:219], v[156:159], v[72:75]
    ds_read_b64_tr_b16 v[224:225], v53 offset:8192
    v_mfma_f32_16x16x32_bf16 v[88:91], v[216:219], v[160:163], v[88:91]
    ds_read_b64_tr_b16 v[226:227], v53 offset:9216
    v_mfma_f32_16x16x32_bf16 v[84:87], v[212:215], v[160:163], v[84:87]
    ds_read_b128 v[184:187], v47 offset:2048
    v_mfma_f32_16x16x32_bf16 v[80:83], v[208:211], v[160:163], v[80:83]
    ds_read_b64_tr_b16 v[228:229], v54 offset:8192
    v_mfma_f32_16x16x32_bf16 v[76:79], v[204:207], v[160:163], v[76:79]
    ds_read_b64_tr_b16 v[230:231], v54 offset:9216
    v_mfma_f32_16x16x32_bf16 v[92:95], v[204:207], v[164:167], v[92:95]
    ds_read_b128 v[188:191], v47 offset:4096
    v_mfma_f32_16x16x32_bf16 v[96:99], v[208:211], v[164:167], v[96:99]
    ds_read_b64_tr_b16 v[232:233], v55 offset:8192
    v_mfma_f32_16x16x32_bf16 v[100:103], v[212:215], v[164:167], v[100:103]
    ds_read_b64_tr_b16 v[234:235], v55 offset:9216
    v_mfma_f32_16x16x32_bf16 v[104:107], v[216:219], v[164:167], v[104:107]
    ds_read_b128 v[192:195], v47 offset:6144
    v_mfma_f32_16x16x32_bf16 v[120:123], v[216:219], v[168:171], v[120:123]
    ds_read_b128 v[196:199], v47 offset:8192
    v_mfma_f32_16x16x32_bf16 v[116:119], v[212:215], v[168:171], v[116:119]
    ds_read_b128 v[200:203], v47 offset:10240
    v_mfma_f32_16x16x32_bf16 v[112:115], v[208:211], v[168:171], v[112:115]
    v_mfma_f32_16x16x32_bf16 v[108:111], v[204:207], v[168:171], v[108:111]
    v_mfma_f32_16x16x32_bf16 v[124:127], v[204:207], v[172:175], v[124:127]
    v_mfma_f32_16x16x32_bf16 v[128:131], v[208:211], v[172:175], v[128:131]
    v_mfma_f32_16x16x32_bf16 v[132:135], v[212:215], v[172:175], v[132:135]
    v_mfma_f32_16x16x32_bf16 v[136:139], v[216:219], v[172:175], v[136:139]
    v_mfma_f32_16x16x32_bf16 v[152:155], v[216:219], v[176:179], v[152:155]
    v_mfma_f32_16x16x32_bf16 v[148:151], v[212:215], v[176:179], v[148:151]
    v_mfma_f32_16x16x32_bf16 v[144:147], v[208:211], v[176:179], v[144:147]
    v_mfma_f32_16x16x32_bf16 v[140:143], v[204:207], v[176:179], v[140:143]
    s_waitcnt lgkmcnt(0)
    s_barrier
    v_mfma_f32_16x16x32_bf16 v[60:63], v[220:223], v[180:183], v[60:63]
    ds_read_b64_tr_b16 v[204:205], v48 offset:0
    v_mfma_f32_16x16x32_bf16 v[64:67], v[224:227], v[180:183], v[64:67]
    ds_read_b64_tr_b16 v[206:207], v48 offset:1024
    v_mfma_f32_16x16x32_bf16 v[68:71], v[228:231], v[180:183], v[68:71]
    ds_read_b128 v[156:159], v44 offset:0
    v_mfma_f32_16x16x32_bf16 v[72:75], v[232:235], v[180:183], v[72:75]
    ds_read_b64_tr_b16 v[208:209], v49 offset:0
    v_mfma_f32_16x16x32_bf16 v[88:91], v[232:235], v[184:187], v[88:91]
    ds_read_b64_tr_b16 v[210:211], v49 offset:1024
    v_mfma_f32_16x16x32_bf16 v[84:87], v[228:231], v[184:187], v[84:87]
    ds_read_b128 v[160:163], v44 offset:2048
    v_mfma_f32_16x16x32_bf16 v[80:83], v[224:227], v[184:187], v[80:83]
    ds_read_b64_tr_b16 v[212:213], v50 offset:0
    v_mfma_f32_16x16x32_bf16 v[76:79], v[220:223], v[184:187], v[76:79]
    ds_read_b64_tr_b16 v[214:215], v50 offset:1024
    v_mfma_f32_16x16x32_bf16 v[92:95], v[220:223], v[188:191], v[92:95]
    ds_read_b128 v[164:167], v44 offset:4096
    v_mfma_f32_16x16x32_bf16 v[96:99], v[224:227], v[188:191], v[96:99]
    ds_read_b64_tr_b16 v[216:217], v51 offset:0
    v_mfma_f32_16x16x32_bf16 v[100:103], v[228:231], v[188:191], v[100:103]
    ds_read_b64_tr_b16 v[218:219], v51 offset:1024
    v_mfma_f32_16x16x32_bf16 v[104:107], v[232:235], v[188:191], v[104:107]
    ds_read_b128 v[168:171], v44 offset:6144
    v_mfma_f32_16x16x32_bf16 v[120:123], v[232:235], v[192:195], v[120:123]
    ds_read_b128 v[172:175], v44 offset:8192
    v_mfma_f32_16x16x32_bf16 v[116:119], v[228:231], v[192:195], v[116:119]
    ds_read_b128 v[176:179], v44 offset:10240
    v_mfma_f32_16x16x32_bf16 v[112:115], v[224:227], v[192:195], v[112:115]
    v_mfma_f32_16x16x32_bf16 v[108:111], v[220:223], v[192:195], v[108:111]
    v_mfma_f32_16x16x32_bf16 v[124:127], v[220:223], v[196:199], v[124:127]
    v_mfma_f32_16x16x32_bf16 v[128:131], v[224:227], v[196:199], v[128:131]
    v_mfma_f32_16x16x32_bf16 v[132:135], v[228:231], v[196:199], v[132:135]
    v_mfma_f32_16x16x32_bf16 v[136:139], v[232:235], v[196:199], v[136:139]
    v_mfma_f32_16x16x32_bf16 v[152:155], v[232:235], v[200:203], v[152:155]
    v_mfma_f32_16x16x32_bf16 v[148:151], v[228:231], v[200:203], v[148:151]
    v_mfma_f32_16x16x32_bf16 v[144:147], v[224:227], v[200:203], v[144:147]
    v_mfma_f32_16x16x32_bf16 v[140:143], v[220:223], v[200:203], v[140:143]
    s_waitcnt lgkmcnt(0)
    v_mfma_f32_16x16x32_bf16 v[60:63], v[204:207], v[156:159], v[60:63]
    ds_read_b64_tr_b16 v[220:221], v48 offset:8192
    v_mfma_f32_16x16x32_bf16 v[64:67], v[208:211], v[156:159], v[64:67]
    ds_read_b64_tr_b16 v[222:223], v48 offset:9216
    v_mfma_f32_16x16x32_bf16 v[68:71], v[212:215], v[156:159], v[68:71]
    ds_read_b128 v[180:183], v45 offset:0
    v_mfma_f32_16x16x32_bf16 v[72:75], v[216:219], v[156:159], v[72:75]
    ds_read_b64_tr_b16 v[224:225], v49 offset:8192
    v_mfma_f32_16x16x32_bf16 v[88:91], v[216:219], v[160:163], v[88:91]
    ds_read_b64_tr_b16 v[226:227], v49 offset:9216
    v_mfma_f32_16x16x32_bf16 v[84:87], v[212:215], v[160:163], v[84:87]
    ds_read_b128 v[184:187], v45 offset:2048
    v_mfma_f32_16x16x32_bf16 v[80:83], v[208:211], v[160:163], v[80:83]
    ds_read_b64_tr_b16 v[228:229], v50 offset:8192
    v_mfma_f32_16x16x32_bf16 v[76:79], v[204:207], v[160:163], v[76:79]
    ds_read_b64_tr_b16 v[230:231], v50 offset:9216
    v_mfma_f32_16x16x32_bf16 v[92:95], v[204:207], v[164:167], v[92:95]
    ds_read_b128 v[188:191], v45 offset:4096
    v_mfma_f32_16x16x32_bf16 v[96:99], v[208:211], v[164:167], v[96:99]
    ds_read_b64_tr_b16 v[232:233], v51 offset:8192
    v_mfma_f32_16x16x32_bf16 v[100:103], v[212:215], v[164:167], v[100:103]
    ds_read_b64_tr_b16 v[234:235], v51 offset:9216
    v_mfma_f32_16x16x32_bf16 v[104:107], v[216:219], v[164:167], v[104:107]
    ds_read_b128 v[192:195], v45 offset:6144
    v_mfma_f32_16x16x32_bf16 v[120:123], v[216:219], v[168:171], v[120:123]
    ds_read_b128 v[196:199], v45 offset:8192
    v_mfma_f32_16x16x32_bf16 v[116:119], v[212:215], v[168:171], v[116:119]
    ds_read_b128 v[200:203], v45 offset:10240
    v_mfma_f32_16x16x32_bf16 v[112:115], v[208:211], v[168:171], v[112:115]
    v_mfma_f32_16x16x32_bf16 v[108:111], v[204:207], v[168:171], v[108:111]
    v_mfma_f32_16x16x32_bf16 v[124:127], v[204:207], v[172:175], v[124:127]
    v_mfma_f32_16x16x32_bf16 v[128:131], v[208:211], v[172:175], v[128:131]
    v_mfma_f32_16x16x32_bf16 v[132:135], v[212:215], v[172:175], v[132:135]
    v_mfma_f32_16x16x32_bf16 v[136:139], v[216:219], v[172:175], v[136:139]
    v_mfma_f32_16x16x32_bf16 v[152:155], v[216:219], v[176:179], v[152:155]
    v_mfma_f32_16x16x32_bf16 v[148:151], v[212:215], v[176:179], v[148:151]
    v_mfma_f32_16x16x32_bf16 v[144:147], v[208:211], v[176:179], v[144:147]
    v_mfma_f32_16x16x32_bf16 v[140:143], v[204:207], v[176:179], v[140:143]
    s_waitcnt lgkmcnt(0)
    s_barrier
    v_mfma_f32_16x16x32_bf16 v[60:63], v[220:223], v[180:183], v[60:63]
    ds_read_b64_tr_b16 v[204:205], v48 offset:40960
    v_mfma_f32_16x16x32_bf16 v[64:67], v[224:227], v[180:183], v[64:67]
    ds_read_b64_tr_b16 v[206:207], v48 offset:41984
    v_mfma_f32_16x16x32_bf16 v[68:71], v[228:231], v[180:183], v[68:71]
    ds_read_b128 v[156:159], v44 offset:40960
    v_mfma_f32_16x16x32_bf16 v[72:75], v[232:235], v[180:183], v[72:75]
    ds_read_b64_tr_b16 v[208:209], v49 offset:40960
    v_mfma_f32_16x16x32_bf16 v[88:91], v[232:235], v[184:187], v[88:91]
    ds_read_b64_tr_b16 v[210:211], v49 offset:41984
    v_mfma_f32_16x16x32_bf16 v[84:87], v[228:231], v[184:187], v[84:87]
    ds_read_b128 v[160:163], v44 offset:43008
    v_mfma_f32_16x16x32_bf16 v[80:83], v[224:227], v[184:187], v[80:83]
    ds_read_b64_tr_b16 v[212:213], v50 offset:40960
    v_mfma_f32_16x16x32_bf16 v[76:79], v[220:223], v[184:187], v[76:79]
    ds_read_b64_tr_b16 v[214:215], v50 offset:41984
    v_mfma_f32_16x16x32_bf16 v[92:95], v[220:223], v[188:191], v[92:95]
    ds_read_b128 v[164:167], v44 offset:45056
    v_mfma_f32_16x16x32_bf16 v[96:99], v[224:227], v[188:191], v[96:99]
    ds_read_b64_tr_b16 v[216:217], v51 offset:40960
    v_mfma_f32_16x16x32_bf16 v[100:103], v[228:231], v[188:191], v[100:103]
    ds_read_b64_tr_b16 v[218:219], v51 offset:41984
    v_mfma_f32_16x16x32_bf16 v[104:107], v[232:235], v[188:191], v[104:107]
    ds_read_b128 v[168:171], v44 offset:47104
    v_mfma_f32_16x16x32_bf16 v[120:123], v[232:235], v[192:195], v[120:123]
    ds_read_b128 v[172:175], v44 offset:49152
    v_mfma_f32_16x16x32_bf16 v[116:119], v[228:231], v[192:195], v[116:119]
    ds_read_b128 v[176:179], v44 offset:51200
    v_mfma_f32_16x16x32_bf16 v[112:115], v[224:227], v[192:195], v[112:115]
    s_sub_u32 s54, s54, 1
    v_mfma_f32_16x16x32_bf16 v[108:111], v[220:223], v[192:195], v[108:111]
    s_cmp_lg_u32 s54, 0
    v_mfma_f32_16x16x32_bf16 v[124:127], v[220:223], v[196:199], v[124:127]
    v_mfma_f32_16x16x32_bf16 v[128:131], v[224:227], v[196:199], v[128:131]
    v_mfma_f32_16x16x32_bf16 v[132:135], v[228:231], v[196:199], v[132:135]
    v_mfma_f32_16x16x32_bf16 v[136:139], v[232:235], v[196:199], v[136:139]
    v_mfma_f32_16x16x32_bf16 v[152:155], v[232:235], v[200:203], v[152:155]
    v_mfma_f32_16x16x32_bf16 v[148:151], v[228:231], v[200:203], v[148:151]
    v_mfma_f32_16x16x32_bf16 v[144:147], v[224:227], v[200:203], v[144:147]
    v_mfma_f32_16x16x32_bf16 v[140:143], v[220:223], v[200:203], v[140:143]
    s_cbranch_scc1 K_CLOOP
    s_waitcnt lgkmcnt(0)
    v_mfma_f32_16x16x32_bf16 v[60:63], v[204:207], v[156:159], v[60:63]
    ds_read_b64_tr_b16 v[220:221], v48 offset:49152
    v_mfma_f32_16x16x32_bf16 v[64:67], v[208:211], v[156:159], v[64:67]
    ds_read_b64_tr_b16 v[222:223], v48 offset:50176
    v_mfma_f32_16x16x32_bf16 v[68:71], v[212:215], v[156:159], v[68:71]
    ds_read_b128 v[180:183], v45 offset:40960
    v_mfma_f32_16x16x32_bf16 v[72:75], v[216:219], v[156:159], v[72:75]
    ds_read_b64_tr_b16 v[224:225], v49 offset:49152
    v_mfma_f32_16x16x32_bf16 v[76:79], v[204:207], v[160:163], v[76:79]
    ds_read_b64_tr_b16 v[226:227], v49 offset:50176
    v_mfma_f32_16x16x32_bf16 v[80:83], v[208:211], v[160:163], v[80:83]
    ds_read_b128 v[184:187], v45 offset:43008
    v_mfma_f32_16x16x32_bf16 v[84:87], v[212:215], v[160:163], v[84:87]
    ds_read_b64_tr_b16 v[228:229], v50 offset:49152
    v_mfma_f32_16x16x32_bf16 v[88:91], v[216:219], v[160:163], v[88:91]
    ds_read_b64_tr_b16 v[230:231], v50 offset:50176
    v_mfma_f32_16x16x32_bf16 v[92:95], v[204:207], v[164:167], v[92:95]
    ds_read_b128 v[188:191], v45 offset:45056
    v_mfma_f32_16x16x32_bf16 v[96:99], v[208:211], v[164:167], v[96:99]
    ds_read_b64_tr_b16 v[232:233], v51 offset:49152
    v_mfma_f32_16x16x32_bf16 v[100:103], v[212:215], v[164:167], v[100:103]
    ds_read_b64_tr_b16 v[234:235], v51 offset:50176
    v_mfma_f32_16x16x32_bf16 v[104:107], v[216:219], v[164:167], v[104:107]
    ds_read_b128 v[192:195], v45 offset:47104
    v_mfma_f32_16x16x32_bf16 v[108:111], v[204:207], v[168:171], v[108:111]
    ds_read_b128 v[196:199], v45 offset:49152
    v_mfma_f32_16x16x32_bf16 v[112:115], v[208:211], v[168:171], v[112:115]
    ds_read_b128 v[200:203], v45 offset:51200
    v_mfma_f32_16x16x32_bf16 v[116:119], v[212:215], v[168:171], v[116:119]
    v_mfma_f32_16x16x32_bf16 v[120:123], v[216:219], v[168:171], v[120:123]
    s_waitcnt lgkmcnt(0)
    v_mfma_f32_16x16x32_bf16 v[60:63], v[220:223], v[180:183], v[60:63]
    v_mfma_f32_16x16x32_bf16 v[64:67], v[224:227], v[180:183], v[64:67]
    v_mfma_f32_16x16x32_bf16 v[68:71], v[228:231], v[180:183], v[68:71]
    v_mfma_f32_16x16x32_bf16 v[72:75], v[232:235], v[180:183], v[72:75]
    v_mfma_f32_16x16x32_bf16 v[76:79], v[220:223], v[184:187], v[76:79]
    v_mfma_f32_16x16x32_bf16 v[80:83], v[224:227], v[184:187], v[80:83]
    v_mfma_f32_16x16x32_bf16 v[84:87], v[228:231], v[184:187], v[84:87]
    v_mfma_f32_16x16x32_bf16 v[88:91], v[232:235], v[184:187], v[88:91]
    v_mfma_f32_16x16x32_bf16 v[92:95], v[220:223], v[188:191], v[92:95]
    v_cvt_pk_bf16_f32 v236, v60, v61
    v_cvt_pk_bf16_f32 v237, v62, v63
    ds_write_b64 v56, v[236:237] offset:0
    v_mfma_f32_16x16x32_bf16 v[96:99], v[224:227], v[188:191], v[96:99]
    v_cvt_pk_bf16_f32 v238, v64, v65
    v_cvt_pk_bf16_f32 v239, v66, v67
    ds_write_b64 v56, v[238:239] offset:32
    v_mfma_f32_16x16x32_bf16 v[100:103], v[228:231], v[188:191], v[100:103]
    v_cvt_pk_bf16_f32 v240, v68, v69
    v_cvt_pk_bf16_f32 v241, v70, v71
    ds_write_b64 v56, v[240:241] offset:64
    v_mfma_f32_16x16x32_bf16 v[104:107], v[232:235], v[188:191], v[104:107]
    v_cvt_pk_bf16_f32 v242, v72, v73
    v_cvt_pk_bf16_f32 v243, v74, v75
    ds_write_b64 v56, v[242:243] offset:96
    v_mfma_f32_16x16x32_bf16 v[108:111], v[220:223], v[192:195], v[108:111]
    v_cvt_pk_bf16_f32 v236, v76, v77
    v_cvt_pk_bf16_f32 v237, v78, v79
    ds_write_b64 v56, v[236:237] offset:4352
    v_mfma_f32_16x16x32_bf16 v[112:115], v[224:227], v[192:195], v[112:115]
    v_cvt_pk_bf16_f32 v238, v80, v81
    v_cvt_pk_bf16_f32 v239, v82, v83
    ds_write_b64 v56, v[238:239] offset:4384
    v_mfma_f32_16x16x32_bf16 v[116:119], v[228:231], v[192:195], v[116:119]
    v_cvt_pk_bf16_f32 v240, v84, v85
    v_cvt_pk_bf16_f32 v241, v86, v87
    ds_write_b64 v56, v[240:241] offset:4416
    v_mfma_f32_16x16x32_bf16 v[120:123], v[232:235], v[192:195], v[120:123]
    v_cvt_pk_bf16_f32 v242, v88, v89
    v_cvt_pk_bf16_f32 v243, v90, v91
    ds_write_b64 v56, v[242:243] offset:4448
    v_mfma_f32_16x16x32_bf16 v[124:127], v[204:207], v[172:175], v[124:127]
    v_cvt_pk_bf16_f32 v236, v92, v93
    v_cvt_pk_bf16_f32 v237, v94, v95
    ds_write_b64 v56, v[236:237] offset:8704
    v_mfma_f32_16x16x32_bf16 v[128:131], v[208:211], v[172:175], v[128:131]
    v_cvt_pk_bf16_f32 v238, v96, v97
    v_cvt_pk_bf16_f32 v239, v98, v99
    ds_write_b64 v56, v[238:239] offset:8736
    v_mfma_f32_16x16x32_bf16 v[132:135], v[212:215], v[172:175], v[132:135]
    v_cvt_pk_bf16_f32 v240, v100, v101
    v_cvt_pk_bf16_f32 v241, v102, v103
    ds_write_b64 v56, v[240:241] offset:8768
    v_mfma_f32_16x16x32_bf16 v[136:139], v[216:219], v[172:175], v[136:139]
    v_cvt_pk_bf16_f32 v242, v104, v105
    v_cvt_pk_bf16_f32 v243, v106, v107
    ds_write_b64 v56, v[242:243] offset:8800
    v_mfma_f32_16x16x32_bf16 v[124:127], v[220:223], v[196:199], v[124:127]
    v_cvt_pk_bf16_f32 v236, v108, v109
    v_cvt_pk_bf16_f32 v237, v110, v111
    ds_write_b64 v56, v[236:237] offset:13056
    v_mfma_f32_16x16x32_bf16 v[128:131], v[224:227], v[196:199], v[128:131]
    v_cvt_pk_bf16_f32 v238, v112, v113
    v_cvt_pk_bf16_f32 v239, v114, v115
    ds_write_b64 v56, v[238:239] offset:13088
    v_mfma_f32_16x16x32_bf16 v[132:135], v[228:231], v[196:199], v[132:135]
    v_cvt_pk_bf16_f32 v240, v116, v117
    v_cvt_pk_bf16_f32 v241, v118, v119
    ds_write_b64 v56, v[240:241] offset:13120
    v_mfma_f32_16x16x32_bf16 v[136:139], v[232:235], v[196:199], v[136:139]
    v_cvt_pk_bf16_f32 v242, v120, v121
    v_cvt_pk_bf16_f32 v243, v122, v123
    ds_write_b64 v56, v[242:243] offset:13152
    v_mfma_f32_16x16x32_bf16 v[140:143], v[204:207], v[176:179], v[140:143]
    v_cvt_pk_bf16_f32 v236, v124, v125
    v_cvt_pk_bf16_f32 v237, v126, v127
    ds_write_b64 v56, v[236:237] offset:17408
    v_mfma_f32_16x16x32_bf16 v[144:147], v[208:211], v[176:179], v[144:147]
    v_cvt_pk_bf16_f32 v238, v128, v129
    v_cvt_pk_bf16_f32 v239, v130, v131
    ds_write_b64 v56, v[238:239] offset:17440
    v_mfma_f32_16x16x32_bf16 v[148:151], v[212:215], v[176:179], v[148:151]
    v_cvt_pk_bf16_f32 v240, v132, v133
    v_cvt_pk_bf16_f32 v241, v134, v135
    ds_write_b64 v56, v[240:241] offset:17472
    v_mfma_f32_16x16x32_bf16 v[152:155], v[216:219], v[176:179], v[152:155]
    v_cvt_pk_bf16_f32 v242, v136, v137
    v_cvt_pk_bf16_f32 v243, v138, v139
    ds_write_b64 v56, v[242:243] offset:17504
    v_mfma_f32_16x16x32_bf16 v[140:143], v[220:223], v[200:203], v[140:143]
    v_mfma_f32_16x16x32_bf16 v[144:147], v[224:227], v[200:203], v[144:147]
    v_mfma_f32_16x16x32_bf16 v[148:151], v[228:231], v[200:203], v[148:151]
    v_mfma_f32_16x16x32_bf16 v[152:155], v[232:235], v[200:203], v[152:155]
    s_nop 7
    v_cvt_pk_bf16_f32 v236, v140, v141
    v_cvt_pk_bf16_f32 v237, v142, v143
    ds_write_b64 v56, v[236:237] offset:21760
    v_cvt_pk_bf16_f32 v238, v144, v145
    v_cvt_pk_bf16_f32 v239, v146, v147
    ds_write_b64 v56, v[238:239] offset:21792
    v_cvt_pk_bf16_f32 v240, v148, v149
    v_cvt_pk_bf16_f32 v241, v150, v151
    ds_write_b64 v56, v[240:241] offset:21824
    v_cvt_pk_bf16_f32 v242, v152, v153
    v_cvt_pk_bf16_f32 v243, v154, v155
    ds_write_b64 v56, v[242:243] offset:21856
    s_setprio 0
    s_branch WS_attd
.p2align 12
WP_attd:
    s_setpc_b64 s[38:39]
WS_attd:
    s_waitcnt lgkmcnt(0)
    s_barrier
    ds_read_b64 v[60:61], v13 offset:80
    ds_read_b64 v[62:63], v14 offset:80
    ds_read_b64 v[44:45], v13 offset:4352
    ds_read_b64 v[46:47], v19 offset:4352
    ds_read_b64 v[64:65], v13 offset:4432
    ds_read_b64 v[66:67], v14 offset:4432
    ds_read_b64 v[72:73], v13 offset:120
    ds_read_b64 v[74:75], v14 offset:120
    ds_read_b64 v[48:49], v13 offset:4392
    ds_read_b64 v[50:51], v20 offset:4352
    ds_read_b64 v[76:77], v13 offset:4472
    ds_read_b64 v[78:79], v14 offset:4472
    ds_read_b64 v[52:53], v13 offset:8704
    ds_read_b64 v[54:55], v19 offset:8704
    ds_read_b64 v[68:69], v13 offset:8784
    ds_read_b64 v[70:71], v14 offset:8784
    s_waitcnt lgkmcnt(10)
    v_mfma_f32_16x16x32_bf16 v[116:119], v[60:63], v[44:47], v[36:39]
    v_mfma_f32_16x16x32_bf16 v[120:123], v[64:67], v[44:47], v[32:35]
    ds_read_b64 v[56:57], v13 offset:8744
    ds_read_b64 v[58:59], v20 offset:8704
    ds_read_b64 v[80:81], v13 offset:8824
    ds_read_b64 v[82:83], v14 offset:8824
    s_waitcnt lgkmcnt(8)
    v_mfma_f32_16x16x32_bf16 v[124:127], v[72:75], v[48:51], v[36:39]
    v_mfma_f32_16x16x32_bf16 v[128:131], v[76:79], v[48:51], v[32:35]
    s_waitcnt lgkmcnt(4)
    v_mfma_f32_16x16x32_bf16 v[132:135], v[64:67], v[52:55], v[28:31]
    v_mfma_f32_16x16x32_bf16 v[136:139], v[68:71], v[52:55], v[32:35]
    s_waitcnt lgkmcnt(0)
    v_mfma_f32_16x16x32_bf16 v[140:143], v[76:79], v[56:59], v[28:31]
    v_mfma_f32_16x16x32_bf16 v[144:147], v[80:83], v[56:59], v[32:35]
    ds_read_b64_tr_b16 v[84:85], v15 offset:160
    ds_read_b64_tr_b16 v[86:87], v15 offset:4512
    ds_read_b64_tr_b16 v[100:101], v21 offset:0
    ds_read_b64_tr_b16 v[102:103], v21 offset:4352
    v_max3_f32 v184, v116, v117, v120
    ds_read_b64_tr_b16 v[92:93], v15 offset:200
    v_max3_f32 v185, v118, v119, v122
    ds_read_b64_tr_b16 v[94:95], v15 offset:4552
    v_max_f32 v184, v184, v121
    ds_read_b64_tr_b16 v[104:105], v22 offset:0
    v_max_f32 v185, v185, v123
    ds_read_b64_tr_b16 v[106:107], v22 offset:4352
    v_max3_f32 v186, v124, v125, v128
    ds_read_b64_tr_b16 v[88:89], v15 offset:8864
    v_max3_f32 v187, v126, v127, v130
    ds_read_b64_tr_b16 v[108:109], v23 offset:4352
    v_max_f32 v186, v186, v129
    ds_read_b64_tr_b16 v[110:111], v23 offset:8704
    v_max_f32 v187, v187, v131
    ds_read_b64_tr_b16 v[96:97], v15 offset:8904
    v_max3_f32 v188, v132, v133, v136
    ds_read_b64_tr_b16 v[112:113], v24 offset:4352
    v_max3_f32 v189, v134, v135, v138
    ds_read_b64_tr_b16 v[114:115], v24 offset:8704
    v_max_f32 v188, v188, v137
    v_max_f32 v189, v189, v139
    v_max3_f32 v190, v140, v141, v144
    v_max3_f32 v191, v142, v143, v146
    v_max_f32 v190, v190, v145
    v_max_f32 v191, v191, v147
    v_cvt_pk_bf16_f32 v192, v184, v185
    v_cvt_pk_bf16_f32 v193, v186, v187
    v_cvt_pk_bf16_f32 v194, v188, v189
    v_cvt_pk_bf16_f32 v195, v190, v191
    v_lshlrev_b32 v184, 16, v192
    v_and_b32 v185, 0xffff0000, v192
    v_lshlrev_b32 v186, 16, v193
    v_and_b32 v187, 0xffff0000, v193
    v_lshlrev_b32 v188, 16, v194
    v_and_b32 v189, 0xffff0000, v194
    v_lshlrev_b32 v190, 16, v195
    v_and_b32 v191, 0xffff0000, v195
    v_pk_mul_f32 v[184:185], v[184:185], s[48:49]
    v_pk_mul_f32 v[186:187], v[186:187], s[48:49]
    v_pk_mul_f32 v[188:189], v[188:189], s[48:49]
    v_pk_mul_f32 v[190:191], v[190:191], s[48:49]
    v_cvt_pk_bf16_f32 v192, v184, v185
    v_cvt_pk_bf16_f32 v193, v186, v187
    v_cvt_pk_bf16_f32 v194, v188, v189
    v_cvt_pk_bf16_f32 v195, v190, v191
    v_permlane16_swap_b32 v192, v193
    s_nop 0
    v_permlane16_swap_b32 v194, v195
    s_nop 1
    v_permlane32_swap_b32 v192, v194
    v_permlane32_swap_b32 v193, v195
    v_lshlrev_b32 v184, 16, v192
    v_and_b32 v185, 0xffff0000, v192
    v_lshlrev_b32 v188, 16, v194
    v_and_b32 v189, 0xffff0000, v194
    v_lshlrev_b32 v186, 16, v193
    v_and_b32 v187, 0xffff0000, v193
    v_lshlrev_b32 v190, 16, v195
    v_and_b32 v191, 0xffff0000, v195
    v_max3_f32 v196, v184, v185, v188
    v_max3_f32 v197, v189, v186, v187
    v_max3_f32 v196, v196, v190, v191
    v_max_f32 v196, v196, v197
    v_mul_f32 v196, s46, v196
    v_pk_fma_f32 v[184:185], v[184:185], s[46:47], v[196:197] op_sel_hi:[1,1,0] neg_lo:[0,0,1] neg_hi:[0,0,1]
    v_pk_fma_f32 v[186:187], v[186:187], s[46:47], v[196:197] op_sel_hi:[1,1,0] neg_lo:[0,0,1] neg_hi:[0,0,1]
    v_pk_fma_f32 v[188:189], v[188:189], s[46:47], v[196:197] op_sel_hi:[1,1,0] neg_lo:[0,0,1] neg_hi:[0,0,1]
    v_pk_fma_f32 v[190:191], v[190:191], s[46:47], v[196:197] op_sel_hi:[1,1,0] neg_lo:[0,0,1] neg_hi:[0,0,1]
    v_exp_f32 v184, v184
    v_exp_f32 v185, v185
    v_exp_f32 v186, v186
    v_exp_f32 v187, v187
    v_exp_f32 v188, v188
    v_exp_f32 v189, v189
    v_exp_f32 v190, v190
    v_exp_f32 v191, v191
    v_pk_add_f32 v[200:201], v[184:185], v[186:187]
    v_pk_add_f32 v[202:203], v[188:189], v[190:191]
    v_pk_add_f32 v[200:201], v[200:201], v[202:203]
    v_add_f32 v200, v200, v201
    v_rcp_f32 v200, v200
    s_waitcnt lgkmcnt(0)
    v_pk_mul_f32 v[184:185], v[184:185], v[200:201] op_sel_hi:[1,0]
    v_pk_mul_f32 v[186:187], v[186:187], v[200:201] op_sel_hi:[1,0]
    v_pk_mul_f32 v[188:189], v[188:189], v[200:201] op_sel_hi:[1,0]
    v_pk_mul_f32 v[190:191], v[190:191], v[200:201] op_sel_hi:[1,0]
    v_cvt_pk_bf16_f32 v192, v184, v185
    v_cvt_pk_bf16_f32 v194, v188, v189
    v_cvt_pk_bf16_f32 v193, v186, v187
    v_cvt_pk_bf16_f32 v195, v190, v191
    v_permlane32_swap_b32 v192, v194
    s_nop 0
    v_permlane32_swap_b32 v193, v195
    s_nop 1
    v_permlane16_swap_b32 v192, v193
    v_permlane16_swap_b32 v194, v195
    v_perm_b32 v148, v192, v192, v40
    v_perm_b32 v149, v192, v192, v41
    v_perm_b32 v150, v192, v192, v42
    v_perm_b32 v151, v192, v192, v43
    v_perm_b32 v152, v193, v193, v40
    v_perm_b32 v153, v193, v193, v41
    v_perm_b32 v154, v193, v193, v42
    v_perm_b32 v155, v193, v193, v43
    v_mfma_f32_16x16x32_bf16 v[164:167], v[84:87], v[148:151], 0
    v_mfma_f32_16x16x32_bf16 v[180:183], v[100:103], v[148:151], 0
    v_perm_b32 v156, v194, v194, v40
    v_perm_b32 v157, v194, v194, v41
    v_perm_b32 v158, v194, v194, v42
    v_perm_b32 v159, v194, v194, v43
    v_mfma_f32_16x16x32_bf16 v[168:171], v[92:95], v[152:155], 0
    v_mfma_f32_16x16x32_bf16 v[180:183], v[104:107], v[152:155], v[180:183]
    v_perm_b32 v160, v195, v195, v40
    v_perm_b32 v161, v195, v195, v41
    v_perm_b32 v162, v195, v195, v42
    v_perm_b32 v163, v195, v195, v43
    v_mfma_f32_16x16x32_bf16 v[172:175], v[86:89], v[156:159], 0
    v_mfma_f32_16x16x32_bf16 v[180:183], v[108:111], v[156:159], v[180:183]
    v_mfma_f32_16x16x32_bf16 v[176:179], v[94:97], v[160:163], 0
    v_mfma_f32_16x16x32_bf16 v[180:183], v[112:115], v[160:163], v[180:183]
    v_cvt_pk_bf16_f32 v204, v164, v165
    v_cvt_pk_bf16_f32 v205, v166, v167
    v_cvt_pk_bf16_f32 v206, v168, v169
    v_cvt_pk_bf16_f32 v207, v170, v171
    buffer_store_dwordx4 v[204:207], v16, s[20:23], s50 offen sc1
    v_cvt_pk_bf16_f32 v208, v172, v173
    v_cvt_pk_bf16_f32 v209, v174, v175
    v_cvt_pk_bf16_f32 v210, v176, v177
    v_cvt_pk_bf16_f32 v211, v178, v179
    buffer_store_dwordx4 v[208:211], v16, s[20:23], s51 offen sc1
    v_cvt_pk_bf16_f32 v196, v180, v181
    v_cvt_pk_bf16_f32 v197, v182, v183
    buffer_store_dwordx2 v[196:197], v17, s[20:23], s50 offen sc1
    s_cmp_lg_u32 s34, -1
    s_cbranch_scc1 K_P2_EARLY
K_DRAIN:
    s_waitcnt vmcnt(0)
    s_barrier
    s_branch K_END
K_W7:
    s_waitcnt vmcnt(26)
    v_and_b32 v4, 7, v1
    v_lshlrev_b32 v4, 2, v4
    s_mov_b32 s3, 131072
K_ZPOLL5:
    v_cmp_eq_u32 vcc, 0, v7
    s_cbranch_vccz K_ZOK5
    s_sub_u32 s3, s3, 1
    s_cbranch_scc1 K_ZOK5
    global_load_dword v7, v4, s[8:9] offset:192 sc1
    s_waitcnt vmcnt(0)
    s_branch K_ZPOLL5
K_ZOK5:
    v_mov_b32 v4, 158720
    v_mov_b32 v3, 1
    s_mov_b64 exec, 1
    s_nop 0
    ds_add_rtn_u32 v2, v4, v3 offset:48
    s_mov_b32 exec_lo, s36
    v_mov_b32 v3, 1
    s_waitcnt lgkmcnt(0)
    v_readfirstlane_b32 s33, v2
    s_nop 3
    s_and_b32 s33, s33, 0xff
    s_cmp_lg_u32 s33, 7
    s_cbranch_scc1 K_ARR7
    global_store_dword v8, v3, s[10:11] sc1
K_ARR7:
    s_mov_b64 exec, -1
    v_mov_b32 v3, 0x100
    s_mov_b64 exec, 1
    s_waitcnt vmcnt(0)
    ds_add_u32 v4, v3 offset:48
    s_mov_b64 exec, -1
    s_branch K_P2_HELP
K_FLAG:
    s_waitcnt vmcnt(0)
    v_and_b32 v4, 7, v1
    v_lshlrev_b32 v4, 2, v4
    s_mov_b32 s3, 131072
K_ZPOLL0:
    v_cmp_eq_u32 vcc, 0, v7
    s_cbranch_vccz K_ZOK0
    s_sub_u32 s3, s3, 1
    s_cbranch_scc1 K_ZOK0
    global_load_dword v7, v4, s[8:9] offset:192 sc1
    s_waitcnt vmcnt(0)
    s_branch K_ZPOLL0
K_ZOK0:
    v_mov_b32 v3, 1
    s_mov_b32 exec_lo, s36
    s_mov_b32 exec_hi, 0
    s_setprio 3
    s_barrier
    global_store_dword v8, v3, s[10:11] sc1
    s_mov_b64 exec, -1
    s_branch K_END
WP_atts:
    s_setpc_b64 s[38:39]
K_JOIN_S:
    s_setprio 0
    s_barrier
    s_cmp_eq_u32 s30, 7
    s_cbranch_scc1 K_FLAG
    ds_read_b64 v[52:53], v13 offset:80
    ds_read_b64 v[54:55], v14 offset:80
    ds_read_b64 v[44:45], v13 offset:4352
    ds_read_b64 v[46:47], v19 offset:4352
    ds_read_b64 v[56:57], v13 offset:4432
    ds_read_b64 v[58:59], v14 offset:4432
    ds_read_b64 v[60:61], v13 offset:120
    ds_read_b64 v[62:63], v14 offset:120
    ds_read_b64 v[48:49], v13 offset:4392
    ds_read_b64 v[50:51], v20 offset:4352
    ds_read_b64 v[64:65], v13 offset:4472
    ds_read_b64 v[66:67], v14 offset:4472
    s_waitcnt lgkmcnt(6)
    v_mfma_f32_16x16x32_bf16 v[84:87], v[52:55], v[44:47], v[36:39]
    v_mfma_f32_16x16x32_bf16 v[88:91], v[56:59], v[44:47], v[32:35]
    s_waitcnt lgkmcnt(0)
    v_mfma_f32_16x16x32_bf16 v[92:95], v[60:63], v[48:51], v[36:39]
    v_mfma_f32_16x16x32_bf16 v[96:99], v[64:67], v[48:51], v[32:35]
    ds_read_b64_tr_b16 v[68:69], v15 offset:160
    ds_read_b64_tr_b16 v[70:71], v15 offset:4512
    ds_read_b64_tr_b16 v[76:77], v21 offset:0
    ds_read_b64_tr_b16 v[78:79], v21 offset:4352
    ds_read_b64_tr_b16 v[72:73], v15 offset:200
    ds_read_b64_tr_b16 v[74:75], v15 offset:4552
    ds_read_b64_tr_b16 v[80:81], v22 offset:0
    ds_read_b64_tr_b16 v[82:83], v22 offset:4352
    v_max3_f32 v120, v84, v85, v88
    v_max3_f32 v121, v86, v87, v90
    v_max_f32 v120, v120, v89
    v_max_f32 v121, v121, v91
    v_max3_f32 v122, v92, v93, v96
    v_max3_f32 v123, v94, v95, v98
    v_max_f32 v122, v122, v97
    v_max_f32 v123, v123, v99
    v_cvt_pk_bf16_f32 v124, v120, v121
    v_cvt_pk_bf16_f32 v125, v122, v123
    v_lshlrev_b32 v120, 16, v124
    v_and_b32 v121, 0xffff0000, v124
    v_lshlrev_b32 v122, 16, v125
    v_and_b32 v123, 0xffff0000, v125
    v_pk_mul_f32 v[120:121], v[120:121], s[48:49]
    v_pk_mul_f32 v[122:123], v[122:123], s[48:49]
    v_cvt_pk_bf16_f32 v124, v120, v121
    v_cvt_pk_bf16_f32 v125, v122, v123
    s_nop 1
    v_permlane16_swap_b32 v124, v125
    v_lshlrev_b32 v120, 16, v124
    v_and_b32 v121, 0xffff0000, v124
    v_lshlrev_b32 v122, 16, v125
    v_and_b32 v123, 0xffff0000, v125
    v_max3_f32 v126, v120, v121, v122
    v_max_f32 v126, v126, v123
    v_mov_b32 v127, v126
    s_nop 1
    v_permlane32_swap_b32 v126, v127
    v_max_f32 v126, v126, v127
    v_mul_f32 v126, s46, v126
    v_pk_fma_f32 v[120:121], v[120:121], s[46:47], v[126:127] op_sel_hi:[1,1,0] neg_lo:[0,0,1] neg_hi:[0,0,1]
    v_pk_fma_f32 v[122:123], v[122:123], s[46:47], v[126:127] op_sel_hi:[1,1,0] neg_lo:[0,0,1] neg_hi:[0,0,1]
    v_exp_f32 v120, v120
    v_exp_f32 v121, v121
    v_exp_f32 v122, v122
    v_exp_f32 v123, v123
    s_nop 0
    v_pk_add_f32 v[128:129], v[120:121], v[122:123]
    v_add_f32 v128, v128, v129
    v_mov_b32 v129, v128
    s_nop 1
    v_permlane32_swap_b32 v128, v129
    v_add_f32 v128, v128, v129
    v_rcp_f32 v128, v128
    s_waitcnt lgkmcnt(0)
    v_pk_mul_f32 v[120:121], v[120:121], v[128:129] op_sel_hi:[1,0]
    v_pk_mul_f32 v[122:123], v[122:123], v[128:129] op_sel_hi:[1,0]
    v_cvt_pk_bf16_f32 v124, v120, v121
    v_cvt_pk_bf16_f32 v125, v122, v123
    s_nop 1
    v_permlane16_swap_b32 v124, v125
    v_perm_b32 v100, v124, v124, v40
    v_perm_b32 v101, v124, v124, v41
    v_perm_b32 v102, v124, v124, v42
    v_perm_b32 v103, v124, v124, v43
    v_perm_b32 v104, v125, v125, v40
    v_perm_b32 v105, v125, v125, v41
    v_perm_b32 v106, v125, v125, v42
    v_perm_b32 v107, v125, v125, v43
    v_mfma_f32_16x16x32_bf16 v[108:111], v[68:71], v[100:103], 0
    v_mfma_f32_16x16x32_bf16 v[116:119], v[76:79], v[100:103], 0
    v_mfma_f32_16x16x32_bf16 v[112:115], v[72:75], v[104:107], 0
    v_mfma_f32_16x16x32_bf16 v[116:119], v[80:83], v[104:107], v[116:119]
    s_nop 4
    v_cvt_pk_bf16_f32 v132, v108, v109
    v_cvt_pk_bf16_f32 v133, v110, v111
    v_cvt_pk_bf16_f32 v134, v112, v113
    v_cvt_pk_bf16_f32 v135, v114, v115
    buffer_store_dwordx4 v[132:135], v16, s[20:23], s50 offen sc1
    v_cvt_pk_bf16_f32 v126, v116, v117
    v_cvt_pk_bf16_f32 v127, v118, v119
    buffer_store_dwordx2 v[126:127], v17, s[20:23], s50 offen sc1
    s_cmp_eq_u32 s34, -1
    s_cbranch_scc1 K_DRAIN
    s_cmp_lg_u32 s30, 6
    s_cbranch_scc1 K_NOFL
    s_waitcnt vmcnt(12)
    v_and_b32 v4, 7, v1
    v_lshlrev_b32 v4, 2, v4
    s_mov_b32 s3, 131072
K_ZPOLL2:
    v_cmp_eq_u32 vcc, 0, v7
    s_cbranch_vccz K_ZOK2
    s_sub_u32 s3, s3, 1
    s_cbranch_scc1 K_ZOK2
    global_load_dword v7, v4, s[8:9] offset:192 sc1
    s_waitcnt vmcnt(0)
    s_branch K_ZPOLL2
K_ZOK2:
    v_and_b32 v2, 1, v1
    v_lshl_add_u32 v2, v2, 2, s42
    global_load_dword v7, v2, s[10:11] offset:128 sc1
K_NOFL:
    v_mov_b32 v4, 158720
    v_mov_b32 v3, 257
    s_mov_b64 exec, 1
    s_waitcnt vmcnt(0)
    ds_add_rtn_u32 v2, v4, v3 offset:48
    s_mov_b32 exec_lo, s36
    v_mov_b32 v3, 1
    s_waitcnt lgkmcnt(0)
    v_readfirstlane_b32 s33, v2
    s_nop 3
    s_and_b32 s33, s33, 0xff
    s_cmp_lg_u32 s33, 7
    s_cbranch_scc1 K_ARRS
    global_store_dword v8, v3, s[10:11] sc1
K_ARRS:
    s_mov_b64 exec, -1
    s_cmp_ge_u32 s30, 6
    s_cbranch_scc1 K_P2_HELP
    s_mov_b32 s3, 1048576
K_LG:
    ds_read_b32 v2, v4 offset:48
    s_sub_u32 s3, s3, 1
    s_waitcnt lgkmcnt(0)
    v_readfirstlane_b32 s33, v2
    s_nop 3
    s_cselect_b32 s33, 8, s33
    s_bitcmp0_b32 s33, 3
    s_cbranch_scc1 K_LG
    s_sub_u32 s44, s30, 4
K_WOL:
    s_lshl_b32 s50, s44, 2
    s_lshr_b32 s50, 0x6431, s50
    s_and_b32 s50, s50, 7
    s_mul_i32 s50, s50, 51200
    s_mul_i32 s51, s44, 5120
    s_add_u32 s3, s50, 0
    s_add_u32 m0, s51, 40960
    s_waitcnt vmcnt(13)
    buffer_load_dwordx4 v18, s[24:27], s3 offen lds
    s_add_u32 s3, s50, 10240
    s_add_u32 m0, s51, 41984
    s_waitcnt vmcnt(13)
    buffer_load_dwordx4 v18, s[24:27], s3 offen lds
    s_add_u32 s3, s50, 20480
    s_add_u32 m0, s51, 43008
    s_waitcnt vmcnt(13)
    buffer_load_dwordx4 v18, s[24:27], s3 offen lds
    s_add_u32 s3, s50, 30720
    s_add_u32 m0, s51, 44032
    s_waitcnt vmcnt(13)
    buffer_load_dwordx4 v18, s[24:27], s3 offen lds
    s_add_u32 s3, s50, 40960
    s_add_u32 m0, s51, 45056
    s_waitcnt vmcnt(13)
    buffer_load_dwordx4 v18, s[24:27], s3 offen lds
    s_add_u32 s3, s50, 409600
    s_add_u32 m0, s51, 61440
    s_waitcnt vmcnt(13)
    buffer_load_dwordx4 v18, s[24:27], s3 offen lds
    s_add_u32 s3, s50, 419840
    s_add_u32 m0, s51, 62464
    s_waitcnt vmcnt(13)
    buffer_load_dwordx4 v18, s[24:27], s3 offen lds
    s_add_u32 s3, s50, 430080
    s_add_u32 m0, s51, 63488
    s_waitcnt vmcnt(13)
    buffer_load_dwordx4 v18, s[24:27], s3 offen lds
    s_add_u32 s3, s50, 440320
    s_add_u32 m0, s51, 64512
    s_waitcnt vmcnt(13)
    buffer_load_dwordx4 v18, s[24:27], s3 offen lds
    s_add_u32 s3, s50, 450560
    s_add_u32 m0, s51, 65536
    s_waitcnt vmcnt(13)
    buffer_load_dwordx4 v18, s[24:27], s3 offen lds
    s_add_u32 s44, s44, 2
    s_cmp_lt_u32 s44, 4
    s_cbranch_scc1 K_WOL
    v_mov_b32 v2, 158720
    v_mov_b32 v3, 2
    s_waitcnt vmcnt(0)
    s_mov_b64 exec, 1
    ds_add_u32 v2, v3 offset:44
    s_mov_b64 exec, -1
    s_branch K_P2_HELP
WP_early:
    s_setpc_b64 s[38:39]
K_P2_EARLY:
    s_lshl_b32 s54, s40, 7
    v_lshrrev_b32 v9, 4, v1
    v_mov_b32 v12, 158720
    s_add_u32 s20, s10, 0x100000
    s_addc_u32 s21, s11, 0
    s_mov_b32 s22, 0x280000
    s_mov_b32 s23, 0x20000
    s_add_u32 s16, s10, 0x1000
    s_addc_u32 s17, s11, 0
    s_mov_b32 s18, 0x2000
    s_mov_b32 s19, 0x20000
    s_mov_b32 s48, s6
    s_mov_b32 s49, s7
    s_mov_b32 s50, 0x280000
    s_mov_b32 s51, 0x20000
    s_lshl_b32 s53, s40, 3
    s_lshl1_add_u32 s53, s30, s53
    s_mov_b32 s55, 20480
    v_bfe_u32 v20, v1, 2, 2
    v_and_b32 v21, 3, v1
    s_mul_i32 s3, s53, 20480
    v_lshl_add_u32 v25, v1, 4, s3
    v_add_u32 v26, 20480, v25
    v_and_b32 v2, 15, v1
    s_lshl_b32 s3, s53, 6
    v_lshl_add_u32 v23, v2, 2, s3
    v_lshl_add_u32 v2, v9, 2, v20
    v_bfe_u32 v3, v2, 1, 2
    v_lshlrev_b32 v2, 7, v2
    v_lshl_add_u32 v2, v21, 3, v2
    v_lshl_add_u32 v24, v3, 5, v2
    v_lshrrev_b32 v3, 1, v20
    v_mul_u32_u24 v2, 40, v9
    v_add3_u32 v2, v2, 16, v20
    v_lshlrev_b32 v2, 7, v2
    v_lshl_add_u32 v2, v21, 3, v2
    v_xor_b32 v4, 0, v3
    v_lshl_add_u32 v56, v4, 5, v2
    v_xor_b32 v4, 1, v3
    v_lshl_add_u32 v57, v4, 5, v2
    v_xor_b32 v4, 2, v3
    v_lshl_add_u32 v58, v4, 5, v2
    v_xor_b32 v4, 3, v3
    v_lshl_add_u32 v59, v4, 5, v2
    v_lshrrev_b32 v3, 4, v1
    v_and_b32 v4, 7, v1
    v_lshrrev_b32 v2, 3, v1
    v_xor_b32 v4, v4, v3
    v_mul_u32_u24 v2, 1280, v2
    v_lshl_add_u32 v27, v4, 4, v2
    v_xor_b32 v28, 64, v27
    s_lshl_b32 s71, s40, 3
    s_lshl1_add_u32 s71, s30, s71
    s_mul_i32 s71, s71, 20480
    s_lshl_b32 s33, s41, 7
    s_add_u32 s71, s71, s33
    s_add_u32 s72, s71, 10240
    s_add_u32 s73, s71, 20480
    s_add_u32 s74, s71, 30720
    s_lshl_b32 s3, s30, 12
    s_add_u32 s3, s3, 140288
    v_lshl_add_u32 v33, v1, 4, s3
    v_and_b32 v2, 15, v1
    v_lshrrev_b32 v3, 1, v2
    v_lshrrev_b32 v4, 5, v1
    v_xor_b32 v3, v3, v4
    v_lshlrev_b32 v3, 4, v3
    v_lshl_add_u32 v3, v2, 7, v3
    v_and_b32 v4, 1, v9
    v_lshl_add_u32 v3, v4, 3, v3
    v_add_u32 v29, s3, v3
    v_xor_b32 v30, 32, v29
    v_xor_b32 v31, 64, v29
    v_xor_b32 v32, 96, v29
    s_lshl_b32 s3, s40, 3
    s_mul_i32 s33, s3, 187
    s_lshr_b32 s33, s33, 11
    s_add_u32 s33, s33, 1
    s_mul_i32 s33, s33, 11
    s_cmp_ge_u32 s53, s33
    s_cselect_b32 s64, 16, 0
    s_add_u32 s3, s53, 1
    s_cmp_ge_u32 s3, s33
    s_cselect_b32 s65, 16, 0
    s_mov_b32 s63, 0
    s_mov_b32 s66, 0
    s_mov_b32 s67, 16384
    v_mov_b32 v4, 158720
    v_mov_b32 v3, 1
    s_mov_b64 exec, 1
    s_waitcnt vmcnt(0)
    ds_add_rtn_u32 v2, v4, v3 offset:48
    s_mov_b32 exec_lo, s36
    v_mov_b32 v3, 1
    s_waitcnt lgkmcnt(0)
    v_readfirstlane_b32 s33, v2
    s_nop 3
    s_and_b32 s33, s33, 0xff
    s_cmp_lg_u32 s33, 7
    s_cbranch_scc1 K_ARRD
    global_store_dword v8, v3, s[10:11] sc1
K_ARRD:
    s_mov_b64 exec, -1
    s_mov_b32 s3, 1048576
K_P2_GE:
    ds_read_b32 v2, v12 offset:48
    s_sub_u32 s3, s3, 1
    s_waitcnt lgkmcnt(0)
    v_readfirstlane_b32 s33, v2
    s_nop 3
    s_cselect_b32 s33, 1024, s33
    s_cmp_lt_u32 s33, 1024
    s_cbranch_scc1 K_P2_GE
K_P2_GEMM:
    ds_read_b64 v[36:37], v29 offset:0
    ds_read_b64 v[38:39], v30 offset:0
    ds_read_b64 v[40:41], v31 offset:0
    ds_read_b64 v[42:43], v32 offset:0
    ds_read_b64 v[44:45], v29 offset:2048
    ds_read_b64 v[46:47], v30 offset:2048
    ds_read_b64 v[48:49], v31 offset:2048
    ds_read_b64 v[50:51], v32 offset:2048
    s_waitcnt lgkmcnt(4)
    v_lshlrev_b32 v68, 16, v36
    v_and_b32 v69, 0xffff0000, v36
    v_lshlrev_b32 v70, 16, v37
    v_and_b32 v71, 0xffff0000, v37
    v_lshlrev_b32 v72, 16, v38
    v_and_b32 v73, 0xffff0000, v38
    v_lshlrev_b32 v74, 16, v39
    v_and_b32 v75, 0xffff0000, v39
    v_lshlrev_b32 v76, 16, v40
    v_and_b32 v77, 0xffff0000, v40
    v_lshlrev_b32 v78, 16, v41
    v_and_b32 v79, 0xffff0000, v41
    v_lshlrev_b32 v80, 16, v42
    v_and_b32 v81, 0xffff0000, v42
    v_lshlrev_b32 v82, 16, v43
    v_and_b32 v83, 0xffff0000, v43
    s_waitcnt lgkmcnt(0)
    v_lshlrev_b32 v84, 16, v44
    v_and_b32 v85, 0xffff0000, v44
    v_lshlrev_b32 v86, 16, v45
    v_and_b32 v87, 0xffff0000, v45
    v_lshlrev_b32 v88, 16, v46
    v_and_b32 v89, 0xffff0000, v46
    v_lshlrev_b32 v90, 16, v47
    v_and_b32 v91, 0xffff0000, v47
    v_lshlrev_b32 v92, 16, v48
    v_and_b32 v93, 0xffff0000, v48
    v_lshlrev_b32 v94, 16, v49
    v_and_b32 v95, 0xffff0000, v49
    v_lshlrev_b32 v96, 16, v50
    v_and_b32 v97, 0xffff0000, v50
    v_lshlrev_b32 v98, 16, v51
    v_and_b32 v99, 0xffff0000, v51
    s_setprio 2
    s_cmp_eq_u32 s63, 0
    s_cbranch_scc1 K_SP0
K_SPR0:
    s_ff1_i32_b32 s33, s63
    s_bitset0_b32 s63, s33
    s_lshl_b32 s75, s33, 10
    buffer_load_dwordx4 v[100:103], v25, s[20:23], s75 offen offset:0 sc1
    buffer_load_dwordx4 v[104:107], v26, s[20:23], s75 offen offset:0 sc1
    v_mad_u32_u24 v52, s75, 5, v24
    v_xor_b32 v54, 64, v52
    v_xor_b32 v53, 32, v52
    v_xor_b32 v55, 96, v52
    ds_read_b64_tr_b16 v[180:181], v52 offset:0
    ds_read_b64_tr_b16 v[182:183], v54 offset:2560
    ds_read_b64_tr_b16 v[184:185], v53 offset:0
    ds_read_b64_tr_b16 v[186:187], v55 offset:2560
    ds_read_b64_tr_b16 v[188:189], v54 offset:0
    ds_read_b64_tr_b16 v[190:191], v52 offset:2560
    ds_read_b64_tr_b16 v[192:193], v55 offset:0
    ds_read_b64_tr_b16 v[194:195], v53 offset:2560
    s_cmp_eq_u32 s63, 0
    s_cbranch_scc1 K_SP1
K_SPR1:
    s_ff1_i32_b32 s33, s63
    s_bitset0_b32 s63, s33
    s_lshl_b32 s76, s33, 10
    buffer_load_dwordx4 v[108:111], v25, s[20:23], s76 offen offset:0 sc1
    buffer_load_dwordx4 v[112:115], v26, s[20:23], s76 offen offset:0 sc1
    v_mad_u32_u24 v52, s76, 5, v24
    v_xor_b32 v54, 64, v52
    v_xor_b32 v53, 32, v52
    v_xor_b32 v55, 96, v52
    ds_read_b64_tr_b16 v[196:197], v52 offset:0
    ds_read_b64_tr_b16 v[198:199], v54 offset:2560
    ds_read_b64_tr_b16 v[200:201], v53 offset:0
    ds_read_b64_tr_b16 v[202:203], v55 offset:2560
    ds_read_b64_tr_b16 v[204:205], v54 offset:0
    ds_read_b64_tr_b16 v[206:207], v52 offset:2560
    ds_read_b64_tr_b16 v[208:209], v55 offset:0
    ds_read_b64_tr_b16 v[210:211], v53 offset:2560
    s_cmp_eq_u32 s63, 0
    s_cbranch_scc1 K_SP2
K_SPR2:
    s_ff1_i32_b32 s33, s63
    s_bitset0_b32 s63, s33
    s_lshl_b32 s77, s33, 10
    buffer_load_dwordx4 v[116:119], v25, s[20:23], s77 offen offset:0 sc1
    buffer_load_dwordx4 v[120:123], v26, s[20:23], s77 offen offset:0 sc1
    s_cmp_eq_u32 s63, 0
    s_cbranch_scc1 K_SP3
K_SPR3:
    s_ff1_i32_b32 s33, s63
    s_bitset0_b32 s63, s33
    s_lshl_b32 s78, s33, 10
    buffer_load_dwordx4 v[124:127], v25, s[20:23], s78 offen offset:0 sc1
    buffer_load_dwordx4 v[128:131], v26, s[20:23], s78 offen offset:0 sc1
    s_cmp_eq_u32 s63, 0
    s_cbranch_scc1 K_SP4
K_SPR4:
    s_ff1_i32_b32 s33, s63
    s_bitset0_b32 s63, s33
    s_lshl_b32 s75, s33, 10
    buffer_load_dwordx4 v[132:135], v25, s[20:23], s75 offen offset:0 sc1
    buffer_load_dwordx4 v[136:139], v26, s[20:23], s75 offen offset:0 sc1
    s_branch WS_p2g
.p2align 12
WP_p2g:
    s_setpc_b64 s[38:39]
WS_p2g:
    s_waitcnt vmcnt(8) lgkmcnt(8)
    v_mfma_f32_16x16x32_bf16 v[148:151], v[180:183], v[100:103], 0
    v_mad_u32_u24 v52, s77, 5, v24
    v_xor_b32 v54, 64, v52
    v_xor_b32 v53, 32, v52
    v_mfma_f32_16x16x32_bf16 v[164:167], v[180:183], v[104:107], 0
    v_xor_b32 v55, 96, v52
    ds_read_b64_tr_b16 v[212:213], v52 offset:0
    ds_read_b64_tr_b16 v[214:215], v54 offset:2560
    v_mfma_f32_16x16x32_bf16 v[152:155], v[184:187], v[100:103], 0
    ds_read_b64_tr_b16 v[216:217], v53 offset:0
    ds_read_b64_tr_b16 v[218:219], v55 offset:2560
    ds_read_b64_tr_b16 v[220:221], v54 offset:0
    v_mfma_f32_16x16x32_bf16 v[168:171], v[184:187], v[104:107], 0
    ds_read_b64_tr_b16 v[222:223], v52 offset:2560
    ds_read_b64_tr_b16 v[224:225], v55 offset:0
    v_mfma_f32_16x16x32_bf16 v[156:159], v[188:191], v[100:103], 0
    ds_read_b64_tr_b16 v[226:227], v53 offset:2560
    s_cmp_eq_u32 s63, 0
    v_mfma_f32_16x16x32_bf16 v[172:175], v[188:191], v[104:107], 0
    s_cbranch_scc1 K_SP5
K_SPR5:
    s_ff1_i32_b32 s33, s63
    v_mfma_f32_16x16x32_bf16 v[160:163], v[192:195], v[100:103], 0
    s_bitset0_b32 s63, s33
    s_lshl_b32 s76, s33, 10
    v_mfma_f32_16x16x32_bf16 v[176:179], v[192:195], v[104:107], 0
    buffer_load_dwordx4 v[140:143], v25, s[20:23], s76 offen offset:0 sc1
    buffer_load_dwordx4 v[144:147], v26, s[20:23], s76 offen offset:0 sc1
    s_waitcnt vmcnt(8) lgkmcnt(8)
    v_mfma_f32_16x16x32_bf16 v[148:151], v[196:199], v[108:111], v[148:151]
    v_mad_u32_u24 v52, s78, 5, v24
    v_xor_b32 v54, 64, v52
    v_xor_b32 v53, 32, v52
    v_mfma_f32_16x16x32_bf16 v[164:167], v[196:199], v[112:115], v[164:167]
    v_xor_b32 v55, 96, v52
    ds_read_b64_tr_b16 v[180:181], v52 offset:0
    ds_read_b64_tr_b16 v[182:183], v54 offset:2560
    v_mfma_f32_16x16x32_bf16 v[152:155], v[200:203], v[108:111], v[152:155]
    ds_read_b64_tr_b16 v[184:185], v53 offset:0
    ds_read_b64_tr_b16 v[186:187], v55 offset:2560
    ds_read_b64_tr_b16 v[188:189], v54 offset:0
    v_mfma_f32_16x16x32_bf16 v[168:171], v[200:203], v[112:115], v[168:171]
    ds_read_b64_tr_b16 v[190:191], v52 offset:2560
    ds_read_b64_tr_b16 v[192:193], v55 offset:0
    v_mfma_f32_16x16x32_bf16 v[156:159], v[204:207], v[108:111], v[156:159]
    ds_read_b64_tr_b16 v[194:195], v53 offset:2560
    s_cmp_eq_u32 s63, 0
    v_mfma_f32_16x16x32_bf16 v[172:175], v[204:207], v[112:115], v[172:175]
    s_cbranch_scc1 K_SP6
K_SPR6:
    s_ff1_i32_b32 s33, s63
    v_mfma_f32_16x16x32_bf16 v[160:163], v[208:211], v[108:111], v[160:163]
    s_bitset0_b32 s63, s33
    s_lshl_b32 s77, s33, 10
    v_mfma_f32_16x16x32_bf16 v[176:179], v[208:211], v[112:115], v[176:179]
    buffer_load_dwordx4 v[100:103], v25, s[20:23], s77 offen offset:0 sc1
    buffer_load_dwordx4 v[104:107], v26, s[20:23], s77 offen offset:0 sc1
    s_waitcnt vmcnt(8) lgkmcnt(8)
    v_mfma_f32_16x16x32_bf16 v[148:151], v[212:215], v[116:119], v[148:151]
    v_mad_u32_u24 v52, s75, 5, v24
    v_xor_b32 v54, 64, v52
    v_xor_b32 v53, 32, v52
    v_mfma_f32_16x16x32_bf16 v[164:167], v[212:215], v[120:123], v[164:167]
    v_xor_b32 v55, 96, v52
    ds_read_b64_tr_b16 v[196:197], v52 offset:0
    ds_read_b64_tr_b16 v[198:199], v54 offset:2560
    v_mfma_f32_16x16x32_bf16 v[152:155], v[216:219], v[116:119], v[152:155]
    ds_read_b64_tr_b16 v[200:201], v53 offset:0
    ds_read_b64_tr_b16 v[202:203], v55 offset:2560
    ds_read_b64_tr_b16 v[204:205], v54 offset:0
    v_mfma_f32_16x16x32_bf16 v[168:171], v[216:219], v[120:123], v[168:171]
    ds_read_b64_tr_b16 v[206:207], v52 offset:2560
    ds_read_b64_tr_b16 v[208:209], v55 offset:0
    v_mfma_f32_16x16x32_bf16 v[156:159], v[220:223], v[116:119], v[156:159]
    ds_read_b64_tr_b16 v[210:211], v53 offset:2560
    s_cmp_eq_u32 s63, 0
    v_mfma_f32_16x16x32_bf16 v[172:175], v[220:223], v[120:123], v[172:175]
    s_cbranch_scc1 K_SP7
K_SPR7:
    s_ff1_i32_b32 s33, s63
    v_mfma_f32_16x16x32_bf16 v[160:163], v[224:227], v[116:119], v[160:163]
    s_bitset0_b32 s63, s33
    s_lshl_b32 s78, s33, 10
    v_mfma_f32_16x16x32_bf16 v[176:179], v[224:227], v[120:123], v[176:179]
    buffer_load_dwordx4 v[108:111], v25, s[20:23], s78 offen offset:0 sc1
    buffer_load_dwordx4 v[112:115], v26, s[20:23], s78 offen offset:0 sc1
    s_mov_b32 s3, 1048576
K_P2_GS:
    ds_read_b32 v2, v12 offset:40
    s_sub_u32 s3, s3, 1
    s_waitcnt lgkmcnt(0)
    v_readfirstlane_b32 s33, v2
    s_nop 3
    s_cselect_b32 s33, 1, s33
    s_cmp_lt_u32 s33, 1
    s_cbranch_scc1 K_P2_GS
    buffer_load_dword v60, v23, s[16:19], 0 offen offset:0 sc1
    buffer_load_dword v62, v23, s[16:19], 0 offen offset:64 sc1
    ds_read_b128 v[16:19], v12
    s_waitcnt vmcnt(10)
    v_mfma_f32_16x16x32_bf16 v[148:151], v[180:183], v[124:127], v[148:151]
    v_mad_u32_u24 v52, s76, 5, v24
    v_xor_b32 v54, 64, v52
    v_mfma_f32_16x16x32_bf16 v[164:167], v[180:183], v[128:131], v[164:167]
    v_xor_b32 v53, 32, v52
    v_xor_b32 v55, 96, v52
    v_mfma_f32_16x16x32_bf16 v[152:155], v[184:187], v[124:127], v[152:155]
    ds_read_b64_tr_b16 v[212:213], v52 offset:0
    ds_read_b64_tr_b16 v[214:215], v54 offset:2560
    v_mfma_f32_16x16x32_bf16 v[168:171], v[184:187], v[128:131], v[168:171]
    ds_read_b64_tr_b16 v[216:217], v53 offset:0
    ds_read_b64_tr_b16 v[218:219], v55 offset:2560
    v_mfma_f32_16x16x32_bf16 v[156:159], v[188:191], v[124:127], v[156:159]
    ds_read_b64_tr_b16 v[220:221], v54 offset:0
    ds_read_b64_tr_b16 v[222:223], v52 offset:2560
    v_mfma_f32_16x16x32_bf16 v[172:175], v[188:191], v[128:131], v[172:175]
    ds_read_b64_tr_b16 v[224:225], v55 offset:0
    ds_read_b64_tr_b16 v[226:227], v53 offset:2560
    v_mfma_f32_16x16x32_bf16 v[160:163], v[192:195], v[124:127], v[160:163]
    buffer_load_dwordx4 v[116:119], v25, s[20:23], s67 offen offset:0 sc1
    buffer_load_dwordx4 v[120:123], v26, s[20:23], s67 offen offset:0 sc1
    v_mfma_f32_16x16x32_bf16 v[176:179], v[192:195], v[128:131], v[176:179]
    s_waitcnt vmcnt(10)
    v_mfma_f32_16x16x32_bf16 v[148:151], v[196:199], v[132:135], v[148:151]
    v_mad_u32_u24 v52, s77, 5, v24
    v_xor_b32 v54, 64, v52
    v_mfma_f32_16x16x32_bf16 v[164:167], v[196:199], v[136:139], v[164:167]
    v_xor_b32 v53, 32, v52
    v_xor_b32 v55, 96, v52
    v_mfma_f32_16x16x32_bf16 v[152:155], v[200:203], v[132:135], v[152:155]
    ds_read_b64_tr_b16 v[180:181], v52 offset:0
    ds_read_b64_tr_b16 v[182:183], v54 offset:2560
    v_mfma_f32_16x16x32_bf16 v[168:171], v[200:203], v[136:139], v[168:171]
    ds_read_b64_tr_b16 v[184:185], v53 offset:0
    ds_read_b64_tr_b16 v[186:187], v55 offset:2560
    v_mfma_f32_16x16x32_bf16 v[156:159], v[204:207], v[132:135], v[156:159]
    ds_read_b64_tr_b16 v[188:189], v54 offset:0
    ds_read_b64_tr_b16 v[190:191], v52 offset:2560
    v_mfma_f32_16x16x32_bf16 v[172:175], v[204:207], v[136:139], v[172:175]
    ds_read_b64_tr_b16 v[192:193], v55 offset:0
    ds_read_b64_tr_b16 v[194:195], v53 offset:2560
    v_mfma_f32_16x16x32_bf16 v[160:163], v[208:211], v[132:135], v[160:163]
    buffer_load_dwordx4 v[124:127], v25, s[20:23], s67 offen offset:1024 sc1
    buffer_load_dwordx4 v[128:131], v26, s[20:23], s67 offen offset:1024 sc1
    v_mfma_f32_16x16x32_bf16 v[176:179], v[208:211], v[136:139], v[176:179]
    s_waitcnt vmcnt(10) lgkmcnt(8)
    v_mfma_f32_16x16x32_bf16 v[148:151], v[212:215], v[140:143], v[148:151]
    v_mad_u32_u24 v52, s78, 5, v24
    v_xor_b32 v54, 64, v52
    v_xor_b32 v53, 32, v52
    v_mfma_f32_16x16x32_bf16 v[164:167], v[212:215], v[144:147], v[164:167]
    v_xor_b32 v55, 96, v52
    ds_read_b64_tr_b16 v[196:197], v52 offset:0
    ds_read_b64_tr_b16 v[198:199], v54 offset:2560
    v_mfma_f32_16x16x32_bf16 v[152:155], v[216:219], v[140:143], v[152:155]
    ds_read_b64_tr_b16 v[200:201], v53 offset:0
    ds_read_b64_tr_b16 v[202:203], v55 offset:2560
    ds_read_b64_tr_b16 v[204:205], v54 offset:0
    v_mfma_f32_16x16x32_bf16 v[168:171], v[216:219], v[144:147], v[168:171]
    ds_read_b64_tr_b16 v[206:207], v52 offset:2560
    ds_read_b64_tr_b16 v[208:209], v55 offset:0
    v_mfma_f32_16x16x32_bf16 v[156:159], v[220:223], v[140:143], v[156:159]
    ds_read_b64_tr_b16 v[210:211], v53 offset:2560
    s_cmp_eq_u32 s63, 0
    v_mfma_f32_16x16x32_bf16 v[172:175], v[220:223], v[144:147], v[172:175]
    s_cbranch_scc1 K_SP10
K_SPR10:
    s_ff1_i32_b32 s33, s63
    v_mfma_f32_16x16x32_bf16 v[160:163], v[224:227], v[140:143], v[160:163]
    s_bitset0_b32 s63, s33
    s_lshl_b32 s77, s33, 10
    v_mfma_f32_16x16x32_bf16 v[176:179], v[224:227], v[144:147], v[176:179]
    buffer_load_dwordx4 v[132:135], v25, s[20:23], s77 offen offset:0 sc1
    buffer_load_dwordx4 v[136:139], v26, s[20:23], s77 offen offset:0 sc1
    s_waitcnt vmcnt(10) lgkmcnt(8)
    v_mfma_f32_16x16x32_bf16 v[148:151], v[180:183], v[100:103], v[148:151]
    ds_read_b64_tr_b16 v[212:213], v56 offset:0
    ds_read_b64_tr_b16 v[214:215], v58 offset:2560
    v_mfma_f32_16x16x32_bf16 v[164:167], v[180:183], v[104:107], v[164:167]
    ds_read_b64_tr_b16 v[216:217], v57 offset:0
    ds_read_b64_tr_b16 v[218:219], v59 offset:2560
    v_mfma_f32_16x16x32_bf16 v[152:155], v[184:187], v[100:103], v[152:155]
    ds_read_b64_tr_b16 v[220:221], v58 offset:0
    ds_read_b64_tr_b16 v[222:223], v56 offset:2560
    v_mfma_f32_16x16x32_bf16 v[168:171], v[184:187], v[104:107], v[168:171]
    ds_read_b64_tr_b16 v[224:225], v59 offset:0
    ds_read_b64_tr_b16 v[226:227], v57 offset:2560
    v_mfma_f32_16x16x32_bf16 v[156:159], v[188:191], v[100:103], v[156:159]
    s_cmp_eq_u32 s63, 0
    s_cbranch_scc1 K_SP11
K_SPR11:
    v_mfma_f32_16x16x32_bf16 v[172:175], v[188:191], v[104:107], v[172:175]
    s_ff1_i32_b32 s33, s63
    s_bitset0_b32 s63, s33
    v_mfma_f32_16x16x32_bf16 v[160:163], v[192:195], v[100:103], v[160:163]
    s_lshl_b32 s78, s33, 10
    buffer_load_dwordx4 v[140:143], v25, s[20:23], s78 offen offset:0 sc1
    v_mfma_f32_16x16x32_bf16 v[176:179], v[192:195], v[104:107], v[176:179]
    buffer_load_dwordx4 v[144:147], v26, s[20:23], s78 offen offset:0 sc1
    s_waitcnt vmcnt(10) lgkmcnt(8)
    v_mfma_f32_16x16x32_bf16 v[148:151], v[196:199], v[108:111], v[148:151]
    ds_read_b64_tr_b16 v[180:181], v56 offset:20480
    ds_read_b64_tr_b16 v[182:183], v58 offset:23040
    v_mfma_f32_16x16x32_bf16 v[164:167], v[196:199], v[112:115], v[164:167]
    ds_read_b64_tr_b16 v[184:185], v57 offset:20480
    ds_read_b64_tr_b16 v[186:187], v59 offset:23040
    v_mfma_f32_16x16x32_bf16 v[152:155], v[200:203], v[108:111], v[152:155]
    ds_read_b64_tr_b16 v[188:189], v58 offset:20480
    ds_read_b64_tr_b16 v[190:191], v56 offset:23040
    v_mfma_f32_16x16x32_bf16 v[168:171], v[200:203], v[112:115], v[168:171]
    ds_read_b64_tr_b16 v[192:193], v59 offset:20480
    ds_read_b64_tr_b16 v[194:195], v57 offset:23040
    v_mfma_f32_16x16x32_bf16 v[156:159], v[204:207], v[108:111], v[156:159]
    s_cmp_eq_u32 s63, 0
    s_cbranch_scc1 K_SP12
K_SPR12:
    v_mfma_f32_16x16x32_bf16 v[172:175], v[204:207], v[112:115], v[172:175]
    s_ff1_i32_b32 s33, s63
    s_bitset0_b32 s63, s33
    v_mfma_f32_16x16x32_bf16 v[160:163], v[208:211], v[108:111], v[160:163]
    s_lshl_b32 s75, s33, 10
    buffer_load_dwordx4 v[100:103], v25, s[20:23], s75 offen offset:0 sc1
    v_mfma_f32_16x16x32_bf16 v[176:179], v[208:211], v[112:115], v[176:179]
    buffer_load_dwordx4 v[104:107], v26, s[20:23], s75 offen offset:0 sc1
    s_mov_b32 s3, 1048576
K_P2_GW:
    ds_read_b32 v2, v12 offset:44
    s_sub_u32 s3, s3, 1
    s_waitcnt lgkmcnt(0)
    v_readfirstlane_b32 s33, v2
    s_nop 3
    s_cselect_b32 s33, 4, s33
    s_cmp_lt_u32 s33, 4
    s_cbranch_scc1 K_P2_GW
    v_readfirstlane_b32 s56, v16
    v_readfirstlane_b32 s57, v17
    s_lshl_b32 s58, s53, 4
    s_waitcnt vmcnt(8)
    v_mfma_f32_16x16x32_bf16 v[148:151], v[212:215], v[116:119], v[148:151]
    v_mad_u32_u24 v52, s77, 5, v24
    v_xor_b32 v54, 64, v52
    v_xor_b32 v53, 32, v52
    v_mfma_f32_16x16x32_bf16 v[164:167], v[212:215], v[120:123], v[164:167]
    v_xor_b32 v55, 96, v52
    ds_read_b64_tr_b16 v[196:197], v52 offset:0
    ds_read_b64_tr_b16 v[198:199], v54 offset:2560
    v_mfma_f32_16x16x32_bf16 v[152:155], v[216:219], v[116:119], v[152:155]
    ds_read_b64_tr_b16 v[200:201], v53 offset:0
    ds_read_b64_tr_b16 v[202:203], v55 offset:2560
    ds_read_b64_tr_b16 v[204:205], v54 offset:0
    v_mfma_f32_16x16x32_bf16 v[168:171], v[216:219], v[120:123], v[168:171]
    ds_read_b64_tr_b16 v[206:207], v52 offset:2560
    ds_read_b64_tr_b16 v[208:209], v55 offset:0
    v_mfma_f32_16x16x32_bf16 v[156:159], v[220:223], v[116:119], v[156:159]
    ds_read_b64_tr_b16 v[210:211], v53 offset:2560
    s_cmp_eq_u32 s63, 0
    v_mfma_f32_16x16x32_bf16 v[172:175], v[220:223], v[120:123], v[172:175]
    s_cbranch_scc1 K_SP13
K_SPR13:
    s_ff1_i32_b32 s33, s63
    v_mfma_f32_16x16x32_bf16 v[160:163], v[224:227], v[116:119], v[160:163]
    s_bitset0_b32 s63, s33
    s_lshl_b32 s76, s33, 10
    v_mfma_f32_16x16x32_bf16 v[176:179], v[224:227], v[120:123], v[176:179]
    buffer_load_dwordx4 v[108:111], v25, s[20:23], s76 offen offset:0 sc1
    buffer_load_dwordx4 v[112:115], v26, s[20:23], s76 offen offset:0 sc1
    s_waitcnt vmcnt(8)
    v_mfma_f32_16x16x32_bf16 v[148:151], v[180:183], v[124:127], v[148:151]
    v_mad_u32_u24 v52, s78, 5, v24
    v_xor_b32 v54, 64, v52
    v_xor_b32 v53, 32, v52
    v_mfma_f32_16x16x32_bf16 v[164:167], v[180:183], v[128:131], v[164:167]
    v_xor_b32 v55, 96, v52
    ds_read_b64_tr_b16 v[212:213], v52 offset:0
    ds_read_b64_tr_b16 v[214:215], v54 offset:2560
    v_mfma_f32_16x16x32_bf16 v[152:155], v[184:187], v[124:127], v[152:155]
    ds_read_b64_tr_b16 v[216:217], v53 offset:0
    ds_read_b64_tr_b16 v[218:219], v55 offset:2560
    ds_read_b64_tr_b16 v[220:221], v54 offset:0
    v_mfma_f32_16x16x32_bf16 v[168:171], v[184:187], v[128:131], v[168:171]
    ds_read_b64_tr_b16 v[222:223], v52 offset:2560
    ds_read_b64_tr_b16 v[224:225], v55 offset:0
    v_mfma_f32_16x16x32_bf16 v[156:159], v[188:191], v[124:127], v[156:159]
    ds_read_b64_tr_b16 v[226:227], v53 offset:2560
    s_cmp_eq_u32 s63, 0
    v_mfma_f32_16x16x32_bf16 v[172:175], v[188:191], v[128:131], v[172:175]
    s_cbranch_scc1 K_SP14
K_SPR14:
    s_ff1_i32_b32 s33, s63
    v_mfma_f32_16x16x32_bf16 v[160:163], v[192:195], v[124:127], v[160:163]
    s_bitset0_b32 s63, s33
    s_lshl_b32 s77, s33, 10
    v_mfma_f32_16x16x32_bf16 v[176:179], v[192:195], v[128:131], v[176:179]
    buffer_load_dwordx4 v[116:119], v25, s[20:23], s77 offen offset:0 sc1
    buffer_load_dwordx4 v[120:123], v26, s[20:23], s77 offen offset:0 sc1
    s_waitcnt vmcnt(8) lgkmcnt(8)
    v_mfma_f32_16x16x32_bf16 v[148:151], v[196:199], v[132:135], v[148:151]
    v_mad_u32_u24 v52, s75, 5, v24
    v_xor_b32 v54, 64, v52
    v_xor_b32 v53, 32, v52
    v_mfma_f32_16x16x32_bf16 v[164:167], v[196:199], v[136:139], v[164:167]
    v_xor_b32 v55, 96, v52
    ds_read_b64_tr_b16 v[180:181], v52 offset:0
    ds_read_b64_tr_b16 v[182:183], v54 offset:2560
    v_mfma_f32_16x16x32_bf16 v[152:155], v[200:203], v[132:135], v[152:155]
    ds_read_b64_tr_b16 v[184:185], v53 offset:0
    ds_read_b64_tr_b16 v[186:187], v55 offset:2560
    ds_read_b64_tr_b16 v[188:189], v54 offset:0
    v_mfma_f32_16x16x32_bf16 v[168:171], v[200:203], v[136:139], v[168:171]
    ds_read_b64_tr_b16 v[190:191], v52 offset:2560
    ds_read_b64_tr_b16 v[192:193], v55 offset:0
    v_mfma_f32_16x16x32_bf16 v[156:159], v[204:207], v[132:135], v[156:159]
    ds_read_b64_tr_b16 v[194:195], v53 offset:2560
    s_cmp_eq_u32 s63, 0
    v_mfma_f32_16x16x32_bf16 v[172:175], v[204:207], v[136:139], v[172:175]
    s_cbranch_scc1 K_SP15
K_SPR15:
    s_ff1_i32_b32 s33, s63
    v_mfma_f32_16x16x32_bf16 v[160:163], v[208:211], v[132:135], v[160:163]
    s_bitset0_b32 s63, s33
    s_lshl_b32 s78, s33, 10
    v_mfma_f32_16x16x32_bf16 v[176:179], v[208:211], v[136:139], v[176:179]
    buffer_load_dwordx4 v[124:127], v25, s[20:23], s78 offen offset:0 sc1
    buffer_load_dwordx4 v[128:131], v26, s[20:23], s78 offen offset:0 sc1
    s_waitcnt vmcnt(8) lgkmcnt(8)
    v_mfma_f32_16x16x32_bf16 v[148:151], v[212:215], v[140:143], v[148:151]
    v_mad_u32_u24 v52, s76, 5, v24
    v_xor_b32 v54, 64, v52
    v_xor_b32 v53, 32, v52
    v_mfma_f32_16x16x32_bf16 v[164:167], v[212:215], v[144:147], v[164:167]
    v_xor_b32 v55, 96, v52
    ds_read_b64_tr_b16 v[196:197], v52 offset:0
    ds_read_b64_tr_b16 v[198:199], v54 offset:2560
    v_mfma_f32_16x16x32_bf16 v[152:155], v[216:219], v[140:143], v[152:155]
    ds_read_b64_tr_b16 v[200:201], v53 offset:0
    ds_read_b64_tr_b16 v[202:203], v55 offset:2560
    ds_read_b64_tr_b16 v[204:205], v54 offset:0
    v_mfma_f32_16x16x32_bf16 v[168:171], v[216:219], v[144:147], v[168:171]
    ds_read_b64_tr_b16 v[206:207], v52 offset:2560
    ds_read_b64_tr_b16 v[208:209], v55 offset:0
    v_mfma_f32_16x16x32_bf16 v[156:159], v[220:223], v[140:143], v[156:159]
    ds_read_b64_tr_b16 v[210:211], v53 offset:2560
    s_cmp_eq_u32 s63, 0
    v_mfma_f32_16x16x32_bf16 v[172:175], v[220:223], v[144:147], v[172:175]
    s_cbranch_scc1 K_SP16
K_SPR16:
    s_ff1_i32_b32 s33, s63
    v_mfma_f32_16x16x32_bf16 v[160:163], v[224:227], v[140:143], v[160:163]
    s_bitset0_b32 s63, s33
    s_lshl_b32 s75, s33, 10
    v_mfma_f32_16x16x32_bf16 v[176:179], v[224:227], v[144:147], v[176:179]
    buffer_load_dwordx4 v[132:135], v25, s[20:23], s75 offen offset:0 sc1
    buffer_load_dwordx4 v[136:139], v26, s[20:23], s75 offen offset:0 sc1
    s_waitcnt vmcnt(8) lgkmcnt(8)
    v_mfma_f32_16x16x32_bf16 v[148:151], v[180:183], v[100:103], v[148:151]
    v_mad_u32_u24 v52, s77, 5, v24
    v_xor_b32 v54, 64, v52
    v_xor_b32 v53, 32, v52
    v_mfma_f32_16x16x32_bf16 v[164:167], v[180:183], v[104:107], v[164:167]
    v_xor_b32 v55, 96, v52
    ds_read_b64_tr_b16 v[212:213], v52 offset:0
    ds_read_b64_tr_b16 v[214:215], v54 offset:2560
    v_mfma_f32_16x16x32_bf16 v[152:155], v[184:187], v[100:103], v[152:155]
    ds_read_b64_tr_b16 v[216:217], v53 offset:0
    ds_read_b64_tr_b16 v[218:219], v55 offset:2560
    ds_read_b64_tr_b16 v[220:221], v54 offset:0
    v_mfma_f32_16x16x32_bf16 v[168:171], v[184:187], v[104:107], v[168:171]
    ds_read_b64_tr_b16 v[222:223], v52 offset:2560
    ds_read_b64_tr_b16 v[224:225], v55 offset:0
    v_mfma_f32_16x16x32_bf16 v[156:159], v[188:191], v[100:103], v[156:159]
    ds_read_b64_tr_b16 v[226:227], v53 offset:2560
    s_cmp_eq_u32 s63, 0
    v_mfma_f32_16x16x32_bf16 v[172:175], v[188:191], v[104:107], v[172:175]
    s_cbranch_scc1 K_SP17
K_SPR17:
    s_ff1_i32_b32 s33, s63
    v_mfma_f32_16x16x32_bf16 v[160:163], v[192:195], v[100:103], v[160:163]
    s_bitset0_b32 s63, s33
    s_lshl_b32 s76, s33, 10
    v_mfma_f32_16x16x32_bf16 v[176:179], v[192:195], v[104:107], v[176:179]
    buffer_load_dwordx4 v[140:143], v25, s[20:23], s76 offen offset:0 sc1
    buffer_load_dwordx4 v[144:147], v26, s[20:23], s76 offen offset:0 sc1
    s_waitcnt vmcnt(8) lgkmcnt(8)
    v_mfma_f32_16x16x32_bf16 v[148:151], v[196:199], v[108:111], v[148:151]
    v_mad_u32_u24 v52, s78, 5, v24
    v_xor_b32 v54, 64, v52
    v_mfma_f32_16x16x32_bf16 v[164:167], v[196:199], v[112:115], v[164:167]
    v_xor_b32 v53, 32, v52
    v_xor_b32 v55, 96, v52
    v_mfma_f32_16x16x32_bf16 v[152:155], v[200:203], v[108:111], v[152:155]
    ds_read_b64_tr_b16 v[180:181], v52 offset:0
    ds_read_b64_tr_b16 v[182:183], v54 offset:2560
    v_mfma_f32_16x16x32_bf16 v[168:171], v[200:203], v[112:115], v[168:171]
    ds_read_b64_tr_b16 v[184:185], v53 offset:0
    ds_read_b64_tr_b16 v[186:187], v55 offset:2560
    v_mfma_f32_16x16x32_bf16 v[156:159], v[204:207], v[108:111], v[156:159]
    ds_read_b64_tr_b16 v[188:189], v54 offset:0
    ds_read_b64_tr_b16 v[190:191], v52 offset:2560
    v_mfma_f32_16x16x32_bf16 v[172:175], v[204:207], v[112:115], v[172:175]
    ds_read_b64_tr_b16 v[192:193], v55 offset:0
    ds_read_b64_tr_b16 v[194:195], v53 offset:2560
    v_mfma_f32_16x16x32_bf16 v[160:163], v[208:211], v[108:111], v[160:163]
    buffer_load_dwordx4 v[100:103], v25, s[20:23], s67 offen offset:2048 sc1
    buffer_load_dwordx4 v[104:107], v26, s[20:23], s67 offen offset:2048 sc1
    v_mfma_f32_16x16x32_bf16 v[176:179], v[208:211], v[112:115], v[176:179]
    s_waitcnt vmcnt(8) lgkmcnt(8)
    v_mfma_f32_16x16x32_bf16 v[148:151], v[212:215], v[116:119], v[148:151]
    v_mad_u32_u24 v52, s75, 5, v24
    v_xor_b32 v54, 64, v52
    v_mfma_f32_16x16x32_bf16 v[164:167], v[212:215], v[120:123], v[164:167]
    v_xor_b32 v53, 32, v52
    v_xor_b32 v55, 96, v52
    v_mfma_f32_16x16x32_bf16 v[152:155], v[216:219], v[116:119], v[152:155]
    ds_read_b64_tr_b16 v[196:197], v52 offset:0
    ds_read_b64_tr_b16 v[198:199], v54 offset:2560
    v_mfma_f32_16x16x32_bf16 v[168:171], v[216:219], v[120:123], v[168:171]
    ds_read_b64_tr_b16 v[200:201], v53 offset:0
    ds_read_b64_tr_b16 v[202:203], v55 offset:2560
    v_mfma_f32_16x16x32_bf16 v[156:159], v[220:223], v[116:119], v[156:159]
    ds_read_b64_tr_b16 v[204:205], v54 offset:0
    ds_read_b64_tr_b16 v[206:207], v52 offset:2560
    v_mfma_f32_16x16x32_bf16 v[172:175], v[220:223], v[120:123], v[172:175]
    ds_read_b64_tr_b16 v[208:209], v55 offset:0
    ds_read_b64_tr_b16 v[210:211], v53 offset:2560
    v_mfma_f32_16x16x32_bf16 v[160:163], v[224:227], v[116:119], v[160:163]
    buffer_load_dwordx4 v[108:111], v25, s[20:23], s67 offen offset:3072 sc1
    buffer_load_dwordx4 v[112:115], v26, s[20:23], s67 offen offset:3072 sc1
    v_mfma_f32_16x16x32_bf16 v[176:179], v[224:227], v[120:123], v[176:179]
    s_waitcnt vmcnt(8) lgkmcnt(8)
    v_mfma_f32_16x16x32_bf16 v[148:151], v[180:183], v[124:127], v[148:151]
    v_mad_u32_u24 v52, s76, 5, v24
    v_xor_b32 v54, 64, v52
    v_mfma_f32_16x16x32_bf16 v[164:167], v[180:183], v[128:131], v[164:167]
    v_xor_b32 v53, 32, v52
    v_xor_b32 v55, 96, v52
    v_mfma_f32_16x16x32_bf16 v[152:155], v[184:187], v[124:127], v[152:155]
    ds_read_b64_tr_b16 v[212:213], v52 offset:0
    ds_read_b64_tr_b16 v[214:215], v54 offset:2560
    v_mfma_f32_16x16x32_bf16 v[168:171], v[184:187], v[128:131], v[168:171]
    ds_read_b64_tr_b16 v[216:217], v53 offset:0
    ds_read_b64_tr_b16 v[218:219], v55 offset:2560
    v_mfma_f32_16x16x32_bf16 v[156:159], v[188:191], v[124:127], v[156:159]
    ds_read_b64_tr_b16 v[220:221], v54 offset:0
    ds_read_b64_tr_b16 v[222:223], v52 offset:2560
    v_mfma_f32_16x16x32_bf16 v[172:175], v[188:191], v[128:131], v[172:175]
    ds_read_b64_tr_b16 v[224:225], v55 offset:0
    ds_read_b64_tr_b16 v[226:227], v53 offset:2560
    v_mfma_f32_16x16x32_bf16 v[160:163], v[192:195], v[124:127], v[160:163]
    v_sub_f32 v64, 1.0, v60
    v_cvt_pk_bf16_f32 v64, v64, v64
    v_mfma_f32_16x16x32_bf16 v[176:179], v[192:195], v[128:131], v[176:179]
    v_lshlrev_b32 v64, 16, v64
    v_sub_f32 v66, 1.0, v62
    s_waitcnt vmcnt(6) lgkmcnt(8)
    v_mfma_f32_16x16x32_bf16 v[148:151], v[196:199], v[132:135], v[148:151]
    ds_read_b64_tr_b16 v[180:181], v56 offset:40960
    ds_read_b64_tr_b16 v[182:183], v58 offset:43520
    v_mfma_f32_16x16x32_bf16 v[164:167], v[196:199], v[136:139], v[164:167]
    ds_read_b64_tr_b16 v[184:185], v57 offset:40960
    ds_read_b64_tr_b16 v[186:187], v59 offset:43520
    v_mfma_f32_16x16x32_bf16 v[152:155], v[200:203], v[132:135], v[152:155]
    ds_read_b64_tr_b16 v[188:189], v58 offset:40960
    ds_read_b64_tr_b16 v[190:191], v56 offset:43520
    v_mfma_f32_16x16x32_bf16 v[168:171], v[200:203], v[136:139], v[168:171]
    ds_read_b64_tr_b16 v[192:193], v59 offset:40960
    ds_read_b64_tr_b16 v[194:195], v57 offset:43520
    v_mfma_f32_16x16x32_bf16 v[156:159], v[204:207], v[132:135], v[156:159]
    v_cvt_pk_bf16_f32 v66, v66, v66
    v_lshlrev_b32 v66, 16, v66
    v_mfma_f32_16x16x32_bf16 v[172:175], v[204:207], v[136:139], v[172:175]
    v_pk_mul_f32 v[68:69], v[68:69], v[64:65] op_sel_hi:[1,0]
    v_pk_mul_f32 v[70:71], v[70:71], v[64:65] op_sel_hi:[1,0]
    v_mfma_f32_16x16x32_bf16 v[160:163], v[208:211], v[132:135], v[160:163]
    v_pk_mul_f32 v[72:73], v[72:73], v[64:65] op_sel_hi:[1,0]
    v_pk_mul_f32 v[74:75], v[74:75], v[64:65] op_sel_hi:[1,0]
    v_mfma_f32_16x16x32_bf16 v[176:179], v[208:211], v[136:139], v[176:179]
    v_pk_mul_f32 v[76:77], v[76:77], v[64:65] op_sel_hi:[1,0]
    v_pk_mul_f32 v[78:79], v[78:79], v[64:65] op_sel_hi:[1,0]
    s_waitcnt vmcnt(4) lgkmcnt(8)
    v_mfma_f32_16x16x32_bf16 v[148:151], v[212:215], v[140:143], v[148:151]
    ds_read_b64_tr_b16 v[196:197], v56 offset:61440
    ds_read_b64_tr_b16 v[198:199], v58 offset:64000
    v_mfma_f32_16x16x32_bf16 v[164:167], v[212:215], v[144:147], v[164:167]
    ds_read_b64_tr_b16 v[200:201], v57 offset:61440
    ds_read_b64_tr_b16 v[202:203], v59 offset:64000
    v_mfma_f32_16x16x32_bf16 v[152:155], v[216:219], v[140:143], v[152:155]
    ds_read_b64_tr_b16 v[204:205], v58 offset:61440
    ds_read_b64_tr_b16 v[206:207], v56 offset:64000
    v_mfma_f32_16x16x32_bf16 v[168:171], v[216:219], v[144:147], v[168:171]
    ds_read_b64_tr_b16 v[208:209], v59 offset:61440
    ds_read_b64_tr_b16 v[210:211], v57 offset:64000
    v_mfma_f32_16x16x32_bf16 v[156:159], v[220:223], v[140:143], v[156:159]
    v_pk_mul_f32 v[80:81], v[80:81], v[64:65] op_sel_hi:[1,0]
    v_pk_mul_f32 v[82:83], v[82:83], v[64:65] op_sel_hi:[1,0]
    v_mfma_f32_16x16x32_bf16 v[172:175], v[220:223], v[144:147], v[172:175]
    v_pk_mul_f32 v[84:85], v[84:85], v[66:67] op_sel_hi:[1,0]
    v_pk_mul_f32 v[86:87], v[86:87], v[66:67] op_sel_hi:[1,0]
    v_mfma_f32_16x16x32_bf16 v[160:163], v[224:227], v[140:143], v[160:163]
    v_pk_mul_f32 v[88:89], v[88:89], v[66:67] op_sel_hi:[1,0]
    v_pk_mul_f32 v[90:91], v[90:91], v[66:67] op_sel_hi:[1,0]
    v_mfma_f32_16x16x32_bf16 v[176:179], v[224:227], v[144:147], v[176:179]
    v_pk_mul_f32 v[92:93], v[92:93], v[66:67] op_sel_hi:[1,0]
    v_pk_mul_f32 v[94:95], v[94:95], v[66:67] op_sel_hi:[1,0]
    s_waitcnt vmcnt(2) lgkmcnt(8)
    v_mfma_f32_16x16x32_bf16 v[148:151], v[180:183], v[100:103], v[148:151]
    v_pk_mul_f32 v[96:97], v[96:97], v[66:67] op_sel_hi:[1,0]
    v_pk_mul_f32 v[98:99], v[98:99], v[66:67] op_sel_hi:[1,0]
    v_mfma_f32_16x16x32_bf16 v[152:155], v[184:187], v[100:103], v[152:155]
    v_mfma_f32_16x16x32_bf16 v[156:159], v[188:191], v[100:103], v[156:159]
    v_mfma_f32_16x16x32_bf16 v[160:163], v[192:195], v[100:103], v[160:163]
    s_sub_u32 s59, s56, s58
    s_cmp_lt_u32 s59, 32
    s_cbranch_scc1 K_YROW0
K_NOY0:
    s_sub_u32 s59, s57, s58
    s_cmp_lt_u32 s59, 32
    s_cbranch_scc1 K_YROW1
K_NOY1:
    s_waitcnt vmcnt(0) lgkmcnt(0)
    v_mfma_f32_16x16x32_bf16 v[148:151], v[196:199], v[108:111], v[148:151]
    v_mfma_f32_16x16x32_bf16 v[152:155], v[200:203], v[108:111], v[152:155]
    v_mfma_f32_16x16x32_bf16 v[156:159], v[204:207], v[108:111], v[156:159]
    v_mfma_f32_16x16x32_bf16 v[160:163], v[208:211], v[108:111], v[160:163]
    v_mfma_f32_16x16x32_bf16 v[164:167], v[180:183], v[104:107], v[164:167]
    v_mfma_f32_16x16x32_bf16 v[168:171], v[184:187], v[104:107], v[168:171]
    v_mfma_f32_16x16x32_bf16 v[172:175], v[188:191], v[104:107], v[172:175]
    s_nop 1
    v_pk_fma_f32 v[148:149], v[148:149], v[60:61], v[68:69] op_sel_hi:[1,0,1]
    v_pk_fma_f32 v[150:151], v[150:151], v[60:61], v[70:71] op_sel_hi:[1,0,1]
    v_cvt_pk_bf16_f32 v36, v148, v149
    v_mfma_f32_16x16x32_bf16 v[176:179], v[192:195], v[104:107], v[176:179]
    v_cvt_pk_bf16_f32 v37, v150, v151
    ds_write_b64 v29, v[36:37] offset:0
    v_pk_fma_f32 v[152:153], v[152:153], v[60:61], v[72:73] op_sel_hi:[1,0,1]
    v_mfma_f32_16x16x32_bf16 v[164:167], v[196:199], v[112:115], v[164:167]
    v_pk_fma_f32 v[154:155], v[154:155], v[60:61], v[74:75] op_sel_hi:[1,0,1]
    v_cvt_pk_bf16_f32 v38, v152, v153
    v_cvt_pk_bf16_f32 v39, v154, v155
    v_mfma_f32_16x16x32_bf16 v[168:171], v[200:203], v[112:115], v[168:171]
    ds_write_b64 v30, v[38:39] offset:0
    v_pk_fma_f32 v[156:157], v[156:157], v[60:61], v[76:77] op_sel_hi:[1,0,1]
    v_pk_fma_f32 v[158:159], v[158:159], v[60:61], v[78:79] op_sel_hi:[1,0,1]
    v_mfma_f32_16x16x32_bf16 v[172:175], v[204:207], v[112:115], v[172:175]
    v_cvt_pk_bf16_f32 v40, v156, v157
    v_cvt_pk_bf16_f32 v41, v158, v159
    ds_write_b64 v31, v[40:41] offset:0
    v_mfma_f32_16x16x32_bf16 v[176:179], v[208:211], v[112:115], v[176:179]
    v_pk_fma_f32 v[160:161], v[160:161], v[60:61], v[80:81] op_sel_hi:[1,0,1]
    v_pk_fma_f32 v[162:163], v[162:163], v[60:61], v[82:83] op_sel_hi:[1,0,1]
    v_cvt_pk_bf16_f32 v42, v160, v161
    v_cvt_pk_bf16_f32 v43, v162, v163
    ds_write_b64 v32, v[42:43] offset:0
    ds_read_b128 v[68:71], v33 offset:0
    ds_read_b128 v[72:75], v33 offset:1024
    v_pk_fma_f32 v[164:165], v[164:165], v[62:63], v[84:85] op_sel_hi:[1,0,1]
    v_pk_fma_f32 v[166:167], v[166:167], v[62:63], v[86:87] op_sel_hi:[1,0,1]
    v_cvt_pk_bf16_f32 v44, v164, v165
    v_cvt_pk_bf16_f32 v45, v166, v167
    ds_write_b64 v29, v[44:45] offset:2048
    v_pk_fma_f32 v[168:169], v[168:169], v[62:63], v[88:89] op_sel_hi:[1,0,1]
    v_pk_fma_f32 v[170:171], v[170:171], v[62:63], v[90:91] op_sel_hi:[1,0,1]
    v_cvt_pk_bf16_f32 v46, v168, v169
    v_cvt_pk_bf16_f32 v47, v170, v171
    ds_write_b64 v30, v[46:47] offset:2048
    v_pk_fma_f32 v[172:173], v[172:173], v[62:63], v[92:93] op_sel_hi:[1,0,1]
    s_waitcnt lgkmcnt(2)
    buffer_store_dwordx4 v[68:71], v27, s[48:51], s71 offen sc1
    buffer_store_dwordx4 v[72:75], v28, s[48:51], s72 offen sc1
    v_pk_fma_f32 v[174:175], v[174:175], v[62:63], v[94:95] op_sel_hi:[1,0,1]
    v_cvt_pk_bf16_f32 v48, v172, v173
    v_cvt_pk_bf16_f32 v49, v174, v175
    ds_write_b64 v31, v[48:49] offset:2048
    v_pk_fma_f32 v[176:177], v[176:177], v[62:63], v[96:97] op_sel_hi:[1,0,1]
    v_pk_fma_f32 v[178:179], v[178:179], v[62:63], v[98:99] op_sel_hi:[1,0,1]
    v_cvt_pk_bf16_f32 v50, v176, v177
    v_cvt_pk_bf16_f32 v51, v178, v179
    ds_write_b64 v32, v[50:51] offset:2048
    ds_read_b128 v[84:87], v33 offset:2048
    ds_read_b128 v[88:91], v33 offset:3072
    s_waitcnt lgkmcnt(1)
    buffer_store_dwordx4 v[84:87], v27, s[48:51], s73 offen sc1
    s_waitcnt lgkmcnt(0)
    buffer_store_dwordx4 v[88:91], v28, s[48:51], s74 offen sc1
K_END:
K_EXIT:
    s_endpgm
.p2align 12
WP_spin:
    s_setpc_b64 s[38:39]
K_SP0:
    ds_read_b32 v2, v12 offset:32
    s_waitcnt lgkmcnt(0)
    v_readfirstlane_b32 s33, v2
    s_nop 3
    s_lshr_b32 s63, s33, s64
    s_lshr_b32 s33, s33, s65
    s_and_b32 s63, s63, s33
    s_and_b32 s63, s63, 0xff
    s_andn2_b32 s63, s63, s66
    s_cbranch_scc0 K_SP0
    s_or_b32 s66, s66, s63
    s_branch K_SPR0
K_SP1:
    ds_read_b32 v2, v12 offset:32
    s_waitcnt lgkmcnt(0)
    v_readfirstlane_b32 s33, v2
    s_nop 3
    s_lshr_b32 s63, s33, s64
    s_lshr_b32 s33, s33, s65
    s_and_b32 s63, s63, s33
    s_and_b32 s63, s63, 0xff
    s_andn2_b32 s63, s63, s66
    s_cbranch_scc0 K_SP1
    s_or_b32 s66, s66, s63
    s_branch K_SPR1
K_SP2:
    ds_read_b32 v2, v12 offset:32
    s_waitcnt lgkmcnt(0)
    v_readfirstlane_b32 s33, v2
    s_nop 3
    s_lshr_b32 s63, s33, s64
    s_lshr_b32 s33, s33, s65
    s_and_b32 s63, s63, s33
    s_and_b32 s63, s63, 0xff
    s_andn2_b32 s63, s63, s66
    s_cbranch_scc0 K_SP2
    s_or_b32 s66, s66, s63
    s_branch K_SPR2
K_SP3:
    ds_read_b32 v2, v12 offset:32
    s_waitcnt lgkmcnt(0)
    v_readfirstlane_b32 s33, v2
    s_nop 3
    s_lshr_b32 s63, s33, s64
    s_lshr_b32 s33, s33, s65
    s_and_b32 s63, s63, s33
    s_and_b32 s63, s63, 0xff
    s_andn2_b32 s63, s63, s66
    s_cbranch_scc0 K_SP3
    s_or_b32 s66, s66, s63
    s_branch K_SPR3
K_SP4:
    ds_read_b32 v2, v12 offset:32
    s_waitcnt lgkmcnt(0)
    v_readfirstlane_b32 s33, v2
    s_nop 3
    s_lshr_b32 s63, s33, s64
    s_lshr_b32 s33, s33, s65
    s_and_b32 s63, s63, s33
    s_and_b32 s63, s63, 0xff
    s_andn2_b32 s63, s63, s66
    s_cbranch_scc0 K_SP4
    s_or_b32 s66, s66, s63
    s_branch K_SPR4
K_SP5:
    ds_read_b32 v2, v12 offset:32
    s_waitcnt lgkmcnt(0)
    v_readfirstlane_b32 s33, v2
    s_nop 3
    s_lshr_b32 s63, s33, s64
    s_lshr_b32 s33, s33, s65
    s_and_b32 s63, s63, s33
    s_and_b32 s63, s63, 0xff
    s_andn2_b32 s63, s63, s66
    s_cbranch_scc0 K_SP5
    s_or_b32 s66, s66, s63
    s_branch K_SPR5
K_SP6:
    ds_read_b32 v2, v12 offset:32
    s_waitcnt lgkmcnt(0)
    v_readfirstlane_b32 s33, v2
    s_nop 3
    s_lshr_b32 s63, s33, s64
    s_lshr_b32 s33, s33, s65
    s_and_b32 s63, s63, s33
    s_and_b32 s63, s63, 0xff
    s_andn2_b32 s63, s63, s66
    s_cbranch_scc0 K_SP6
    s_or_b32 s66, s66, s63
    s_branch K_SPR6
K_SP7:
    ds_read_b32 v2, v12 offset:32
    s_waitcnt lgkmcnt(0)
    v_readfirstlane_b32 s33, v2
    s_nop 3
    s_lshr_b32 s63, s33, s64
    s_lshr_b32 s33, s33, s65
    s_and_b32 s63, s63, s33
    s_and_b32 s63, s63, 0xff
    s_andn2_b32 s63, s63, s66
    s_cbranch_scc0 K_SP7
    s_or_b32 s66, s66, s63
    s_branch K_SPR7
K_SP10:
    ds_read_b32 v2, v12 offset:32
    s_waitcnt lgkmcnt(0)
    v_readfirstlane_b32 s33, v2
    s_nop 3
    s_lshr_b32 s63, s33, s64
    s_lshr_b32 s33, s33, s65
    s_and_b32 s63, s63, s33
    s_and_b32 s63, s63, 0xff00
    s_andn2_b32 s63, s63, s66
    s_cbranch_scc0 K_SP10
    s_or_b32 s66, s66, s63
    s_branch K_SPR10
K_SP11:
    ds_read_b32 v2, v12 offset:32
    s_waitcnt lgkmcnt(0)
    v_readfirstlane_b32 s33, v2
    s_nop 3
    s_lshr_b32 s63, s33, s64
    s_lshr_b32 s33, s33, s65
    s_and_b32 s63, s63, s33
    s_and_b32 s63, s63, 0xff00
    s_andn2_b32 s63, s63, s66
    s_cbranch_scc0 K_SP11
    s_or_b32 s66, s66, s63
    s_branch K_SPR11
K_SP12:
    ds_read_b32 v2, v12 offset:32
    s_waitcnt lgkmcnt(0)
    v_readfirstlane_b32 s33, v2
    s_nop 3
    s_lshr_b32 s63, s33, s64
    s_lshr_b32 s33, s33, s65
    s_and_b32 s63, s63, s33
    s_and_b32 s63, s63, 0xff00
    s_andn2_b32 s63, s63, s66
    s_cbranch_scc0 K_SP12
    s_or_b32 s66, s66, s63
    s_branch K_SPR12
K_SP13:
    ds_read_b32 v2, v12 offset:32
    s_waitcnt lgkmcnt(0)
    v_readfirstlane_b32 s33, v2
    s_nop 3
    s_lshr_b32 s63, s33, s64
    s_lshr_b32 s33, s33, s65
    s_and_b32 s63, s63, s33
    s_and_b32 s63, s63, 0xff00
    s_andn2_b32 s63, s63, s66
    s_cbranch_scc0 K_SP13
    s_or_b32 s66, s66, s63
    s_branch K_SPR13
K_SP14:
    ds_read_b32 v2, v12 offset:32
    s_waitcnt lgkmcnt(0)
    v_readfirstlane_b32 s33, v2
    s_nop 3
    s_lshr_b32 s63, s33, s64
    s_lshr_b32 s33, s33, s65
    s_and_b32 s63, s63, s33
    s_and_b32 s63, s63, 0xff00
    s_andn2_b32 s63, s63, s66
    s_cbranch_scc0 K_SP14
    s_or_b32 s66, s66, s63
    s_branch K_SPR14
K_SP15:
    ds_read_b32 v2, v12 offset:32
    s_waitcnt lgkmcnt(0)
    v_readfirstlane_b32 s33, v2
    s_nop 3
    s_lshr_b32 s63, s33, s64
    s_lshr_b32 s33, s33, s65
    s_and_b32 s63, s63, s33
    s_and_b32 s63, s63, 0xff00
    s_andn2_b32 s63, s63, s66
    s_cbranch_scc0 K_SP15
    s_or_b32 s66, s66, s63
    s_branch K_SPR15
K_SP16:
    ds_read_b32 v2, v12 offset:32
    s_waitcnt lgkmcnt(0)
    v_readfirstlane_b32 s33, v2
    s_nop 3
    s_lshr_b32 s63, s33, s64
    s_lshr_b32 s33, s33, s65
    s_and_b32 s63, s63, s33
    s_and_b32 s63, s63, 0xff00
    s_andn2_b32 s63, s63, s66
    s_cbranch_scc0 K_SP16
    s_or_b32 s66, s66, s63
    s_branch K_SPR16
K_SP17:
    ds_read_b32 v2, v12 offset:32
    s_waitcnt lgkmcnt(0)
    v_readfirstlane_b32 s33, v2
    s_nop 3
    s_lshr_b32 s63, s33, s64
    s_lshr_b32 s33, s33, s65
    s_and_b32 s63, s63, s33
    s_and_b32 s63, s63, 0xff00
    s_andn2_b32 s63, s63, s66
    s_cbranch_scc0 K_SP17
    s_or_b32 s66, s66, s63
    s_branch K_SPR17
WP_yr0:
    s_setpc_b64 s[38:39]
K_YROW0:
    v_lshlrev_b32 v5, 4, v9
    v_add_u32 v5, 158976, v5
    v_and_b32 v3, 15, v1
    s_and_b32 s33, s59, 15
    v_cmp_eq_u32 vcc, s33, v3
    s_mov_b32 s3, 1048576
K_P2_GY0:
    ds_read_b32 v2, v12 offset:64
    s_sub_u32 s3, s3, 1
    s_waitcnt lgkmcnt(0)
    v_readfirstlane_b32 s33, v2
    s_nop 3
    s_cselect_b32 s33, 1, s33
    s_cmp_lt_u32 s33, 1
    s_cbranch_scc1 K_P2_GY0
    s_mov_b64 exec, vcc
    s_cmp_ge_u32 s59, 16
    s_cbranch_scc1 K_YR1_0
    ds_read_b128 v[68:71], v5 offset:0
    ds_read_b128 v[72:75], v5 offset:64
    ds_read_b128 v[76:79], v5 offset:128
    ds_read_b128 v[80:83], v5 offset:192
    s_mov_b64 exec, -1
    s_branch K_NOY0
K_YR1_0:
    ds_read_b128 v[84:87], v5 offset:0
    ds_read_b128 v[88:91], v5 offset:64
    ds_read_b128 v[92:95], v5 offset:128
    ds_read_b128 v[96:99], v5 offset:192
    s_mov_b64 exec, -1
    s_branch K_NOY0
K_YROW1:
    v_lshlrev_b32 v5, 4, v9
    v_add_u32 v5, 159232, v5
    v_and_b32 v3, 15, v1
    s_and_b32 s33, s59, 15
    v_cmp_eq_u32 vcc, s33, v3
    s_mov_b32 s3, 1048576
K_P2_GY1:
    ds_read_b32 v2, v12 offset:68
    s_sub_u32 s3, s3, 1
    s_waitcnt lgkmcnt(0)
    v_readfirstlane_b32 s33, v2
    s_nop 3
    s_cselect_b32 s33, 1, s33
    s_cmp_lt_u32 s33, 1
    s_cbranch_scc1 K_P2_GY1
    s_mov_b64 exec, vcc
    s_cmp_ge_u32 s59, 16
    s_cbranch_scc1 K_YR1_1
    ds_read_b128 v[68:71], v5 offset:0
    ds_read_b128 v[72:75], v5 offset:64
    ds_read_b128 v[76:79], v5 offset:128
    ds_read_b128 v[80:83], v5 offset:192
    s_mov_b64 exec, -1
    s_branch K_NOY1
K_YR1_1:
    ds_read_b128 v[84:87], v5 offset:0
    ds_read_b128 v[88:91], v5 offset:64
    ds_read_b128 v[92:95], v5 offset:128
    ds_read_b128 v[96:99], v5 offset:192
    s_mov_b64 exec, -1
    s_branch K_NOY1
.p2align 12
WP_gen:
    s_setpc_b64 s[38:39]
K_P2:
    s_cmp_ge_u32 s30, 4
    s_cbranch_scc1 K_P2_HELP
    s_lshl_b32 s54, s40, 7
    v_lshrrev_b32 v9, 4, v1
    v_mov_b32 v12, 158720
    s_add_u32 s20, s10, 0x100000
    s_addc_u32 s21, s11, 0
    s_mov_b32 s22, 0x280000
    s_mov_b32 s23, 0x20000
    s_add_u32 s16, s10, 0x1000
    s_addc_u32 s17, s11, 0
    s_mov_b32 s18, 0x2000
    s_mov_b32 s19, 0x20000
    s_mov_b32 s48, s6
    s_mov_b32 s49, s7
    s_mov_b32 s50, 0x280000
    s_mov_b32 s51, 0x20000
    s_lshl_b32 s53, s40, 3
    s_lshl1_add_u32 s53, s30, s53
    s_mov_b32 s55, 20480
    v_bfe_u32 v20, v1, 2, 2
    v_and_b32 v21, 3, v1
    s_mul_i32 s3, s53, 20480
    v_lshl_add_u32 v25, v1, 4, s3
    v_add_u32 v26, 20480, v25
    v_and_b32 v2, 15, v1
    s_lshl_b32 s3, s53, 6
    v_lshl_add_u32 v23, v2, 2, s3
    v_lshl_add_u32 v2, v9, 2, v20
    v_bfe_u32 v3, v2, 1, 2
    v_lshlrev_b32 v2, 7, v2
    v_lshl_add_u32 v2, v21, 3, v2
    v_lshl_add_u32 v24, v3, 5, v2
    v_lshrrev_b32 v3, 1, v20
    v_mul_u32_u24 v2, 40, v9
    v_add3_u32 v2, v2, 16, v20
    v_lshlrev_b32 v2, 7, v2
    v_lshl_add_u32 v2, v21, 3, v2
    v_xor_b32 v4, 0, v3
    v_lshl_add_u32 v56, v4, 5, v2
    v_xor_b32 v4, 1, v3
    v_lshl_add_u32 v57, v4, 5, v2
    v_xor_b32 v4, 2, v3
    v_lshl_add_u32 v58, v4, 5, v2
    v_xor_b32 v4, 3, v3
    v_lshl_add_u32 v59, v4, 5, v2
    v_lshrrev_b32 v3, 4, v1
    v_and_b32 v4, 7, v1
    v_lshrrev_b32 v2, 3, v1
    v_xor_b32 v4, v4, v3
    v_mul_u32_u24 v2, 1280, v2
    v_lshl_add_u32 v27, v4, 4, v2
    v_xor_b32 v28, 64, v27
    s_lshl_b32 s71, s40, 3
    s_lshl1_add_u32 s71, s30, s71
    s_mul_i32 s71, s71, 20480
    s_lshl_b32 s33, s41, 7
    s_add_u32 s71, s71, s33
    s_add_u32 s72, s71, 10240
    s_add_u32 s73, s71, 20480
    s_add_u32 s74, s71, 30720
    s_lshl_b32 s3, s30, 12
    s_add_u32 s3, s3, 140288
    v_lshl_add_u32 v33, v1, 4, s3
    v_and_b32 v2, 15, v1
    v_lshrrev_b32 v3, 1, v2
    v_lshrrev_b32 v4, 5, v1
    v_xor_b32 v3, v3, v4
    v_lshlrev_b32 v3, 4, v3
    v_lshl_add_u32 v3, v2, 7, v3
    v_and_b32 v4, 1, v9
    v_lshl_add_u32 v3, v4, 3, v3
    v_add_u32 v29, s3, v3
    v_xor_b32 v30, 32, v29
    v_xor_b32 v31, 64, v29
    v_xor_b32 v32, 96, v29
    s_lshl_b32 s3, s40, 3
    s_mul_i32 s33, s3, 187
    s_lshr_b32 s33, s33, 11
    s_add_u32 s33, s33, 1
    s_mul_i32 s33, s33, 11
    s_cmp_ge_u32 s53, s33
    s_cselect_b32 s64, 16, 0
    s_add_u32 s3, s53, 1
    s_cmp_ge_u32 s3, s33
    s_cselect_b32 s65, 16, 0
    s_mov_b32 s63, 0
    s_mov_b32 s66, 0
    s_mov_b32 s67, 16384
    s_cmp_eq_u32 s30, 0
    s_cbranch_scc1 K_P2_AUXW
    v_lshrrev_b32 v2, 3, v1
    v_mul_u32_u24 v2, 1280, v2
    v_lshrrev_b32 v3, 4, v1
    v_lshlrev_b32 v3, 1, v3
    v_and_b32 v4, 7, v1
    v_xor_b32 v3, v3, v4
    v_lshl_add_u32 v2, v3, 4, v2
    s_lshl_b32 s33, s41, 7
    v_add_u32 v22, s33, v2
    s_mov_b32 s60, 0xfda87520
    s_mov_b32 s61, 0xecb96431
    s_sub_u32 s58, s30, 1
K_P2_WS:
    s_lshl_b32 s3, s58, 2
    s_lshr_b64 s[4:5], s[60:61], s3
    s_and_b32 s4, s4, 15
    s_mul_i32 s4, s4, 51200
    s_mul_i32 s59, s58, 5120
    s_add_u32 s52, s4, 0
    s_add_u32 m0, s59, 0
    s_waitcnt vmcnt(11)
    buffer_load_dwordx4 v22, s[24:27], s52 offen lds
    s_add_u32 s52, s4, 10240
    s_add_u32 m0, s59, 1024
    s_waitcnt vmcnt(11)
    buffer_load_dwordx4 v22, s[24:27], s52 offen lds
    s_add_u32 s52, s4, 20480
    s_add_u32 m0, s59, 2048
    s_waitcnt vmcnt(11)
    buffer_load_dwordx4 v22, s[24:27], s52 offen lds
    s_add_u32 s52, s4, 30720
    s_add_u32 m0, s59, 3072
    s_waitcnt vmcnt(11)
    buffer_load_dwordx4 v22, s[24:27], s52 offen lds
    s_add_u32 s52, s4, 40960
    s_add_u32 m0, s59, 4096
    s_waitcnt vmcnt(11)
    buffer_load_dwordx4 v22, s[24:27], s52 offen lds
    s_cmp_ge_u32 s58, 3
    s_cbranch_scc1 K_P2_WS1
    v_mov_b32 v3, 1
    s_waitcnt vmcnt(5)
    s_mov_b64 exec, 1
    ds_add_u32 v12, v3 offset:52
    s_mov_b64 exec, -1
K_P2_WS1:
    s_add_u32 s58, s58, 3
    s_cmp_lt_u32 s58, 16
    s_cbranch_scc1 K_P2_WS
K_P2_AUXW:
    s_lshl_b32 s33, s30, 12
    s_add_u32 m0, s33, 140288
    s_add_u32 s3, s71, 0
    buffer_load_dwordx4 v27, s[12:15], s3 offen lds
    s_add_u32 m0, s33, 141312
    s_add_u32 s3, s71, 10240
    buffer_load_dwordx4 v28, s[12:15], s3 offen lds
    s_add_u32 m0, s33, 142336
    s_add_u32 s3, s71, 20480
    buffer_load_dwordx4 v27, s[12:15], s3 offen lds
    s_add_u32 m0, s33, 143360
    s_add_u32 s3, s71, 30720
    buffer_load_dwordx4 v28, s[12:15], s3 offen lds
    v_mov_b32 v3, 1
    s_waitcnt vmcnt(0)
    s_mov_b64 exec, 1
    ds_add_u32 v12, v3 offset:44
    s_mov_b64 exec, -1
    s_mov_b32 s3, 1048576
K_P2_GWA:
    ds_read_b32 v2, v12 offset:44
    s_sub_u32 s3, s3, 1
    s_waitcnt lgkmcnt(0)
    v_readfirstlane_b32 s33, v2
    s_nop 3
    s_cselect_b32 s33, 4, s33
    s_cmp_lt_u32 s33, 4
    s_cbranch_scc1 K_P2_GWA
    s_branch K_P2_GEMM
WP_help:
    s_setpc_b64 s[38:39]
K_P2_HELP:
    s_setprio 3
    s_lshl_b32 s53, s40, 3
    s_mul_i32 s58, s53, 187
    s_lshr_b32 s58, s58, 11
    s_add_u32 s3, s53, 7
    s_mul_i32 s59, s3, 187
    s_lshr_b32 s59, s59, 11
    s_sub_u32 s59, s59, s58
    s_lshl_b32 s59, s59, 4
    s_or_b32 s59, s59, 15
    v_and_b32 v10, s59, v1
    v_lshl_add_u32 v10, v10, 2, s42
    s_cmp_lg_u32 s30, 7
    s_cbranch_scc1 K_P2_N7
    v_and_b32 v4, 7, v1
    v_lshlrev_b32 v4, 2, v4
    s_mov_b32 s3, 131072
K_ZPOLL1:
    v_cmp_eq_u32 vcc, 0, v7
    s_cbranch_vccz K_ZOK1
    s_sub_u32 s3, s3, 1
    s_cbranch_scc1 K_ZOK1
    global_load_dword v7, v4, s[8:9] offset:192 sc1
    s_waitcnt vmcnt(0)
    s_branch K_ZPOLL1
K_ZOK1:
    global_load_dword v7, v10, s[10:11] sc1
K_P2_N7:
    s_lshl_b32 s54, s40, 7
    v_lshrrev_b32 v9, 4, v1
    v_mov_b32 v12, 158720
    s_add_u32 s44, s10, 0x10000
    s_addc_u32 s45, s11, 0
    s_mov_b32 s46, 0x43800
    s_mov_b32 s47, 0x20000
    v_mov_b32 v80, 1
    s_cmp_eq_u32 s30, 7
    s_cbranch_scc1 K_P2_FLAGS
    s_cmp_lg_u32 s30, 6
    s_cbranch_scc1 K_P2_HW
    s_mov_b32 s3, 131072
K_P2_DPOLL:
    v_cmp_eq_u32 vcc, 0, v7
    s_cbranch_vccz K_P2_DOK
    s_cmp_eq_u32 s3, 131072
    s_cbranch_scc1 K_P2_DNS
    s_sleep 12
K_P2_DNS:
    v_and_b32 v11, 1, v1
    v_lshl_add_u32 v11, v11, 2, s42
    global_load_dword v7, v11, s[10:11] offset:128 sc1
    s_sub_u32 s3, s3, 1
    s_waitcnt vmcnt(0)
    s_cmp_lg_u32 s3, 0
    s_cbranch_scc1 K_P2_DPOLL
K_P2_DOK:
    v_readlane_b32 s58, v7, 0
    v_readlane_b32 s59, v7, 1
    s_nop 3
    s_and_b32 s3, s58, 0x7ff
    s_sub_u32 s3, 2047, s3
    v_mov_b32 v20, s3
    v_mov_b32 v4, s58
    v_and_b32 v4, 0xffff0000, v4
    v_ashrrev_i32 v5, 31, v4
    v_not_b32 v5, v5
    v_or_b32 v5, 0x80000000, v5
    v_xor_b32 v4, v4, v5
    v_and_b32 v4, 0xffff0000, v4
    v_mul_f32 v5, 0xbfb8aa3b, v4
    v_exp_f32 v5, v5
    s_nop 0
    v_add_f32 v5, 1.0, v5
    v_rcp_f32 v4, v5
    s_nop 0
    v_cvt_pk_bf16_f32 v22, v4, v4
    v_lshlrev_b32 v22, 16, v22
    s_and_b32 s3, s59, 0x7ff
    s_sub_u32 s3, 2047, s3
    v_mov_b32 v21, s3
    v_mov_b32 v4, s59
    v_and_b32 v4, 0xffff0000, v4
    v_ashrrev_i32 v5, 31, v4
    v_not_b32 v5, v5
    v_or_b32 v5, 0x80000000, v5
    v_xor_b32 v4, v4, v5
    v_and_b32 v4, 0xffff0000, v4
    v_mul_f32 v5, 0xbfb8aa3b, v4
    v_exp_f32 v5, v5
    s_nop 0
    v_add_f32 v5, 1.0, v5
    v_rcp_f32 v4, v5
    s_nop 0
    v_cvt_pk_bf16_f32 v23, v4, v4
    v_lshlrev_b32 v23, 16, v23
    ds_write_b128 v12, v[20:23]
    ds_write_b32 v12, v80 offset:40
    s_branch K_END
K_P2_HW:
    s_mov_b32 s3, 1048576
K_P2_GS2:
    ds_read_b32 v2, v12 offset:40
    s_sleep 1
    s_sub_u32 s3, s3, 1
    s_waitcnt lgkmcnt(0)
    v_readfirstlane_b32 s33, v2
    s_nop 3
    s_cselect_b32 s33, 1, s33
    s_cmp_lt_u32 s33, 1
    s_cbranch_scc1 K_P2_GS2
    ds_read_b128 v[16:19], v12
    s_waitcnt lgkmcnt(0)
    s_cmp_eq_u32 s30, 4
    s_cselect_b64 vcc, -1, 0
    s_nop 1
    v_cndmask_b32 v2, v17, v16, vcc
    v_cndmask_b32 v5, v19, v18, vcc
    s_nop 0
    v_readfirstlane_b32 s58, v2
    s_nop 3
    s_sub_u32 s3, s58, s54
    s_cmp_lt_u32 s3, 128
    s_cbranch_scc0 K_END
    s_call_b64 s[38:39], WP_yr0
    s_mul_i32 s3, s58, 1280
    s_lshl_b32 s33, s41, 7
    s_add_u32 s3, s3, s33
    v_and_b32 v2, 15, v1
    v_lshlrev_b32 v2, 3, v2
    buffer_load_dwordx2 v[84:85], v2, s[12:15], s3 offen
    s_lshl_b32 s3, s58, 2
    s_add_u32 s3, s3, 4096
    v_mov_b32 v2, s3
    global_load_dword v88, v2, s[10:11] sc1
    v_min_u32 v3, 53, v1
    v_lshlrev_b32 v3, 5, v3
    v_add_u32 v3, 565248, v3
    s_mov_b32 s3, 1048576
K_P2_GY:
    ds_read_b32 v2, v12 offset:32
    s_sleep 1
    s_sub_u32 s3, s3, 1
    s_waitcnt lgkmcnt(0)
    v_readfirstlane_b32 s33, v2
    s_nop 3
    s_cselect_b32 s33, 255, s33
    s_and_b32 s33, s33, 255
    s_cmp_lt_u32 s33, 255
    s_cbranch_scc1 K_P2_GY
    s_mov_b32 s3, 131072
K_P2_YPOLL:
    global_load_dwordx4 v[20:23], v3, s[10:11] sc1
    s_sub_u32 s3, s3, 1
    s_waitcnt vmcnt(0)
    v_and_b32 v2, v20, v21
    v_and_b32 v2, v2, v22
    v_and_b32 v2, v2, v23
    v_cmp_ne_u32 vcc, 1, v2
    s_cbranch_vccz K_P2_YGO
    s_sleep 8
    s_cmp_lg_u32 s3, 0
    s_cbranch_scc1 K_P2_YPOLL
K_P2_YGO:
    v_and_b32 v2, 15, v1
    v_lshlrev_b32 v2, 4, v2
    v_mul_u32_u24 v4, 5120, v9
    s_sub_u32 s59, s30, 4
    s_mul_i32 s33, s59, 2560
    s_lshl_b32 s3, s41, 8
    s_add_u32 s3, s3, s33
    v_add3_u32 v3, v2, v4, s3
    s_mov_b32 s52, 0
    buffer_load_dwordx4 v[24:27], v3, s[44:47], s52 offen sc1
    s_mov_b32 s52, 20480
    buffer_load_dwordx4 v[28:31], v3, s[44:47], s52 offen sc1
    s_mov_b32 s52, 40960
    buffer_load_dwordx4 v[32:35], v3, s[44:47], s52 offen sc1
    s_mov_b32 s52, 61440
    buffer_load_dwordx4 v[36:39], v3, s[44:47], s52 offen sc1
    s_mov_b32 s52, 81920
    buffer_load_dwordx4 v[40:43], v3, s[44:47], s52 offen sc1
    s_mov_b32 s52, 102400
    buffer_load_dwordx4 v[44:47], v3, s[44:47], s52 offen sc1
    s_mov_b32 s52, 122880
    buffer_load_dwordx4 v[48:51], v3, s[44:47], s52 offen sc1
    s_mov_b32 s52, 143360
    buffer_load_dwordx4 v[52:55], v3, s[44:47], s52 offen sc1
    s_mov_b32 s52, 163840
    buffer_load_dwordx4 v[56:59], v3, s[44:47], s52 offen sc1
    s_mov_b32 s52, 184320
    buffer_load_dwordx4 v[60:63], v3, s[44:47], s52 offen sc1
    s_mov_b32 s52, 204800
    buffer_load_dwordx4 v[64:67], v3, s[44:47], s52 offen sc1
    s_mov_b32 s52, 225280
    buffer_load_dwordx4 v[68:71], v3, s[44:47], s52 offen sc1
    s_mov_b32 s52, 245760
    buffer_load_dwordx4 v[72:75], v3, s[44:47], s52 offen sc1
    s_mov_b32 s52, 266240
    buffer_load_dwordx4 v[76:79], v3, s[44:47], s52 offen sc1
    v_sub_f32 v88, 1.0, v88
    v_cvt_pk_bf16_f32 v88, v88, v88
    v_lshlrev_b32 v88, 16, v88
    v_lshlrev_b32 v86, 16, v85
    v_and_b32 v87, 0xffff0000, v85
    v_and_b32 v85, 0xffff0000, v84
    v_lshlrev_b32 v84, 16, v84
    s_waitcnt vmcnt(12)
    v_add_f32 v20, v24, v28
    v_add_f32 v21, v25, v29
    v_add_f32 v22, v26, v30
    v_add_f32 v23, v27, v31
    s_waitcnt vmcnt(11)
    v_add_f32 v20, v20, v32
    v_add_f32 v21, v21, v33
    v_add_f32 v22, v22, v34
    v_add_f32 v23, v23, v35
    s_waitcnt vmcnt(10)
    v_add_f32 v20, v20, v36
    v_add_f32 v21, v21, v37
    v_add_f32 v22, v22, v38
    v_add_f32 v23, v23, v39
    s_waitcnt vmcnt(9)
    v_add_f32 v20, v20, v40
    v_add_f32 v21, v21, v41
    v_add_f32 v22, v22, v42
    v_add_f32 v23, v23, v43
    s_waitcnt vmcnt(8)
    v_add_f32 v20, v20, v44
    v_add_f32 v21, v21, v45
    v_add_f32 v22, v22, v46
    v_add_f32 v23, v23, v47
    s_waitcnt vmcnt(7)
    v_add_f32 v20, v20, v48
    v_add_f32 v21, v21, v49
    v_add_f32 v22, v22, v50
    v_add_f32 v23, v23, v51
    s_waitcnt vmcnt(6)
    v_add_f32 v20, v20, v52
    v_add_f32 v21, v21, v53
    v_add_f32 v22, v22, v54
    v_add_f32 v23, v23, v55
    s_waitcnt vmcnt(5)
    v_add_f32 v20, v20, v56
    v_add_f32 v21, v21, v57
    v_add_f32 v22, v22, v58
    v_add_f32 v23, v23, v59
    s_waitcnt vmcnt(4)
    v_add_f32 v20, v20, v60
    v_add_f32 v21, v21, v61
    v_add_f32 v22, v22, v62
    v_add_f32 v23, v23, v63
    s_waitcnt vmcnt(3)
    v_add_f32 v20, v20, v64
    v_add_f32 v21, v21, v65
    v_add_f32 v22, v22, v66
    v_add_f32 v23, v23, v67
    s_waitcnt vmcnt(2)
    v_add_f32 v20, v20, v68
    v_add_f32 v21, v21, v69
    v_add_f32 v22, v22, v70
    v_add_f32 v23, v23, v71
    s_waitcnt vmcnt(1)
    v_add_f32 v20, v20, v72
    v_add_f32 v21, v21, v73
    v_add_f32 v22, v22, v74
    v_add_f32 v23, v23, v75
    s_waitcnt vmcnt(0)
    v_add_f32 v20, v20, v76
    v_add_f32 v21, v21, v77
    v_add_f32 v22, v22, v78
    v_add_f32 v23, v23, v79
    v_mov_b32 v24, v20
    v_mov_b32 v25, v21
    v_mov_b32 v26, v22
    v_mov_b32 v27, v23
    s_nop 0
    v_permlane16_swap_b32 v20, v24
    v_permlane16_swap_b32 v21, v25
    v_permlane16_swap_b32 v22, v26
    v_permlane16_swap_b32 v23, v27
    v_add_f32 v20, v20, v24
    v_add_f32 v21, v21, v25
    v_add_f32 v22, v22, v26
    v_add_f32 v23, v23, v27
    v_mov_b32 v24, v20
    v_mov_b32 v25, v21
    v_mov_b32 v26, v22
    v_mov_b32 v27, v23
    s_nop 0
    v_permlane32_swap_b32 v20, v24
    v_permlane32_swap_b32 v21, v25
    v_permlane32_swap_b32 v22, v26
    v_permlane32_swap_b32 v23, v27
    v_add_f32 v20, v20, v24
    v_add_f32 v21, v21, v25
    v_add_f32 v22, v22, v26
    v_add_f32 v23, v23, v27
    v_cvt_pk_bf16_f32 v20, v20, v20
    v_lshlrev_b32 v20, 16, v20
    v_mul_f32 v20, v5, v20
    v_cvt_pk_bf16_f32 v20, v20, v20
    v_lshlrev_b32 v20, 16, v20
    v_add_f32 v20, v20, v84
    v_cvt_pk_bf16_f32 v20, v20, v20
    v_lshlrev_b32 v20, 16, v20
    v_mul_f32 v20, v20, v88
    v_cvt_pk_bf16_f32 v21, v21, v21
    v_lshlrev_b32 v21, 16, v21
    v_mul_f32 v21, v5, v21
    v_cvt_pk_bf16_f32 v21, v21, v21
    v_lshlrev_b32 v21, 16, v21
    v_add_f32 v21, v21, v85
    v_cvt_pk_bf16_f32 v21, v21, v21
    v_lshlrev_b32 v21, 16, v21
    v_mul_f32 v21, v21, v88
    v_cvt_pk_bf16_f32 v22, v22, v22
    v_lshlrev_b32 v22, 16, v22
    v_mul_f32 v22, v5, v22
    v_cvt_pk_bf16_f32 v22, v22, v22
    v_lshlrev_b32 v22, 16, v22
    v_add_f32 v22, v22, v86
    v_cvt_pk_bf16_f32 v22, v22, v22
    v_lshlrev_b32 v22, 16, v22
    v_mul_f32 v22, v22, v88
    v_cvt_pk_bf16_f32 v23, v23, v23
    v_lshlrev_b32 v23, 16, v23
    v_mul_f32 v23, v5, v23
    v_cvt_pk_bf16_f32 v23, v23, v23
    v_lshlrev_b32 v23, 16, v23
    v_add_f32 v23, v23, v87
    v_cvt_pk_bf16_f32 v23, v23, v23
    v_lshlrev_b32 v23, 16, v23
    v_mul_f32 v23, v23, v88
    s_lshl_b32 s3, s59, 8
    s_add_u32 s3, s3, 158976
    v_add_u32 v2, s3, v2
    ds_write_b128 v2, v[20:23]
    s_lshl_b32 s3, s59, 2
    v_add_u32 v2, s3, v12
    ds_write_b32 v2, v80 offset:64
    s_branch K_END
WP_flags:
    s_setpc_b64 s[38:39]
K_P2_FLAGS:
    s_mov_b32 exec_hi, 0
    s_waitcnt vmcnt(0)
    s_mov_b32 s3, 131072
K_P2_FCHK:
    v_cmp_eq_u32 vcc, 1, v7
    s_nop 1
    v_mov_b32 v2, vcc_lo
    ds_write_b32 v12, v2 offset:32
    s_cmp_eq_u32 vcc_lo, -1
    s_cbranch_scc1 K_P2_FGO
    s_cmp_lg_u32 vcc_lo, 0
    s_cbranch_scc1 K_P2_FS
    s_sleep 4
K_P2_FS:
    s_sleep 6
    global_load_dword v7, v10, s[10:11] sc1
    s_sub_u32 s3, s3, 1
    s_waitcnt vmcnt(0)
    s_cbranch_scc0 K_P2_FCHK
    v_mov_b32 v2, -1
    ds_write_b32 v12, v2 offset:32
K_P2_FGO:
    s_mov_b64 exec, -1
    s_branch K_END
.p2align 12
K_AUX:
    s_load_dwordx8 s[48:55], s[0:1], 32
    s_load_dwordx2 s[56:57], s[0:1], 64
    s_mul_i32 s44, s28, 7
    s_add_u32 s44, s44, s29
    s_sub_u32 s44, s44, 1
    s_cmp_lt_u32 s44, 54
    s_cselect_b32 s44, s44, 63
    s_cmp_eq_u32 s29, 0
    s_cselect_b32 s44, 63, s44
    s_lshl_b32 s74, s28, 8
    s_lshl_b32 s3, s29, 5
    s_add_u32 s74, s74, s3
    v_mov_b32 v12, 158720
    v_mov_b32 v13, 1
    s_cmp_lt_u32 s30, 4
    s_cbranch_scc1 K_AUX_LO
    s_lshl_b32 s3, s30, 3
    s_add_u32 s3, s3, s74
    s_sub_u32 s3, s3, 32
    v_lshrrev_b32 v9, 3, v1
    v_add_u32 v9, s3, v9
    v_and_b32 v11, 7, v1
    v_lshlrev_b32 v11, 4, v11
    v_mul_u32_u24 v10, 1280, v9
    v_add_u32 v10, v10, v11
    s_waitcnt lgkmcnt(0)
    buffer_load_dwordx4 v[16:19], v10, s[12:15], 0 offen offset:0
    buffer_load_dwordx4 v[20:23], v10, s[12:15], 0 offen offset:128
    buffer_load_dwordx4 v[24:27], v10, s[12:15], 0 offen offset:256
    buffer_load_dwordx4 v[28:31], v10, s[12:15], 0 offen offset:384
    buffer_load_dwordx4 v[32:35], v10, s[12:15], 0 offen offset:512
    buffer_load_dwordx4 v[36:39], v10, s[12:15], 0 offen offset:640
    buffer_load_dwordx4 v[40:43], v10, s[12:15], 0 offen offset:768
    buffer_load_dwordx4 v[44:47], v10, s[12:15], 0 offen offset:896
    buffer_load_dwordx4 v[48:51], v10, s[12:15], 0 offen offset:1024
    buffer_load_dwordx4 v[52:55], v10, s[12:15], 0 offen offset:1152
    s_mov_b32 s16, s48
    s_mov_b32 s17, s49
    s_mov_b32 s18, 0x500
    s_mov_b32 s19, 0x20000
    s_mov_b32 s20, s56
    s_mov_b32 s21, s57
    s_mov_b32 s22, 0x500
    s_mov_b32 s23, 0x20000
    buffer_load_dwordx4 v[56:59], v11, s[16:19], 0 offen offset:0
    buffer_load_dwordx4 v[60:63], v11, s[16:19], 0 offen offset:128
    buffer_load_dwordx4 v[64:67], v11, s[16:19], 0 offen offset:256
    buffer_load_dwordx4 v[68:71], v11, s[16:19], 0 offen offset:384
    buffer_load_dwordx4 v[72:75], v11, s[16:19], 0 offen offset:512
    buffer_load_dwordx4 v[76:79], v11, s[16:19], 0 offen offset:640
    buffer_load_dwordx4 v[80:83], v11, s[16:19], 0 offen offset:768
    buffer_load_dwordx4 v[84:87], v11, s[16:19], 0 offen offset:896
    buffer_load_dwordx4 v[88:91], v11, s[16:19], 0 offen offset:1024
    buffer_load_dwordx4 v[92:95], v11, s[16:19], 0 offen offset:1152
    buffer_load_dwordx4 v[96:99], v11, s[20:23], 0 offen offset:0
    buffer_load_dwordx4 v[100:103], v11, s[20:23], 0 offen offset:128
    buffer_load_dwordx4 v[104:107], v11, s[20:23], 0 offen offset:256
    buffer_load_dwordx4 v[108:111], v11, s[20:23], 0 offen offset:384
    buffer_load_dwordx4 v[112:115], v11, s[20:23], 0 offen offset:512
    buffer_load_dwordx4 v[116:119], v11, s[20:23], 0 offen offset:640
    buffer_load_dwordx4 v[120:123], v11, s[20:23], 0 offen offset:768
    buffer_load_dwordx4 v[124:127], v11, s[20:23], 0 offen offset:896
    buffer_load_dwordx4 v[128:131], v11, s[20:23], 0 offen offset:1024
    buffer_load_dwordx4 v[132:135], v11, s[20:23], 0 offen offset:1152
    s_barrier
    v_mov_b32 v180, 0
    v_mov_b32 v181, 0
    v_mov_b32 v182, 0
    v_mov_b32 v183, 0
    v_and_b32 v10, 31, v9
    v_lshlrev_b32 v10, 2, v10
    v_add_u32 v10, 122880, v10
    v_sub_u32 v4, 0x87ff, v9
    s_setprio 2
    s_waitcnt vmcnt(10)
    v_dot2c_f32_bf16 v180, v16, v56
    v_dot2c_f32_bf16 v181, v17, v57
    v_dot2c_f32_bf16 v180, v18, v58
    v_dot2c_f32_bf16 v181, v19, v59
    v_dot2c_f32_bf16 v180, v20, v60
    v_dot2c_f32_bf16 v181, v21, v61
    v_dot2c_f32_bf16 v180, v22, v62
    v_dot2c_f32_bf16 v181, v23, v63
    v_dot2c_f32_bf16 v180, v24, v64
    v_dot2c_f32_bf16 v181, v25, v65
    v_dot2c_f32_bf16 v180, v26, v66
    v_dot2c_f32_bf16 v181, v27, v67
    v_dot2c_f32_bf16 v180, v28, v68
    v_dot2c_f32_bf16 v181, v29, v69
    v_dot2c_f32_bf16 v180, v30, v70
    v_dot2c_f32_bf16 v181, v31, v71
    v_dot2c_f32_bf16 v180, v32, v72
    v_dot2c_f32_bf16 v181, v33, v73
    v_dot2c_f32_bf16 v180, v34, v74
    v_dot2c_f32_bf16 v181, v35, v75
    v_dot2c_f32_bf16 v180, v36, v76
    v_dot2c_f32_bf16 v181, v37, v77
    v_dot2c_f32_bf16 v180, v38, v78
    v_dot2c_f32_bf16 v181, v39, v79
    v_dot2c_f32_bf16 v180, v40, v80
    v_dot2c_f32_bf16 v181, v41, v81
    v_dot2c_f32_bf16 v180, v42, v82
    v_dot2c_f32_bf16 v181, v43, v83
    v_dot2c_f32_bf16 v180, v44, v84
    v_dot2c_f32_bf16 v181, v45, v85
    v_dot2c_f32_bf16 v180, v46, v86
    v_dot2c_f32_bf16 v181, v47, v87
    v_dot2c_f32_bf16 v180, v48, v88
    v_dot2c_f32_bf16 v181, v49, v89
    v_dot2c_f32_bf16 v180, v50, v90
    v_dot2c_f32_bf16 v181, v51, v91
    v_dot2c_f32_bf16 v180, v52, v92
    v_dot2c_f32_bf16 v181, v53, v93
    v_dot2c_f32_bf16 v180, v54, v94
    v_dot2c_f32_bf16 v181, v55, v95
    s_waitcnt vmcnt(0)
    v_dot2c_f32_bf16 v182, v16, v96
    v_dot2c_f32_bf16 v183, v17, v97
    v_dot2c_f32_bf16 v182, v18, v98
    v_dot2c_f32_bf16 v183, v19, v99
    v_dot2c_f32_bf16 v182, v20, v100
    v_dot2c_f32_bf16 v183, v21, v101
    v_dot2c_f32_bf16 v182, v22, v102
    v_dot2c_f32_bf16 v183, v23, v103
    v_dot2c_f32_bf16 v182, v24, v104
    v_dot2c_f32_bf16 v183, v25, v105
    v_dot2c_f32_bf16 v182, v26, v106
    v_dot2c_f32_bf16 v183, v27, v107
    v_dot2c_f32_bf16 v182, v28, v108
    v_dot2c_f32_bf16 v183, v29, v109
    v_dot2c_f32_bf16 v182, v30, v110
    v_dot2c_f32_bf16 v183, v31, v111
    v_dot2c_f32_bf16 v182, v32, v112
    v_dot2c_f32_bf16 v183, v33, v113
    v_dot2c_f32_bf16 v182, v34, v114
    v_dot2c_f32_bf16 v183, v35, v115
    v_dot2c_f32_bf16 v182, v36, v116
    v_dot2c_f32_bf16 v183, v37, v117
    v_dot2c_f32_bf16 v182, v38, v118
    v_dot2c_f32_bf16 v183, v39, v119
    v_dot2c_f32_bf16 v182, v40, v120
    v_dot2c_f32_bf16 v183, v41, v121
    v_dot2c_f32_bf16 v182, v42, v122
    v_dot2c_f32_bf16 v183, v43, v123
    v_dot2c_f32_bf16 v182, v44, v124
    v_dot2c_f32_bf16 v183, v45, v125
    v_dot2c_f32_bf16 v182, v46, v126
    v_dot2c_f32_bf16 v183, v47, v127
    v_dot2c_f32_bf16 v182, v48, v128
    v_dot2c_f32_bf16 v183, v49, v129
    v_dot2c_f32_bf16 v182, v50, v130
    v_dot2c_f32_bf16 v183, v51, v131
    v_dot2c_f32_bf16 v182, v52, v132
    v_dot2c_f32_bf16 v183, v53, v133
    v_dot2c_f32_bf16 v182, v54, v134
    v_dot2c_f32_bf16 v183, v55, v135
    s_nop 2
    v_add_f32 v180, v180, v181
    v_add_f32 v182, v182, v183
    s_nop 0
    v_add_f32_dpp v180, v180, v180 quad_perm:[1,0,3,2] row_mask:0xf bank_mask:0xf
    v_add_f32_dpp v182, v182, v182 quad_perm:[1,0,3,2] row_mask:0xf bank_mask:0xf
    s_nop 0
    v_add_f32_dpp v180, v180, v180 quad_perm:[2,3,0,1] row_mask:0xf bank_mask:0xf
    v_add_f32_dpp v182, v182, v182 quad_perm:[2,3,0,1] row_mask:0xf bank_mask:0xf
    s_nop 0
    v_add_f32_dpp v180, v180, v180 row_half_mirror row_mask:0xf bank_mask:0xf
    v_add_f32_dpp v182, v182, v182 row_half_mirror row_mask:0xf bank_mask:0xf
    v_cvt_pk_bf16_f32 v2, v180, v180
    v_lshlrev_b32 v2, 16, v2
    v_ashrrev_i32 v3, 31, v2
    v_or_b32 v3, 0x80000000, v3
    v_xor_b32 v2, v2, v3
    v_and_b32 v2, 0xffff0000, v2
    v_or_b32 v2, v2, v4
    ds_write2_b32 v10, v2, v182 offset0:0 offset1:32
    s_mov_b64 exec, 1
    ds_add_u32 v12, v13 offset:36
    s_mov_b64 exec, -1
    s_setprio 0
    s_cmp_lg_u32 s30, 4
    s_cbranch_scc1 K_WARMA0
    s_call_b64 s[38:39], WP_p2g
    s_branch K_WARMAX
K_WARMA0:
    s_cmp_lg_u32 s30, 5
    s_cbranch_scc1 K_WARMA1
    s_call_b64 s[38:39], WP_gen
    s_branch K_WARMAX
K_WARMA1:
    s_cmp_lg_u32 s30, 6
    s_cbranch_scc1 K_WARMA2
    s_call_b64 s[38:39], WP_help
    s_call_b64 s[38:39], WP_flags
    s_branch K_WARMAX
K_WARMA2:
    s_call_b64 s[38:39], WP_spin
K_WARMAX:
    s_cmp_ge_u32 s30, 6
    s_cselect_b32 s44, 63, s44
    s_cmp_lg_u32 s44, 63
    s_cbranch_scc1 K_FFN_C
    s_mov_b32 s3, 1048576
K_FGH:
    ds_read_b32 v2, v12 offset:48
    s_sleep 8
    s_sub_u32 s3, s3, 1
    s_waitcnt lgkmcnt(0)
    v_readfirstlane_b32 s33, v2
    s_nop 3
    s_cselect_b32 s33, 1, s33
    s_cmp_lt_u32 s33, 1
    s_cbranch_scc1 K_FGH
    s_cmp_eq_u32 s30, 6
    s_cbranch_scc1 K_P2_HELP
    v_mov_b32 v7, 1
    s_branch K_P2_HELP
K_AUX_LO:
    s_waitcnt lgkmcnt(0)
    s_cmp_eq_u32 s30, 0
    s_cbranch_scc1 K_AUX_PUB
    s_cmp_eq_u32 s44, 63
    s_cbranch_scc1 K_AUX_NOF
    s_and_b32 s3, s44, 1
    s_cmp_eq_u32 s3, 0
    s_cselect_b64 s[60:61], s[50:51], s[52:53]
    s_cselect_b64 s[64:65], s[52:53], s[50:51]
    s_cselect_b32 s75, 0, 40960
    s_mov_b32 s62, 0x21c000
    s_mov_b32 s63, 0x20000
    s_mov_b32 s66, 0x21c000
    s_mov_b32 s67, 0x20000
    v_lshrrev_b32 v2, 2, v1
    v_mul_u32_u24 v184, 3456, v2
    v_and_b32 v2, 3, v1
    v_lshl_add_u32 v184, v2, 4, v184
    s_lshl_b32 s72, s44, 6
    v_add_u32 v184, s72, v184
    s_sub_u32 s74, s30, 1
K_FSA0:
    s_lshl_b32 s73, s74, 10
    s_mul_i32 s72, s74, 55296
    s_add_u32 m0, s73, s75
    s_waitcnt vmcnt(5)
    buffer_load_dwordx4 v184, s[60:63], s72 offen lds
    s_add_u32 s74, s74, 3
    s_cmp_lt_u32 s74, 18
    s_cbranch_scc1 K_FSA0
    s_barrier
K_FSA:
    s_lshl_b32 s73, s74, 10
    s_mul_i32 s72, s74, 55296
    s_add_u32 m0, s73, s75
    s_waitcnt vmcnt(5)
    buffer_load_dwordx4 v184, s[60:63], s72 offen lds
    s_add_u32 s74, s74, 3
    s_cmp_lt_u32 s74, 40
    s_cbranch_scc1 K_FSA
    s_sub_u32 s74, s74, 40
    s_xor_b32 s75, s75, 40960
    s_mov_b32 s68, s54
    s_mov_b32 s69, s55
    s_mov_b32 s70, 0x21c000
    s_mov_b32 s71, 0x20000
    s_mul_i32 s3, s44, 40960
    v_lshrrev_b32 v2, 3, v1
    v_mul_u32_u24 v2, 1280, v2
    v_lshrrev_b32 v3, 4, v1
    v_lshlrev_b32 v3, 1, v3
    v_and_b32 v4, 7, v1
    v_xor_b32 v3, v3, v4
    v_lshl_add_u32 v2, v3, 4, v2
    v_add_u32 v185, s3, v2
K_FSB:
    s_lshl_b32 s73, s74, 10
    s_mul_i32 s72, s74, 55296
    s_add_u32 m0, s73, s75
    s_waitcnt vmcnt(5)
    buffer_load_dwordx4 v184, s[64:67], s72 offen lds
    s_add_u32 s74, s74, 3
    s_cmp_lt_u32 s74, 40
    s_cbranch_scc1 K_FSB
    s_sub_u32 s74, s74, 40
    s_mov_b32 s75, 81920
K_FSD0:
    s_lshl_b32 s73, s74, 10
    s_and_b32 s72, s74, 3
    s_mul_i32 s72, s72, 10208
    s_lshl_b32 s3, s74, 5
    s_add_u32 s72, s72, s3
    s_add_u32 m0, s73, s75
    s_waitcnt vmcnt(5)
    buffer_load_dwordx4 v185, s[68:71], s72 offen lds
    s_add_u32 s74, s74, 3
    s_cmp_lt_u32 s74, 18
    s_cbranch_scc1 K_FSD0
    s_waitcnt vmcnt(6)
    s_mov_b64 exec, 1
    ds_add_u32 v12, v13 offset:56
    s_mov_b64 exec, -1
K_FSD:
    s_lshl_b32 s73, s74, 10
    s_and_b32 s72, s74, 3
    s_mul_i32 s72, s72, 10208
    s_lshl_b32 s3, s74, 5
    s_add_u32 s72, s72, s3
    s_add_u32 m0, s73, s75
    s_waitcnt vmcnt(5)
    buffer_load_dwordx4 v185, s[68:71], s72 offen lds
    s_add_u32 s74, s74, 3
    s_cmp_lt_u32 s74, 40
    s_cbranch_scc1 K_FSD
    s_mul_i32 s3, s29, 96
    s_lshl_b32 s72, s30, 5
    s_add_u32 s3, s3, s72
    s_sub_u32 s3, s3, 128
    v_lshrrev_b32 v2, 1, v1
    v_add_u32 v2, s3, v2
    v_mul_u32_u24 v2, 1280, v2
    v_and_b32 v3, 1, v1
    v_lshl_add_u32 v2, v3, 7, v2
    buffer_load_dword v6, v2, s[24:27], 0 offen offset:1024
K_AUX_WR:
    s_mov_b32 s3, 1048576
K_FGR:
    ds_read_b32 v2, v12 offset:60
    s_sleep 2
    s_sub_u32 s3, s3, 1
    s_waitcnt lgkmcnt(0)
    v_readfirstlane_b32 s33, v2
    s_nop 3
    s_cselect_b32 s33, 2, s33
    s_cmp_lt_u32 s33, 2
    s_cbranch_scc1 K_FGR
    s_branch K_P2
K_AUX_NOF:
    s_cmp_lg_u32 s2, 63
    s_cbranch_scc1 K_AUX_NOZ
    s_cmp_lg_u32 s30, 1
    s_cbranch_scc1 K_AUX_NOZ
    s_add_u32 s60, s10, 0x80000
    s_addc_u32 s61, s11, 0
    s_mov_b32 s62, 0xc000
    s_mov_b32 s63, 0x20000
    s_barrier
    s_mov_b32 s3, 1048576
K_FGZ:
    ds_read_b32 v2, v12 offset:36
    s_sleep 2
    s_sub_u32 s3, s3, 1
    s_waitcnt lgkmcnt(0)
    v_readfirstlane_b32 s33, v2
    s_nop 3
    s_cselect_b32 s33, 4, s33
    s_cmp_lt_u32 s33, 4
    s_cbranch_scc1 K_FGZ
    v_and_b32 v4, 7, v1
    v_lshlrev_b32 v4, 2, v4
    s_mov_b32 s3, 131072
K_ZPOLL4:
    v_cmp_eq_u32 vcc, 0, v7
    s_cbranch_vccz K_ZOK4
    s_sub_u32 s3, s3, 1
    s_cbranch_scc1 K_ZOK4
    global_load_dword v7, v4, s[8:9] offset:192 sc1
    s_waitcnt vmcnt(0)
    s_branch K_ZPOLL4
K_ZOK4:
    v_lshlrev_b32 v4, 3, v1
    s_mov_b32 s72, 43008
    s_mov_b32 s3, 131072
    s_setprio 3
K_AGG_POLL:
    buffer_load_dwordx2 v[176:177], v4, s[60:63], s72 offen sc1
    s_waitcnt vmcnt(0)
    v_min_u32 v2, v176, v177
    v_cmp_eq_u32 vcc, 0, v2
    s_cbranch_vccz K_AGG_GOT
    s_sleep 2
    s_sub_u32 s3, s3, 1
    s_cmp_lg_u32 s3, 0
    s_cbranch_scc1 K_AGG_POLL
K_AGG_GOT:
    s_nop 1
    v_max_u32_dpp v3, v176, v176 quad_perm:[1,0,3,2] row_mask:0xf bank_mask:0xf
    s_nop 1
    v_max_u32_dpp v3, v3, v3 quad_perm:[2,3,0,1] row_mask:0xf bank_mask:0xf
    s_nop 1
    v_max_u32_dpp v3, v3, v3 row_half_mirror row_mask:0xf bank_mask:0xf
    s_nop 1
    v_max_u32_dpp v3, v3, v3 row_mirror row_mask:0xf bank_mask:0xf
    s_nop 1
    v_readlane_b32 s74, v3, 0
    v_readlane_b32 s76, v3, 16
    v_readlane_b32 s77, v3, 32
    v_readlane_b32 s78, v3, 48
    s_nop 3
    s_max_u32 s74, s74, s76
    s_max_u32 s77, s77, s78
    s_max_u32 s74, s74, s77
    v_cmp_ne_u32 vcc, s74, v176
    s_nop 1
    v_cndmask_b32 v2, v177, v176, vcc
    s_nop 1
    v_max_u32_dpp v3, v2, v2 quad_perm:[1,0,3,2] row_mask:0xf bank_mask:0xf
    s_nop 1
    v_max_u32_dpp v3, v3, v3 quad_perm:[2,3,0,1] row_mask:0xf bank_mask:0xf
    s_nop 1
    v_max_u32_dpp v3, v3, v3 row_half_mirror row_mask:0xf bank_mask:0xf
    s_nop 1
    v_max_u32_dpp v3, v3, v3 row_mirror row_mask:0xf bank_mask:0xf
    s_nop 1
    v_readlane_b32 s75, v3, 0
    v_readlane_b32 s76, v3, 16
    v_readlane_b32 s77, v3, 32
    v_readlane_b32 s78, v3, 48
    s_nop 3
    s_max_u32 s75, s75, s76
    s_max_u32 s77, s77, s78
    s_max_u32 s75, s75, s77
    v_mov_b32 v176, s74
    v_mov_b32 v177, s75
    s_mov_b32 s62, 40960
    v_lshlrev_b32 v3, 8, v1
    s_mov_b32 s3, 0
    buffer_store_dwordx2 v[176:177], v3, s[60:63], s3 offen offset:128 sc1
    s_mov_b32 s3, 16384
    buffer_store_dwordx2 v[176:177], v3, s[60:63], s3 offen offset:128 sc1
    s_mov_b32 s3, 32768
    buffer_store_dwordx2 v[176:177], v3, s[60:63], s3 offen offset:128 sc1
    s_setprio 0
    s_branch K_AUX_NOK
K_AUX_NOZ:
    s_barrier
K_AUX_NOK:
    s_mov_b32 s3, 1048576
K_FGWD:
    ds_read_b32 v2, v12 offset:48
    s_sleep 4
    s_sub_u32 s3, s3, 1
    s_waitcnt lgkmcnt(0)
    v_readfirstlane_b32 s33, v2
    s_nop 3
    s_cselect_b32 s33, 1, s33
    s_cmp_lt_u32 s33, 1
    s_cbranch_scc1 K_FGWD
    s_branch K_P2
K_AUX_PUB:
    s_add_u32 s60, s10, 0x1000
    s_addc_u32 s61, s11, 0
    s_mov_b32 s62, 0x2000
    s_mov_b32 s63, 0x20000
    v_and_b32 v3, 31, v1
    v_lshlrev_b32 v10, 2, v3
    v_add_u32 v11, 122880, v10
    s_lshl_b32 s72, s74, 2
    s_lshl_b32 s3, s2, 3
    s_add_u32 s3, s3, 567296
    v_mov_b32 v9, s3
    v_and_b32 v5, 7, v1
    v_lshlrev_b32 v5, 2, v5
    s_barrier
    s_setprio 3
    s_mov_b32 s3, 1048576
K_FGRT:
    ds_read_b32 v2, v12 offset:36
    s_sleep 0
    s_sub_u32 s3, s3, 1
    s_waitcnt lgkmcnt(0)
    v_readfirstlane_b32 s33, v2
    s_nop 3
    s_cselect_b32 s33, 4, s33
    s_cmp_lt_u32 s33, 4
    s_cbranch_scc1 K_FGRT
    ds_read2_b32 v[176:177], v11 offset0:0 offset1:32
    global_load_dword v7, v5, s[8:9] offset:192 sc1
    s_waitcnt lgkmcnt(0)
    v_cvt_pk_bf16_f32 v177, v177, v177
    v_lshlrev_b32 v177, 16, v177
    v_mul_f32 v5, 0xbfb8aa3b, v177
    v_exp_f32 v5, v5
    s_nop 0
    v_add_f32 v5, 1.0, v5
    v_rcp_f32 v177, v5
    s_nop 0
    v_cvt_pk_bf16_f32 v177, v177, v177
    v_lshlrev_b32 v177, 16, v177
    s_mov_b32 exec_hi, 0
    buffer_store_dword v177, v10, s[60:63], s72 offen sc1
    s_mov_b64 exec, -1
    s_nop 1
    v_max_u32_dpp v3, v176, v176 quad_perm:[1,0,3,2] row_mask:0xf bank_mask:0xf
    s_nop 1
    v_max_u32_dpp v3, v3, v3 quad_perm:[2,3,0,1] row_mask:0xf bank_mask:0xf
    s_nop 1
    v_max_u32_dpp v3, v3, v3 row_half_mirror row_mask:0xf bank_mask:0xf
    s_nop 1
    v_max_u32_dpp v3, v3, v3 row_mirror row_mask:0xf bank_mask:0xf
    s_nop 1
    v_readlane_b32 s74, v3, 0
    v_readlane_b32 s76, v3, 16
    v_readlane_b32 s77, v3, 32
    v_readlane_b32 s78, v3, 48
    s_nop 3
    s_max_u32 s74, s74, s76
    s_max_u32 s77, s77, s78
    s_max_u32 s74, s74, s77
    v_cmp_ne_u32 vcc, s74, v176
    s_nop 1
    v_cndmask_b32 v176, 0, v176, vcc
    s_nop 1
    v_max_u32_dpp v3, v176, v176 quad_perm:[1,0,3,2] row_mask:0xf bank_mask:0xf
    s_nop 1
    v_max_u32_dpp v3, v3, v3 quad_perm:[2,3,0,1] row_mask:0xf bank_mask:0xf
    s_nop 1
    v_max_u32_dpp v3, v3, v3 row_half_mirror row_mask:0xf bank_mask:0xf
    s_nop 1
    v_max_u32_dpp v3, v3, v3 row_mirror row_mask:0xf bank_mask:0xf
    s_nop 1
    v_readlane_b32 s75, v3, 0
    v_readlane_b32 s76, v3, 16
    v_readlane_b32 s77, v3, 32
    v_readlane_b32 s78, v3, 48
    s_nop 3
    s_max_u32 s75, s75, s76
    s_max_u32 s77, s77, s78
    s_max_u32 s75, s75, s77
    v_mov_b32 v176, s74
    v_mov_b32 v177, s75
    s_waitcnt vmcnt(0)
    v_and_b32 v4, 7, v1
    v_lshlrev_b32 v4, 2, v4
    s_mov_b32 s3, 131072
K_ZPOLL3:
    v_cmp_eq_u32 vcc, 0, v7
    s_cbranch_vccz K_ZOK3
    s_sub_u32 s3, s3, 1
    s_cbranch_scc1 K_ZOK3
    global_load_dword v7, v4, s[8:9] offset:192 sc1
    s_waitcnt vmcnt(0)
    s_branch K_ZPOLL3
K_ZOK3:
    s_mov_b64 exec, 1
    global_store_dwordx2 v9, v[176:177], s[10:11] sc1
    s_mov_b64 exec, -1
    v_and_b32 v3, 1, v1
    v_lshl_add_u32 v3, v3, 2, s42
    v_lshlrev_b32 v10, 4, v1
    s_mov_b32 s3, 131072
K_AUX_POLL:
    s_sleep 6
    global_load_dword v2, v3, s[10:11] offset:128 sc1
    s_waitcnt vmcnt(0)
    v_cmp_eq_u32 vcc, 0, v2
    s_cbranch_vccz K_AUX_GOT
    s_sub_u32 s3, s3, 1
    s_cmp_lg_u32 s3, 0
    s_cbranch_scc1 K_AUX_POLL
K_AUX_GOT:
    v_readlane_b32 s74, v2, 0
    v_readlane_b32 s75, v2, 1
    s_nop 3
    s_and_b32 s74, s74, 0x7ff
    s_sub_u32 s74, 2047, s74
    s_mul_i32 s74, s74, 1280
    s_mov_b32 m0, 125184
    s_nop 0
    buffer_load_dwordx4 v10, s[12:15], s74 offen lds
    s_mov_b64 exec, 0xffff
    buffer_load_dwordx4 v10, s[12:15], s74 offen offset:1024 lds
    s_mov_b64 exec, -1
    s_and_b32 s75, s75, 0x7ff
    s_sub_u32 s75, 2047, s75
    s_mul_i32 s75, s75, 1280
    s_mov_b32 m0, 126528
    s_nop 0
    buffer_load_dwordx4 v10, s[12:15], s75 offen lds
    s_mov_b64 exec, 0xffff
    buffer_load_dwordx4 v10, s[12:15], s75 offen offset:1024 lds
    s_mov_b64 exec, -1
    s_waitcnt vmcnt(0)
    ds_write_b32 v12, v13 offset:48
    s_setprio 0
    s_branch K_P2
.p2align 12
K_FFN_C:
    s_add_u32 s64, s10, 0x10000
    s_addc_u32 s65, s11, 0
    s_mov_b32 s66, 0x43800
    s_mov_b32 s67, 0x20000
    s_and_b32 s73, s30, 1
    v_lshrrev_b32 v232, 4, v1
    v_bfe_u32 v4, v1, 2, 2
    v_lshl_add_u32 v2, v232, 3, v4
    v_and_b32 v3, 3, v1
    v_lshlrev_b32 v3, 3, v3
    v_lshl_add_u32 v233, v2, 6, v3
    s_lshl_b32 s72, s73, 5
    v_add_u32 v233, s72, v233
    v_lshl_add_u32 v2, v232, 2, v4
    v_bfe_u32 v4, v2, 1, 2
    v_lshl_add_u32 v3, v2, 7, v3
    v_lshl_add_u32 v3, v4, 5, v3
    s_mul_i32 s3, s73, 20480
    s_add_u32 s3, s3, 81920
    v_add_u32 v238, s3, v3
    v_xor_b32 v239, 32, v238
    v_xor_b32 v240, 64, v238
    v_xor_b32 v241, 96, v238
    v_and_b32 v2, 1, v1
    v_mul_u32_u24 v234, 1344, v2
    v_lshl_add_u32 v234, v232, 4, v234
    v_add_u32 v234, 125184, v234
    v_lshlrev_b32 v236, 4, v1
    v_add_u32 v236, 124160, v236
    s_lshl_b32 s3, s73, 3
    v_add_u32 v235, s3, v236
    v_mul_u32_u24 v2, 2560, v2
    v_lshl_add_u32 v237, v232, 4, v2
    s_mul_i32 s3, s44, 5120
    s_mul_i32 s72, s73, 1280
    s_add_u32 s72, s72, s3
    v_lshlrev_b32 v2, 4, v1
    buffer_store_dwordx4 v[16:19], v2, s[64:67], s72 offen offset:0 sc1
    buffer_store_dwordx4 v[16:19], v2, s[64:67], s72 offen offset:2560 sc1
    s_mov_b64 exec, 0xffff
    buffer_store_dwordx4 v[16:19], v2, s[64:67], s72 offen offset:1024 sc1
    buffer_store_dwordx4 v[16:19], v2, s[64:67], s72 offen offset:3584 sc1
    s_mov_b64 exec, -1
    v_add_u32 v5, 40960, v233
    s_mov_b32 s3, 1048576
K_FGD:
    ds_read_b32 v2, v12 offset:56
    s_sleep 2
    s_sub_u32 s3, s3, 1
    s_waitcnt lgkmcnt(0)
    v_readfirstlane_b32 s33, v2
    s_nop 3
    s_cselect_b32 s33, 3, s33
    s_cmp_lt_u32 s33, 3
    s_cbranch_scc1 K_FGD
    s_setprio 3
    ds_read_b64_tr_b16 v[16:17], v233 offset:0
    ds_read_b64_tr_b16 v[18:19], v233 offset:256
    ds_read_b64_tr_b16 v[20:21], v233 offset:2048
    ds_read_b64_tr_b16 v[22:23], v233 offset:2304
    ds_read_b64_tr_b16 v[24:25], v233 offset:4096
    ds_read_b64_tr_b16 v[26:27], v233 offset:4352
    ds_read_b64_tr_b16 v[28:29], v233 offset:6144
    ds_read_b64_tr_b16 v[30:31], v233 offset:6400
    ds_read_b64_tr_b16 v[32:33], v233 offset:8192
    ds_read_b64_tr_b16 v[34:35], v233 offset:8448
    ds_read_b64_tr_b16 v[36:37], v233 offset:10240
    ds_read_b64_tr_b16 v[38:39], v233 offset:10496
    ds_read_b64_tr_b16 v[40:41], v233 offset:12288
    ds_read_b64_tr_b16 v[42:43], v233 offset:12544
    ds_read_b64_tr_b16 v[44:45], v233 offset:14336
    ds_read_b64_tr_b16 v[46:47], v233 offset:14592
    ds_read_b64_tr_b16 v[48:49], v233 offset:16384
    ds_read_b64_tr_b16 v[50:51], v233 offset:16640
    ds_read_b64_tr_b16 v[52:53], v233 offset:18432
    ds_read_b64_tr_b16 v[54:55], v233 offset:18688
    ds_read_b64_tr_b16 v[56:57], v233 offset:20480
    ds_read_b64_tr_b16 v[58:59], v233 offset:20736
    ds_read_b64_tr_b16 v[60:61], v233 offset:22528
    ds_read_b64_tr_b16 v[62:63], v233 offset:22784
    ds_read_b64_tr_b16 v[64:65], v233 offset:24576
    ds_read_b64_tr_b16 v[66:67], v233 offset:24832
    ds_read_b64_tr_b16 v[68:69], v233 offset:26624
    ds_read_b64_tr_b16 v[70:71], v233 offset:26880
    ds_read_b64_tr_b16 v[72:73], v233 offset:28672
    ds_read_b64_tr_b16 v[74:75], v233 offset:28928
    ds_read_b64_tr_b16 v[76:77], v233 offset:30720
    ds_read_b64_tr_b16 v[78:79], v233 offset:30976
    ds_read_b64_tr_b16 v[80:81], v233 offset:32768
    ds_read_b64_tr_b16 v[82:83], v233 offset:33024
    ds_read_b64_tr_b16 v[84:85], v233 offset:34816
    ds_read_b64_tr_b16 v[86:87], v233 offset:35072
    ds_read_b64_tr_b16 v[88:89], v233 offset:36864
    ds_read_b64_tr_b16 v[90:91], v233 offset:37120
    ds_read_b64_tr_b16 v[92:93], v233 offset:38912
    ds_read_b64_tr_b16 v[94:95], v233 offset:39168
    ds_read_b64_tr_b16 v[96:97], v5 offset:0
    ds_read_b64_tr_b16 v[98:99], v5 offset:256
    ds_read_b64_tr_b16 v[100:101], v5 offset:2048
    ds_read_b64_tr_b16 v[102:103], v5 offset:2304
    ds_read_b64_tr_b16 v[104:105], v5 offset:4096
    ds_read_b64_tr_b16 v[106:107], v5 offset:4352
    ds_read_b64_tr_b16 v[108:109], v5 offset:6144
    ds_read_b64_tr_b16 v[110:111], v5 offset:6400
    ds_read_b64_tr_b16 v[112:113], v5 offset:8192
    ds_read_b64_tr_b16 v[114:115], v5 offset:8448
    ds_read_b64_tr_b16 v[116:117], v5 offset:10240
    ds_read_b64_tr_b16 v[118:119], v5 offset:10496
    ds_read_b64_tr_b16 v[120:121], v5 offset:12288
    ds_read_b64_tr_b16 v[122:123], v5 offset:12544
    ds_read_b64_tr_b16 v[124:125], v5 offset:14336
    ds_read_b64_tr_b16 v[126:127], v5 offset:14592
    ds_read_b64_tr_b16 v[128:129], v5 offset:16384
    ds_read_b64_tr_b16 v[130:131], v5 offset:16640
    ds_read_b64_tr_b16 v[132:133], v5 offset:18432
    ds_read_b64_tr_b16 v[134:135], v5 offset:18688
    ds_read_b64_tr_b16 v[136:137], v5 offset:20480
    ds_read_b64_tr_b16 v[138:139], v5 offset:20736
    ds_read_b64_tr_b16 v[140:141], v5 offset:22528
    ds_read_b64_tr_b16 v[142:143], v5 offset:22784
    ds_read_b64_tr_b16 v[144:145], v5 offset:24576
    ds_read_b64_tr_b16 v[146:147], v5 offset:24832
    ds_read_b64_tr_b16 v[148:149], v5 offset:26624
    ds_read_b64_tr_b16 v[150:151], v5 offset:26880
    ds_read_b64_tr_b16 v[152:153], v5 offset:28672
    ds_read_b64_tr_b16 v[154:155], v5 offset:28928
    ds_read_b64_tr_b16 v[156:157], v5 offset:30720
    ds_read_b64_tr_b16 v[158:159], v5 offset:30976
    ds_read_b64_tr_b16 v[160:161], v5 offset:32768
    ds_read_b64_tr_b16 v[162:163], v5 offset:33024
    ds_read_b64_tr_b16 v[164:165], v5 offset:34816
    ds_read_b64_tr_b16 v[166:167], v5 offset:35072
    ds_read_b64_tr_b16 v[168:169], v5 offset:36864
    ds_read_b64_tr_b16 v[170:171], v5 offset:37120
    ds_read_b64_tr_b16 v[172:173], v5 offset:38912
    ds_read_b64_tr_b16 v[174:175], v5 offset:39168
    s_waitcnt vmcnt(0) lgkmcnt(0)
    s_mov_b64 exec, 1
    ds_add_u32 v12, v13 offset:60
    s_mov_b64 exec, -1
    s_mov_b32 s3, 1048576
K_FGK:
    ds_read_b32 v2, v12 offset:48
    s_sleep 1
    s_sub_u32 s3, s3, 1
    s_waitcnt lgkmcnt(0)
    v_readfirstlane_b32 s33, v2
    s_nop 3
    s_cselect_b32 s33, 1, s33
    s_cmp_lt_u32 s33, 1
    s_cbranch_scc1 K_FGK
    ds_read_b128 v[188:191], v234 offset:0
    ds_read_b128 v[192:195], v234 offset:64
    ds_read_b128 v[196:199], v234 offset:128
    ds_read_b128 v[200:203], v234 offset:192
    ds_read_b128 v[204:207], v234 offset:256
    ds_read_b128 v[208:211], v234 offset:320
    ds_read_b128 v[212:215], v234 offset:384
    ds_read_b128 v[216:219], v234 offset:448
    s_waitcnt lgkmcnt(7)
    v_mfma_f32_16x16x32_bf16 v[220:223], v[16:19], v[188:191], 0
    v_mfma_f32_16x16x32_bf16 v[224:227], v[96:99], v[188:191], 0
    ds_read_b128 v[188:191], v234 offset:512
    s_waitcnt lgkmcnt(7)
    v_mfma_f32_16x16x32_bf16 v[220:223], v[20:23], v[192:195], v[220:223]
    v_mfma_f32_16x16x32_bf16 v[224:227], v[100:103], v[192:195], v[224:227]
    ds_read_b128 v[192:195], v234 offset:576
    s_waitcnt lgkmcnt(7)
    v_mfma_f32_16x16x32_bf16 v[220:223], v[24:27], v[196:199], v[220:223]
    v_mfma_f32_16x16x32_bf16 v[224:227], v[104:107], v[196:199], v[224:227]
    ds_read_b128 v[196:199], v234 offset:640
    s_waitcnt lgkmcnt(7)
    v_mfma_f32_16x16x32_bf16 v[220:223], v[28:31], v[200:203], v[220:223]
    v_mfma_f32_16x16x32_bf16 v[224:227], v[108:111], v[200:203], v[224:227]
    ds_read_b128 v[200:203], v234 offset:704
    s_waitcnt lgkmcnt(7)
    v_mfma_f32_16x16x32_bf16 v[220:223], v[32:35], v[204:207], v[220:223]
    v_mfma_f32_16x16x32_bf16 v[224:227], v[112:115], v[204:207], v[224:227]
    ds_read_b128 v[204:207], v234 offset:768
    s_waitcnt lgkmcnt(7)
    v_mfma_f32_16x16x32_bf16 v[220:223], v[36:39], v[208:211], v[220:223]
    v_mfma_f32_16x16x32_bf16 v[224:227], v[116:119], v[208:211], v[224:227]
    ds_read_b128 v[208:211], v234 offset:832
    s_waitcnt lgkmcnt(7)
    v_mfma_f32_16x16x32_bf16 v[220:223], v[40:43], v[212:215], v[220:223]
    v_mfma_f32_16x16x32_bf16 v[224:227], v[120:123], v[212:215], v[224:227]
    ds_read_b128 v[212:215], v234 offset:896
    s_waitcnt lgkmcnt(7)
    v_mfma_f32_16x16x32_bf16 v[220:223], v[44:47], v[216:219], v[220:223]
    v_mfma_f32_16x16x32_bf16 v[224:227], v[124:127], v[216:219], v[224:227]
    ds_read_b128 v[216:219], v234 offset:960
    s_waitcnt lgkmcnt(7)
    v_mfma_f32_16x16x32_bf16 v[220:223], v[48:51], v[188:191], v[220:223]
    v_mfma_f32_16x16x32_bf16 v[224:227], v[128:131], v[188:191], v[224:227]
    ds_read_b128 v[188:191], v234 offset:1024
    s_waitcnt lgkmcnt(7)
    v_mfma_f32_16x16x32_bf16 v[220:223], v[52:55], v[192:195], v[220:223]
    v_mfma_f32_16x16x32_bf16 v[224:227], v[132:135], v[192:195], v[224:227]
    ds_read_b128 v[192:195], v234 offset:1088
    s_waitcnt lgkmcnt(7)
    v_mfma_f32_16x16x32_bf16 v[220:223], v[56:59], v[196:199], v[220:223]
    v_mfma_f32_16x16x32_bf16 v[224:227], v[136:139], v[196:199], v[224:227]
    ds_read_b128 v[196:199], v234 offset:1152
    s_waitcnt lgkmcnt(7)
    v_mfma_f32_16x16x32_bf16 v[220:223], v[60:63], v[200:203], v[220:223]
    v_mfma_f32_16x16x32_bf16 v[224:227], v[140:143], v[200:203], v[224:227]
    ds_read_b128 v[200:203], v234 offset:1216
    s_waitcnt lgkmcnt(7)
    v_mfma_f32_16x16x32_bf16 v[220:223], v[64:67], v[204:207], v[220:223]
    v_mfma_f32_16x16x32_bf16 v[224:227], v[144:147], v[204:207], v[224:227]
    s_waitcnt lgkmcnt(6)
    v_mfma_f32_16x16x32_bf16 v[220:223], v[68:71], v[208:211], v[220:223]
    v_mfma_f32_16x16x32_bf16 v[224:227], v[148:151], v[208:211], v[224:227]
    s_waitcnt lgkmcnt(5)
    v_mfma_f32_16x16x32_bf16 v[220:223], v[72:75], v[212:215], v[220:223]
    v_mfma_f32_16x16x32_bf16 v[224:227], v[152:155], v[212:215], v[224:227]
    s_waitcnt lgkmcnt(4)
    v_mfma_f32_16x16x32_bf16 v[220:223], v[76:79], v[216:219], v[220:223]
    v_mfma_f32_16x16x32_bf16 v[224:227], v[156:159], v[216:219], v[224:227]
    s_waitcnt lgkmcnt(3)
    v_mfma_f32_16x16x32_bf16 v[220:223], v[80:83], v[188:191], v[220:223]
    v_mfma_f32_16x16x32_bf16 v[224:227], v[160:163], v[188:191], v[224:227]
    s_waitcnt lgkmcnt(2)
    v_mfma_f32_16x16x32_bf16 v[220:223], v[84:87], v[192:195], v[220:223]
    v_mfma_f32_16x16x32_bf16 v[224:227], v[164:167], v[192:195], v[224:227]
    s_waitcnt lgkmcnt(1)
    v_mfma_f32_16x16x32_bf16 v[220:223], v[88:91], v[196:199], v[220:223]
    v_mfma_f32_16x16x32_bf16 v[224:227], v[168:171], v[196:199], v[224:227]
    s_waitcnt lgkmcnt(0)
    v_mfma_f32_16x16x32_bf16 v[220:223], v[92:95], v[200:203], v[220:223]
    v_mfma_f32_16x16x32_bf16 v[224:227], v[172:175], v[200:203], v[224:227]
    s_mov_b32 s3, 1048576
K_FGDN:
    ds_read_b32 v2, v12 offset:52
    s_sleep 1
    s_sub_u32 s3, s3, 1
    s_waitcnt lgkmcnt(0)
    v_readfirstlane_b32 s33, v2
    s_nop 3
    s_cselect_b32 s33, 3, s33
    s_cmp_lt_u32 s33, 3
    s_cbranch_scc1 K_FGDN
    ds_read_b64_tr_b16 v[16:17], v238 offset:0
    ds_read_b64_tr_b16 v[18:19], v238 offset:2048
    ds_read_b64_tr_b16 v[20:21], v239 offset:0
    ds_read_b64_tr_b16 v[22:23], v239 offset:2048
    ds_read_b64_tr_b16 v[24:25], v240 offset:0
    ds_read_b64_tr_b16 v[26:27], v240 offset:2048
    ds_read_b64_tr_b16 v[28:29], v241 offset:0
    ds_read_b64_tr_b16 v[30:31], v241 offset:2048
    ds_read_b64_tr_b16 v[32:33], v238 offset:4096
    ds_read_b64_tr_b16 v[34:35], v238 offset:6144
    ds_read_b64_tr_b16 v[36:37], v239 offset:4096
    ds_read_b64_tr_b16 v[38:39], v239 offset:6144
    ds_read_b64_tr_b16 v[40:41], v240 offset:4096
    ds_read_b64_tr_b16 v[42:43], v240 offset:6144
    v_cvt_pk_bf16_f32 v221, v220, v221
    v_lshlrev_b32 v220, 16, v221
    v_and_b32 v221, 0xffff0000, v221
    v_cvt_pk_bf16_f32 v223, v222, v223
    v_lshlrev_b32 v222, 16, v223
    v_and_b32 v223, 0xffff0000, v223
    v_cvt_pk_bf16_f32 v225, v224, v225
    v_lshlrev_b32 v224, 16, v225
    v_and_b32 v225, 0xffff0000, v225
    v_cvt_pk_bf16_f32 v227, v226, v227
    v_lshlrev_b32 v226, 16, v227
    v_and_b32 v227, 0xffff0000, v227
    v_mul_f32 v188, 0xbfb8aa3b, v220
    v_mul_f32 v189, 0xbfb8aa3b, v221
    v_mul_f32 v190, 0xbfb8aa3b, v222
    v_mul_f32 v191, 0xbfb8aa3b, v223
    v_exp_f32 v188, v188
    v_exp_f32 v189, v189
    v_exp_f32 v190, v190
    v_exp_f32 v191, v191
    v_add_f32 v188, 1.0, v188
    v_add_f32 v189, 1.0, v189
    v_add_f32 v190, 1.0, v190
    v_add_f32 v191, 1.0, v191
    v_rcp_f32 v188, v188
    v_rcp_f32 v189, v189
    v_rcp_f32 v190, v190
    v_rcp_f32 v191, v191
    v_mul_f32 v220, v220, v188
    v_mul_f32 v221, v221, v189
    v_mul_f32 v222, v222, v190
    v_mul_f32 v223, v223, v191
    v_cvt_pk_bf16_f32 v221, v220, v221
    v_lshlrev_b32 v220, 16, v221
    v_and_b32 v221, 0xffff0000, v221
    v_cvt_pk_bf16_f32 v223, v222, v223
    v_lshlrev_b32 v222, 16, v223
    v_and_b32 v223, 0xffff0000, v223
    v_mul_f32 v220, v220, v224
    v_mul_f32 v221, v221, v225
    v_mul_f32 v222, v222, v226
    v_mul_f32 v223, v223, v227
    v_cvt_pk_bf16_f32 v228, v220, v221
    v_cvt_pk_bf16_f32 v229, v222, v223
    ds_write_b64 v235, v[228:229]
    s_mov_b64 exec, 1
    ds_add_u32 v12, v13 offset:52
    s_mov_b64 exec, -1
    ds_read_b64_tr_b16 v[44:45], v241 offset:4096
    ds_read_b64_tr_b16 v[46:47], v241 offset:6144
    ds_read_b64_tr_b16 v[48:49], v238 offset:8192
    ds_read_b64_tr_b16 v[50:51], v238 offset:10240
    ds_read_b64_tr_b16 v[52:53], v239 offset:8192
    ds_read_b64_tr_b16 v[54:55], v239 offset:10240
    ds_read_b64_tr_b16 v[56:57], v240 offset:8192
    ds_read_b64_tr_b16 v[58:59], v240 offset:10240
    ds_read_b64_tr_b16 v[60:61], v241 offset:8192
    ds_read_b64_tr_b16 v[62:63], v241 offset:10240
    ds_read_b64_tr_b16 v[64:65], v238 offset:12288
    ds_read_b64_tr_b16 v[66:67], v238 offset:14336
    ds_read_b64_tr_b16 v[68:69], v239 offset:12288
    ds_read_b64_tr_b16 v[70:71], v239 offset:14336
    ds_read_b64_tr_b16 v[72:73], v240 offset:12288
    ds_read_b64_tr_b16 v[74:75], v240 offset:14336
    ds_read_b64_tr_b16 v[76:77], v241 offset:12288
    ds_read_b64_tr_b16 v[78:79], v241 offset:14336
    ds_read_b64_tr_b16 v[80:81], v238 offset:16384
    ds_read_b64_tr_b16 v[82:83], v238 offset:18432
    ds_read_b64_tr_b16 v[84:85], v239 offset:16384
    ds_read_b64_tr_b16 v[86:87], v239 offset:18432
    ds_read_b64_tr_b16 v[88:89], v240 offset:16384
    ds_read_b64_tr_b16 v[90:91], v240 offset:18432
    ds_read_b64_tr_b16 v[92:93], v241 offset:16384
    ds_read_b64_tr_b16 v[94:95], v241 offset:18432
    s_mov_b32 s3, 1048576
K_FGP:
    ds_read_b32 v2, v12 offset:52
    s_sleep 0
    s_sub_u32 s3, s3, 1
    s_waitcnt lgkmcnt(0)
    v_readfirstlane_b32 s33, v2
    s_nop 3
    s_cselect_b32 s33, 5, s33
    s_cmp_lt_u32 s33, 5
    s_cbranch_scc1 K_FGP
    ds_read_b128 v[228:231], v236
    s_waitcnt lgkmcnt(0)
    v_mfma_f32_16x16x32_bf16 v[96:99], v[16:19], v[228:231], 0
    v_mfma_f32_16x16x32_bf16 v[100:103], v[20:23], v[228:231], 0
    v_mfma_f32_16x16x32_bf16 v[104:107], v[24:27], v[228:231], 0
    v_mfma_f32_16x16x32_bf16 v[108:111], v[28:31], v[228:231], 0
    v_mfma_f32_16x16x32_bf16 v[112:115], v[32:35], v[228:231], 0
    v_mfma_f32_16x16x32_bf16 v[116:119], v[36:39], v[228:231], 0
    v_mfma_f32_16x16x32_bf16 v[120:123], v[40:43], v[228:231], 0
    v_mfma_f32_16x16x32_bf16 v[124:127], v[44:47], v[228:231], 0
    v_mfma_f32_16x16x32_bf16 v[128:131], v[48:51], v[228:231], 0
    v_mfma_f32_16x16x32_bf16 v[132:135], v[52:55], v[228:231], 0
    v_mfma_f32_16x16x32_bf16 v[136:139], v[56:59], v[228:231], 0
    v_mfma_f32_16x16x32_bf16 v[140:143], v[60:63], v[228:231], 0
    v_mfma_f32_16x16x32_bf16 v[144:147], v[64:67], v[228:231], 0
    v_mfma_f32_16x16x32_bf16 v[148:151], v[68:71], v[228:231], 0
    v_mfma_f32_16x16x32_bf16 v[152:155], v[72:75], v[228:231], 0
    v_mfma_f32_16x16x32_bf16 v[156:159], v[76:79], v[228:231], 0
    v_mfma_f32_16x16x32_bf16 v[160:163], v[80:83], v[228:231], 0
    v_mfma_f32_16x16x32_bf16 v[164:167], v[84:87], v[228:231], 0
    v_mfma_f32_16x16x32_bf16 v[168:171], v[88:91], v[228:231], 0
    v_mfma_f32_16x16x32_bf16 v[172:175], v[92:95], v[228:231], 0
    s_mov_b32 exec_lo, 0x00030003
    s_mov_b32 exec_hi, 0x00030003
    buffer_store_dwordx4 v[96:99], v237, s[64:67], s72 offen offset:0 sc1
    buffer_store_dwordx4 v[100:103], v237, s[64:67], s72 offen offset:64 sc1
    buffer_store_dwordx4 v[104:107], v237, s[64:67], s72 offen offset:128 sc1
    buffer_store_dwordx4 v[108:111], v237, s[64:67], s72 offen offset:192 sc1
    buffer_store_dwordx4 v[112:115], v237, s[64:67], s72 offen offset:256 sc1
    buffer_store_dwordx4 v[116:119], v237, s[64:67], s72 offen offset:320 sc1
    buffer_store_dwordx4 v[120:123], v237, s[64:67], s72 offen offset:384 sc1
    buffer_store_dwordx4 v[124:127], v237, s[64:67], s72 offen offset:448 sc1
    buffer_store_dwordx4 v[128:131], v237, s[64:67], s72 offen offset:512 sc1
    buffer_store_dwordx4 v[132:135], v237, s[64:67], s72 offen offset:576 sc1
    buffer_store_dwordx4 v[136:139], v237, s[64:67], s72 offen offset:640 sc1
    buffer_store_dwordx4 v[140:143], v237, s[64:67], s72 offen offset:704 sc1
    buffer_store_dwordx4 v[144:147], v237, s[64:67], s72 offen offset:768 sc1
    buffer_store_dwordx4 v[148:151], v237, s[64:67], s72 offen offset:832 sc1
    buffer_store_dwordx4 v[152:155], v237, s[64:67], s72 offen offset:896 sc1
    buffer_store_dwordx4 v[156:159], v237, s[64:67], s72 offen offset:960 sc1
    buffer_store_dwordx4 v[160:163], v237, s[64:67], s72 offen offset:1024 sc1
    buffer_store_dwordx4 v[164:167], v237, s[64:67], s72 offen offset:1088 sc1
    buffer_store_dwordx4 v[168:171], v237, s[64:67], s72 offen offset:1152 sc1
    buffer_store_dwordx4 v[172:175], v237, s[64:67], s72 offen offset:1216 sc1
    s_mov_b64 exec, -1
    s_lshl_b32 s3, s44, 5
    s_lshl3_add_u32 s3, s73, s3
    s_add_u32 s3, s3, 565248
    v_mov_b32 v2, s3
    v_mov_b32 v228, 1
    v_mov_b32 v229, 1
    s_waitcnt vmcnt(0)
    s_mov_b64 exec, 1
    global_store_dwordx2 v2, v[228:229], s[10:11] sc1
    s_mov_b64 exec, -1
    s_branch K_P2_HELP
K_CODE_END:
.section .rodata,"a"
.p2align 6
.amdhsa_kernel gated_mix__sliding_local_dilated__moe_arch_mod__prompt_kernel
  .amdhsa_next_free_vgpr 248
  .amdhsa_next_free_sgpr 79
  .amdhsa_accum_offset 248
  .amdhsa_group_segment_fixed_size 0
  .amdhsa_kernarg_size 96
  .amdhsa_user_sgpr_count 2
  .amdhsa_user_sgpr_kernarg_segment_ptr 1
  .amdhsa_system_sgpr_workgroup_id_x 1
.end_amdhsa_kernel
```

```asm
; @launch grid=(256,1,1) block=(512,1,1) lds=163840
.amdgcn_target "amdgcn-amd-amdhsa--gfx950"
.text
.p2align 12
.p2align 8
.globl gated_mix__sliding_local_dilated__moe_arch_mod__prompt_kernel
.type gated_mix__sliding_local_dilated__moe_arch_mod__prompt_kernel,@function
gated_mix__sliding_local_dilated__moe_arch_mod__prompt_kernel:
    s_cmp_ge_u32 s2, 256
    s_cbranch_scc1 K_EXIT
    s_load_dwordx2 s[12:13], s[0:1], 0
    s_load_dwordx2 s[16:17], s[0:1], 8
    v_readfirstlane_b32 s30, v0
    s_load_dwordx4 s[8:11], s[0:1], 80
    s_load_dwordx2 s[24:25], s[0:1], 16
    s_load_dwordx2 s[6:7], s[0:1], 72
    s_and_b32 s28, s2, 7
    v_and_b32 v1, 63, v0
    s_mov_b32 s14, 0x280000
    s_mov_b32 s15, 0x20000
    s_lshr_b32 s30, s30, 6
    s_cmp_lt_u32 s2, 64
    s_cbranch_scc1 K_SLOW
    s_cmp_lt_u32 s30, 4
    s_cbranch_scc1 K_FAST
K_SLOW:
    s_getpc_b64 s[38:39]
K_PC:
    s_bfe_u32 s3, s2, 0x30003
    s_mul_i32 s3, s3, ((K_CODE_END-gated_mix__sliding_local_dilated__moe_arch_mod__prompt_kernel+1023)/1024)
    s_sub_u32 s38, s38, K_PC-gated_mix__sliding_local_dilated__moe_arch_mod__prompt_kernel
    s_subb_u32 s39, s39, 0
    v_subrev_u32 v3, 256, v0
    v_add_u32 v2, s3, v3
    v_lshlrev_b32 v2, 7, v2
    v_min_u32 v2, K_CODE_END-gated_mix__sliding_local_dilated__moe_arch_mod__prompt_kernel-4, v2
    v_cmp_gt_u32 vcc, ((K_CODE_END-gated_mix__sliding_local_dilated__moe_arch_mod__prompt_kernel+1023)/1024), v3
    s_and_saveexec_b64 s[4:5], vcc
    s_cbranch_execz K_NOPF
    global_load_dword v6, v2, s[38:39]
K_NOPF:
    s_mov_b64 exec, -1
    v_mov_b32 v2, 0
    v_mov_b32 v3, 158752
    ds_write2_b32 v3, v2, v2 offset0:0 offset1:1
    ds_write2_b32 v3, v2, v2 offset0:2 offset1:3
    ds_write2_b32 v3, v2, v2 offset0:4 offset1:5
    ds_write2_b32 v3, v2, v2 offset0:6 offset1:7
    ds_write2_b32 v3, v2, v2 offset0:8 offset1:9
    s_mov_b32 s43, 1
    s_lshl_b32 s3, s30, 8
    s_add_u32 s3, s3, s2
    s_lshr_b32 s3, s3, 3
    s_cmp_lg_u32 s3, 160
    s_cbranch_scc1 K_COMMON
    s_mul_i32 s3, s2, 6144
    s_add_u32 s3, s3, 527360
    v_lshl_add_u32 v6, v1, 4, s3
    v_mov_b64 v[28:29], 0
    v_mov_b64 v[30:31], 0
    s_waitcnt lgkmcnt(0)
    global_store_dwordx4 v6, v[28:31], s[10:11] offset:-3072 sc1
    global_store_dwordx4 v6, v[28:31], s[10:11] offset:-2048 sc1
    global_store_dwordx4 v6, v[28:31], s[10:11] offset:-1024 sc1
    global_store_dwordx4 v6, v[28:31], s[10:11] offset:0 sc1
    global_store_dwordx4 v6, v[28:31], s[10:11] offset:1024 sc1
    global_store_dwordx4 v6, v[28:31], s[10:11] offset:2048 sc1
    s_lshl_b32 s3, s2, 2
    v_mov_b32 v2, s3
    v_mov_b32 v3, 1
    s_mov_b64 exec, 1
    s_waitcnt vmcnt(0)
    global_store_dword v2, v3, s[8:9] offset:192 sc1
    s_mov_b64 exec, -1
    s_branch K_COMMON
K_FAST:
    s_lshr_b32 s32, s2, 1
    s_and_b32 s32, s32, 28
    v_lshrrev_b32 v3, 4, v1
    s_lshr_b32 s3, s2, 6
    s_mov_b32 s59, 0x98450216
    s_cmp_eq_u32 s3, 2
    s_cselect_b32 s59, 0x70238164, s59
    v_and_b32 v4, 7, v1
    s_cmp_eq_u32 s3, 3
    s_cselect_b32 s59, 0x65703481, s59
    v_lshrrev_b32 v2, 3, v1
    s_lshr_b32 s59, s59, s32
    s_and_b32 s59, s59, 15
    v_xor_b32 v4, v4, v3
    s_add_u32 s59, s59, s28
    s_cmp_ge_u32 s59, 10
    v_mul_u32_u24 v2, 1280, v2
    s_cselect_b32 s33, 10, 0
    s_sub_u32 s59, s59, s33
    s_lshr_b32 s53, s28, 1
    v_lshl_add_u32 v44, v4, 4, v2
    s_mul_i32 s53, s53, 675840
    s_mul_i32 s3, s3, 225280
    v_xor_b32 v45, 64, v44
    s_add_u32 s53, s53, s3
    s_mul_i32 s54, s30, 61440
    s_add_u32 s53, s53, s54
    s_sub_u32 s53, s53, 245760
    s_mul_i32 s55, s30, 6144
    s_add_u32 s55, s55, 40960
    s_lshl_b32 s57, s59, 7
    s_add_u32 s57, s57, s53
    s_waitcnt lgkmcnt(0)
    s_add_u32 m0, s55, 0
    s_max_i32 s60, s57, 0
    buffer_load_dwordx4 v44, s[12:15], s60 offen lds
    s_add_u32 s60, s57, 10240
    s_add_u32 m0, s55, 1024
    s_max_i32 s60, s60, 0
    buffer_load_dwordx4 v45, s[12:15], s60 offen lds
    s_add_u32 m0, s55, 2048
    s_add_u32 s60, s57, 20480
    buffer_load_dwordx4 v44, s[12:15], s60 offen lds
    s_add_u32 m0, s55, 3072
    s_add_u32 s60, s57, 30720
    buffer_load_dwordx4 v45, s[12:15], s60 offen lds
    s_add_u32 m0, s55, 4096
    s_add_u32 s60, s57, 40960
    buffer_load_dwordx4 v44, s[12:15], s60 offen lds
    s_add_u32 m0, s55, 5120
    s_add_u32 s60, s57, 51200
    buffer_load_dwordx4 v45, s[12:15], s60 offen lds
    v_lshlrev_b32 v2, 1, v3
    s_lshr_b32 s32, 0x64317520, s32
    v_sub_u32 v2, v1, v2
    s_and_b32 s32, s32, 7
    v_and_b32 v2, 15, v2
    s_and_b32 s3, s28, 1
    v_mul_u32_u24 v3, 3840, v3
    s_lshl3_add_u32 s32, s3, s32
    v_mul_u32_u24 v4, 13, v2
    s_mul_i32 s3, s32, 80
    v_lshrrev_b32 v4, 6, v4
    s_add_u32 s54, s54, s3
    v_mul_u32_u24 v4, 1200, v4
    s_lshl_b32 s56, s30, 12
    v_lshl_add_u32 v4, v2, 4, v4
    s_add_u32 s56, s56, 65536
    v_add_u32 v5, 1, v2
    s_mov_b32 s18, 0x258000
    v_and_b32 v5, 16, v5
    s_mov_b32 s19, 0x20000
    v_lshl_add_u32 v4, v5, 24, v4
    v_add_u32 v46, v3, v4
    s_mul_i32 s58, s59, 245760
    s_add_u32 s58, s58, s54
    s_add_u32 s59, s59, 1
    s_cmp_eq_u32 s59, 10
    s_cselect_b32 s59, 0, s59
    s_add_u32 m0, s56, 0
    s_add_u32 s60, s58, 0
    buffer_load_dwordx4 v46, s[16:19], s60 offen lds
    s_add_u32 m0, s56, 1024
    s_add_u32 s60, s58, 15360
    buffer_load_dwordx4 v46, s[16:19], s60 offen lds
    v_xor_b32 v2, 8, v2
    v_mul_u32_u24 v4, 13, v2
    v_lshrrev_b32 v4, 6, v4
    v_mul_u32_u24 v4, 1200, v4
    v_lshl_add_u32 v4, v2, 4, v4
    v_add_u32 v5, 1, v2
    v_and_b32 v5, 16, v5
    v_lshl_add_u32 v4, v5, 24, v4
    v_add_u32 v47, v3, v4
    s_add_u32 m0, s56, 2048
    s_add_u32 s60, s58, 30720
    buffer_load_dwordx4 v47, s[16:19], s60 offen lds
    s_add_u32 m0, s56, 3072
    s_add_u32 s60, s58, 46080
    buffer_load_dwordx4 v47, s[16:19], s60 offen lds
    s_mov_b32 s3, 40960
    s_cmp_ge_u32 s55, 81920
    s_cselect_b32 s60, -81920, s3
    s_add_u32 s55, s55, s60
    s_add_u32 s56, s56, s60
    s_lshl_b32 s57, s59, 7
    s_add_u32 s57, s57, s53
    s_mul_i32 s58, s59, 245760
    s_add_u32 s58, s58, s54
    s_add_u32 s59, s59, 1
    s_cmp_eq_u32 s59, 10
    s_cselect_b32 s59, 0, s59
    s_add_u32 m0, s56, 0
    s_add_u32 s60, s58, 0
    buffer_load_dwordx4 v46, s[16:19], s60 offen lds
    s_add_u32 m0, s55, 0
    s_max_i32 s60, s57, 0
    buffer_load_dwordx4 v44, s[12:15], s60 offen lds
    s_add_u32 m0, s56, 1024
    s_add_u32 s60, s58, 15360
    buffer_load_dwordx4 v46, s[16:19], s60 offen lds
    s_add_u32 s60, s57, 10240
    s_add_u32 m0, s55, 1024
    s_max_i32 s60, s60, 0
    buffer_load_dwordx4 v45, s[12:15], s60 offen lds
    s_add_u32 m0, s55, 2048
    s_add_u32 s60, s57, 20480
    buffer_load_dwordx4 v44, s[12:15], s60 offen lds
    s_mov_b32 s52, s30
    s_mov_b32 s43, 0
K_COMMON:
    v_mov_b32 v7, 0
    s_lshr_b32 s29, s2, 3
    s_xor_b32 s30, s30, 4
    s_mov_b32 s26, 0xc8000
    s_mov_b32 s27, 0x20000
    s_lshr_b32 s34, s29, 3
    s_lshl_b32 s34, s34, 2
    s_and_b32 s3, s29, 3
    s_add_u32 s34, s34, s3
    s_add_u32 s34, s34, 4
    s_bitcmp1_b32 s29, 2
    s_cselect_b32 s34, -1, s34
    s_cmp_lt_u32 s29, 8
    s_cselect_b32 s34, s29, s34
    s_lshl_b32 s40, s28, 1
    s_cmp_ge_u32 s34, 10
    s_addc_u32 s40, s40, 0
    s_sub_u32 s41, s34, 10
    s_cmp_ge_u32 s34, 10
    s_cselect_b32 s41, s41, s34
    s_mul_i32 s42, s28, 20
    s_add_u32 s42, s42, s34
    s_and_b32 s42, s42, 255
    s_lshl_b32 s42, s42, 8
    s_add_u32 s42, s42, 524288
    s_cmp_lt_u32 s29, 8
    s_cbranch_scc1 K_AUX
    s_lshr_b32 s31, s28, 1
    s_mul_i32 s31, s31, 3
    s_lshr_b32 s3, s29, 3
    s_add_u32 s31, s31, s3
    s_sub_u32 s31, s31, 1
    s_and_b32 s35, s29, 3
    s_and_b32 s3, s29, 4
    s_lshl_b32 s3, s3, 1
    s_add_u32 s35, s35, s3
    s_and_b32 s3, s28, 1
    s_lshl_b32 s3, s3, 2
    s_add_u32 s35, s35, s3
    v_and_b32 v9, 15, v1
    v_lshrrev_b32 v10, 4, v1
    v_bfe_u32 v11, v1, 2, 2
    v_and_b32 v12, 3, v1
    s_waitcnt lgkmcnt(0)
    s_add_u32 s20, s10, 0x100000
    s_addc_u32 s21, s11, 0
    s_mov_b32 s22, 0x280000
    s_mov_b32 s23, 0x20000
    s_and_b32 s3, s30, 3
    s_mul_i32 s3, s3, 3
    s_lshr_b32 s33, s30, 2
    s_lshl1_add_u32 s3, s33, s3
    s_mul_i32 s44, s31, 11
    s_add_u32 s44, s44, s3
    s_mul_i32 s3, s3, 4352
    s_add_u32 s3, s3, 81920
    v_mul_u32_u24 v14, 272, v9
    v_lshl_add_u32 v13, v10, 3, v14
    v_add_u32 v13, s3, v13
    v_add3_u32 v14, v14, 32, s3
    v_cmp_eq_u32 vcc, 0, v10
    v_add_u32 v2, 208, v14
    v_add_u32 v3, 0, v14
    v_add_u32 v4, 40, v14
    v_cndmask_b32 v19, v2, v3, vcc
    v_cndmask_b32 v20, v2, v4, vcc
    v_lshl_add_u32 v15, v10, 2, v11
    v_mul_u32_u24 v15, 272, v15
    v_add_u32 v5, s3, v15
    v_lshl_add_u32 v15, v12, 3, v5
    v_add_u32 v2, 240, v5
    v_add_u32 v3, 192, v5
    v_add_u32 v4, 232, v5
    v_cmp_eq_u32 vcc, 0, v12
    s_nop 1
    v_cndmask_b32 v21, v2, v3, vcc
    v_cmp_eq_u32 vcc, 1, v12
    s_nop 1
    v_cndmask_b32 v22, v2, v4, vcc
    v_cmp_eq_u32 vcc, 2, v12
    s_nop 1
    v_cndmask_b32 v23, v2, v3, vcc
    v_cmp_eq_u32 vcc, 3, v12
    s_nop 1
    v_cndmask_b32 v24, v2, v4, vcc
    s_lshl_b32 s3, s35, 10
    v_lshl_add_u32 v16, v1, 4, s3
    s_lshl_b32 s3, s35, 8
    s_add_u32 s3, s3, 16384
    v_lshl_add_u32 v17, v9, 4, s3
    v_and_b32 v2, 1, v10
    v_lshl_add_u32 v17, v2, 3, v17
    s_cmp_lt_u32 s30, 4
    s_cselect_b32 s3, 0, 0x800000
    s_add_u32 s3, s3, 20480
    v_lshrrev_b32 v2, 1, v10
    v_mad_u32_u24 v17, v2, s3, v17
    s_mul_i32 s50, s44, 20480
    s_add_u32 s51, s50, 20480
    v_mov_b32 v18, 0xf149f2ca
    v_lshlrev_b32 v2, 2, v10
    v_sub_u32 v2, v9, v2
    s_cmp_eq_u32 s44, 0
    s_cselect_b32 s3, 0xf149f2ca, 0
    v_subrev_u32 v3, 0, v2
    v_and_b32 v4, 0x80000001, v3
    v_cmp_eq_u32 vcc, 0, v4
    s_nop 1
    v_cndmask_b32 v32, v18, 0, vcc
    v_cmp_eq_u32 vcc, 0x80000000, v4
    s_nop 1
    v_cndmask_b32 v28, v18, 0, vcc
    v_add_f32 v36, s3, v28
    v_subrev_u32 v3, 1, v2
    v_and_b32 v4, 0x80000001, v3
    v_cmp_eq_u32 vcc, 0, v4
    s_nop 1
    v_cndmask_b32 v33, v18, 0, vcc
    v_cmp_eq_u32 vcc, 0x80000000, v4
    s_nop 1
    v_cndmask_b32 v29, v18, 0, vcc
    v_add_f32 v37, s3, v29
    v_subrev_u32 v3, 2, v2
    v_and_b32 v4, 0x80000001, v3
    v_cmp_eq_u32 vcc, 0, v4
    s_nop 1
    v_cndmask_b32 v34, v18, 0, vcc
    v_cmp_eq_u32 vcc, 0x80000000, v4
    s_nop 1
    v_cndmask_b32 v30, v18, 0, vcc
    v_add_f32 v38, s3, v30
    v_subrev_u32 v3, 3, v2
    v_and_b32 v4, 0x80000001, v3
    v_cmp_eq_u32 vcc, 0, v4
    s_nop 1
    v_cndmask_b32 v35, v18, 0, vcc
    v_cmp_eq_u32 vcc, 0x80000000, v4
    s_nop 1
    v_cndmask_b32 v31, v18, 0, vcc
    v_add_f32 v39, s3, v31
    v_mov_b32 v3, 0x0c0c0c0c
    v_mov_b32 v4, 0xc0c0100
    v_cmp_eq_u32 vcc, 0, v28
    v_mov_b32 v5, 0x1000c0c
    s_nop 0
    v_cndmask_b32 v3, v3, v4, vcc
    v_cmp_eq_u32 vcc, 0, v29
    s_nop 1
    v_cndmask_b32 v40, v3, v5, vcc
    v_mov_b32 v3, 0x0c0c0c0c
    v_mov_b32 v4, 0xc0c0302
    v_cmp_eq_u32 vcc, 0, v30
    v_mov_b32 v5, 0x3020c0c
    s_nop 0
    v_cndmask_b32 v3, v3, v4, vcc
    v_cmp_eq_u32 vcc, 0, v31
    s_nop 1
    v_cndmask_b32 v41, v3, v5, vcc
    v_mov_b32 v3, 0x0c0c0c0c
    v_mov_b32 v4, 0xc0c0100
    v_cmp_eq_u32 vcc, 0, v32
    v_mov_b32 v5, 0x1000c0c
    s_nop 0
    v_cndmask_b32 v3, v3, v4, vcc
    v_cmp_eq_u32 vcc, 0, v33
    s_nop 1
    v_cndmask_b32 v42, v3, v5, vcc
    v_mov_b32 v3, 0x0c0c0c0c
    v_mov_b32 v4, 0xc0c0302
    v_cmp_eq_u32 vcc, 0, v34
    v_mov_b32 v5, 0x3020c0c
    s_nop 0
    v_cndmask_b32 v3, v3, v4, vcc
    v_cmp_eq_u32 vcc, 0, v35
    s_nop 1
    v_cndmask_b32 v43, v3, v5, vcc
    s_mov_b32 s46, 0x3fb8aa3b
    s_mov_b32 s47, s46
    s_mov_b32 s48, 0x3e64f92e
    s_mov_b32 s49, s48
    s_mul_i32 s3, s31, 11
    s_add_u32 s33, s3, 10
    s_lshr_b32 s3, s3, 3
    s_lshr_b32 s33, s33, 3
    s_min_u32 s33, s33, 15
    s_sub_u32 s33, s33, s3
    s_add_u32 s33, s33, 1
    s_mul_i32 s33, s33, 10
    s_bfm_b32 s36, s33, 0
    v_mul_u32_u24 v2, 205, v1
    v_lshrrev_b32 v2, 11, v2
    v_add_u32 v2, s3, v2
    v_mul_u32_u24 v2, 1496, v2
    v_lshrrev_b32 v2, 11, v2
    v_sub_u32 v2, s31, v2
    v_and_b32 v2, 1, v2
    v_lshlrev_b32 v2, 6, v2
    v_lshl_add_u32 v2, v1, 8, v2
    s_mul_i32 s3, s3, 2560
    s_lshl_b32 s33, s35, 2
    s_add_u32 s3, s3, s33
    s_add_u32 s3, s3, 524288
    v_add_u32 v8, s3, v2
    s_cmp_eq_u32 s43, 1
    s_cbranch_scc1 K_CONS
    v_lshrrev_b32 v2, 3, v1
    v_mul_u32_u24 v2, 1280, v2
    v_lshrrev_b32 v3, 4, v1
    v_lshlrev_b32 v3, 1, v3
    v_and_b32 v4, 7, v1
    v_xor_b32 v3, v3, v4
    v_lshl_add_u32 v2, v3, 4, v2
    s_lshl_b32 s33, s41, 7
    v_add_u32 v18, s33, v2
    s_mov_b32 s61, 9
    s_mov_b32 s3, 40960
K_LOOP0:
    s_waitcnt vmcnt(5)
    s_barrier
    s_add_u32 m0, s56, 2048
    s_add_u32 s60, s58, 30720
    buffer_load_dwordx4 v47, s[16:19], s60 offen lds
    s_add_u32 m0, s55, 3072
    s_add_u32 s60, s57, 30720
    buffer_load_dwordx4 v45, s[12:15], s60 offen lds
    s_add_u32 m0, s56, 3072
    s_add_u32 s60, s58, 46080
    buffer_load_dwordx4 v47, s[16:19], s60 offen lds
    s_add_u32 m0, s55, 4096
    s_add_u32 s60, s57, 40960
    buffer_load_dwordx4 v44, s[12:15], s60 offen lds
    s_add_u32 m0, s55, 5120
    s_add_u32 s60, s57, 51200
    buffer_load_dwordx4 v45, s[12:15], s60 offen lds
    s_sub_u32 s61, s61, 1
    s_cmp_eq_u32 s61, 0
    s_cbranch_scc1 K_LOOPX
    s_cmp_ge_u32 s55, 81920
    s_cselect_b32 s60, -81920, s3
    s_add_u32 s55, s55, s60
    s_add_u32 s56, s56, s60
    s_lshl_b32 s57, s59, 7
    s_add_u32 s57, s57, s53
    s_mul_i32 s58, s59, 245760
    s_add_u32 s58, s58, s54
    s_add_u32 s59, s59, 1
    s_cmp_eq_u32 s59, 10
    s_cselect_b32 s59, 0, s59
    s_add_u32 m0, s56, 0
    s_add_u32 s60, s58, 0
    buffer_load_dwordx4 v46, s[16:19], s60 offen lds
    s_add_u32 m0, s55, 0
    s_max_i32 s60, s57, 0
    buffer_load_dwordx4 v44, s[12:15], s60 offen lds
    s_add_u32 m0, s56, 1024
    s_add_u32 s60, s58, 15360
    buffer_load_dwordx4 v46, s[16:19], s60 offen lds
    s_add_u32 s60, s57, 10240
    s_add_u32 m0, s55, 1024
    s_max_i32 s60, s60, 0
    buffer_load_dwordx4 v45, s[12:15], s60 offen lds
    s_add_u32 m0, s55, 2048
    s_add_u32 s60, s57, 20480
    buffer_load_dwordx4 v44, s[12:15], s60 offen lds
    s_branch K_LOOP0
K_LOOPX:
    v_and_b32 v2, 7, v1
    v_lshlrev_b32 v2, 2, v2
    s_waitcnt vmcnt(0)
    s_barrier
    s_cmp_lt_u32 s30, 6
    s_cbranch_scc1 K_NOSMP
    global_load_dword v7, v2, s[8:9] offset:192 sc1
K_NOSMP:
    s_cmp_eq_u32 s34, -1
    s_cbranch_scc1 K_JOIN_S
    s_cmp_lg_u32 s30, 7
    s_cbranch_scc1 K_WOE
    s_barrier
K_WOE:
    s_lshl_b32 s57, s52, 2
    s_lshr_b32 s57, 0x7520, s57
    s_and_b32 s57, s57, 7
    s_mul_i32 s57, s57, 51200
    s_mul_i32 s58, s52, 5120
    s_add_u32 s3, s57, 0
    s_add_u32 m0, s58, 0
    s_nop 0
    buffer_load_dwordx4 v18, s[24:27], s3 offen lds
    s_add_u32 s3, s57, 10240
    s_add_u32 m0, s58, 1024
    s_nop 0
    buffer_load_dwordx4 v18, s[24:27], s3 offen lds
    s_add_u32 s3, s57, 20480
    s_add_u32 m0, s58, 2048
    s_nop 0
    buffer_load_dwordx4 v18, s[24:27], s3 offen lds
    s_add_u32 s3, s57, 30720
    s_add_u32 m0, s58, 3072
    s_nop 0
    buffer_load_dwordx4 v18, s[24:27], s3 offen lds
    s_add_u32 s3, s57, 40960
    s_add_u32 m0, s58, 4096
    s_nop 0
    buffer_load_dwordx4 v18, s[24:27], s3 offen lds
    s_add_u32 s3, s57, 409600
    s_add_u32 m0, s58, 20480
    s_nop 0
    buffer_load_dwordx4 v18, s[24:27], s3 offen lds
    s_add_u32 s3, s57, 419840
    s_add_u32 m0, s58, 21504
    s_nop 0
    buffer_load_dwordx4 v18, s[24:27], s3 offen lds
    s_add_u32 s3, s57, 430080
    s_add_u32 m0, s58, 22528
    s_nop 0
    buffer_load_dwordx4 v18, s[24:27], s3 offen lds
    s_add_u32 s3, s57, 440320
    s_add_u32 m0, s58, 23552
    s_nop 0
    buffer_load_dwordx4 v18, s[24:27], s3 offen lds
    s_add_u32 s3, s57, 450560
    s_add_u32 m0, s58, 24576
    s_nop 0
    buffer_load_dwordx4 v18, s[24:27], s3 offen lds
    s_cmp_lg_u32 s30, 7
    s_cbranch_scc1 K_JOIN_S
    s_mov_b32 s52, 0
K_XD:
    s_lshl_b32 s57, s40, 3
    s_lshl1_add_u32 s57, s52, s57
    s_mul_i32 s57, s57, 20480
    s_lshl_b32 s33, s41, 7
    s_add_u32 s57, s57, s33
    s_lshl_b32 s33, s52, 12
    s_add_u32 m0, s33, 140288
    s_add_u32 s3, s57, 0
    buffer_load_dwordx4 v44, s[12:15], s3 offen lds
    s_add_u32 m0, s33, 141312
    s_add_u32 s3, s57, 10240
    buffer_load_dwordx4 v45, s[12:15], s3 offen lds
    s_add_u32 m0, s33, 142336
    s_add_u32 s3, s57, 20480
    buffer_load_dwordx4 v44, s[12:15], s3 offen lds
    s_add_u32 m0, s33, 143360
    s_add_u32 s3, s57, 30720
    buffer_load_dwordx4 v45, s[12:15], s3 offen lds
    s_add_u32 s52, s52, 1
    s_cmp_lt_u32 s52, 4
    s_cbranch_scc1 K_XD
    s_branch K_W7
.p2align 12
K_CONS:
    s_lshr_b32 s52, s30, 1
    s_and_b32 s53, s30, 1
    v_lshrrev_b32 v2, 1, v9
    v_xor_b32 v2, v2, v10
    v_lshlrev_b32 v2, 4, v2
    v_lshl_add_u32 v2, v9, 7, v2
    s_mul_i32 s3, s52, 12288
    v_add_u32 v44, s3, v2
    v_xor_b32 v45, 64, v44
    v_add_u32 v46, 81920, v44
    v_add_u32 v47, 81920, v45
    v_and_b32 v2, 1, v10
    v_lshl_or_b32 v2, v2, 2, v11
    v_lshl_add_u32 v3, v10, 3, v11
    v_lshlrev_b32 v3, 8, v3
    v_lshl_add_u32 v3, v12, 3, v3
    v_add_u32 v3, 24576, v3
    s_lshl_b32 s3, s53, 2
    v_add_u32 v2, s3, v2
    v_add_u32 v4, 0, v2
    v_and_b32 v4, 7, v4
    v_lshl_add_u32 v48, v4, 5, v3
    v_add_u32 v52, 81920, v48
    v_add_u32 v4, 1, v2
    v_and_b32 v4, 7, v4
    v_lshl_add_u32 v49, v4, 5, v3
    v_add_u32 v53, 81920, v49
    v_add_u32 v4, 2, v2
    v_and_b32 v4, 7, v4
    v_lshl_add_u32 v50, v4, 5, v3
    v_add_u32 v54, 81920, v50
    v_add_u32 v4, 3, v2
    v_and_b32 v4, 7, v4
    v_lshl_add_u32 v51, v4, 5, v3
    v_add_u32 v55, 81920, v51
    v_mul_u32_u24 v56, 272, v9
    v_lshl_add_u32 v56, v10, 3, v56
    s_mul_i32 s3, s52, 26112
    s_lshl_b32 s33, s53, 7
    s_add_u32 s3, s3, s33
    s_add_u32 s3, s3, 81920
    v_add_u32 v56, s3, v56
    v_mov_b64 v[60:61], 0
    v_mov_b64 v[62:63], 0
    v_mov_b64 v[64:65], 0
    v_mov_b64 v[66:67], 0
    v_mov_b64 v[68:69], 0
    v_mov_b64 v[70:71], 0
    v_mov_b64 v[72:73], 0
    v_mov_b64 v[74:75], 0
    v_mov_b64 v[76:77], 0
    v_mov_b64 v[78:79], 0
    v_mov_b64 v[80:81], 0
    v_mov_b64 v[82:83], 0
    v_mov_b64 v[84:85], 0
    v_mov_b64 v[86:87], 0
    v_mov_b64 v[88:89], 0
    v_mov_b64 v[90:91], 0
    v_mov_b64 v[92:93], 0
    v_mov_b64 v[94:95], 0
    v_mov_b64 v[96:97], 0
    v_mov_b64 v[98:99], 0
    v_mov_b64 v[100:101], 0
    v_mov_b64 v[102:103], 0
    v_mov_b64 v[104:105], 0
    v_mov_b64 v[106:107], 0
    v_mov_b64 v[108:109], 0
    v_mov_b64 v[110:111], 0
    v_mov_b64 v[112:113], 0
    v_mov_b64 v[114:115], 0
    v_mov_b64 v[116:117], 0
    v_mov_b64 v[118:119], 0
    v_mov_b64 v[120:121], 0
    v_mov_b64 v[122:123], 0
    v_mov_b64 v[124:125], 0
    v_mov_b64 v[126:127], 0
    v_mov_b64 v[128:129], 0
    v_mov_b64 v[130:131], 0
    v_mov_b64 v[132:133], 0
    v_mov_b64 v[134:135], 0
    v_mov_b64 v[136:137], 0
    v_mov_b64 v[138:139], 0
    v_mov_b64 v[140:141], 0
    v_mov_b64 v[142:143], 0
    v_mov_b64 v[144:145], 0
    v_mov_b64 v[146:147], 0
    v_mov_b64 v[148:149], 0
    v_mov_b64 v[150:151], 0
    v_mov_b64 v[152:153], 0
    v_mov_b64 v[154:155], 0
    s_mov_b32 s54, 3
    s_cmp_lg_u32 s30, 0
    s_cbranch_scc1 K_WARMM0
    s_call_b64 s[38:39], WP_attd
    s_call_b64 s[38:39], WP_p2g
    s_branch K_WARMMX
K_WARMM0:
    s_cmp_lg_u32 s30, 1
    s_cbranch_scc1 K_WARMM1
    s_call_b64 s[38:39], WP_atts
    s_call_b64 s[38:39], WP_early
    s_branch K_WARMMX
K_WARMM1:
    s_cmp_lg_u32 s30, 2
    s_cbranch_scc1 K_WARMM2
    s_call_b64 s[38:39], WP_help
    s_call_b64 s[38:39], WP_flags
    s_branch K_WARMMX
K_WARMM2:
    s_call_b64 s[38:39], WP_spin
K_WARMMX:
    s_setprio 2
    s_barrier
    ds_read_b64_tr_b16 v[204:205], v48 offset:40960
    ds_read_b64_tr_b16 v[206:207], v48 offset:41984
    ds_read_b128 v[156:159], v44 offset:40960
    ds_read_b64_tr_b16 v[208:209], v49 offset:40960
    ds_read_b64_tr_b16 v[210:211], v49 offset:41984
    ds_read_b128 v[160:163], v44 offset:43008
    ds_read_b64_tr_b16 v[212:213], v50 offset:40960
    ds_read_b64_tr_b16 v[214:215], v50 offset:41984
    ds_read_b128 v[164:167], v44 offset:45056
    ds_read_b64_tr_b16 v[216:217], v51 offset:40960
    ds_read_b64_tr_b16 v[218:219], v51 offset:41984
    ds_read_b128 v[168:171], v44 offset:47104
    ds_read_b128 v[172:175], v44 offset:49152
    ds_read_b128 v[176:179], v44 offset:51200
K_CLOOP:
    s_waitcnt lgkmcnt(0)
    v_mfma_f32_16x16x32_bf16 v[60:63], v[204:207], v[156:159], v[60:63]
    ds_read_b64_tr_b16 v[220:221], v48 offset:49152
    v_mfma_f32_16x16x32_bf16 v[64:67], v[208:211], v[156:159], v[64:67]
    ds_read_b64_tr_b16 v[222:223], v48 offset:50176
    v_mfma_f32_16x16x32_bf16 v[68:71], v[212:215], v[156:159], v[68:71]
    ds_read_b128 v[180:183], v45 offset:40960
    v_mfma_f32_16x16x32_bf16 v[72:75], v[216:219], v[156:159], v[72:75]
    ds_read_b64_tr_b16 v[224:225], v49 offset:49152
    v_mfma_f32_16x16x32_bf16 v[88:91], v[216:219], v[160:163], v[88:91]
    ds_read_b64_tr_b16 v[226:227], v49 offset:50176
    v_mfma_f32_16x16x32_bf16 v[84:87], v[212:215], v[160:163], v[84:87]
    ds_read_b128 v[184:187], v45 offset:43008
    v_mfma_f32_16x16x32_bf16 v[80:83], v[208:211], v[160:163], v[80:83]
    ds_read_b64_tr_b16 v[228:229], v50 offset:49152
    v_mfma_f32_16x16x32_bf16 v[76:79], v[204:207], v[160:163], v[76:79]
    ds_read_b64_tr_b16 v[230:231], v50 offset:50176
    v_mfma_f32_16x16x32_bf16 v[92:95], v[204:207], v[164:167], v[92:95]
    ds_read_b128 v[188:191], v45 offset:45056
    v_mfma_f32_16x16x32_bf16 v[96:99], v[208:211], v[164:167], v[96:99]
    ds_read_b64_tr_b16 v[232:233], v51 offset:49152
    v_mfma_f32_16x16x32_bf16 v[100:103], v[212:215], v[164:167], v[100:103]
    ds_read_b64_tr_b16 v[234:235], v51 offset:50176
    v_mfma_f32_16x16x32_bf16 v[104:107], v[216:219], v[164:167], v[104:107]
    ds_read_b128 v[192:195], v45 offset:47104
    v_mfma_f32_16x16x32_bf16 v[120:123], v[216:219], v[168:171], v[120:123]
    ds_read_b128 v[196:199], v45 offset:49152
    v_mfma_f32_16x16x32_bf16 v[116:119], v[212:215], v[168:171], v[116:119]
    ds_read_b128 v[200:203], v45 offset:51200
    v_mfma_f32_16x16x32_bf16 v[112:115], v[208:211], v[168:171], v[112:115]
    v_mfma_f32_16x16x32_bf16 v[108:111], v[204:207], v[168:171], v[108:111]
    v_mfma_f32_16x16x32_bf16 v[124:127], v[204:207], v[172:175], v[124:127]
    v_mfma_f32_16x16x32_bf16 v[128:131], v[208:211], v[172:175], v[128:131]
    v_mfma_f32_16x16x32_bf16 v[132:135], v[212:215], v[172:175], v[132:135]
    v_mfma_f32_16x16x32_bf16 v[136:139], v[216:219], v[172:175], v[136:139]
    v_mfma_f32_16x16x32_bf16 v[152:155], v[216:219], v[176:179], v[152:155]
    v_mfma_f32_16x16x32_bf16 v[148:151], v[212:215], v[176:179], v[148:151]
    v_mfma_f32_16x16x32_bf16 v[144:147], v[208:211], v[176:179], v[144:147]
    v_mfma_f32_16x16x32_bf16 v[140:143], v[204:207], v[176:179], v[140:143]
    s_waitcnt lgkmcnt(0)
    s_barrier
    v_mfma_f32_16x16x32_bf16 v[60:63], v[220:223], v[180:183], v[60:63]
    ds_read_b64_tr_b16 v[204:205], v52 offset:0
    v_mfma_f32_16x16x32_bf16 v[64:67], v[224:227], v[180:183], v[64:67]
    ds_read_b64_tr_b16 v[206:207], v52 offset:1024
    v_mfma_f32_16x16x32_bf16 v[68:71], v[228:231], v[180:183], v[68:71]
    ds_read_b128 v[156:159], v46 offset:0
    v_mfma_f32_16x16x32_bf16 v[72:75], v[232:235], v[180:183], v[72:75]
    ds_read_b64_tr_b16 v[208:209], v53 offset:0
    v_mfma_f32_16x16x32_bf16 v[88:91], v[232:235], v[184:187], v[88:91]
    ds_read_b64_tr_b16 v[210:211], v53 offset:1024
    v_mfma_f32_16x16x32_bf16 v[84:87], v[228:231], v[184:187], v[84:87]
    ds_read_b128 v[160:163], v46 offset:2048
    v_mfma_f32_16x16x32_bf16 v[80:83], v[224:227], v[184:187], v[80:83]
    ds_read_b64_tr_b16 v[212:213], v54 offset:0
    v_mfma_f32_16x16x32_bf16 v[76:79], v[220:223], v[184:187], v[76:79]
    ds_read_b64_tr_b16 v[214:215], v54 offset:1024
    v_mfma_f32_16x16x32_bf16 v[92:95], v[220:223], v[188:191], v[92:95]
    ds_read_b128 v[164:167], v46 offset:4096
    v_mfma_f32_16x16x32_bf16 v[96:99], v[224:227], v[188:191], v[96:99]
    ds_read_b64_tr_b16 v[216:217], v55 offset:0
    v_mfma_f32_16x16x32_bf16 v[100:103], v[228:231], v[188:191], v[100:103]
    ds_read_b64_tr_b16 v[218:219], v55 offset:1024
    v_mfma_f32_16x16x32_bf16 v[104:107], v[232:235], v[188:191], v[104:107]
    ds_read_b128 v[168:171], v46 offset:6144
    v_mfma_f32_16x16x32_bf16 v[120:123], v[232:235], v[192:195], v[120:123]
    ds_read_b128 v[172:175], v46 offset:8192
    v_mfma_f32_16x16x32_bf16 v[116:119], v[228:231], v[192:195], v[116:119]
    ds_read_b128 v[176:179], v46 offset:10240
    v_mfma_f32_16x16x32_bf16 v[112:115], v[224:227], v[192:195], v[112:115]
    v_mfma_f32_16x16x32_bf16 v[108:111], v[220:223], v[192:195], v[108:111]
    v_mfma_f32_16x16x32_bf16 v[124:127], v[220:223], v[196:199], v[124:127]
    v_mfma_f32_16x16x32_bf16 v[128:131], v[224:227], v[196:199], v[128:131]
    v_mfma_f32_16x16x32_bf16 v[132:135], v[228:231], v[196:199], v[132:135]
    v_mfma_f32_16x16x32_bf16 v[136:139], v[232:235], v[196:199], v[136:139]
    v_mfma_f32_16x16x32_bf16 v[152:155], v[232:235], v[200:203], v[152:155]
    v_mfma_f32_16x16x32_bf16 v[148:151], v[228:231], v[200:203], v[148:151]
    v_mfma_f32_16x16x32_bf16 v[144:147], v[224:227], v[200:203], v[144:147]
    v_mfma_f32_16x16x32_bf16 v[140:143], v[220:223], v[200:203], v[140:143]
    s_waitcnt lgkmcnt(0)
    v_mfma_f32_16x16x32_bf16 v[60:63], v[204:207], v[156:159], v[60:63]
    ds_read_b64_tr_b16 v[220:221], v52 offset:8192
    v_mfma_f32_16x16x32_bf16 v[64:67], v[208:211], v[156:159], v[64:67]
    ds_read_b64_tr_b16 v[222:223], v52 offset:9216
    v_mfma_f32_16x16x32_bf16 v[68:71], v[212:215], v[156:159], v[68:71]
    ds_read_b128 v[180:183], v47 offset:0
    v_mfma_f32_16x16x32_bf16 v[72:75], v[216:219], v[156:159], v[72:75]
    ds_read_b64_tr_b16 v[224:225], v53 offset:8192
    v_mfma_f32_16x16x32_bf16 v[88:91], v[216:219], v[160:163], v[88:91]
    ds_read_b64_tr_b16 v[226:227], v53 offset:9216
    v_mfma_f32_16x16x32_bf16 v[84:87], v[212:215], v[160:163], v[84:87]
    ds_read_b128 v[184:187], v47 offset:2048
    v_mfma_f32_16x16x32_bf16 v[80:83], v[208:211], v[160:163], v[80:83]
    ds_read_b64_tr_b16 v[228:229], v54 offset:8192
    v_mfma_f32_16x16x32_bf16 v[76:79], v[204:207], v[160:163], v[76:79]
    ds_read_b64_tr_b16 v[230:231], v54 offset:9216
    v_mfma_f32_16x16x32_bf16 v[92:95], v[204:207], v[164:167], v[92:95]
    ds_read_b128 v[188:191], v47 offset:4096
    v_mfma_f32_16x16x32_bf16 v[96:99], v[208:211], v[164:167], v[96:99]
    ds_read_b64_tr_b16 v[232:233], v55 offset:8192
    v_mfma_f32_16x16x32_bf16 v[100:103], v[212:215], v[164:167], v[100:103]
    ds_read_b64_tr_b16 v[234:235], v55 offset:9216
    v_mfma_f32_16x16x32_bf16 v[104:107], v[216:219], v[164:167], v[104:107]
    ds_read_b128 v[192:195], v47 offset:6144
    v_mfma_f32_16x16x32_bf16 v[120:123], v[216:219], v[168:171], v[120:123]
    ds_read_b128 v[196:199], v47 offset:8192
    v_mfma_f32_16x16x32_bf16 v[116:119], v[212:215], v[168:171], v[116:119]
    ds_read_b128 v[200:203], v47 offset:10240
    v_mfma_f32_16x16x32_bf16 v[112:115], v[208:211], v[168:171], v[112:115]
    v_mfma_f32_16x16x32_bf16 v[108:111], v[204:207], v[168:171], v[108:111]
    v_mfma_f32_16x16x32_bf16 v[124:127], v[204:207], v[172:175], v[124:127]
    v_mfma_f32_16x16x32_bf16 v[128:131], v[208:211], v[172:175], v[128:131]
    v_mfma_f32_16x16x32_bf16 v[132:135], v[212:215], v[172:175], v[132:135]
    v_mfma_f32_16x16x32_bf16 v[136:139], v[216:219], v[172:175], v[136:139]
    v_mfma_f32_16x16x32_bf16 v[152:155], v[216:219], v[176:179], v[152:155]
    v_mfma_f32_16x16x32_bf16 v[148:151], v[212:215], v[176:179], v[148:151]
    v_mfma_f32_16x16x32_bf16 v[144:147], v[208:211], v[176:179], v[144:147]
    v_mfma_f32_16x16x32_bf16 v[140:143], v[204:207], v[176:179], v[140:143]
    s_waitcnt lgkmcnt(0)
    s_barrier
    v_mfma_f32_16x16x32_bf16 v[60:63], v[220:223], v[180:183], v[60:63]
    ds_read_b64_tr_b16 v[204:205], v48 offset:0
    v_mfma_f32_16x16x32_bf16 v[64:67], v[224:227], v[180:183], v[64:67]
    ds_read_b64_tr_b16 v[206:207], v48 offset:1024
    v_mfma_f32_16x16x32_bf16 v[68:71], v[228:231], v[180:183], v[68:71]
    ds_read_b128 v[156:159], v44 offset:0
    v_mfma_f32_16x16x32_bf16 v[72:75], v[232:235], v[180:183], v[72:75]
    ds_read_b64_tr_b16 v[208:209], v49 offset:0
    v_mfma_f32_16x16x32_bf16 v[88:91], v[232:235], v[184:187], v[88:91]
    ds_read_b64_tr_b16 v[210:211], v49 offset:1024
    v_mfma_f32_16x16x32_bf16 v[84:87], v[228:231], v[184:187], v[84:87]
    ds_read_b128 v[160:163], v44 offset:2048
    v_mfma_f32_16x16x32_bf16 v[80:83], v[224:227], v[184:187], v[80:83]
    ds_read_b64_tr_b16 v[212:213], v50 offset:0
    v_mfma_f32_16x16x32_bf16 v[76:79], v[220:223], v[184:187], v[76:79]
    ds_read_b64_tr_b16 v[214:215], v50 offset:1024
    v_mfma_f32_16x16x32_bf16 v[92:95], v[220:223], v[188:191], v[92:95]
    ds_read_b128 v[164:167], v44 offset:4096
    v_mfma_f32_16x16x32_bf16 v[96:99], v[224:227], v[188:191], v[96:99]
    ds_read_b64_tr_b16 v[216:217], v51 offset:0
    v_mfma_f32_16x16x32_bf16 v[100:103], v[228:231], v[188:191], v[100:103]
    ds_read_b64_tr_b16 v[218:219], v51 offset:1024
    v_mfma_f32_16x16x32_bf16 v[104:107], v[232:235], v[188:191], v[104:107]
    ds_read_b128 v[168:171], v44 offset:6144
    v_mfma_f32_16x16x32_bf16 v[120:123], v[232:235], v[192:195], v[120:123]
    ds_read_b128 v[172:175], v44 offset:8192
    v_mfma_f32_16x16x32_bf16 v[116:119], v[228:231], v[192:195], v[116:119]
    ds_read_b128 v[176:179], v44 offset:10240
    v_mfma_f32_16x16x32_bf16 v[112:115], v[224:227], v[192:195], v[112:115]
    v_mfma_f32_16x16x32_bf16 v[108:111], v[220:223], v[192:195], v[108:111]
    v_mfma_f32_16x16x32_bf16 v[124:127], v[220:223], v[196:199], v[124:127]
    v_mfma_f32_16x16x32_bf16 v[128:131], v[224:227], v[196:199], v[128:131]
    v_mfma_f32_16x16x32_bf16 v[132:135], v[228:231], v[196:199], v[132:135]
    v_mfma_f32_16x16x32_bf16 v[136:139], v[232:235], v[196:199], v[136:139]
    v_mfma_f32_16x16x32_bf16 v[152:155], v[232:235], v[200:203], v[152:155]
    v_mfma_f32_16x16x32_bf16 v[148:151], v[228:231], v[200:203], v[148:151]
    v_mfma_f32_16x16x32_bf16 v[144:147], v[224:227], v[200:203], v[144:147]
    v_mfma_f32_16x16x32_bf16 v[140:143], v[220:223], v[200:203], v[140:143]
    s_waitcnt lgkmcnt(0)
    v_mfma_f32_16x16x32_bf16 v[60:63], v[204:207], v[156:159], v[60:63]
    ds_read_b64_tr_b16 v[220:221], v48 offset:8192
    v_mfma_f32_16x16x32_bf16 v[64:67], v[208:211], v[156:159], v[64:67]
    ds_read_b64_tr_b16 v[222:223], v48 offset:9216
    v_mfma_f32_16x16x32_bf16 v[68:71], v[212:215], v[156:159], v[68:71]
    ds_read_b128 v[180:183], v45 offset:0
    v_mfma_f32_16x16x32_bf16 v[72:75], v[216:219], v[156:159], v[72:75]
    ds_read_b64_tr_b16 v[224:225], v49 offset:8192
    v_mfma_f32_16x16x32_bf16 v[88:91], v[216:219], v[160:163], v[88:91]
    ds_read_b64_tr_b16 v[226:227], v49 offset:9216
    v_mfma_f32_16x16x32_bf16 v[84:87], v[212:215], v[160:163], v[84:87]
    ds_read_b128 v[184:187], v45 offset:2048
    v_mfma_f32_16x16x32_bf16 v[80:83], v[208:211], v[160:163], v[80:83]
    ds_read_b64_tr_b16 v[228:229], v50 offset:8192
    v_mfma_f32_16x16x32_bf16 v[76:79], v[204:207], v[160:163], v[76:79]
    ds_read_b64_tr_b16 v[230:231], v50 offset:9216
    v_mfma_f32_16x16x32_bf16 v[92:95], v[204:207], v[164:167], v[92:95]
    ds_read_b128 v[188:191], v45 offset:4096
    v_mfma_f32_16x16x32_bf16 v[96:99], v[208:211], v[164:167], v[96:99]
    ds_read_b64_tr_b16 v[232:233], v51 offset:8192
    v_mfma_f32_16x16x32_bf16 v[100:103], v[212:215], v[164:167], v[100:103]
    ds_read_b64_tr_b16 v[234:235], v51 offset:9216
    v_mfma_f32_16x16x32_bf16 v[104:107], v[216:219], v[164:167], v[104:107]
    ds_read_b128 v[192:195], v45 offset:6144
    v_mfma_f32_16x16x32_bf16 v[120:123], v[216:219], v[168:171], v[120:123]
    ds_read_b128 v[196:199], v45 offset:8192
    v_mfma_f32_16x16x32_bf16 v[116:119], v[212:215], v[168:171], v[116:119]
    ds_read_b128 v[200:203], v45 offset:10240
    v_mfma_f32_16x16x32_bf16 v[112:115], v[208:211], v[168:171], v[112:115]
    v_mfma_f32_16x16x32_bf16 v[108:111], v[204:207], v[168:171], v[108:111]
    v_mfma_f32_16x16x32_bf16 v[124:127], v[204:207], v[172:175], v[124:127]
    v_mfma_f32_16x16x32_bf16 v[128:131], v[208:211], v[172:175], v[128:131]
    v_mfma_f32_16x16x32_bf16 v[132:135], v[212:215], v[172:175], v[132:135]
    v_mfma_f32_16x16x32_bf16 v[136:139], v[216:219], v[172:175], v[136:139]
    v_mfma_f32_16x16x32_bf16 v[152:155], v[216:219], v[176:179], v[152:155]
    v_mfma_f32_16x16x32_bf16 v[148:151], v[212:215], v[176:179], v[148:151]
    v_mfma_f32_16x16x32_bf16 v[144:147], v[208:211], v[176:179], v[144:147]
    v_mfma_f32_16x16x32_bf16 v[140:143], v[204:207], v[176:179], v[140:143]
    s_waitcnt lgkmcnt(0)
    s_barrier
    v_mfma_f32_16x16x32_bf16 v[60:63], v[220:223], v[180:183], v[60:63]
    ds_read_b64_tr_b16 v[204:205], v48 offset:40960
    v_mfma_f32_16x16x32_bf16 v[64:67], v[224:227], v[180:183], v[64:67]
    ds_read_b64_tr_b16 v[206:207], v48 offset:41984
    v_mfma_f32_16x16x32_bf16 v[68:71], v[228:231], v[180:183], v[68:71]
    ds_read_b128 v[156:159], v44 offset:40960
    v_mfma_f32_16x16x32_bf16 v[72:75], v[232:235], v[180:183], v[72:75]
    ds_read_b64_tr_b16 v[208:209], v49 offset:40960
    v_mfma_f32_16x16x32_bf16 v[88:91], v[232:235], v[184:187], v[88:91]
    ds_read_b64_tr_b16 v[210:211], v49 offset:41984
    v_mfma_f32_16x16x32_bf16 v[84:87], v[228:231], v[184:187], v[84:87]
    ds_read_b128 v[160:163], v44 offset:43008
    v_mfma_f32_16x16x32_bf16 v[80:83], v[224:227], v[184:187], v[80:83]
    ds_read_b64_tr_b16 v[212:213], v50 offset:40960
    v_mfma_f32_16x16x32_bf16 v[76:79], v[220:223], v[184:187], v[76:79]
    ds_read_b64_tr_b16 v[214:215], v50 offset:41984
    v_mfma_f32_16x16x32_bf16 v[92:95], v[220:223], v[188:191], v[92:95]
    ds_read_b128 v[164:167], v44 offset:45056
    v_mfma_f32_16x16x32_bf16 v[96:99], v[224:227], v[188:191], v[96:99]
    ds_read_b64_tr_b16 v[216:217], v51 offset:40960
    v_mfma_f32_16x16x32_bf16 v[100:103], v[228:231], v[188:191], v[100:103]
    ds_read_b64_tr_b16 v[218:219], v51 offset:41984
    v_mfma_f32_16x16x32_bf16 v[104:107], v[232:235], v[188:191], v[104:107]
    ds_read_b128 v[168:171], v44 offset:47104
    v_mfma_f32_16x16x32_bf16 v[120:123], v[232:235], v[192:195], v[120:123]
    ds_read_b128 v[172:175], v44 offset:49152
    v_mfma_f32_16x16x32_bf16 v[116:119], v[228:231], v[192:195], v[116:119]
    ds_read_b128 v[176:179], v44 offset:51200
    v_mfma_f32_16x16x32_bf16 v[112:115], v[224:227], v[192:195], v[112:115]
    s_sub_u32 s54, s54, 1
    v_mfma_f32_16x16x32_bf16 v[108:111], v[220:223], v[192:195], v[108:111]
    s_cmp_lg_u32 s54, 0
    v_mfma_f32_16x16x32_bf16 v[124:127], v[220:223], v[196:199], v[124:127]
    v_mfma_f32_16x16x32_bf16 v[128:131], v[224:227], v[196:199], v[128:131]
    v_mfma_f32_16x16x32_bf16 v[132:135], v[228:231], v[196:199], v[132:135]
    v_mfma_f32_16x16x32_bf16 v[136:139], v[232:235], v[196:199], v[136:139]
    v_mfma_f32_16x16x32_bf16 v[152:155], v[232:235], v[200:203], v[152:155]
    v_mfma_f32_16x16x32_bf16 v[148:151], v[228:231], v[200:203], v[148:151]
    v_mfma_f32_16x16x32_bf16 v[144:147], v[224:227], v[200:203], v[144:147]
    v_mfma_f32_16x16x32_bf16 v[140:143], v[220:223], v[200:203], v[140:143]
    s_cbranch_scc1 K_CLOOP
    s_waitcnt lgkmcnt(0)
    v_mfma_f32_16x16x32_bf16 v[60:63], v[204:207], v[156:159], v[60:63]
    ds_read_b64_tr_b16 v[220:221], v48 offset:49152
    v_mfma_f32_16x16x32_bf16 v[64:67], v[208:211], v[156:159], v[64:67]
    ds_read_b64_tr_b16 v[222:223], v48 offset:50176
    v_mfma_f32_16x16x32_bf16 v[68:71], v[212:215], v[156:159], v[68:71]
    ds_read_b128 v[180:183], v45 offset:40960
    v_mfma_f32_16x16x32_bf16 v[72:75], v[216:219], v[156:159], v[72:75]
    ds_read_b64_tr_b16 v[224:225], v49 offset:49152
    v_mfma_f32_16x16x32_bf16 v[76:79], v[204:207], v[160:163], v[76:79]
    ds_read_b64_tr_b16 v[226:227], v49 offset:50176
    v_mfma_f32_16x16x32_bf16 v[80:83], v[208:211], v[160:163], v[80:83]
    ds_read_b128 v[184:187], v45 offset:43008
    v_mfma_f32_16x16x32_bf16 v[84:87], v[212:215], v[160:163], v[84:87]
    ds_read_b64_tr_b16 v[228:229], v50 offset:49152
    v_mfma_f32_16x16x32_bf16 v[88:91], v[216:219], v[160:163], v[88:91]
    ds_read_b64_tr_b16 v[230:231], v50 offset:50176
    v_mfma_f32_16x16x32_bf16 v[92:95], v[204:207], v[164:167], v[92:95]
    ds_read_b128 v[188:191], v45 offset:45056
    v_mfma_f32_16x16x32_bf16 v[96:99], v[208:211], v[164:167], v[96:99]
    ds_read_b64_tr_b16 v[232:233], v51 offset:49152
    v_mfma_f32_16x16x32_bf16 v[100:103], v[212:215], v[164:167], v[100:103]
    ds_read_b64_tr_b16 v[234:235], v51 offset:50176
    v_mfma_f32_16x16x32_bf16 v[104:107], v[216:219], v[164:167], v[104:107]
    ds_read_b128 v[192:195], v45 offset:47104
    v_mfma_f32_16x16x32_bf16 v[108:111], v[204:207], v[168:171], v[108:111]
    ds_read_b128 v[196:199], v45 offset:49152
    v_mfma_f32_16x16x32_bf16 v[112:115], v[208:211], v[168:171], v[112:115]
    ds_read_b128 v[200:203], v45 offset:51200
    v_mfma_f32_16x16x32_bf16 v[116:119], v[212:215], v[168:171], v[116:119]
    v_mfma_f32_16x16x32_bf16 v[120:123], v[216:219], v[168:171], v[120:123]
    s_waitcnt lgkmcnt(0)
    v_mfma_f32_16x16x32_bf16 v[60:63], v[220:223], v[180:183], v[60:63]
    v_mfma_f32_16x16x32_bf16 v[64:67], v[224:227], v[180:183], v[64:67]
    v_mfma_f32_16x16x32_bf16 v[68:71], v[228:231], v[180:183], v[68:71]
    v_mfma_f32_16x16x32_bf16 v[72:75], v[232:235], v[180:183], v[72:75]
    v_mfma_f32_16x16x32_bf16 v[76:79], v[220:223], v[184:187], v[76:79]
    v_mfma_f32_16x16x32_bf16 v[80:83], v[224:227], v[184:187], v[80:83]
    v_mfma_f32_16x16x32_bf16 v[84:87], v[228:231], v[184:187], v[84:87]
    v_mfma_f32_16x16x32_bf16 v[88:91], v[232:235], v[184:187], v[88:91]
    v_mfma_f32_16x16x32_bf16 v[92:95], v[220:223], v[188:191], v[92:95]
    v_cvt_pk_bf16_f32 v236, v60, v61
    v_cvt_pk_bf16_f32 v237, v62, v63
    ds_write_b64 v56, v[236:237] offset:0
    v_mfma_f32_16x16x32_bf16 v[96:99], v[224:227], v[188:191], v[96:99]
    v_cvt_pk_bf16_f32 v238, v64, v65
    v_cvt_pk_bf16_f32 v239, v66, v67
    ds_write_b64 v56, v[238:239] offset:32
    v_mfma_f32_16x16x32_bf16 v[100:103], v[228:231], v[188:191], v[100:103]
    v_cvt_pk_bf16_f32 v240, v68, v69
    v_cvt_pk_bf16_f32 v241, v70, v71
    ds_write_b64 v56, v[240:241] offset:64
    v_mfma_f32_16x16x32_bf16 v[104:107], v[232:235], v[188:191], v[104:107]
    v_cvt_pk_bf16_f32 v242, v72, v73
    v_cvt_pk_bf16_f32 v243, v74, v75
    ds_write_b64 v56, v[242:243] offset:96
    v_mfma_f32_16x16x32_bf16 v[108:111], v[220:223], v[192:195], v[108:111]
    v_cvt_pk_bf16_f32 v236, v76, v77
    v_cvt_pk_bf16_f32 v237, v78, v79
    ds_write_b64 v56, v[236:237] offset:4352
    v_mfma_f32_16x16x32_bf16 v[112:115], v[224:227], v[192:195], v[112:115]
    v_cvt_pk_bf16_f32 v238, v80, v81
    v_cvt_pk_bf16_f32 v239, v82, v83
    ds_write_b64 v56, v[238:239] offset:4384
    v_mfma_f32_16x16x32_bf16 v[116:119], v[228:231], v[192:195], v[116:119]
    v_cvt_pk_bf16_f32 v240, v84, v85
    v_cvt_pk_bf16_f32 v241, v86, v87
    ds_write_b64 v56, v[240:241] offset:4416
    v_mfma_f32_16x16x32_bf16 v[120:123], v[232:235], v[192:195], v[120:123]
    v_cvt_pk_bf16_f32 v242, v88, v89
    v_cvt_pk_bf16_f32 v243, v90, v91
    ds_write_b64 v56, v[242:243] offset:4448
    v_mfma_f32_16x16x32_bf16 v[124:127], v[204:207], v[172:175], v[124:127]
    v_cvt_pk_bf16_f32 v236, v92, v93
    v_cvt_pk_bf16_f32 v237, v94, v95
    ds_write_b64 v56, v[236:237] offset:8704
    v_mfma_f32_16x16x32_bf16 v[128:131], v[208:211], v[172:175], v[128:131]
    v_cvt_pk_bf16_f32 v238, v96, v97
    v_cvt_pk_bf16_f32 v239, v98, v99
    ds_write_b64 v56, v[238:239] offset:8736
    v_mfma_f32_16x16x32_bf16 v[132:135], v[212:215], v[172:175], v[132:135]
    v_cvt_pk_bf16_f32 v240, v100, v101
    v_cvt_pk_bf16_f32 v241, v102, v103
    ds_write_b64 v56, v[240:241] offset:8768
    v_mfma_f32_16x16x32_bf16 v[136:139], v[216:219], v[172:175], v[136:139]
    v_cvt_pk_bf16_f32 v242, v104, v105
    v_cvt_pk_bf16_f32 v243, v106, v107
    ds_write_b64 v56, v[242:243] offset:8800
    v_mfma_f32_16x16x32_bf16 v[124:127], v[220:223], v[196:199], v[124:127]
    v_cvt_pk_bf16_f32 v236, v108, v109
    v_cvt_pk_bf16_f32 v237, v110, v111
    ds_write_b64 v56, v[236:237] offset:13056
    v_mfma_f32_16x16x32_bf16 v[128:131], v[224:227], v[196:199], v[128:131]
    v_cvt_pk_bf16_f32 v238, v112, v113
    v_cvt_pk_bf16_f32 v239, v114, v115
    ds_write_b64 v56, v[238:239] offset:13088
    v_mfma_f32_16x16x32_bf16 v[132:135], v[228:231], v[196:199], v[132:135]
    v_cvt_pk_bf16_f32 v240, v116, v117
    v_cvt_pk_bf16_f32 v241, v118, v119
    ds_write_b64 v56, v[240:241] offset:13120
    v_mfma_f32_16x16x32_bf16 v[136:139], v[232:235], v[196:199], v[136:139]
    v_cvt_pk_bf16_f32 v242, v120, v121
    v_cvt_pk_bf16_f32 v243, v122, v123
    ds_write_b64 v56, v[242:243] offset:13152
    v_mfma_f32_16x16x32_bf16 v[140:143], v[204:207], v[176:179], v[140:143]
    v_cvt_pk_bf16_f32 v236, v124, v125
    v_cvt_pk_bf16_f32 v237, v126, v127
    ds_write_b64 v56, v[236:237] offset:17408
    v_mfma_f32_16x16x32_bf16 v[144:147], v[208:211], v[176:179], v[144:147]
    v_cvt_pk_bf16_f32 v238, v128, v129
    v_cvt_pk_bf16_f32 v239, v130, v131
    ds_write_b64 v56, v[238:239] offset:17440
    v_mfma_f32_16x16x32_bf16 v[148:151], v[212:215], v[176:179], v[148:151]
    v_cvt_pk_bf16_f32 v240, v132, v133
    v_cvt_pk_bf16_f32 v241, v134, v135
    ds_write_b64 v56, v[240:241] offset:17472
    v_mfma_f32_16x16x32_bf16 v[152:155], v[216:219], v[176:179], v[152:155]
    v_cvt_pk_bf16_f32 v242, v136, v137
    v_cvt_pk_bf16_f32 v243, v138, v139
    ds_write_b64 v56, v[242:243] offset:17504
    v_mfma_f32_16x16x32_bf16 v[140:143], v[220:223], v[200:203], v[140:143]
    v_mfma_f32_16x16x32_bf16 v[144:147], v[224:227], v[200:203], v[144:147]
    v_mfma_f32_16x16x32_bf16 v[148:151], v[228:231], v[200:203], v[148:151]
    v_mfma_f32_16x16x32_bf16 v[152:155], v[232:235], v[200:203], v[152:155]
    s_nop 7
    v_cvt_pk_bf16_f32 v236, v140, v141
    v_cvt_pk_bf16_f32 v237, v142, v143
    ds_write_b64 v56, v[236:237] offset:21760
    v_cvt_pk_bf16_f32 v238, v144, v145
    v_cvt_pk_bf16_f32 v239, v146, v147
    ds_write_b64 v56, v[238:239] offset:21792
    v_cvt_pk_bf16_f32 v240, v148, v149
    v_cvt_pk_bf16_f32 v241, v150, v151
    ds_write_b64 v56, v[240:241] offset:21824
    v_cvt_pk_bf16_f32 v242, v152, v153
    v_cvt_pk_bf16_f32 v243, v154, v155
    ds_write_b64 v56, v[242:243] offset:21856
    s_setprio 0
    s_branch WS_attd
.p2align 12
WP_attd:
    s_setpc_b64 s[38:39]
WS_attd:
    s_waitcnt lgkmcnt(0)
    s_barrier
    ds_read_b64 v[60:61], v13 offset:80
    ds_read_b64 v[62:63], v14 offset:80
    ds_read_b64 v[44:45], v13 offset:4352
    ds_read_b64 v[46:47], v19 offset:4352
    ds_read_b64 v[64:65], v13 offset:4432
    ds_read_b64 v[66:67], v14 offset:4432
    ds_read_b64 v[72:73], v13 offset:120
    ds_read_b64 v[74:75], v14 offset:120
    ds_read_b64 v[48:49], v13 offset:4392
    ds_read_b64 v[50:51], v20 offset:4352
    ds_read_b64 v[76:77], v13 offset:4472
    ds_read_b64 v[78:79], v14 offset:4472
    ds_read_b64 v[52:53], v13 offset:8704
    ds_read_b64 v[54:55], v19 offset:8704
    ds_read_b64 v[68:69], v13 offset:8784
    ds_read_b64 v[70:71], v14 offset:8784
    s_waitcnt lgkmcnt(10)
    v_mfma_f32_16x16x32_bf16 v[116:119], v[60:63], v[44:47], v[36:39]
    v_mfma_f32_16x16x32_bf16 v[120:123], v[64:67], v[44:47], v[32:35]
    ds_read_b64 v[56:57], v13 offset:8744
    ds_read_b64 v[58:59], v20 offset:8704
    ds_read_b64 v[80:81], v13 offset:8824
    ds_read_b64 v[82:83], v14 offset:8824
    s_waitcnt lgkmcnt(8)
    v_mfma_f32_16x16x32_bf16 v[124:127], v[72:75], v[48:51], v[36:39]
    v_mfma_f32_16x16x32_bf16 v[128:131], v[76:79], v[48:51], v[32:35]
    s_waitcnt lgkmcnt(4)
    v_mfma_f32_16x16x32_bf16 v[132:135], v[64:67], v[52:55], v[28:31]
    v_mfma_f32_16x16x32_bf16 v[136:139], v[68:71], v[52:55], v[32:35]
    s_waitcnt lgkmcnt(0)
    v_mfma_f32_16x16x32_bf16 v[140:143], v[76:79], v[56:59], v[28:31]
    v_mfma_f32_16x16x32_bf16 v[144:147], v[80:83], v[56:59], v[32:35]
    ds_read_b64_tr_b16 v[84:85], v15 offset:160
    ds_read_b64_tr_b16 v[86:87], v15 offset:4512
    ds_read_b64_tr_b16 v[100:101], v21 offset:0
    ds_read_b64_tr_b16 v[102:103], v21 offset:4352
    v_max3_f32 v184, v116, v117, v120
    ds_read_b64_tr_b16 v[92:93], v15 offset:200
    v_max3_f32 v185, v118, v119, v122
    ds_read_b64_tr_b16 v[94:95], v15 offset:4552
    v_max_f32 v184, v184, v121
    ds_read_b64_tr_b16 v[104:105], v22 offset:0
    v_max_f32 v185, v185, v123
    ds_read_b64_tr_b16 v[106:107], v22 offset:4352
    v_max3_f32 v186, v124, v125, v128
    ds_read_b64_tr_b16 v[88:89], v15 offset:8864
    v_max3_f32 v187, v126, v127, v130
    ds_read_b64_tr_b16 v[108:109], v23 offset:4352
    v_max_f32 v186, v186, v129
    ds_read_b64_tr_b16 v[110:111], v23 offset:8704
    v_max_f32 v187, v187, v131
    ds_read_b64_tr_b16 v[96:97], v15 offset:8904
    v_max3_f32 v188, v132, v133, v136
    ds_read_b64_tr_b16 v[112:113], v24 offset:4352
    v_max3_f32 v189, v134, v135, v138
    ds_read_b64_tr_b16 v[114:115], v24 offset:8704
    v_max_f32 v188, v188, v137
    v_max_f32 v189, v189, v139
    v_max3_f32 v190, v140, v141, v144
    v_max3_f32 v191, v142, v143, v146
    v_max_f32 v190, v190, v145
    v_max_f32 v191, v191, v147
    v_cvt_pk_bf16_f32 v192, v184, v185
    v_cvt_pk_bf16_f32 v193, v186, v187
    v_cvt_pk_bf16_f32 v194, v188, v189
    v_cvt_pk_bf16_f32 v195, v190, v191
    v_lshlrev_b32 v184, 16, v192
    v_and_b32 v185, 0xffff0000, v192
    v_lshlrev_b32 v186, 16, v193
    v_and_b32 v187, 0xffff0000, v193
    v_lshlrev_b32 v188, 16, v194
    v_and_b32 v189, 0xffff0000, v194
    v_lshlrev_b32 v190, 16, v195
    v_and_b32 v191, 0xffff0000, v195
    v_pk_mul_f32 v[184:185], v[184:185], s[48:49]
    v_pk_mul_f32 v[186:187], v[186:187], s[48:49]
    v_pk_mul_f32 v[188:189], v[188:189], s[48:49]
    v_pk_mul_f32 v[190:191], v[190:191], s[48:49]
    v_cvt_pk_bf16_f32 v192, v184, v185
    v_cvt_pk_bf16_f32 v193, v186, v187
    v_cvt_pk_bf16_f32 v194, v188, v189
    v_cvt_pk_bf16_f32 v195, v190, v191
    v_permlane16_swap_b32 v192, v193
    s_nop 0
    v_permlane16_swap_b32 v194, v195
    s_nop 1
    v_permlane32_swap_b32 v192, v194
    v_permlane32_swap_b32 v193, v195
    v_lshlrev_b32 v184, 16, v192
    v_and_b32 v185, 0xffff0000, v192
    v_lshlrev_b32 v188, 16, v194
    v_and_b32 v189, 0xffff0000, v194
    v_lshlrev_b32 v186, 16, v193
    v_and_b32 v187, 0xffff0000, v193
    v_lshlrev_b32 v190, 16, v195
    v_and_b32 v191, 0xffff0000, v195
    v_max3_f32 v196, v184, v185, v188
    v_max3_f32 v197, v189, v186, v187
    v_max3_f32 v196, v196, v190, v191
    v_max_f32 v196, v196, v197
    v_mul_f32 v196, s46, v196
    v_pk_fma_f32 v[184:185], v[184:185], s[46:47], v[196:197] op_sel_hi:[1,1,0] neg_lo:[0,0,1] neg_hi:[0,0,1]
    v_pk_fma_f32 v[186:187], v[186:187], s[46:47], v[196:197] op_sel_hi:[1,1,0] neg_lo:[0,0,1] neg_hi:[0,0,1]
    v_pk_fma_f32 v[188:189], v[188:189], s[46:47], v[196:197] op_sel_hi:[1,1,0] neg_lo:[0,0,1] neg_hi:[0,0,1]
    v_pk_fma_f32 v[190:191], v[190:191], s[46:47], v[196:197] op_sel_hi:[1,1,0] neg_lo:[0,0,1] neg_hi:[0,0,1]
    v_exp_f32 v184, v184
    v_exp_f32 v185, v185
    v_exp_f32 v186, v186
    v_exp_f32 v187, v187
    v_exp_f32 v188, v188
    v_exp_f32 v189, v189
    v_exp_f32 v190, v190
    v_exp_f32 v191, v191
    v_pk_add_f32 v[200:201], v[184:185], v[186:187]
    v_pk_add_f32 v[202:203], v[188:189], v[190:191]
    v_pk_add_f32 v[200:201], v[200:201], v[202:203]
    v_add_f32 v200, v200, v201
    v_rcp_f32 v200, v200
    s_waitcnt lgkmcnt(0)
    v_pk_mul_f32 v[184:185], v[184:185], v[200:201] op_sel_hi:[1,0]
    v_pk_mul_f32 v[186:187], v[186:187], v[200:201] op_sel_hi:[1,0]
    v_pk_mul_f32 v[188:189], v[188:189], v[200:201] op_sel_hi:[1,0]
    v_pk_mul_f32 v[190:191], v[190:191], v[200:201] op_sel_hi:[1,0]
    v_cvt_pk_bf16_f32 v192, v184, v185
    v_cvt_pk_bf16_f32 v194, v188, v189
    v_cvt_pk_bf16_f32 v193, v186, v187
    v_cvt_pk_bf16_f32 v195, v190, v191
    v_permlane32_swap_b32 v192, v194
    s_nop 0
    v_permlane32_swap_b32 v193, v195
    s_nop 1
    v_permlane16_swap_b32 v192, v193
    v_permlane16_swap_b32 v194, v195
    v_perm_b32 v148, v192, v192, v40
    v_perm_b32 v149, v192, v192, v41
    v_perm_b32 v150, v192, v192, v42
    v_perm_b32 v151, v192, v192, v43
    v_perm_b32 v152, v193, v193, v40
    v_perm_b32 v153, v193, v193, v41
    v_perm_b32 v154, v193, v193, v42
    v_perm_b32 v155, v193, v193, v43
    v_mfma_f32_16x16x32_bf16 v[164:167], v[84:87], v[148:151], 0
    v_mfma_f32_16x16x32_bf16 v[180:183], v[100:103], v[148:151], 0
    v_perm_b32 v156, v194, v194, v40
    v_perm_b32 v157, v194, v194, v41
    v_perm_b32 v158, v194, v194, v42
    v_perm_b32 v159, v194, v194, v43
    v_mfma_f32_16x16x32_bf16 v[168:171], v[92:95], v[152:155], 0
    v_mfma_f32_16x16x32_bf16 v[180:183], v[104:107], v[152:155], v[180:183]
    v_perm_b32 v160, v195, v195, v40
    v_perm_b32 v161, v195, v195, v41
    v_perm_b32 v162, v195, v195, v42
    v_perm_b32 v163, v195, v195, v43
    v_mfma_f32_16x16x32_bf16 v[172:175], v[86:89], v[156:159], 0
    v_mfma_f32_16x16x32_bf16 v[180:183], v[108:111], v[156:159], v[180:183]
    v_mfma_f32_16x16x32_bf16 v[176:179], v[94:97], v[160:163], 0
    v_mfma_f32_16x16x32_bf16 v[180:183], v[112:115], v[160:163], v[180:183]
    v_cvt_pk_bf16_f32 v204, v164, v165
    v_cvt_pk_bf16_f32 v205, v166, v167
    v_cvt_pk_bf16_f32 v206, v168, v169
    v_cvt_pk_bf16_f32 v207, v170, v171
    buffer_store_dwordx4 v[204:207], v16, s[20:23], s50 offen sc1
    v_cvt_pk_bf16_f32 v208, v172, v173
    v_cvt_pk_bf16_f32 v209, v174, v175
    v_cvt_pk_bf16_f32 v210, v176, v177
    v_cvt_pk_bf16_f32 v211, v178, v179
    buffer_store_dwordx4 v[208:211], v16, s[20:23], s51 offen sc1
    v_cvt_pk_bf16_f32 v196, v180, v181
    v_cvt_pk_bf16_f32 v197, v182, v183
    buffer_store_dwordx2 v[196:197], v17, s[20:23], s50 offen sc1
    s_cmp_lg_u32 s34, -1
    s_cbranch_scc1 K_P2_EARLY
K_DRAIN:
    s_waitcnt vmcnt(0)
    s_barrier
    s_branch K_END
K_W7:
    s_waitcnt vmcnt(26)
    v_and_b32 v4, 7, v1
    v_lshlrev_b32 v4, 2, v4
    s_mov_b32 s3, 131072
K_ZPOLL5:
    v_cmp_eq_u32 vcc, 0, v7
    s_cbranch_vccz K_ZOK5
    s_sub_u32 s3, s3, 1
    s_cbranch_scc1 K_ZOK5
    global_load_dword v7, v4, s[8:9] offset:192 sc1
    s_waitcnt vmcnt(0)
    s_branch K_ZPOLL5
K_ZOK5:
    v_mov_b32 v4, 158720
    v_mov_b32 v3, 1
    s_mov_b64 exec, 1
    s_nop 0
    ds_add_rtn_u32 v2, v4, v3 offset:48
    s_mov_b32 exec_lo, s36
    v_mov_b32 v3, 1
    s_waitcnt lgkmcnt(0)
    v_readfirstlane_b32 s33, v2
    s_nop 3
    s_and_b32 s33, s33, 0xff
    s_cmp_lg_u32 s33, 7
    s_cbranch_scc1 K_ARR7
    global_store_dword v8, v3, s[10:11] sc1
K_ARR7:
    s_mov_b64 exec, -1
    v_mov_b32 v3, 0x100
    s_mov_b64 exec, 1
    s_waitcnt vmcnt(0)
    ds_add_u32 v4, v3 offset:48
    s_mov_b64 exec, -1
    s_branch K_P2_HELP
K_FLAG:
    s_waitcnt vmcnt(0)
    v_and_b32 v4, 7, v1
    v_lshlrev_b32 v4, 2, v4
    s_mov_b32 s3, 131072
K_ZPOLL0:
    v_cmp_eq_u32 vcc, 0, v7
    s_cbranch_vccz K_ZOK0
    s_sub_u32 s3, s3, 1
    s_cbranch_scc1 K_ZOK0
    global_load_dword v7, v4, s[8:9] offset:192 sc1
    s_waitcnt vmcnt(0)
    s_branch K_ZPOLL0
K_ZOK0:
    v_mov_b32 v3, 1
    s_mov_b32 exec_lo, s36
    s_mov_b32 exec_hi, 0
    s_setprio 3
    s_barrier
    global_store_dword v8, v3, s[10:11] sc1
    s_mov_b64 exec, -1
    s_branch K_END
WP_atts:
    s_setpc_b64 s[38:39]
K_JOIN_S:
    s_setprio 0
    s_barrier
    s_cmp_eq_u32 s30, 7
    s_cbranch_scc1 K_FLAG
    ds_read_b64 v[52:53], v13 offset:80
    ds_read_b64 v[54:55], v14 offset:80
    ds_read_b64 v[44:45], v13 offset:4352
    ds_read_b64 v[46:47], v19 offset:4352
    ds_read_b64 v[56:57], v13 offset:4432
    ds_read_b64 v[58:59], v14 offset:4432
    ds_read_b64 v[60:61], v13 offset:120
    ds_read_b64 v[62:63], v14 offset:120
    ds_read_b64 v[48:49], v13 offset:4392
    ds_read_b64 v[50:51], v20 offset:4352
    ds_read_b64 v[64:65], v13 offset:4472
    ds_read_b64 v[66:67], v14 offset:4472
    s_waitcnt lgkmcnt(6)
    v_mfma_f32_16x16x32_bf16 v[84:87], v[52:55], v[44:47], v[36:39]
    v_mfma_f32_16x16x32_bf16 v[88:91], v[56:59], v[44:47], v[32:35]
    s_waitcnt lgkmcnt(0)
    v_mfma_f32_16x16x32_bf16 v[92:95], v[60:63], v[48:51], v[36:39]
    v_mfma_f32_16x16x32_bf16 v[96:99], v[64:67], v[48:51], v[32:35]
    ds_read_b64_tr_b16 v[68:69], v15 offset:160
    ds_read_b64_tr_b16 v[70:71], v15 offset:4512
    ds_read_b64_tr_b16 v[76:77], v21 offset:0
    ds_read_b64_tr_b16 v[78:79], v21 offset:4352
    ds_read_b64_tr_b16 v[72:73], v15 offset:200
    ds_read_b64_tr_b16 v[74:75], v15 offset:4552
    ds_read_b64_tr_b16 v[80:81], v22 offset:0
    ds_read_b64_tr_b16 v[82:83], v22 offset:4352
    v_max3_f32 v120, v84, v85, v88
    v_max3_f32 v121, v86, v87, v90
    v_max_f32 v120, v120, v89
    v_max_f32 v121, v121, v91
    v_max3_f32 v122, v92, v93, v96
    v_max3_f32 v123, v94, v95, v98
    v_max_f32 v122, v122, v97
    v_max_f32 v123, v123, v99
    v_cvt_pk_bf16_f32 v124, v120, v121
    v_cvt_pk_bf16_f32 v125, v122, v123
    v_lshlrev_b32 v120, 16, v124
    v_and_b32 v121, 0xffff0000, v124
    v_lshlrev_b32 v122, 16, v125
    v_and_b32 v123, 0xffff0000, v125
    v_pk_mul_f32 v[120:121], v[120:121], s[48:49]
    v_pk_mul_f32 v[122:123], v[122:123], s[48:49]
    v_cvt_pk_bf16_f32 v124, v120, v121
    v_cvt_pk_bf16_f32 v125, v122, v123
    s_nop 1
    v_permlane16_swap_b32 v124, v125
    v_lshlrev_b32 v120, 16, v124
    v_and_b32 v121, 0xffff0000, v124
    v_lshlrev_b32 v122, 16, v125
    v_and_b32 v123, 0xffff0000, v125
    v_max3_f32 v126, v120, v121, v122
    v_max_f32 v126, v126, v123
    v_mov_b32 v127, v126
    s_nop 1
    v_permlane32_swap_b32 v126, v127
    v_max_f32 v126, v126, v127
    v_mul_f32 v126, s46, v126
    v_pk_fma_f32 v[120:121], v[120:121], s[46:47], v[126:127] op_sel_hi:[1,1,0] neg_lo:[0,0,1] neg_hi:[0,0,1]
    v_pk_fma_f32 v[122:123], v[122:123], s[46:47], v[126:127] op_sel_hi:[1,1,0] neg_lo:[0,0,1] neg_hi:[0,0,1]
    v_exp_f32 v120, v120
    v_exp_f32 v121, v121
    v_exp_f32 v122, v122
    v_exp_f32 v123, v123
    s_nop 0
    v_pk_add_f32 v[128:129], v[120:121], v[122:123]
    v_add_f32 v128, v128, v129
    v_mov_b32 v129, v128
    s_nop 1
    v_permlane32_swap_b32 v128, v129
    v_add_f32 v128, v128, v129
    v_rcp_f32 v128, v128
    s_waitcnt lgkmcnt(0)
    v_pk_mul_f32 v[120:121], v[120:121], v[128:129] op_sel_hi:[1,0]
    v_pk_mul_f32 v[122:123], v[122:123], v[128:129] op_sel_hi:[1,0]
    v_cvt_pk_bf16_f32 v124, v120, v121
    v_cvt_pk_bf16_f32 v125, v122, v123
    s_nop 1
    v_permlane16_swap_b32 v124, v125
    v_perm_b32 v100, v124, v124, v40
    v_perm_b32 v101, v124, v124, v41
    v_perm_b32 v102, v124, v124, v42
    v_perm_b32 v103, v124, v124, v43
    v_perm_b32 v104, v125, v125, v40
    v_perm_b32 v105, v125, v125, v41
    v_perm_b32 v106, v125, v125, v42
    v_perm_b32 v107, v125, v125, v43
    v_mfma_f32_16x16x32_bf16 v[108:111], v[68:71], v[100:103], 0
    v_mfma_f32_16x16x32_bf16 v[116:119], v[76:79], v[100:103], 0
    v_mfma_f32_16x16x32_bf16 v[112:115], v[72:75], v[104:107], 0
    v_mfma_f32_16x16x32_bf16 v[116:119], v[80:83], v[104:107], v[116:119]
    s_nop 4
    v_cvt_pk_bf16_f32 v132, v108, v109
    v_cvt_pk_bf16_f32 v133, v110, v111
    v_cvt_pk_bf16_f32 v134, v112, v113
    v_cvt_pk_bf16_f32 v135, v114, v115
    buffer_store_dwordx4 v[132:135], v16, s[20:23], s50 offen sc1
    v_cvt_pk_bf16_f32 v126, v116, v117
    v_cvt_pk_bf16_f32 v127, v118, v119
    buffer_store_dwordx2 v[126:127], v17, s[20:23], s50 offen sc1
    s_cmp_eq_u32 s34, -1
    s_cbranch_scc1 K_DRAIN
    s_cmp_lg_u32 s30, 6
    s_cbranch_scc1 K_NOFL
    s_waitcnt vmcnt(12)
    v_and_b32 v4, 7, v1
    v_lshlrev_b32 v4, 2, v4
    s_mov_b32 s3, 131072
K_ZPOLL2:
    v_cmp_eq_u32 vcc, 0, v7
    s_cbranch_vccz K_ZOK2
    s_sub_u32 s3, s3, 1
    s_cbranch_scc1 K_ZOK2
    global_load_dword v7, v4, s[8:9] offset:192 sc1
    s_waitcnt vmcnt(0)
    s_branch K_ZPOLL2
K_ZOK2:
    v_and_b32 v2, 1, v1
    v_lshl_add_u32 v2, v2, 2, s42
    global_load_dword v7, v2, s[10:11] offset:128 sc1
K_NOFL:
    v_mov_b32 v4, 158720
    v_mov_b32 v3, 257
    s_mov_b64 exec, 1
    s_waitcnt vmcnt(0)
    ds_add_rtn_u32 v2, v4, v3 offset:48
    s_mov_b32 exec_lo, s36
    v_mov_b32 v3, 1
    s_waitcnt lgkmcnt(0)
    v_readfirstlane_b32 s33, v2
    s_nop 3
    s_and_b32 s33, s33, 0xff
    s_cmp_lg_u32 s33, 7
    s_cbranch_scc1 K_ARRS
    global_store_dword v8, v3, s[10:11] sc1
K_ARRS:
    s_mov_b64 exec, -1
    s_cmp_ge_u32 s30, 6
    s_cbranch_scc1 K_P2_HELP
    s_mov_b32 s3, 1048576
K_LG:
    ds_read_b32 v2, v4 offset:48
    s_sub_u32 s3, s3, 1
    s_waitcnt lgkmcnt(0)
    v_readfirstlane_b32 s33, v2
    s_nop 3
    s_cselect_b32 s33, 8, s33
    s_bitcmp0_b32 s33, 3
    s_cbranch_scc1 K_LG
    s_sub_u32 s44, s30, 4
K_WOL:
    s_lshl_b32 s50, s44, 2
    s_lshr_b32 s50, 0x6431, s50
    s_and_b32 s50, s50, 7
    s_mul_i32 s50, s50, 51200
    s_mul_i32 s51, s44, 5120
    s_add_u32 s3, s50, 0
    s_add_u32 m0, s51, 40960
    s_waitcnt vmcnt(13)
    buffer_load_dwordx4 v18, s[24:27], s3 offen lds
    s_add_u32 s3, s50, 10240
    s_add_u32 m0, s51, 41984
    s_waitcnt vmcnt(13)
    buffer_load_dwordx4 v18, s[24:27], s3 offen lds
    s_add_u32 s3, s50, 20480
    s_add_u32 m0, s51, 43008
    s_waitcnt vmcnt(13)
    buffer_load_dwordx4 v18, s[24:27], s3 offen lds
    s_add_u32 s3, s50, 30720
    s_add_u32 m0, s51, 44032
    s_waitcnt vmcnt(13)
    buffer_load_dwordx4 v18, s[24:27], s3 offen lds
    s_add_u32 s3, s50, 40960
    s_add_u32 m0, s51, 45056
    s_waitcnt vmcnt(13)
    buffer_load_dwordx4 v18, s[24:27], s3 offen lds
    s_add_u32 s3, s50, 409600
    s_add_u32 m0, s51, 61440
    s_waitcnt vmcnt(13)
    buffer_load_dwordx4 v18, s[24:27], s3 offen lds
    s_add_u32 s3, s50, 419840
    s_add_u32 m0, s51, 62464
    s_waitcnt vmcnt(13)
    buffer_load_dwordx4 v18, s[24:27], s3 offen lds
    s_add_u32 s3, s50, 430080
    s_add_u32 m0, s51, 63488
    s_waitcnt vmcnt(13)
    buffer_load_dwordx4 v18, s[24:27], s3 offen lds
    s_add_u32 s3, s50, 440320
    s_add_u32 m0, s51, 64512
    s_waitcnt vmcnt(13)
    buffer_load_dwordx4 v18, s[24:27], s3 offen lds
    s_add_u32 s3, s50, 450560
    s_add_u32 m0, s51, 65536
    s_waitcnt vmcnt(13)
    buffer_load_dwordx4 v18, s[24:27], s3 offen lds
    s_add_u32 s44, s44, 2
    s_cmp_lt_u32 s44, 4
    s_cbranch_scc1 K_WOL
    v_mov_b32 v2, 158720
    v_mov_b32 v3, 2
    s_waitcnt vmcnt(0)
    s_mov_b64 exec, 1
    ds_add_u32 v2, v3 offset:44
    s_mov_b64 exec, -1
    s_branch K_P2_HELP
WP_early:
    s_setpc_b64 s[38:39]
K_P2_EARLY:
    s_lshl_b32 s54, s40, 7
    v_lshrrev_b32 v9, 4, v1
    v_mov_b32 v12, 158720
    s_add_u32 s20, s10, 0x100000
    s_addc_u32 s21, s11, 0
    s_mov_b32 s22, 0x280000
    s_mov_b32 s23, 0x20000
    s_add_u32 s16, s10, 0x1000
    s_addc_u32 s17, s11, 0
    s_mov_b32 s18, 0x2000
    s_mov_b32 s19, 0x20000
    s_mov_b32 s48, s6
    s_mov_b32 s49, s7
    s_mov_b32 s50, 0x280000
    s_mov_b32 s51, 0x20000
    s_lshl_b32 s53, s40, 3
    s_lshl1_add_u32 s53, s30, s53
    s_mov_b32 s55, 20480
    v_bfe_u32 v20, v1, 2, 2
    v_and_b32 v21, 3, v1
    s_mul_i32 s3, s53, 20480
    v_lshl_add_u32 v25, v1, 4, s3
    v_add_u32 v26, 20480, v25
    v_and_b32 v2, 15, v1
    s_lshl_b32 s3, s53, 6
    v_lshl_add_u32 v23, v2, 2, s3
    v_lshl_add_u32 v2, v9, 2, v20
    v_bfe_u32 v3, v2, 1, 2
    v_lshlrev_b32 v2, 7, v2
    v_lshl_add_u32 v2, v21, 3, v2
    v_lshl_add_u32 v24, v3, 5, v2
    v_lshrrev_b32 v3, 1, v20
    v_mul_u32_u24 v2, 40, v9
    v_add3_u32 v2, v2, 16, v20
    v_lshlrev_b32 v2, 7, v2
    v_lshl_add_u32 v2, v21, 3, v2
    v_xor_b32 v4, 0, v3
    v_lshl_add_u32 v56, v4, 5, v2
    v_xor_b32 v4, 1, v3
    v_lshl_add_u32 v57, v4, 5, v2
    v_xor_b32 v4, 2, v3
    v_lshl_add_u32 v58, v4, 5, v2
    v_xor_b32 v4, 3, v3
    v_lshl_add_u32 v59, v4, 5, v2
    v_lshrrev_b32 v3, 4, v1
    v_and_b32 v4, 7, v1
    v_lshrrev_b32 v2, 3, v1
    v_xor_b32 v4, v4, v3
    v_mul_u32_u24 v2, 1280, v2
    v_lshl_add_u32 v27, v4, 4, v2
    v_xor_b32 v28, 64, v27
    s_lshl_b32 s71, s40, 3
    s_lshl1_add_u32 s71, s30, s71
    s_mul_i32 s71, s71, 20480
    s_lshl_b32 s33, s41, 7
    s_add_u32 s71, s71, s33
    s_add_u32 s72, s71, 10240
    s_add_u32 s73, s71, 20480
    s_add_u32 s74, s71, 30720
    s_lshl_b32 s3, s30, 12
    s_add_u32 s3, s3, 140288
    v_lshl_add_u32 v33, v1, 4, s3
    v_and_b32 v2, 15, v1
    v_lshrrev_b32 v3, 1, v2
    v_lshrrev_b32 v4, 5, v1
    v_xor_b32 v3, v3, v4
    v_lshlrev_b32 v3, 4, v3
    v_lshl_add_u32 v3, v2, 7, v3
    v_and_b32 v4, 1, v9
    v_lshl_add_u32 v3, v4, 3, v3
    v_add_u32 v29, s3, v3
    v_xor_b32 v30, 32, v29
    v_xor_b32 v31, 64, v29
    v_xor_b32 v32, 96, v29
    s_lshl_b32 s3, s40, 3
    s_mul_i32 s33, s3, 187
    s_lshr_b32 s33, s33, 11
    s_add_u32 s33, s33, 1
    s_mul_i32 s33, s33, 11
    s_cmp_ge_u32 s53, s33
    s_cselect_b32 s64, 16, 0
    s_add_u32 s3, s53, 1
    s_cmp_ge_u32 s3, s33
    s_cselect_b32 s65, 16, 0
    s_mov_b32 s63, 0
    s_mov_b32 s66, 0
    s_mov_b32 s67, 16384
    v_mov_b32 v4, 158720
    v_mov_b32 v3, 1
    s_mov_b64 exec, 1
    s_waitcnt vmcnt(0)
    ds_add_rtn_u32 v2, v4, v3 offset:48
    s_mov_b32 exec_lo, s36
    v_mov_b32 v3, 1
    s_waitcnt lgkmcnt(0)
    v_readfirstlane_b32 s33, v2
    s_nop 3
    s_and_b32 s33, s33, 0xff
    s_cmp_lg_u32 s33, 7
    s_cbranch_scc1 K_ARRD
    global_store_dword v8, v3, s[10:11] sc1
K_ARRD:
    s_mov_b64 exec, -1
    s_mov_b32 s3, 1048576
K_P2_GE:
    ds_read_b32 v2, v12 offset:48
    s_sub_u32 s3, s3, 1
    s_waitcnt lgkmcnt(0)
    v_readfirstlane_b32 s33, v2
    s_nop 3
    s_cselect_b32 s33, 1024, s33
    s_cmp_lt_u32 s33, 1024
    s_cbranch_scc1 K_P2_GE
K_P2_GEMM:
    ds_read_b64 v[36:37], v29 offset:0
    ds_read_b64 v[38:39], v30 offset:0
    ds_read_b64 v[40:41], v31 offset:0
    ds_read_b64 v[42:43], v32 offset:0
    ds_read_b64 v[44:45], v29 offset:2048
    ds_read_b64 v[46:47], v30 offset:2048
    ds_read_b64 v[48:49], v31 offset:2048
    ds_read_b64 v[50:51], v32 offset:2048
    s_waitcnt lgkmcnt(4)
    v_lshlrev_b32 v68, 16, v36
    v_and_b32 v69, 0xffff0000, v36
    v_lshlrev_b32 v70, 16, v37
    v_and_b32 v71, 0xffff0000, v37
    v_lshlrev_b32 v72, 16, v38
    v_and_b32 v73, 0xffff0000, v38
    v_lshlrev_b32 v74, 16, v39
    v_and_b32 v75, 0xffff0000, v39
    v_lshlrev_b32 v76, 16, v40
    v_and_b32 v77, 0xffff0000, v40
    v_lshlrev_b32 v78, 16, v41
    v_and_b32 v79, 0xffff0000, v41
    v_lshlrev_b32 v80, 16, v42
    v_and_b32 v81, 0xffff0000, v42
    v_lshlrev_b32 v82, 16, v43
    v_and_b32 v83, 0xffff0000, v43
    s_waitcnt lgkmcnt(0)
    v_lshlrev_b32 v84, 16, v44
    v_and_b32 v85, 0xffff0000, v44
    v_lshlrev_b32 v86, 16, v45
    v_and_b32 v87, 0xffff0000, v45
    v_lshlrev_b32 v88, 16, v46
    v_and_b32 v89, 0xffff0000, v46
    v_lshlrev_b32 v90, 16, v47
    v_and_b32 v91, 0xffff0000, v47
    v_lshlrev_b32 v92, 16, v48
    v_and_b32 v93, 0xffff0000, v48
    v_lshlrev_b32 v94, 16, v49
    v_and_b32 v95, 0xffff0000, v49
    v_lshlrev_b32 v96, 16, v50
    v_and_b32 v97, 0xffff0000, v50
    v_lshlrev_b32 v98, 16, v51
    v_and_b32 v99, 0xffff0000, v51
    s_setprio 2
    s_cmp_eq_u32 s63, 0
    s_cbranch_scc1 K_SP0
K_SPR0:
    s_ff1_i32_b32 s33, s63
    s_bitset0_b32 s63, s33
    s_lshl_b32 s75, s33, 10
    buffer_load_dwordx4 v[100:103], v25, s[20:23], s75 offen offset:0 sc1
    buffer_load_dwordx4 v[104:107], v26, s[20:23], s75 offen offset:0 sc1
    v_mad_u32_u24 v52, s75, 5, v24
    v_xor_b32 v54, 64, v52
    v_xor_b32 v53, 32, v52
    v_xor_b32 v55, 96, v52
    ds_read_b64_tr_b16 v[180:181], v52 offset:0
    ds_read_b64_tr_b16 v[182:183], v54 offset:2560
    ds_read_b64_tr_b16 v[184:185], v53 offset:0
    ds_read_b64_tr_b16 v[186:187], v55 offset:2560
    ds_read_b64_tr_b16 v[188:189], v54 offset:0
    ds_read_b64_tr_b16 v[190:191], v52 offset:2560
    ds_read_b64_tr_b16 v[192:193], v55 offset:0
    ds_read_b64_tr_b16 v[194:195], v53 offset:2560
    s_cmp_eq_u32 s63, 0
    s_cbranch_scc1 K_SP1
K_SPR1:
    s_ff1_i32_b32 s33, s63
    s_bitset0_b32 s63, s33
    s_lshl_b32 s76, s33, 10
    buffer_load_dwordx4 v[108:111], v25, s[20:23], s76 offen offset:0 sc1
    buffer_load_dwordx4 v[112:115], v26, s[20:23], s76 offen offset:0 sc1
    v_mad_u32_u24 v52, s76, 5, v24
    v_xor_b32 v54, 64, v52
    v_xor_b32 v53, 32, v52
    v_xor_b32 v55, 96, v52
    ds_read_b64_tr_b16 v[196:197], v52 offset:0
    ds_read_b64_tr_b16 v[198:199], v54 offset:2560
    ds_read_b64_tr_b16 v[200:201], v53 offset:0
    ds_read_b64_tr_b16 v[202:203], v55 offset:2560
    ds_read_b64_tr_b16 v[204:205], v54 offset:0
    ds_read_b64_tr_b16 v[206:207], v52 offset:2560
    ds_read_b64_tr_b16 v[208:209], v55 offset:0
    ds_read_b64_tr_b16 v[210:211], v53 offset:2560
    s_cmp_eq_u32 s63, 0
    s_cbranch_scc1 K_SP2
K_SPR2:
    s_ff1_i32_b32 s33, s63
    s_bitset0_b32 s63, s33
    s_lshl_b32 s77, s33, 10
    buffer_load_dwordx4 v[116:119], v25, s[20:23], s77 offen offset:0 sc1
    buffer_load_dwordx4 v[120:123], v26, s[20:23], s77 offen offset:0 sc1
    s_cmp_eq_u32 s63, 0
    s_cbranch_scc1 K_SP3
K_SPR3:
    s_ff1_i32_b32 s33, s63
    s_bitset0_b32 s63, s33
    s_lshl_b32 s78, s33, 10
    buffer_load_dwordx4 v[124:127], v25, s[20:23], s78 offen offset:0 sc1
    buffer_load_dwordx4 v[128:131], v26, s[20:23], s78 offen offset:0 sc1
    s_cmp_eq_u32 s63, 0
    s_cbranch_scc1 K_SP4
K_SPR4:
    s_ff1_i32_b32 s33, s63
    s_bitset0_b32 s63, s33
    s_lshl_b32 s75, s33, 10
    buffer_load_dwordx4 v[132:135], v25, s[20:23], s75 offen offset:0 sc1
    buffer_load_dwordx4 v[136:139], v26, s[20:23], s75 offen offset:0 sc1
    s_branch WS_p2g
.p2align 12
WP_p2g:
    s_setpc_b64 s[38:39]
WS_p2g:
    s_waitcnt vmcnt(8) lgkmcnt(8)
    v_mfma_f32_16x16x32_bf16 v[148:151], v[180:183], v[100:103], 0
    v_mad_u32_u24 v52, s77, 5, v24
    v_xor_b32 v54, 64, v52
    v_xor_b32 v53, 32, v52
    v_mfma_f32_16x16x32_bf16 v[164:167], v[180:183], v[104:107], 0
    v_xor_b32 v55, 96, v52
    ds_read_b64_tr_b16 v[212:213], v52 offset:0
    ds_read_b64_tr_b16 v[214:215], v54 offset:2560
    v_mfma_f32_16x16x32_bf16 v[152:155], v[184:187], v[100:103], 0
    ds_read_b64_tr_b16 v[216:217], v53 offset:0
    ds_read_b64_tr_b16 v[218:219], v55 offset:2560
    ds_read_b64_tr_b16 v[220:221], v54 offset:0
    v_mfma_f32_16x16x32_bf16 v[168:171], v[184:187], v[104:107], 0
    ds_read_b64_tr_b16 v[222:223], v52 offset:2560
    ds_read_b64_tr_b16 v[224:225], v55 offset:0
    v_mfma_f32_16x16x32_bf16 v[156:159], v[188:191], v[100:103], 0
    ds_read_b64_tr_b16 v[226:227], v53 offset:2560
    s_cmp_eq_u32 s63, 0
    v_mfma_f32_16x16x32_bf16 v[172:175], v[188:191], v[104:107], 0
    s_cbranch_scc1 K_SP5
K_SPR5:
    s_ff1_i32_b32 s33, s63
    v_mfma_f32_16x16x32_bf16 v[160:163], v[192:195], v[100:103], 0
    s_bitset0_b32 s63, s33
    s_lshl_b32 s76, s33, 10
    v_mfma_f32_16x16x32_bf16 v[176:179], v[192:195], v[104:107], 0
    buffer_load_dwordx4 v[140:143], v25, s[20:23], s76 offen offset:0 sc1
    buffer_load_dwordx4 v[144:147], v26, s[20:23], s76 offen offset:0 sc1
    s_waitcnt vmcnt(8) lgkmcnt(8)
    v_mfma_f32_16x16x32_bf16 v[148:151], v[196:199], v[108:111], v[148:151]
    v_mad_u32_u24 v52, s78, 5, v24
    v_xor_b32 v54, 64, v52
    v_xor_b32 v53, 32, v52
    v_mfma_f32_16x16x32_bf16 v[164:167], v[196:199], v[112:115], v[164:167]
    v_xor_b32 v55, 96, v52
    ds_read_b64_tr_b16 v[180:181], v52 offset:0
    ds_read_b64_tr_b16 v[182:183], v54 offset:2560
    v_mfma_f32_16x16x32_bf16 v[152:155], v[200:203], v[108:111], v[152:155]
    ds_read_b64_tr_b16 v[184:185], v53 offset:0
    ds_read_b64_tr_b16 v[186:187], v55 offset:2560
    ds_read_b64_tr_b16 v[188:189], v54 offset:0
    v_mfma_f32_16x16x32_bf16 v[168:171], v[200:203], v[112:115], v[168:171]
    ds_read_b64_tr_b16 v[190:191], v52 offset:2560
    ds_read_b64_tr_b16 v[192:193], v55 offset:0
    v_mfma_f32_16x16x32_bf16 v[156:159], v[204:207], v[108:111], v[156:159]
    ds_read_b64_tr_b16 v[194:195], v53 offset:2560
    s_cmp_eq_u32 s63, 0
    v_mfma_f32_16x16x32_bf16 v[172:175], v[204:207], v[112:115], v[172:175]
    s_cbranch_scc1 K_SP6
K_SPR6:
    s_ff1_i32_b32 s33, s63
    v_mfma_f32_16x16x32_bf16 v[160:163], v[208:211], v[108:111], v[160:163]
    s_bitset0_b32 s63, s33
    s_lshl_b32 s77, s33, 10
    v_mfma_f32_16x16x32_bf16 v[176:179], v[208:211], v[112:115], v[176:179]
    buffer_load_dwordx4 v[100:103], v25, s[20:23], s77 offen offset:0 sc1
    buffer_load_dwordx4 v[104:107], v26, s[20:23], s77 offen offset:0 sc1
    s_waitcnt vmcnt(8) lgkmcnt(8)
    v_mfma_f32_16x16x32_bf16 v[148:151], v[212:215], v[116:119], v[148:151]
    v_mad_u32_u24 v52, s75, 5, v24
    v_xor_b32 v54, 64, v52
    v_xor_b32 v53, 32, v52
    v_mfma_f32_16x16x32_bf16 v[164:167], v[212:215], v[120:123], v[164:167]
    v_xor_b32 v55, 96, v52
    ds_read_b64_tr_b16 v[196:197], v52 offset:0
    ds_read_b64_tr_b16 v[198:199], v54 offset:2560
    v_mfma_f32_16x16x32_bf16 v[152:155], v[216:219], v[116:119], v[152:155]
    ds_read_b64_tr_b16 v[200:201], v53 offset:0
    ds_read_b64_tr_b16 v[202:203], v55 offset:2560
    ds_read_b64_tr_b16 v[204:205], v54 offset:0
    v_mfma_f32_16x16x32_bf16 v[168:171], v[216:219], v[120:123], v[168:171]
    ds_read_b64_tr_b16 v[206:207], v52 offset:2560
    ds_read_b64_tr_b16 v[208:209], v55 offset:0
    v_mfma_f32_16x16x32_bf16 v[156:159], v[220:223], v[116:119], v[156:159]
    ds_read_b64_tr_b16 v[210:211], v53 offset:2560
    s_cmp_eq_u32 s63, 0
    v_mfma_f32_16x16x32_bf16 v[172:175], v[220:223], v[120:123], v[172:175]
    s_cbranch_scc1 K_SP7
K_SPR7:
    s_ff1_i32_b32 s33, s63
    v_mfma_f32_16x16x32_bf16 v[160:163], v[224:227], v[116:119], v[160:163]
    s_bitset0_b32 s63, s33
    s_lshl_b32 s78, s33, 10
    v_mfma_f32_16x16x32_bf16 v[176:179], v[224:227], v[120:123], v[176:179]
    buffer_load_dwordx4 v[108:111], v25, s[20:23], s78 offen offset:0 sc1
    buffer_load_dwordx4 v[112:115], v26, s[20:23], s78 offen offset:0 sc1
    s_mov_b32 s3, 1048576
K_P2_GS:
    ds_read_b32 v2, v12 offset:40
    s_sub_u32 s3, s3, 1
    s_waitcnt lgkmcnt(0)
    v_readfirstlane_b32 s33, v2
    s_nop 3
    s_cselect_b32 s33, 1, s33
    s_cmp_lt_u32 s33, 1
    s_cbranch_scc1 K_P2_GS
    buffer_load_dword v60, v23, s[16:19], 0 offen offset:0 sc1
    buffer_load_dword v62, v23, s[16:19], 0 offen offset:64 sc1
    ds_read_b128 v[16:19], v12
    s_waitcnt vmcnt(10)
    v_mfma_f32_16x16x32_bf16 v[148:151], v[180:183], v[124:127], v[148:151]
    v_mad_u32_u24 v52, s76, 5, v24
    v_xor_b32 v54, 64, v52
    v_mfma_f32_16x16x32_bf16 v[164:167], v[180:183], v[128:131], v[164:167]
    v_xor_b32 v53, 32, v52
    v_xor_b32 v55, 96, v52
    v_mfma_f32_16x16x32_bf16 v[152:155], v[184:187], v[124:127], v[152:155]
    ds_read_b64_tr_b16 v[212:213], v52 offset:0
    ds_read_b64_tr_b16 v[214:215], v54 offset:2560
    v_mfma_f32_16x16x32_bf16 v[168:171], v[184:187], v[128:131], v[168:171]
    ds_read_b64_tr_b16 v[216:217], v53 offset:0
    ds_read_b64_tr_b16 v[218:219], v55 offset:2560
    v_mfma_f32_16x16x32_bf16 v[156:159], v[188:191], v[124:127], v[156:159]
    ds_read_b64_tr_b16 v[220:221], v54 offset:0
    ds_read_b64_tr_b16 v[222:223], v52 offset:2560
    v_mfma_f32_16x16x32_bf16 v[172:175], v[188:191], v[128:131], v[172:175]
    ds_read_b64_tr_b16 v[224:225], v55 offset:0
    ds_read_b64_tr_b16 v[226:227], v53 offset:2560
    v_mfma_f32_16x16x32_bf16 v[160:163], v[192:195], v[124:127], v[160:163]
    buffer_load_dwordx4 v[116:119], v25, s[20:23], s67 offen offset:0 sc1
    buffer_load_dwordx4 v[120:123], v26, s[20:23], s67 offen offset:0 sc1
    v_mfma_f32_16x16x32_bf16 v[176:179], v[192:195], v[128:131], v[176:179]
    s_waitcnt vmcnt(10)
    v_mfma_f32_16x16x32_bf16 v[148:151], v[196:199], v[132:135], v[148:151]
    v_mad_u32_u24 v52, s77, 5, v24
    v_xor_b32 v54, 64, v52
    v_mfma_f32_16x16x32_bf16 v[164:167], v[196:199], v[136:139], v[164:167]
    v_xor_b32 v53, 32, v52
    v_xor_b32 v55, 96, v52
    v_mfma_f32_16x16x32_bf16 v[152:155], v[200:203], v[132:135], v[152:155]
    ds_read_b64_tr_b16 v[180:181], v52 offset:0
    ds_read_b64_tr_b16 v[182:183], v54 offset:2560
    v_mfma_f32_16x16x32_bf16 v[168:171], v[200:203], v[136:139], v[168:171]
    ds_read_b64_tr_b16 v[184:185], v53 offset:0
    ds_read_b64_tr_b16 v[186:187], v55 offset:2560
    v_mfma_f32_16x16x32_bf16 v[156:159], v[204:207], v[132:135], v[156:159]
    ds_read_b64_tr_b16 v[188:189], v54 offset:0
    ds_read_b64_tr_b16 v[190:191], v52 offset:2560
    v_mfma_f32_16x16x32_bf16 v[172:175], v[204:207], v[136:139], v[172:175]
    ds_read_b64_tr_b16 v[192:193], v55 offset:0
    ds_read_b64_tr_b16 v[194:195], v53 offset:2560
    v_mfma_f32_16x16x32_bf16 v[160:163], v[208:211], v[132:135], v[160:163]
    buffer_load_dwordx4 v[124:127], v25, s[20:23], s67 offen offset:1024 sc1
    buffer_load_dwordx4 v[128:131], v26, s[20:23], s67 offen offset:1024 sc1
    v_mfma_f32_16x16x32_bf16 v[176:179], v[208:211], v[136:139], v[176:179]
    s_waitcnt vmcnt(10) lgkmcnt(8)
    v_mfma_f32_16x16x32_bf16 v[148:151], v[212:215], v[140:143], v[148:151]
    v_mad_u32_u24 v52, s78, 5, v24
    v_xor_b32 v54, 64, v52
    v_xor_b32 v53, 32, v52
    v_mfma_f32_16x16x32_bf16 v[164:167], v[212:215], v[144:147], v[164:167]
    v_xor_b32 v55, 96, v52
    ds_read_b64_tr_b16 v[196:197], v52 offset:0
    ds_read_b64_tr_b16 v[198:199], v54 offset:2560
    v_mfma_f32_16x16x32_bf16 v[152:155], v[216:219], v[140:143], v[152:155]
    ds_read_b64_tr_b16 v[200:201], v53 offset:0
    ds_read_b64_tr_b16 v[202:203], v55 offset:2560
    ds_read_b64_tr_b16 v[204:205], v54 offset:0
    v_mfma_f32_16x16x32_bf16 v[168:171], v[216:219], v[144:147], v[168:171]
    ds_read_b64_tr_b16 v[206:207], v52 offset:2560
    ds_read_b64_tr_b16 v[208:209], v55 offset:0
    v_mfma_f32_16x16x32_bf16 v[156:159], v[220:223], v[140:143], v[156:159]
    ds_read_b64_tr_b16 v[210:211], v53 offset:2560
    s_cmp_eq_u32 s63, 0
    v_mfma_f32_16x16x32_bf16 v[172:175], v[220:223], v[144:147], v[172:175]
    s_cbranch_scc1 K_SP10
K_SPR10:
    s_ff1_i32_b32 s33, s63
    v_mfma_f32_16x16x32_bf16 v[160:163], v[224:227], v[140:143], v[160:163]
    s_bitset0_b32 s63, s33
    s_lshl_b32 s77, s33, 10
    v_mfma_f32_16x16x32_bf16 v[176:179], v[224:227], v[144:147], v[176:179]
    buffer_load_dwordx4 v[132:135], v25, s[20:23], s77 offen offset:0 sc1
    buffer_load_dwordx4 v[136:139], v26, s[20:23], s77 offen offset:0 sc1
    s_waitcnt vmcnt(10) lgkmcnt(8)
    v_mfma_f32_16x16x32_bf16 v[148:151], v[180:183], v[100:103], v[148:151]
    ds_read_b64_tr_b16 v[212:213], v56 offset:0
    ds_read_b64_tr_b16 v[214:215], v58 offset:2560
    v_mfma_f32_16x16x32_bf16 v[164:167], v[180:183], v[104:107], v[164:167]
    ds_read_b64_tr_b16 v[216:217], v57 offset:0
    ds_read_b64_tr_b16 v[218:219], v59 offset:2560
    v_mfma_f32_16x16x32_bf16 v[152:155], v[184:187], v[100:103], v[152:155]
    ds_read_b64_tr_b16 v[220:221], v58 offset:0
    ds_read_b64_tr_b16 v[222:223], v56 offset:2560
    v_mfma_f32_16x16x32_bf16 v[168:171], v[184:187], v[104:107], v[168:171]
    ds_read_b64_tr_b16 v[224:225], v59 offset:0
    ds_read_b64_tr_b16 v[226:227], v57 offset:2560
    v_mfma_f32_16x16x32_bf16 v[156:159], v[188:191], v[100:103], v[156:159]
    s_cmp_eq_u32 s63, 0
    s_cbranch_scc1 K_SP11
K_SPR11:
    v_mfma_f32_16x16x32_bf16 v[172:175], v[188:191], v[104:107], v[172:175]
    s_ff1_i32_b32 s33, s63
    s_bitset0_b32 s63, s33
    v_mfma_f32_16x16x32_bf16 v[160:163], v[192:195], v[100:103], v[160:163]
    s_lshl_b32 s78, s33, 10
    buffer_load_dwordx4 v[140:143], v25, s[20:23], s78 offen offset:0 sc1
    v_mfma_f32_16x16x32_bf16 v[176:179], v[192:195], v[104:107], v[176:179]
    buffer_load_dwordx4 v[144:147], v26, s[20:23], s78 offen offset:0 sc1
    s_waitcnt vmcnt(10) lgkmcnt(8)
    v_mfma_f32_16x16x32_bf16 v[148:151], v[196:199], v[108:111], v[148:151]
    ds_read_b64_tr_b16 v[180:181], v56 offset:20480
    ds_read_b64_tr_b16 v[182:183], v58 offset:23040
    v_mfma_f32_16x16x32_bf16 v[164:167], v[196:199], v[112:115], v[164:167]
    ds_read_b64_tr_b16 v[184:185], v57 offset:20480
    ds_read_b64_tr_b16 v[186:187], v59 offset:23040
    v_mfma_f32_16x16x32_bf16 v[152:155], v[200:203], v[108:111], v[152:155]
    ds_read_b64_tr_b16 v[188:189], v58 offset:20480
    ds_read_b64_tr_b16 v[190:191], v56 offset:23040
    v_mfma_f32_16x16x32_bf16 v[168:171], v[200:203], v[112:115], v[168:171]
    ds_read_b64_tr_b16 v[192:193], v59 offset:20480
    ds_read_b64_tr_b16 v[194:195], v57 offset:23040
    v_mfma_f32_16x16x32_bf16 v[156:159], v[204:207], v[108:111], v[156:159]
    s_cmp_eq_u32 s63, 0
    s_cbranch_scc1 K_SP12
K_SPR12:
    v_mfma_f32_16x16x32_bf16 v[172:175], v[204:207], v[112:115], v[172:175]
    s_ff1_i32_b32 s33, s63
    s_bitset0_b32 s63, s33
    v_mfma_f32_16x16x32_bf16 v[160:163], v[208:211], v[108:111], v[160:163]
    s_lshl_b32 s75, s33, 10
    buffer_load_dwordx4 v[100:103], v25, s[20:23], s75 offen offset:0 sc1
    v_mfma_f32_16x16x32_bf16 v[176:179], v[208:211], v[112:115], v[176:179]
    buffer_load_dwordx4 v[104:107], v26, s[20:23], s75 offen offset:0 sc1
    s_mov_b32 s3, 1048576
K_P2_GW:
    ds_read_b32 v2, v12 offset:44
    s_sub_u32 s3, s3, 1
    s_waitcnt lgkmcnt(0)
    v_readfirstlane_b32 s33, v2
    s_nop 3
    s_cselect_b32 s33, 4, s33
    s_cmp_lt_u32 s33, 4
    s_cbranch_scc1 K_P2_GW
    v_readfirstlane_b32 s56, v16
    v_readfirstlane_b32 s57, v17
    s_lshl_b32 s58, s53, 4
    s_waitcnt vmcnt(8)
    v_mfma_f32_16x16x32_bf16 v[148:151], v[212:215], v[116:119], v[148:151]
    v_mad_u32_u24 v52, s77, 5, v24
    v_xor_b32 v54, 64, v52
    v_xor_b32 v53, 32, v52
    v_mfma_f32_16x16x32_bf16 v[164:167], v[212:215], v[120:123], v[164:167]
    v_xor_b32 v55, 96, v52
    ds_read_b64_tr_b16 v[196:197], v52 offset:0
    ds_read_b64_tr_b16 v[198:199], v54 offset:2560
    v_mfma_f32_16x16x32_bf16 v[152:155], v[216:219], v[116:119], v[152:155]
    ds_read_b64_tr_b16 v[200:201], v53 offset:0
    ds_read_b64_tr_b16 v[202:203], v55 offset:2560
    ds_read_b64_tr_b16 v[204:205], v54 offset:0
    v_mfma_f32_16x16x32_bf16 v[168:171], v[216:219], v[120:123], v[168:171]
    ds_read_b64_tr_b16 v[206:207], v52 offset:2560
    ds_read_b64_tr_b16 v[208:209], v55 offset:0
    v_mfma_f32_16x16x32_bf16 v[156:159], v[220:223], v[116:119], v[156:159]
    ds_read_b64_tr_b16 v[210:211], v53 offset:2560
    s_cmp_eq_u32 s63, 0
    v_mfma_f32_16x16x32_bf16 v[172:175], v[220:223], v[120:123], v[172:175]
    s_cbranch_scc1 K_SP13
K_SPR13:
    s_ff1_i32_b32 s33, s63
    v_mfma_f32_16x16x32_bf16 v[160:163], v[224:227], v[116:119], v[160:163]
    s_bitset0_b32 s63, s33
    s_lshl_b32 s76, s33, 10
    v_mfma_f32_16x16x32_bf16 v[176:179], v[224:227], v[120:123], v[176:179]
    buffer_load_dwordx4 v[108:111], v25, s[20:23], s76 offen offset:0 sc1
    buffer_load_dwordx4 v[112:115], v26, s[20:23], s76 offen offset:0 sc1
    s_waitcnt vmcnt(8)
    v_mfma_f32_16x16x32_bf16 v[148:151], v[180:183], v[124:127], v[148:151]
    v_mad_u32_u24 v52, s78, 5, v24
    v_xor_b32 v54, 64, v52
    v_xor_b32 v53, 32, v52
    v_mfma_f32_16x16x32_bf16 v[164:167], v[180:183], v[128:131], v[164:167]
    v_xor_b32 v55, 96, v52
    ds_read_b64_tr_b16 v[212:213], v52 offset:0
    ds_read_b64_tr_b16 v[214:215], v54 offset:2560
    v_mfma_f32_16x16x32_bf16 v[152:155], v[184:187], v[124:127], v[152:155]
    ds_read_b64_tr_b16 v[216:217], v53 offset:0
    ds_read_b64_tr_b16 v[218:219], v55 offset:2560
    ds_read_b64_tr_b16 v[220:221], v54 offset:0
    v_mfma_f32_16x16x32_bf16 v[168:171], v[184:187], v[128:131], v[168:171]
    ds_read_b64_tr_b16 v[222:223], v52 offset:2560
    ds_read_b64_tr_b16 v[224:225], v55 offset:0
    v_mfma_f32_16x16x32_bf16 v[156:159], v[188:191], v[124:127], v[156:159]
    ds_read_b64_tr_b16 v[226:227], v53 offset:2560
    s_cmp_eq_u32 s63, 0
    v_mfma_f32_16x16x32_bf16 v[172:175], v[188:191], v[128:131], v[172:175]
    s_cbranch_scc1 K_SP14
K_SPR14:
    s_ff1_i32_b32 s33, s63
    v_mfma_f32_16x16x32_bf16 v[160:163], v[192:195], v[124:127], v[160:163]
    s_bitset0_b32 s63, s33
    s_lshl_b32 s77, s33, 10
    v_mfma_f32_16x16x32_bf16 v[176:179], v[192:195], v[128:131], v[176:179]
    buffer_load_dwordx4 v[116:119], v25, s[20:23], s77 offen offset:0 sc1
    buffer_load_dwordx4 v[120:123], v26, s[20:23], s77 offen offset:0 sc1
    s_waitcnt vmcnt(8) lgkmcnt(8)
    v_mfma_f32_16x16x32_bf16 v[148:151], v[196:199], v[132:135], v[148:151]
    v_mad_u32_u24 v52, s75, 5, v24
    v_xor_b32 v54, 64, v52
    v_xor_b32 v53, 32, v52
    v_mfma_f32_16x16x32_bf16 v[164:167], v[196:199], v[136:139], v[164:167]
    v_xor_b32 v55, 96, v52
    ds_read_b64_tr_b16 v[180:181], v52 offset:0
    ds_read_b64_tr_b16 v[182:183], v54 offset:2560
    v_mfma_f32_16x16x32_bf16 v[152:155], v[200:203], v[132:135], v[152:155]
    ds_read_b64_tr_b16 v[184:185], v53 offset:0
    ds_read_b64_tr_b16 v[186:187], v55 offset:2560
    ds_read_b64_tr_b16 v[188:189], v54 offset:0
    v_mfma_f32_16x16x32_bf16 v[168:171], v[200:203], v[136:139], v[168:171]
    ds_read_b64_tr_b16 v[190:191], v52 offset:2560
    ds_read_b64_tr_b16 v[192:193], v55 offset:0
    v_mfma_f32_16x16x32_bf16 v[156:159], v[204:207], v[132:135], v[156:159]
    ds_read_b64_tr_b16 v[194:195], v53 offset:2560
    s_cmp_eq_u32 s63, 0
    v_mfma_f32_16x16x32_bf16 v[172:175], v[204:207], v[136:139], v[172:175]
    s_cbranch_scc1 K_SP15
K_SPR15:
    s_ff1_i32_b32 s33, s63
    v_mfma_f32_16x16x32_bf16 v[160:163], v[208:211], v[132:135], v[160:163]
    s_bitset0_b32 s63, s33
    s_lshl_b32 s78, s33, 10
    v_mfma_f32_16x16x32_bf16 v[176:179], v[208:211], v[136:139], v[176:179]
    buffer_load_dwordx4 v[124:127], v25, s[20:23], s78 offen offset:0 sc1
    buffer_load_dwordx4 v[128:131], v26, s[20:23], s78 offen offset:0 sc1
    s_waitcnt vmcnt(8) lgkmcnt(8)
    v_mfma_f32_16x16x32_bf16 v[148:151], v[212:215], v[140:143], v[148:151]
    v_mad_u32_u24 v52, s76, 5, v24
    v_xor_b32 v54, 64, v52
    v_xor_b32 v53, 32, v52
    v_mfma_f32_16x16x32_bf16 v[164:167], v[212:215], v[144:147], v[164:167]
    v_xor_b32 v55, 96, v52
    ds_read_b64_tr_b16 v[196:197], v52 offset:0
    ds_read_b64_tr_b16 v[198:199], v54 offset:2560
    v_mfma_f32_16x16x32_bf16 v[152:155], v[216:219], v[140:143], v[152:155]
    ds_read_b64_tr_b16 v[200:201], v53 offset:0
    ds_read_b64_tr_b16 v[202:203], v55 offset:2560
    ds_read_b64_tr_b16 v[204:205], v54 offset:0
    v_mfma_f32_16x16x32_bf16 v[168:171], v[216:219], v[144:147], v[168:171]
    ds_read_b64_tr_b16 v[206:207], v52 offset:2560
    ds_read_b64_tr_b16 v[208:209], v55 offset:0
    v_mfma_f32_16x16x32_bf16 v[156:159], v[220:223], v[140:143], v[156:159]
    ds_read_b64_tr_b16 v[210:211], v53 offset:2560
    s_cmp_eq_u32 s63, 0
    v_mfma_f32_16x16x32_bf16 v[172:175], v[220:223], v[144:147], v[172:175]
    s_cbranch_scc1 K_SP16
K_SPR16:
    s_ff1_i32_b32 s33, s63
    v_mfma_f32_16x16x32_bf16 v[160:163], v[224:227], v[140:143], v[160:163]
    s_bitset0_b32 s63, s33
    s_lshl_b32 s75, s33, 10
    v_mfma_f32_16x16x32_bf16 v[176:179], v[224:227], v[144:147], v[176:179]
    buffer_load_dwordx4 v[132:135], v25, s[20:23], s75 offen offset:0 sc1
    buffer_load_dwordx4 v[136:139], v26, s[20:23], s75 offen offset:0 sc1
    s_waitcnt vmcnt(8) lgkmcnt(8)
    v_mfma_f32_16x16x32_bf16 v[148:151], v[180:183], v[100:103], v[148:151]
    v_mad_u32_u24 v52, s77, 5, v24
    v_xor_b32 v54, 64, v52
    v_xor_b32 v53, 32, v52
    v_mfma_f32_16x16x32_bf16 v[164:167], v[180:183], v[104:107], v[164:167]
    v_xor_b32 v55, 96, v52
    ds_read_b64_tr_b16 v[212:213], v52 offset:0
    ds_read_b64_tr_b16 v[214:215], v54 offset:2560
    v_mfma_f32_16x16x32_bf16 v[152:155], v[184:187], v[100:103], v[152:155]
    ds_read_b64_tr_b16 v[216:217], v53 offset:0
    ds_read_b64_tr_b16 v[218:219], v55 offset:2560
    ds_read_b64_tr_b16 v[220:221], v54 offset:0
    v_mfma_f32_16x16x32_bf16 v[168:171], v[184:187], v[104:107], v[168:171]
    ds_read_b64_tr_b16 v[222:223], v52 offset:2560
    ds_read_b64_tr_b16 v[224:225], v55 offset:0
    v_mfma_f32_16x16x32_bf16 v[156:159], v[188:191], v[100:103], v[156:159]
    ds_read_b64_tr_b16 v[226:227], v53 offset:2560
    s_cmp_eq_u32 s63, 0
    v_mfma_f32_16x16x32_bf16 v[172:175], v[188:191], v[104:107], v[172:175]
    s_cbranch_scc1 K_SP17
K_SPR17:
    s_ff1_i32_b32 s33, s63
    v_mfma_f32_16x16x32_bf16 v[160:163], v[192:195], v[100:103], v[160:163]
    s_bitset0_b32 s63, s33
    s_lshl_b32 s76, s33, 10
    v_mfma_f32_16x16x32_bf16 v[176:179], v[192:195], v[104:107], v[176:179]
    buffer_load_dwordx4 v[140:143], v25, s[20:23], s76 offen offset:0 sc1
    buffer_load_dwordx4 v[144:147], v26, s[20:23], s76 offen offset:0 sc1
    s_waitcnt vmcnt(8) lgkmcnt(8)
    v_mfma_f32_16x16x32_bf16 v[148:151], v[196:199], v[108:111], v[148:151]
    v_mad_u32_u24 v52, s78, 5, v24
    v_xor_b32 v54, 64, v52
    v_mfma_f32_16x16x32_bf16 v[164:167], v[196:199], v[112:115], v[164:167]
    v_xor_b32 v53, 32, v52
    v_xor_b32 v55, 96, v52
    v_mfma_f32_16x16x32_bf16 v[152:155], v[200:203], v[108:111], v[152:155]
    ds_read_b64_tr_b16 v[180:181], v52 offset:0
    ds_read_b64_tr_b16 v[182:183], v54 offset:2560
    v_mfma_f32_16x16x32_bf16 v[168:171], v[200:203], v[112:115], v[168:171]
    ds_read_b64_tr_b16 v[184:185], v53 offset:0
    ds_read_b64_tr_b16 v[186:187], v55 offset:2560
    v_mfma_f32_16x16x32_bf16 v[156:159], v[204:207], v[108:111], v[156:159]
    ds_read_b64_tr_b16 v[188:189], v54 offset:0
    ds_read_b64_tr_b16 v[190:191], v52 offset:2560
    v_mfma_f32_16x16x32_bf16 v[172:175], v[204:207], v[112:115], v[172:175]
    ds_read_b64_tr_b16 v[192:193], v55 offset:0
    ds_read_b64_tr_b16 v[194:195], v53 offset:2560
    v_mfma_f32_16x16x32_bf16 v[160:163], v[208:211], v[108:111], v[160:163]
    buffer_load_dwordx4 v[100:103], v25, s[20:23], s67 offen offset:2048 sc1
    buffer_load_dwordx4 v[104:107], v26, s[20:23], s67 offen offset:2048 sc1
    v_mfma_f32_16x16x32_bf16 v[176:179], v[208:211], v[112:115], v[176:179]
    s_waitcnt vmcnt(8) lgkmcnt(8)
    v_mfma_f32_16x16x32_bf16 v[148:151], v[212:215], v[116:119], v[148:151]
    v_mad_u32_u24 v52, s75, 5, v24
    v_xor_b32 v54, 64, v52
    v_mfma_f32_16x16x32_bf16 v[164:167], v[212:215], v[120:123], v[164:167]
    v_xor_b32 v53, 32, v52
    v_xor_b32 v55, 96, v52
    v_mfma_f32_16x16x32_bf16 v[152:155], v[216:219], v[116:119], v[152:155]
    ds_read_b64_tr_b16 v[196:197], v52 offset:0
    ds_read_b64_tr_b16 v[198:199], v54 offset:2560
    v_mfma_f32_16x16x32_bf16 v[168:171], v[216:219], v[120:123], v[168:171]
    ds_read_b64_tr_b16 v[200:201], v53 offset:0
    ds_read_b64_tr_b16 v[202:203], v55 offset:2560
    v_mfma_f32_16x16x32_bf16 v[156:159], v[220:223], v[116:119], v[156:159]
    ds_read_b64_tr_b16 v[204:205], v54 offset:0
    ds_read_b64_tr_b16 v[206:207], v52 offset:2560
    v_mfma_f32_16x16x32_bf16 v[172:175], v[220:223], v[120:123], v[172:175]
    ds_read_b64_tr_b16 v[208:209], v55 offset:0
    ds_read_b64_tr_b16 v[210:211], v53 offset:2560
    v_mfma_f32_16x16x32_bf16 v[160:163], v[224:227], v[116:119], v[160:163]
    buffer_load_dwordx4 v[108:111], v25, s[20:23], s67 offen offset:3072 sc1
    buffer_load_dwordx4 v[112:115], v26, s[20:23], s67 offen offset:3072 sc1
    v_mfma_f32_16x16x32_bf16 v[176:179], v[224:227], v[120:123], v[176:179]
    s_waitcnt vmcnt(8) lgkmcnt(8)
    v_mfma_f32_16x16x32_bf16 v[148:151], v[180:183], v[124:127], v[148:151]
    v_mad_u32_u24 v52, s76, 5, v24
    v_xor_b32 v54, 64, v52
    v_mfma_f32_16x16x32_bf16 v[164:167], v[180:183], v[128:131], v[164:167]
    v_xor_b32 v53, 32, v52
    v_xor_b32 v55, 96, v52
    v_mfma_f32_16x16x32_bf16 v[152:155], v[184:187], v[124:127], v[152:155]
    ds_read_b64_tr_b16 v[212:213], v52 offset:0
    ds_read_b64_tr_b16 v[214:215], v54 offset:2560
    v_mfma_f32_16x16x32_bf16 v[168:171], v[184:187], v[128:131], v[168:171]
    ds_read_b64_tr_b16 v[216:217], v53 offset:0
    ds_read_b64_tr_b16 v[218:219], v55 offset:2560
    v_mfma_f32_16x16x32_bf16 v[156:159], v[188:191], v[124:127], v[156:159]
    ds_read_b64_tr_b16 v[220:221], v54 offset:0
    ds_read_b64_tr_b16 v[222:223], v52 offset:2560
    v_mfma_f32_16x16x32_bf16 v[172:175], v[188:191], v[128:131], v[172:175]
    ds_read_b64_tr_b16 v[224:225], v55 offset:0
    ds_read_b64_tr_b16 v[226:227], v53 offset:2560
    v_mfma_f32_16x16x32_bf16 v[160:163], v[192:195], v[124:127], v[160:163]
    v_sub_f32 v64, 1.0, v60
    v_cvt_pk_bf16_f32 v64, v64, v64
    v_mfma_f32_16x16x32_bf16 v[176:179], v[192:195], v[128:131], v[176:179]
    v_lshlrev_b32 v64, 16, v64
    v_sub_f32 v66, 1.0, v62
    s_waitcnt vmcnt(6) lgkmcnt(8)
    v_mfma_f32_16x16x32_bf16 v[148:151], v[196:199], v[132:135], v[148:151]
    ds_read_b64_tr_b16 v[180:181], v56 offset:40960
    ds_read_b64_tr_b16 v[182:183], v58 offset:43520
    v_mfma_f32_16x16x32_bf16 v[164:167], v[196:199], v[136:139], v[164:167]
    ds_read_b64_tr_b16 v[184:185], v57 offset:40960
    ds_read_b64_tr_b16 v[186:187], v59 offset:43520
    v_mfma_f32_16x16x32_bf16 v[152:155], v[200:203], v[132:135], v[152:155]
    ds_read_b64_tr_b16 v[188:189], v58 offset:40960
    ds_read_b64_tr_b16 v[190:191], v56 offset:43520
    v_mfma_f32_16x16x32_bf16 v[168:171], v[200:203], v[136:139], v[168:171]
    ds_read_b64_tr_b16 v[192:193], v59 offset:40960
    ds_read_b64_tr_b16 v[194:195], v57 offset:43520
    v_mfma_f32_16x16x32_bf16 v[156:159], v[204:207], v[132:135], v[156:159]
    v_cvt_pk_bf16_f32 v66, v66, v66
    v_lshlrev_b32 v66, 16, v66
    v_mfma_f32_16x16x32_bf16 v[172:175], v[204:207], v[136:139], v[172:175]
    v_pk_mul_f32 v[68:69], v[68:69], v[64:65] op_sel_hi:[1,0]
    v_pk_mul_f32 v[70:71], v[70:71], v[64:65] op_sel_hi:[1,0]
    v_mfma_f32_16x16x32_bf16 v[160:163], v[208:211], v[132:135], v[160:163]
    v_pk_mul_f32 v[72:73], v[72:73], v[64:65] op_sel_hi:[1,0]
    v_pk_mul_f32 v[74:75], v[74:75], v[64:65] op_sel_hi:[1,0]
    v_mfma_f32_16x16x32_bf16 v[176:179], v[208:211], v[136:139], v[176:179]
    v_pk_mul_f32 v[76:77], v[76:77], v[64:65] op_sel_hi:[1,0]
    v_pk_mul_f32 v[78:79], v[78:79], v[64:65] op_sel_hi:[1,0]
    s_waitcnt vmcnt(4) lgkmcnt(8)
    v_mfma_f32_16x16x32_bf16 v[148:151], v[212:215], v[140:143], v[148:151]
    ds_read_b64_tr_b16 v[196:197], v56 offset:61440
    ds_read_b64_tr_b16 v[198:199], v58 offset:64000
    v_mfma_f32_16x16x32_bf16 v[164:167], v[212:215], v[144:147], v[164:167]
    ds_read_b64_tr_b16 v[200:201], v57 offset:61440
    ds_read_b64_tr_b16 v[202:203], v59 offset:64000
    v_mfma_f32_16x16x32_bf16 v[152:155], v[216:219], v[140:143], v[152:155]
    ds_read_b64_tr_b16 v[204:205], v58 offset:61440
    ds_read_b64_tr_b16 v[206:207], v56 offset:64000
    v_mfma_f32_16x16x32_bf16 v[168:171], v[216:219], v[144:147], v[168:171]
    ds_read_b64_tr_b16 v[208:209], v59 offset:61440
    ds_read_b64_tr_b16 v[210:211], v57 offset:64000
    v_mfma_f32_16x16x32_bf16 v[156:159], v[220:223], v[140:143], v[156:159]
    v_pk_mul_f32 v[80:81], v[80:81], v[64:65] op_sel_hi:[1,0]
    v_pk_mul_f32 v[82:83], v[82:83], v[64:65] op_sel_hi:[1,0]
    v_mfma_f32_16x16x32_bf16 v[172:175], v[220:223], v[144:147], v[172:175]
    v_pk_mul_f32 v[84:85], v[84:85], v[66:67] op_sel_hi:[1,0]
    v_pk_mul_f32 v[86:87], v[86:87], v[66:67] op_sel_hi:[1,0]
    v_mfma_f32_16x16x32_bf16 v[160:163], v[224:227], v[140:143], v[160:163]
    v_pk_mul_f32 v[88:89], v[88:89], v[66:67] op_sel_hi:[1,0]
    v_pk_mul_f32 v[90:91], v[90:91], v[66:67] op_sel_hi:[1,0]
    v_mfma_f32_16x16x32_bf16 v[176:179], v[224:227], v[144:147], v[176:179]
    v_pk_mul_f32 v[92:93], v[92:93], v[66:67] op_sel_hi:[1,0]
    v_pk_mul_f32 v[94:95], v[94:95], v[66:67] op_sel_hi:[1,0]
    s_waitcnt vmcnt(2) lgkmcnt(8)
    v_mfma_f32_16x16x32_bf16 v[148:151], v[180:183], v[100:103], v[148:151]
    v_pk_mul_f32 v[96:97], v[96:97], v[66:67] op_sel_hi:[1,0]
    v_pk_mul_f32 v[98:99], v[98:99], v[66:67] op_sel_hi:[1,0]
    v_mfma_f32_16x16x32_bf16 v[152:155], v[184:187], v[100:103], v[152:155]
    v_mfma_f32_16x16x32_bf16 v[156:159], v[188:191], v[100:103], v[156:159]
    v_mfma_f32_16x16x32_bf16 v[160:163], v[192:195], v[100:103], v[160:163]
    s_sub_u32 s59, s56, s58
    s_cmp_lt_u32 s59, 32
    s_cbranch_scc1 K_YROW0
K_NOY0:
    s_sub_u32 s59, s57, s58
    s_cmp_lt_u32 s59, 32
    s_cbranch_scc1 K_YROW1
K_NOY1:
    s_waitcnt vmcnt(0) lgkmcnt(0)
    v_mfma_f32_16x16x32_bf16 v[148:151], v[196:199], v[108:111], v[148:151]
    v_mfma_f32_16x16x32_bf16 v[152:155], v[200:203], v[108:111], v[152:155]
    v_mfma_f32_16x16x32_bf16 v[156:159], v[204:207], v[108:111], v[156:159]
    v_mfma_f32_16x16x32_bf16 v[160:163], v[208:211], v[108:111], v[160:163]
    v_mfma_f32_16x16x32_bf16 v[164:167], v[180:183], v[104:107], v[164:167]
    v_mfma_f32_16x16x32_bf16 v[168:171], v[184:187], v[104:107], v[168:171]
    v_mfma_f32_16x16x32_bf16 v[172:175], v[188:191], v[104:107], v[172:175]
    s_nop 1
    v_pk_fma_f32 v[148:149], v[148:149], v[60:61], v[68:69] op_sel_hi:[1,0,1]
    v_pk_fma_f32 v[150:151], v[150:151], v[60:61], v[70:71] op_sel_hi:[1,0,1]
    v_cvt_pk_bf16_f32 v36, v148, v149
    v_mfma_f32_16x16x32_bf16 v[176:179], v[192:195], v[104:107], v[176:179]
    v_cvt_pk_bf16_f32 v37, v150, v151
    ds_write_b64 v29, v[36:37] offset:0
    v_pk_fma_f32 v[152:153], v[152:153], v[60:61], v[72:73] op_sel_hi:[1,0,1]
    v_mfma_f32_16x16x32_bf16 v[164:167], v[196:199], v[112:115], v[164:167]
    v_pk_fma_f32 v[154:155], v[154:155], v[60:61], v[74:75] op_sel_hi:[1,0,1]
    v_cvt_pk_bf16_f32 v38, v152, v153
    v_cvt_pk_bf16_f32 v39, v154, v155
    v_mfma_f32_16x16x32_bf16 v[168:171], v[200:203], v[112:115], v[168:171]
    ds_write_b64 v30, v[38:39] offset:0
    v_pk_fma_f32 v[156:157], v[156:157], v[60:61], v[76:77] op_sel_hi:[1,0,1]
    v_pk_fma_f32 v[158:159], v[158:159], v[60:61], v[78:79] op_sel_hi:[1,0,1]
    v_mfma_f32_16x16x32_bf16 v[172:175], v[204:207], v[112:115], v[172:175]
    v_cvt_pk_bf16_f32 v40, v156, v157
    v_cvt_pk_bf16_f32 v41, v158, v159
    ds_write_b64 v31, v[40:41] offset:0
    v_mfma_f32_16x16x32_bf16 v[176:179], v[208:211], v[112:115], v[176:179]
    v_pk_fma_f32 v[160:161], v[160:161], v[60:61], v[80:81] op_sel_hi:[1,0,1]
    v_pk_fma_f32 v[162:163], v[162:163], v[60:61], v[82:83] op_sel_hi:[1,0,1]
    v_cvt_pk_bf16_f32 v42, v160, v161
    v_cvt_pk_bf16_f32 v43, v162, v163
    ds_write_b64 v32, v[42:43] offset:0
    ds_read_b128 v[68:71], v33 offset:0
    ds_read_b128 v[72:75], v33 offset:1024
    v_pk_fma_f32 v[164:165], v[164:165], v[62:63], v[84:85] op_sel_hi:[1,0,1]
    v_pk_fma_f32 v[166:167], v[166:167], v[62:63], v[86:87] op_sel_hi:[1,0,1]
    v_cvt_pk_bf16_f32 v44, v164, v165
    v_cvt_pk_bf16_f32 v45, v166, v167
    ds_write_b64 v29, v[44:45] offset:2048
    v_pk_fma_f32 v[168:169], v[168:169], v[62:63], v[88:89] op_sel_hi:[1,0,1]
    v_pk_fma_f32 v[170:171], v[170:171], v[62:63], v[90:91] op_sel_hi:[1,0,1]
    v_cvt_pk_bf16_f32 v46, v168, v169
    v_cvt_pk_bf16_f32 v47, v170, v171
    ds_write_b64 v30, v[46:47] offset:2048
    v_pk_fma_f32 v[172:173], v[172:173], v[62:63], v[92:93] op_sel_hi:[1,0,1]
    s_waitcnt lgkmcnt(2)
    buffer_store_dwordx4 v[68:71], v27, s[48:51], s71 offen sc1
    buffer_store_dwordx4 v[72:75], v28, s[48:51], s72 offen sc1
    v_pk_fma_f32 v[174:175], v[174:175], v[62:63], v[94:95] op_sel_hi:[1,0,1]
    v_cvt_pk_bf16_f32 v48, v172, v173
    v_cvt_pk_bf16_f32 v49, v174, v175
    ds_write_b64 v31, v[48:49] offset:2048
    v_pk_fma_f32 v[176:177], v[176:177], v[62:63], v[96:97] op_sel_hi:[1,0,1]
    v_pk_fma_f32 v[178:179], v[178:179], v[62:63], v[98:99] op_sel_hi:[1,0,1]
    v_cvt_pk_bf16_f32 v50, v176, v177
    v_cvt_pk_bf16_f32 v51, v178, v179
    ds_write_b64 v32, v[50:51] offset:2048
    ds_read_b128 v[84:87], v33 offset:2048
    ds_read_b128 v[88:91], v33 offset:3072
    s_waitcnt lgkmcnt(1)
    buffer_store_dwordx4 v[84:87], v27, s[48:51], s73 offen sc1
    s_waitcnt lgkmcnt(0)
    buffer_store_dwordx4 v[88:91], v28, s[48:51], s74 offen sc1
K_END:
K_EXIT:
    s_endpgm
.p2align 12
WP_spin:
    s_setpc_b64 s[38:39]
K_SP0:
    ds_read_b32 v2, v12 offset:32
    s_waitcnt lgkmcnt(0)
    v_readfirstlane_b32 s33, v2
    s_nop 3
    s_lshr_b32 s63, s33, s64
    s_lshr_b32 s33, s33, s65
    s_and_b32 s63, s63, s33
    s_and_b32 s63, s63, 0xff
    s_andn2_b32 s63, s63, s66
    s_cbranch_scc0 K_SP0
    s_or_b32 s66, s66, s63
    s_branch K_SPR0
K_SP1:
    ds_read_b32 v2, v12 offset:32
    s_waitcnt lgkmcnt(0)
    v_readfirstlane_b32 s33, v2
    s_nop 3
    s_lshr_b32 s63, s33, s64
    s_lshr_b32 s33, s33, s65
    s_and_b32 s63, s63, s33
    s_and_b32 s63, s63, 0xff
    s_andn2_b32 s63, s63, s66
    s_cbranch_scc0 K_SP1
    s_or_b32 s66, s66, s63
    s_branch K_SPR1
K_SP2:
    ds_read_b32 v2, v12 offset:32
    s_waitcnt lgkmcnt(0)
    v_readfirstlane_b32 s33, v2
    s_nop 3
    s_lshr_b32 s63, s33, s64
    s_lshr_b32 s33, s33, s65
    s_and_b32 s63, s63, s33
    s_and_b32 s63, s63, 0xff
    s_andn2_b32 s63, s63, s66
    s_cbranch_scc0 K_SP2
    s_or_b32 s66, s66, s63
    s_branch K_SPR2
K_SP3:
    ds_read_b32 v2, v12 offset:32
    s_waitcnt lgkmcnt(0)
    v_readfirstlane_b32 s33, v2
    s_nop 3
    s_lshr_b32 s63, s33, s64
    s_lshr_b32 s33, s33, s65
    s_and_b32 s63, s63, s33
    s_and_b32 s63, s63, 0xff
    s_andn2_b32 s63, s63, s66
    s_cbranch_scc0 K_SP3
    s_or_b32 s66, s66, s63
    s_branch K_SPR3
K_SP4:
    ds_read_b32 v2, v12 offset:32
    s_waitcnt lgkmcnt(0)
    v_readfirstlane_b32 s33, v2
    s_nop 3
    s_lshr_b32 s63, s33, s64
    s_lshr_b32 s33, s33, s65
    s_and_b32 s63, s63, s33
    s_and_b32 s63, s63, 0xff
    s_andn2_b32 s63, s63, s66
    s_cbranch_scc0 K_SP4
    s_or_b32 s66, s66, s63
    s_branch K_SPR4
K_SP5:
    ds_read_b32 v2, v12 offset:32
    s_waitcnt lgkmcnt(0)
    v_readfirstlane_b32 s33, v2
    s_nop 3
    s_lshr_b32 s63, s33, s64
    s_lshr_b32 s33, s33, s65
    s_and_b32 s63, s63, s33
    s_and_b32 s63, s63, 0xff
    s_andn2_b32 s63, s63, s66
    s_cbranch_scc0 K_SP5
    s_or_b32 s66, s66, s63
    s_branch K_SPR5
K_SP6:
    ds_read_b32 v2, v12 offset:32
    s_waitcnt lgkmcnt(0)
    v_readfirstlane_b32 s33, v2
    s_nop 3
    s_lshr_b32 s63, s33, s64
    s_lshr_b32 s33, s33, s65
    s_and_b32 s63, s63, s33
    s_and_b32 s63, s63, 0xff
    s_andn2_b32 s63, s63, s66
    s_cbranch_scc0 K_SP6
    s_or_b32 s66, s66, s63
    s_branch K_SPR6
K_SP7:
    ds_read_b32 v2, v12 offset:32
    s_waitcnt lgkmcnt(0)
    v_readfirstlane_b32 s33, v2
    s_nop 3
    s_lshr_b32 s63, s33, s64
    s_lshr_b32 s33, s33, s65
    s_and_b32 s63, s63, s33
    s_and_b32 s63, s63, 0xff
    s_andn2_b32 s63, s63, s66
    s_cbranch_scc0 K_SP7
    s_or_b32 s66, s66, s63
    s_branch K_SPR7
K_SP10:
    ds_read_b32 v2, v12 offset:32
    s_waitcnt lgkmcnt(0)
    v_readfirstlane_b32 s33, v2
    s_nop 3
    s_lshr_b32 s63, s33, s64
    s_lshr_b32 s33, s33, s65
    s_and_b32 s63, s63, s33
    s_and_b32 s63, s63, 0xff00
    s_andn2_b32 s63, s63, s66
    s_cbranch_scc0 K_SP10
    s_or_b32 s66, s66, s63
    s_branch K_SPR10
K_SP11:
    ds_read_b32 v2, v12 offset:32
    s_waitcnt lgkmcnt(0)
    v_readfirstlane_b32 s33, v2
    s_nop 3
    s_lshr_b32 s63, s33, s64
    s_lshr_b32 s33, s33, s65
    s_and_b32 s63, s63, s33
    s_and_b32 s63, s63, 0xff00
    s_andn2_b32 s63, s63, s66
    s_cbranch_scc0 K_SP11
    s_or_b32 s66, s66, s63
    s_branch K_SPR11
K_SP12:
    ds_read_b32 v2, v12 offset:32
    s_waitcnt lgkmcnt(0)
    v_readfirstlane_b32 s33, v2
    s_nop 3
    s_lshr_b32 s63, s33, s64
    s_lshr_b32 s33, s33, s65
    s_and_b32 s63, s63, s33
    s_and_b32 s63, s63, 0xff00
    s_andn2_b32 s63, s63, s66
    s_cbranch_scc0 K_SP12
    s_or_b32 s66, s66, s63
    s_branch K_SPR12
K_SP13:
    ds_read_b32 v2, v12 offset:32
    s_waitcnt lgkmcnt(0)
    v_readfirstlane_b32 s33, v2
    s_nop 3
    s_lshr_b32 s63, s33, s64
    s_lshr_b32 s33, s33, s65
    s_and_b32 s63, s63, s33
    s_and_b32 s63, s63, 0xff00
    s_andn2_b32 s63, s63, s66
    s_cbranch_scc0 K_SP13
    s_or_b32 s66, s66, s63
    s_branch K_SPR13
K_SP14:
    ds_read_b32 v2, v12 offset:32
    s_waitcnt lgkmcnt(0)
    v_readfirstlane_b32 s33, v2
    s_nop 3
    s_lshr_b32 s63, s33, s64
    s_lshr_b32 s33, s33, s65
    s_and_b32 s63, s63, s33
    s_and_b32 s63, s63, 0xff00
    s_andn2_b32 s63, s63, s66
    s_cbranch_scc0 K_SP14
    s_or_b32 s66, s66, s63
    s_branch K_SPR14
K_SP15:
    ds_read_b32 v2, v12 offset:32
    s_waitcnt lgkmcnt(0)
    v_readfirstlane_b32 s33, v2
    s_nop 3
    s_lshr_b32 s63, s33, s64
    s_lshr_b32 s33, s33, s65
    s_and_b32 s63, s63, s33
    s_and_b32 s63, s63, 0xff00
    s_andn2_b32 s63, s63, s66
    s_cbranch_scc0 K_SP15
    s_or_b32 s66, s66, s63
    s_branch K_SPR15
K_SP16:
    ds_read_b32 v2, v12 offset:32
    s_waitcnt lgkmcnt(0)
    v_readfirstlane_b32 s33, v2
    s_nop 3
    s_lshr_b32 s63, s33, s64
    s_lshr_b32 s33, s33, s65
    s_and_b32 s63, s63, s33
    s_and_b32 s63, s63, 0xff00
    s_andn2_b32 s63, s63, s66
    s_cbranch_scc0 K_SP16
    s_or_b32 s66, s66, s63
    s_branch K_SPR16
K_SP17:
    ds_read_b32 v2, v12 offset:32
    s_waitcnt lgkmcnt(0)
    v_readfirstlane_b32 s33, v2
    s_nop 3
    s_lshr_b32 s63, s33, s64
    s_lshr_b32 s33, s33, s65
    s_and_b32 s63, s63, s33
    s_and_b32 s63, s63, 0xff00
    s_andn2_b32 s63, s63, s66
    s_cbranch_scc0 K_SP17
    s_or_b32 s66, s66, s63
    s_branch K_SPR17
WP_yr0:
    s_setpc_b64 s[38:39]
K_YROW0:
    v_lshlrev_b32 v5, 4, v9
    v_add_u32 v5, 158976, v5
    v_and_b32 v3, 15, v1
    s_and_b32 s33, s59, 15
    v_cmp_eq_u32 vcc, s33, v3
    s_mov_b32 s3, 1048576
K_P2_GY0:
    ds_read_b32 v2, v12 offset:64
    s_sub_u32 s3, s3, 1
    s_waitcnt lgkmcnt(0)
    v_readfirstlane_b32 s33, v2
    s_nop 3
    s_cselect_b32 s33, 1, s33
    s_cmp_lt_u32 s33, 1
    s_cbranch_scc1 K_P2_GY0
    s_mov_b64 exec, vcc
    s_cmp_ge_u32 s59, 16
    s_cbranch_scc1 K_YR1_0
    ds_read_b128 v[68:71], v5 offset:0
    ds_read_b128 v[72:75], v5 offset:64
    ds_read_b128 v[76:79], v5 offset:128
    ds_read_b128 v[80:83], v5 offset:192
    s_mov_b64 exec, -1
    s_branch K_NOY0
K_YR1_0:
    ds_read_b128 v[84:87], v5 offset:0
    ds_read_b128 v[88:91], v5 offset:64
    ds_read_b128 v[92:95], v5 offset:128
    ds_read_b128 v[96:99], v5 offset:192
    s_mov_b64 exec, -1
    s_branch K_NOY0
K_YROW1:
    v_lshlrev_b32 v5, 4, v9
    v_add_u32 v5, 159232, v5
    v_and_b32 v3, 15, v1
    s_and_b32 s33, s59, 15
    v_cmp_eq_u32 vcc, s33, v3
    s_mov_b32 s3, 1048576
K_P2_GY1:
    ds_read_b32 v2, v12 offset:68
    s_sub_u32 s3, s3, 1
    s_waitcnt lgkmcnt(0)
    v_readfirstlane_b32 s33, v2
    s_nop 3
    s_cselect_b32 s33, 1, s33
    s_cmp_lt_u32 s33, 1
    s_cbranch_scc1 K_P2_GY1
    s_mov_b64 exec, vcc
    s_cmp_ge_u32 s59, 16
    s_cbranch_scc1 K_YR1_1
    ds_read_b128 v[68:71], v5 offset:0
    ds_read_b128 v[72:75], v5 offset:64
    ds_read_b128 v[76:79], v5 offset:128
    ds_read_b128 v[80:83], v5 offset:192
    s_mov_b64 exec, -1
    s_branch K_NOY1
K_YR1_1:
    ds_read_b128 v[84:87], v5 offset:0
    ds_read_b128 v[88:91], v5 offset:64
    ds_read_b128 v[92:95], v5 offset:128
    ds_read_b128 v[96:99], v5 offset:192
    s_mov_b64 exec, -1
    s_branch K_NOY1
.p2align 12
WP_gen:
    s_setpc_b64 s[38:39]
K_P2:
    s_cmp_ge_u32 s30, 4
    s_cbranch_scc1 K_P2_HELP
    s_lshl_b32 s54, s40, 7
    v_lshrrev_b32 v9, 4, v1
    v_mov_b32 v12, 158720
    s_add_u32 s20, s10, 0x100000
    s_addc_u32 s21, s11, 0
    s_mov_b32 s22, 0x280000
    s_mov_b32 s23, 0x20000
    s_add_u32 s16, s10, 0x1000
    s_addc_u32 s17, s11, 0
    s_mov_b32 s18, 0x2000
    s_mov_b32 s19, 0x20000
    s_mov_b32 s48, s6
    s_mov_b32 s49, s7
    s_mov_b32 s50, 0x280000
    s_mov_b32 s51, 0x20000
    s_lshl_b32 s53, s40, 3
    s_lshl1_add_u32 s53, s30, s53
    s_mov_b32 s55, 20480
    v_bfe_u32 v20, v1, 2, 2
    v_and_b32 v21, 3, v1
    s_mul_i32 s3, s53, 20480
    v_lshl_add_u32 v25, v1, 4, s3
    v_add_u32 v26, 20480, v25
    v_and_b32 v2, 15, v1
    s_lshl_b32 s3, s53, 6
    v_lshl_add_u32 v23, v2, 2, s3
    v_lshl_add_u32 v2, v9, 2, v20
    v_bfe_u32 v3, v2, 1, 2
    v_lshlrev_b32 v2, 7, v2
    v_lshl_add_u32 v2, v21, 3, v2
    v_lshl_add_u32 v24, v3, 5, v2
    v_lshrrev_b32 v3, 1, v20
    v_mul_u32_u24 v2, 40, v9
    v_add3_u32 v2, v2, 16, v20
    v_lshlrev_b32 v2, 7, v2
    v_lshl_add_u32 v2, v21, 3, v2
    v_xor_b32 v4, 0, v3
    v_lshl_add_u32 v56, v4, 5, v2
    v_xor_b32 v4, 1, v3
    v_lshl_add_u32 v57, v4, 5, v2
    v_xor_b32 v4, 2, v3
    v_lshl_add_u32 v58, v4, 5, v2
    v_xor_b32 v4, 3, v3
    v_lshl_add_u32 v59, v4, 5, v2
    v_lshrrev_b32 v3, 4, v1
    v_and_b32 v4, 7, v1
    v_lshrrev_b32 v2, 3, v1
    v_xor_b32 v4, v4, v3
    v_mul_u32_u24 v2, 1280, v2
    v_lshl_add_u32 v27, v4, 4, v2
    v_xor_b32 v28, 64, v27
    s_lshl_b32 s71, s40, 3
    s_lshl1_add_u32 s71, s30, s71
    s_mul_i32 s71, s71, 20480
    s_lshl_b32 s33, s41, 7
    s_add_u32 s71, s71, s33
    s_add_u32 s72, s71, 10240
    s_add_u32 s73, s71, 20480
    s_add_u32 s74, s71, 30720
    s_lshl_b32 s3, s30, 12
    s_add_u32 s3, s3, 140288
    v_lshl_add_u32 v33, v1, 4, s3
    v_and_b32 v2, 15, v1
    v_lshrrev_b32 v3, 1, v2
    v_lshrrev_b32 v4, 5, v1
    v_xor_b32 v3, v3, v4
    v_lshlrev_b32 v3, 4, v3
    v_lshl_add_u32 v3, v2, 7, v3
    v_and_b32 v4, 1, v9
    v_lshl_add_u32 v3, v4, 3, v3
    v_add_u32 v29, s3, v3
    v_xor_b32 v30, 32, v29
    v_xor_b32 v31, 64, v29
    v_xor_b32 v32, 96, v29
    s_lshl_b32 s3, s40, 3
    s_mul_i32 s33, s3, 187
    s_lshr_b32 s33, s33, 11
    s_add_u32 s33, s33, 1
    s_mul_i32 s33, s33, 11
    s_cmp_ge_u32 s53, s33
    s_cselect_b32 s64, 16, 0
    s_add_u32 s3, s53, 1
    s_cmp_ge_u32 s3, s33
    s_cselect_b32 s65, 16, 0
    s_mov_b32 s63, 0
    s_mov_b32 s66, 0
    s_mov_b32 s67, 16384
    s_cmp_eq_u32 s30, 0
    s_cbranch_scc1 K_P2_AUXW
    v_lshrrev_b32 v2, 3, v1
    v_mul_u32_u24 v2, 1280, v2
    v_lshrrev_b32 v3, 4, v1
    v_lshlrev_b32 v3, 1, v3
    v_and_b32 v4, 7, v1
    v_xor_b32 v3, v3, v4
    v_lshl_add_u32 v2, v3, 4, v2
    s_lshl_b32 s33, s41, 7
    v_add_u32 v22, s33, v2
    s_mov_b32 s60, 0xfda87520
    s_mov_b32 s61, 0xecb96431
    s_sub_u32 s58, s30, 1
K_P2_WS:
    s_lshl_b32 s3, s58, 2
    s_lshr_b64 s[4:5], s[60:61], s3
    s_and_b32 s4, s4, 15
    s_mul_i32 s4, s4, 51200
    s_mul_i32 s59, s58, 5120
    s_add_u32 s52, s4, 0
    s_add_u32 m0, s59, 0
    s_waitcnt vmcnt(11)
    buffer_load_dwordx4 v22, s[24:27], s52 offen lds
    s_add_u32 s52, s4, 10240
    s_add_u32 m0, s59, 1024
    s_waitcnt vmcnt(11)
    buffer_load_dwordx4 v22, s[24:27], s52 offen lds
    s_add_u32 s52, s4, 20480
    s_add_u32 m0, s59, 2048
    s_waitcnt vmcnt(11)
    buffer_load_dwordx4 v22, s[24:27], s52 offen lds
    s_add_u32 s52, s4, 30720
    s_add_u32 m0, s59, 3072
    s_waitcnt vmcnt(11)
    buffer_load_dwordx4 v22, s[24:27], s52 offen lds
    s_add_u32 s52, s4, 40960
    s_add_u32 m0, s59, 4096
    s_waitcnt vmcnt(11)
    buffer_load_dwordx4 v22, s[24:27], s52 offen lds
    s_cmp_ge_u32 s58, 3
    s_cbranch_scc1 K_P2_WS1
    v_mov_b32 v3, 1
    s_waitcnt vmcnt(5)
    s_mov_b64 exec, 1
    ds_add_u32 v12, v3 offset:52
    s_mov_b64 exec, -1
K_P2_WS1:
    s_add_u32 s58, s58, 3
    s_cmp_lt_u32 s58, 16
    s_cbranch_scc1 K_P2_WS
K_P2_AUXW:
    s_lshl_b32 s33, s30, 12
    s_add_u32 m0, s33, 140288
    s_add_u32 s3, s71, 0
    buffer_load_dwordx4 v27, s[12:15], s3 offen lds
    s_add_u32 m0, s33, 141312
    s_add_u32 s3, s71, 10240
    buffer_load_dwordx4 v28, s[12:15], s3 offen lds
    s_add_u32 m0, s33, 142336
    s_add_u32 s3, s71, 20480
    buffer_load_dwordx4 v27, s[12:15], s3 offen lds
    s_add_u32 m0, s33, 143360
    s_add_u32 s3, s71, 30720
    buffer_load_dwordx4 v28, s[12:15], s3 offen lds
    v_mov_b32 v3, 1
    s_waitcnt vmcnt(0)
    s_mov_b64 exec, 1
    ds_add_u32 v12, v3 offset:44
    s_mov_b64 exec, -1
    s_mov_b32 s3, 1048576
K_P2_GWA:
    ds_read_b32 v2, v12 offset:44
    s_sub_u32 s3, s3, 1
    s_waitcnt lgkmcnt(0)
    v_readfirstlane_b32 s33, v2
    s_nop 3
    s_cselect_b32 s33, 4, s33
    s_cmp_lt_u32 s33, 4
    s_cbranch_scc1 K_P2_GWA
    s_branch K_P2_GEMM
WP_help:
    s_setpc_b64 s[38:39]
K_P2_HELP:
    s_setprio 3
    s_lshl_b32 s53, s40, 3
    s_mul_i32 s58, s53, 187
    s_lshr_b32 s58, s58, 11
    s_add_u32 s3, s53, 7
    s_mul_i32 s59, s3, 187
    s_lshr_b32 s59, s59, 11
    s_sub_u32 s59, s59, s58
    s_lshl_b32 s59, s59, 4
    s_or_b32 s59, s59, 15
    v_and_b32 v10, s59, v1
    v_lshl_add_u32 v10, v10, 2, s42
    s_cmp_lg_u32 s30, 7
    s_cbranch_scc1 K_P2_N7
    v_and_b32 v4, 7, v1
    v_lshlrev_b32 v4, 2, v4
    s_mov_b32 s3, 131072
K_ZPOLL1:
    v_cmp_eq_u32 vcc, 0, v7
    s_cbranch_vccz K_ZOK1
    s_sub_u32 s3, s3, 1
    s_cbranch_scc1 K_ZOK1
    global_load_dword v7, v4, s[8:9] offset:192 sc1
    s_waitcnt vmcnt(0)
    s_branch K_ZPOLL1
K_ZOK1:
    global_load_dword v7, v10, s[10:11] sc1
K_P2_N7:
    s_lshl_b32 s54, s40, 7
    v_lshrrev_b32 v9, 4, v1
    v_mov_b32 v12, 158720
    s_add_u32 s44, s10, 0x10000
    s_addc_u32 s45, s11, 0
    s_mov_b32 s46, 0x43800
    s_mov_b32 s47, 0x20000
    v_mov_b32 v80, 1
    s_cmp_eq_u32 s30, 7
    s_cbranch_scc1 K_P2_FLAGS
    s_cmp_lg_u32 s30, 6
    s_cbranch_scc1 K_P2_HW
    s_mov_b32 s3, 131072
K_P2_DPOLL:
    v_cmp_eq_u32 vcc, 0, v7
    s_cbranch_vccz K_P2_DOK
    s_cmp_eq_u32 s3, 131072
    s_cbranch_scc1 K_P2_DNS
    s_sleep 12
K_P2_DNS:
    v_and_b32 v11, 1, v1
    v_lshl_add_u32 v11, v11, 2, s42
    global_load_dword v7, v11, s[10:11] offset:128 sc1
    s_sub_u32 s3, s3, 1
    s_waitcnt vmcnt(0)
    s_cmp_lg_u32 s3, 0
    s_cbranch_scc1 K_P2_DPOLL
K_P2_DOK:
    v_readlane_b32 s58, v7, 0
    v_readlane_b32 s59, v7, 1
    s_nop 3
    s_and_b32 s3, s58, 0x7ff
    s_sub_u32 s3, 2047, s3
    v_mov_b32 v20, s3
    v_mov_b32 v4, s58
    v_and_b32 v4, 0xffff0000, v4
    v_ashrrev_i32 v5, 31, v4
    v_not_b32 v5, v5
    v_or_b32 v5, 0x80000000, v5
    v_xor_b32 v4, v4, v5
    v_and_b32 v4, 0xffff0000, v4
    v_mul_f32 v5, 0xbfb8aa3b, v4
    v_exp_f32 v5, v5
    s_nop 0
    v_add_f32 v5, 1.0, v5
    v_rcp_f32 v4, v5
    s_nop 0
    v_cvt_pk_bf16_f32 v22, v4, v4
    v_lshlrev_b32 v22, 16, v22
    s_and_b32 s3, s59, 0x7ff
    s_sub_u32 s3, 2047, s3
    v_mov_b32 v21, s3
    v_mov_b32 v4, s59
    v_and_b32 v4, 0xffff0000, v4
    v_ashrrev_i32 v5, 31, v4
    v_not_b32 v5, v5
    v_or_b32 v5, 0x80000000, v5
    v_xor_b32 v4, v4, v5
    v_and_b32 v4, 0xffff0000, v4
    v_mul_f32 v5, 0xbfb8aa3b, v4
    v_exp_f32 v5, v5
    s_nop 0
    v_add_f32 v5, 1.0, v5
    v_rcp_f32 v4, v5
    s_nop 0
    v_cvt_pk_bf16_f32 v23, v4, v4
    v_lshlrev_b32 v23, 16, v23
    ds_write_b128 v12, v[20:23]
    ds_write_b32 v12, v80 offset:40
    s_branch K_END
K_P2_HW:
    s_mov_b32 s3, 1048576
K_P2_GS2:
    ds_read_b32 v2, v12 offset:40
    s_sleep 1
    s_sub_u32 s3, s3, 1
    s_waitcnt lgkmcnt(0)
    v_readfirstlane_b32 s33, v2
    s_nop 3
    s_cselect_b32 s33, 1, s33
    s_cmp_lt_u32 s33, 1
    s_cbranch_scc1 K_P2_GS2
    ds_read_b128 v[16:19], v12
    s_waitcnt lgkmcnt(0)
    s_cmp_eq_u32 s30, 4
    s_cselect_b64 vcc, -1, 0
    s_nop 1
    v_cndmask_b32 v2, v17, v16, vcc
    v_cndmask_b32 v5, v19, v18, vcc
    s_nop 0
    v_readfirstlane_b32 s58, v2
    s_nop 3
    s_sub_u32 s3, s58, s54
    s_cmp_lt_u32 s3, 128
    s_cbranch_scc0 K_END
    s_call_b64 s[38:39], WP_yr0
    s_mul_i32 s3, s58, 1280
    s_lshl_b32 s33, s41, 7
    s_add_u32 s3, s3, s33
    v_and_b32 v2, 15, v1
    v_lshlrev_b32 v2, 3, v2
    buffer_load_dwordx2 v[84:85], v2, s[12:15], s3 offen
    s_lshl_b32 s3, s58, 2
    s_add_u32 s3, s3, 4096
    v_mov_b32 v2, s3
    global_load_dword v88, v2, s[10:11] sc1
    v_min_u32 v3, 53, v1
    v_lshlrev_b32 v3, 5, v3
    v_add_u32 v3, 565248, v3
    s_mov_b32 s3, 1048576
K_P2_GY:
    ds_read_b32 v2, v12 offset:32
    s_sleep 1
    s_sub_u32 s3, s3, 1
    s_waitcnt lgkmcnt(0)
    v_readfirstlane_b32 s33, v2
    s_nop 3
    s_cselect_b32 s33, 255, s33
    s_and_b32 s33, s33, 255
    s_cmp_lt_u32 s33, 255
    s_cbranch_scc1 K_P2_GY
    s_mov_b32 s3, 131072
K_P2_YPOLL:
    global_load_dwordx4 v[20:23], v3, s[10:11] sc1
    s_sub_u32 s3, s3, 1
    s_waitcnt vmcnt(0)
    v_and_b32 v2, v20, v21
    v_and_b32 v2, v2, v22
    v_and_b32 v2, v2, v23
    v_cmp_ne_u32 vcc, 1, v2
    s_cbranch_vccz K_P2_YGO
    s_sleep 8
    s_cmp_lg_u32 s3, 0
    s_cbranch_scc1 K_P2_YPOLL
K_P2_YGO:
    v_and_b32 v2, 15, v1
    v_lshlrev_b32 v2, 4, v2
    v_mul_u32_u24 v4, 5120, v9
    s_sub_u32 s59, s30, 4
    s_mul_i32 s33, s59, 2560
    s_lshl_b32 s3, s41, 8
    s_add_u32 s3, s3, s33
    v_add3_u32 v3, v2, v4, s3
    s_mov_b32 s52, 0
    buffer_load_dwordx4 v[24:27], v3, s[44:47], s52 offen sc1
    s_mov_b32 s52, 20480
    buffer_load_dwordx4 v[28:31], v3, s[44:47], s52 offen sc1
    s_mov_b32 s52, 40960
    buffer_load_dwordx4 v[32:35], v3, s[44:47], s52 offen sc1
    s_mov_b32 s52, 61440
    buffer_load_dwordx4 v[36:39], v3, s[44:47], s52 offen sc1
    s_mov_b32 s52, 81920
    buffer_load_dwordx4 v[40:43], v3, s[44:47], s52 offen sc1
    s_mov_b32 s52, 102400
    buffer_load_dwordx4 v[44:47], v3, s[44:47], s52 offen sc1
    s_mov_b32 s52, 122880
    buffer_load_dwordx4 v[48:51], v3, s[44:47], s52 offen sc1
    s_mov_b32 s52, 143360
    buffer_load_dwordx4 v[52:55], v3, s[44:47], s52 offen sc1
    s_mov_b32 s52, 163840
    buffer_load_dwordx4 v[56:59], v3, s[44:47], s52 offen sc1
    s_mov_b32 s52, 184320
    buffer_load_dwordx4 v[60:63], v3, s[44:47], s52 offen sc1
    s_mov_b32 s52, 204800
    buffer_load_dwordx4 v[64:67], v3, s[44:47], s52 offen sc1
    s_mov_b32 s52, 225280
    buffer_load_dwordx4 v[68:71], v3, s[44:47], s52 offen sc1
    s_mov_b32 s52, 245760
    buffer_load_dwordx4 v[72:75], v3, s[44:47], s52 offen sc1
    s_mov_b32 s52, 266240
    buffer_load_dwordx4 v[76:79], v3, s[44:47], s52 offen sc1
    v_sub_f32 v88, 1.0, v88
    v_cvt_pk_bf16_f32 v88, v88, v88
    v_lshlrev_b32 v88, 16, v88
    v_lshlrev_b32 v86, 16, v85
    v_and_b32 v87, 0xffff0000, v85
    v_and_b32 v85, 0xffff0000, v84
    v_lshlrev_b32 v84, 16, v84
    s_waitcnt vmcnt(12)
    v_add_f32 v20, v24, v28
    v_add_f32 v21, v25, v29
    v_add_f32 v22, v26, v30
    v_add_f32 v23, v27, v31
    s_waitcnt vmcnt(11)
    v_add_f32 v20, v20, v32
    v_add_f32 v21, v21, v33
    v_add_f32 v22, v22, v34
    v_add_f32 v23, v23, v35
    s_waitcnt vmcnt(10)
    v_add_f32 v20, v20, v36
    v_add_f32 v21, v21, v37
    v_add_f32 v22, v22, v38
    v_add_f32 v23, v23, v39
    s_waitcnt vmcnt(9)
    v_add_f32 v20, v20, v40
    v_add_f32 v21, v21, v41
    v_add_f32 v22, v22, v42
    v_add_f32 v23, v23, v43
    s_waitcnt vmcnt(8)
    v_add_f32 v20, v20, v44
    v_add_f32 v21, v21, v45
    v_add_f32 v22, v22, v46
    v_add_f32 v23, v23, v47
    s_waitcnt vmcnt(7)
    v_add_f32 v20, v20, v48
    v_add_f32 v21, v21, v49
    v_add_f32 v22, v22, v50
    v_add_f32 v23, v23, v51
    s_waitcnt vmcnt(6)
    v_add_f32 v20, v20, v52
    v_add_f32 v21, v21, v53
    v_add_f32 v22, v22, v54
    v_add_f32 v23, v23, v55
    s_waitcnt vmcnt(5)
    v_add_f32 v20, v20, v56
    v_add_f32 v21, v21, v57
    v_add_f32 v22, v22, v58
    v_add_f32 v23, v23, v59
    s_waitcnt vmcnt(4)
    v_add_f32 v20, v20, v60
    v_add_f32 v21, v21, v61
    v_add_f32 v22, v22, v62
    v_add_f32 v23, v23, v63
    s_waitcnt vmcnt(3)
    v_add_f32 v20, v20, v64
    v_add_f32 v21, v21, v65
    v_add_f32 v22, v22, v66
    v_add_f32 v23, v23, v67
    s_waitcnt vmcnt(2)
    v_add_f32 v20, v20, v68
    v_add_f32 v21, v21, v69
    v_add_f32 v22, v22, v70
    v_add_f32 v23, v23, v71
    s_waitcnt vmcnt(1)
    v_add_f32 v20, v20, v72
    v_add_f32 v21, v21, v73
    v_add_f32 v22, v22, v74
    v_add_f32 v23, v23, v75
    s_waitcnt vmcnt(0)
    v_add_f32 v20, v20, v76
    v_add_f32 v21, v21, v77
    v_add_f32 v22, v22, v78
    v_add_f32 v23, v23, v79
    v_mov_b32 v24, v20
    v_mov_b32 v25, v21
    v_mov_b32 v26, v22
    v_mov_b32 v27, v23
    s_nop 0
    v_permlane16_swap_b32 v20, v24
    v_permlane16_swap_b32 v21, v25
    v_permlane16_swap_b32 v22, v26
    v_permlane16_swap_b32 v23, v27
    v_add_f32 v20, v20, v24
    v_add_f32 v21, v21, v25
    v_add_f32 v22, v22, v26
    v_add_f32 v23, v23, v27
    v_mov_b32 v24, v20
    v_mov_b32 v25, v21
    v_mov_b32 v26, v22
    v_mov_b32 v27, v23
    s_nop 0
    v_permlane32_swap_b32 v20, v24
    v_permlane32_swap_b32 v21, v25
    v_permlane32_swap_b32 v22, v26
    v_permlane32_swap_b32 v23, v27
    v_add_f32 v20, v20, v24
    v_add_f32 v21, v21, v25
    v_add_f32 v22, v22, v26
    v_add_f32 v23, v23, v27
    v_cvt_pk_bf16_f32 v20, v20, v20
    v_lshlrev_b32 v20, 16, v20
    v_mul_f32 v20, v5, v20
    v_cvt_pk_bf16_f32 v20, v20, v20
    v_lshlrev_b32 v20, 16, v20
    v_add_f32 v20, v20, v84
    v_cvt_pk_bf16_f32 v20, v20, v20
    v_lshlrev_b32 v20, 16, v20
    v_mul_f32 v20, v20, v88
    v_cvt_pk_bf16_f32 v21, v21, v21
    v_lshlrev_b32 v21, 16, v21
    v_mul_f32 v21, v5, v21
    v_cvt_pk_bf16_f32 v21, v21, v21
    v_lshlrev_b32 v21, 16, v21
    v_add_f32 v21, v21, v85
    v_cvt_pk_bf16_f32 v21, v21, v21
    v_lshlrev_b32 v21, 16, v21
    v_mul_f32 v21, v21, v88
    v_cvt_pk_bf16_f32 v22, v22, v22
    v_lshlrev_b32 v22, 16, v22
    v_mul_f32 v22, v5, v22
    v_cvt_pk_bf16_f32 v22, v22, v22
    v_lshlrev_b32 v22, 16, v22
    v_add_f32 v22, v22, v86
    v_cvt_pk_bf16_f32 v22, v22, v22
    v_lshlrev_b32 v22, 16, v22
    v_mul_f32 v22, v22, v88
    v_cvt_pk_bf16_f32 v23, v23, v23
    v_lshlrev_b32 v23, 16, v23
    v_mul_f32 v23, v5, v23
    v_cvt_pk_bf16_f32 v23, v23, v23
    v_lshlrev_b32 v23, 16, v23
    v_add_f32 v23, v23, v87
    v_cvt_pk_bf16_f32 v23, v23, v23
    v_lshlrev_b32 v23, 16, v23
    v_mul_f32 v23, v23, v88
    s_lshl_b32 s3, s59, 8
    s_add_u32 s3, s3, 158976
    v_add_u32 v2, s3, v2
    ds_write_b128 v2, v[20:23]
    s_lshl_b32 s3, s59, 2
    v_add_u32 v2, s3, v12
    ds_write_b32 v2, v80 offset:64
    s_branch K_END
WP_flags:
    s_setpc_b64 s[38:39]
K_P2_FLAGS:
    s_mov_b32 exec_hi, 0
    s_waitcnt vmcnt(0)
    s_mov_b32 s3, 131072
K_P2_FCHK:
    v_cmp_eq_u32 vcc, 1, v7
    s_nop 1
    v_mov_b32 v2, vcc_lo
    ds_write_b32 v12, v2 offset:32
    s_cmp_eq_u32 vcc_lo, -1
    s_cbranch_scc1 K_P2_FGO
    s_cmp_lg_u32 vcc_lo, 0
    s_cbranch_scc1 K_P2_FS
    s_sleep 4
K_P2_FS:
    s_sleep 6
    global_load_dword v7, v10, s[10:11] sc1
    s_sub_u32 s3, s3, 1
    s_waitcnt vmcnt(0)
    s_cbranch_scc0 K_P2_FCHK
    v_mov_b32 v2, -1
    ds_write_b32 v12, v2 offset:32
K_P2_FGO:
    s_mov_b64 exec, -1
    s_branch K_END
.p2align 12
K_AUX:
    s_load_dwordx8 s[48:55], s[0:1], 32
    s_load_dwordx2 s[56:57], s[0:1], 64
    s_mul_i32 s44, s28, 7
    s_add_u32 s44, s44, s29
    s_sub_u32 s44, s44, 1
    s_cmp_lt_u32 s44, 54
    s_cselect_b32 s44, s44, 63
    s_cmp_eq_u32 s29, 0
    s_cselect_b32 s44, 63, s44
    s_lshl_b32 s74, s28, 8
    s_lshl_b32 s3, s29, 5
    s_add_u32 s74, s74, s3
    v_mov_b32 v12, 158720
    v_mov_b32 v13, 1
    s_cmp_lt_u32 s30, 4
    s_cbranch_scc1 K_AUX_LO
    s_lshl_b32 s3, s30, 3
    s_add_u32 s3, s3, s74
    s_sub_u32 s3, s3, 32
    v_lshrrev_b32 v9, 3, v1
    v_add_u32 v9, s3, v9
    v_and_b32 v11, 7, v1
    v_lshlrev_b32 v11, 4, v11
    v_mul_u32_u24 v10, 1280, v9
    v_add_u32 v10, v10, v11
    s_waitcnt lgkmcnt(0)
    buffer_load_dwordx4 v[16:19], v10, s[12:15], 0 offen offset:0
    buffer_load_dwordx4 v[20:23], v10, s[12:15], 0 offen offset:128
    buffer_load_dwordx4 v[24:27], v10, s[12:15], 0 offen offset:256
    buffer_load_dwordx4 v[28:31], v10, s[12:15], 0 offen offset:384
    buffer_load_dwordx4 v[32:35], v10, s[12:15], 0 offen offset:512
    buffer_load_dwordx4 v[36:39], v10, s[12:15], 0 offen offset:640
    buffer_load_dwordx4 v[40:43], v10, s[12:15], 0 offen offset:768
    buffer_load_dwordx4 v[44:47], v10, s[12:15], 0 offen offset:896
    buffer_load_dwordx4 v[48:51], v10, s[12:15], 0 offen offset:1024
    buffer_load_dwordx4 v[52:55], v10, s[12:15], 0 offen offset:1152
    s_mov_b32 s16, s48
    s_mov_b32 s17, s49
    s_mov_b32 s18, 0x500
    s_mov_b32 s19, 0x20000
    s_mov_b32 s20, s56
    s_mov_b32 s21, s57
    s_mov_b32 s22, 0x500
    s_mov_b32 s23, 0x20000
    buffer_load_dwordx4 v[56:59], v11, s[16:19], 0 offen offset:0
    buffer_load_dwordx4 v[60:63], v11, s[16:19], 0 offen offset:128
    buffer_load_dwordx4 v[64:67], v11, s[16:19], 0 offen offset:256
    buffer_load_dwordx4 v[68:71], v11, s[16:19], 0 offen offset:384
    buffer_load_dwordx4 v[72:75], v11, s[16:19], 0 offen offset:512
    buffer_load_dwordx4 v[76:79], v11, s[16:19], 0 offen offset:640
    buffer_load_dwordx4 v[80:83], v11, s[16:19], 0 offen offset:768
    buffer_load_dwordx4 v[84:87], v11, s[16:19], 0 offen offset:896
    buffer_load_dwordx4 v[88:91], v11, s[16:19], 0 offen offset:1024
    buffer_load_dwordx4 v[92:95], v11, s[16:19], 0 offen offset:1152
    buffer_load_dwordx4 v[96:99], v11, s[20:23], 0 offen offset:0
    buffer_load_dwordx4 v[100:103], v11, s[20:23], 0 offen offset:128
    buffer_load_dwordx4 v[104:107], v11, s[20:23], 0 offen offset:256
    buffer_load_dwordx4 v[108:111], v11, s[20:23], 0 offen offset:384
    buffer_load_dwordx4 v[112:115], v11, s[20:23], 0 offen offset:512
    buffer_load_dwordx4 v[116:119], v11, s[20:23], 0 offen offset:640
    buffer_load_dwordx4 v[120:123], v11, s[20:23], 0 offen offset:768
    buffer_load_dwordx4 v[124:127], v11, s[20:23], 0 offen offset:896
    buffer_load_dwordx4 v[128:131], v11, s[20:23], 0 offen offset:1024
    buffer_load_dwordx4 v[132:135], v11, s[20:23], 0 offen offset:1152
    s_barrier
    v_mov_b32 v180, 0
    v_mov_b32 v181, 0
    v_mov_b32 v182, 0
    v_mov_b32 v183, 0
    v_and_b32 v10, 31, v9
    v_lshlrev_b32 v10, 2, v10
    v_add_u32 v10, 122880, v10
    v_sub_u32 v4, 0x87ff, v9
    s_setprio 2
    s_waitcnt vmcnt(10)
    v_dot2c_f32_bf16 v180, v16, v56
    v_dot2c_f32_bf16 v181, v17, v57
    v_dot2c_f32_bf16 v180, v18, v58
    v_dot2c_f32_bf16 v181, v19, v59
    v_dot2c_f32_bf16 v180, v20, v60
    v_dot2c_f32_bf16 v181, v21, v61
    v_dot2c_f32_bf16 v180, v22, v62
    v_dot2c_f32_bf16 v181, v23, v63
    v_dot2c_f32_bf16 v180, v24, v64
    v_dot2c_f32_bf16 v181, v25, v65
    v_dot2c_f32_bf16 v180, v26, v66
    v_dot2c_f32_bf16 v181, v27, v67
    v_dot2c_f32_bf16 v180, v28, v68
    v_dot2c_f32_bf16 v181, v29, v69
    v_dot2c_f32_bf16 v180, v30, v70
    v_dot2c_f32_bf16 v181, v31, v71
    v_dot2c_f32_bf16 v180, v32, v72
    v_dot2c_f32_bf16 v181, v33, v73
    v_dot2c_f32_bf16 v180, v34, v74
    v_dot2c_f32_bf16 v181, v35, v75
    v_dot2c_f32_bf16 v180, v36, v76
    v_dot2c_f32_bf16 v181, v37, v77
    v_dot2c_f32_bf16 v180, v38, v78
    v_dot2c_f32_bf16 v181, v39, v79
    v_dot2c_f32_bf16 v180, v40, v80
    v_dot2c_f32_bf16 v181, v41, v81
    v_dot2c_f32_bf16 v180, v42, v82
    v_dot2c_f32_bf16 v181, v43, v83
    v_dot2c_f32_bf16 v180, v44, v84
    v_dot2c_f32_bf16 v181, v45, v85
    v_dot2c_f32_bf16 v180, v46, v86
    v_dot2c_f32_bf16 v181, v47, v87
    v_dot2c_f32_bf16 v180, v48, v88
    v_dot2c_f32_bf16 v181, v49, v89
    v_dot2c_f32_bf16 v180, v50, v90
    v_dot2c_f32_bf16 v181, v51, v91
    v_dot2c_f32_bf16 v180, v52, v92
    v_dot2c_f32_bf16 v181, v53, v93
    v_dot2c_f32_bf16 v180, v54, v94
    v_dot2c_f32_bf16 v181, v55, v95
    s_waitcnt vmcnt(0)
    v_dot2c_f32_bf16 v182, v16, v96
    v_dot2c_f32_bf16 v183, v17, v97
    v_dot2c_f32_bf16 v182, v18, v98
    v_dot2c_f32_bf16 v183, v19, v99
    v_dot2c_f32_bf16 v182, v20, v100
    v_dot2c_f32_bf16 v183, v21, v101
    v_dot2c_f32_bf16 v182, v22, v102
    v_dot2c_f32_bf16 v183, v23, v103
    v_dot2c_f32_bf16 v182, v24, v104
    v_dot2c_f32_bf16 v183, v25, v105
    v_dot2c_f32_bf16 v182, v26, v106
    v_dot2c_f32_bf16 v183, v27, v107
    v_dot2c_f32_bf16 v182, v28, v108
    v_dot2c_f32_bf16 v183, v29, v109
    v_dot2c_f32_bf16 v182, v30, v110
    v_dot2c_f32_bf16 v183, v31, v111
    v_dot2c_f32_bf16 v182, v32, v112
    v_dot2c_f32_bf16 v183, v33, v113
    v_dot2c_f32_bf16 v182, v34, v114
    v_dot2c_f32_bf16 v183, v35, v115
    v_dot2c_f32_bf16 v182, v36, v116
    v_dot2c_f32_bf16 v183, v37, v117
    v_dot2c_f32_bf16 v182, v38, v118
    v_dot2c_f32_bf16 v183, v39, v119
    v_dot2c_f32_bf16 v182, v40, v120
    v_dot2c_f32_bf16 v183, v41, v121
    v_dot2c_f32_bf16 v182, v42, v122
    v_dot2c_f32_bf16 v183, v43, v123
    v_dot2c_f32_bf16 v182, v44, v124
    v_dot2c_f32_bf16 v183, v45, v125
    v_dot2c_f32_bf16 v182, v46, v126
    v_dot2c_f32_bf16 v183, v47, v127
    v_dot2c_f32_bf16 v182, v48, v128
    v_dot2c_f32_bf16 v183, v49, v129
    v_dot2c_f32_bf16 v182, v50, v130
    v_dot2c_f32_bf16 v183, v51, v131
    v_dot2c_f32_bf16 v182, v52, v132
    v_dot2c_f32_bf16 v183, v53, v133
    v_dot2c_f32_bf16 v182, v54, v134
    v_dot2c_f32_bf16 v183, v55, v135
    s_nop 2
    v_add_f32 v180, v180, v181
    v_add_f32 v182, v182, v183
    s_nop 0
    v_add_f32_dpp v180, v180, v180 quad_perm:[1,0,3,2] row_mask:0xf bank_mask:0xf
    v_add_f32_dpp v182, v182, v182 quad_perm:[1,0,3,2] row_mask:0xf bank_mask:0xf
    s_nop 0
    v_add_f32_dpp v180, v180, v180 quad_perm:[2,3,0,1] row_mask:0xf bank_mask:0xf
    v_add_f32_dpp v182, v182, v182 quad_perm:[2,3,0,1] row_mask:0xf bank_mask:0xf
    s_nop 0
    v_add_f32_dpp v180, v180, v180 row_half_mirror row_mask:0xf bank_mask:0xf
    v_add_f32_dpp v182, v182, v182 row_half_mirror row_mask:0xf bank_mask:0xf
    v_cvt_pk_bf16_f32 v2, v180, v180
    v_lshlrev_b32 v2, 16, v2
    v_ashrrev_i32 v3, 31, v2
    v_or_b32 v3, 0x80000000, v3
    v_xor_b32 v2, v2, v3
    v_and_b32 v2, 0xffff0000, v2
    v_or_b32 v2, v2, v4
    ds_write2_b32 v10, v2, v182 offset0:0 offset1:32
    s_mov_b64 exec, 1
    ds_add_u32 v12, v13 offset:36
    s_mov_b64 exec, -1
    s_setprio 0
    s_cmp_lg_u32 s30, 4
    s_cbranch_scc1 K_WARMA0
    s_call_b64 s[38:39], WP_p2g
    s_branch K_WARMAX
K_WARMA0:
    s_cmp_lg_u32 s30, 5
    s_cbranch_scc1 K_WARMA1
    s_call_b64 s[38:39], WP_gen
    s_branch K_WARMAX
K_WARMA1:
    s_cmp_lg_u32 s30, 6
    s_cbranch_scc1 K_WARMA2
    s_call_b64 s[38:39], WP_help
    s_call_b64 s[38:39], WP_flags
    s_branch K_WARMAX
K_WARMA2:
    s_call_b64 s[38:39], WP_spin
K_WARMAX:
    s_cmp_ge_u32 s30, 6
    s_cselect_b32 s44, 63, s44
    s_cmp_lg_u32 s44, 63
    s_cbranch_scc1 K_FFN_C
    s_mov_b32 s3, 1048576
K_FGH:
    ds_read_b32 v2, v12 offset:48
    s_sleep 8
    s_sub_u32 s3, s3, 1
    s_waitcnt lgkmcnt(0)
    v_readfirstlane_b32 s33, v2
    s_nop 3
    s_cselect_b32 s33, 1, s33
    s_cmp_lt_u32 s33, 1
    s_cbranch_scc1 K_FGH
    s_cmp_eq_u32 s30, 6
    s_cbranch_scc1 K_P2_HELP
    v_mov_b32 v7, 1
    s_branch K_P2_HELP
K_AUX_LO:
    s_waitcnt lgkmcnt(0)
    s_cmp_eq_u32 s30, 0
    s_cbranch_scc1 K_AUX_PUB
    s_cmp_eq_u32 s44, 63
    s_cbranch_scc1 K_AUX_NOF
    s_and_b32 s3, s44, 1
    s_cmp_eq_u32 s3, 0
    s_cselect_b64 s[60:61], s[50:51], s[52:53]
    s_cselect_b64 s[64:65], s[52:53], s[50:51]
    s_cselect_b32 s75, 0, 40960
    s_mov_b32 s62, 0x21c000
    s_mov_b32 s63, 0x20000
    s_mov_b32 s66, 0x21c000
    s_mov_b32 s67, 0x20000
    v_lshrrev_b32 v2, 2, v1
    v_mul_u32_u24 v184, 3456, v2
    v_and_b32 v2, 3, v1
    v_lshl_add_u32 v184, v2, 4, v184
    s_lshl_b32 s72, s44, 6
    v_add_u32 v184, s72, v184
    s_sub_u32 s74, s30, 1
K_FSA0:
    s_lshl_b32 s73, s74, 10
    s_mul_i32 s72, s74, 55296
    s_add_u32 m0, s73, s75
    s_waitcnt vmcnt(5)
    buffer_load_dwordx4 v184, s[60:63], s72 offen lds
    s_add_u32 s74, s74, 3
    s_cmp_lt_u32 s74, 18
    s_cbranch_scc1 K_FSA0
    s_barrier
K_FSA:
    s_lshl_b32 s73, s74, 10
    s_mul_i32 s72, s74, 55296
    s_add_u32 m0, s73, s75
    s_waitcnt vmcnt(5)
    buffer_load_dwordx4 v184, s[60:63], s72 offen lds
    s_add_u32 s74, s74, 3
    s_cmp_lt_u32 s74, 40
    s_cbranch_scc1 K_FSA
    s_sub_u32 s74, s74, 40
    s_xor_b32 s75, s75, 40960
    s_mov_b32 s68, s54
    s_mov_b32 s69, s55
    s_mov_b32 s70, 0x21c000
    s_mov_b32 s71, 0x20000
    s_mul_i32 s3, s44, 40960
    v_lshrrev_b32 v2, 3, v1
    v_mul_u32_u24 v2, 1280, v2
    v_lshrrev_b32 v3, 4, v1
    v_lshlrev_b32 v3, 1, v3
    v_and_b32 v4, 7, v1
    v_xor_b32 v3, v3, v4
    v_lshl_add_u32 v2, v3, 4, v2
    v_add_u32 v185, s3, v2
K_FSB:
    s_lshl_b32 s73, s74, 10
    s_mul_i32 s72, s74, 55296
    s_add_u32 m0, s73, s75
    s_waitcnt vmcnt(5)
    buffer_load_dwordx4 v184, s[64:67], s72 offen lds
    s_add_u32 s74, s74, 3
    s_cmp_lt_u32 s74, 40
    s_cbranch_scc1 K_FSB
    s_sub_u32 s74, s74, 40
    s_mov_b32 s75, 81920
K_FSD0:
    s_lshl_b32 s73, s74, 10
    s_and_b32 s72, s74, 3
    s_mul_i32 s72, s72, 10208
    s_lshl_b32 s3, s74, 5
    s_add_u32 s72, s72, s3
    s_add_u32 m0, s73, s75
    s_waitcnt vmcnt(5)
    buffer_load_dwordx4 v185, s[68:71], s72 offen lds
    s_add_u32 s74, s74, 3
    s_cmp_lt_u32 s74, 18
    s_cbranch_scc1 K_FSD0
    s_waitcnt vmcnt(6)
    s_mov_b64 exec, 1
    ds_add_u32 v12, v13 offset:56
    s_mov_b64 exec, -1
K_FSD:
    s_lshl_b32 s73, s74, 10
    s_and_b32 s72, s74, 3
    s_mul_i32 s72, s72, 10208
    s_lshl_b32 s3, s74, 5
    s_add_u32 s72, s72, s3
    s_add_u32 m0, s73, s75
    s_waitcnt vmcnt(5)
    buffer_load_dwordx4 v185, s[68:71], s72 offen lds
    s_add_u32 s74, s74, 3
    s_cmp_lt_u32 s74, 40
    s_cbranch_scc1 K_FSD
    s_mul_i32 s3, s29, 96
    s_lshl_b32 s72, s30, 5
    s_add_u32 s3, s3, s72
    s_sub_u32 s3, s3, 128
    v_lshrrev_b32 v2, 1, v1
    v_add_u32 v2, s3, v2
    v_mul_u32_u24 v2, 1280, v2
    v_and_b32 v3, 1, v1
    v_lshl_add_u32 v2, v3, 7, v2
    buffer_load_dword v6, v2, s[24:27], 0 offen offset:1024
K_AUX_WR:
    s_mov_b32 s3, 1048576
K_FGR:
    ds_read_b32 v2, v12 offset:60
    s_sleep 2
    s_sub_u32 s3, s3, 1
    s_waitcnt lgkmcnt(0)
    v_readfirstlane_b32 s33, v2
    s_nop 3
    s_cselect_b32 s33, 2, s33
    s_cmp_lt_u32 s33, 2
    s_cbranch_scc1 K_FGR
    s_branch K_P2
K_AUX_NOF:
    s_cmp_lg_u32 s2, 63
    s_cbranch_scc1 K_AUX_NOZ
    s_cmp_lg_u32 s30, 1
    s_cbranch_scc1 K_AUX_NOZ
    s_add_u32 s60, s10, 0x80000
    s_addc_u32 s61, s11, 0
    s_mov_b32 s62, 0xc000
    s_mov_b32 s63, 0x20000
    s_barrier
    s_mov_b32 s3, 1048576
K_FGZ:
    ds_read_b32 v2, v12 offset:36
    s_sleep 2
    s_sub_u32 s3, s3, 1
    s_waitcnt lgkmcnt(0)
    v_readfirstlane_b32 s33, v2
    s_nop 3
    s_cselect_b32 s33, 4, s33
    s_cmp_lt_u32 s33, 4
    s_cbranch_scc1 K_FGZ
    v_and_b32 v4, 7, v1
    v_lshlrev_b32 v4, 2, v4
    s_mov_b32 s3, 131072
K_ZPOLL4:
    v_cmp_eq_u32 vcc, 0, v7
    s_cbranch_vccz K_ZOK4
    s_sub_u32 s3, s3, 1
    s_cbranch_scc1 K_ZOK4
    global_load_dword v7, v4, s[8:9] offset:192 sc1
    s_waitcnt vmcnt(0)
    s_branch K_ZPOLL4
K_ZOK4:
    v_lshlrev_b32 v4, 3, v1
    s_mov_b32 s72, 43008
    s_mov_b32 s3, 131072
    s_setprio 3
K_AGG_POLL:
    buffer_load_dwordx2 v[176:177], v4, s[60:63], s72 offen sc1
    s_waitcnt vmcnt(0)
    v_min_u32 v2, v176, v177
    v_cmp_eq_u32 vcc, 0, v2
    s_cbranch_vccz K_AGG_GOT
    s_sleep 2
    s_sub_u32 s3, s3, 1
    s_cmp_lg_u32 s3, 0
    s_cbranch_scc1 K_AGG_POLL
K_AGG_GOT:
    s_nop 1
    v_max_u32_dpp v3, v176, v176 quad_perm:[1,0,3,2] row_mask:0xf bank_mask:0xf
    s_nop 1
    v_max_u32_dpp v3, v3, v3 quad_perm:[2,3,0,1] row_mask:0xf bank_mask:0xf
    s_nop 1
    v_max_u32_dpp v3, v3, v3 row_half_mirror row_mask:0xf bank_mask:0xf
    s_nop 1
    v_max_u32_dpp v3, v3, v3 row_mirror row_mask:0xf bank_mask:0xf
    s_nop 1
    v_readlane_b32 s74, v3, 0
    v_readlane_b32 s76, v3, 16
    v_readlane_b32 s77, v3, 32
    v_readlane_b32 s78, v3, 48
    s_nop 3
    s_max_u32 s74, s74, s76
    s_max_u32 s77, s77, s78
    s_max_u32 s74, s74, s77
    v_cmp_ne_u32 vcc, s74, v176
    s_nop 1
    v_cndmask_b32 v2, v177, v176, vcc
    s_nop 1
    v_max_u32_dpp v3, v2, v2 quad_perm:[1,0,3,2] row_mask:0xf bank_mask:0xf
    s_nop 1
    v_max_u32_dpp v3, v3, v3 quad_perm:[2,3,0,1] row_mask:0xf bank_mask:0xf
    s_nop 1
    v_max_u32_dpp v3, v3, v3 row_half_mirror row_mask:0xf bank_mask:0xf
    s_nop 1
    v_max_u32_dpp v3, v3, v3 row_mirror row_mask:0xf bank_mask:0xf
    s_nop 1
    v_readlane_b32 s75, v3, 0
    v_readlane_b32 s76, v3, 16
    v_readlane_b32 s77, v3, 32
    v_readlane_b32 s78, v3, 48
    s_nop 3
    s_max_u32 s75, s75, s76
    s_max_u32 s77, s77, s78
    s_max_u32 s75, s75, s77
    v_mov_b32 v176, s74
    v_mov_b32 v177, s75
    s_mov_b32 s62, 40960
    v_lshlrev_b32 v3, 8, v1
    s_mov_b32 s3, 0
    buffer_store_dwordx2 v[176:177], v3, s[60:63], s3 offen offset:128 sc1
    s_mov_b32 s3, 16384
    buffer_store_dwordx2 v[176:177], v3, s[60:63], s3 offen offset:128 sc1
    s_mov_b32 s3, 32768
    buffer_store_dwordx2 v[176:177], v3, s[60:63], s3 offen offset:128 sc1
    s_setprio 0
    s_branch K_AUX_NOK
K_AUX_NOZ:
    s_barrier
K_AUX_NOK:
    s_mov_b32 s3, 1048576
K_FGWD:
    ds_read_b32 v2, v12 offset:48
    s_sleep 4
    s_sub_u32 s3, s3, 1
    s_waitcnt lgkmcnt(0)
    v_readfirstlane_b32 s33, v2
    s_nop 3
    s_cselect_b32 s33, 1, s33
    s_cmp_lt_u32 s33, 1
    s_cbranch_scc1 K_FGWD
    s_branch K_P2
K_AUX_PUB:
    s_add_u32 s60, s10, 0x1000
    s_addc_u32 s61, s11, 0
    s_mov_b32 s62, 0x2000
    s_mov_b32 s63, 0x20000
    v_and_b32 v3, 31, v1
    v_lshlrev_b32 v10, 2, v3
    v_add_u32 v11, 122880, v10
    s_lshl_b32 s72, s74, 2
    s_lshl_b32 s3, s2, 3
    s_add_u32 s3, s3, 567296
    v_mov_b32 v9, s3
    v_and_b32 v5, 7, v1
    v_lshlrev_b32 v5, 2, v5
    s_barrier
    s_setprio 3
    s_mov_b32 s3, 1048576
K_FGRT:
    ds_read_b32 v2, v12 offset:36
    s_sleep 0
    s_sub_u32 s3, s3, 1
    s_waitcnt lgkmcnt(0)
    v_readfirstlane_b32 s33, v2
    s_nop 3
    s_cselect_b32 s33, 4, s33
    s_cmp_lt_u32 s33, 4
    s_cbranch_scc1 K_FGRT
    ds_read2_b32 v[176:177], v11 offset0:0 offset1:32
    global_load_dword v7, v5, s[8:9] offset:192 sc1
    s_waitcnt lgkmcnt(0)
    v_cvt_pk_bf16_f32 v177, v177, v177
    v_lshlrev_b32 v177, 16, v177
    v_mul_f32 v5, 0xbfb8aa3b, v177
    v_exp_f32 v5, v5
    s_nop 0
    v_add_f32 v5, 1.0, v5
    v_rcp_f32 v177, v5
    s_nop 0
    v_cvt_pk_bf16_f32 v177, v177, v177
    v_lshlrev_b32 v177, 16, v177
    s_mov_b32 exec_hi, 0
    buffer_store_dword v177, v10, s[60:63], s72 offen sc1
    s_mov_b64 exec, -1
    s_nop 1
    v_max_u32_dpp v3, v176, v176 quad_perm:[1,0,3,2] row_mask:0xf bank_mask:0xf
    s_nop 1
    v_max_u32_dpp v3, v3, v3 quad_perm:[2,3,0,1] row_mask:0xf bank_mask:0xf
    s_nop 1
    v_max_u32_dpp v3, v3, v3 row_half_mirror row_mask:0xf bank_mask:0xf
    s_nop 1
    v_max_u32_dpp v3, v3, v3 row_mirror row_mask:0xf bank_mask:0xf
    s_nop 1
    v_readlane_b32 s74, v3, 0
    v_readlane_b32 s76, v3, 16
    v_readlane_b32 s77, v3, 32
    v_readlane_b32 s78, v3, 48
    s_nop 3
    s_max_u32 s74, s74, s76
    s_max_u32 s77, s77, s78
    s_max_u32 s74, s74, s77
    v_cmp_ne_u32 vcc, s74, v176
    s_nop 1
    v_cndmask_b32 v176, 0, v176, vcc
    s_nop 1
    v_max_u32_dpp v3, v176, v176 quad_perm:[1,0,3,2] row_mask:0xf bank_mask:0xf
    s_nop 1
    v_max_u32_dpp v3, v3, v3 quad_perm:[2,3,0,1] row_mask:0xf bank_mask:0xf
    s_nop 1
    v_max_u32_dpp v3, v3, v3 row_half_mirror row_mask:0xf bank_mask:0xf
    s_nop 1
    v_max_u32_dpp v3, v3, v3 row_mirror row_mask:0xf bank_mask:0xf
    s_nop 1
    v_readlane_b32 s75, v3, 0
    v_readlane_b32 s76, v3, 16
    v_readlane_b32 s77, v3, 32
    v_readlane_b32 s78, v3, 48
    s_nop 3
    s_max_u32 s75, s75, s76
    s_max_u32 s77, s77, s78
    s_max_u32 s75, s75, s77
    v_mov_b32 v176, s74
    v_mov_b32 v177, s75
    s_waitcnt vmcnt(0)
    v_and_b32 v4, 7, v1
    v_lshlrev_b32 v4, 2, v4
    s_mov_b32 s3, 131072
K_ZPOLL3:
    v_cmp_eq_u32 vcc, 0, v7
    s_cbranch_vccz K_ZOK3
    s_sub_u32 s3, s3, 1
    s_cbranch_scc1 K_ZOK3
    global_load_dword v7, v4, s[8:9] offset:192 sc1
    s_waitcnt vmcnt(0)
    s_branch K_ZPOLL3
K_ZOK3:
    s_mov_b64 exec, 1
    global_store_dwordx2 v9, v[176:177], s[10:11] sc1
    s_mov_b64 exec, -1
    v_and_b32 v3, 1, v1
    v_lshl_add_u32 v3, v3, 2, s42
    v_lshlrev_b32 v10, 4, v1
    s_mov_b32 s3, 131072
K_AUX_POLL:
    s_sleep 6
    global_load_dword v2, v3, s[10:11] offset:128 sc1
    s_waitcnt vmcnt(0)
    v_cmp_eq_u32 vcc, 0, v2
    s_cbranch_vccz K_AUX_GOT
    s_sub_u32 s3, s3, 1
    s_cmp_lg_u32 s3, 0
    s_cbranch_scc1 K_AUX_POLL
K_AUX_GOT:
    v_readlane_b32 s74, v2, 0
    v_readlane_b32 s75, v2, 1
    s_nop 3
    s_and_b32 s74, s74, 0x7ff
    s_sub_u32 s74, 2047, s74
    s_mul_i32 s74, s74, 1280
    s_mov_b32 m0, 125184
    s_nop 0
    buffer_load_dwordx4 v10, s[12:15], s74 offen lds
    s_mov_b64 exec, 0xffff
    buffer_load_dwordx4 v10, s[12:15], s74 offen offset:1024 lds
    s_mov_b64 exec, -1
    s_and_b32 s75, s75, 0x7ff
    s_sub_u32 s75, 2047, s75
    s_mul_i32 s75, s75, 1280
    s_mov_b32 m0, 126528
    s_nop 0
    buffer_load_dwordx4 v10, s[12:15], s75 offen lds
    s_mov_b64 exec, 0xffff
    buffer_load_dwordx4 v10, s[12:15], s75 offen offset:1024 lds
    s_mov_b64 exec, -1
    s_waitcnt vmcnt(0)
    ds_write_b32 v12, v13 offset:48
    s_setprio 0
    s_branch K_P2
.p2align 12
K_FFN_C:
    s_add_u32 s64, s10, 0x10000
    s_addc_u32 s65, s11, 0
    s_mov_b32 s66, 0x43800
    s_mov_b32 s67, 0x20000
    s_and_b32 s73, s30, 1
    v_lshrrev_b32 v232, 4, v1
    v_bfe_u32 v4, v1, 2, 2
    v_lshl_add_u32 v2, v232, 3, v4
    v_and_b32 v3, 3, v1
    v_lshlrev_b32 v3, 3, v3
    v_lshl_add_u32 v233, v2, 6, v3
    s_lshl_b32 s72, s73, 5
    v_add_u32 v233, s72, v233
    v_lshl_add_u32 v2, v232, 2, v4
    v_bfe_u32 v4, v2, 1, 2
    v_lshl_add_u32 v3, v2, 7, v3
    v_lshl_add_u32 v3, v4, 5, v3
    s_mul_i32 s3, s73, 20480
    s_add_u32 s3, s3, 81920
    v_add_u32 v238, s3, v3
    v_xor_b32 v239, 32, v238
    v_xor_b32 v240, 64, v238
    v_xor_b32 v241, 96, v238
    v_and_b32 v2, 1, v1
    v_mul_u32_u24 v234, 1344, v2
    v_lshl_add_u32 v234, v232, 4, v234
    v_add_u32 v234, 125184, v234
    v_lshlrev_b32 v236, 4, v1
    v_add_u32 v236, 124160, v236
    s_lshl_b32 s3, s73, 3
    v_add_u32 v235, s3, v236
    v_mul_u32_u24 v2, 2560, v2
    v_lshl_add_u32 v237, v232, 4, v2
    s_mul_i32 s3, s44, 5120
    s_mul_i32 s72, s73, 1280
    s_add_u32 s72, s72, s3
    v_lshlrev_b32 v2, 4, v1
    buffer_store_dwordx4 v[16:19], v2, s[64:67], s72 offen offset:0 sc1
    buffer_store_dwordx4 v[16:19], v2, s[64:67], s72 offen offset:2560 sc1
    s_mov_b64 exec, 0xffff
    buffer_store_dwordx4 v[16:19], v2, s[64:67], s72 offen offset:1024 sc1
    buffer_store_dwordx4 v[16:19], v2, s[64:67], s72 offen offset:3584 sc1
    s_mov_b64 exec, -1
    v_add_u32 v5, 40960, v233
    s_mov_b32 s3, 1048576
K_FGD:
    ds_read_b32 v2, v12 offset:56
    s_sleep 2
    s_sub_u32 s3, s3, 1
    s_waitcnt lgkmcnt(0)
    v_readfirstlane_b32 s33, v2
    s_nop 3
    s_cselect_b32 s33, 3, s33
    s_cmp_lt_u32 s33, 3
    s_cbranch_scc1 K_FGD
    s_setprio 3
    ds_read_b64_tr_b16 v[16:17], v233 offset:0
    ds_read_b64_tr_b16 v[18:19], v233 offset:256
    ds_read_b64_tr_b16 v[20:21], v233 offset:2048
    ds_read_b64_tr_b16 v[22:23], v233 offset:2304
    ds_read_b64_tr_b16 v[24:25], v233 offset:4096
    ds_read_b64_tr_b16 v[26:27], v233 offset:4352
    ds_read_b64_tr_b16 v[28:29], v233 offset:6144
    ds_read_b64_tr_b16 v[30:31], v233 offset:6400
    ds_read_b64_tr_b16 v[32:33], v233 offset:8192
    ds_read_b64_tr_b16 v[34:35], v233 offset:8448
    ds_read_b64_tr_b16 v[36:37], v233 offset:10240
    ds_read_b64_tr_b16 v[38:39], v233 offset:10496
    ds_read_b64_tr_b16 v[40:41], v233 offset:12288
    ds_read_b64_tr_b16 v[42:43], v233 offset:12544
    ds_read_b64_tr_b16 v[44:45], v233 offset:14336
    ds_read_b64_tr_b16 v[46:47], v233 offset:14592
    ds_read_b64_tr_b16 v[48:49], v233 offset:16384
    ds_read_b64_tr_b16 v[50:51], v233 offset:16640
    ds_read_b64_tr_b16 v[52:53], v233 offset:18432
    ds_read_b64_tr_b16 v[54:55], v233 offset:18688
    ds_read_b64_tr_b16 v[56:57], v233 offset:20480
    ds_read_b64_tr_b16 v[58:59], v233 offset:20736
    ds_read_b64_tr_b16 v[60:61], v233 offset:22528
    ds_read_b64_tr_b16 v[62:63], v233 offset:22784
    ds_read_b64_tr_b16 v[64:65], v233 offset:24576
    ds_read_b64_tr_b16 v[66:67], v233 offset:24832
    ds_read_b64_tr_b16 v[68:69], v233 offset:26624
    ds_read_b64_tr_b16 v[70:71], v233 offset:26880
    ds_read_b64_tr_b16 v[72:73], v233 offset:28672
    ds_read_b64_tr_b16 v[74:75], v233 offset:28928
    ds_read_b64_tr_b16 v[76:77], v233 offset:30720
    ds_read_b64_tr_b16 v[78:79], v233 offset:30976
    ds_read_b64_tr_b16 v[80:81], v233 offset:32768
    ds_read_b64_tr_b16 v[82:83], v233 offset:33024
    ds_read_b64_tr_b16 v[84:85], v233 offset:34816
    ds_read_b64_tr_b16 v[86:87], v233 offset:35072
    ds_read_b64_tr_b16 v[88:89], v233 offset:36864
    ds_read_b64_tr_b16 v[90:91], v233 offset:37120
    ds_read_b64_tr_b16 v[92:93], v233 offset:38912
    ds_read_b64_tr_b16 v[94:95], v233 offset:39168
    ds_read_b64_tr_b16 v[96:97], v5 offset:0
    ds_read_b64_tr_b16 v[98:99], v5 offset:256
    ds_read_b64_tr_b16 v[100:101], v5 offset:2048
    ds_read_b64_tr_b16 v[102:103], v5 offset:2304
    ds_read_b64_tr_b16 v[104:105], v5 offset:4096
    ds_read_b64_tr_b16 v[106:107], v5 offset:4352
    ds_read_b64_tr_b16 v[108:109], v5 offset:6144
    ds_read_b64_tr_b16 v[110:111], v5 offset:6400
    ds_read_b64_tr_b16 v[112:113], v5 offset:8192
    ds_read_b64_tr_b16 v[114:115], v5 offset:8448
    ds_read_b64_tr_b16 v[116:117], v5 offset:10240
    ds_read_b64_tr_b16 v[118:119], v5 offset:10496
    ds_read_b64_tr_b16 v[120:121], v5 offset:12288
    ds_read_b64_tr_b16 v[122:123], v5 offset:12544
    ds_read_b64_tr_b16 v[124:125], v5 offset:14336
    ds_read_b64_tr_b16 v[126:127], v5 offset:14592
    ds_read_b64_tr_b16 v[128:129], v5 offset:16384
    ds_read_b64_tr_b16 v[130:131], v5 offset:16640
    ds_read_b64_tr_b16 v[132:133], v5 offset:18432
    ds_read_b64_tr_b16 v[134:135], v5 offset:18688
    ds_read_b64_tr_b16 v[136:137], v5 offset:20480
    ds_read_b64_tr_b16 v[138:139], v5 offset:20736
    ds_read_b64_tr_b16 v[140:141], v5 offset:22528
    ds_read_b64_tr_b16 v[142:143], v5 offset:22784
    ds_read_b64_tr_b16 v[144:145], v5 offset:24576
    ds_read_b64_tr_b16 v[146:147], v5 offset:24832
    ds_read_b64_tr_b16 v[148:149], v5 offset:26624
    ds_read_b64_tr_b16 v[150:151], v5 offset:26880
    ds_read_b64_tr_b16 v[152:153], v5 offset:28672
    ds_read_b64_tr_b16 v[154:155], v5 offset:28928
    ds_read_b64_tr_b16 v[156:157], v5 offset:30720
    ds_read_b64_tr_b16 v[158:159], v5 offset:30976
    ds_read_b64_tr_b16 v[160:161], v5 offset:32768
    ds_read_b64_tr_b16 v[162:163], v5 offset:33024
    ds_read_b64_tr_b16 v[164:165], v5 offset:34816
    ds_read_b64_tr_b16 v[166:167], v5 offset:35072
    ds_read_b64_tr_b16 v[168:169], v5 offset:36864
    ds_read_b64_tr_b16 v[170:171], v5 offset:37120
    ds_read_b64_tr_b16 v[172:173], v5 offset:38912
    ds_read_b64_tr_b16 v[174:175], v5 offset:39168
    s_waitcnt vmcnt(0) lgkmcnt(0)
    s_mov_b64 exec, 1
    ds_add_u32 v12, v13 offset:60
    s_mov_b64 exec, -1
    s_mov_b32 s3, 1048576
K_FGK:
    ds_read_b32 v2, v12 offset:48
    s_sleep 1
    s_sub_u32 s3, s3, 1
    s_waitcnt lgkmcnt(0)
    v_readfirstlane_b32 s33, v2
    s_nop 3
    s_cselect_b32 s33, 1, s33
    s_cmp_lt_u32 s33, 1
    s_cbranch_scc1 K_FGK
    ds_read_b128 v[188:191], v234 offset:0
    ds_read_b128 v[192:195], v234 offset:64
    ds_read_b128 v[196:199], v234 offset:128
    ds_read_b128 v[200:203], v234 offset:192
    ds_read_b128 v[204:207], v234 offset:256
    ds_read_b128 v[208:211], v234 offset:320
    ds_read_b128 v[212:215], v234 offset:384
    ds_read_b128 v[216:219], v234 offset:448
    s_waitcnt lgkmcnt(7)
    v_mfma_f32_16x16x32_bf16 v[220:223], v[16:19], v[188:191], 0
    v_mfma_f32_16x16x32_bf16 v[224:227], v[96:99], v[188:191], 0
    ds_read_b128 v[188:191], v234 offset:512
    s_waitcnt lgkmcnt(7)
    v_mfma_f32_16x16x32_bf16 v[220:223], v[20:23], v[192:195], v[220:223]
    v_mfma_f32_16x16x32_bf16 v[224:227], v[100:103], v[192:195], v[224:227]
    ds_read_b128 v[192:195], v234 offset:576
    s_waitcnt lgkmcnt(7)
    v_mfma_f32_16x16x32_bf16 v[220:223], v[24:27], v[196:199], v[220:223]
    v_mfma_f32_16x16x32_bf16 v[224:227], v[104:107], v[196:199], v[224:227]
    ds_read_b128 v[196:199], v234 offset:640
    s_waitcnt lgkmcnt(7)
    v_mfma_f32_16x16x32_bf16 v[220:223], v[28:31], v[200:203], v[220:223]
    v_mfma_f32_16x16x32_bf16 v[224:227], v[108:111], v[200:203], v[224:227]
    ds_read_b128 v[200:203], v234 offset:704
    s_waitcnt lgkmcnt(7)
    v_mfma_f32_16x16x32_bf16 v[220:223], v[32:35], v[204:207], v[220:223]
    v_mfma_f32_16x16x32_bf16 v[224:227], v[112:115], v[204:207], v[224:227]
    ds_read_b128 v[204:207], v234 offset:768
    s_waitcnt lgkmcnt(7)
    v_mfma_f32_16x16x32_bf16 v[220:223], v[36:39], v[208:211], v[220:223]
    v_mfma_f32_16x16x32_bf16 v[224:227], v[116:119], v[208:211], v[224:227]
    ds_read_b128 v[208:211], v234 offset:832
    s_waitcnt lgkmcnt(7)
    v_mfma_f32_16x16x32_bf16 v[220:223], v[40:43], v[212:215], v[220:223]
    v_mfma_f32_16x16x32_bf16 v[224:227], v[120:123], v[212:215], v[224:227]
    ds_read_b128 v[212:215], v234 offset:896
    s_waitcnt lgkmcnt(7)
    v_mfma_f32_16x16x32_bf16 v[220:223], v[44:47], v[216:219], v[220:223]
    v_mfma_f32_16x16x32_bf16 v[224:227], v[124:127], v[216:219], v[224:227]
    ds_read_b128 v[216:219], v234 offset:960
    s_waitcnt lgkmcnt(7)
    v_mfma_f32_16x16x32_bf16 v[220:223], v[48:51], v[188:191], v[220:223]
    v_mfma_f32_16x16x32_bf16 v[224:227], v[128:131], v[188:191], v[224:227]
    ds_read_b128 v[188:191], v234 offset:1024
    s_waitcnt lgkmcnt(7)
    v_mfma_f32_16x16x32_bf16 v[220:223], v[52:55], v[192:195], v[220:223]
    v_mfma_f32_16x16x32_bf16 v[224:227], v[132:135], v[192:195], v[224:227]
    ds_read_b128 v[192:195], v234 offset:1088
    s_waitcnt lgkmcnt(7)
    v_mfma_f32_16x16x32_bf16 v[220:223], v[56:59], v[196:199], v[220:223]
    v_mfma_f32_16x16x32_bf16 v[224:227], v[136:139], v[196:199], v[224:227]
    ds_read_b128 v[196:199], v234 offset:1152
    s_waitcnt lgkmcnt(7)
    v_mfma_f32_16x16x32_bf16 v[220:223], v[60:63], v[200:203], v[220:223]
    v_mfma_f32_16x16x32_bf16 v[224:227], v[140:143], v[200:203], v[224:227]
    ds_read_b128 v[200:203], v234 offset:1216
    s_waitcnt lgkmcnt(7)
    v_mfma_f32_16x16x32_bf16 v[220:223], v[64:67], v[204:207], v[220:223]
    v_mfma_f32_16x16x32_bf16 v[224:227], v[144:147], v[204:207], v[224:227]
    s_waitcnt lgkmcnt(6)
    v_mfma_f32_16x16x32_bf16 v[220:223], v[68:71], v[208:211], v[220:223]
    v_mfma_f32_16x16x32_bf16 v[224:227], v[148:151], v[208:211], v[224:227]
    s_waitcnt lgkmcnt(5)
    v_mfma_f32_16x16x32_bf16 v[220:223], v[72:75], v[212:215], v[220:223]
    v_mfma_f32_16x16x32_bf16 v[224:227], v[152:155], v[212:215], v[224:227]
    s_waitcnt lgkmcnt(4)
    v_mfma_f32_16x16x32_bf16 v[220:223], v[76:79], v[216:219], v[220:223]
    v_mfma_f32_16x16x32_bf16 v[224:227], v[156:159], v[216:219], v[224:227]
    s_waitcnt lgkmcnt(3)
    v_mfma_f32_16x16x32_bf16 v[220:223], v[80:83], v[188:191], v[220:223]
    v_mfma_f32_16x16x32_bf16 v[224:227], v[160:163], v[188:191], v[224:227]
    s_waitcnt lgkmcnt(2)
    v_mfma_f32_16x16x32_bf16 v[220:223], v[84:87], v[192:195], v[220:223]
    v_mfma_f32_16x16x32_bf16 v[224:227], v[164:167], v[192:195], v[224:227]
    s_waitcnt lgkmcnt(1)
    v_mfma_f32_16x16x32_bf16 v[220:223], v[88:91], v[196:199], v[220:223]
    v_mfma_f32_16x16x32_bf16 v[224:227], v[168:171], v[196:199], v[224:227]
    s_waitcnt lgkmcnt(0)
    v_mfma_f32_16x16x32_bf16 v[220:223], v[92:95], v[200:203], v[220:223]
    v_mfma_f32_16x16x32_bf16 v[224:227], v[172:175], v[200:203], v[224:227]
    s_mov_b32 s3, 1048576
K_FGDN:
    ds_read_b32 v2, v12 offset:52
    s_sleep 1
    s_sub_u32 s3, s3, 1
    s_waitcnt lgkmcnt(0)
    v_readfirstlane_b32 s33, v2
    s_nop 3
    s_cselect_b32 s33, 3, s33
    s_cmp_lt_u32 s33, 3
    s_cbranch_scc1 K_FGDN
    ds_read_b64_tr_b16 v[16:17], v238 offset:0
    ds_read_b64_tr_b16 v[18:19], v238 offset:2048
    ds_read_b64_tr_b16 v[20:21], v239 offset:0
    ds_read_b64_tr_b16 v[22:23], v239 offset:2048
    ds_read_b64_tr_b16 v[24:25], v240 offset:0
    ds_read_b64_tr_b16 v[26:27], v240 offset:2048
    ds_read_b64_tr_b16 v[28:29], v241 offset:0
    ds_read_b64_tr_b16 v[30:31], v241 offset:2048
    ds_read_b64_tr_b16 v[32:33], v238 offset:4096
    ds_read_b64_tr_b16 v[34:35], v238 offset:6144
    ds_read_b64_tr_b16 v[36:37], v239 offset:4096
    ds_read_b64_tr_b16 v[38:39], v239 offset:6144
    ds_read_b64_tr_b16 v[40:41], v240 offset:4096
    ds_read_b64_tr_b16 v[42:43], v240 offset:6144
    v_cvt_pk_bf16_f32 v221, v220, v221
    v_lshlrev_b32 v220, 16, v221
    v_and_b32 v221, 0xffff0000, v221
    v_cvt_pk_bf16_f32 v223, v222, v223
    v_lshlrev_b32 v222, 16, v223
    v_and_b32 v223, 0xffff0000, v223
    v_cvt_pk_bf16_f32 v225, v224, v225
    v_lshlrev_b32 v224, 16, v225
    v_and_b32 v225, 0xffff0000, v225
    v_cvt_pk_bf16_f32 v227, v226, v227
    v_lshlrev_b32 v226, 16, v227
    v_and_b32 v227, 0xffff0000, v227
    v_mul_f32 v188, 0xbfb8aa3b, v220
    v_mul_f32 v189, 0xbfb8aa3b, v221
    v_mul_f32 v190, 0xbfb8aa3b, v222
    v_mul_f32 v191, 0xbfb8aa3b, v223
    v_exp_f32 v188, v188
    v_exp_f32 v189, v189
    v_exp_f32 v190, v190
    v_exp_f32 v191, v191
    v_add_f32 v188, 1.0, v188
    v_add_f32 v189, 1.0, v189
    v_add_f32 v190, 1.0, v190
    v_add_f32 v191, 1.0, v191
    v_rcp_f32 v188, v188
    v_rcp_f32 v189, v189
    v_rcp_f32 v190, v190
    v_rcp_f32 v191, v191
    v_mul_f32 v220, v220, v188
    v_mul_f32 v221, v221, v189
    v_mul_f32 v222, v222, v190
    v_mul_f32 v223, v223, v191
    v_cvt_pk_bf16_f32 v221, v220, v221
    v_lshlrev_b32 v220, 16, v221
    v_and_b32 v221, 0xffff0000, v221
    v_cvt_pk_bf16_f32 v223, v222, v223
    v_lshlrev_b32 v222, 16, v223
    v_and_b32 v223, 0xffff0000, v223
    v_mul_f32 v220, v220, v224
    v_mul_f32 v221, v221, v225
    v_mul_f32 v222, v222, v226
    v_mul_f32 v223, v223, v227
    v_cvt_pk_bf16_f32 v228, v220, v221
    v_cvt_pk_bf16_f32 v229, v222, v223
    ds_write_b64 v235, v[228:229]
    s_mov_b64 exec, 1
    ds_add_u32 v12, v13 offset:52
    s_mov_b64 exec, -1
    ds_read_b64_tr_b16 v[44:45], v241 offset:4096
    ds_read_b64_tr_b16 v[46:47], v241 offset:6144
    ds_read_b64_tr_b16 v[48:49], v238 offset:8192
    ds_read_b64_tr_b16 v[50:51], v238 offset:10240
    ds_read_b64_tr_b16 v[52:53], v239 offset:8192
    ds_read_b64_tr_b16 v[54:55], v239 offset:10240
    ds_read_b64_tr_b16 v[56:57], v240 offset:8192
    ds_read_b64_tr_b16 v[58:59], v240 offset:10240
    ds_read_b64_tr_b16 v[60:61], v241 offset:8192
    ds_read_b64_tr_b16 v[62:63], v241 offset:10240
    ds_read_b64_tr_b16 v[64:65], v238 offset:12288
    ds_read_b64_tr_b16 v[66:67], v238 offset:14336
    ds_read_b64_tr_b16 v[68:69], v239 offset:12288
    ds_read_b64_tr_b16 v[70:71], v239 offset:14336
    ds_read_b64_tr_b16 v[72:73], v240 offset:12288
    ds_read_b64_tr_b16 v[74:75], v240 offset:14336
    ds_read_b64_tr_b16 v[76:77], v241 offset:12288
    ds_read_b64_tr_b16 v[78:79], v241 offset:14336
    ds_read_b64_tr_b16 v[80:81], v238 offset:16384
    ds_read_b64_tr_b16 v[82:83], v238 offset:18432
    ds_read_b64_tr_b16 v[84:85], v239 offset:16384
    ds_read_b64_tr_b16 v[86:87], v239 offset:18432
    ds_read_b64_tr_b16 v[88:89], v240 offset:16384
    ds_read_b64_tr_b16 v[90:91], v240 offset:18432
    ds_read_b64_tr_b16 v[92:93], v241 offset:16384
    ds_read_b64_tr_b16 v[94:95], v241 offset:18432
    s_mov_b32 s3, 1048576
K_FGP:
    ds_read_b32 v2, v12 offset:52
    s_sleep 0
    s_sub_u32 s3, s3, 1
    s_waitcnt lgkmcnt(0)
    v_readfirstlane_b32 s33, v2
    s_nop 3
    s_cselect_b32 s33, 5, s33
    s_cmp_lt_u32 s33, 5
    s_cbranch_scc1 K_FGP
    ds_read_b128 v[228:231], v236
    s_waitcnt lgkmcnt(0)
    v_mfma_f32_16x16x32_bf16 v[96:99], v[16:19], v[228:231], 0
    v_mfma_f32_16x16x32_bf16 v[100:103], v[20:23], v[228:231], 0
    v_mfma_f32_16x16x32_bf16 v[104:107], v[24:27], v[228:231], 0
    v_mfma_f32_16x16x32_bf16 v[108:111], v[28:31], v[228:231], 0
    v_mfma_f32_16x16x32_bf16 v[112:115], v[32:35], v[228:231], 0
    v_mfma_f32_16x16x32_bf16 v[116:119], v[36:39], v[228:231], 0
    v_mfma_f32_16x16x32_bf16 v[120:123], v[40:43], v[228:231], 0
    v_mfma_f32_16x16x32_bf16 v[124:127], v[44:47], v[228:231], 0
    v_mfma_f32_16x16x32_bf16 v[128:131], v[48:51], v[228:231], 0
    v_mfma_f32_16x16x32_bf16 v[132:135], v[52:55], v[228:231], 0
    v_mfma_f32_16x16x32_bf16 v[136:139], v[56:59], v[228:231], 0
    v_mfma_f32_16x16x32_bf16 v[140:143], v[60:63], v[228:231], 0
    v_mfma_f32_16x16x32_bf16 v[144:147], v[64:67], v[228:231], 0
    v_mfma_f32_16x16x32_bf16 v[148:151], v[68:71], v[228:231], 0
    v_mfma_f32_16x16x32_bf16 v[152:155], v[72:75], v[228:231], 0
    v_mfma_f32_16x16x32_bf16 v[156:159], v[76:79], v[228:231], 0
    v_mfma_f32_16x16x32_bf16 v[160:163], v[80:83], v[228:231], 0
    v_mfma_f32_16x16x32_bf16 v[164:167], v[84:87], v[228:231], 0
    v_mfma_f32_16x16x32_bf16 v[168:171], v[88:91], v[228:231], 0
    v_mfma_f32_16x16x32_bf16 v[172:175], v[92:95], v[228:231], 0
    s_mov_b32 exec_lo, 0x00030003
    s_mov_b32 exec_hi, 0x00030003
    buffer_store_dwordx4 v[96:99], v237, s[64:67], s72 offen offset:0 sc1
    buffer_store_dwordx4 v[100:103], v237, s[64:67], s72 offen offset:64 sc1
    buffer_store_dwordx4 v[104:107], v237, s[64:67], s72 offen offset:128 sc1
    buffer_store_dwordx4 v[108:111], v237, s[64:67], s72 offen offset:192 sc1
    buffer_store_dwordx4 v[112:115], v237, s[64:67], s72 offen offset:256 sc1
    buffer_store_dwordx4 v[116:119], v237, s[64:67], s72 offen offset:320 sc1
    buffer_store_dwordx4 v[120:123], v237, s[64:67], s72 offen offset:384 sc1
    buffer_store_dwordx4 v[124:127], v237, s[64:67], s72 offen offset:448 sc1
    buffer_store_dwordx4 v[128:131], v237, s[64:67], s72 offen offset:512 sc1
    buffer_store_dwordx4 v[132:135], v237, s[64:67], s72 offen offset:576 sc1
    buffer_store_dwordx4 v[136:139], v237, s[64:67], s72 offen offset:640 sc1
    buffer_store_dwordx4 v[140:143], v237, s[64:67], s72 offen offset:704 sc1
    buffer_store_dwordx4 v[144:147], v237, s[64:67], s72 offen offset:768 sc1
    buffer_store_dwordx4 v[148:151], v237, s[64:67], s72 offen offset:832 sc1
    buffer_store_dwordx4 v[152:155], v237, s[64:67], s72 offen offset:896 sc1
    buffer_store_dwordx4 v[156:159], v237, s[64:67], s72 offen offset:960 sc1
    buffer_store_dwordx4 v[160:163], v237, s[64:67], s72 offen offset:1024 sc1
    buffer_store_dwordx4 v[164:167], v237, s[64:67], s72 offen offset:1088 sc1
    buffer_store_dwordx4 v[168:171], v237, s[64:67], s72 offen offset:1152 sc1
    buffer_store_dwordx4 v[172:175], v237, s[64:67], s72 offen offset:1216 sc1
    s_mov_b64 exec, -1
    s_lshl_b32 s3, s44, 5
    s_lshl3_add_u32 s3, s73, s3
    s_add_u32 s3, s3, 565248
    v_mov_b32 v2, s3
    v_mov_b32 v228, 1
    v_mov_b32 v229, 1
    s_waitcnt vmcnt(0)
    s_mov_b64 exec, 1
    global_store_dwordx2 v2, v[228:229], s[10:11] sc1
    s_mov_b64 exec, -1
    s_branch K_P2_HELP
K_CODE_END:
.section .rodata,"a"
.p2align 6
.amdhsa_kernel gated_mix__sliding_local_dilated__moe_arch_mod__prompt_kernel
  .amdhsa_next_free_vgpr 248
  .amdhsa_next_free_sgpr 79
  .amdhsa_accum_offset 248
  .amdhsa_group_segment_fixed_size 0
  .amdhsa_kernarg_size 96
  .amdhsa_user_sgpr_count 2
  .amdhsa_user_sgpr_kernarg_segment_ptr 1
  .amdhsa_system_sgpr_workgroup_id_x 1
.end_amdhsa_kernel
```

```asm
; @launch grid=(256,1,1) block=(512,1,1) lds=163840
.amdgcn_target "amdgcn-amd-amdhsa--gfx950"
.text
.p2align 12
.p2align 8
.globl gated_mix__sliding_local_dilated__moe_arch_mod__prompt_kernel
.type gated_mix__sliding_local_dilated__moe_arch_mod__prompt_kernel,@function
gated_mix__sliding_local_dilated__moe_arch_mod__prompt_kernel:
    s_cmp_ge_u32 s2, 256
    s_cbranch_scc1 K_EXIT
    s_load_dwordx2 s[12:13], s[0:1], 0
    s_load_dwordx2 s[16:17], s[0:1], 8
    v_readfirstlane_b32 s30, v0
    s_load_dwordx4 s[8:11], s[0:1], 80
    s_load_dwordx2 s[24:25], s[0:1], 16
    s_load_dwordx2 s[6:7], s[0:1], 72
    s_and_b32 s28, s2, 7
    v_and_b32 v1, 63, v0
    s_mov_b32 s14, 0x280000
    s_mov_b32 s15, 0x20000
    s_lshr_b32 s30, s30, 6
    s_cmp_lt_u32 s2, 64
    s_cbranch_scc1 K_SLOW
    s_cmp_lt_u32 s30, 4
    s_cbranch_scc1 K_FAST
K_SLOW:
    s_getpc_b64 s[38:39]
K_PC:
    s_bfe_u32 s3, s2, 0x30003
    s_mul_i32 s3, s3, ((K_CODE_END-gated_mix__sliding_local_dilated__moe_arch_mod__prompt_kernel+1023)/1024)
    s_sub_u32 s38, s38, K_PC-gated_mix__sliding_local_dilated__moe_arch_mod__prompt_kernel
    s_subb_u32 s39, s39, 0
    v_subrev_u32 v3, 256, v0
    v_add_u32 v2, s3, v3
    v_lshlrev_b32 v2, 7, v2
    v_min_u32 v2, K_CODE_END-gated_mix__sliding_local_dilated__moe_arch_mod__prompt_kernel-4, v2
    v_cmp_gt_u32 vcc, ((K_CODE_END-gated_mix__sliding_local_dilated__moe_arch_mod__prompt_kernel+1023)/1024), v3
    s_and_saveexec_b64 s[4:5], vcc
    s_cbranch_execz K_NOPF
    global_load_dword v6, v2, s[38:39]
K_NOPF:
    s_mov_b64 exec, -1
    v_mov_b32 v2, 0
    v_mov_b32 v3, 158752
    ds_write2_b32 v3, v2, v2 offset0:0 offset1:1
    ds_write2_b32 v3, v2, v2 offset0:2 offset1:3
    ds_write2_b32 v3, v2, v2 offset0:4 offset1:5
    ds_write2_b32 v3, v2, v2 offset0:6 offset1:7
    ds_write2_b32 v3, v2, v2 offset0:8 offset1:9
    s_mov_b32 s43, 1
    s_lshl_b32 s3, s30, 8
    s_add_u32 s3, s3, s2
    s_lshr_b32 s3, s3, 3
    s_cmp_lg_u32 s3, 160
    s_cbranch_scc1 K_COMMON
    s_mul_i32 s3, s2, 6144
    s_add_u32 s3, s3, 527360
    v_lshl_add_u32 v6, v1, 4, s3
    v_mov_b64 v[28:29], 0
    v_mov_b64 v[30:31], 0
    s_waitcnt lgkmcnt(0)
    global_store_dwordx4 v6, v[28:31], s[10:11] offset:-3072 sc1
    global_store_dwordx4 v6, v[28:31], s[10:11] offset:-2048 sc1
    global_store_dwordx4 v6, v[28:31], s[10:11] offset:-1024 sc1
    global_store_dwordx4 v6, v[28:31], s[10:11] offset:0 sc1
    global_store_dwordx4 v6, v[28:31], s[10:11] offset:1024 sc1
    global_store_dwordx4 v6, v[28:31], s[10:11] offset:2048 sc1
    s_lshl_b32 s3, s2, 2
    v_mov_b32 v2, s3
    v_mov_b32 v3, 1
    s_mov_b64 exec, 1
    s_waitcnt vmcnt(0)
    global_store_dword v2, v3, s[8:9] offset:192 sc1
    s_mov_b64 exec, -1
    s_branch K_COMMON
K_FAST:
    s_lshr_b32 s32, s2, 1
    s_and_b32 s32, s32, 28
    v_lshrrev_b32 v3, 4, v1
    s_lshr_b32 s3, s2, 6
    s_mov_b32 s59, 0x98450216
    s_cmp_eq_u32 s3, 2
    s_cselect_b32 s59, 0x70238164, s59
    v_and_b32 v4, 7, v1
    s_cmp_eq_u32 s3, 3
    s_cselect_b32 s59, 0x65703481, s59
    v_lshrrev_b32 v2, 3, v1
    s_lshr_b32 s59, s59, s32
    s_and_b32 s59, s59, 15
    v_xor_b32 v4, v4, v3
    s_add_u32 s59, s59, s28
    s_cmp_ge_u32 s59, 10
    v_mul_u32_u24 v2, 1280, v2
    s_cselect_b32 s33, 10, 0
    s_sub_u32 s59, s59, s33
    s_lshr_b32 s53, s28, 1
    v_lshl_add_u32 v44, v4, 4, v2
    s_mul_i32 s53, s53, 675840
    s_mul_i32 s3, s3, 225280
    v_xor_b32 v45, 64, v44
    s_add_u32 s53, s53, s3
    s_mul_i32 s54, s30, 61440
    s_add_u32 s53, s53, s54
    s_sub_u32 s53, s53, 245760
    s_mul_i32 s55, s30, 6144
    s_add_u32 s55, s55, 40960
    s_lshl_b32 s57, s59, 7
    s_add_u32 s57, s57, s53
    s_waitcnt lgkmcnt(0)
    s_add_u32 m0, s55, 0
    s_max_i32 s60, s57, 0
    buffer_load_dwordx4 v44, s[12:15], s60 offen lds
    s_add_u32 s60, s57, 10240
    s_add_u32 m0, s55, 1024
    s_max_i32 s60, s60, 0
    buffer_load_dwordx4 v45, s[12:15], s60 offen lds
    s_add_u32 m0, s55, 2048
    s_add_u32 s60, s57, 20480
    buffer_load_dwordx4 v44, s[12:15], s60 offen lds
    s_add_u32 m0, s55, 3072
    s_add_u32 s60, s57, 30720
    buffer_load_dwordx4 v45, s[12:15], s60 offen lds
    s_add_u32 m0, s55, 4096
    s_add_u32 s60, s57, 40960
    buffer_load_dwordx4 v44, s[12:15], s60 offen lds
    s_add_u32 m0, s55, 5120
    s_add_u32 s60, s57, 51200
    buffer_load_dwordx4 v45, s[12:15], s60 offen lds
    v_lshlrev_b32 v2, 1, v3
    s_lshr_b32 s32, 0x64317520, s32
    v_sub_u32 v2, v1, v2
    s_and_b32 s32, s32, 7
    v_and_b32 v2, 15, v2
    s_and_b32 s3, s28, 1
    v_mul_u32_u24 v3, 3840, v3
    s_lshl3_add_u32 s32, s3, s32
    v_mul_u32_u24 v4, 13, v2
    s_mul_i32 s3, s32, 80
    v_lshrrev_b32 v4, 6, v4
    s_add_u32 s54, s54, s3
    v_mul_u32_u24 v4, 1200, v4
    s_lshl_b32 s56, s30, 12
    v_lshl_add_u32 v4, v2, 4, v4
    s_add_u32 s56, s56, 65536
    v_add_u32 v5, 1, v2
    s_mov_b32 s18, 0x258000
    v_and_b32 v5, 16, v5
    s_mov_b32 s19, 0x20000
    v_lshl_add_u32 v4, v5, 24, v4
    v_add_u32 v46, v3, v4
    s_mul_i32 s58, s59, 245760
    s_add_u32 s58, s58, s54
    s_add_u32 s59, s59, 1
    s_cmp_eq_u32 s59, 10
    s_cselect_b32 s59, 0, s59
    s_add_u32 m0, s56, 0
    s_add_u32 s60, s58, 0
    buffer_load_dwordx4 v46, s[16:19], s60 offen lds
    s_add_u32 m0, s56, 1024
    s_add_u32 s60, s58, 15360
    buffer_load_dwordx4 v46, s[16:19], s60 offen lds
    v_xor_b32 v2, 8, v2
    v_mul_u32_u24 v4, 13, v2
    v_lshrrev_b32 v4, 6, v4
    v_mul_u32_u24 v4, 1200, v4
    v_lshl_add_u32 v4, v2, 4, v4
    v_add_u32 v5, 1, v2
    v_and_b32 v5, 16, v5
    v_lshl_add_u32 v4, v5, 24, v4
    v_add_u32 v47, v3, v4
    s_add_u32 m0, s56, 2048
    s_add_u32 s60, s58, 30720
    buffer_load_dwordx4 v47, s[16:19], s60 offen lds
    s_add_u32 m0, s56, 3072
    s_add_u32 s60, s58, 46080
    buffer_load_dwordx4 v47, s[16:19], s60 offen lds
    s_mov_b32 s3, 40960
    s_cmp_ge_u32 s55, 81920
    s_cselect_b32 s60, -81920, s3
    s_add_u32 s55, s55, s60
    s_add_u32 s56, s56, s60
    s_lshl_b32 s57, s59, 7
    s_add_u32 s57, s57, s53
    s_mul_i32 s58, s59, 245760
    s_add_u32 s58, s58, s54
    s_add_u32 s59, s59, 1
    s_cmp_eq_u32 s59, 10
    s_cselect_b32 s59, 0, s59
    s_add_u32 m0, s56, 0
    s_add_u32 s60, s58, 0
    buffer_load_dwordx4 v46, s[16:19], s60 offen lds
    s_add_u32 m0, s55, 0
    s_max_i32 s60, s57, 0
    buffer_load_dwordx4 v44, s[12:15], s60 offen lds
    s_add_u32 m0, s56, 1024
    s_add_u32 s60, s58, 15360
    buffer_load_dwordx4 v46, s[16:19], s60 offen lds
    s_add_u32 s60, s57, 10240
    s_add_u32 m0, s55, 1024
    s_max_i32 s60, s60, 0
    buffer_load_dwordx4 v45, s[12:15], s60 offen lds
    s_add_u32 m0, s55, 2048
    s_add_u32 s60, s57, 20480
    buffer_load_dwordx4 v44, s[12:15], s60 offen lds
    s_mov_b32 s52, s30
    s_mov_b32 s43, 0
K_COMMON:
    v_mov_b32 v7, 0
    s_lshr_b32 s29, s2, 3
    s_xor_b32 s30, s30, 4
    s_mov_b32 s26, 0xc8000
    s_mov_b32 s27, 0x20000
    s_lshr_b32 s34, s29, 3
    s_lshl_b32 s34, s34, 2
    s_and_b32 s3, s29, 3
    s_add_u32 s34, s34, s3
    s_add_u32 s34, s34, 4
    s_bitcmp1_b32 s29, 2
    s_cselect_b32 s34, -1, s34
    s_cmp_lt_u32 s29, 8
    s_cselect_b32 s34, s29, s34
    s_lshl_b32 s40, s28, 1
    s_cmp_ge_u32 s34, 10
    s_addc_u32 s40, s40, 0
    s_sub_u32 s41, s34, 10
    s_cmp_ge_u32 s34, 10
    s_cselect_b32 s41, s41, s34
    s_mul_i32 s42, s28, 20
    s_add_u32 s42, s42, s34
    s_and_b32 s42, s42, 255
    s_lshl_b32 s42, s42, 8
    s_add_u32 s42, s42, 524288
    s_cmp_lt_u32 s29, 8
    s_cbranch_scc1 K_AUX
    s_lshr_b32 s31, s28, 1
    s_mul_i32 s31, s31, 3
    s_lshr_b32 s3, s29, 3
    s_add_u32 s31, s31, s3
    s_sub_u32 s31, s31, 1
    s_and_b32 s35, s29, 3
    s_and_b32 s3, s29, 4
    s_lshl_b32 s3, s3, 1
    s_add_u32 s35, s35, s3
    s_and_b32 s3, s28, 1
    s_lshl_b32 s3, s3, 2
    s_add_u32 s35, s35, s3
    v_and_b32 v9, 15, v1
    v_lshrrev_b32 v10, 4, v1
    v_bfe_u32 v11, v1, 2, 2
    v_and_b32 v12, 3, v1
    s_waitcnt lgkmcnt(0)
    s_add_u32 s20, s10, 0x100000
    s_addc_u32 s21, s11, 0
    s_mov_b32 s22, 0x280000
    s_mov_b32 s23, 0x20000
    s_and_b32 s3, s30, 3
    s_mul_i32 s3, s3, 3
    s_lshr_b32 s33, s30, 2
    s_lshl1_add_u32 s3, s33, s3
    s_mul_i32 s44, s31, 11
    s_add_u32 s44, s44, s3
    s_mul_i32 s3, s3, 4352
    s_add_u32 s3, s3, 81920
    v_mul_u32_u24 v14, 272, v9
    v_lshl_add_u32 v13, v10, 3, v14
    v_add_u32 v13, s3, v13
    v_add3_u32 v14, v14, 32, s3
    v_cmp_eq_u32 vcc, 0, v10
    v_add_u32 v2, 208, v14
    v_add_u32 v3, 0, v14
    v_add_u32 v4, 40, v14
    v_cndmask_b32 v19, v2, v3, vcc
    v_cndmask_b32 v20, v2, v4, vcc
    v_lshl_add_u32 v15, v10, 2, v11
    v_mul_u32_u24 v15, 272, v15
    v_add_u32 v5, s3, v15
    v_lshl_add_u32 v15, v12, 3, v5
    v_add_u32 v2, 240, v5
    v_add_u32 v3, 192, v5
    v_add_u32 v4, 232, v5
    v_cmp_eq_u32 vcc, 0, v12
    s_nop 1
    v_cndmask_b32 v21, v2, v3, vcc
    v_cmp_eq_u32 vcc, 1, v12
    s_nop 1
    v_cndmask_b32 v22, v2, v4, vcc
    v_cmp_eq_u32 vcc, 2, v12
    s_nop 1
    v_cndmask_b32 v23, v2, v3, vcc
    v_cmp_eq_u32 vcc, 3, v12
    s_nop 1
    v_cndmask_b32 v24, v2, v4, vcc
    s_lshl_b32 s3, s35, 10
    v_lshl_add_u32 v16, v1, 4, s3
    s_lshl_b32 s3, s35, 8
    s_add_u32 s3, s3, 16384
    v_lshl_add_u32 v17, v9, 4, s3
    v_and_b32 v2, 1, v10
    v_lshl_add_u32 v17, v2, 3, v17
    s_cmp_lt_u32 s30, 4
    s_cselect_b32 s3, 0, 0x800000
    s_add_u32 s3, s3, 20480
    v_lshrrev_b32 v2, 1, v10
    v_mad_u32_u24 v17, v2, s3, v17
    s_mul_i32 s50, s44, 20480
    s_add_u32 s51, s50, 20480
    v_mov_b32 v18, 0xf149f2ca
    v_lshlrev_b32 v2, 2, v10
    v_sub_u32 v2, v9, v2
    s_cmp_eq_u32 s44, 0
    s_cselect_b32 s3, 0xf149f2ca, 0
    v_subrev_u32 v3, 0, v2
    v_and_b32 v4, 0x80000001, v3
    v_cmp_eq_u32 vcc, 0, v4
    s_nop 1
    v_cndmask_b32 v32, v18, 0, vcc
    v_cmp_eq_u32 vcc, 0x80000000, v4
    s_nop 1
    v_cndmask_b32 v28, v18, 0, vcc
    v_add_f32 v36, s3, v28
    v_subrev_u32 v3, 1, v2
    v_and_b32 v4, 0x80000001, v3
    v_cmp_eq_u32 vcc, 0, v4
    s_nop 1
    v_cndmask_b32 v33, v18, 0, vcc
    v_cmp_eq_u32 vcc, 0x80000000, v4
    s_nop 1
    v_cndmask_b32 v29, v18, 0, vcc
    v_add_f32 v37, s3, v29
    v_subrev_u32 v3, 2, v2
    v_and_b32 v4, 0x80000001, v3
    v_cmp_eq_u32 vcc, 0, v4
    s_nop 1
    v_cndmask_b32 v34, v18, 0, vcc
    v_cmp_eq_u32 vcc, 0x80000000, v4
    s_nop 1
    v_cndmask_b32 v30, v18, 0, vcc
    v_add_f32 v38, s3, v30
    v_subrev_u32 v3, 3, v2
    v_and_b32 v4, 0x80000001, v3
    v_cmp_eq_u32 vcc, 0, v4
    s_nop 1
    v_cndmask_b32 v35, v18, 0, vcc
    v_cmp_eq_u32 vcc, 0x80000000, v4
    s_nop 1
    v_cndmask_b32 v31, v18, 0, vcc
    v_add_f32 v39, s3, v31
    v_mov_b32 v3, 0x0c0c0c0c
    v_mov_b32 v4, 0xc0c0100
    v_cmp_eq_u32 vcc, 0, v28
    v_mov_b32 v5, 0x1000c0c
    s_nop 0
    v_cndmask_b32 v3, v3, v4, vcc
    v_cmp_eq_u32 vcc, 0, v29
    s_nop 1
    v_cndmask_b32 v40, v3, v5, vcc
    v_mov_b32 v3, 0x0c0c0c0c
    v_mov_b32 v4, 0xc0c0302
    v_cmp_eq_u32 vcc, 0, v30
    v_mov_b32 v5, 0x3020c0c
    s_nop 0
    v_cndmask_b32 v3, v3, v4, vcc
    v_cmp_eq_u32 vcc, 0, v31
    s_nop 1
    v_cndmask_b32 v41, v3, v5, vcc
    v_mov_b32 v3, 0x0c0c0c0c
    v_mov_b32 v4, 0xc0c0100
    v_cmp_eq_u32 vcc, 0, v32
    v_mov_b32 v5, 0x1000c0c
    s_nop 0
    v_cndmask_b32 v3, v3, v4, vcc
    v_cmp_eq_u32 vcc, 0, v33
    s_nop 1
    v_cndmask_b32 v42, v3, v5, vcc
    v_mov_b32 v3, 0x0c0c0c0c
    v_mov_b32 v4, 0xc0c0302
    v_cmp_eq_u32 vcc, 0, v34
    v_mov_b32 v5, 0x3020c0c
    s_nop 0
    v_cndmask_b32 v3, v3, v4, vcc
    v_cmp_eq_u32 vcc, 0, v35
    s_nop 1
    v_cndmask_b32 v43, v3, v5, vcc
    s_mov_b32 s46, 0x3fb8aa3b
    s_mov_b32 s47, s46
    s_mov_b32 s48, 0x3e64f92e
    s_mov_b32 s49, s48
    s_mul_i32 s3, s31, 11
    s_add_u32 s33, s3, 10
    s_lshr_b32 s3, s3, 3
    s_lshr_b32 s33, s33, 3
    s_min_u32 s33, s33, 15
    s_sub_u32 s33, s33, s3
    s_add_u32 s33, s33, 1
    s_mul_i32 s33, s33, 10
    s_bfm_b32 s36, s33, 0
    v_mul_u32_u24 v2, 205, v1
    v_lshrrev_b32 v2, 11, v2
    v_add_u32 v2, s3, v2
    v_mul_u32_u24 v2, 1496, v2
    v_lshrrev_b32 v2, 11, v2
    v_sub_u32 v2, s31, v2
    v_and_b32 v2, 1, v2
    v_lshlrev_b32 v2, 6, v2
    v_lshl_add_u32 v2, v1, 8, v2
    s_mul_i32 s3, s3, 2560
    s_lshl_b32 s33, s35, 2
    s_add_u32 s3, s3, s33
    s_add_u32 s3, s3, 524288
    v_add_u32 v8, s3, v2
    s_cmp_eq_u32 s43, 1
    s_cbranch_scc1 K_CONS
    v_lshrrev_b32 v2, 3, v1
    v_mul_u32_u24 v2, 1280, v2
    v_lshrrev_b32 v3, 4, v1
    v_lshlrev_b32 v3, 1, v3
    v_and_b32 v4, 7, v1
    v_xor_b32 v3, v3, v4
    v_lshl_add_u32 v2, v3, 4, v2
    s_lshl_b32 s33, s41, 7
    v_add_u32 v18, s33, v2
    s_mov_b32 s61, 9
    s_mov_b32 s3, 40960
K_LOOP0:
    s_waitcnt vmcnt(5)
    s_barrier
    s_add_u32 m0, s56, 2048
    s_add_u32 s60, s58, 30720
    buffer_load_dwordx4 v47, s[16:19], s60 offen lds
    s_add_u32 m0, s55, 3072
    s_add_u32 s60, s57, 30720
    buffer_load_dwordx4 v45, s[12:15], s60 offen lds
    s_add_u32 m0, s56, 3072
    s_add_u32 s60, s58, 46080
    buffer_load_dwordx4 v47, s[16:19], s60 offen lds
    s_add_u32 m0, s55, 4096
    s_add_u32 s60, s57, 40960
    buffer_load_dwordx4 v44, s[12:15], s60 offen lds
    s_add_u32 m0, s55, 5120
    s_add_u32 s60, s57, 51200
    buffer_load_dwordx4 v45, s[12:15], s60 offen lds
    s_sub_u32 s61, s61, 1
    s_cmp_eq_u32 s61, 0
    s_cbranch_scc1 K_LOOPX
    s_cmp_ge_u32 s55, 81920
    s_cselect_b32 s60, -81920, s3
    s_add_u32 s55, s55, s60
    s_add_u32 s56, s56, s60
    s_lshl_b32 s57, s59, 7
    s_add_u32 s57, s57, s53
    s_mul_i32 s58, s59, 245760
    s_add_u32 s58, s58, s54
    s_add_u32 s59, s59, 1
    s_cmp_eq_u32 s59, 10
    s_cselect_b32 s59, 0, s59
    s_add_u32 m0, s56, 0
    s_add_u32 s60, s58, 0
    buffer_load_dwordx4 v46, s[16:19], s60 offen lds
    s_add_u32 m0, s55, 0
    s_max_i32 s60, s57, 0
    buffer_load_dwordx4 v44, s[12:15], s60 offen lds
    s_add_u32 m0, s56, 1024
    s_add_u32 s60, s58, 15360
    buffer_load_dwordx4 v46, s[16:19], s60 offen lds
    s_add_u32 s60, s57, 10240
    s_add_u32 m0, s55, 1024
    s_max_i32 s60, s60, 0
    buffer_load_dwordx4 v45, s[12:15], s60 offen lds
    s_add_u32 m0, s55, 2048
    s_add_u32 s60, s57, 20480
    buffer_load_dwordx4 v44, s[12:15], s60 offen lds
    s_branch K_LOOP0
K_LOOPX:
    v_and_b32 v2, 7, v1
    v_lshlrev_b32 v2, 2, v2
    s_waitcnt vmcnt(0)
    s_barrier
    s_cmp_lt_u32 s30, 6
    s_cbranch_scc1 K_NOSMP
    global_load_dword v7, v2, s[8:9] offset:192 sc1
K_NOSMP:
    s_cmp_eq_u32 s34, -1
    s_cbranch_scc1 K_JOIN_S
    s_cmp_lg_u32 s30, 7
    s_cbranch_scc1 K_WOE
    s_barrier
K_WOE:
    s_lshl_b32 s57, s52, 2
    s_lshr_b32 s57, 0x7520, s57
    s_and_b32 s57, s57, 7
    s_mul_i32 s57, s57, 51200
    s_mul_i32 s58, s52, 5120
    s_add_u32 s3, s57, 0
    s_add_u32 m0, s58, 0
    s_nop 0
    buffer_load_dwordx4 v18, s[24:27], s3 offen lds
    s_add_u32 s3, s57, 10240
    s_add_u32 m0, s58, 1024
    s_nop 0
    buffer_load_dwordx4 v18, s[24:27], s3 offen lds
    s_add_u32 s3, s57, 20480
    s_add_u32 m0, s58, 2048
    s_nop 0
    buffer_load_dwordx4 v18, s[24:27], s3 offen lds
    s_add_u32 s3, s57, 30720
    s_add_u32 m0, s58, 3072
    s_nop 0
    buffer_load_dwordx4 v18, s[24:27], s3 offen lds
    s_add_u32 s3, s57, 40960
    s_add_u32 m0, s58, 4096
    s_nop 0
    buffer_load_dwordx4 v18, s[24:27], s3 offen lds
    s_add_u32 s3, s57, 409600
    s_add_u32 m0, s58, 20480
    s_nop 0
    buffer_load_dwordx4 v18, s[24:27], s3 offen lds
    s_add_u32 s3, s57, 419840
    s_add_u32 m0, s58, 21504
    s_nop 0
    buffer_load_dwordx4 v18, s[24:27], s3 offen lds
    s_add_u32 s3, s57, 430080
    s_add_u32 m0, s58, 22528
    s_nop 0
    buffer_load_dwordx4 v18, s[24:27], s3 offen lds
    s_add_u32 s3, s57, 440320
    s_add_u32 m0, s58, 23552
    s_nop 0
    buffer_load_dwordx4 v18, s[24:27], s3 offen lds
    s_add_u32 s3, s57, 450560
    s_add_u32 m0, s58, 24576
    s_nop 0
    buffer_load_dwordx4 v18, s[24:27], s3 offen lds
    s_cmp_lg_u32 s30, 7
    s_cbranch_scc1 K_JOIN_S
    s_mov_b32 s52, 0
K_XD:
    s_lshl_b32 s57, s40, 3
    s_lshl1_add_u32 s57, s52, s57
    s_mul_i32 s57, s57, 20480
    s_lshl_b32 s33, s41, 7
    s_add_u32 s57, s57, s33
    s_lshl_b32 s33, s52, 12
    s_add_u32 m0, s33, 140288
    s_add_u32 s3, s57, 0
    buffer_load_dwordx4 v44, s[12:15], s3 offen lds
    s_add_u32 m0, s33, 141312
    s_add_u32 s3, s57, 10240
    buffer_load_dwordx4 v45, s[12:15], s3 offen lds
    s_add_u32 m0, s33, 142336
    s_add_u32 s3, s57, 20480
    buffer_load_dwordx4 v44, s[12:15], s3 offen lds
    s_add_u32 m0, s33, 143360
    s_add_u32 s3, s57, 30720
    buffer_load_dwordx4 v45, s[12:15], s3 offen lds
    s_add_u32 s52, s52, 1
    s_cmp_lt_u32 s52, 4
    s_cbranch_scc1 K_XD
    s_branch K_W7
.p2align 12
K_CONS:
    s_lshr_b32 s52, s30, 1
    s_and_b32 s53, s30, 1
    v_lshrrev_b32 v2, 1, v9
    v_xor_b32 v2, v2, v10
    v_lshlrev_b32 v2, 4, v2
    v_lshl_add_u32 v2, v9, 7, v2
    s_mul_i32 s3, s52, 12288
    v_add_u32 v44, s3, v2
    v_xor_b32 v45, 64, v44
    v_add_u32 v46, 81920, v44
    v_add_u32 v47, 81920, v45
    v_and_b32 v2, 1, v10
    v_lshl_or_b32 v2, v2, 2, v11
    v_lshl_add_u32 v3, v10, 3, v11
    v_lshlrev_b32 v3, 8, v3
    v_lshl_add_u32 v3, v12, 3, v3
    v_add_u32 v3, 24576, v3
    s_lshl_b32 s3, s53, 2
    v_add_u32 v2, s3, v2
    v_add_u32 v4, 0, v2
    v_and_b32 v4, 7, v4
    v_lshl_add_u32 v48, v4, 5, v3
    v_add_u32 v52, 81920, v48
    v_add_u32 v4, 1, v2
    v_and_b32 v4, 7, v4
    v_lshl_add_u32 v49, v4, 5, v3
    v_add_u32 v53, 81920, v49
    v_add_u32 v4, 2, v2
    v_and_b32 v4, 7, v4
    v_lshl_add_u32 v50, v4, 5, v3
    v_add_u32 v54, 81920, v50
    v_add_u32 v4, 3, v2
    v_and_b32 v4, 7, v4
    v_lshl_add_u32 v51, v4, 5, v3
    v_add_u32 v55, 81920, v51
    v_mul_u32_u24 v56, 272, v9
    v_lshl_add_u32 v56, v10, 3, v56
    s_mul_i32 s3, s52, 26112
    s_lshl_b32 s33, s53, 7
    s_add_u32 s3, s3, s33
    s_add_u32 s3, s3, 81920
    v_add_u32 v56, s3, v56
    v_mov_b64 v[60:61], 0
    v_mov_b64 v[62:63], 0
    v_mov_b64 v[64:65], 0
    v_mov_b64 v[66:67], 0
    v_mov_b64 v[68:69], 0
    v_mov_b64 v[70:71], 0
    v_mov_b64 v[72:73], 0
    v_mov_b64 v[74:75], 0
    v_mov_b64 v[76:77], 0
    v_mov_b64 v[78:79], 0
    v_mov_b64 v[80:81], 0
    v_mov_b64 v[82:83], 0
    v_mov_b64 v[84:85], 0
    v_mov_b64 v[86:87], 0
    v_mov_b64 v[88:89], 0
    v_mov_b64 v[90:91], 0
    v_mov_b64 v[92:93], 0
    v_mov_b64 v[94:95], 0
    v_mov_b64 v[96:97], 0
    v_mov_b64 v[98:99], 0
    v_mov_b64 v[100:101], 0
    v_mov_b64 v[102:103], 0
    v_mov_b64 v[104:105], 0
    v_mov_b64 v[106:107], 0
    v_mov_b64 v[108:109], 0
    v_mov_b64 v[110:111], 0
    v_mov_b64 v[112:113], 0
    v_mov_b64 v[114:115], 0
    v_mov_b64 v[116:117], 0
    v_mov_b64 v[118:119], 0
    v_mov_b64 v[120:121], 0
    v_mov_b64 v[122:123], 0
    v_mov_b64 v[124:125], 0
    v_mov_b64 v[126:127], 0
    v_mov_b64 v[128:129], 0
    v_mov_b64 v[130:131], 0
    v_mov_b64 v[132:133], 0
    v_mov_b64 v[134:135], 0
    v_mov_b64 v[136:137], 0
    v_mov_b64 v[138:139], 0
    v_mov_b64 v[140:141], 0
    v_mov_b64 v[142:143], 0
    v_mov_b64 v[144:145], 0
    v_mov_b64 v[146:147], 0
    v_mov_b64 v[148:149], 0
    v_mov_b64 v[150:151], 0
    v_mov_b64 v[152:153], 0
    v_mov_b64 v[154:155], 0
    s_mov_b32 s54, 3
    s_cmp_lg_u32 s30, 0
    s_cbranch_scc1 K_WARMM0
    s_call_b64 s[38:39], WP_attd
    s_call_b64 s[38:39], WP_p2g
    s_branch K_WARMMX
K_WARMM0:
    s_cmp_lg_u32 s30, 1
    s_cbranch_scc1 K_WARMM1
    s_call_b64 s[38:39], WP_atts
    s_call_b64 s[38:39], WP_early
    s_branch K_WARMMX
K_WARMM1:
    s_cmp_lg_u32 s30, 2
    s_cbranch_scc1 K_WARMM2
    s_call_b64 s[38:39], WP_help
    s_call_b64 s[38:39], WP_flags
    s_branch K_WARMMX
K_WARMM2:
    s_call_b64 s[38:39], WP_spin
K_WARMMX:
    s_setprio 2
    s_barrier
    ds_read_b64_tr_b16 v[204:205], v48 offset:40960
    ds_read_b64_tr_b16 v[206:207], v48 offset:41984
    ds_read_b128 v[156:159], v44 offset:40960
    ds_read_b64_tr_b16 v[208:209], v49 offset:40960
    ds_read_b64_tr_b16 v[210:211], v49 offset:41984
    ds_read_b128 v[160:163], v44 offset:43008
    ds_read_b64_tr_b16 v[212:213], v50 offset:40960
    ds_read_b64_tr_b16 v[214:215], v50 offset:41984
    ds_read_b128 v[164:167], v44 offset:45056
    ds_read_b64_tr_b16 v[216:217], v51 offset:40960
    ds_read_b64_tr_b16 v[218:219], v51 offset:41984
    ds_read_b128 v[168:171], v44 offset:47104
    ds_read_b128 v[172:175], v44 offset:49152
    ds_read_b128 v[176:179], v44 offset:51200
K_CLOOP:
    s_waitcnt lgkmcnt(0)
    v_mfma_f32_16x16x32_bf16 v[60:63], v[204:207], v[156:159], v[60:63]
    ds_read_b64_tr_b16 v[220:221], v48 offset:49152
    v_mfma_f32_16x16x32_bf16 v[64:67], v[208:211], v[156:159], v[64:67]
    ds_read_b64_tr_b16 v[222:223], v48 offset:50176
    v_mfma_f32_16x16x32_bf16 v[68:71], v[212:215], v[156:159], v[68:71]
    ds_read_b128 v[180:183], v45 offset:40960
    v_mfma_f32_16x16x32_bf16 v[72:75], v[216:219], v[156:159], v[72:75]
    ds_read_b64_tr_b16 v[224:225], v49 offset:49152
    v_mfma_f32_16x16x32_bf16 v[88:91], v[216:219], v[160:163], v[88:91]
    ds_read_b64_tr_b16 v[226:227], v49 offset:50176
    v_mfma_f32_16x16x32_bf16 v[84:87], v[212:215], v[160:163], v[84:87]
    ds_read_b128 v[184:187], v45 offset:43008
    v_mfma_f32_16x16x32_bf16 v[80:83], v[208:211], v[160:163], v[80:83]
    ds_read_b64_tr_b16 v[228:229], v50 offset:49152
    v_mfma_f32_16x16x32_bf16 v[76:79], v[204:207], v[160:163], v[76:79]
    ds_read_b64_tr_b16 v[230:231], v50 offset:50176
    v_mfma_f32_16x16x32_bf16 v[92:95], v[204:207], v[164:167], v[92:95]
    ds_read_b128 v[188:191], v45 offset:45056
    v_mfma_f32_16x16x32_bf16 v[96:99], v[208:211], v[164:167], v[96:99]
    ds_read_b64_tr_b16 v[232:233], v51 offset:49152
    v_mfma_f32_16x16x32_bf16 v[100:103], v[212:215], v[164:167], v[100:103]
    ds_read_b64_tr_b16 v[234:235], v51 offset:50176
    v_mfma_f32_16x16x32_bf16 v[104:107], v[216:219], v[164:167], v[104:107]
    ds_read_b128 v[192:195], v45 offset:47104
    v_mfma_f32_16x16x32_bf16 v[120:123], v[216:219], v[168:171], v[120:123]
    ds_read_b128 v[196:199], v45 offset:49152
    v_mfma_f32_16x16x32_bf16 v[116:119], v[212:215], v[168:171], v[116:119]
    ds_read_b128 v[200:203], v45 offset:51200
    v_mfma_f32_16x16x32_bf16 v[112:115], v[208:211], v[168:171], v[112:115]
    v_mfma_f32_16x16x32_bf16 v[108:111], v[204:207], v[168:171], v[108:111]
    v_mfma_f32_16x16x32_bf16 v[124:127], v[204:207], v[172:175], v[124:127]
    v_mfma_f32_16x16x32_bf16 v[128:131], v[208:211], v[172:175], v[128:131]
    v_mfma_f32_16x16x32_bf16 v[132:135], v[212:215], v[172:175], v[132:135]
    v_mfma_f32_16x16x32_bf16 v[136:139], v[216:219], v[172:175], v[136:139]
    v_mfma_f32_16x16x32_bf16 v[152:155], v[216:219], v[176:179], v[152:155]
    v_mfma_f32_16x16x32_bf16 v[148:151], v[212:215], v[176:179], v[148:151]
    v_mfma_f32_16x16x32_bf16 v[144:147], v[208:211], v[176:179], v[144:147]
    v_mfma_f32_16x16x32_bf16 v[140:143], v[204:207], v[176:179], v[140:143]
    s_waitcnt lgkmcnt(0)
    s_barrier
    v_mfma_f32_16x16x32_bf16 v[60:63], v[220:223], v[180:183], v[60:63]
    ds_read_b64_tr_b16 v[204:205], v52 offset:0
    v_mfma_f32_16x16x32_bf16 v[64:67], v[224:227], v[180:183], v[64:67]
    ds_read_b64_tr_b16 v[206:207], v52 offset:1024
    v_mfma_f32_16x16x32_bf16 v[68:71], v[228:231], v[180:183], v[68:71]
    ds_read_b128 v[156:159], v46 offset:0
    v_mfma_f32_16x16x32_bf16 v[72:75], v[232:235], v[180:183], v[72:75]
    ds_read_b64_tr_b16 v[208:209], v53 offset:0
    v_mfma_f32_16x16x32_bf16 v[88:91], v[232:235], v[184:187], v[88:91]
    ds_read_b64_tr_b16 v[210:211], v53 offset:1024
    v_mfma_f32_16x16x32_bf16 v[84:87], v[228:231], v[184:187], v[84:87]
    ds_read_b128 v[160:163], v46 offset:2048
    v_mfma_f32_16x16x32_bf16 v[80:83], v[224:227], v[184:187], v[80:83]
    ds_read_b64_tr_b16 v[212:213], v54 offset:0
    v_mfma_f32_16x16x32_bf16 v[76:79], v[220:223], v[184:187], v[76:79]
    ds_read_b64_tr_b16 v[214:215], v54 offset:1024
    v_mfma_f32_16x16x32_bf16 v[92:95], v[220:223], v[188:191], v[92:95]
    ds_read_b128 v[164:167], v46 offset:4096
    v_mfma_f32_16x16x32_bf16 v[96:99], v[224:227], v[188:191], v[96:99]
    ds_read_b64_tr_b16 v[216:217], v55 offset:0
    v_mfma_f32_16x16x32_bf16 v[100:103], v[228:231], v[188:191], v[100:103]
    ds_read_b64_tr_b16 v[218:219], v55 offset:1024
    v_mfma_f32_16x16x32_bf16 v[104:107], v[232:235], v[188:191], v[104:107]
    ds_read_b128 v[168:171], v46 offset:6144
    v_mfma_f32_16x16x32_bf16 v[120:123], v[232:235], v[192:195], v[120:123]
    ds_read_b128 v[172:175], v46 offset:8192
    v_mfma_f32_16x16x32_bf16 v[116:119], v[228:231], v[192:195], v[116:119]
    ds_read_b128 v[176:179], v46 offset:10240
    v_mfma_f32_16x16x32_bf16 v[112:115], v[224:227], v[192:195], v[112:115]
    v_mfma_f32_16x16x32_bf16 v[108:111], v[220:223], v[192:195], v[108:111]
    v_mfma_f32_16x16x32_bf16 v[124:127], v[220:223], v[196:199], v[124:127]
    v_mfma_f32_16x16x32_bf16 v[128:131], v[224:227], v[196:199], v[128:131]
    v_mfma_f32_16x16x32_bf16 v[132:135], v[228:231], v[196:199], v[132:135]
    v_mfma_f32_16x16x32_bf16 v[136:139], v[232:235], v[196:199], v[136:139]
    v_mfma_f32_16x16x32_bf16 v[152:155], v[232:235], v[200:203], v[152:155]
    v_mfma_f32_16x16x32_bf16 v[148:151], v[228:231], v[200:203], v[148:151]
    v_mfma_f32_16x16x32_bf16 v[144:147], v[224:227], v[200:203], v[144:147]
    v_mfma_f32_16x16x32_bf16 v[140:143], v[220:223], v[200:203], v[140:143]
    s_waitcnt lgkmcnt(0)
    v_mfma_f32_16x16x32_bf16 v[60:63], v[204:207], v[156:159], v[60:63]
    ds_read_b64_tr_b16 v[220:221], v52 offset:8192
    v_mfma_f32_16x16x32_bf16 v[64:67], v[208:211], v[156:159], v[64:67]
    ds_read_b64_tr_b16 v[222:223], v52 offset:9216
    v_mfma_f32_16x16x32_bf16 v[68:71], v[212:215], v[156:159], v[68:71]
    ds_read_b128 v[180:183], v47 offset:0
    v_mfma_f32_16x16x32_bf16 v[72:75], v[216:219], v[156:159], v[72:75]
    ds_read_b64_tr_b16 v[224:225], v53 offset:8192
    v_mfma_f32_16x16x32_bf16 v[88:91], v[216:219], v[160:163], v[88:91]
    ds_read_b64_tr_b16 v[226:227], v53 offset:9216
    v_mfma_f32_16x16x32_bf16 v[84:87], v[212:215], v[160:163], v[84:87]
    ds_read_b128 v[184:187], v47 offset:2048
    v_mfma_f32_16x16x32_bf16 v[80:83], v[208:211], v[160:163], v[80:83]
    ds_read_b64_tr_b16 v[228:229], v54 offset:8192
    v_mfma_f32_16x16x32_bf16 v[76:79], v[204:207], v[160:163], v[76:79]
    ds_read_b64_tr_b16 v[230:231], v54 offset:9216
    v_mfma_f32_16x16x32_bf16 v[92:95], v[204:207], v[164:167], v[92:95]
    ds_read_b128 v[188:191], v47 offset:4096
    v_mfma_f32_16x16x32_bf16 v[96:99], v[208:211], v[164:167], v[96:99]
    ds_read_b64_tr_b16 v[232:233], v55 offset:8192
    v_mfma_f32_16x16x32_bf16 v[100:103], v[212:215], v[164:167], v[100:103]
    ds_read_b64_tr_b16 v[234:235], v55 offset:9216
    v_mfma_f32_16x16x32_bf16 v[104:107], v[216:219], v[164:167], v[104:107]
    ds_read_b128 v[192:195], v47 offset:6144
    v_mfma_f32_16x16x32_bf16 v[120:123], v[216:219], v[168:171], v[120:123]
    ds_read_b128 v[196:199], v47 offset:8192
    v_mfma_f32_16x16x32_bf16 v[116:119], v[212:215], v[168:171], v[116:119]
    ds_read_b128 v[200:203], v47 offset:10240
    v_mfma_f32_16x16x32_bf16 v[112:115], v[208:211], v[168:171], v[112:115]
    v_mfma_f32_16x16x32_bf16 v[108:111], v[204:207], v[168:171], v[108:111]
    v_mfma_f32_16x16x32_bf16 v[124:127], v[204:207], v[172:175], v[124:127]
    v_mfma_f32_16x16x32_bf16 v[128:131], v[208:211], v[172:175], v[128:131]
    v_mfma_f32_16x16x32_bf16 v[132:135], v[212:215], v[172:175], v[132:135]
    v_mfma_f32_16x16x32_bf16 v[136:139], v[216:219], v[172:175], v[136:139]
    v_mfma_f32_16x16x32_bf16 v[152:155], v[216:219], v[176:179], v[152:155]
    v_mfma_f32_16x16x32_bf16 v[148:151], v[212:215], v[176:179], v[148:151]
    v_mfma_f32_16x16x32_bf16 v[144:147], v[208:211], v[176:179], v[144:147]
    v_mfma_f32_16x16x32_bf16 v[140:143], v[204:207], v[176:179], v[140:143]
    s_waitcnt lgkmcnt(0)
    s_barrier
    v_mfma_f32_16x16x32_bf16 v[60:63], v[220:223], v[180:183], v[60:63]
    ds_read_b64_tr_b16 v[204:205], v48 offset:0
    v_mfma_f32_16x16x32_bf16 v[64:67], v[224:227], v[180:183], v[64:67]
    ds_read_b64_tr_b16 v[206:207], v48 offset:1024
    v_mfma_f32_16x16x32_bf16 v[68:71], v[228:231], v[180:183], v[68:71]
    ds_read_b128 v[156:159], v44 offset:0
    v_mfma_f32_16x16x32_bf16 v[72:75], v[232:235], v[180:183], v[72:75]
    ds_read_b64_tr_b16 v[208:209], v49 offset:0
    v_mfma_f32_16x16x32_bf16 v[88:91], v[232:235], v[184:187], v[88:91]
    ds_read_b64_tr_b16 v[210:211], v49 offset:1024
    v_mfma_f32_16x16x32_bf16 v[84:87], v[228:231], v[184:187], v[84:87]
    ds_read_b128 v[160:163], v44 offset:2048
    v_mfma_f32_16x16x32_bf16 v[80:83], v[224:227], v[184:187], v[80:83]
    ds_read_b64_tr_b16 v[212:213], v50 offset:0
    v_mfma_f32_16x16x32_bf16 v[76:79], v[220:223], v[184:187], v[76:79]
    ds_read_b64_tr_b16 v[214:215], v50 offset:1024
    v_mfma_f32_16x16x32_bf16 v[92:95], v[220:223], v[188:191], v[92:95]
    ds_read_b128 v[164:167], v44 offset:4096
    v_mfma_f32_16x16x32_bf16 v[96:99], v[224:227], v[188:191], v[96:99]
    ds_read_b64_tr_b16 v[216:217], v51 offset:0
    v_mfma_f32_16x16x32_bf16 v[100:103], v[228:231], v[188:191], v[100:103]
    ds_read_b64_tr_b16 v[218:219], v51 offset:1024
    v_mfma_f32_16x16x32_bf16 v[104:107], v[232:235], v[188:191], v[104:107]
    ds_read_b128 v[168:171], v44 offset:6144
    v_mfma_f32_16x16x32_bf16 v[120:123], v[232:235], v[192:195], v[120:123]
    ds_read_b128 v[172:175], v44 offset:8192
    v_mfma_f32_16x16x32_bf16 v[116:119], v[228:231], v[192:195], v[116:119]
    ds_read_b128 v[176:179], v44 offset:10240
    v_mfma_f32_16x16x32_bf16 v[112:115], v[224:227], v[192:195], v[112:115]
    v_mfma_f32_16x16x32_bf16 v[108:111], v[220:223], v[192:195], v[108:111]
    v_mfma_f32_16x16x32_bf16 v[124:127], v[220:223], v[196:199], v[124:127]
    v_mfma_f32_16x16x32_bf16 v[128:131], v[224:227], v[196:199], v[128:131]
    v_mfma_f32_16x16x32_bf16 v[132:135], v[228:231], v[196:199], v[132:135]
    v_mfma_f32_16x16x32_bf16 v[136:139], v[232:235], v[196:199], v[136:139]
    v_mfma_f32_16x16x32_bf16 v[152:155], v[232:235], v[200:203], v[152:155]
    v_mfma_f32_16x16x32_bf16 v[148:151], v[228:231], v[200:203], v[148:151]
    v_mfma_f32_16x16x32_bf16 v[144:147], v[224:227], v[200:203], v[144:147]
    v_mfma_f32_16x16x32_bf16 v[140:143], v[220:223], v[200:203], v[140:143]
    s_waitcnt lgkmcnt(0)
    v_mfma_f32_16x16x32_bf16 v[60:63], v[204:207], v[156:159], v[60:63]
    ds_read_b64_tr_b16 v[220:221], v48 offset:8192
    v_mfma_f32_16x16x32_bf16 v[64:67], v[208:211], v[156:159], v[64:67]
    ds_read_b64_tr_b16 v[222:223], v48 offset:9216
    v_mfma_f32_16x16x32_bf16 v[68:71], v[212:215], v[156:159], v[68:71]
    ds_read_b128 v[180:183], v45 offset:0
    v_mfma_f32_16x16x32_bf16 v[72:75], v[216:219], v[156:159], v[72:75]
    ds_read_b64_tr_b16 v[224:225], v49 offset:8192
    v_mfma_f32_16x16x32_bf16 v[88:91], v[216:219], v[160:163], v[88:91]
    ds_read_b64_tr_b16 v[226:227], v49 offset:9216
    v_mfma_f32_16x16x32_bf16 v[84:87], v[212:215], v[160:163], v[84:87]
    ds_read_b128 v[184:187], v45 offset:2048
    v_mfma_f32_16x16x32_bf16 v[80:83], v[208:211], v[160:163], v[80:83]
    ds_read_b64_tr_b16 v[228:229], v50 offset:8192
    v_mfma_f32_16x16x32_bf16 v[76:79], v[204:207], v[160:163], v[76:79]
    ds_read_b64_tr_b16 v[230:231], v50 offset:9216
    v_mfma_f32_16x16x32_bf16 v[92:95], v[204:207], v[164:167], v[92:95]
    ds_read_b128 v[188:191], v45 offset:4096
    v_mfma_f32_16x16x32_bf16 v[96:99], v[208:211], v[164:167], v[96:99]
    ds_read_b64_tr_b16 v[232:233], v51 offset:8192
    v_mfma_f32_16x16x32_bf16 v[100:103], v[212:215], v[164:167], v[100:103]
    ds_read_b64_tr_b16 v[234:235], v51 offset:9216
    v_mfma_f32_16x16x32_bf16 v[104:107], v[216:219], v[164:167], v[104:107]
    ds_read_b128 v[192:195], v45 offset:6144
    v_mfma_f32_16x16x32_bf16 v[120:123], v[216:219], v[168:171], v[120:123]
    ds_read_b128 v[196:199], v45 offset:8192
    v_mfma_f32_16x16x32_bf16 v[116:119], v[212:215], v[168:171], v[116:119]
    ds_read_b128 v[200:203], v45 offset:10240
    v_mfma_f32_16x16x32_bf16 v[112:115], v[208:211], v[168:171], v[112:115]
    v_mfma_f32_16x16x32_bf16 v[108:111], v[204:207], v[168:171], v[108:111]
    v_mfma_f32_16x16x32_bf16 v[124:127], v[204:207], v[172:175], v[124:127]
    v_mfma_f32_16x16x32_bf16 v[128:131], v[208:211], v[172:175], v[128:131]
    v_mfma_f32_16x16x32_bf16 v[132:135], v[212:215], v[172:175], v[132:135]
    v_mfma_f32_16x16x32_bf16 v[136:139], v[216:219], v[172:175], v[136:139]
    v_mfma_f32_16x16x32_bf16 v[152:155], v[216:219], v[176:179], v[152:155]
    v_mfma_f32_16x16x32_bf16 v[148:151], v[212:215], v[176:179], v[148:151]
    v_mfma_f32_16x16x32_bf16 v[144:147], v[208:211], v[176:179], v[144:147]
    v_mfma_f32_16x16x32_bf16 v[140:143], v[204:207], v[176:179], v[140:143]
    s_waitcnt lgkmcnt(0)
    s_barrier
    v_mfma_f32_16x16x32_bf16 v[60:63], v[220:223], v[180:183], v[60:63]
    ds_read_b64_tr_b16 v[204:205], v48 offset:40960
    v_mfma_f32_16x16x32_bf16 v[64:67], v[224:227], v[180:183], v[64:67]
    ds_read_b64_tr_b16 v[206:207], v48 offset:41984
    v_mfma_f32_16x16x32_bf16 v[68:71], v[228:231], v[180:183], v[68:71]
    ds_read_b128 v[156:159], v44 offset:40960
    v_mfma_f32_16x16x32_bf16 v[72:75], v[232:235], v[180:183], v[72:75]
    ds_read_b64_tr_b16 v[208:209], v49 offset:40960
    v_mfma_f32_16x16x32_bf16 v[88:91], v[232:235], v[184:187], v[88:91]
    ds_read_b64_tr_b16 v[210:211], v49 offset:41984
    v_mfma_f32_16x16x32_bf16 v[84:87], v[228:231], v[184:187], v[84:87]
    ds_read_b128 v[160:163], v44 offset:43008
    v_mfma_f32_16x16x32_bf16 v[80:83], v[224:227], v[184:187], v[80:83]
    ds_read_b64_tr_b16 v[212:213], v50 offset:40960
    v_mfma_f32_16x16x32_bf16 v[76:79], v[220:223], v[184:187], v[76:79]
    ds_read_b64_tr_b16 v[214:215], v50 offset:41984
    v_mfma_f32_16x16x32_bf16 v[92:95], v[220:223], v[188:191], v[92:95]
    ds_read_b128 v[164:167], v44 offset:45056
    v_mfma_f32_16x16x32_bf16 v[96:99], v[224:227], v[188:191], v[96:99]
    ds_read_b64_tr_b16 v[216:217], v51 offset:40960
    v_mfma_f32_16x16x32_bf16 v[100:103], v[228:231], v[188:191], v[100:103]
    ds_read_b64_tr_b16 v[218:219], v51 offset:41984
    v_mfma_f32_16x16x32_bf16 v[104:107], v[232:235], v[188:191], v[104:107]
    ds_read_b128 v[168:171], v44 offset:47104
    v_mfma_f32_16x16x32_bf16 v[120:123], v[232:235], v[192:195], v[120:123]
    ds_read_b128 v[172:175], v44 offset:49152
    v_mfma_f32_16x16x32_bf16 v[116:119], v[228:231], v[192:195], v[116:119]
    ds_read_b128 v[176:179], v44 offset:51200
    v_mfma_f32_16x16x32_bf16 v[112:115], v[224:227], v[192:195], v[112:115]
    s_sub_u32 s54, s54, 1
    v_mfma_f32_16x16x32_bf16 v[108:111], v[220:223], v[192:195], v[108:111]
    s_cmp_lg_u32 s54, 0
    v_mfma_f32_16x16x32_bf16 v[124:127], v[220:223], v[196:199], v[124:127]
    v_mfma_f32_16x16x32_bf16 v[128:131], v[224:227], v[196:199], v[128:131]
    v_mfma_f32_16x16x32_bf16 v[132:135], v[228:231], v[196:199], v[132:135]
    v_mfma_f32_16x16x32_bf16 v[136:139], v[232:235], v[196:199], v[136:139]
    v_mfma_f32_16x16x32_bf16 v[152:155], v[232:235], v[200:203], v[152:155]
    v_mfma_f32_16x16x32_bf16 v[148:151], v[228:231], v[200:203], v[148:151]
    v_mfma_f32_16x16x32_bf16 v[144:147], v[224:227], v[200:203], v[144:147]
    v_mfma_f32_16x16x32_bf16 v[140:143], v[220:223], v[200:203], v[140:143]
    s_cbranch_scc1 K_CLOOP
    s_waitcnt lgkmcnt(0)
    v_mfma_f32_16x16x32_bf16 v[60:63], v[204:207], v[156:159], v[60:63]
    ds_read_b128 v[180:183], v45 offset:40960
    ds_read_b64_tr_b16 v[220:221], v48 offset:49152
    v_mfma_f32_16x16x32_bf16 v[64:67], v[208:211], v[156:159], v[64:67]
    ds_read_b64_tr_b16 v[222:223], v48 offset:50176
    ds_read_b64_tr_b16 v[224:225], v49 offset:49152
    v_mfma_f32_16x16x32_bf16 v[68:71], v[212:215], v[156:159], v[68:71]
    ds_read_b64_tr_b16 v[226:227], v49 offset:50176
    ds_read_b64_tr_b16 v[228:229], v50 offset:49152
    v_mfma_f32_16x16x32_bf16 v[72:75], v[216:219], v[156:159], v[72:75]
    ds_read_b64_tr_b16 v[230:231], v50 offset:50176
    ds_read_b64_tr_b16 v[232:233], v51 offset:49152
    v_mfma_f32_16x16x32_bf16 v[76:79], v[204:207], v[160:163], v[76:79]
    ds_read_b64_tr_b16 v[234:235], v51 offset:50176
    ds_read_b128 v[184:187], v45 offset:43008
    v_mfma_f32_16x16x32_bf16 v[80:83], v[208:211], v[160:163], v[80:83]
    ds_read_b128 v[188:191], v45 offset:45056
    ds_read_b128 v[192:195], v45 offset:47104
    v_mfma_f32_16x16x32_bf16 v[84:87], v[212:215], v[160:163], v[84:87]
    ds_read_b128 v[196:199], v45 offset:49152
    ds_read_b128 v[200:203], v45 offset:51200
    v_mfma_f32_16x16x32_bf16 v[88:91], v[216:219], v[160:163], v[88:91]
    s_waitcnt lgkmcnt(11)
    v_mfma_f32_16x16x32_bf16 v[60:63], v[220:223], v[180:183], v[60:63]
    s_nop 1
    s_waitcnt lgkmcnt(9)
    v_mfma_f32_16x16x32_bf16 v[64:67], v[224:227], v[180:183], v[64:67]
    s_nop 1
    s_waitcnt lgkmcnt(7)
    v_mfma_f32_16x16x32_bf16 v[68:71], v[228:231], v[180:183], v[68:71]
    v_cvt_pk_bf16_f32 v60, v60, v61
    v_cvt_pk_bf16_f32 v61, v62, v63
    s_waitcnt lgkmcnt(5)
    v_mfma_f32_16x16x32_bf16 v[72:75], v[232:235], v[180:183], v[72:75]
    ds_write_b64 v56, v[60:61] offset:0
    s_waitcnt lgkmcnt(5)
    v_mfma_f32_16x16x32_bf16 v[76:79], v[220:223], v[184:187], v[76:79]
    v_cvt_pk_bf16_f32 v64, v64, v65
    v_cvt_pk_bf16_f32 v65, v66, v67
    v_mfma_f32_16x16x32_bf16 v[80:83], v[224:227], v[184:187], v[80:83]
    ds_write_b64 v56, v[64:65] offset:32
    v_mfma_f32_16x16x32_bf16 v[84:87], v[228:231], v[184:187], v[84:87]
    v_cvt_pk_bf16_f32 v68, v68, v69
    v_cvt_pk_bf16_f32 v69, v70, v71
    v_mfma_f32_16x16x32_bf16 v[88:91], v[232:235], v[184:187], v[88:91]
    ds_write_b64 v56, v[68:69] offset:64
    v_mfma_f32_16x16x32_bf16 v[92:95], v[204:207], v[164:167], v[92:95]
    v_cvt_pk_bf16_f32 v72, v72, v73
    v_cvt_pk_bf16_f32 v73, v74, v75
    v_mfma_f32_16x16x32_bf16 v[96:99], v[208:211], v[164:167], v[96:99]
    ds_write_b64 v56, v[72:73] offset:96
    v_mfma_f32_16x16x32_bf16 v[100:103], v[212:215], v[164:167], v[100:103]
    v_cvt_pk_bf16_f32 v76, v76, v77
    v_cvt_pk_bf16_f32 v77, v78, v79
    v_mfma_f32_16x16x32_bf16 v[104:107], v[216:219], v[164:167], v[104:107]
    ds_write_b64 v56, v[76:77] offset:4352
    s_waitcnt lgkmcnt(8)
    v_mfma_f32_16x16x32_bf16 v[92:95], v[220:223], v[188:191], v[92:95]
    v_cvt_pk_bf16_f32 v80, v80, v81
    v_cvt_pk_bf16_f32 v81, v82, v83
    v_mfma_f32_16x16x32_bf16 v[96:99], v[224:227], v[188:191], v[96:99]
    ds_write_b64 v56, v[80:81] offset:4384
    v_mfma_f32_16x16x32_bf16 v[100:103], v[228:231], v[188:191], v[100:103]
    v_cvt_pk_bf16_f32 v84, v84, v85
    v_cvt_pk_bf16_f32 v85, v86, v87
    v_mfma_f32_16x16x32_bf16 v[104:107], v[232:235], v[188:191], v[104:107]
    ds_write_b64 v56, v[84:85] offset:4416
    v_mfma_f32_16x16x32_bf16 v[108:111], v[204:207], v[168:171], v[108:111]
    v_cvt_pk_bf16_f32 v88, v88, v89
    v_cvt_pk_bf16_f32 v89, v90, v91
    v_mfma_f32_16x16x32_bf16 v[112:115], v[208:211], v[168:171], v[112:115]
    ds_write_b64 v56, v[88:89] offset:4448
    v_mfma_f32_16x16x32_bf16 v[116:119], v[212:215], v[168:171], v[116:119]
    v_cvt_pk_bf16_f32 v92, v92, v93
    v_cvt_pk_bf16_f32 v93, v94, v95
    v_mfma_f32_16x16x32_bf16 v[120:123], v[216:219], v[168:171], v[120:123]
    ds_write_b64 v56, v[92:93] offset:8704
    s_waitcnt lgkmcnt(11)
    v_mfma_f32_16x16x32_bf16 v[108:111], v[220:223], v[192:195], v[108:111]
    v_cvt_pk_bf16_f32 v96, v96, v97
    v_cvt_pk_bf16_f32 v97, v98, v99
    v_mfma_f32_16x16x32_bf16 v[112:115], v[224:227], v[192:195], v[112:115]
    ds_write_b64 v56, v[96:97] offset:8736
    v_mfma_f32_16x16x32_bf16 v[116:119], v[228:231], v[192:195], v[116:119]
    v_cvt_pk_bf16_f32 v100, v100, v101
    v_cvt_pk_bf16_f32 v101, v102, v103
    v_mfma_f32_16x16x32_bf16 v[120:123], v[232:235], v[192:195], v[120:123]
    ds_write_b64 v56, v[100:101] offset:8768
    v_mfma_f32_16x16x32_bf16 v[124:127], v[204:207], v[172:175], v[124:127]
    v_cvt_pk_bf16_f32 v104, v104, v105
    v_cvt_pk_bf16_f32 v105, v106, v107
    v_mfma_f32_16x16x32_bf16 v[128:131], v[208:211], v[172:175], v[128:131]
    ds_write_b64 v56, v[104:105] offset:8800
    v_mfma_f32_16x16x32_bf16 v[132:135], v[212:215], v[172:175], v[132:135]
    v_cvt_pk_bf16_f32 v108, v108, v109
    v_cvt_pk_bf16_f32 v109, v110, v111
    v_mfma_f32_16x16x32_bf16 v[136:139], v[216:219], v[172:175], v[136:139]
    ds_write_b64 v56, v[108:109] offset:13056
    s_waitcnt lgkmcnt(14)
    v_mfma_f32_16x16x32_bf16 v[124:127], v[220:223], v[196:199], v[124:127]
    v_cvt_pk_bf16_f32 v112, v112, v113
    v_cvt_pk_bf16_f32 v113, v114, v115
    v_mfma_f32_16x16x32_bf16 v[128:131], v[224:227], v[196:199], v[128:131]
    ds_write_b64 v56, v[112:113] offset:13088
    v_mfma_f32_16x16x32_bf16 v[132:135], v[228:231], v[196:199], v[132:135]
    v_cvt_pk_bf16_f32 v116, v116, v117
    v_cvt_pk_bf16_f32 v117, v118, v119
    v_mfma_f32_16x16x32_bf16 v[136:139], v[232:235], v[196:199], v[136:139]
    ds_write_b64 v56, v[116:117] offset:13120
    v_mfma_f32_16x16x32_bf16 v[140:143], v[204:207], v[176:179], v[140:143]
    v_cvt_pk_bf16_f32 v120, v120, v121
    v_cvt_pk_bf16_f32 v121, v122, v123
    v_mfma_f32_16x16x32_bf16 v[144:147], v[208:211], v[176:179], v[144:147]
    ds_write_b64 v56, v[120:121] offset:13152
    v_mfma_f32_16x16x32_bf16 v[148:151], v[212:215], v[176:179], v[148:151]
    v_cvt_pk_bf16_f32 v124, v124, v125
    v_cvt_pk_bf16_f32 v125, v126, v127
    v_mfma_f32_16x16x32_bf16 v[152:155], v[216:219], v[176:179], v[152:155]
    ds_write_b64 v56, v[124:125] offset:17408
    s_waitcnt lgkmcnt(15)
    v_mfma_f32_16x16x32_bf16 v[140:143], v[220:223], v[200:203], v[140:143]
    v_cvt_pk_bf16_f32 v128, v128, v129
    v_cvt_pk_bf16_f32 v129, v130, v131
    v_mfma_f32_16x16x32_bf16 v[144:147], v[224:227], v[200:203], v[144:147]
    ds_write_b64 v56, v[128:129] offset:17440
    v_mfma_f32_16x16x32_bf16 v[148:151], v[228:231], v[200:203], v[148:151]
    v_cvt_pk_bf16_f32 v132, v132, v133
    v_cvt_pk_bf16_f32 v133, v134, v135
    v_mfma_f32_16x16x32_bf16 v[152:155], v[232:235], v[200:203], v[152:155]
    ds_write_b64 v56, v[132:133] offset:17472
    v_cvt_pk_bf16_f32 v136, v136, v137
    v_cvt_pk_bf16_f32 v137, v138, v139
    v_cvt_pk_bf16_f32 v140, v140, v141
    v_cvt_pk_bf16_f32 v141, v142, v143
    v_cvt_pk_bf16_f32 v144, v144, v145
    v_cvt_pk_bf16_f32 v145, v146, v147
    v_cvt_pk_bf16_f32 v148, v148, v149
    v_cvt_pk_bf16_f32 v149, v150, v151
    v_cvt_pk_bf16_f32 v152, v152, v153
    v_cvt_pk_bf16_f32 v153, v154, v155
    ds_write_b64 v56, v[136:137] offset:17504
    ds_write_b64 v56, v[140:141] offset:21760
    ds_write_b64 v56, v[144:145] offset:21792
    ds_write_b64 v56, v[148:149] offset:21824
    ds_write_b64 v56, v[152:153] offset:21856
    s_setprio 0
    s_branch WS_attd
.p2align 12
WP_attd:
    s_setpc_b64 s[38:39]
WS_attd:
    s_waitcnt lgkmcnt(0)
    s_barrier
    ds_read_b64 v[60:61], v13 offset:80
    ds_read_b64 v[62:63], v14 offset:80
    ds_read_b64 v[44:45], v13 offset:4352
    ds_read_b64 v[46:47], v19 offset:4352
    ds_read_b64 v[64:65], v13 offset:4432
    ds_read_b64 v[66:67], v14 offset:4432
    ds_read_b64 v[72:73], v13 offset:120
    ds_read_b64 v[74:75], v14 offset:120
    ds_read_b64 v[48:49], v13 offset:4392
    ds_read_b64 v[50:51], v20 offset:4352
    ds_read_b64 v[76:77], v13 offset:4472
    ds_read_b64 v[78:79], v14 offset:4472
    ds_read_b64 v[52:53], v13 offset:8704
    ds_read_b64 v[54:55], v19 offset:8704
    ds_read_b64 v[68:69], v13 offset:8784
    ds_read_b64 v[70:71], v14 offset:8784
    s_waitcnt lgkmcnt(10)
    v_mfma_f32_16x16x32_bf16 v[116:119], v[60:63], v[44:47], v[36:39]
    v_mfma_f32_16x16x32_bf16 v[120:123], v[64:67], v[44:47], v[32:35]
    ds_read_b64 v[56:57], v13 offset:8744
    ds_read_b64 v[58:59], v20 offset:8704
    ds_read_b64 v[80:81], v13 offset:8824
    ds_read_b64 v[82:83], v14 offset:8824
    s_waitcnt lgkmcnt(8)
    v_mfma_f32_16x16x32_bf16 v[124:127], v[72:75], v[48:51], v[36:39]
    v_mfma_f32_16x16x32_bf16 v[128:131], v[76:79], v[48:51], v[32:35]
    s_waitcnt lgkmcnt(4)
    v_mfma_f32_16x16x32_bf16 v[132:135], v[64:67], v[52:55], v[28:31]
    v_mfma_f32_16x16x32_bf16 v[136:139], v[68:71], v[52:55], v[32:35]
    s_waitcnt lgkmcnt(0)
    v_mfma_f32_16x16x32_bf16 v[140:143], v[76:79], v[56:59], v[28:31]
    v_mfma_f32_16x16x32_bf16 v[144:147], v[80:83], v[56:59], v[32:35]
    ds_read_b64_tr_b16 v[84:85], v15 offset:160
    ds_read_b64_tr_b16 v[86:87], v15 offset:4512
    ds_read_b64_tr_b16 v[100:101], v21 offset:0
    ds_read_b64_tr_b16 v[102:103], v21 offset:4352
    v_max3_f32 v184, v116, v117, v120
    ds_read_b64_tr_b16 v[92:93], v15 offset:200
    v_max3_f32 v185, v118, v119, v122
    ds_read_b64_tr_b16 v[94:95], v15 offset:4552
    v_max_f32 v184, v184, v121
    ds_read_b64_tr_b16 v[104:105], v22 offset:0
    v_max_f32 v185, v185, v123
    ds_read_b64_tr_b16 v[106:107], v22 offset:4352
    v_max3_f32 v186, v124, v125, v128
    ds_read_b64_tr_b16 v[88:89], v15 offset:8864
    v_max3_f32 v187, v126, v127, v130
    ds_read_b64_tr_b16 v[108:109], v23 offset:4352
    v_max_f32 v186, v186, v129
    ds_read_b64_tr_b16 v[110:111], v23 offset:8704
    v_max_f32 v187, v187, v131
    ds_read_b64_tr_b16 v[96:97], v15 offset:8904
    v_max3_f32 v188, v132, v133, v136
    ds_read_b64_tr_b16 v[112:113], v24 offset:4352
    v_max3_f32 v189, v134, v135, v138
    ds_read_b64_tr_b16 v[114:115], v24 offset:8704
    v_max_f32 v188, v188, v137
    v_max_f32 v189, v189, v139
    v_max3_f32 v190, v140, v141, v144
    v_max3_f32 v191, v142, v143, v146
    v_max_f32 v190, v190, v145
    v_max_f32 v191, v191, v147
    v_cvt_pk_bf16_f32 v192, v184, v185
    v_cvt_pk_bf16_f32 v193, v186, v187
    v_cvt_pk_bf16_f32 v194, v188, v189
    v_cvt_pk_bf16_f32 v195, v190, v191
    v_lshlrev_b32 v184, 16, v192
    v_and_b32 v185, 0xffff0000, v192
    v_lshlrev_b32 v186, 16, v193
    v_and_b32 v187, 0xffff0000, v193
    v_lshlrev_b32 v188, 16, v194
    v_and_b32 v189, 0xffff0000, v194
    v_lshlrev_b32 v190, 16, v195
    v_and_b32 v191, 0xffff0000, v195
    v_pk_mul_f32 v[184:185], v[184:185], s[48:49]
    v_pk_mul_f32 v[186:187], v[186:187], s[48:49]
    v_pk_mul_f32 v[188:189], v[188:189], s[48:49]
    v_pk_mul_f32 v[190:191], v[190:191], s[48:49]
    v_cvt_pk_bf16_f32 v192, v184, v185
    v_cvt_pk_bf16_f32 v193, v186, v187
    v_cvt_pk_bf16_f32 v194, v188, v189
    v_cvt_pk_bf16_f32 v195, v190, v191
    v_permlane16_swap_b32 v192, v193
    s_nop 0
    v_permlane16_swap_b32 v194, v195
    s_nop 1
    v_permlane32_swap_b32 v192, v194
    v_permlane32_swap_b32 v193, v195
    v_lshlrev_b32 v184, 16, v192
    v_and_b32 v185, 0xffff0000, v192
    v_lshlrev_b32 v188, 16, v194
    v_and_b32 v189, 0xffff0000, v194
    v_lshlrev_b32 v186, 16, v193
    v_and_b32 v187, 0xffff0000, v193
    v_lshlrev_b32 v190, 16, v195
    v_and_b32 v191, 0xffff0000, v195
    v_max3_f32 v196, v184, v185, v188
    v_max3_f32 v197, v189, v186, v187
    v_max3_f32 v196, v196, v190, v191
    v_max_f32 v196, v196, v197
    v_mul_f32 v196, s46, v196
    v_pk_fma_f32 v[184:185], v[184:185], s[46:47], v[196:197] op_sel_hi:[1,1,0] neg_lo:[0,0,1] neg_hi:[0,0,1]
    v_pk_fma_f32 v[186:187], v[186:187], s[46:47], v[196:197] op_sel_hi:[1,1,0] neg_lo:[0,0,1] neg_hi:[0,0,1]
    v_pk_fma_f32 v[188:189], v[188:189], s[46:47], v[196:197] op_sel_hi:[1,1,0] neg_lo:[0,0,1] neg_hi:[0,0,1]
    v_pk_fma_f32 v[190:191], v[190:191], s[46:47], v[196:197] op_sel_hi:[1,1,0] neg_lo:[0,0,1] neg_hi:[0,0,1]
    v_exp_f32 v184, v184
    v_exp_f32 v185, v185
    v_exp_f32 v186, v186
    v_exp_f32 v187, v187
    v_exp_f32 v188, v188
    v_exp_f32 v189, v189
    v_exp_f32 v190, v190
    v_exp_f32 v191, v191
    v_pk_add_f32 v[200:201], v[184:185], v[186:187]
    v_pk_add_f32 v[202:203], v[188:189], v[190:191]
    v_pk_add_f32 v[200:201], v[200:201], v[202:203]
    v_add_f32 v200, v200, v201
    v_rcp_f32 v200, v200
    s_waitcnt lgkmcnt(0)
    v_pk_mul_f32 v[184:185], v[184:185], v[200:201] op_sel_hi:[1,0]
    v_pk_mul_f32 v[186:187], v[186:187], v[200:201] op_sel_hi:[1,0]
    v_pk_mul_f32 v[188:189], v[188:189], v[200:201] op_sel_hi:[1,0]
    v_pk_mul_f32 v[190:191], v[190:191], v[200:201] op_sel_hi:[1,0]
    v_cvt_pk_bf16_f32 v192, v184, v185
    v_cvt_pk_bf16_f32 v194, v188, v189
    v_cvt_pk_bf16_f32 v193, v186, v187
    v_cvt_pk_bf16_f32 v195, v190, v191
    v_permlane32_swap_b32 v192, v194
    s_nop 0
    v_permlane32_swap_b32 v193, v195
    s_nop 1
    v_permlane16_swap_b32 v192, v193
    v_permlane16_swap_b32 v194, v195
    v_perm_b32 v148, v192, v192, v40
    v_perm_b32 v149, v192, v192, v41
    v_perm_b32 v150, v192, v192, v42
    v_perm_b32 v151, v192, v192, v43
    v_perm_b32 v152, v193, v193, v40
    v_perm_b32 v153, v193, v193, v41
    v_perm_b32 v154, v193, v193, v42
    v_perm_b32 v155, v193, v193, v43
    v_mfma_f32_16x16x32_bf16 v[164:167], v[84:87], v[148:151], 0
    v_mfma_f32_16x16x32_bf16 v[180:183], v[100:103], v[148:151], 0
    v_perm_b32 v156, v194, v194, v40
    v_perm_b32 v157, v194, v194, v41
    v_perm_b32 v158, v194, v194, v42
    v_perm_b32 v159, v194, v194, v43
    v_mfma_f32_16x16x32_bf16 v[168:171], v[92:95], v[152:155], 0
    v_mfma_f32_16x16x32_bf16 v[180:183], v[104:107], v[152:155], v[180:183]
    v_perm_b32 v160, v195, v195, v40
    v_perm_b32 v161, v195, v195, v41
    v_perm_b32 v162, v195, v195, v42
    v_perm_b32 v163, v195, v195, v43
    v_mfma_f32_16x16x32_bf16 v[172:175], v[86:89], v[156:159], 0
    v_mfma_f32_16x16x32_bf16 v[180:183], v[108:111], v[156:159], v[180:183]
    v_mfma_f32_16x16x32_bf16 v[176:179], v[94:97], v[160:163], 0
    v_mfma_f32_16x16x32_bf16 v[180:183], v[112:115], v[160:163], v[180:183]
    v_cvt_pk_bf16_f32 v204, v164, v165
    v_cvt_pk_bf16_f32 v205, v166, v167
    v_cvt_pk_bf16_f32 v206, v168, v169
    v_cvt_pk_bf16_f32 v207, v170, v171
    buffer_store_dwordx4 v[204:207], v16, s[20:23], s50 offen sc1
    v_cvt_pk_bf16_f32 v208, v172, v173
    v_cvt_pk_bf16_f32 v209, v174, v175
    v_cvt_pk_bf16_f32 v210, v176, v177
    v_cvt_pk_bf16_f32 v211, v178, v179
    buffer_store_dwordx4 v[208:211], v16, s[20:23], s51 offen sc1
    v_cvt_pk_bf16_f32 v196, v180, v181
    v_cvt_pk_bf16_f32 v197, v182, v183
    buffer_store_dwordx2 v[196:197], v17, s[20:23], s50 offen sc1
    s_cmp_lg_u32 s34, -1
    s_cbranch_scc1 K_P2_EARLY
K_DRAIN:
    s_waitcnt vmcnt(0)
    s_barrier
    s_branch K_END
K_W7:
    s_waitcnt vmcnt(26)
    v_and_b32 v4, 7, v1
    v_lshlrev_b32 v4, 2, v4
    s_mov_b32 s3, 131072
K_ZPOLL5:
    v_cmp_eq_u32 vcc, 0, v7
    s_cbranch_vccz K_ZOK5
    s_sub_u32 s3, s3, 1
    s_cbranch_scc1 K_ZOK5
    global_load_dword v7, v4, s[8:9] offset:192 sc1
    s_waitcnt vmcnt(0)
    s_branch K_ZPOLL5
K_ZOK5:
    v_mov_b32 v4, 158720
    v_mov_b32 v3, 1
    s_mov_b64 exec, 1
    s_nop 0
    ds_add_rtn_u32 v2, v4, v3 offset:48
    s_mov_b32 exec_lo, s36
    v_mov_b32 v3, 1
    s_waitcnt lgkmcnt(0)
    v_readfirstlane_b32 s33, v2
    s_nop 3
    s_and_b32 s33, s33, 0xff
    s_cmp_lg_u32 s33, 7
    s_cbranch_scc1 K_ARR7
    global_store_dword v8, v3, s[10:11] sc1
K_ARR7:
    s_mov_b64 exec, -1
    v_mov_b32 v3, 0x100
    s_mov_b64 exec, 1
    s_waitcnt vmcnt(0)
    ds_add_u32 v4, v3 offset:48
    s_mov_b64 exec, -1
    s_branch K_P2_HELP
K_FLAG:
    s_waitcnt vmcnt(0)
    v_and_b32 v4, 7, v1
    v_lshlrev_b32 v4, 2, v4
    s_mov_b32 s3, 131072
K_ZPOLL0:
    v_cmp_eq_u32 vcc, 0, v7
    s_cbranch_vccz K_ZOK0
    s_sub_u32 s3, s3, 1
    s_cbranch_scc1 K_ZOK0
    global_load_dword v7, v4, s[8:9] offset:192 sc1
    s_waitcnt vmcnt(0)
    s_branch K_ZPOLL0
K_ZOK0:
    v_mov_b32 v3, 1
    s_mov_b32 exec_lo, s36
    s_mov_b32 exec_hi, 0
    s_setprio 3
    s_barrier
    global_store_dword v8, v3, s[10:11] sc1
    s_mov_b64 exec, -1
    s_branch K_END
WP_atts:
    s_setpc_b64 s[38:39]
K_JOIN_S:
    s_setprio 0
    s_barrier
    s_cmp_eq_u32 s30, 7
    s_cbranch_scc1 K_FLAG
    ds_read_b64 v[52:53], v13 offset:80
    ds_read_b64 v[54:55], v14 offset:80
    ds_read_b64 v[44:45], v13 offset:4352
    ds_read_b64 v[46:47], v19 offset:4352
    ds_read_b64 v[56:57], v13 offset:4432
    ds_read_b64 v[58:59], v14 offset:4432
    ds_read_b64 v[60:61], v13 offset:120
    ds_read_b64 v[62:63], v14 offset:120
    ds_read_b64 v[48:49], v13 offset:4392
    ds_read_b64 v[50:51], v20 offset:4352
    ds_read_b64 v[64:65], v13 offset:4472
    ds_read_b64 v[66:67], v14 offset:4472
    s_waitcnt lgkmcnt(6)
    v_mfma_f32_16x16x32_bf16 v[84:87], v[52:55], v[44:47], v[36:39]
    v_mfma_f32_16x16x32_bf16 v[88:91], v[56:59], v[44:47], v[32:35]
    s_waitcnt lgkmcnt(0)
    v_mfma_f32_16x16x32_bf16 v[92:95], v[60:63], v[48:51], v[36:39]
    v_mfma_f32_16x16x32_bf16 v[96:99], v[64:67], v[48:51], v[32:35]
    ds_read_b64_tr_b16 v[68:69], v15 offset:160
    ds_read_b64_tr_b16 v[70:71], v15 offset:4512
    ds_read_b64_tr_b16 v[76:77], v21 offset:0
    ds_read_b64_tr_b16 v[78:79], v21 offset:4352
    ds_read_b64_tr_b16 v[72:73], v15 offset:200
    ds_read_b64_tr_b16 v[74:75], v15 offset:4552
    ds_read_b64_tr_b16 v[80:81], v22 offset:0
    ds_read_b64_tr_b16 v[82:83], v22 offset:4352
    v_max3_f32 v120, v84, v85, v88
    v_max3_f32 v121, v86, v87, v90
    v_max_f32 v120, v120, v89
    v_max_f32 v121, v121, v91
    v_max3_f32 v122, v92, v93, v96
    v_max3_f32 v123, v94, v95, v98
    v_max_f32 v122, v122, v97
    v_max_f32 v123, v123, v99
    v_cvt_pk_bf16_f32 v124, v120, v121
    v_cvt_pk_bf16_f32 v125, v122, v123
    v_lshlrev_b32 v120, 16, v124
    v_and_b32 v121, 0xffff0000, v124
    v_lshlrev_b32 v122, 16, v125
    v_and_b32 v123, 0xffff0000, v125
    v_pk_mul_f32 v[120:121], v[120:121], s[48:49]
    v_pk_mul_f32 v[122:123], v[122:123], s[48:49]
    v_cvt_pk_bf16_f32 v124, v120, v121
    v_cvt_pk_bf16_f32 v125, v122, v123
    s_nop 1
    v_permlane16_swap_b32 v124, v125
    v_lshlrev_b32 v120, 16, v124
    v_and_b32 v121, 0xffff0000, v124
    v_lshlrev_b32 v122, 16, v125
    v_and_b32 v123, 0xffff0000, v125
    v_max3_f32 v126, v120, v121, v122
    v_max_f32 v126, v126, v123
    v_mov_b32 v127, v126
    s_nop 1
    v_permlane32_swap_b32 v126, v127
    v_max_f32 v126, v126, v127
    v_mul_f32 v126, s46, v126
    v_pk_fma_f32 v[120:121], v[120:121], s[46:47], v[126:127] op_sel_hi:[1,1,0] neg_lo:[0,0,1] neg_hi:[0,0,1]
    v_pk_fma_f32 v[122:123], v[122:123], s[46:47], v[126:127] op_sel_hi:[1,1,0] neg_lo:[0,0,1] neg_hi:[0,0,1]
    v_exp_f32 v120, v120
    v_exp_f32 v121, v121
    v_exp_f32 v122, v122
    v_exp_f32 v123, v123
    s_nop 0
    v_pk_add_f32 v[128:129], v[120:121], v[122:123]
    v_add_f32 v128, v128, v129
    v_mov_b32 v129, v128
    s_nop 1
    v_permlane32_swap_b32 v128, v129
    v_add_f32 v128, v128, v129
    v_rcp_f32 v128, v128
    s_waitcnt lgkmcnt(0)
    v_pk_mul_f32 v[120:121], v[120:121], v[128:129] op_sel_hi:[1,0]
    v_pk_mul_f32 v[122:123], v[122:123], v[128:129] op_sel_hi:[1,0]
    v_cvt_pk_bf16_f32 v124, v120, v121
    v_cvt_pk_bf16_f32 v125, v122, v123
    s_nop 1
    v_permlane16_swap_b32 v124, v125
    v_perm_b32 v100, v124, v124, v40
    v_perm_b32 v101, v124, v124, v41
    v_perm_b32 v102, v124, v124, v42
    v_perm_b32 v103, v124, v124, v43
    v_perm_b32 v104, v125, v125, v40
    v_perm_b32 v105, v125, v125, v41
    v_perm_b32 v106, v125, v125, v42
    v_perm_b32 v107, v125, v125, v43
    v_mfma_f32_16x16x32_bf16 v[108:111], v[68:71], v[100:103], 0
    v_mfma_f32_16x16x32_bf16 v[116:119], v[76:79], v[100:103], 0
    v_mfma_f32_16x16x32_bf16 v[112:115], v[72:75], v[104:107], 0
    v_mfma_f32_16x16x32_bf16 v[116:119], v[80:83], v[104:107], v[116:119]
    s_nop 4
    v_cvt_pk_bf16_f32 v132, v108, v109
    v_cvt_pk_bf16_f32 v133, v110, v111
    v_cvt_pk_bf16_f32 v134, v112, v113
    v_cvt_pk_bf16_f32 v135, v114, v115
    buffer_store_dwordx4 v[132:135], v16, s[20:23], s50 offen sc1
    v_cvt_pk_bf16_f32 v126, v116, v117
    v_cvt_pk_bf16_f32 v127, v118, v119
    buffer_store_dwordx2 v[126:127], v17, s[20:23], s50 offen sc1
    s_cmp_eq_u32 s34, -1
    s_cbranch_scc1 K_DRAIN
    s_cmp_lg_u32 s30, 6
    s_cbranch_scc1 K_NOFL
    s_waitcnt vmcnt(12)
    v_and_b32 v4, 7, v1
    v_lshlrev_b32 v4, 2, v4
    s_mov_b32 s3, 131072
K_ZPOLL2:
    v_cmp_eq_u32 vcc, 0, v7
    s_cbranch_vccz K_ZOK2
    s_sub_u32 s3, s3, 1
    s_cbranch_scc1 K_ZOK2
    global_load_dword v7, v4, s[8:9] offset:192 sc1
    s_waitcnt vmcnt(0)
    s_branch K_ZPOLL2
K_ZOK2:
    v_and_b32 v2, 1, v1
    v_lshl_add_u32 v2, v2, 2, s42
    global_load_dword v7, v2, s[10:11] offset:128 sc1
K_NOFL:
    v_mov_b32 v4, 158720
    v_mov_b32 v3, 257
    s_mov_b64 exec, 1
    s_waitcnt vmcnt(0)
    ds_add_rtn_u32 v2, v4, v3 offset:48
    s_mov_b32 exec_lo, s36
    v_mov_b32 v3, 1
    s_waitcnt lgkmcnt(0)
    v_readfirstlane_b32 s33, v2
    s_nop 3
    s_and_b32 s33, s33, 0xff
    s_cmp_lg_u32 s33, 7
    s_cbranch_scc1 K_ARRS
    global_store_dword v8, v3, s[10:11] sc1
K_ARRS:
    s_mov_b64 exec, -1
    s_cmp_ge_u32 s30, 6
    s_cbranch_scc1 K_P2_HELP
    s_branch K_LATE
WP_early:
    s_setpc_b64 s[38:39]
K_P2_EARLY:
    s_lshl_b32 s54, s40, 7
    v_lshrrev_b32 v9, 4, v1
    v_mov_b32 v12, 158720
    s_add_u32 s20, s10, 0x100000
    s_addc_u32 s21, s11, 0
    s_mov_b32 s22, 0x280000
    s_mov_b32 s23, 0x20000
    s_add_u32 s16, s10, 0x1000
    s_addc_u32 s17, s11, 0
    s_mov_b32 s18, 0x2000
    s_mov_b32 s19, 0x20000
    s_mov_b32 s48, s6
    s_mov_b32 s49, s7
    s_mov_b32 s50, 0x280000
    s_mov_b32 s51, 0x20000
    s_lshl_b32 s53, s40, 3
    s_lshl1_add_u32 s53, s30, s53
    s_mov_b32 s55, 20480
    v_bfe_u32 v20, v1, 2, 2
    v_and_b32 v21, 3, v1
    s_mul_i32 s3, s53, 20480
    v_lshl_add_u32 v25, v1, 4, s3
    v_add_u32 v26, 20480, v25
    v_and_b32 v2, 15, v1
    s_lshl_b32 s3, s53, 6
    v_lshl_add_u32 v23, v2, 2, s3
    v_lshl_add_u32 v2, v9, 2, v20
    v_bfe_u32 v3, v2, 1, 2
    v_lshlrev_b32 v2, 7, v2
    v_lshl_add_u32 v2, v21, 3, v2
    v_lshl_add_u32 v24, v3, 5, v2
    v_lshrrev_b32 v3, 1, v20
    v_mul_u32_u24 v2, 40, v9
    v_add3_u32 v2, v2, 16, v20
    v_lshlrev_b32 v2, 7, v2
    v_lshl_add_u32 v2, v21, 3, v2
    v_xor_b32 v4, 0, v3
    v_lshl_add_u32 v56, v4, 5, v2
    v_xor_b32 v4, 1, v3
    v_lshl_add_u32 v57, v4, 5, v2
    v_xor_b32 v4, 2, v3
    v_lshl_add_u32 v58, v4, 5, v2
    v_xor_b32 v4, 3, v3
    v_lshl_add_u32 v59, v4, 5, v2
    v_lshrrev_b32 v3, 4, v1
    v_and_b32 v4, 7, v1
    v_lshrrev_b32 v2, 3, v1
    v_xor_b32 v4, v4, v3
    v_mul_u32_u24 v2, 1280, v2
    v_lshl_add_u32 v27, v4, 4, v2
    v_xor_b32 v28, 64, v27
    s_lshl_b32 s71, s40, 3
    s_lshl1_add_u32 s71, s30, s71
    s_mul_i32 s71, s71, 20480
    s_lshl_b32 s33, s41, 7
    s_add_u32 s71, s71, s33
    s_add_u32 s72, s71, 10240
    s_add_u32 s73, s71, 20480
    s_add_u32 s74, s71, 30720
    s_lshl_b32 s3, s30, 12
    s_add_u32 s3, s3, 140288
    v_lshl_add_u32 v33, v1, 4, s3
    v_and_b32 v2, 15, v1
    v_lshrrev_b32 v3, 1, v2
    v_lshrrev_b32 v4, 5, v1
    v_xor_b32 v3, v3, v4
    v_lshlrev_b32 v3, 4, v3
    v_lshl_add_u32 v3, v2, 7, v3
    v_and_b32 v4, 1, v9
    v_lshl_add_u32 v3, v4, 3, v3
    v_add_u32 v29, s3, v3
    v_xor_b32 v30, 32, v29
    v_xor_b32 v31, 64, v29
    v_xor_b32 v32, 96, v29
    s_lshl_b32 s3, s40, 3
    s_mul_i32 s33, s3, 187
    s_lshr_b32 s33, s33, 11
    s_add_u32 s33, s33, 1
    s_mul_i32 s33, s33, 11
    s_cmp_ge_u32 s53, s33
    s_cselect_b32 s64, 16, 0
    s_add_u32 s3, s53, 1
    s_cmp_ge_u32 s3, s33
    s_cselect_b32 s65, 16, 0
    s_mov_b32 s63, 0
    s_mov_b32 s66, 0
    s_mov_b32 s67, 16384
    v_mov_b32 v4, 158720
    v_mov_b32 v3, 1
    s_mov_b64 exec, 1
    s_waitcnt vmcnt(0)
    ds_add_rtn_u32 v2, v4, v3 offset:48
    s_mov_b32 exec_lo, s36
    v_mov_b32 v3, 1
    s_waitcnt lgkmcnt(0)
    v_readfirstlane_b32 s33, v2
    s_nop 3
    s_and_b32 s33, s33, 0xff
    s_cmp_lg_u32 s33, 7
    s_cbranch_scc1 K_ARRD
    global_store_dword v8, v3, s[10:11] sc1
K_ARRD:
    s_mov_b64 exec, -1
    s_mov_b32 s3, 1048576
K_P2_GE:
    ds_read_b32 v2, v12 offset:48
    s_sub_u32 s3, s3, 1
    s_waitcnt lgkmcnt(0)
    v_readfirstlane_b32 s33, v2
    s_nop 3
    s_cselect_b32 s33, 1024, s33
    s_cmp_lt_u32 s33, 1024
    s_cbranch_scc1 K_P2_GE
K_P2_GEMM:
    s_setprio 2
    s_mov_b32 s3, 1048576
K_P2_GS:
    ds_read_b32 v2, v12 offset:40
    s_sub_u32 s3, s3, 1
    s_waitcnt lgkmcnt(0)
    v_readfirstlane_b32 s33, v2
    s_nop 3
    s_cselect_b32 s33, 1, s33
    s_cmp_lt_u32 s33, 1
    s_cbranch_scc1 K_P2_GS
    buffer_load_dword v60, v23, s[16:19], 0 offen offset:0 sc1
    buffer_load_dword v62, v23, s[16:19], 0 offen offset:64 sc1
    ds_read_b128 v[16:19], v12
    ds_read_b64 v[36:37], v29 offset:0
    ds_read_b64 v[38:39], v30 offset:0
    ds_read_b64 v[40:41], v31 offset:0
    ds_read_b64 v[42:43], v32 offset:0
    ds_read_b64 v[44:45], v29 offset:2048
    ds_read_b64 v[46:47], v30 offset:2048
    ds_read_b64 v[48:49], v31 offset:2048
    ds_read_b64 v[50:51], v32 offset:2048
    s_waitcnt lgkmcnt(4)
    v_lshlrev_b32 v68, 16, v36
    v_and_b32 v69, 0xffff0000, v36
    v_lshlrev_b32 v70, 16, v37
    v_and_b32 v71, 0xffff0000, v37
    v_lshlrev_b32 v72, 16, v38
    v_and_b32 v73, 0xffff0000, v38
    v_lshlrev_b32 v74, 16, v39
    v_and_b32 v75, 0xffff0000, v39
    v_lshlrev_b32 v76, 16, v40
    v_and_b32 v77, 0xffff0000, v40
    v_lshlrev_b32 v78, 16, v41
    v_and_b32 v79, 0xffff0000, v41
    v_lshlrev_b32 v80, 16, v42
    v_and_b32 v81, 0xffff0000, v42
    v_lshlrev_b32 v82, 16, v43
    v_and_b32 v83, 0xffff0000, v43
    s_waitcnt lgkmcnt(0)
    v_lshlrev_b32 v84, 16, v44
    v_and_b32 v85, 0xffff0000, v44
    v_lshlrev_b32 v86, 16, v45
    v_and_b32 v87, 0xffff0000, v45
    v_lshlrev_b32 v88, 16, v46
    v_and_b32 v89, 0xffff0000, v46
    v_lshlrev_b32 v90, 16, v47
    v_and_b32 v91, 0xffff0000, v47
    v_lshlrev_b32 v92, 16, v48
    v_and_b32 v93, 0xffff0000, v48
    v_lshlrev_b32 v94, 16, v49
    v_and_b32 v95, 0xffff0000, v49
    v_lshlrev_b32 v96, 16, v50
    v_and_b32 v97, 0xffff0000, v50
    v_lshlrev_b32 v98, 16, v51
    v_and_b32 v99, 0xffff0000, v51
    s_cmp_eq_u32 s63, 0
    s_cbranch_scc1 K_SP0
K_SPR0:
    s_ff1_i32_b32 s33, s63
    s_bitset0_b32 s63, s33
    s_lshl_b32 s75, s33, 10
    buffer_load_dwordx4 v[100:103], v25, s[20:23], s75 offen offset:0 sc1
    buffer_load_dwordx4 v[104:107], v26, s[20:23], s75 offen offset:0 sc1
    v_mad_u32_u24 v52, s75, 5, v24
    v_xor_b32 v54, 64, v52
    v_xor_b32 v53, 32, v52
    v_xor_b32 v55, 96, v52
    ds_read_b64_tr_b16 v[180:181], v52 offset:0
    ds_read_b64_tr_b16 v[182:183], v54 offset:2560
    ds_read_b64_tr_b16 v[184:185], v53 offset:0
    ds_read_b64_tr_b16 v[186:187], v55 offset:2560
    ds_read_b64_tr_b16 v[188:189], v54 offset:0
    ds_read_b64_tr_b16 v[190:191], v52 offset:2560
    ds_read_b64_tr_b16 v[192:193], v55 offset:0
    ds_read_b64_tr_b16 v[194:195], v53 offset:2560
    s_cmp_eq_u32 s63, 0
    s_cbranch_scc1 K_SP1
K_SPR1:
    s_ff1_i32_b32 s33, s63
    s_bitset0_b32 s63, s33
    s_lshl_b32 s76, s33, 10
    buffer_load_dwordx4 v[108:111], v25, s[20:23], s76 offen offset:0 sc1
    buffer_load_dwordx4 v[112:115], v26, s[20:23], s76 offen offset:0 sc1
    v_mad_u32_u24 v52, s76, 5, v24
    v_xor_b32 v54, 64, v52
    v_xor_b32 v53, 32, v52
    v_xor_b32 v55, 96, v52
    ds_read_b64_tr_b16 v[196:197], v52 offset:0
    ds_read_b64_tr_b16 v[198:199], v54 offset:2560
    ds_read_b64_tr_b16 v[200:201], v53 offset:0
    ds_read_b64_tr_b16 v[202:203], v55 offset:2560
    ds_read_b64_tr_b16 v[204:205], v54 offset:0
    ds_read_b64_tr_b16 v[206:207], v52 offset:2560
    ds_read_b64_tr_b16 v[208:209], v55 offset:0
    ds_read_b64_tr_b16 v[210:211], v53 offset:2560
    s_waitcnt vmcnt(4)
    v_sub_f32 v64, 1.0, v60
    v_cvt_pk_bf16_f32 v64, v64, v64
    v_lshlrev_b32 v64, 16, v64
    v_sub_f32 v66, 1.0, v62
    v_cvt_pk_bf16_f32 v66, v66, v66
    v_lshlrev_b32 v66, 16, v66
    v_pk_mul_f32 v[68:69], v[68:69], v[64:65] op_sel_hi:[1,0]
    v_pk_mul_f32 v[70:71], v[70:71], v[64:65] op_sel_hi:[1,0]
    v_pk_mul_f32 v[72:73], v[72:73], v[64:65] op_sel_hi:[1,0]
    v_pk_mul_f32 v[74:75], v[74:75], v[64:65] op_sel_hi:[1,0]
    v_pk_mul_f32 v[76:77], v[76:77], v[64:65] op_sel_hi:[1,0]
    v_pk_mul_f32 v[78:79], v[78:79], v[64:65] op_sel_hi:[1,0]
    v_pk_mul_f32 v[80:81], v[80:81], v[64:65] op_sel_hi:[1,0]
    v_pk_mul_f32 v[82:83], v[82:83], v[64:65] op_sel_hi:[1,0]
    v_pk_mul_f32 v[84:85], v[84:85], v[66:67] op_sel_hi:[1,0]
    v_pk_mul_f32 v[86:87], v[86:87], v[66:67] op_sel_hi:[1,0]
    v_pk_mul_f32 v[88:89], v[88:89], v[66:67] op_sel_hi:[1,0]
    v_pk_mul_f32 v[90:91], v[90:91], v[66:67] op_sel_hi:[1,0]
    v_pk_mul_f32 v[92:93], v[92:93], v[66:67] op_sel_hi:[1,0]
    v_pk_mul_f32 v[94:95], v[94:95], v[66:67] op_sel_hi:[1,0]
    v_pk_mul_f32 v[96:97], v[96:97], v[66:67] op_sel_hi:[1,0]
    v_pk_mul_f32 v[98:99], v[98:99], v[66:67] op_sel_hi:[1,0]
    s_cmp_eq_u32 s63, 0
    s_cbranch_scc1 K_SP2
K_SPR2:
    s_ff1_i32_b32 s33, s63
    s_bitset0_b32 s63, s33
    s_lshl_b32 s77, s33, 10
    buffer_load_dwordx4 v[116:119], v25, s[20:23], s77 offen offset:0 sc1
    buffer_load_dwordx4 v[120:123], v26, s[20:23], s77 offen offset:0 sc1
    s_cmp_eq_u32 s63, 0
    s_cbranch_scc1 K_SP3
K_SPR3:
    s_ff1_i32_b32 s33, s63
    s_bitset0_b32 s63, s33
    s_lshl_b32 s78, s33, 10
    buffer_load_dwordx4 v[124:127], v25, s[20:23], s78 offen offset:0 sc1
    buffer_load_dwordx4 v[128:131], v26, s[20:23], s78 offen offset:0 sc1
    s_cmp_eq_u32 s63, 0
    s_cbranch_scc1 K_SP4
K_SPR4:
    s_ff1_i32_b32 s33, s63
    s_bitset0_b32 s63, s33
    s_lshl_b32 s75, s33, 10
    buffer_load_dwordx4 v[132:135], v25, s[20:23], s75 offen offset:0 sc1
    buffer_load_dwordx4 v[136:139], v26, s[20:23], s75 offen offset:0 sc1
    s_branch WS_p2g
.p2align 12
WP_p2g:
    s_setpc_b64 s[38:39]
WS_p2g:
    s_waitcnt vmcnt(8) lgkmcnt(8)
    v_mfma_f32_16x16x32_bf16 v[148:151], v[180:183], v[100:103], 0
    v_mad_u32_u24 v52, s77, 5, v24
    v_xor_b32 v54, 64, v52
    v_xor_b32 v53, 32, v52
    v_mfma_f32_16x16x32_bf16 v[164:167], v[180:183], v[104:107], 0
    v_xor_b32 v55, 96, v52
    ds_read_b64_tr_b16 v[212:213], v52 offset:0
    ds_read_b64_tr_b16 v[214:215], v54 offset:2560
    v_mfma_f32_16x16x32_bf16 v[152:155], v[184:187], v[100:103], 0
    ds_read_b64_tr_b16 v[216:217], v53 offset:0
    ds_read_b64_tr_b16 v[218:219], v55 offset:2560
    ds_read_b64_tr_b16 v[220:221], v54 offset:0
    v_mfma_f32_16x16x32_bf16 v[168:171], v[184:187], v[104:107], 0
    ds_read_b64_tr_b16 v[222:223], v52 offset:2560
    ds_read_b64_tr_b16 v[224:225], v55 offset:0
    v_mfma_f32_16x16x32_bf16 v[156:159], v[188:191], v[100:103], 0
    ds_read_b64_tr_b16 v[226:227], v53 offset:2560
    s_cmp_eq_u32 s63, 0
    v_mfma_f32_16x16x32_bf16 v[172:175], v[188:191], v[104:107], 0
    s_cbranch_scc1 K_SP5
K_SPR5:
    s_ff1_i32_b32 s33, s63
    v_mfma_f32_16x16x32_bf16 v[160:163], v[192:195], v[100:103], 0
    s_bitset0_b32 s63, s33
    s_lshl_b32 s76, s33, 10
    v_mfma_f32_16x16x32_bf16 v[176:179], v[192:195], v[104:107], 0
    buffer_load_dwordx4 v[140:143], v25, s[20:23], s76 offen offset:0 sc1
    buffer_load_dwordx4 v[144:147], v26, s[20:23], s76 offen offset:0 sc1
    s_waitcnt vmcnt(8) lgkmcnt(8)
    v_mfma_f32_16x16x32_bf16 v[148:151], v[196:199], v[108:111], v[148:151]
    v_mad_u32_u24 v52, s78, 5, v24
    v_xor_b32 v54, 64, v52
    v_xor_b32 v53, 32, v52
    v_mfma_f32_16x16x32_bf16 v[164:167], v[196:199], v[112:115], v[164:167]
    v_xor_b32 v55, 96, v52
    ds_read_b64_tr_b16 v[180:181], v52 offset:0
    ds_read_b64_tr_b16 v[182:183], v54 offset:2560
    v_mfma_f32_16x16x32_bf16 v[152:155], v[200:203], v[108:111], v[152:155]
    ds_read_b64_tr_b16 v[184:185], v53 offset:0
    ds_read_b64_tr_b16 v[186:187], v55 offset:2560
    ds_read_b64_tr_b16 v[188:189], v54 offset:0
    v_mfma_f32_16x16x32_bf16 v[168:171], v[200:203], v[112:115], v[168:171]
    ds_read_b64_tr_b16 v[190:191], v52 offset:2560
    ds_read_b64_tr_b16 v[192:193], v55 offset:0
    v_mfma_f32_16x16x32_bf16 v[156:159], v[204:207], v[108:111], v[156:159]
    ds_read_b64_tr_b16 v[194:195], v53 offset:2560
    s_cmp_eq_u32 s63, 0
    v_mfma_f32_16x16x32_bf16 v[172:175], v[204:207], v[112:115], v[172:175]
    s_cbranch_scc1 K_SP6
K_SPR6:
    s_ff1_i32_b32 s33, s63
    v_mfma_f32_16x16x32_bf16 v[160:163], v[208:211], v[108:111], v[160:163]
    s_bitset0_b32 s63, s33
    s_lshl_b32 s77, s33, 10
    v_mfma_f32_16x16x32_bf16 v[176:179], v[208:211], v[112:115], v[176:179]
    buffer_load_dwordx4 v[100:103], v25, s[20:23], s77 offen offset:0 sc1
    buffer_load_dwordx4 v[104:107], v26, s[20:23], s77 offen offset:0 sc1
    s_waitcnt vmcnt(8) lgkmcnt(8)
    v_mfma_f32_16x16x32_bf16 v[148:151], v[212:215], v[116:119], v[148:151]
    v_mad_u32_u24 v52, s75, 5, v24
    v_xor_b32 v54, 64, v52
    v_xor_b32 v53, 32, v52
    v_mfma_f32_16x16x32_bf16 v[164:167], v[212:215], v[120:123], v[164:167]
    v_xor_b32 v55, 96, v52
    ds_read_b64_tr_b16 v[196:197], v52 offset:0
    ds_read_b64_tr_b16 v[198:199], v54 offset:2560
    v_mfma_f32_16x16x32_bf16 v[152:155], v[216:219], v[116:119], v[152:155]
    ds_read_b64_tr_b16 v[200:201], v53 offset:0
    ds_read_b64_tr_b16 v[202:203], v55 offset:2560
    ds_read_b64_tr_b16 v[204:205], v54 offset:0
    v_mfma_f32_16x16x32_bf16 v[168:171], v[216:219], v[120:123], v[168:171]
    ds_read_b64_tr_b16 v[206:207], v52 offset:2560
    ds_read_b64_tr_b16 v[208:209], v55 offset:0
    v_mfma_f32_16x16x32_bf16 v[156:159], v[220:223], v[116:119], v[156:159]
    ds_read_b64_tr_b16 v[210:211], v53 offset:2560
    s_cmp_eq_u32 s63, 0
    v_mfma_f32_16x16x32_bf16 v[172:175], v[220:223], v[120:123], v[172:175]
    s_cbranch_scc1 K_SP7
K_SPR7:
    s_ff1_i32_b32 s33, s63
    v_mfma_f32_16x16x32_bf16 v[160:163], v[224:227], v[116:119], v[160:163]
    s_bitset0_b32 s63, s33
    s_lshl_b32 s78, s33, 10
    v_mfma_f32_16x16x32_bf16 v[176:179], v[224:227], v[120:123], v[176:179]
    buffer_load_dwordx4 v[108:111], v25, s[20:23], s78 offen offset:0 sc1
    buffer_load_dwordx4 v[112:115], v26, s[20:23], s78 offen offset:0 sc1
    s_waitcnt vmcnt(8) lgkmcnt(8)
    v_mfma_f32_16x16x32_bf16 v[148:151], v[180:183], v[124:127], v[148:151]
    v_mad_u32_u24 v52, s76, 5, v24
    v_xor_b32 v54, 64, v52
    v_mfma_f32_16x16x32_bf16 v[164:167], v[180:183], v[128:131], v[164:167]
    v_xor_b32 v53, 32, v52
    v_xor_b32 v55, 96, v52
    v_mfma_f32_16x16x32_bf16 v[152:155], v[184:187], v[124:127], v[152:155]
    ds_read_b64_tr_b16 v[212:213], v52 offset:0
    ds_read_b64_tr_b16 v[214:215], v54 offset:2560
    v_mfma_f32_16x16x32_bf16 v[168:171], v[184:187], v[128:131], v[168:171]
    ds_read_b64_tr_b16 v[216:217], v53 offset:0
    ds_read_b64_tr_b16 v[218:219], v55 offset:2560
    v_mfma_f32_16x16x32_bf16 v[156:159], v[188:191], v[124:127], v[156:159]
    ds_read_b64_tr_b16 v[220:221], v54 offset:0
    ds_read_b64_tr_b16 v[222:223], v52 offset:2560
    v_mfma_f32_16x16x32_bf16 v[172:175], v[188:191], v[128:131], v[172:175]
    ds_read_b64_tr_b16 v[224:225], v55 offset:0
    ds_read_b64_tr_b16 v[226:227], v53 offset:2560
    v_mfma_f32_16x16x32_bf16 v[160:163], v[192:195], v[124:127], v[160:163]
    buffer_load_dwordx4 v[116:119], v25, s[20:23], s67 offen offset:0 sc1
    buffer_load_dwordx4 v[120:123], v26, s[20:23], s67 offen offset:0 sc1
    v_mfma_f32_16x16x32_bf16 v[176:179], v[192:195], v[128:131], v[176:179]
    s_waitcnt vmcnt(8) lgkmcnt(8)
    v_mfma_f32_16x16x32_bf16 v[148:151], v[196:199], v[132:135], v[148:151]
    v_mad_u32_u24 v52, s77, 5, v24
    v_xor_b32 v54, 64, v52
    v_mfma_f32_16x16x32_bf16 v[164:167], v[196:199], v[136:139], v[164:167]
    v_xor_b32 v53, 32, v52
    v_xor_b32 v55, 96, v52
    v_mfma_f32_16x16x32_bf16 v[152:155], v[200:203], v[132:135], v[152:155]
    ds_read_b64_tr_b16 v[180:181], v52 offset:0
    ds_read_b64_tr_b16 v[182:183], v54 offset:2560
    v_mfma_f32_16x16x32_bf16 v[168:171], v[200:203], v[136:139], v[168:171]
    ds_read_b64_tr_b16 v[184:185], v53 offset:0
    ds_read_b64_tr_b16 v[186:187], v55 offset:2560
    v_mfma_f32_16x16x32_bf16 v[156:159], v[204:207], v[132:135], v[156:159]
    ds_read_b64_tr_b16 v[188:189], v54 offset:0
    ds_read_b64_tr_b16 v[190:191], v52 offset:2560
    v_mfma_f32_16x16x32_bf16 v[172:175], v[204:207], v[136:139], v[172:175]
    ds_read_b64_tr_b16 v[192:193], v55 offset:0
    ds_read_b64_tr_b16 v[194:195], v53 offset:2560
    v_mfma_f32_16x16x32_bf16 v[160:163], v[208:211], v[132:135], v[160:163]
    buffer_load_dwordx4 v[124:127], v25, s[20:23], s67 offen offset:1024 sc1
    buffer_load_dwordx4 v[128:131], v26, s[20:23], s67 offen offset:1024 sc1
    v_mfma_f32_16x16x32_bf16 v[176:179], v[208:211], v[136:139], v[176:179]
    s_waitcnt vmcnt(8) lgkmcnt(8)
    v_mfma_f32_16x16x32_bf16 v[148:151], v[212:215], v[140:143], v[148:151]
    v_mad_u32_u24 v52, s78, 5, v24
    v_xor_b32 v54, 64, v52
    v_xor_b32 v53, 32, v52
    v_mfma_f32_16x16x32_bf16 v[164:167], v[212:215], v[144:147], v[164:167]
    v_xor_b32 v55, 96, v52
    ds_read_b64_tr_b16 v[196:197], v52 offset:0
    ds_read_b64_tr_b16 v[198:199], v54 offset:2560
    v_mfma_f32_16x16x32_bf16 v[152:155], v[216:219], v[140:143], v[152:155]
    ds_read_b64_tr_b16 v[200:201], v53 offset:0
    ds_read_b64_tr_b16 v[202:203], v55 offset:2560
    ds_read_b64_tr_b16 v[204:205], v54 offset:0
    v_mfma_f32_16x16x32_bf16 v[168:171], v[216:219], v[144:147], v[168:171]
    ds_read_b64_tr_b16 v[206:207], v52 offset:2560
    ds_read_b64_tr_b16 v[208:209], v55 offset:0
    v_mfma_f32_16x16x32_bf16 v[156:159], v[220:223], v[140:143], v[156:159]
    ds_read_b64_tr_b16 v[210:211], v53 offset:2560
    s_cmp_eq_u32 s63, 0
    v_mfma_f32_16x16x32_bf16 v[172:175], v[220:223], v[144:147], v[172:175]
    s_cbranch_scc1 K_SP10
K_SPR10:
    s_ff1_i32_b32 s33, s63
    v_mfma_f32_16x16x32_bf16 v[160:163], v[224:227], v[140:143], v[160:163]
    s_bitset0_b32 s63, s33
    s_lshl_b32 s77, s33, 10
    v_mfma_f32_16x16x32_bf16 v[176:179], v[224:227], v[144:147], v[176:179]
    buffer_load_dwordx4 v[132:135], v25, s[20:23], s77 offen offset:0 sc1
    buffer_load_dwordx4 v[136:139], v26, s[20:23], s77 offen offset:0 sc1
    s_waitcnt vmcnt(8) lgkmcnt(8)
    v_mfma_f32_16x16x32_bf16 v[148:151], v[180:183], v[100:103], v[148:151]
    ds_read_b64_tr_b16 v[212:213], v56 offset:0
    ds_read_b64_tr_b16 v[214:215], v58 offset:2560
    v_mfma_f32_16x16x32_bf16 v[164:167], v[180:183], v[104:107], v[164:167]
    ds_read_b64_tr_b16 v[216:217], v57 offset:0
    ds_read_b64_tr_b16 v[218:219], v59 offset:2560
    v_mfma_f32_16x16x32_bf16 v[152:155], v[184:187], v[100:103], v[152:155]
    ds_read_b64_tr_b16 v[220:221], v58 offset:0
    ds_read_b64_tr_b16 v[222:223], v56 offset:2560
    v_mfma_f32_16x16x32_bf16 v[168:171], v[184:187], v[104:107], v[168:171]
    ds_read_b64_tr_b16 v[224:225], v59 offset:0
    ds_read_b64_tr_b16 v[226:227], v57 offset:2560
    v_mfma_f32_16x16x32_bf16 v[156:159], v[188:191], v[100:103], v[156:159]
    s_cmp_eq_u32 s63, 0
    s_cbranch_scc1 K_SP11
K_SPR11:
    v_mfma_f32_16x16x32_bf16 v[172:175], v[188:191], v[104:107], v[172:175]
    s_ff1_i32_b32 s33, s63
    s_bitset0_b32 s63, s33
    v_mfma_f32_16x16x32_bf16 v[160:163], v[192:195], v[100:103], v[160:163]
    s_lshl_b32 s78, s33, 10
    buffer_load_dwordx4 v[140:143], v25, s[20:23], s78 offen offset:0 sc1
    v_mfma_f32_16x16x32_bf16 v[176:179], v[192:195], v[104:107], v[176:179]
    buffer_load_dwordx4 v[144:147], v26, s[20:23], s78 offen offset:0 sc1
    s_waitcnt vmcnt(8) lgkmcnt(8)
    v_mfma_f32_16x16x32_bf16 v[148:151], v[196:199], v[108:111], v[148:151]
    ds_read_b64_tr_b16 v[180:181], v56 offset:20480
    ds_read_b64_tr_b16 v[182:183], v58 offset:23040
    v_mfma_f32_16x16x32_bf16 v[164:167], v[196:199], v[112:115], v[164:167]
    ds_read_b64_tr_b16 v[184:185], v57 offset:20480
    ds_read_b64_tr_b16 v[186:187], v59 offset:23040
    v_mfma_f32_16x16x32_bf16 v[152:155], v[200:203], v[108:111], v[152:155]
    ds_read_b64_tr_b16 v[188:189], v58 offset:20480
    ds_read_b64_tr_b16 v[190:191], v56 offset:23040
    v_mfma_f32_16x16x32_bf16 v[168:171], v[200:203], v[112:115], v[168:171]
    ds_read_b64_tr_b16 v[192:193], v59 offset:20480
    ds_read_b64_tr_b16 v[194:195], v57 offset:23040
    v_mfma_f32_16x16x32_bf16 v[156:159], v[204:207], v[108:111], v[156:159]
    s_cmp_eq_u32 s63, 0
    s_cbranch_scc1 K_SP12
K_SPR12:
    v_mfma_f32_16x16x32_bf16 v[172:175], v[204:207], v[112:115], v[172:175]
    s_ff1_i32_b32 s33, s63
    s_bitset0_b32 s63, s33
    v_mfma_f32_16x16x32_bf16 v[160:163], v[208:211], v[108:111], v[160:163]
    s_lshl_b32 s75, s33, 10
    buffer_load_dwordx4 v[100:103], v25, s[20:23], s75 offen offset:0 sc1
    v_mfma_f32_16x16x32_bf16 v[176:179], v[208:211], v[112:115], v[176:179]
    buffer_load_dwordx4 v[104:107], v26, s[20:23], s75 offen offset:0 sc1
    s_mov_b32 s3, 1048576
K_P2_GW:
    ds_read_b32 v2, v12 offset:44
    s_sub_u32 s3, s3, 1
    s_waitcnt lgkmcnt(0)
    v_readfirstlane_b32 s33, v2
    s_nop 3
    s_cselect_b32 s33, 4, s33
    s_cmp_lt_u32 s33, 4
    s_cbranch_scc1 K_P2_GW
    v_readfirstlane_b32 s56, v16
    v_readfirstlane_b32 s57, v17
    s_lshl_b32 s58, s53, 4
    s_waitcnt vmcnt(8)
    v_mfma_f32_16x16x32_bf16 v[148:151], v[212:215], v[116:119], v[148:151]
    v_mad_u32_u24 v52, s77, 5, v24
    v_xor_b32 v54, 64, v52
    v_xor_b32 v53, 32, v52
    v_mfma_f32_16x16x32_bf16 v[164:167], v[212:215], v[120:123], v[164:167]
    v_xor_b32 v55, 96, v52
    ds_read_b64_tr_b16 v[196:197], v52 offset:0
    ds_read_b64_tr_b16 v[198:199], v54 offset:2560
    v_mfma_f32_16x16x32_bf16 v[152:155], v[216:219], v[116:119], v[152:155]
    ds_read_b64_tr_b16 v[200:201], v53 offset:0
    ds_read_b64_tr_b16 v[202:203], v55 offset:2560
    ds_read_b64_tr_b16 v[204:205], v54 offset:0
    v_mfma_f32_16x16x32_bf16 v[168:171], v[216:219], v[120:123], v[168:171]
    ds_read_b64_tr_b16 v[206:207], v52 offset:2560
    ds_read_b64_tr_b16 v[208:209], v55 offset:0
    v_mfma_f32_16x16x32_bf16 v[156:159], v[220:223], v[116:119], v[156:159]
    ds_read_b64_tr_b16 v[210:211], v53 offset:2560
    s_cmp_eq_u32 s63, 0
    v_mfma_f32_16x16x32_bf16 v[172:175], v[220:223], v[120:123], v[172:175]
    s_cbranch_scc1 K_SP13
K_SPR13:
    s_ff1_i32_b32 s33, s63
    v_mfma_f32_16x16x32_bf16 v[160:163], v[224:227], v[116:119], v[160:163]
    s_bitset0_b32 s63, s33
    s_lshl_b32 s76, s33, 10
    v_mfma_f32_16x16x32_bf16 v[176:179], v[224:227], v[120:123], v[176:179]
    buffer_load_dwordx4 v[108:111], v25, s[20:23], s76 offen offset:0 sc1
    buffer_load_dwordx4 v[112:115], v26, s[20:23], s76 offen offset:0 sc1
    s_waitcnt vmcnt(8)
    v_mfma_f32_16x16x32_bf16 v[148:151], v[180:183], v[124:127], v[148:151]
    v_mad_u32_u24 v52, s78, 5, v24
    v_xor_b32 v54, 64, v52
    v_xor_b32 v53, 32, v52
    v_mfma_f32_16x16x32_bf16 v[164:167], v[180:183], v[128:131], v[164:167]
    v_xor_b32 v55, 96, v52
    ds_read_b64_tr_b16 v[212:213], v52 offset:0
    ds_read_b64_tr_b16 v[214:215], v54 offset:2560
    v_mfma_f32_16x16x32_bf16 v[152:155], v[184:187], v[124:127], v[152:155]
    ds_read_b64_tr_b16 v[216:217], v53 offset:0
    ds_read_b64_tr_b16 v[218:219], v55 offset:2560
    ds_read_b64_tr_b16 v[220:221], v54 offset:0
    v_mfma_f32_16x16x32_bf16 v[168:171], v[184:187], v[128:131], v[168:171]
    ds_read_b64_tr_b16 v[222:223], v52 offset:2560
    ds_read_b64_tr_b16 v[224:225], v55 offset:0
    v_mfma_f32_16x16x32_bf16 v[156:159], v[188:191], v[124:127], v[156:159]
    ds_read_b64_tr_b16 v[226:227], v53 offset:2560
    s_cmp_eq_u32 s63, 0
    v_mfma_f32_16x16x32_bf16 v[172:175], v[188:191], v[128:131], v[172:175]
    s_cbranch_scc1 K_SP14
K_SPR14:
    s_ff1_i32_b32 s33, s63
    v_mfma_f32_16x16x32_bf16 v[160:163], v[192:195], v[124:127], v[160:163]
    s_bitset0_b32 s63, s33
    s_lshl_b32 s77, s33, 10
    v_mfma_f32_16x16x32_bf16 v[176:179], v[192:195], v[128:131], v[176:179]
    buffer_load_dwordx4 v[116:119], v25, s[20:23], s77 offen offset:0 sc1
    buffer_load_dwordx4 v[120:123], v26, s[20:23], s77 offen offset:0 sc1
    s_waitcnt vmcnt(8) lgkmcnt(8)
    v_mfma_f32_16x16x32_bf16 v[148:151], v[196:199], v[132:135], v[148:151]
    v_mad_u32_u24 v52, s75, 5, v24
    v_xor_b32 v54, 64, v52
    v_xor_b32 v53, 32, v52
    v_mfma_f32_16x16x32_bf16 v[164:167], v[196:199], v[136:139], v[164:167]
    v_xor_b32 v55, 96, v52
    ds_read_b64_tr_b16 v[180:181], v52 offset:0
    ds_read_b64_tr_b16 v[182:183], v54 offset:2560
    v_mfma_f32_16x16x32_bf16 v[152:155], v[200:203], v[132:135], v[152:155]
    ds_read_b64_tr_b16 v[184:185], v53 offset:0
    ds_read_b64_tr_b16 v[186:187], v55 offset:2560
    ds_read_b64_tr_b16 v[188:189], v54 offset:0
    v_mfma_f32_16x16x32_bf16 v[168:171], v[200:203], v[136:139], v[168:171]
    ds_read_b64_tr_b16 v[190:191], v52 offset:2560
    ds_read_b64_tr_b16 v[192:193], v55 offset:0
    v_mfma_f32_16x16x32_bf16 v[156:159], v[204:207], v[132:135], v[156:159]
    ds_read_b64_tr_b16 v[194:195], v53 offset:2560
    s_cmp_eq_u32 s63, 0
    v_mfma_f32_16x16x32_bf16 v[172:175], v[204:207], v[136:139], v[172:175]
    s_cbranch_scc1 K_SP15
K_SPR15:
    s_ff1_i32_b32 s33, s63
    v_mfma_f32_16x16x32_bf16 v[160:163], v[208:211], v[132:135], v[160:163]
    s_bitset0_b32 s63, s33
    s_lshl_b32 s78, s33, 10
    v_mfma_f32_16x16x32_bf16 v[176:179], v[208:211], v[136:139], v[176:179]
    buffer_load_dwordx4 v[124:127], v25, s[20:23], s78 offen offset:0 sc1
    buffer_load_dwordx4 v[128:131], v26, s[20:23], s78 offen offset:0 sc1
    s_waitcnt vmcnt(8) lgkmcnt(8)
    v_mfma_f32_16x16x32_bf16 v[148:151], v[212:215], v[140:143], v[148:151]
    v_mad_u32_u24 v52, s76, 5, v24
    v_xor_b32 v54, 64, v52
    v_xor_b32 v53, 32, v52
    v_mfma_f32_16x16x32_bf16 v[164:167], v[212:215], v[144:147], v[164:167]
    v_xor_b32 v55, 96, v52
    ds_read_b64_tr_b16 v[196:197], v52 offset:0
    ds_read_b64_tr_b16 v[198:199], v54 offset:2560
    v_mfma_f32_16x16x32_bf16 v[152:155], v[216:219], v[140:143], v[152:155]
    ds_read_b64_tr_b16 v[200:201], v53 offset:0
    ds_read_b64_tr_b16 v[202:203], v55 offset:2560
    ds_read_b64_tr_b16 v[204:205], v54 offset:0
    v_mfma_f32_16x16x32_bf16 v[168:171], v[216:219], v[144:147], v[168:171]
    ds_read_b64_tr_b16 v[206:207], v52 offset:2560
    ds_read_b64_tr_b16 v[208:209], v55 offset:0
    v_mfma_f32_16x16x32_bf16 v[156:159], v[220:223], v[140:143], v[156:159]
    ds_read_b64_tr_b16 v[210:211], v53 offset:2560
    s_cmp_eq_u32 s63, 0
    v_mfma_f32_16x16x32_bf16 v[172:175], v[220:223], v[144:147], v[172:175]
    s_cbranch_scc1 K_SP16
K_SPR16:
    s_ff1_i32_b32 s33, s63
    v_mfma_f32_16x16x32_bf16 v[160:163], v[224:227], v[140:143], v[160:163]
    s_bitset0_b32 s63, s33
    s_lshl_b32 s75, s33, 10
    v_mfma_f32_16x16x32_bf16 v[176:179], v[224:227], v[144:147], v[176:179]
    buffer_load_dwordx4 v[132:135], v25, s[20:23], s75 offen offset:0 sc1
    buffer_load_dwordx4 v[136:139], v26, s[20:23], s75 offen offset:0 sc1
    s_waitcnt vmcnt(8) lgkmcnt(8)
    v_mfma_f32_16x16x32_bf16 v[148:151], v[180:183], v[100:103], v[148:151]
    v_mad_u32_u24 v52, s77, 5, v24
    v_xor_b32 v54, 64, v52
    v_xor_b32 v53, 32, v52
    v_mfma_f32_16x16x32_bf16 v[164:167], v[180:183], v[104:107], v[164:167]
    v_xor_b32 v55, 96, v52
    ds_read_b64_tr_b16 v[212:213], v52 offset:0
    ds_read_b64_tr_b16 v[214:215], v54 offset:2560
    v_mfma_f32_16x16x32_bf16 v[152:155], v[184:187], v[100:103], v[152:155]
    ds_read_b64_tr_b16 v[216:217], v53 offset:0
    ds_read_b64_tr_b16 v[218:219], v55 offset:2560
    ds_read_b64_tr_b16 v[220:221], v54 offset:0
    v_mfma_f32_16x16x32_bf16 v[168:171], v[184:187], v[104:107], v[168:171]
    ds_read_b64_tr_b16 v[222:223], v52 offset:2560
    ds_read_b64_tr_b16 v[224:225], v55 offset:0
    v_mfma_f32_16x16x32_bf16 v[156:159], v[188:191], v[100:103], v[156:159]
    ds_read_b64_tr_b16 v[226:227], v53 offset:2560
    s_cmp_eq_u32 s63, 0
    v_mfma_f32_16x16x32_bf16 v[172:175], v[188:191], v[104:107], v[172:175]
    s_cbranch_scc1 K_SP17
K_SPR17:
    s_ff1_i32_b32 s33, s63
    v_mfma_f32_16x16x32_bf16 v[160:163], v[192:195], v[100:103], v[160:163]
    s_bitset0_b32 s63, s33
    s_lshl_b32 s76, s33, 10
    v_mfma_f32_16x16x32_bf16 v[176:179], v[192:195], v[104:107], v[176:179]
    buffer_load_dwordx4 v[140:143], v25, s[20:23], s76 offen offset:0 sc1
    buffer_load_dwordx4 v[144:147], v26, s[20:23], s76 offen offset:0 sc1
    s_waitcnt vmcnt(8) lgkmcnt(8)
    v_mfma_f32_16x16x32_bf16 v[148:151], v[196:199], v[108:111], v[148:151]
    v_mad_u32_u24 v52, s78, 5, v24
    v_xor_b32 v54, 64, v52
    v_mfma_f32_16x16x32_bf16 v[164:167], v[196:199], v[112:115], v[164:167]
    v_xor_b32 v53, 32, v52
    v_xor_b32 v55, 96, v52
    v_mfma_f32_16x16x32_bf16 v[152:155], v[200:203], v[108:111], v[152:155]
    ds_read_b64_tr_b16 v[180:181], v52 offset:0
    ds_read_b64_tr_b16 v[182:183], v54 offset:2560
    v_mfma_f32_16x16x32_bf16 v[168:171], v[200:203], v[112:115], v[168:171]
    ds_read_b64_tr_b16 v[184:185], v53 offset:0
    ds_read_b64_tr_b16 v[186:187], v55 offset:2560
    v_mfma_f32_16x16x32_bf16 v[156:159], v[204:207], v[108:111], v[156:159]
    ds_read_b64_tr_b16 v[188:189], v54 offset:0
    ds_read_b64_tr_b16 v[190:191], v52 offset:2560
    v_mfma_f32_16x16x32_bf16 v[172:175], v[204:207], v[112:115], v[172:175]
    ds_read_b64_tr_b16 v[192:193], v55 offset:0
    ds_read_b64_tr_b16 v[194:195], v53 offset:2560
    v_mfma_f32_16x16x32_bf16 v[160:163], v[208:211], v[108:111], v[160:163]
    buffer_load_dwordx4 v[100:103], v25, s[20:23], s67 offen offset:2048 sc1
    buffer_load_dwordx4 v[104:107], v26, s[20:23], s67 offen offset:2048 sc1
    v_mfma_f32_16x16x32_bf16 v[176:179], v[208:211], v[112:115], v[176:179]
    s_waitcnt vmcnt(8) lgkmcnt(8)
    v_mfma_f32_16x16x32_bf16 v[148:151], v[212:215], v[116:119], v[148:151]
    v_mad_u32_u24 v52, s75, 5, v24
    v_xor_b32 v54, 64, v52
    v_mfma_f32_16x16x32_bf16 v[164:167], v[212:215], v[120:123], v[164:167]
    v_xor_b32 v53, 32, v52
    v_xor_b32 v55, 96, v52
    v_mfma_f32_16x16x32_bf16 v[152:155], v[216:219], v[116:119], v[152:155]
    ds_read_b64_tr_b16 v[196:197], v52 offset:0
    ds_read_b64_tr_b16 v[198:199], v54 offset:2560
    v_mfma_f32_16x16x32_bf16 v[168:171], v[216:219], v[120:123], v[168:171]
    ds_read_b64_tr_b16 v[200:201], v53 offset:0
    ds_read_b64_tr_b16 v[202:203], v55 offset:2560
    v_mfma_f32_16x16x32_bf16 v[156:159], v[220:223], v[116:119], v[156:159]
    ds_read_b64_tr_b16 v[204:205], v54 offset:0
    ds_read_b64_tr_b16 v[206:207], v52 offset:2560
    v_mfma_f32_16x16x32_bf16 v[172:175], v[220:223], v[120:123], v[172:175]
    ds_read_b64_tr_b16 v[208:209], v55 offset:0
    ds_read_b64_tr_b16 v[210:211], v53 offset:2560
    v_mfma_f32_16x16x32_bf16 v[160:163], v[224:227], v[116:119], v[160:163]
    buffer_load_dwordx4 v[108:111], v25, s[20:23], s67 offen offset:3072 sc1
    buffer_load_dwordx4 v[112:115], v26, s[20:23], s67 offen offset:3072 sc1
    v_mfma_f32_16x16x32_bf16 v[176:179], v[224:227], v[120:123], v[176:179]
    s_waitcnt vmcnt(8) lgkmcnt(8)
    v_mfma_f32_16x16x32_bf16 v[148:151], v[180:183], v[124:127], v[148:151]
    v_mad_u32_u24 v52, s76, 5, v24
    v_xor_b32 v54, 64, v52
    v_mfma_f32_16x16x32_bf16 v[164:167], v[180:183], v[128:131], v[164:167]
    v_xor_b32 v53, 32, v52
    v_xor_b32 v55, 96, v52
    v_mfma_f32_16x16x32_bf16 v[152:155], v[184:187], v[124:127], v[152:155]
    ds_read_b64_tr_b16 v[212:213], v52 offset:0
    ds_read_b64_tr_b16 v[214:215], v54 offset:2560
    v_mfma_f32_16x16x32_bf16 v[168:171], v[184:187], v[128:131], v[168:171]
    ds_read_b64_tr_b16 v[216:217], v53 offset:0
    ds_read_b64_tr_b16 v[218:219], v55 offset:2560
    v_mfma_f32_16x16x32_bf16 v[156:159], v[188:191], v[124:127], v[156:159]
    ds_read_b64_tr_b16 v[220:221], v54 offset:0
    ds_read_b64_tr_b16 v[222:223], v52 offset:2560
    v_mfma_f32_16x16x32_bf16 v[172:175], v[188:191], v[128:131], v[172:175]
    ds_read_b64_tr_b16 v[224:225], v55 offset:0
    ds_read_b64_tr_b16 v[226:227], v53 offset:2560
    v_mfma_f32_16x16x32_bf16 v[160:163], v[192:195], v[124:127], v[160:163]
    v_mfma_f32_16x16x32_bf16 v[176:179], v[192:195], v[128:131], v[176:179]
    s_waitcnt vmcnt(6) lgkmcnt(8)
    v_mfma_f32_16x16x32_bf16 v[148:151], v[196:199], v[132:135], v[148:151]
    ds_read_b64_tr_b16 v[180:181], v56 offset:40960
    ds_read_b64_tr_b16 v[182:183], v58 offset:43520
    v_mfma_f32_16x16x32_bf16 v[164:167], v[196:199], v[136:139], v[164:167]
    ds_read_b64_tr_b16 v[184:185], v57 offset:40960
    ds_read_b64_tr_b16 v[186:187], v59 offset:43520
    v_mfma_f32_16x16x32_bf16 v[152:155], v[200:203], v[132:135], v[152:155]
    ds_read_b64_tr_b16 v[188:189], v58 offset:40960
    ds_read_b64_tr_b16 v[190:191], v56 offset:43520
    v_mfma_f32_16x16x32_bf16 v[168:171], v[200:203], v[136:139], v[168:171]
    ds_read_b64_tr_b16 v[192:193], v59 offset:40960
    ds_read_b64_tr_b16 v[194:195], v57 offset:43520
    v_mfma_f32_16x16x32_bf16 v[156:159], v[204:207], v[132:135], v[156:159]
    v_mfma_f32_16x16x32_bf16 v[172:175], v[204:207], v[136:139], v[172:175]
    v_mfma_f32_16x16x32_bf16 v[160:163], v[208:211], v[132:135], v[160:163]
    v_mfma_f32_16x16x32_bf16 v[176:179], v[208:211], v[136:139], v[176:179]
    s_waitcnt vmcnt(4) lgkmcnt(8)
    v_mfma_f32_16x16x32_bf16 v[148:151], v[212:215], v[140:143], v[148:151]
    ds_read_b64_tr_b16 v[196:197], v56 offset:61440
    ds_read_b64_tr_b16 v[198:199], v58 offset:64000
    v_mfma_f32_16x16x32_bf16 v[164:167], v[212:215], v[144:147], v[164:167]
    ds_read_b64_tr_b16 v[200:201], v57 offset:61440
    ds_read_b64_tr_b16 v[202:203], v59 offset:64000
    v_mfma_f32_16x16x32_bf16 v[152:155], v[216:219], v[140:143], v[152:155]
    ds_read_b64_tr_b16 v[204:205], v58 offset:61440
    ds_read_b64_tr_b16 v[206:207], v56 offset:64000
    v_mfma_f32_16x16x32_bf16 v[168:171], v[216:219], v[144:147], v[168:171]
    ds_read_b64_tr_b16 v[208:209], v59 offset:61440
    ds_read_b64_tr_b16 v[210:211], v57 offset:64000
    v_mfma_f32_16x16x32_bf16 v[156:159], v[220:223], v[140:143], v[156:159]
    v_mfma_f32_16x16x32_bf16 v[172:175], v[220:223], v[144:147], v[172:175]
    v_mfma_f32_16x16x32_bf16 v[160:163], v[224:227], v[140:143], v[160:163]
    v_mfma_f32_16x16x32_bf16 v[176:179], v[224:227], v[144:147], v[176:179]
    s_waitcnt vmcnt(2) lgkmcnt(8)
    v_mfma_f32_16x16x32_bf16 v[148:151], v[180:183], v[100:103], v[148:151]
    v_mfma_f32_16x16x32_bf16 v[152:155], v[184:187], v[100:103], v[152:155]
    v_mfma_f32_16x16x32_bf16 v[156:159], v[188:191], v[100:103], v[156:159]
    v_mfma_f32_16x16x32_bf16 v[160:163], v[192:195], v[100:103], v[160:163]
    s_sub_u32 s59, s56, s58
    s_cmp_lt_u32 s59, 32
    s_cbranch_scc1 K_YROW0
K_NOY0:
    s_sub_u32 s59, s57, s58
    s_cmp_lt_u32 s59, 32
    s_cbranch_scc1 K_YROW1
K_NOY1:
    s_waitcnt vmcnt(0) lgkmcnt(0)
    v_mfma_f32_16x16x32_bf16 v[148:151], v[196:199], v[108:111], v[148:151]
    v_mfma_f32_16x16x32_bf16 v[152:155], v[200:203], v[108:111], v[152:155]
    v_mfma_f32_16x16x32_bf16 v[156:159], v[204:207], v[108:111], v[156:159]
    v_mfma_f32_16x16x32_bf16 v[160:163], v[208:211], v[108:111], v[160:163]
    v_mfma_f32_16x16x32_bf16 v[164:167], v[180:183], v[104:107], v[164:167]
    v_mfma_f32_16x16x32_bf16 v[168:171], v[184:187], v[104:107], v[168:171]
    v_mfma_f32_16x16x32_bf16 v[172:175], v[188:191], v[104:107], v[172:175]
    s_nop 1
    v_fma_f32 v148, v148, v60, v68
    v_fma_f32 v149, v149, v60, v69
    v_fma_f32 v150, v150, v60, v70
    v_mfma_f32_16x16x32_bf16 v[176:179], v[192:195], v[104:107], v[176:179]
    v_fma_f32 v151, v151, v60, v71
    v_cvt_pk_bf16_f32 v36, v148, v149
    v_cvt_pk_bf16_f32 v37, v150, v151
    v_mfma_f32_16x16x32_bf16 v[164:167], v[196:199], v[112:115], v[164:167]
    v_fma_f32 v152, v152, v60, v72
    v_fma_f32 v153, v153, v60, v73
    ds_write_b64 v29, v[36:37] offset:0
    v_mfma_f32_16x16x32_bf16 v[168:171], v[200:203], v[112:115], v[168:171]
    v_fma_f32 v154, v154, v60, v74
    v_fma_f32 v155, v155, v60, v75
    v_cvt_pk_bf16_f32 v38, v152, v153
    v_mfma_f32_16x16x32_bf16 v[172:175], v[204:207], v[112:115], v[172:175]
    v_cvt_pk_bf16_f32 v39, v154, v155
    v_fma_f32 v156, v156, v60, v76
    v_fma_f32 v157, v157, v60, v77
    v_mfma_f32_16x16x32_bf16 v[176:179], v[208:211], v[112:115], v[176:179]
    ds_write_b64 v30, v[38:39] offset:0
    v_fma_f32 v158, v158, v60, v78
    v_fma_f32 v159, v159, v60, v79
    v_cvt_pk_bf16_f32 v40, v156, v157
    v_cvt_pk_bf16_f32 v41, v158, v159
    v_pk_fma_f32 v[160:161], v[160:161], v[60:61], v[80:81] op_sel_hi:[1,0,1]
    v_pk_fma_f32 v[162:163], v[162:163], v[60:61], v[82:83] op_sel_hi:[1,0,1]
    ds_write_b64 v31, v[40:41] offset:0
    v_cvt_pk_bf16_f32 v42, v160, v161
    v_cvt_pk_bf16_f32 v43, v162, v163
    ds_write_b64 v32, v[42:43] offset:0
    ds_read_b128 v[68:71], v33 offset:0
    ds_read_b128 v[72:75], v33 offset:1024
    v_pk_fma_f32 v[164:165], v[164:165], v[62:63], v[84:85] op_sel_hi:[1,0,1]
    v_pk_fma_f32 v[166:167], v[166:167], v[62:63], v[86:87] op_sel_hi:[1,0,1]
    v_cvt_pk_bf16_f32 v44, v164, v165
    v_cvt_pk_bf16_f32 v45, v166, v167
    v_pk_fma_f32 v[168:169], v[168:169], v[62:63], v[88:89] op_sel_hi:[1,0,1]
    v_pk_fma_f32 v[170:171], v[170:171], v[62:63], v[90:91] op_sel_hi:[1,0,1]
    v_cvt_pk_bf16_f32 v46, v168, v169
    v_cvt_pk_bf16_f32 v47, v170, v171
    v_pk_fma_f32 v[172:173], v[172:173], v[62:63], v[92:93] op_sel_hi:[1,0,1]
    v_pk_fma_f32 v[174:175], v[174:175], v[62:63], v[94:95] op_sel_hi:[1,0,1]
    v_cvt_pk_bf16_f32 v48, v172, v173
    v_cvt_pk_bf16_f32 v49, v174, v175
    v_pk_fma_f32 v[176:177], v[176:177], v[62:63], v[96:97] op_sel_hi:[1,0,1]
    v_pk_fma_f32 v[178:179], v[178:179], v[62:63], v[98:99] op_sel_hi:[1,0,1]
    v_cvt_pk_bf16_f32 v50, v176, v177
    v_cvt_pk_bf16_f32 v51, v178, v179
    s_waitcnt lgkmcnt(0)
    buffer_store_dwordx4 v[68:71], v27, s[48:51], s71 offen sc1
    buffer_store_dwordx4 v[72:75], v28, s[48:51], s72 offen sc1
    ds_write_b64 v29, v[44:45] offset:2048
    ds_write_b64 v30, v[46:47] offset:2048
    ds_write_b64 v31, v[48:49] offset:2048
    ds_write_b64 v32, v[50:51] offset:2048
    ds_read_b128 v[84:87], v33 offset:2048
    ds_read_b128 v[88:91], v33 offset:3072
    s_waitcnt lgkmcnt(1)
    buffer_store_dwordx4 v[84:87], v27, s[48:51], s73 offen sc1
    s_waitcnt lgkmcnt(0)
    buffer_store_dwordx4 v[88:91], v28, s[48:51], s74 offen sc1
K_END:
K_EXIT:
    s_endpgm
.p2align 12
WP_spin:
    s_setpc_b64 s[38:39]
K_SP0:
    ds_read_b32 v2, v12 offset:32
    s_waitcnt lgkmcnt(0)
    v_readfirstlane_b32 s33, v2
    s_nop 3
    s_lshr_b32 s63, s33, s64
    s_lshr_b32 s33, s33, s65
    s_and_b32 s63, s63, s33
    s_and_b32 s63, s63, 0xff
    s_andn2_b32 s63, s63, s66
    s_cbranch_scc0 K_SP0
    s_or_b32 s66, s66, s63
    s_branch K_SPR0
K_SP1:
    ds_read_b32 v2, v12 offset:32
    s_waitcnt lgkmcnt(0)
    v_readfirstlane_b32 s33, v2
    s_nop 3
    s_lshr_b32 s63, s33, s64
    s_lshr_b32 s33, s33, s65
    s_and_b32 s63, s63, s33
    s_and_b32 s63, s63, 0xff
    s_andn2_b32 s63, s63, s66
    s_cbranch_scc0 K_SP1
    s_or_b32 s66, s66, s63
    s_branch K_SPR1
K_SP2:
    ds_read_b32 v2, v12 offset:32
    s_waitcnt lgkmcnt(0)
    v_readfirstlane_b32 s33, v2
    s_nop 3
    s_lshr_b32 s63, s33, s64
    s_lshr_b32 s33, s33, s65
    s_and_b32 s63, s63, s33
    s_and_b32 s63, s63, 0xff
    s_andn2_b32 s63, s63, s66
    s_cbranch_scc0 K_SP2
    s_or_b32 s66, s66, s63
    s_branch K_SPR2
K_SP3:
    ds_read_b32 v2, v12 offset:32
    s_waitcnt lgkmcnt(0)
    v_readfirstlane_b32 s33, v2
    s_nop 3
    s_lshr_b32 s63, s33, s64
    s_lshr_b32 s33, s33, s65
    s_and_b32 s63, s63, s33
    s_and_b32 s63, s63, 0xff
    s_andn2_b32 s63, s63, s66
    s_cbranch_scc0 K_SP3
    s_or_b32 s66, s66, s63
    s_branch K_SPR3
K_SP4:
    ds_read_b32 v2, v12 offset:32
    s_waitcnt lgkmcnt(0)
    v_readfirstlane_b32 s33, v2
    s_nop 3
    s_lshr_b32 s63, s33, s64
    s_lshr_b32 s33, s33, s65
    s_and_b32 s63, s63, s33
    s_and_b32 s63, s63, 0xff
    s_andn2_b32 s63, s63, s66
    s_cbranch_scc0 K_SP4
    s_or_b32 s66, s66, s63
    s_branch K_SPR4
K_SP5:
    ds_read_b32 v2, v12 offset:32
    s_waitcnt lgkmcnt(0)
    v_readfirstlane_b32 s33, v2
    s_nop 3
    s_lshr_b32 s63, s33, s64
    s_lshr_b32 s33, s33, s65
    s_and_b32 s63, s63, s33
    s_and_b32 s63, s63, 0xff
    s_andn2_b32 s63, s63, s66
    s_cbranch_scc0 K_SP5
    s_or_b32 s66, s66, s63
    s_branch K_SPR5
K_SP6:
    ds_read_b32 v2, v12 offset:32
    s_waitcnt lgkmcnt(0)
    v_readfirstlane_b32 s33, v2
    s_nop 3
    s_lshr_b32 s63, s33, s64
    s_lshr_b32 s33, s33, s65
    s_and_b32 s63, s63, s33
    s_and_b32 s63, s63, 0xff
    s_andn2_b32 s63, s63, s66
    s_cbranch_scc0 K_SP6
    s_or_b32 s66, s66, s63
    s_branch K_SPR6
K_SP7:
    ds_read_b32 v2, v12 offset:32
    s_waitcnt lgkmcnt(0)
    v_readfirstlane_b32 s33, v2
    s_nop 3
    s_lshr_b32 s63, s33, s64
    s_lshr_b32 s33, s33, s65
    s_and_b32 s63, s63, s33
    s_and_b32 s63, s63, 0xff
    s_andn2_b32 s63, s63, s66
    s_cbranch_scc0 K_SP7
    s_or_b32 s66, s66, s63
    s_branch K_SPR7
K_SP10:
    ds_read_b32 v2, v12 offset:32
    s_waitcnt lgkmcnt(0)
    v_readfirstlane_b32 s33, v2
    s_nop 3
    s_lshr_b32 s63, s33, s64
    s_lshr_b32 s33, s33, s65
    s_and_b32 s63, s63, s33
    s_and_b32 s63, s63, 0xff00
    s_andn2_b32 s63, s63, s66
    s_cbranch_scc0 K_SP10
    s_or_b32 s66, s66, s63
    s_branch K_SPR10
K_SP11:
    ds_read_b32 v2, v12 offset:32
    s_waitcnt lgkmcnt(0)
    v_readfirstlane_b32 s33, v2
    s_nop 3
    s_lshr_b32 s63, s33, s64
    s_lshr_b32 s33, s33, s65
    s_and_b32 s63, s63, s33
    s_and_b32 s63, s63, 0xff00
    s_andn2_b32 s63, s63, s66
    s_cbranch_scc0 K_SP11
    s_or_b32 s66, s66, s63
    s_branch K_SPR11
K_SP12:
    ds_read_b32 v2, v12 offset:32
    s_waitcnt lgkmcnt(0)
    v_readfirstlane_b32 s33, v2
    s_nop 3
    s_lshr_b32 s63, s33, s64
    s_lshr_b32 s33, s33, s65
    s_and_b32 s63, s63, s33
    s_and_b32 s63, s63, 0xff00
    s_andn2_b32 s63, s63, s66
    s_cbranch_scc0 K_SP12
    s_or_b32 s66, s66, s63
    s_branch K_SPR12
K_SP13:
    ds_read_b32 v2, v12 offset:32
    s_waitcnt lgkmcnt(0)
    v_readfirstlane_b32 s33, v2
    s_nop 3
    s_lshr_b32 s63, s33, s64
    s_lshr_b32 s33, s33, s65
    s_and_b32 s63, s63, s33
    s_and_b32 s63, s63, 0xff00
    s_andn2_b32 s63, s63, s66
    s_cbranch_scc0 K_SP13
    s_or_b32 s66, s66, s63
    s_branch K_SPR13
K_SP14:
    ds_read_b32 v2, v12 offset:32
    s_waitcnt lgkmcnt(0)
    v_readfirstlane_b32 s33, v2
    s_nop 3
    s_lshr_b32 s63, s33, s64
    s_lshr_b32 s33, s33, s65
    s_and_b32 s63, s63, s33
    s_and_b32 s63, s63, 0xff00
    s_andn2_b32 s63, s63, s66
    s_cbranch_scc0 K_SP14
    s_or_b32 s66, s66, s63
    s_branch K_SPR14
K_SP15:
    ds_read_b32 v2, v12 offset:32
    s_waitcnt lgkmcnt(0)
    v_readfirstlane_b32 s33, v2
    s_nop 3
    s_lshr_b32 s63, s33, s64
    s_lshr_b32 s33, s33, s65
    s_and_b32 s63, s63, s33
    s_and_b32 s63, s63, 0xff00
    s_andn2_b32 s63, s63, s66
    s_cbranch_scc0 K_SP15
    s_or_b32 s66, s66, s63
    s_branch K_SPR15
K_SP16:
    ds_read_b32 v2, v12 offset:32
    s_waitcnt lgkmcnt(0)
    v_readfirstlane_b32 s33, v2
    s_nop 3
    s_lshr_b32 s63, s33, s64
    s_lshr_b32 s33, s33, s65
    s_and_b32 s63, s63, s33
    s_and_b32 s63, s63, 0xff00
    s_andn2_b32 s63, s63, s66
    s_cbranch_scc0 K_SP16
    s_or_b32 s66, s66, s63
    s_branch K_SPR16
K_SP17:
    ds_read_b32 v2, v12 offset:32
    s_waitcnt lgkmcnt(0)
    v_readfirstlane_b32 s33, v2
    s_nop 3
    s_lshr_b32 s63, s33, s64
    s_lshr_b32 s33, s33, s65
    s_and_b32 s63, s63, s33
    s_and_b32 s63, s63, 0xff00
    s_andn2_b32 s63, s63, s66
    s_cbranch_scc0 K_SP17
    s_or_b32 s66, s66, s63
    s_branch K_SPR17
WP_yr0:
    s_setpc_b64 s[38:39]
K_YROW0:
    v_lshlrev_b32 v5, 4, v9
    v_add_u32 v5, 158976, v5
    v_and_b32 v3, 15, v1
    s_and_b32 s33, s59, 15
    v_cmp_eq_u32 vcc, s33, v3
    s_mov_b32 s3, 1048576
K_P2_GY0:
    ds_read_b32 v2, v12 offset:64
    s_sub_u32 s3, s3, 1
    s_waitcnt lgkmcnt(0)
    v_readfirstlane_b32 s33, v2
    s_nop 3
    s_cselect_b32 s33, 1, s33
    s_cmp_lt_u32 s33, 1
    s_cbranch_scc1 K_P2_GY0
    s_mov_b64 exec, vcc
    s_cmp_ge_u32 s59, 16
    s_cbranch_scc1 K_YR1_0
    ds_read_b128 v[68:71], v5 offset:0
    ds_read_b128 v[72:75], v5 offset:64
    ds_read_b128 v[76:79], v5 offset:128
    ds_read_b128 v[80:83], v5 offset:192
    s_mov_b64 exec, -1
    s_branch K_NOY0
K_YR1_0:
    ds_read_b128 v[84:87], v5 offset:0
    ds_read_b128 v[88:91], v5 offset:64
    ds_read_b128 v[92:95], v5 offset:128
    ds_read_b128 v[96:99], v5 offset:192
    s_mov_b64 exec, -1
    s_branch K_NOY0
K_YROW1:
    v_lshlrev_b32 v5, 4, v9
    v_add_u32 v5, 159232, v5
    v_and_b32 v3, 15, v1
    s_and_b32 s33, s59, 15
    v_cmp_eq_u32 vcc, s33, v3
    s_mov_b32 s3, 1048576
K_P2_GY1:
    ds_read_b32 v2, v12 offset:68
    s_sub_u32 s3, s3, 1
    s_waitcnt lgkmcnt(0)
    v_readfirstlane_b32 s33, v2
    s_nop 3
    s_cselect_b32 s33, 1, s33
    s_cmp_lt_u32 s33, 1
    s_cbranch_scc1 K_P2_GY1
    s_mov_b64 exec, vcc
    s_cmp_ge_u32 s59, 16
    s_cbranch_scc1 K_YR1_1
    ds_read_b128 v[68:71], v5 offset:0
    ds_read_b128 v[72:75], v5 offset:64
    ds_read_b128 v[76:79], v5 offset:128
    ds_read_b128 v[80:83], v5 offset:192
    s_mov_b64 exec, -1
    s_branch K_NOY1
K_YR1_1:
    ds_read_b128 v[84:87], v5 offset:0
    ds_read_b128 v[88:91], v5 offset:64
    ds_read_b128 v[92:95], v5 offset:128
    ds_read_b128 v[96:99], v5 offset:192
    s_mov_b64 exec, -1
    s_branch K_NOY1
.p2align 12
WP_gen:
    s_setpc_b64 s[38:39]
K_P2:
    s_cmp_ge_u32 s30, 4
    s_cbranch_scc1 K_P2_HELP
    s_lshl_b32 s54, s40, 7
    v_lshrrev_b32 v9, 4, v1
    v_mov_b32 v12, 158720
    s_add_u32 s20, s10, 0x100000
    s_addc_u32 s21, s11, 0
    s_mov_b32 s22, 0x280000
    s_mov_b32 s23, 0x20000
    s_add_u32 s16, s10, 0x1000
    s_addc_u32 s17, s11, 0
    s_mov_b32 s18, 0x2000
    s_mov_b32 s19, 0x20000
    s_mov_b32 s48, s6
    s_mov_b32 s49, s7
    s_mov_b32 s50, 0x280000
    s_mov_b32 s51, 0x20000
    s_lshl_b32 s53, s40, 3
    s_lshl1_add_u32 s53, s30, s53
    s_mov_b32 s55, 20480
    v_bfe_u32 v20, v1, 2, 2
    v_and_b32 v21, 3, v1
    s_mul_i32 s3, s53, 20480
    v_lshl_add_u32 v25, v1, 4, s3
    v_add_u32 v26, 20480, v25
    v_and_b32 v2, 15, v1
    s_lshl_b32 s3, s53, 6
    v_lshl_add_u32 v23, v2, 2, s3
    v_lshl_add_u32 v2, v9, 2, v20
    v_bfe_u32 v3, v2, 1, 2
    v_lshlrev_b32 v2, 7, v2
    v_lshl_add_u32 v2, v21, 3, v2
    v_lshl_add_u32 v24, v3, 5, v2
    v_lshrrev_b32 v3, 1, v20
    v_mul_u32_u24 v2, 40, v9
    v_add3_u32 v2, v2, 16, v20
    v_lshlrev_b32 v2, 7, v2
    v_lshl_add_u32 v2, v21, 3, v2
    v_xor_b32 v4, 0, v3
    v_lshl_add_u32 v56, v4, 5, v2
    v_xor_b32 v4, 1, v3
    v_lshl_add_u32 v57, v4, 5, v2
    v_xor_b32 v4, 2, v3
    v_lshl_add_u32 v58, v4, 5, v2
    v_xor_b32 v4, 3, v3
    v_lshl_add_u32 v59, v4, 5, v2
    v_lshrrev_b32 v3, 4, v1
    v_and_b32 v4, 7, v1
    v_lshrrev_b32 v2, 3, v1
    v_xor_b32 v4, v4, v3
    v_mul_u32_u24 v2, 1280, v2
    v_lshl_add_u32 v27, v4, 4, v2
    v_xor_b32 v28, 64, v27
    s_lshl_b32 s71, s40, 3
    s_lshl1_add_u32 s71, s30, s71
    s_mul_i32 s71, s71, 20480
    s_lshl_b32 s33, s41, 7
    s_add_u32 s71, s71, s33
    s_add_u32 s72, s71, 10240
    s_add_u32 s73, s71, 20480
    s_add_u32 s74, s71, 30720
    s_lshl_b32 s3, s30, 12
    s_add_u32 s3, s3, 140288
    v_lshl_add_u32 v33, v1, 4, s3
    v_and_b32 v2, 15, v1
    v_lshrrev_b32 v3, 1, v2
    v_lshrrev_b32 v4, 5, v1
    v_xor_b32 v3, v3, v4
    v_lshlrev_b32 v3, 4, v3
    v_lshl_add_u32 v3, v2, 7, v3
    v_and_b32 v4, 1, v9
    v_lshl_add_u32 v3, v4, 3, v3
    v_add_u32 v29, s3, v3
    v_xor_b32 v30, 32, v29
    v_xor_b32 v31, 64, v29
    v_xor_b32 v32, 96, v29
    s_lshl_b32 s3, s40, 3
    s_mul_i32 s33, s3, 187
    s_lshr_b32 s33, s33, 11
    s_add_u32 s33, s33, 1
    s_mul_i32 s33, s33, 11
    s_cmp_ge_u32 s53, s33
    s_cselect_b32 s64, 16, 0
    s_add_u32 s3, s53, 1
    s_cmp_ge_u32 s3, s33
    s_cselect_b32 s65, 16, 0
    s_mov_b32 s63, 0
    s_mov_b32 s66, 0
    s_mov_b32 s67, 16384
    s_cmp_eq_u32 s30, 0
    s_cbranch_scc1 K_P2_AUXW
    v_lshrrev_b32 v2, 3, v1
    v_mul_u32_u24 v2, 1280, v2
    v_lshrrev_b32 v3, 4, v1
    v_lshlrev_b32 v3, 1, v3
    v_and_b32 v4, 7, v1
    v_xor_b32 v3, v3, v4
    v_lshl_add_u32 v2, v3, 4, v2
    s_lshl_b32 s33, s41, 7
    v_add_u32 v22, s33, v2
    s_mov_b32 s60, 0xfda87520
    s_mov_b32 s61, 0xecb96431
    s_sub_u32 s58, s30, 1
K_P2_WS:
    s_lshl_b32 s3, s58, 2
    s_lshr_b64 s[4:5], s[60:61], s3
    s_and_b32 s4, s4, 15
    s_mul_i32 s4, s4, 51200
    s_mul_i32 s59, s58, 5120
    s_add_u32 s52, s4, 0
    s_add_u32 m0, s59, 0
    s_waitcnt vmcnt(11)
    buffer_load_dwordx4 v22, s[24:27], s52 offen lds
    s_add_u32 s52, s4, 10240
    s_add_u32 m0, s59, 1024
    s_waitcnt vmcnt(11)
    buffer_load_dwordx4 v22, s[24:27], s52 offen lds
    s_add_u32 s52, s4, 20480
    s_add_u32 m0, s59, 2048
    s_waitcnt vmcnt(11)
    buffer_load_dwordx4 v22, s[24:27], s52 offen lds
    s_add_u32 s52, s4, 30720
    s_add_u32 m0, s59, 3072
    s_waitcnt vmcnt(11)
    buffer_load_dwordx4 v22, s[24:27], s52 offen lds
    s_add_u32 s52, s4, 40960
    s_add_u32 m0, s59, 4096
    s_waitcnt vmcnt(11)
    buffer_load_dwordx4 v22, s[24:27], s52 offen lds
    s_cmp_ge_u32 s58, 3
    s_cbranch_scc1 K_P2_WS1
    v_mov_b32 v3, 1
    s_waitcnt vmcnt(5)
    s_mov_b64 exec, 1
    ds_add_u32 v12, v3 offset:52
    s_mov_b64 exec, -1
K_P2_WS1:
    s_add_u32 s58, s58, 3
    s_cmp_lt_u32 s58, 16
    s_cbranch_scc1 K_P2_WS
K_P2_AUXW:
    s_lshl_b32 s33, s30, 12
    s_add_u32 m0, s33, 140288
    s_add_u32 s3, s71, 0
    buffer_load_dwordx4 v27, s[12:15], s3 offen lds
    s_add_u32 m0, s33, 141312
    s_add_u32 s3, s71, 10240
    buffer_load_dwordx4 v28, s[12:15], s3 offen lds
    s_add_u32 m0, s33, 142336
    s_add_u32 s3, s71, 20480
    buffer_load_dwordx4 v27, s[12:15], s3 offen lds
    s_add_u32 m0, s33, 143360
    s_add_u32 s3, s71, 30720
    buffer_load_dwordx4 v28, s[12:15], s3 offen lds
    v_mov_b32 v3, 1
    s_waitcnt vmcnt(0)
    s_mov_b64 exec, 1
    ds_add_u32 v12, v3 offset:44
    s_mov_b64 exec, -1
    s_mov_b32 s3, 1048576
K_P2_GWA:
    ds_read_b32 v2, v12 offset:44
    s_sub_u32 s3, s3, 1
    s_waitcnt lgkmcnt(0)
    v_readfirstlane_b32 s33, v2
    s_nop 3
    s_cselect_b32 s33, 4, s33
    s_cmp_lt_u32 s33, 4
    s_cbranch_scc1 K_P2_GWA
    s_branch K_P2_GEMM
WP_help:
    s_setpc_b64 s[38:39]
K_LATE:
    s_mov_b32 s3, 1048576
K_LG:
    ds_read_b32 v2, v4 offset:48
    s_sub_u32 s3, s3, 1
    s_waitcnt lgkmcnt(0)
    v_readfirstlane_b32 s33, v2
    s_nop 3
    s_cselect_b32 s33, 8, s33
    s_bitcmp0_b32 s33, 3
    s_cbranch_scc1 K_LG
    s_sub_u32 s44, s30, 4
K_WOL:
    s_lshl_b32 s50, s44, 2
    s_lshr_b32 s50, 0x6431, s50
    s_and_b32 s50, s50, 7
    s_mul_i32 s50, s50, 51200
    s_mul_i32 s51, s44, 5120
    s_add_u32 s3, s50, 0
    s_add_u32 m0, s51, 40960
    s_waitcnt vmcnt(13)
    buffer_load_dwordx4 v18, s[24:27], s3 offen lds
    s_add_u32 s3, s50, 10240
    s_add_u32 m0, s51, 41984
    s_waitcnt vmcnt(13)
    buffer_load_dwordx4 v18, s[24:27], s3 offen lds
    s_add_u32 s3, s50, 20480
    s_add_u32 m0, s51, 43008
    s_waitcnt vmcnt(13)
    buffer_load_dwordx4 v18, s[24:27], s3 offen lds
    s_add_u32 s3, s50, 30720
    s_add_u32 m0, s51, 44032
    s_waitcnt vmcnt(13)
    buffer_load_dwordx4 v18, s[24:27], s3 offen lds
    s_add_u32 s3, s50, 40960
    s_add_u32 m0, s51, 45056
    s_waitcnt vmcnt(13)
    buffer_load_dwordx4 v18, s[24:27], s3 offen lds
    s_add_u32 s3, s50, 409600
    s_add_u32 m0, s51, 61440
    s_waitcnt vmcnt(13)
    buffer_load_dwordx4 v18, s[24:27], s3 offen lds
    s_add_u32 s3, s50, 419840
    s_add_u32 m0, s51, 62464
    s_waitcnt vmcnt(13)
    buffer_load_dwordx4 v18, s[24:27], s3 offen lds
    s_add_u32 s3, s50, 430080
    s_add_u32 m0, s51, 63488
    s_waitcnt vmcnt(13)
    buffer_load_dwordx4 v18, s[24:27], s3 offen lds
    s_add_u32 s3, s50, 440320
    s_add_u32 m0, s51, 64512
    s_waitcnt vmcnt(13)
    buffer_load_dwordx4 v18, s[24:27], s3 offen lds
    s_add_u32 s3, s50, 450560
    s_add_u32 m0, s51, 65536
    s_waitcnt vmcnt(13)
    buffer_load_dwordx4 v18, s[24:27], s3 offen lds
    s_add_u32 s44, s44, 2
    s_cmp_lt_u32 s44, 4
    s_cbranch_scc1 K_WOL
    v_mov_b32 v2, 158720
    v_mov_b32 v3, 2
    s_waitcnt vmcnt(0)
    s_mov_b64 exec, 1
    ds_add_u32 v2, v3 offset:44
    s_mov_b64 exec, -1
K_P2_HELP:
    s_setprio 3
    s_lshl_b32 s53, s40, 3
    s_mul_i32 s58, s53, 187
    s_lshr_b32 s58, s58, 11
    s_add_u32 s3, s53, 7
    s_mul_i32 s59, s3, 187
    s_lshr_b32 s59, s59, 11
    s_sub_u32 s59, s59, s58
    s_lshl_b32 s59, s59, 4
    s_or_b32 s59, s59, 15
    v_and_b32 v10, s59, v1
    v_lshl_add_u32 v10, v10, 2, s42
    s_cmp_lg_u32 s30, 7
    s_cbranch_scc1 K_P2_N7
    v_and_b32 v4, 7, v1
    v_lshlrev_b32 v4, 2, v4
    s_mov_b32 s3, 131072
K_ZPOLL1:
    v_cmp_eq_u32 vcc, 0, v7
    s_cbranch_vccz K_ZOK1
    s_sub_u32 s3, s3, 1
    s_cbranch_scc1 K_ZOK1
    global_load_dword v7, v4, s[8:9] offset:192 sc1
    s_waitcnt vmcnt(0)
    s_branch K_ZPOLL1
K_ZOK1:
    global_load_dword v7, v10, s[10:11] sc1
K_P2_N7:
    s_lshl_b32 s54, s40, 7
    v_lshrrev_b32 v9, 4, v1
    v_mov_b32 v12, 158720
    s_add_u32 s44, s10, 0x10000
    s_addc_u32 s45, s11, 0
    s_mov_b32 s46, 0x43800
    s_mov_b32 s47, 0x20000
    v_mov_b32 v80, 1
    s_cmp_eq_u32 s30, 7
    s_cbranch_scc1 K_P2_FLAGS
    s_cmp_lg_u32 s30, 6
    s_cbranch_scc1 K_P2_HW
    s_mov_b32 s3, 131072
K_P2_DPOLL:
    v_cmp_eq_u32 vcc, 0, v7
    s_cbranch_vccz K_P2_DOK
    s_cmp_eq_u32 s3, 131072
    s_cbranch_scc1 K_P2_DNS
    s_sleep 12
K_P2_DNS:
    v_and_b32 v11, 1, v1
    v_lshl_add_u32 v11, v11, 2, s42
    global_load_dword v7, v11, s[10:11] offset:128 sc1
    s_sub_u32 s3, s3, 1
    s_waitcnt vmcnt(0)
    s_cmp_lg_u32 s3, 0
    s_cbranch_scc1 K_P2_DPOLL
K_P2_DOK:
    v_readlane_b32 s58, v7, 0
    v_readlane_b32 s59, v7, 1
    s_nop 3
    s_and_b32 s3, s58, 0x7ff
    s_sub_u32 s3, 2047, s3
    v_mov_b32 v20, s3
    v_mov_b32 v4, s58
    v_and_b32 v4, 0xffff0000, v4
    v_ashrrev_i32 v5, 31, v4
    v_not_b32 v5, v5
    v_or_b32 v5, 0x80000000, v5
    v_xor_b32 v4, v4, v5
    v_and_b32 v4, 0xffff0000, v4
    v_mul_f32 v5, 0xbfb8aa3b, v4
    v_exp_f32 v5, v5
    s_nop 0
    v_add_f32 v5, 1.0, v5
    v_rcp_f32 v4, v5
    s_nop 0
    v_cvt_pk_bf16_f32 v22, v4, v4
    v_lshlrev_b32 v22, 16, v22
    s_and_b32 s3, s59, 0x7ff
    s_sub_u32 s3, 2047, s3
    v_mov_b32 v21, s3
    v_mov_b32 v4, s59
    v_and_b32 v4, 0xffff0000, v4
    v_ashrrev_i32 v5, 31, v4
    v_not_b32 v5, v5
    v_or_b32 v5, 0x80000000, v5
    v_xor_b32 v4, v4, v5
    v_and_b32 v4, 0xffff0000, v4
    v_mul_f32 v5, 0xbfb8aa3b, v4
    v_exp_f32 v5, v5
    s_nop 0
    v_add_f32 v5, 1.0, v5
    v_rcp_f32 v4, v5
    s_nop 0
    v_cvt_pk_bf16_f32 v23, v4, v4
    v_lshlrev_b32 v23, 16, v23
    ds_write_b128 v12, v[20:23]
    ds_write_b32 v12, v80 offset:40
    s_branch K_END
K_P2_HW:
    s_mov_b32 s3, 1048576
K_P2_GS2:
    ds_read_b32 v2, v12 offset:40
    s_sleep 1
    s_sub_u32 s3, s3, 1
    s_waitcnt lgkmcnt(0)
    v_readfirstlane_b32 s33, v2
    s_nop 3
    s_cselect_b32 s33, 1, s33
    s_cmp_lt_u32 s33, 1
    s_cbranch_scc1 K_P2_GS2
    ds_read_b128 v[16:19], v12
    s_waitcnt lgkmcnt(0)
    s_cmp_eq_u32 s30, 4
    s_cselect_b64 vcc, -1, 0
    s_nop 1
    v_cndmask_b32 v2, v17, v16, vcc
    v_cndmask_b32 v5, v19, v18, vcc
    s_nop 0
    v_readfirstlane_b32 s58, v2
    s_nop 3
    s_sub_u32 s3, s58, s54
    s_cmp_lt_u32 s3, 128
    s_cbranch_scc0 K_END
    s_call_b64 s[38:39], WP_yr0
    s_mul_i32 s3, s58, 1280
    s_lshl_b32 s33, s41, 7
    s_add_u32 s3, s3, s33
    v_and_b32 v2, 15, v1
    v_lshlrev_b32 v2, 3, v2
    buffer_load_dwordx2 v[84:85], v2, s[12:15], s3 offen
    s_lshl_b32 s3, s58, 2
    s_add_u32 s3, s3, 4096
    v_mov_b32 v2, s3
    global_load_dword v88, v2, s[10:11] sc1
    v_min_u32 v3, 53, v1
    v_lshlrev_b32 v3, 5, v3
    v_add_u32 v3, 565248, v3
    s_mov_b32 s3, 1048576
K_P2_GY:
    ds_read_b32 v2, v12 offset:32
    s_sleep 1
    s_sub_u32 s3, s3, 1
    s_waitcnt lgkmcnt(0)
    v_readfirstlane_b32 s33, v2
    s_nop 3
    s_cselect_b32 s33, 255, s33
    s_and_b32 s33, s33, 255
    s_cmp_lt_u32 s33, 255
    s_cbranch_scc1 K_P2_GY
    s_mov_b32 s3, 131072
K_P2_YPOLL:
    global_load_dwordx4 v[20:23], v3, s[10:11] sc1
    s_sub_u32 s3, s3, 1
    s_waitcnt vmcnt(0)
    v_and_b32 v2, v20, v21
    v_and_b32 v2, v2, v22
    v_and_b32 v2, v2, v23
    v_cmp_ne_u32 vcc, 1, v2
    s_cbranch_vccz K_P2_YGO
    s_sleep 8
    s_cmp_lg_u32 s3, 0
    s_cbranch_scc1 K_P2_YPOLL
K_P2_YGO:
    v_and_b32 v2, 15, v1
    v_lshlrev_b32 v2, 4, v2
    v_mul_u32_u24 v4, 5120, v9
    s_sub_u32 s59, s30, 4
    s_mul_i32 s33, s59, 2560
    s_lshl_b32 s3, s41, 8
    s_add_u32 s3, s3, s33
    v_add3_u32 v3, v2, v4, s3
    s_mov_b32 s52, 0
    buffer_load_dwordx4 v[24:27], v3, s[44:47], s52 offen sc1
    s_mov_b32 s52, 20480
    buffer_load_dwordx4 v[28:31], v3, s[44:47], s52 offen sc1
    s_mov_b32 s52, 40960
    buffer_load_dwordx4 v[32:35], v3, s[44:47], s52 offen sc1
    s_mov_b32 s52, 61440
    buffer_load_dwordx4 v[36:39], v3, s[44:47], s52 offen sc1
    s_mov_b32 s52, 81920
    buffer_load_dwordx4 v[40:43], v3, s[44:47], s52 offen sc1
    s_mov_b32 s52, 102400
    buffer_load_dwordx4 v[44:47], v3, s[44:47], s52 offen sc1
    s_mov_b32 s52, 122880
    buffer_load_dwordx4 v[48:51], v3, s[44:47], s52 offen sc1
    s_mov_b32 s52, 143360
    buffer_load_dwordx4 v[52:55], v3, s[44:47], s52 offen sc1
    s_mov_b32 s52, 163840
    buffer_load_dwordx4 v[56:59], v3, s[44:47], s52 offen sc1
    s_mov_b32 s52, 184320
    buffer_load_dwordx4 v[60:63], v3, s[44:47], s52 offen sc1
    s_mov_b32 s52, 204800
    buffer_load_dwordx4 v[64:67], v3, s[44:47], s52 offen sc1
    s_mov_b32 s52, 225280
    buffer_load_dwordx4 v[68:71], v3, s[44:47], s52 offen sc1
    s_mov_b32 s52, 245760
    buffer_load_dwordx4 v[72:75], v3, s[44:47], s52 offen sc1
    s_mov_b32 s52, 266240
    buffer_load_dwordx4 v[76:79], v3, s[44:47], s52 offen sc1
    v_sub_f32 v88, 1.0, v88
    v_cvt_pk_bf16_f32 v88, v88, v88
    v_lshlrev_b32 v88, 16, v88
    v_lshlrev_b32 v86, 16, v85
    v_and_b32 v87, 0xffff0000, v85
    v_and_b32 v85, 0xffff0000, v84
    v_lshlrev_b32 v84, 16, v84
    s_waitcnt vmcnt(12)
    v_add_f32 v20, v24, v28
    v_add_f32 v21, v25, v29
    v_add_f32 v22, v26, v30
    v_add_f32 v23, v27, v31
    s_waitcnt vmcnt(11)
    v_add_f32 v20, v20, v32
    v_add_f32 v21, v21, v33
    v_add_f32 v22, v22, v34
    v_add_f32 v23, v23, v35
    s_waitcnt vmcnt(10)
    v_add_f32 v20, v20, v36
    v_add_f32 v21, v21, v37
    v_add_f32 v22, v22, v38
    v_add_f32 v23, v23, v39
    s_waitcnt vmcnt(9)
    v_add_f32 v20, v20, v40
    v_add_f32 v21, v21, v41
    v_add_f32 v22, v22, v42
    v_add_f32 v23, v23, v43
    s_waitcnt vmcnt(8)
    v_add_f32 v20, v20, v44
    v_add_f32 v21, v21, v45
    v_add_f32 v22, v22, v46
    v_add_f32 v23, v23, v47
    s_waitcnt vmcnt(7)
    v_add_f32 v20, v20, v48
    v_add_f32 v21, v21, v49
    v_add_f32 v22, v22, v50
    v_add_f32 v23, v23, v51
    s_waitcnt vmcnt(6)
    v_add_f32 v20, v20, v52
    v_add_f32 v21, v21, v53
    v_add_f32 v22, v22, v54
    v_add_f32 v23, v23, v55
    s_waitcnt vmcnt(5)
    v_add_f32 v20, v20, v56
    v_add_f32 v21, v21, v57
    v_add_f32 v22, v22, v58
    v_add_f32 v23, v23, v59
    s_waitcnt vmcnt(4)
    v_add_f32 v20, v20, v60
    v_add_f32 v21, v21, v61
    v_add_f32 v22, v22, v62
    v_add_f32 v23, v23, v63
    s_waitcnt vmcnt(3)
    v_add_f32 v20, v20, v64
    v_add_f32 v21, v21, v65
    v_add_f32 v22, v22, v66
    v_add_f32 v23, v23, v67
    s_waitcnt vmcnt(2)
    v_add_f32 v20, v20, v68
    v_add_f32 v21, v21, v69
    v_add_f32 v22, v22, v70
    v_add_f32 v23, v23, v71
    s_waitcnt vmcnt(1)
    v_add_f32 v20, v20, v72
    v_add_f32 v21, v21, v73
    v_add_f32 v22, v22, v74
    v_add_f32 v23, v23, v75
    s_waitcnt vmcnt(0)
    v_add_f32 v20, v20, v76
    v_add_f32 v21, v21, v77
    v_add_f32 v22, v22, v78
    v_add_f32 v23, v23, v79
    v_mov_b32 v24, v20
    v_mov_b32 v25, v21
    v_mov_b32 v26, v22
    v_mov_b32 v27, v23
    s_nop 0
    v_permlane16_swap_b32 v20, v24
    v_permlane16_swap_b32 v21, v25
    v_permlane16_swap_b32 v22, v26
    v_permlane16_swap_b32 v23, v27
    v_add_f32 v20, v20, v24
    v_add_f32 v21, v21, v25
    v_add_f32 v22, v22, v26
    v_add_f32 v23, v23, v27
    v_mov_b32 v24, v20
    v_mov_b32 v25, v21
    v_mov_b32 v26, v22
    v_mov_b32 v27, v23
    s_nop 0
    v_permlane32_swap_b32 v20, v24
    v_permlane32_swap_b32 v21, v25
    v_permlane32_swap_b32 v22, v26
    v_permlane32_swap_b32 v23, v27
    v_add_f32 v20, v20, v24
    v_add_f32 v21, v21, v25
    v_add_f32 v22, v22, v26
    v_add_f32 v23, v23, v27
    v_cvt_pk_bf16_f32 v20, v20, v20
    v_lshlrev_b32 v20, 16, v20
    v_mul_f32 v20, v5, v20
    v_cvt_pk_bf16_f32 v20, v20, v20
    v_lshlrev_b32 v20, 16, v20
    v_add_f32 v20, v20, v84
    v_cvt_pk_bf16_f32 v20, v20, v20
    v_lshlrev_b32 v20, 16, v20
    v_mul_f32 v20, v20, v88
    v_cvt_pk_bf16_f32 v21, v21, v21
    v_lshlrev_b32 v21, 16, v21
    v_mul_f32 v21, v5, v21
    v_cvt_pk_bf16_f32 v21, v21, v21
    v_lshlrev_b32 v21, 16, v21
    v_add_f32 v21, v21, v85
    v_cvt_pk_bf16_f32 v21, v21, v21
    v_lshlrev_b32 v21, 16, v21
    v_mul_f32 v21, v21, v88
    v_cvt_pk_bf16_f32 v22, v22, v22
    v_lshlrev_b32 v22, 16, v22
    v_mul_f32 v22, v5, v22
    v_cvt_pk_bf16_f32 v22, v22, v22
    v_lshlrev_b32 v22, 16, v22
    v_add_f32 v22, v22, v86
    v_cvt_pk_bf16_f32 v22, v22, v22
    v_lshlrev_b32 v22, 16, v22
    v_mul_f32 v22, v22, v88
    v_cvt_pk_bf16_f32 v23, v23, v23
    v_lshlrev_b32 v23, 16, v23
    v_mul_f32 v23, v5, v23
    v_cvt_pk_bf16_f32 v23, v23, v23
    v_lshlrev_b32 v23, 16, v23
    v_add_f32 v23, v23, v87
    v_cvt_pk_bf16_f32 v23, v23, v23
    v_lshlrev_b32 v23, 16, v23
    v_mul_f32 v23, v23, v88
    s_lshl_b32 s3, s59, 8
    s_add_u32 s3, s3, 158976
    v_add_u32 v2, s3, v2
    ds_write_b128 v2, v[20:23]
    s_lshl_b32 s3, s59, 2
    v_add_u32 v2, s3, v12
    ds_write_b32 v2, v80 offset:64
    s_branch K_END
WP_flags:
    s_setpc_b64 s[38:39]
K_P2_FLAGS:
    s_mov_b32 exec_hi, 0
    s_waitcnt vmcnt(0)
    s_mov_b32 s3, 131072
K_P2_FCHK:
    v_cmp_eq_u32 vcc, 1, v7
    s_nop 1
    v_mov_b32 v2, vcc_lo
    ds_write_b32 v12, v2 offset:32
    s_cmp_eq_u32 vcc_lo, -1
    s_cbranch_scc1 K_P2_FGO
    s_cmp_lg_u32 vcc_lo, 0
    s_cbranch_scc1 K_P2_FS
    s_sleep 4
K_P2_FS:
    s_sleep 6
    global_load_dword v7, v10, s[10:11] sc1
    s_sub_u32 s3, s3, 1
    s_waitcnt vmcnt(0)
    s_cbranch_scc0 K_P2_FCHK
    v_mov_b32 v2, -1
    ds_write_b32 v12, v2 offset:32
K_P2_FGO:
    s_mov_b64 exec, -1
    s_branch K_END
.p2align 12
K_AUX:
    s_load_dwordx8 s[48:55], s[0:1], 32
    s_load_dwordx2 s[56:57], s[0:1], 64
    s_mul_i32 s44, s28, 7
    s_add_u32 s44, s44, s29
    s_sub_u32 s44, s44, 1
    s_cmp_lt_u32 s44, 54
    s_cselect_b32 s44, s44, 63
    s_cmp_eq_u32 s29, 0
    s_cselect_b32 s44, 63, s44
    s_lshl_b32 s74, s28, 8
    s_lshl_b32 s3, s29, 5
    s_add_u32 s74, s74, s3
    v_mov_b32 v12, 158720
    v_mov_b32 v13, 1
    s_cmp_lt_u32 s30, 4
    s_cbranch_scc1 K_AUX_LO
    s_lshl_b32 s3, s30, 3
    s_add_u32 s3, s3, s74
    s_sub_u32 s3, s3, 32
    v_lshrrev_b32 v9, 3, v1
    v_add_u32 v9, s3, v9
    v_and_b32 v11, 7, v1
    v_lshlrev_b32 v11, 4, v11
    v_mul_u32_u24 v10, 1280, v9
    v_add_u32 v10, v10, v11
    s_waitcnt lgkmcnt(0)
    buffer_load_dwordx4 v[16:19], v10, s[12:15], 0 offen offset:0
    buffer_load_dwordx4 v[20:23], v10, s[12:15], 0 offen offset:128
    buffer_load_dwordx4 v[24:27], v10, s[12:15], 0 offen offset:256
    buffer_load_dwordx4 v[28:31], v10, s[12:15], 0 offen offset:384
    buffer_load_dwordx4 v[32:35], v10, s[12:15], 0 offen offset:512
    buffer_load_dwordx4 v[36:39], v10, s[12:15], 0 offen offset:640
    buffer_load_dwordx4 v[40:43], v10, s[12:15], 0 offen offset:768
    buffer_load_dwordx4 v[44:47], v10, s[12:15], 0 offen offset:896
    buffer_load_dwordx4 v[48:51], v10, s[12:15], 0 offen offset:1024
    buffer_load_dwordx4 v[52:55], v10, s[12:15], 0 offen offset:1152
    s_mov_b32 s16, s48
    s_mov_b32 s17, s49
    s_mov_b32 s18, 0x500
    s_mov_b32 s19, 0x20000
    s_mov_b32 s20, s56
    s_mov_b32 s21, s57
    s_mov_b32 s22, 0x500
    s_mov_b32 s23, 0x20000
    buffer_load_dwordx4 v[56:59], v11, s[16:19], 0 offen offset:0
    buffer_load_dwordx4 v[60:63], v11, s[16:19], 0 offen offset:128
    buffer_load_dwordx4 v[64:67], v11, s[16:19], 0 offen offset:256
    buffer_load_dwordx4 v[68:71], v11, s[16:19], 0 offen offset:384
    buffer_load_dwordx4 v[72:75], v11, s[16:19], 0 offen offset:512
    buffer_load_dwordx4 v[76:79], v11, s[16:19], 0 offen offset:640
    buffer_load_dwordx4 v[80:83], v11, s[16:19], 0 offen offset:768
    buffer_load_dwordx4 v[84:87], v11, s[16:19], 0 offen offset:896
    buffer_load_dwordx4 v[88:91], v11, s[16:19], 0 offen offset:1024
    buffer_load_dwordx4 v[92:95], v11, s[16:19], 0 offen offset:1152
    buffer_load_dwordx4 v[96:99], v11, s[20:23], 0 offen offset:0
    buffer_load_dwordx4 v[100:103], v11, s[20:23], 0 offen offset:128
    buffer_load_dwordx4 v[104:107], v11, s[20:23], 0 offen offset:256
    buffer_load_dwordx4 v[108:111], v11, s[20:23], 0 offen offset:384
    buffer_load_dwordx4 v[112:115], v11, s[20:23], 0 offen offset:512
    buffer_load_dwordx4 v[116:119], v11, s[20:23], 0 offen offset:640
    buffer_load_dwordx4 v[120:123], v11, s[20:23], 0 offen offset:768
    buffer_load_dwordx4 v[124:127], v11, s[20:23], 0 offen offset:896
    buffer_load_dwordx4 v[128:131], v11, s[20:23], 0 offen offset:1024
    buffer_load_dwordx4 v[132:135], v11, s[20:23], 0 offen offset:1152
    s_barrier
    v_mov_b32 v180, 0
    v_mov_b32 v181, 0
    v_mov_b32 v182, 0
    v_mov_b32 v183, 0
    v_and_b32 v10, 31, v9
    v_lshlrev_b32 v10, 2, v10
    v_add_u32 v10, 122880, v10
    v_sub_u32 v4, 0x87ff, v9
    s_setprio 2
    s_waitcnt vmcnt(10)
    v_dot2c_f32_bf16 v180, v16, v56
    v_dot2c_f32_bf16 v181, v17, v57
    v_dot2c_f32_bf16 v180, v18, v58
    v_dot2c_f32_bf16 v181, v19, v59
    v_dot2c_f32_bf16 v180, v20, v60
    v_dot2c_f32_bf16 v181, v21, v61
    v_dot2c_f32_bf16 v180, v22, v62
    v_dot2c_f32_bf16 v181, v23, v63
    v_dot2c_f32_bf16 v180, v24, v64
    v_dot2c_f32_bf16 v181, v25, v65
    v_dot2c_f32_bf16 v180, v26, v66
    v_dot2c_f32_bf16 v181, v27, v67
    v_dot2c_f32_bf16 v180, v28, v68
    v_dot2c_f32_bf16 v181, v29, v69
    v_dot2c_f32_bf16 v180, v30, v70
    v_dot2c_f32_bf16 v181, v31, v71
    v_dot2c_f32_bf16 v180, v32, v72
    v_dot2c_f32_bf16 v181, v33, v73
    v_dot2c_f32_bf16 v180, v34, v74
    v_dot2c_f32_bf16 v181, v35, v75
    v_dot2c_f32_bf16 v180, v36, v76
    v_dot2c_f32_bf16 v181, v37, v77
    v_dot2c_f32_bf16 v180, v38, v78
    v_dot2c_f32_bf16 v181, v39, v79
    v_dot2c_f32_bf16 v180, v40, v80
    v_dot2c_f32_bf16 v181, v41, v81
    v_dot2c_f32_bf16 v180, v42, v82
    v_dot2c_f32_bf16 v181, v43, v83
    v_dot2c_f32_bf16 v180, v44, v84
    v_dot2c_f32_bf16 v181, v45, v85
    v_dot2c_f32_bf16 v180, v46, v86
    v_dot2c_f32_bf16 v181, v47, v87
    v_dot2c_f32_bf16 v180, v48, v88
    v_dot2c_f32_bf16 v181, v49, v89
    v_dot2c_f32_bf16 v180, v50, v90
    v_dot2c_f32_bf16 v181, v51, v91
    v_dot2c_f32_bf16 v180, v52, v92
    v_dot2c_f32_bf16 v181, v53, v93
    v_dot2c_f32_bf16 v180, v54, v94
    v_dot2c_f32_bf16 v181, v55, v95
    s_waitcnt vmcnt(0)
    v_dot2c_f32_bf16 v182, v16, v96
    v_dot2c_f32_bf16 v183, v17, v97
    v_dot2c_f32_bf16 v182, v18, v98
    v_dot2c_f32_bf16 v183, v19, v99
    v_dot2c_f32_bf16 v182, v20, v100
    v_dot2c_f32_bf16 v183, v21, v101
    v_dot2c_f32_bf16 v182, v22, v102
    v_dot2c_f32_bf16 v183, v23, v103
    v_dot2c_f32_bf16 v182, v24, v104
    v_dot2c_f32_bf16 v183, v25, v105
    v_dot2c_f32_bf16 v182, v26, v106
    v_dot2c_f32_bf16 v183, v27, v107
    v_dot2c_f32_bf16 v182, v28, v108
    v_dot2c_f32_bf16 v183, v29, v109
    v_dot2c_f32_bf16 v182, v30, v110
    v_dot2c_f32_bf16 v183, v31, v111
    v_dot2c_f32_bf16 v182, v32, v112
    v_dot2c_f32_bf16 v183, v33, v113
    v_dot2c_f32_bf16 v182, v34, v114
    v_dot2c_f32_bf16 v183, v35, v115
    v_dot2c_f32_bf16 v182, v36, v116
    v_dot2c_f32_bf16 v183, v37, v117
    v_dot2c_f32_bf16 v182, v38, v118
    v_dot2c_f32_bf16 v183, v39, v119
    v_dot2c_f32_bf16 v182, v40, v120
    v_dot2c_f32_bf16 v183, v41, v121
    v_dot2c_f32_bf16 v182, v42, v122
    v_dot2c_f32_bf16 v183, v43, v123
    v_dot2c_f32_bf16 v182, v44, v124
    v_dot2c_f32_bf16 v183, v45, v125
    v_dot2c_f32_bf16 v182, v46, v126
    v_dot2c_f32_bf16 v183, v47, v127
    v_dot2c_f32_bf16 v182, v48, v128
    v_dot2c_f32_bf16 v183, v49, v129
    v_dot2c_f32_bf16 v182, v50, v130
    v_dot2c_f32_bf16 v183, v51, v131
    v_dot2c_f32_bf16 v182, v52, v132
    v_dot2c_f32_bf16 v183, v53, v133
    v_dot2c_f32_bf16 v182, v54, v134
    v_dot2c_f32_bf16 v183, v55, v135
    s_nop 2
    v_add_f32 v180, v180, v181
    v_add_f32 v182, v182, v183
    s_nop 0
    v_add_f32_dpp v180, v180, v180 quad_perm:[1,0,3,2] row_mask:0xf bank_mask:0xf
    v_add_f32_dpp v182, v182, v182 quad_perm:[1,0,3,2] row_mask:0xf bank_mask:0xf
    s_nop 0
    v_add_f32_dpp v180, v180, v180 quad_perm:[2,3,0,1] row_mask:0xf bank_mask:0xf
    v_add_f32_dpp v182, v182, v182 quad_perm:[2,3,0,1] row_mask:0xf bank_mask:0xf
    s_nop 0
    v_add_f32_dpp v180, v180, v180 row_half_mirror row_mask:0xf bank_mask:0xf
    v_add_f32_dpp v182, v182, v182 row_half_mirror row_mask:0xf bank_mask:0xf
    v_cvt_pk_bf16_f32 v2, v180, v180
    v_lshlrev_b32 v2, 16, v2
    v_ashrrev_i32 v3, 31, v2
    v_or_b32 v3, 0x80000000, v3
    v_xor_b32 v2, v2, v3
    v_and_b32 v2, 0xffff0000, v2
    v_or_b32 v2, v2, v4
    ds_write2_b32 v10, v2, v182 offset0:0 offset1:32
    s_mov_b64 exec, 1
    ds_add_u32 v12, v13 offset:36
    s_mov_b64 exec, -1
    s_setprio 0
    s_cmp_lg_u32 s30, 4
    s_cbranch_scc1 K_WARMA0
    s_call_b64 s[38:39], WP_p2g
    s_branch K_WARMAX
K_WARMA0:
    s_cmp_lg_u32 s30, 5
    s_cbranch_scc1 K_WARMA1
    s_call_b64 s[38:39], WP_gen
    s_branch K_WARMAX
K_WARMA1:
    s_cmp_lg_u32 s30, 6
    s_cbranch_scc1 K_WARMA2
    s_call_b64 s[38:39], WP_help
    s_call_b64 s[38:39], WP_flags
    s_branch K_WARMAX
K_WARMA2:
    s_call_b64 s[38:39], WP_spin
K_WARMAX:
    s_cmp_ge_u32 s30, 6
    s_cselect_b32 s44, 63, s44
    s_cmp_lg_u32 s44, 63
    s_cbranch_scc1 K_FFN_C
    s_mov_b32 s3, 1048576
K_FGH:
    ds_read_b32 v2, v12 offset:48
    s_sleep 8
    s_sub_u32 s3, s3, 1
    s_waitcnt lgkmcnt(0)
    v_readfirstlane_b32 s33, v2
    s_nop 3
    s_cselect_b32 s33, 1, s33
    s_cmp_lt_u32 s33, 1
    s_cbranch_scc1 K_FGH
    s_cmp_eq_u32 s30, 6
    s_cbranch_scc1 K_P2_HELP
    v_mov_b32 v7, 1
    s_branch K_P2_HELP
K_AUX_LO:
    s_waitcnt lgkmcnt(0)
    s_cmp_eq_u32 s30, 0
    s_cbranch_scc1 K_AUX_PUB
    s_cmp_eq_u32 s44, 63
    s_cbranch_scc1 K_AUX_NOF
    s_and_b32 s3, s44, 1
    s_cmp_eq_u32 s3, 0
    s_cselect_b64 s[60:61], s[50:51], s[52:53]
    s_cselect_b64 s[64:65], s[52:53], s[50:51]
    s_cselect_b32 s75, 0, 40960
    s_mov_b32 s62, 0x21c000
    s_mov_b32 s63, 0x20000
    s_mov_b32 s66, 0x21c000
    s_mov_b32 s67, 0x20000
    v_lshrrev_b32 v2, 2, v1
    v_mul_u32_u24 v184, 3456, v2
    v_and_b32 v2, 3, v1
    v_lshl_add_u32 v184, v2, 4, v184
    s_lshl_b32 s72, s44, 6
    v_add_u32 v184, s72, v184
    s_sub_u32 s74, s30, 1
K_FSA0:
    s_lshl_b32 s73, s74, 10
    s_mul_i32 s72, s74, 55296
    s_add_u32 m0, s73, s75
    s_waitcnt vmcnt(5)
    buffer_load_dwordx4 v184, s[60:63], s72 offen lds
    s_add_u32 s74, s74, 3
    s_cmp_lt_u32 s74, 18
    s_cbranch_scc1 K_FSA0
    s_barrier
K_FSA:
    s_lshl_b32 s73, s74, 10
    s_mul_i32 s72, s74, 55296
    s_add_u32 m0, s73, s75
    s_waitcnt vmcnt(5)
    buffer_load_dwordx4 v184, s[60:63], s72 offen lds
    s_add_u32 s74, s74, 3
    s_cmp_lt_u32 s74, 40
    s_cbranch_scc1 K_FSA
    s_sub_u32 s74, s74, 40
    s_xor_b32 s75, s75, 40960
    s_mov_b32 s68, s54
    s_mov_b32 s69, s55
    s_mov_b32 s70, 0x21c000
    s_mov_b32 s71, 0x20000
    s_mul_i32 s3, s44, 40960
    v_lshrrev_b32 v2, 3, v1
    v_mul_u32_u24 v2, 1280, v2
    v_lshrrev_b32 v3, 4, v1
    v_lshlrev_b32 v3, 1, v3
    v_and_b32 v4, 7, v1
    v_xor_b32 v3, v3, v4
    v_lshl_add_u32 v2, v3, 4, v2
    v_add_u32 v185, s3, v2
K_FSB:
    s_lshl_b32 s73, s74, 10
    s_mul_i32 s72, s74, 55296
    s_add_u32 m0, s73, s75
    s_waitcnt vmcnt(5)
    buffer_load_dwordx4 v184, s[64:67], s72 offen lds
    s_add_u32 s74, s74, 3
    s_cmp_lt_u32 s74, 40
    s_cbranch_scc1 K_FSB
    s_sub_u32 s74, s74, 40
    s_mov_b32 s75, 81920
K_FSD0:
    s_lshl_b32 s73, s74, 10
    s_and_b32 s72, s74, 3
    s_mul_i32 s72, s72, 10208
    s_lshl_b32 s3, s74, 5
    s_add_u32 s72, s72, s3
    s_add_u32 m0, s73, s75
    s_waitcnt vmcnt(5)
    buffer_load_dwordx4 v185, s[68:71], s72 offen lds
    s_add_u32 s74, s74, 3
    s_cmp_lt_u32 s74, 18
    s_cbranch_scc1 K_FSD0
    s_waitcnt vmcnt(6)
    s_mov_b64 exec, 1
    ds_add_u32 v12, v13 offset:56
    s_mov_b64 exec, -1
K_FSD:
    s_lshl_b32 s73, s74, 10
    s_and_b32 s72, s74, 3
    s_mul_i32 s72, s72, 10208
    s_lshl_b32 s3, s74, 5
    s_add_u32 s72, s72, s3
    s_add_u32 m0, s73, s75
    s_waitcnt vmcnt(5)
    buffer_load_dwordx4 v185, s[68:71], s72 offen lds
    s_add_u32 s74, s74, 3
    s_cmp_lt_u32 s74, 40
    s_cbranch_scc1 K_FSD
    s_mul_i32 s3, s29, 96
    s_lshl_b32 s72, s30, 5
    s_add_u32 s3, s3, s72
    s_sub_u32 s3, s3, 128
    v_lshrrev_b32 v2, 1, v1
    v_add_u32 v2, s3, v2
    v_mul_u32_u24 v2, 1280, v2
    v_and_b32 v3, 1, v1
    v_lshl_add_u32 v2, v3, 7, v2
    buffer_load_dword v6, v2, s[24:27], 0 offen offset:1024
K_AUX_WR:
    s_mov_b32 s3, 1048576
K_FGR:
    ds_read_b32 v2, v12 offset:60
    s_sleep 2
    s_sub_u32 s3, s3, 1
    s_waitcnt lgkmcnt(0)
    v_readfirstlane_b32 s33, v2
    s_nop 3
    s_cselect_b32 s33, 2, s33
    s_cmp_lt_u32 s33, 2
    s_cbranch_scc1 K_FGR
    s_branch K_P2
K_AUX_NOF:
    s_cmp_lg_u32 s2, 63
    s_cbranch_scc1 K_AUX_NOZ
    s_cmp_lg_u32 s30, 1
    s_cbranch_scc1 K_AUX_NOZ
    s_add_u32 s60, s10, 0x80000
    s_addc_u32 s61, s11, 0
    s_mov_b32 s62, 0xc000
    s_mov_b32 s63, 0x20000
    s_barrier
    s_mov_b32 s3, 1048576
K_FGZ:
    ds_read_b32 v2, v12 offset:36
    s_sleep 2
    s_sub_u32 s3, s3, 1
    s_waitcnt lgkmcnt(0)
    v_readfirstlane_b32 s33, v2
    s_nop 3
    s_cselect_b32 s33, 4, s33
    s_cmp_lt_u32 s33, 4
    s_cbranch_scc1 K_FGZ
    v_and_b32 v4, 7, v1
    v_lshlrev_b32 v4, 2, v4
    s_mov_b32 s3, 131072
K_ZPOLL4:
    v_cmp_eq_u32 vcc, 0, v7
    s_cbranch_vccz K_ZOK4
    s_sub_u32 s3, s3, 1
    s_cbranch_scc1 K_ZOK4
    global_load_dword v7, v4, s[8:9] offset:192 sc1
    s_waitcnt vmcnt(0)
    s_branch K_ZPOLL4
K_ZOK4:
    v_lshlrev_b32 v4, 3, v1
    s_mov_b32 s72, 43008
    s_mov_b32 s3, 131072
    s_setprio 3
K_AGG_POLL:
    buffer_load_dwordx2 v[176:177], v4, s[60:63], s72 offen sc1
    s_waitcnt vmcnt(0)
    v_min_u32 v2, v176, v177
    v_cmp_eq_u32 vcc, 0, v2
    s_cbranch_vccz K_AGG_GOT
    s_sleep 2
    s_sub_u32 s3, s3, 1
    s_cmp_lg_u32 s3, 0
    s_cbranch_scc1 K_AGG_POLL
K_AGG_GOT:
    s_nop 1
    v_max_u32_dpp v3, v176, v176 quad_perm:[1,0,3,2] row_mask:0xf bank_mask:0xf
    s_nop 1
    v_max_u32_dpp v3, v3, v3 quad_perm:[2,3,0,1] row_mask:0xf bank_mask:0xf
    s_nop 1
    v_max_u32_dpp v3, v3, v3 row_half_mirror row_mask:0xf bank_mask:0xf
    s_nop 1
    v_max_u32_dpp v3, v3, v3 row_mirror row_mask:0xf bank_mask:0xf
    s_nop 1
    v_readlane_b32 s74, v3, 0
    v_readlane_b32 s76, v3, 16
    v_readlane_b32 s77, v3, 32
    v_readlane_b32 s78, v3, 48
    s_nop 3
    s_max_u32 s74, s74, s76
    s_max_u32 s77, s77, s78
    s_max_u32 s74, s74, s77
    v_cmp_ne_u32 vcc, s74, v176
    s_nop 1
    v_cndmask_b32 v2, v177, v176, vcc
    s_nop 1
    v_max_u32_dpp v3, v2, v2 quad_perm:[1,0,3,2] row_mask:0xf bank_mask:0xf
    s_nop 1
    v_max_u32_dpp v3, v3, v3 quad_perm:[2,3,0,1] row_mask:0xf bank_mask:0xf
    s_nop 1
    v_max_u32_dpp v3, v3, v3 row_half_mirror row_mask:0xf bank_mask:0xf
    s_nop 1
    v_max_u32_dpp v3, v3, v3 row_mirror row_mask:0xf bank_mask:0xf
    s_nop 1
    v_readlane_b32 s75, v3, 0
    v_readlane_b32 s76, v3, 16
    v_readlane_b32 s77, v3, 32
    v_readlane_b32 s78, v3, 48
    s_nop 3
    s_max_u32 s75, s75, s76
    s_max_u32 s77, s77, s78
    s_max_u32 s75, s75, s77
    v_mov_b32 v176, s74
    v_mov_b32 v177, s75
    s_mov_b32 s62, 40960
    v_lshlrev_b32 v3, 8, v1
    s_mov_b32 s3, 0
    buffer_store_dwordx2 v[176:177], v3, s[60:63], s3 offen offset:128 sc1
    s_mov_b32 s3, 16384
    buffer_store_dwordx2 v[176:177], v3, s[60:63], s3 offen offset:128 sc1
    s_mov_b32 s3, 32768
    buffer_store_dwordx2 v[176:177], v3, s[60:63], s3 offen offset:128 sc1
    s_setprio 0
    s_branch K_AUX_NOK
K_AUX_NOZ:
    s_barrier
K_AUX_NOK:
    s_mov_b32 s3, 1048576
K_FGWD:
    ds_read_b32 v2, v12 offset:48
    s_sleep 4
    s_sub_u32 s3, s3, 1
    s_waitcnt lgkmcnt(0)
    v_readfirstlane_b32 s33, v2
    s_nop 3
    s_cselect_b32 s33, 1, s33
    s_cmp_lt_u32 s33, 1
    s_cbranch_scc1 K_FGWD
    s_branch K_P2
K_AUX_PUB:
    s_add_u32 s60, s10, 0x1000
    s_addc_u32 s61, s11, 0
    s_mov_b32 s62, 0x2000
    s_mov_b32 s63, 0x20000
    v_and_b32 v3, 31, v1
    v_lshlrev_b32 v10, 2, v3
    v_add_u32 v11, 122880, v10
    s_lshl_b32 s72, s74, 2
    s_lshl_b32 s3, s2, 3
    s_add_u32 s3, s3, 567296
    v_mov_b32 v9, s3
    v_and_b32 v5, 7, v1
    v_lshlrev_b32 v5, 2, v5
    s_barrier
    s_setprio 3
    s_mov_b32 s3, 1048576
K_FGRT:
    ds_read_b32 v2, v12 offset:36
    s_sleep 0
    s_sub_u32 s3, s3, 1
    s_waitcnt lgkmcnt(0)
    v_readfirstlane_b32 s33, v2
    s_nop 3
    s_cselect_b32 s33, 4, s33
    s_cmp_lt_u32 s33, 4
    s_cbranch_scc1 K_FGRT
    ds_read2_b32 v[176:177], v11 offset0:0 offset1:32
    global_load_dword v7, v5, s[8:9] offset:192 sc1
    s_waitcnt lgkmcnt(0)
    v_cvt_pk_bf16_f32 v177, v177, v177
    v_lshlrev_b32 v177, 16, v177
    v_mul_f32 v5, 0xbfb8aa3b, v177
    v_exp_f32 v5, v5
    s_nop 0
    v_add_f32 v5, 1.0, v5
    v_rcp_f32 v177, v5
    s_nop 0
    v_cvt_pk_bf16_f32 v177, v177, v177
    v_lshlrev_b32 v177, 16, v177
    s_mov_b32 exec_hi, 0
    buffer_store_dword v177, v10, s[60:63], s72 offen sc1
    s_mov_b64 exec, -1
    s_nop 1
    v_max_u32_dpp v3, v176, v176 quad_perm:[1,0,3,2] row_mask:0xf bank_mask:0xf
    s_nop 1
    v_max_u32_dpp v3, v3, v3 quad_perm:[2,3,0,1] row_mask:0xf bank_mask:0xf
    s_nop 1
    v_max_u32_dpp v3, v3, v3 row_half_mirror row_mask:0xf bank_mask:0xf
    s_nop 1
    v_max_u32_dpp v3, v3, v3 row_mirror row_mask:0xf bank_mask:0xf
    s_nop 1
    v_readlane_b32 s74, v3, 0
    v_readlane_b32 s76, v3, 16
    v_readlane_b32 s77, v3, 32
    v_readlane_b32 s78, v3, 48
    s_nop 3
    s_max_u32 s74, s74, s76
    s_max_u32 s77, s77, s78
    s_max_u32 s74, s74, s77
    v_cmp_ne_u32 vcc, s74, v176
    s_nop 1
    v_cndmask_b32 v176, 0, v176, vcc
    s_nop 1
    v_max_u32_dpp v3, v176, v176 quad_perm:[1,0,3,2] row_mask:0xf bank_mask:0xf
    s_nop 1
    v_max_u32_dpp v3, v3, v3 quad_perm:[2,3,0,1] row_mask:0xf bank_mask:0xf
    s_nop 1
    v_max_u32_dpp v3, v3, v3 row_half_mirror row_mask:0xf bank_mask:0xf
    s_nop 1
    v_max_u32_dpp v3, v3, v3 row_mirror row_mask:0xf bank_mask:0xf
    s_nop 1
    v_readlane_b32 s75, v3, 0
    v_readlane_b32 s76, v3, 16
    v_readlane_b32 s77, v3, 32
    v_readlane_b32 s78, v3, 48
    s_nop 3
    s_max_u32 s75, s75, s76
    s_max_u32 s77, s77, s78
    s_max_u32 s75, s75, s77
    v_mov_b32 v176, s74
    v_mov_b32 v177, s75
    s_waitcnt vmcnt(0)
    v_and_b32 v4, 7, v1
    v_lshlrev_b32 v4, 2, v4
    s_mov_b32 s3, 131072
K_ZPOLL3:
    v_cmp_eq_u32 vcc, 0, v7
    s_cbranch_vccz K_ZOK3
    s_sub_u32 s3, s3, 1
    s_cbranch_scc1 K_ZOK3
    global_load_dword v7, v4, s[8:9] offset:192 sc1
    s_waitcnt vmcnt(0)
    s_branch K_ZPOLL3
K_ZOK3:
    s_mov_b64 exec, 1
    global_store_dwordx2 v9, v[176:177], s[10:11] sc1
    s_mov_b64 exec, -1
    v_and_b32 v3, 1, v1
    v_lshl_add_u32 v3, v3, 2, s42
    v_lshlrev_b32 v10, 4, v1
    s_mov_b32 s3, 131072
K_AUX_POLL:
    s_sleep 6
    global_load_dword v2, v3, s[10:11] offset:128 sc1
    s_waitcnt vmcnt(0)
    v_cmp_eq_u32 vcc, 0, v2
    s_cbranch_vccz K_AUX_GOT
    s_sub_u32 s3, s3, 1
    s_cmp_lg_u32 s3, 0
    s_cbranch_scc1 K_AUX_POLL
K_AUX_GOT:
    v_readlane_b32 s74, v2, 0
    v_readlane_b32 s75, v2, 1
    s_nop 3
    s_and_b32 s74, s74, 0x7ff
    s_sub_u32 s74, 2047, s74
    s_mul_i32 s74, s74, 1280
    s_mov_b32 m0, 125184
    s_nop 0
    buffer_load_dwordx4 v10, s[12:15], s74 offen lds
    s_mov_b64 exec, 0xffff
    buffer_load_dwordx4 v10, s[12:15], s74 offen offset:1024 lds
    s_mov_b64 exec, -1
    s_and_b32 s75, s75, 0x7ff
    s_sub_u32 s75, 2047, s75
    s_mul_i32 s75, s75, 1280
    s_mov_b32 m0, 126528
    s_nop 0
    buffer_load_dwordx4 v10, s[12:15], s75 offen lds
    s_mov_b64 exec, 0xffff
    buffer_load_dwordx4 v10, s[12:15], s75 offen offset:1024 lds
    s_mov_b64 exec, -1
    s_waitcnt vmcnt(0)
    ds_write_b32 v12, v13 offset:48
    s_setprio 0
    s_branch K_P2
.p2align 12
K_FFN_C:
    s_add_u32 s64, s10, 0x10000
    s_addc_u32 s65, s11, 0
    s_mov_b32 s66, 0x43800
    s_mov_b32 s67, 0x20000
    s_and_b32 s73, s30, 1
    v_lshrrev_b32 v232, 4, v1
    v_bfe_u32 v4, v1, 2, 2
    v_lshl_add_u32 v2, v232, 3, v4
    v_and_b32 v3, 3, v1
    v_lshlrev_b32 v3, 3, v3
    v_lshl_add_u32 v233, v2, 6, v3
    s_lshl_b32 s72, s73, 5
    v_add_u32 v233, s72, v233
    v_lshl_add_u32 v2, v232, 2, v4
    v_bfe_u32 v4, v2, 1, 2
    v_lshl_add_u32 v3, v2, 7, v3
    v_lshl_add_u32 v3, v4, 5, v3
    s_mul_i32 s3, s73, 20480
    s_add_u32 s3, s3, 81920
    v_add_u32 v238, s3, v3
    v_xor_b32 v239, 32, v238
    v_xor_b32 v240, 64, v238
    v_xor_b32 v241, 96, v238
    v_and_b32 v2, 1, v1
    v_mul_u32_u24 v234, 1344, v2
    v_lshl_add_u32 v234, v232, 4, v234
    v_add_u32 v234, 125184, v234
    v_lshlrev_b32 v236, 4, v1
    v_add_u32 v236, 124160, v236
    s_lshl_b32 s3, s73, 3
    v_add_u32 v235, s3, v236
    v_mul_u32_u24 v2, 2560, v2
    v_lshl_add_u32 v237, v232, 4, v2
    s_mul_i32 s3, s44, 5120
    s_mul_i32 s72, s73, 1280
    s_add_u32 s72, s72, s3
    v_lshlrev_b32 v2, 4, v1
    buffer_store_dwordx4 v[16:19], v2, s[64:67], s72 offen offset:0 sc1
    buffer_store_dwordx4 v[16:19], v2, s[64:67], s72 offen offset:2560 sc1
    s_mov_b64 exec, 0xffff
    buffer_store_dwordx4 v[16:19], v2, s[64:67], s72 offen offset:1024 sc1
    buffer_store_dwordx4 v[16:19], v2, s[64:67], s72 offen offset:3584 sc1
    s_mov_b64 exec, -1
    v_add_u32 v5, 40960, v233
    s_mov_b32 s3, 1048576
K_FGD:
    ds_read_b32 v2, v12 offset:56
    s_sleep 2
    s_sub_u32 s3, s3, 1
    s_waitcnt lgkmcnt(0)
    v_readfirstlane_b32 s33, v2
    s_nop 3
    s_cselect_b32 s33, 3, s33
    s_cmp_lt_u32 s33, 3
    s_cbranch_scc1 K_FGD
    s_setprio 3
    ds_read_b64_tr_b16 v[16:17], v233 offset:0
    ds_read_b64_tr_b16 v[18:19], v233 offset:256
    ds_read_b64_tr_b16 v[20:21], v233 offset:2048
    ds_read_b64_tr_b16 v[22:23], v233 offset:2304
    ds_read_b64_tr_b16 v[24:25], v233 offset:4096
    ds_read_b64_tr_b16 v[26:27], v233 offset:4352
    ds_read_b64_tr_b16 v[28:29], v233 offset:6144
    ds_read_b64_tr_b16 v[30:31], v233 offset:6400
    ds_read_b64_tr_b16 v[32:33], v233 offset:8192
    ds_read_b64_tr_b16 v[34:35], v233 offset:8448
    ds_read_b64_tr_b16 v[36:37], v233 offset:10240
    ds_read_b64_tr_b16 v[38:39], v233 offset:10496
    ds_read_b64_tr_b16 v[40:41], v233 offset:12288
    ds_read_b64_tr_b16 v[42:43], v233 offset:12544
    ds_read_b64_tr_b16 v[44:45], v233 offset:14336
    ds_read_b64_tr_b16 v[46:47], v233 offset:14592
    ds_read_b64_tr_b16 v[48:49], v233 offset:16384
    ds_read_b64_tr_b16 v[50:51], v233 offset:16640
    ds_read_b64_tr_b16 v[52:53], v233 offset:18432
    ds_read_b64_tr_b16 v[54:55], v233 offset:18688
    ds_read_b64_tr_b16 v[56:57], v233 offset:20480
    ds_read_b64_tr_b16 v[58:59], v233 offset:20736
    ds_read_b64_tr_b16 v[60:61], v233 offset:22528
    ds_read_b64_tr_b16 v[62:63], v233 offset:22784
    ds_read_b64_tr_b16 v[64:65], v233 offset:24576
    ds_read_b64_tr_b16 v[66:67], v233 offset:24832
    ds_read_b64_tr_b16 v[68:69], v233 offset:26624
    ds_read_b64_tr_b16 v[70:71], v233 offset:26880
    ds_read_b64_tr_b16 v[72:73], v233 offset:28672
    ds_read_b64_tr_b16 v[74:75], v233 offset:28928
    ds_read_b64_tr_b16 v[76:77], v233 offset:30720
    ds_read_b64_tr_b16 v[78:79], v233 offset:30976
    ds_read_b64_tr_b16 v[80:81], v233 offset:32768
    ds_read_b64_tr_b16 v[82:83], v233 offset:33024
    ds_read_b64_tr_b16 v[84:85], v233 offset:34816
    ds_read_b64_tr_b16 v[86:87], v233 offset:35072
    ds_read_b64_tr_b16 v[88:89], v233 offset:36864
    ds_read_b64_tr_b16 v[90:91], v233 offset:37120
    ds_read_b64_tr_b16 v[92:93], v233 offset:38912
    ds_read_b64_tr_b16 v[94:95], v233 offset:39168
    ds_read_b64_tr_b16 v[96:97], v5 offset:0
    ds_read_b64_tr_b16 v[98:99], v5 offset:256
    ds_read_b64_tr_b16 v[100:101], v5 offset:2048
    ds_read_b64_tr_b16 v[102:103], v5 offset:2304
    ds_read_b64_tr_b16 v[104:105], v5 offset:4096
    ds_read_b64_tr_b16 v[106:107], v5 offset:4352
    ds_read_b64_tr_b16 v[108:109], v5 offset:6144
    ds_read_b64_tr_b16 v[110:111], v5 offset:6400
    ds_read_b64_tr_b16 v[112:113], v5 offset:8192
    ds_read_b64_tr_b16 v[114:115], v5 offset:8448
    ds_read_b64_tr_b16 v[116:117], v5 offset:10240
    ds_read_b64_tr_b16 v[118:119], v5 offset:10496
    ds_read_b64_tr_b16 v[120:121], v5 offset:12288
    ds_read_b64_tr_b16 v[122:123], v5 offset:12544
    ds_read_b64_tr_b16 v[124:125], v5 offset:14336
    ds_read_b64_tr_b16 v[126:127], v5 offset:14592
    ds_read_b64_tr_b16 v[128:129], v5 offset:16384
    ds_read_b64_tr_b16 v[130:131], v5 offset:16640
    ds_read_b64_tr_b16 v[132:133], v5 offset:18432
    ds_read_b64_tr_b16 v[134:135], v5 offset:18688
    ds_read_b64_tr_b16 v[136:137], v5 offset:20480
    ds_read_b64_tr_b16 v[138:139], v5 offset:20736
    ds_read_b64_tr_b16 v[140:141], v5 offset:22528
    ds_read_b64_tr_b16 v[142:143], v5 offset:22784
    ds_read_b64_tr_b16 v[144:145], v5 offset:24576
    ds_read_b64_tr_b16 v[146:147], v5 offset:24832
    ds_read_b64_tr_b16 v[148:149], v5 offset:26624
    ds_read_b64_tr_b16 v[150:151], v5 offset:26880
    ds_read_b64_tr_b16 v[152:153], v5 offset:28672
    ds_read_b64_tr_b16 v[154:155], v5 offset:28928
    ds_read_b64_tr_b16 v[156:157], v5 offset:30720
    ds_read_b64_tr_b16 v[158:159], v5 offset:30976
    ds_read_b64_tr_b16 v[160:161], v5 offset:32768
    ds_read_b64_tr_b16 v[162:163], v5 offset:33024
    ds_read_b64_tr_b16 v[164:165], v5 offset:34816
    ds_read_b64_tr_b16 v[166:167], v5 offset:35072
    ds_read_b64_tr_b16 v[168:169], v5 offset:36864
    ds_read_b64_tr_b16 v[170:171], v5 offset:37120
    ds_read_b64_tr_b16 v[172:173], v5 offset:38912
    ds_read_b64_tr_b16 v[174:175], v5 offset:39168
    s_waitcnt vmcnt(0) lgkmcnt(0)
    s_mov_b64 exec, 1
    ds_add_u32 v12, v13 offset:60
    s_mov_b64 exec, -1
    s_mov_b32 s3, 1048576
K_FGK:
    ds_read_b32 v2, v12 offset:48
    s_sleep 1
    s_sub_u32 s3, s3, 1
    s_waitcnt lgkmcnt(0)
    v_readfirstlane_b32 s33, v2
    s_nop 3
    s_cselect_b32 s33, 1, s33
    s_cmp_lt_u32 s33, 1
    s_cbranch_scc1 K_FGK
    ds_read_b128 v[188:191], v234 offset:0
    ds_read_b128 v[192:195], v234 offset:64
    ds_read_b128 v[196:199], v234 offset:128
    ds_read_b128 v[200:203], v234 offset:192
    ds_read_b128 v[204:207], v234 offset:256
    ds_read_b128 v[208:211], v234 offset:320
    ds_read_b128 v[212:215], v234 offset:384
    ds_read_b128 v[216:219], v234 offset:448
    s_waitcnt lgkmcnt(7)
    v_mfma_f32_16x16x32_bf16 v[220:223], v[16:19], v[188:191], 0
    v_mfma_f32_16x16x32_bf16 v[224:227], v[96:99], v[188:191], 0
    ds_read_b128 v[188:191], v234 offset:512
    s_waitcnt lgkmcnt(7)
    v_mfma_f32_16x16x32_bf16 v[220:223], v[20:23], v[192:195], v[220:223]
    v_mfma_f32_16x16x32_bf16 v[224:227], v[100:103], v[192:195], v[224:227]
    ds_read_b128 v[192:195], v234 offset:576
    s_waitcnt lgkmcnt(7)
    v_mfma_f32_16x16x32_bf16 v[220:223], v[24:27], v[196:199], v[220:223]
    v_mfma_f32_16x16x32_bf16 v[224:227], v[104:107], v[196:199], v[224:227]
    ds_read_b128 v[196:199], v234 offset:640
    s_waitcnt lgkmcnt(7)
    v_mfma_f32_16x16x32_bf16 v[220:223], v[28:31], v[200:203], v[220:223]
    v_mfma_f32_16x16x32_bf16 v[224:227], v[108:111], v[200:203], v[224:227]
    ds_read_b128 v[200:203], v234 offset:704
    s_waitcnt lgkmcnt(7)
    v_mfma_f32_16x16x32_bf16 v[220:223], v[32:35], v[204:207], v[220:223]
    v_mfma_f32_16x16x32_bf16 v[224:227], v[112:115], v[204:207], v[224:227]
    ds_read_b128 v[204:207], v234 offset:768
    s_waitcnt lgkmcnt(7)
    v_mfma_f32_16x16x32_bf16 v[220:223], v[36:39], v[208:211], v[220:223]
    v_mfma_f32_16x16x32_bf16 v[224:227], v[116:119], v[208:211], v[224:227]
    ds_read_b128 v[208:211], v234 offset:832
    s_waitcnt lgkmcnt(7)
    v_mfma_f32_16x16x32_bf16 v[220:223], v[40:43], v[212:215], v[220:223]
    v_mfma_f32_16x16x32_bf16 v[224:227], v[120:123], v[212:215], v[224:227]
    ds_read_b128 v[212:215], v234 offset:896
    s_waitcnt lgkmcnt(7)
    v_mfma_f32_16x16x32_bf16 v[220:223], v[44:47], v[216:219], v[220:223]
    v_mfma_f32_16x16x32_bf16 v[224:227], v[124:127], v[216:219], v[224:227]
    ds_read_b128 v[216:219], v234 offset:960
    s_waitcnt lgkmcnt(7)
    v_mfma_f32_16x16x32_bf16 v[220:223], v[48:51], v[188:191], v[220:223]
    v_mfma_f32_16x16x32_bf16 v[224:227], v[128:131], v[188:191], v[224:227]
    ds_read_b128 v[188:191], v234 offset:1024
    s_waitcnt lgkmcnt(7)
    v_mfma_f32_16x16x32_bf16 v[220:223], v[52:55], v[192:195], v[220:223]
    v_mfma_f32_16x16x32_bf16 v[224:227], v[132:135], v[192:195], v[224:227]
    ds_read_b128 v[192:195], v234 offset:1088
    s_waitcnt lgkmcnt(7)
    v_mfma_f32_16x16x32_bf16 v[220:223], v[56:59], v[196:199], v[220:223]
    v_mfma_f32_16x16x32_bf16 v[224:227], v[136:139], v[196:199], v[224:227]
    ds_read_b128 v[196:199], v234 offset:1152
    s_waitcnt lgkmcnt(7)
    v_mfma_f32_16x16x32_bf16 v[220:223], v[60:63], v[200:203], v[220:223]
    v_mfma_f32_16x16x32_bf16 v[224:227], v[140:143], v[200:203], v[224:227]
    ds_read_b128 v[200:203], v234 offset:1216
    s_waitcnt lgkmcnt(7)
    v_mfma_f32_16x16x32_bf16 v[220:223], v[64:67], v[204:207], v[220:223]
    v_mfma_f32_16x16x32_bf16 v[224:227], v[144:147], v[204:207], v[224:227]
    s_waitcnt lgkmcnt(6)
    v_mfma_f32_16x16x32_bf16 v[220:223], v[68:71], v[208:211], v[220:223]
    v_mfma_f32_16x16x32_bf16 v[224:227], v[148:151], v[208:211], v[224:227]
    s_waitcnt lgkmcnt(5)
    v_mfma_f32_16x16x32_bf16 v[220:223], v[72:75], v[212:215], v[220:223]
    v_mfma_f32_16x16x32_bf16 v[224:227], v[152:155], v[212:215], v[224:227]
    s_waitcnt lgkmcnt(4)
    v_mfma_f32_16x16x32_bf16 v[220:223], v[76:79], v[216:219], v[220:223]
    v_mfma_f32_16x16x32_bf16 v[224:227], v[156:159], v[216:219], v[224:227]
    s_waitcnt lgkmcnt(3)
    v_mfma_f32_16x16x32_bf16 v[220:223], v[80:83], v[188:191], v[220:223]
    v_mfma_f32_16x16x32_bf16 v[224:227], v[160:163], v[188:191], v[224:227]
    s_waitcnt lgkmcnt(2)
    v_mfma_f32_16x16x32_bf16 v[220:223], v[84:87], v[192:195], v[220:223]
    v_mfma_f32_16x16x32_bf16 v[224:227], v[164:167], v[192:195], v[224:227]
    s_waitcnt lgkmcnt(1)
    v_mfma_f32_16x16x32_bf16 v[220:223], v[88:91], v[196:199], v[220:223]
    v_mfma_f32_16x16x32_bf16 v[224:227], v[168:171], v[196:199], v[224:227]
    s_waitcnt lgkmcnt(0)
    v_mfma_f32_16x16x32_bf16 v[220:223], v[92:95], v[200:203], v[220:223]
    v_mfma_f32_16x16x32_bf16 v[224:227], v[172:175], v[200:203], v[224:227]
    s_mov_b32 s3, 1048576
K_FGDN:
    ds_read_b32 v2, v12 offset:52
    s_sleep 1
    s_sub_u32 s3, s3, 1
    s_waitcnt lgkmcnt(0)
    v_readfirstlane_b32 s33, v2
    s_nop 3
    s_cselect_b32 s33, 3, s33
    s_cmp_lt_u32 s33, 3
    s_cbranch_scc1 K_FGDN
    ds_read_b64_tr_b16 v[16:17], v238 offset:0
    ds_read_b64_tr_b16 v[18:19], v238 offset:2048
    ds_read_b64_tr_b16 v[20:21], v239 offset:0
    ds_read_b64_tr_b16 v[22:23], v239 offset:2048
    ds_read_b64_tr_b16 v[24:25], v240 offset:0
    ds_read_b64_tr_b16 v[26:27], v240 offset:2048
    ds_read_b64_tr_b16 v[28:29], v241 offset:0
    ds_read_b64_tr_b16 v[30:31], v241 offset:2048
    ds_read_b64_tr_b16 v[32:33], v238 offset:4096
    ds_read_b64_tr_b16 v[34:35], v238 offset:6144
    ds_read_b64_tr_b16 v[36:37], v239 offset:4096
    ds_read_b64_tr_b16 v[38:39], v239 offset:6144
    ds_read_b64_tr_b16 v[40:41], v240 offset:4096
    ds_read_b64_tr_b16 v[42:43], v240 offset:6144
    v_cvt_pk_bf16_f32 v221, v220, v221
    v_lshlrev_b32 v220, 16, v221
    v_and_b32 v221, 0xffff0000, v221
    v_cvt_pk_bf16_f32 v223, v222, v223
    v_lshlrev_b32 v222, 16, v223
    v_and_b32 v223, 0xffff0000, v223
    v_cvt_pk_bf16_f32 v225, v224, v225
    v_lshlrev_b32 v224, 16, v225
    v_and_b32 v225, 0xffff0000, v225
    v_cvt_pk_bf16_f32 v227, v226, v227
    v_lshlrev_b32 v226, 16, v227
    v_and_b32 v227, 0xffff0000, v227
    v_mul_f32 v188, 0xbfb8aa3b, v220
    v_mul_f32 v189, 0xbfb8aa3b, v221
    v_mul_f32 v190, 0xbfb8aa3b, v222
    v_mul_f32 v191, 0xbfb8aa3b, v223
    v_exp_f32 v188, v188
    v_exp_f32 v189, v189
    v_exp_f32 v190, v190
    v_exp_f32 v191, v191
    v_add_f32 v188, 1.0, v188
    v_add_f32 v189, 1.0, v189
    v_add_f32 v190, 1.0, v190
    v_add_f32 v191, 1.0, v191
    v_rcp_f32 v188, v188
    v_rcp_f32 v189, v189
    v_rcp_f32 v190, v190
    v_rcp_f32 v191, v191
    v_mul_f32 v220, v220, v188
    v_mul_f32 v221, v221, v189
    v_mul_f32 v222, v222, v190
    v_mul_f32 v223, v223, v191
    v_cvt_pk_bf16_f32 v221, v220, v221
    v_lshlrev_b32 v220, 16, v221
    v_and_b32 v221, 0xffff0000, v221
    v_cvt_pk_bf16_f32 v223, v222, v223
    v_lshlrev_b32 v222, 16, v223
    v_and_b32 v223, 0xffff0000, v223
    v_mul_f32 v220, v220, v224
    v_mul_f32 v221, v221, v225
    v_mul_f32 v222, v222, v226
    v_mul_f32 v223, v223, v227
    v_cvt_pk_bf16_f32 v228, v220, v221
    v_cvt_pk_bf16_f32 v229, v222, v223
    ds_write_b64 v235, v[228:229]
    s_mov_b64 exec, 1
    ds_add_u32 v12, v13 offset:52
    s_mov_b64 exec, -1
    ds_read_b64_tr_b16 v[44:45], v241 offset:4096
    ds_read_b64_tr_b16 v[46:47], v241 offset:6144
    ds_read_b64_tr_b16 v[48:49], v238 offset:8192
    ds_read_b64_tr_b16 v[50:51], v238 offset:10240
    ds_read_b64_tr_b16 v[52:53], v239 offset:8192
    ds_read_b64_tr_b16 v[54:55], v239 offset:10240
    ds_read_b64_tr_b16 v[56:57], v240 offset:8192
    ds_read_b64_tr_b16 v[58:59], v240 offset:10240
    ds_read_b64_tr_b16 v[60:61], v241 offset:8192
    ds_read_b64_tr_b16 v[62:63], v241 offset:10240
    ds_read_b64_tr_b16 v[64:65], v238 offset:12288
    ds_read_b64_tr_b16 v[66:67], v238 offset:14336
    ds_read_b64_tr_b16 v[68:69], v239 offset:12288
    ds_read_b64_tr_b16 v[70:71], v239 offset:14336
    ds_read_b64_tr_b16 v[72:73], v240 offset:12288
    ds_read_b64_tr_b16 v[74:75], v240 offset:14336
    ds_read_b64_tr_b16 v[76:77], v241 offset:12288
    ds_read_b64_tr_b16 v[78:79], v241 offset:14336
    ds_read_b64_tr_b16 v[80:81], v238 offset:16384
    ds_read_b64_tr_b16 v[82:83], v238 offset:18432
    ds_read_b64_tr_b16 v[84:85], v239 offset:16384
    ds_read_b64_tr_b16 v[86:87], v239 offset:18432
    ds_read_b64_tr_b16 v[88:89], v240 offset:16384
    ds_read_b64_tr_b16 v[90:91], v240 offset:18432
    ds_read_b64_tr_b16 v[92:93], v241 offset:16384
    ds_read_b64_tr_b16 v[94:95], v241 offset:18432
    s_mov_b32 s3, 1048576
K_FGP:
    ds_read_b32 v2, v12 offset:52
    s_sleep 0
    s_sub_u32 s3, s3, 1
    s_waitcnt lgkmcnt(0)
    v_readfirstlane_b32 s33, v2
    s_nop 3
    s_cselect_b32 s33, 5, s33
    s_cmp_lt_u32 s33, 5
    s_cbranch_scc1 K_FGP
    ds_read_b128 v[228:231], v236
    s_waitcnt lgkmcnt(0)
    v_mfma_f32_16x16x32_bf16 v[96:99], v[16:19], v[228:231], 0
    v_mfma_f32_16x16x32_bf16 v[100:103], v[20:23], v[228:231], 0
    v_mfma_f32_16x16x32_bf16 v[104:107], v[24:27], v[228:231], 0
    v_mfma_f32_16x16x32_bf16 v[108:111], v[28:31], v[228:231], 0
    v_mfma_f32_16x16x32_bf16 v[112:115], v[32:35], v[228:231], 0
    v_mfma_f32_16x16x32_bf16 v[116:119], v[36:39], v[228:231], 0
    v_mfma_f32_16x16x32_bf16 v[120:123], v[40:43], v[228:231], 0
    v_mfma_f32_16x16x32_bf16 v[124:127], v[44:47], v[228:231], 0
    v_mfma_f32_16x16x32_bf16 v[128:131], v[48:51], v[228:231], 0
    v_mfma_f32_16x16x32_bf16 v[132:135], v[52:55], v[228:231], 0
    v_mfma_f32_16x16x32_bf16 v[136:139], v[56:59], v[228:231], 0
    v_mfma_f32_16x16x32_bf16 v[140:143], v[60:63], v[228:231], 0
    v_mfma_f32_16x16x32_bf16 v[144:147], v[64:67], v[228:231], 0
    v_mfma_f32_16x16x32_bf16 v[148:151], v[68:71], v[228:231], 0
    v_mfma_f32_16x16x32_bf16 v[152:155], v[72:75], v[228:231], 0
    v_mfma_f32_16x16x32_bf16 v[156:159], v[76:79], v[228:231], 0
    v_mfma_f32_16x16x32_bf16 v[160:163], v[80:83], v[228:231], 0
    v_mfma_f32_16x16x32_bf16 v[164:167], v[84:87], v[228:231], 0
    v_mfma_f32_16x16x32_bf16 v[168:171], v[88:91], v[228:231], 0
    v_mfma_f32_16x16x32_bf16 v[172:175], v[92:95], v[228:231], 0
    s_mov_b32 exec_lo, 0x00030003
    s_mov_b32 exec_hi, 0x00030003
    buffer_store_dwordx4 v[96:99], v237, s[64:67], s72 offen offset:0 sc1
    buffer_store_dwordx4 v[100:103], v237, s[64:67], s72 offen offset:64 sc1
    buffer_store_dwordx4 v[104:107], v237, s[64:67], s72 offen offset:128 sc1
    buffer_store_dwordx4 v[108:111], v237, s[64:67], s72 offen offset:192 sc1
    buffer_store_dwordx4 v[112:115], v237, s[64:67], s72 offen offset:256 sc1
    buffer_store_dwordx4 v[116:119], v237, s[64:67], s72 offen offset:320 sc1
    buffer_store_dwordx4 v[120:123], v237, s[64:67], s72 offen offset:384 sc1
    buffer_store_dwordx4 v[124:127], v237, s[64:67], s72 offen offset:448 sc1
    buffer_store_dwordx4 v[128:131], v237, s[64:67], s72 offen offset:512 sc1
    buffer_store_dwordx4 v[132:135], v237, s[64:67], s72 offen offset:576 sc1
    buffer_store_dwordx4 v[136:139], v237, s[64:67], s72 offen offset:640 sc1
    buffer_store_dwordx4 v[140:143], v237, s[64:67], s72 offen offset:704 sc1
    buffer_store_dwordx4 v[144:147], v237, s[64:67], s72 offen offset:768 sc1
    buffer_store_dwordx4 v[148:151], v237, s[64:67], s72 offen offset:832 sc1
    buffer_store_dwordx4 v[152:155], v237, s[64:67], s72 offen offset:896 sc1
    buffer_store_dwordx4 v[156:159], v237, s[64:67], s72 offen offset:960 sc1
    buffer_store_dwordx4 v[160:163], v237, s[64:67], s72 offen offset:1024 sc1
    buffer_store_dwordx4 v[164:167], v237, s[64:67], s72 offen offset:1088 sc1
    buffer_store_dwordx4 v[168:171], v237, s[64:67], s72 offen offset:1152 sc1
    buffer_store_dwordx4 v[172:175], v237, s[64:67], s72 offen offset:1216 sc1
    s_mov_b64 exec, -1
    s_lshl_b32 s3, s44, 5
    s_lshl3_add_u32 s3, s73, s3
    s_add_u32 s3, s3, 565248
    v_mov_b32 v2, s3
    v_mov_b32 v228, 1
    v_mov_b32 v229, 1
    s_waitcnt vmcnt(0)
    s_mov_b64 exec, 1
    global_store_dwordx2 v2, v[228:229], s[10:11] sc1
    s_mov_b64 exec, -1
    s_branch K_P2_HELP
K_CODE_END:
.section .rodata,"a"
.p2align 6
.amdhsa_kernel gated_mix__sliding_local_dilated__moe_arch_mod__prompt_kernel
  .amdhsa_next_free_vgpr 248
  .amdhsa_next_free_sgpr 79
  .amdhsa_accum_offset 248
  .amdhsa_group_segment_fixed_size 0
  .amdhsa_kernarg_size 96
  .amdhsa_user_sgpr_count 2
  .amdhsa_user_sgpr_kernarg_segment_ptr 1
  .amdhsa_system_sgpr_workgroup_id_x 1
.end_amdhsa_kernel
```

```asm
; @launch grid=(256,1,1) block=(512,1,1) lds=163840
.amdgcn_target "amdgcn-amd-amdhsa--gfx950"
.text
.p2align 12
.p2align 8
.globl gated_mix__sliding_local_dilated__moe_arch_mod__prompt_kernel
.type gated_mix__sliding_local_dilated__moe_arch_mod__prompt_kernel,@function
gated_mix__sliding_local_dilated__moe_arch_mod__prompt_kernel:
    s_cmp_ge_u32 s2, 256
    s_cbranch_scc1 K_EXIT
    s_load_dwordx2 s[12:13], s[0:1], 0
    s_load_dwordx2 s[16:17], s[0:1], 8
    v_readfirstlane_b32 s30, v0
    s_load_dwordx4 s[8:11], s[0:1], 80
    s_load_dwordx2 s[24:25], s[0:1], 16
    s_load_dwordx2 s[6:7], s[0:1], 72
    s_and_b32 s28, s2, 7
    v_and_b32 v1, 63, v0
    s_mov_b32 s14, 0x280000
    s_mov_b32 s15, 0x20000
    s_lshr_b32 s30, s30, 6
    s_cmp_lt_u32 s2, 64
    s_cbranch_scc1 K_SLOW
    s_cmp_lt_u32 s30, 4
    s_cbranch_scc1 K_FAST
K_SLOW:
    s_getpc_b64 s[38:39]
K_PC:
    s_bfe_u32 s3, s2, 0x30003
    s_mul_i32 s3, s3, ((K_CODE_END-gated_mix__sliding_local_dilated__moe_arch_mod__prompt_kernel+1023)/1024)
    s_sub_u32 s38, s38, K_PC-gated_mix__sliding_local_dilated__moe_arch_mod__prompt_kernel
    s_subb_u32 s39, s39, 0
    v_subrev_u32 v3, 256, v0
    v_add_u32 v2, s3, v3
    v_lshlrev_b32 v2, 7, v2
    v_min_u32 v2, K_CODE_END-gated_mix__sliding_local_dilated__moe_arch_mod__prompt_kernel-4, v2
    v_cmp_gt_u32 vcc, ((K_CODE_END-gated_mix__sliding_local_dilated__moe_arch_mod__prompt_kernel+1023)/1024), v3
    s_and_saveexec_b64 s[4:5], vcc
    s_cbranch_execz K_NOPF
    global_load_dword v6, v2, s[38:39]
K_NOPF:
    s_mov_b64 exec, -1
    v_mov_b32 v2, 0
    v_mov_b32 v3, 158752
    ds_write2_b32 v3, v2, v2 offset0:0 offset1:1
    ds_write2_b32 v3, v2, v2 offset0:2 offset1:3
    ds_write2_b32 v3, v2, v2 offset0:4 offset1:5
    ds_write2_b32 v3, v2, v2 offset0:6 offset1:7
    ds_write2_b32 v3, v2, v2 offset0:8 offset1:9
    s_mov_b32 s43, 1
    s_lshl_b32 s3, s30, 8
    s_add_u32 s3, s3, s2
    s_lshr_b32 s3, s3, 3
    s_cmp_lg_u32 s3, 160
    s_cbranch_scc1 K_COMMON
    s_mul_i32 s3, s2, 6144
    s_add_u32 s3, s3, 527360
    v_lshl_add_u32 v6, v1, 4, s3
    v_mov_b64 v[28:29], 0
    v_mov_b64 v[30:31], 0
    s_waitcnt lgkmcnt(0)
    global_store_dwordx4 v6, v[28:31], s[10:11] offset:-3072 sc1
    global_store_dwordx4 v6, v[28:31], s[10:11] offset:-2048 sc1
    global_store_dwordx4 v6, v[28:31], s[10:11] offset:-1024 sc1
    global_store_dwordx4 v6, v[28:31], s[10:11] offset:0 sc1
    global_store_dwordx4 v6, v[28:31], s[10:11] offset:1024 sc1
    global_store_dwordx4 v6, v[28:31], s[10:11] offset:2048 sc1
    s_lshl_b32 s3, s2, 2
    v_mov_b32 v2, s3
    v_mov_b32 v3, 1
    s_mov_b64 exec, 1
    s_waitcnt vmcnt(0)
    global_store_dword v2, v3, s[8:9] offset:192 sc1
    s_mov_b64 exec, -1
    s_branch K_COMMON
K_FAST:
    s_lshr_b32 s32, s2, 1
    s_and_b32 s32, s32, 28
    v_lshrrev_b32 v3, 4, v1
    s_lshr_b32 s3, s2, 6
    s_mov_b32 s59, 0x98450216
    s_cmp_eq_u32 s3, 2
    s_cselect_b32 s59, 0x70238164, s59
    v_and_b32 v4, 7, v1
    s_cmp_eq_u32 s3, 3
    s_cselect_b32 s59, 0x65703481, s59
    v_lshrrev_b32 v2, 3, v1
    s_lshr_b32 s59, s59, s32
    s_and_b32 s59, s59, 15
    v_xor_b32 v4, v4, v3
    s_add_u32 s59, s59, s28
    s_cmp_ge_u32 s59, 10
    v_mul_u32_u24 v2, 1280, v2
    s_cselect_b32 s33, 10, 0
    s_sub_u32 s59, s59, s33
    s_lshr_b32 s53, s28, 1
    v_lshl_add_u32 v44, v4, 4, v2
    s_mul_i32 s53, s53, 655360
    s_lshl2_add_u32 s62, s3, s30
    s_cmp_eq_u32 s62, 15
    s_cselect_b32 s62, 0x800000, 0
    s_add_u32 s62, s62, 40960
    s_mul_i32 s3, s3, 225280
    v_xor_b32 v45, 64, v44
    s_add_u32 s53, s53, s3
    s_mul_i32 s54, s30, 61440
    s_add_u32 s53, s53, s54
    s_sub_u32 s53, s53, 245760
    s_mul_i32 s55, s30, 6144
    s_add_u32 s55, s55, 40960
    s_lshl_b32 s57, s59, 7
    s_add_u32 s57, s57, s53
    s_waitcnt lgkmcnt(0)
    s_add_u32 m0, s55, 0
    s_max_i32 s60, s57, 0
    buffer_load_dwordx4 v44, s[12:15], s60 offen lds
    s_add_u32 s60, s57, 10240
    s_add_u32 m0, s55, 1024
    s_max_i32 s60, s60, 0
    buffer_load_dwordx4 v45, s[12:15], s60 offen lds
    s_add_u32 m0, s55, 2048
    s_add_u32 s60, s57, 20480
    buffer_load_dwordx4 v44, s[12:15], s60 offen lds
    s_add_u32 m0, s55, 3072
    s_add_u32 s60, s57, 30720
    buffer_load_dwordx4 v45, s[12:15], s60 offen lds
    s_add_u32 m0, s55, 4096
    s_add_u32 s60, s57, s62
    buffer_load_dwordx4 v44, s[12:15], s60 offen lds
    s_add_u32 m0, s55, 5120
    s_add_u32 s60, s60, 10240
    buffer_load_dwordx4 v45, s[12:15], s60 offen lds
    v_lshlrev_b32 v2, 1, v3
    s_lshr_b32 s32, 0x64317520, s32
    v_sub_u32 v2, v1, v2
    s_and_b32 s32, s32, 7
    v_and_b32 v2, 15, v2
    s_and_b32 s3, s28, 1
    v_mul_u32_u24 v3, 3840, v3
    s_lshl3_add_u32 s32, s3, s32
    v_mul_u32_u24 v4, 13, v2
    s_mul_i32 s3, s32, 80
    v_lshrrev_b32 v4, 6, v4
    s_add_u32 s54, s54, s3
    v_mul_u32_u24 v4, 1200, v4
    s_lshl_b32 s56, s30, 12
    v_lshl_add_u32 v4, v2, 4, v4
    s_add_u32 s56, s56, 65536
    v_add_u32 v5, 1, v2
    s_mov_b32 s18, 0x258000
    v_and_b32 v5, 16, v5
    s_mov_b32 s19, 0x20000
    v_lshl_add_u32 v4, v5, 24, v4
    v_add_u32 v46, v3, v4
    s_mul_i32 s58, s59, 245760
    s_add_u32 s58, s58, s54
    s_add_u32 s59, s59, 1
    s_cmp_eq_u32 s59, 10
    s_cselect_b32 s59, 0, s59
    s_add_u32 m0, s56, 0
    s_add_u32 s60, s58, 0
    buffer_load_dwordx4 v46, s[16:19], s60 offen lds
    s_add_u32 m0, s56, 1024
    s_add_u32 s60, s58, 15360
    buffer_load_dwordx4 v46, s[16:19], s60 offen lds
    v_xor_b32 v2, 8, v2
    v_mul_u32_u24 v4, 13, v2
    v_lshrrev_b32 v4, 6, v4
    v_mul_u32_u24 v4, 1200, v4
    v_lshl_add_u32 v4, v2, 4, v4
    v_add_u32 v5, 1, v2
    v_and_b32 v5, 16, v5
    v_lshl_add_u32 v4, v5, 24, v4
    v_add_u32 v47, v3, v4
    s_add_u32 m0, s56, 2048
    s_add_u32 s60, s58, 30720
    buffer_load_dwordx4 v47, s[16:19], s60 offen lds
    s_add_u32 m0, s56, 3072
    s_add_u32 s60, s58, 46080
    buffer_load_dwordx4 v47, s[16:19], s60 offen lds
    s_mov_b32 s3, 40960
    s_cmp_ge_u32 s55, 81920
    s_cselect_b32 s60, -81920, s3
    s_add_u32 s55, s55, s60
    s_add_u32 s56, s56, s60
    s_lshl_b32 s57, s59, 7
    s_add_u32 s57, s57, s53
    s_mul_i32 s58, s59, 245760
    s_add_u32 s58, s58, s54
    s_add_u32 s59, s59, 1
    s_cmp_eq_u32 s59, 10
    s_cselect_b32 s59, 0, s59
    s_add_u32 m0, s56, 0
    s_add_u32 s60, s58, 0
    buffer_load_dwordx4 v46, s[16:19], s60 offen lds
    s_add_u32 m0, s55, 0
    s_max_i32 s60, s57, 0
    buffer_load_dwordx4 v44, s[12:15], s60 offen lds
    s_add_u32 m0, s56, 1024
    s_add_u32 s60, s58, 15360
    buffer_load_dwordx4 v46, s[16:19], s60 offen lds
    s_add_u32 s60, s57, 10240
    s_add_u32 m0, s55, 1024
    s_max_i32 s60, s60, 0
    buffer_load_dwordx4 v45, s[12:15], s60 offen lds
    s_add_u32 m0, s55, 2048
    s_add_u32 s60, s57, 20480
    buffer_load_dwordx4 v44, s[12:15], s60 offen lds
    s_mov_b32 s52, s30
    s_mov_b32 s43, 0
K_COMMON:
    v_mov_b32 v7, 0
    s_lshr_b32 s29, s2, 3
    s_xor_b32 s30, s30, 4
    s_mov_b32 s26, 0xc8000
    s_mov_b32 s27, 0x20000
    s_lshr_b32 s34, s29, 3
    s_lshl_b32 s34, s34, 2
    s_and_b32 s3, s29, 3
    s_add_u32 s34, s34, s3
    s_add_u32 s34, s34, 4
    s_bitcmp1_b32 s29, 2
    s_cselect_b32 s34, -1, s34
    s_cmp_lt_u32 s29, 8
    s_cselect_b32 s34, s29, s34
    s_lshl_b32 s40, s28, 1
    s_cmp_ge_u32 s34, 10
    s_addc_u32 s40, s40, 0
    s_sub_u32 s41, s34, 10
    s_cmp_ge_u32 s34, 10
    s_cselect_b32 s41, s41, s34
    s_mul_i32 s42, s28, 20
    s_add_u32 s42, s42, s34
    s_and_b32 s42, s42, 255
    s_lshl_b32 s42, s42, 8
    s_add_u32 s42, s42, 524288
    s_cmp_lt_u32 s29, 8
    s_cbranch_scc1 K_AUX
    s_lshr_b32 s31, s29, 3
    s_sub_u32 s31, s31, 1
    s_and_b32 s35, s29, 3
    s_and_b32 s3, s29, 4
    s_lshl_b32 s3, s3, 1
    s_add_u32 s35, s35, s3
    s_and_b32 s3, s28, 1
    s_lshl_b32 s3, s3, 2
    s_add_u32 s35, s35, s3
    v_and_b32 v9, 15, v1
    v_lshrrev_b32 v10, 4, v1
    v_bfe_u32 v11, v1, 2, 2
    v_and_b32 v12, 3, v1
    s_waitcnt lgkmcnt(0)
    s_add_u32 s20, s10, 0x100000
    s_addc_u32 s21, s11, 0
    s_mov_b32 s22, 0x280000
    s_mov_b32 s23, 0x20000
    s_and_b32 s3, s30, 3
    s_mul_i32 s3, s3, 3
    s_lshr_b32 s33, s30, 2
    s_lshl1_add_u32 s3, s33, s3
    s_mul_i32 s44, s31, 11
    s_add_u32 s44, s44, s3
    s_cmp_eq_u32 s44, 31
    s_cselect_b32 s51, 4, s30
    s_lshr_b32 s33, s28, 1
    s_lshl_b32 s33, s33, 5
    s_add_u32 s44, s44, s33
    s_mul_i32 s3, s3, 4352
    s_add_u32 s3, s3, 81920
    v_mul_u32_u24 v14, 272, v9
    v_lshl_add_u32 v13, v10, 3, v14
    v_add_u32 v13, s3, v13
    v_add3_u32 v14, v14, 32, s3
    v_cmp_eq_u32 vcc, 0, v10
    v_add_u32 v2, 208, v14
    v_add_u32 v3, 0, v14
    v_add_u32 v4, 40, v14
    v_cndmask_b32 v19, v2, v3, vcc
    v_cndmask_b32 v20, v2, v4, vcc
    v_lshl_add_u32 v15, v10, 2, v11
    v_mul_u32_u24 v15, 272, v15
    v_add_u32 v5, s3, v15
    v_lshl_add_u32 v15, v12, 3, v5
    v_add_u32 v2, 240, v5
    v_add_u32 v3, 192, v5
    v_add_u32 v4, 232, v5
    v_cmp_eq_u32 vcc, 0, v12
    s_nop 1
    v_cndmask_b32 v21, v2, v3, vcc
    v_cmp_eq_u32 vcc, 1, v12
    s_nop 1
    v_cndmask_b32 v22, v2, v4, vcc
    v_cmp_eq_u32 vcc, 2, v12
    s_nop 1
    v_cndmask_b32 v23, v2, v3, vcc
    v_cmp_eq_u32 vcc, 3, v12
    s_nop 1
    v_cndmask_b32 v24, v2, v4, vcc
    s_lshl_b32 s3, s35, 10
    v_lshl_add_u32 v16, v1, 4, s3
    s_lshl_b32 s3, s35, 8
    s_add_u32 s3, s3, 16384
    v_lshl_add_u32 v17, v9, 4, s3
    v_and_b32 v2, 1, v10
    v_lshl_add_u32 v17, v2, 3, v17
    s_cmp_lt_u32 s51, 4
    s_cselect_b32 s3, 0, 0x800000
    s_add_u32 s3, s3, 20480
    v_lshrrev_b32 v2, 1, v10
    v_mad_u32_u24 v17, v2, s3, v17
    s_mul_i32 s50, s44, 20480
    s_add_u32 s51, s50, s3
    v_mov_b32 v18, 0xf149f2ca
    v_lshlrev_b32 v2, 2, v10
    v_sub_u32 v2, v9, v2
    s_cmp_eq_u32 s44, 0
    s_cselect_b32 s3, 0xf149f2ca, 0
    v_subrev_u32 v3, 0, v2
    v_and_b32 v4, 0x80000001, v3
    v_cmp_eq_u32 vcc, 0, v4
    s_nop 1
    v_cndmask_b32 v32, v18, 0, vcc
    v_cmp_eq_u32 vcc, 0x80000000, v4
    s_nop 1
    v_cndmask_b32 v28, v18, 0, vcc
    v_add_f32 v36, s3, v28
    v_subrev_u32 v3, 1, v2
    v_and_b32 v4, 0x80000001, v3
    v_cmp_eq_u32 vcc, 0, v4
    s_nop 1
    v_cndmask_b32 v33, v18, 0, vcc
    v_cmp_eq_u32 vcc, 0x80000000, v4
    s_nop 1
    v_cndmask_b32 v29, v18, 0, vcc
    v_add_f32 v37, s3, v29
    v_subrev_u32 v3, 2, v2
    v_and_b32 v4, 0x80000001, v3
    v_cmp_eq_u32 vcc, 0, v4
    s_nop 1
    v_cndmask_b32 v34, v18, 0, vcc
    v_cmp_eq_u32 vcc, 0x80000000, v4
    s_nop 1
    v_cndmask_b32 v30, v18, 0, vcc
    v_add_f32 v38, s3, v30
    v_subrev_u32 v3, 3, v2
    v_and_b32 v4, 0x80000001, v3
    v_cmp_eq_u32 vcc, 0, v4
    s_nop 1
    v_cndmask_b32 v35, v18, 0, vcc
    v_cmp_eq_u32 vcc, 0x80000000, v4
    s_nop 1
    v_cndmask_b32 v31, v18, 0, vcc
    v_add_f32 v39, s3, v31
    v_mov_b32 v3, 0x0c0c0c0c
    v_mov_b32 v4, 0xc0c0100
    v_cmp_eq_u32 vcc, 0, v28
    v_mov_b32 v5, 0x1000c0c
    s_nop 0
    v_cndmask_b32 v3, v3, v4, vcc
    v_cmp_eq_u32 vcc, 0, v29
    s_nop 1
    v_cndmask_b32 v40, v3, v5, vcc
    v_mov_b32 v3, 0x0c0c0c0c
    v_mov_b32 v4, 0xc0c0302
    v_cmp_eq_u32 vcc, 0, v30
    v_mov_b32 v5, 0x3020c0c
    s_nop 0
    v_cndmask_b32 v3, v3, v4, vcc
    v_cmp_eq_u32 vcc, 0, v31
    s_nop 1
    v_cndmask_b32 v41, v3, v5, vcc
    v_mov_b32 v3, 0x0c0c0c0c
    v_mov_b32 v4, 0xc0c0100
    v_cmp_eq_u32 vcc, 0, v32
    v_mov_b32 v5, 0x1000c0c
    s_nop 0
    v_cndmask_b32 v3, v3, v4, vcc
    v_cmp_eq_u32 vcc, 0, v33
    s_nop 1
    v_cndmask_b32 v42, v3, v5, vcc
    v_mov_b32 v3, 0x0c0c0c0c
    v_mov_b32 v4, 0xc0c0302
    v_cmp_eq_u32 vcc, 0, v34
    v_mov_b32 v5, 0x3020c0c
    s_nop 0
    v_cndmask_b32 v3, v3, v4, vcc
    v_cmp_eq_u32 vcc, 0, v35
    s_nop 1
    v_cndmask_b32 v43, v3, v5, vcc
    s_mov_b32 s46, 0x3fb8aa3b
    s_mov_b32 s47, s46
    s_mov_b32 s48, 0x3e64f92e
    s_mov_b32 s49, s48
    s_mov_b32 s36, 0xfffff
    s_cmp_lg_u32 s31, 0
    s_cselect_b32 s33, 64, 0
    v_mov_b32 v2, s33
    v_cmp_gt_u32 vcc, 10, v1
    s_lshr_b32 s3, s28, 1
    s_lshl2_add_u32 s3, s3, s31
    v_cndmask_b32 v2, 0, v2, vcc
    v_lshl_add_u32 v2, v1, 8, v2
    s_mul_i32 s3, s3, 2560
    s_lshl2_add_u32 s3, s35, s3
    s_add_u32 s3, s3, 524288
    v_add_u32 v8, s3, v2
    s_cmp_eq_u32 s43, 1
    s_cbranch_scc1 K_CONS
    v_lshrrev_b32 v2, 3, v1
    v_mul_u32_u24 v2, 1280, v2
    v_lshrrev_b32 v3, 4, v1
    v_lshlrev_b32 v3, 1, v3
    v_and_b32 v4, 7, v1
    v_xor_b32 v3, v3, v4
    v_lshl_add_u32 v2, v3, 4, v2
    s_lshl_b32 s33, s41, 7
    v_add_u32 v18, s33, v2
    s_mov_b32 s61, 9
    s_mov_b32 s3, 40960
K_LOOP0:
    s_waitcnt vmcnt(5)
    s_barrier
    s_add_u32 m0, s56, 2048
    s_add_u32 s60, s58, 30720
    buffer_load_dwordx4 v47, s[16:19], s60 offen lds
    s_add_u32 m0, s55, 3072
    s_add_u32 s60, s57, 30720
    buffer_load_dwordx4 v45, s[12:15], s60 offen lds
    s_add_u32 m0, s56, 3072
    s_add_u32 s60, s58, 46080
    buffer_load_dwordx4 v47, s[16:19], s60 offen lds
    s_add_u32 m0, s55, 4096
    s_add_u32 s60, s57, s62
    buffer_load_dwordx4 v44, s[12:15], s60 offen lds
    s_add_u32 m0, s55, 5120
    s_add_u32 s60, s60, 10240
    buffer_load_dwordx4 v45, s[12:15], s60 offen lds
    s_sub_u32 s61, s61, 1
    s_cmp_eq_u32 s61, 0
    s_cbranch_scc1 K_LOOPX
    s_cmp_ge_u32 s55, 81920
    s_cselect_b32 s60, -81920, s3
    s_add_u32 s55, s55, s60
    s_add_u32 s56, s56, s60
    s_lshl_b32 s57, s59, 7
    s_add_u32 s57, s57, s53
    s_mul_i32 s58, s59, 245760
    s_add_u32 s58, s58, s54
    s_add_u32 s59, s59, 1
    s_cmp_eq_u32 s59, 10
    s_cselect_b32 s59, 0, s59
    s_add_u32 m0, s56, 0
    s_add_u32 s60, s58, 0
    buffer_load_dwordx4 v46, s[16:19], s60 offen lds
    s_add_u32 m0, s55, 0
    s_max_i32 s60, s57, 0
    buffer_load_dwordx4 v44, s[12:15], s60 offen lds
    s_add_u32 m0, s56, 1024
    s_add_u32 s60, s58, 15360
    buffer_load_dwordx4 v46, s[16:19], s60 offen lds
    s_add_u32 s60, s57, 10240
    s_add_u32 m0, s55, 1024
    s_max_i32 s60, s60, 0
    buffer_load_dwordx4 v45, s[12:15], s60 offen lds
    s_add_u32 m0, s55, 2048
    s_add_u32 s60, s57, 20480
    buffer_load_dwordx4 v44, s[12:15], s60 offen lds
    s_branch K_LOOP0
K_LOOPX:
    v_and_b32 v2, 7, v1
    v_lshlrev_b32 v2, 2, v2
    s_waitcnt vmcnt(0)
    s_barrier
    s_cmp_lt_u32 s30, 6
    s_cbranch_scc1 K_NOSMP
    global_load_dword v7, v2, s[8:9] offset:192 sc1
K_NOSMP:
    s_cmp_eq_u32 s34, -1
    s_cbranch_scc1 K_JOIN_S
    s_cmp_lg_u32 s30, 7
    s_cbranch_scc1 K_WOE
    s_barrier
K_WOE:
    s_lshl_b32 s57, s52, 2
    s_lshr_b32 s57, 0x7520, s57
    s_and_b32 s57, s57, 7
    s_mul_i32 s57, s57, 51200
    s_mul_i32 s58, s52, 5120
    s_add_u32 s3, s57, 0
    s_add_u32 m0, s58, 0
    s_nop 0
    buffer_load_dwordx4 v18, s[24:27], s3 offen lds
    s_add_u32 s3, s57, 10240
    s_add_u32 m0, s58, 1024
    s_nop 0
    buffer_load_dwordx4 v18, s[24:27], s3 offen lds
    s_add_u32 s3, s57, 20480
    s_add_u32 m0, s58, 2048
    s_nop 0
    buffer_load_dwordx4 v18, s[24:27], s3 offen lds
    s_add_u32 s3, s57, 30720
    s_add_u32 m0, s58, 3072
    s_nop 0
    buffer_load_dwordx4 v18, s[24:27], s3 offen lds
    s_add_u32 s3, s57, 40960
    s_add_u32 m0, s58, 4096
    s_nop 0
    buffer_load_dwordx4 v18, s[24:27], s3 offen lds
    s_add_u32 s3, s57, 409600
    s_add_u32 m0, s58, 20480
    s_nop 0
    buffer_load_dwordx4 v18, s[24:27], s3 offen lds
    s_add_u32 s3, s57, 419840
    s_add_u32 m0, s58, 21504
    s_nop 0
    buffer_load_dwordx4 v18, s[24:27], s3 offen lds
    s_add_u32 s3, s57, 430080
    s_add_u32 m0, s58, 22528
    s_nop 0
    buffer_load_dwordx4 v18, s[24:27], s3 offen lds
    s_add_u32 s3, s57, 440320
    s_add_u32 m0, s58, 23552
    s_nop 0
    buffer_load_dwordx4 v18, s[24:27], s3 offen lds
    s_add_u32 s3, s57, 450560
    s_add_u32 m0, s58, 24576
    s_nop 0
    buffer_load_dwordx4 v18, s[24:27], s3 offen lds
    s_cmp_lg_u32 s30, 7
    s_cbranch_scc1 K_JOIN_S
    s_mov_b32 s52, 0
K_XD:
    s_lshl_b32 s57, s40, 3
    s_lshl1_add_u32 s57, s52, s57
    s_mul_i32 s57, s57, 20480
    s_lshl_b32 s33, s41, 7
    s_add_u32 s57, s57, s33
    s_lshl_b32 s33, s52, 12
    s_add_u32 m0, s33, 140288
    s_add_u32 s3, s57, 0
    buffer_load_dwordx4 v44, s[12:15], s3 offen lds
    s_add_u32 m0, s33, 141312
    s_add_u32 s3, s57, 10240
    buffer_load_dwordx4 v45, s[12:15], s3 offen lds
    s_add_u32 m0, s33, 142336
    s_add_u32 s3, s57, 20480
    buffer_load_dwordx4 v44, s[12:15], s3 offen lds
    s_add_u32 m0, s33, 143360
    s_add_u32 s3, s57, 30720
    buffer_load_dwordx4 v45, s[12:15], s3 offen lds
    s_add_u32 s52, s52, 1
    s_cmp_lt_u32 s52, 4
    s_cbranch_scc1 K_XD
    s_branch K_W7
.p2align 12
K_CONS:
    s_lshr_b32 s52, s30, 1
    s_and_b32 s53, s30, 1
    v_lshrrev_b32 v2, 1, v9
    v_xor_b32 v2, v2, v10
    v_lshlrev_b32 v2, 4, v2
    v_lshl_add_u32 v2, v9, 7, v2
    s_mul_i32 s3, s52, 12288
    v_add_u32 v44, s3, v2
    v_xor_b32 v45, 64, v44
    v_add_u32 v46, 81920, v44
    v_add_u32 v47, 81920, v45
    v_and_b32 v2, 1, v10
    v_lshl_or_b32 v2, v2, 2, v11
    v_lshl_add_u32 v3, v10, 3, v11
    v_lshlrev_b32 v3, 8, v3
    v_lshl_add_u32 v3, v12, 3, v3
    v_add_u32 v3, 24576, v3
    s_lshl_b32 s3, s53, 2
    v_add_u32 v2, s3, v2
    v_add_u32 v4, 0, v2
    v_and_b32 v4, 7, v4
    v_lshl_add_u32 v48, v4, 5, v3
    v_add_u32 v52, 81920, v48
    v_add_u32 v4, 1, v2
    v_and_b32 v4, 7, v4
    v_lshl_add_u32 v49, v4, 5, v3
    v_add_u32 v53, 81920, v49
    v_add_u32 v4, 2, v2
    v_and_b32 v4, 7, v4
    v_lshl_add_u32 v50, v4, 5, v3
    v_add_u32 v54, 81920, v50
    v_add_u32 v4, 3, v2
    v_and_b32 v4, 7, v4
    v_lshl_add_u32 v51, v4, 5, v3
    v_add_u32 v55, 81920, v51
    v_mul_u32_u24 v56, 272, v9
    v_lshl_add_u32 v56, v10, 3, v56
    s_mul_i32 s3, s52, 26112
    s_lshl_b32 s33, s53, 7
    s_add_u32 s3, s3, s33
    s_add_u32 s3, s3, 81920
    v_add_u32 v56, s3, v56
    v_mov_b64 v[60:61], 0
    v_mov_b64 v[62:63], 0
    v_mov_b64 v[64:65], 0
    v_mov_b64 v[66:67], 0
    v_mov_b64 v[68:69], 0
    v_mov_b64 v[70:71], 0
    v_mov_b64 v[72:73], 0
    v_mov_b64 v[74:75], 0
    v_mov_b64 v[76:77], 0
    v_mov_b64 v[78:79], 0
    v_mov_b64 v[80:81], 0
    v_mov_b64 v[82:83], 0
    v_mov_b64 v[84:85], 0
    v_mov_b64 v[86:87], 0
    v_mov_b64 v[88:89], 0
    v_mov_b64 v[90:91], 0
    v_mov_b64 v[92:93], 0
    v_mov_b64 v[94:95], 0
    v_mov_b64 v[96:97], 0
    v_mov_b64 v[98:99], 0
    v_mov_b64 v[100:101], 0
    v_mov_b64 v[102:103], 0
    v_mov_b64 v[104:105], 0
    v_mov_b64 v[106:107], 0
    v_mov_b64 v[108:109], 0
    v_mov_b64 v[110:111], 0
    v_mov_b64 v[112:113], 0
    v_mov_b64 v[114:115], 0
    v_mov_b64 v[116:117], 0
    v_mov_b64 v[118:119], 0
    v_mov_b64 v[120:121], 0
    v_mov_b64 v[122:123], 0
    v_mov_b64 v[124:125], 0
    v_mov_b64 v[126:127], 0
    v_mov_b64 v[128:129], 0
    v_mov_b64 v[130:131], 0
    v_mov_b64 v[132:133], 0
    v_mov_b64 v[134:135], 0
    v_mov_b64 v[136:137], 0
    v_mov_b64 v[138:139], 0
    v_mov_b64 v[140:141], 0
    v_mov_b64 v[142:143], 0
    v_mov_b64 v[144:145], 0
    v_mov_b64 v[146:147], 0
    v_mov_b64 v[148:149], 0
    v_mov_b64 v[150:151], 0
    v_mov_b64 v[152:153], 0
    v_mov_b64 v[154:155], 0
    s_mov_b32 s54, 3
    s_cmp_lg_u32 s30, 0
    s_cbranch_scc1 K_WARMM0
    s_call_b64 s[38:39], WP_attd
    s_call_b64 s[38:39], WP_p2g
    s_branch K_WARMMX
K_WARMM0:
    s_cmp_lg_u32 s30, 1
    s_cbranch_scc1 K_WARMM1
    s_call_b64 s[38:39], WP_atts
    s_call_b64 s[38:39], WP_early
    s_branch K_WARMMX
K_WARMM1:
    s_cmp_lg_u32 s30, 2
    s_cbranch_scc1 K_WARMM2
    s_call_b64 s[38:39], WP_help
    s_call_b64 s[38:39], WP_flags
    s_branch K_WARMMX
K_WARMM2:
    s_call_b64 s[38:39], WP_spin
K_WARMMX:
    s_setprio 2
    s_barrier
    ds_read_b64_tr_b16 v[204:205], v48 offset:40960
    ds_read_b64_tr_b16 v[206:207], v48 offset:41984
    ds_read_b128 v[156:159], v44 offset:40960
    ds_read_b64_tr_b16 v[208:209], v49 offset:40960
    ds_read_b64_tr_b16 v[210:211], v49 offset:41984
    ds_read_b128 v[160:163], v44 offset:43008
    ds_read_b64_tr_b16 v[212:213], v50 offset:40960
    ds_read_b64_tr_b16 v[214:215], v50 offset:41984
    ds_read_b128 v[164:167], v44 offset:45056
    ds_read_b64_tr_b16 v[216:217], v51 offset:40960
    ds_read_b64_tr_b16 v[218:219], v51 offset:41984
    ds_read_b128 v[168:171], v44 offset:47104
    ds_read_b128 v[172:175], v44 offset:49152
    ds_read_b128 v[176:179], v44 offset:51200
K_CLOOP:
    s_waitcnt lgkmcnt(0)
    v_mfma_f32_16x16x32_bf16 v[60:63], v[204:207], v[156:159], v[60:63]
    ds_read_b64_tr_b16 v[220:221], v48 offset:49152
    v_mfma_f32_16x16x32_bf16 v[64:67], v[208:211], v[156:159], v[64:67]
    ds_read_b64_tr_b16 v[222:223], v48 offset:50176
    v_mfma_f32_16x16x32_bf16 v[68:71], v[212:215], v[156:159], v[68:71]
    ds_read_b128 v[180:183], v45 offset:40960
    v_mfma_f32_16x16x32_bf16 v[72:75], v[216:219], v[156:159], v[72:75]
    ds_read_b64_tr_b16 v[224:225], v49 offset:49152
    v_mfma_f32_16x16x32_bf16 v[88:91], v[216:219], v[160:163], v[88:91]
    ds_read_b64_tr_b16 v[226:227], v49 offset:50176
    v_mfma_f32_16x16x32_bf16 v[84:87], v[212:215], v[160:163], v[84:87]
    ds_read_b128 v[184:187], v45 offset:43008
    v_mfma_f32_16x16x32_bf16 v[80:83], v[208:211], v[160:163], v[80:83]
    ds_read_b64_tr_b16 v[228:229], v50 offset:49152
    v_mfma_f32_16x16x32_bf16 v[76:79], v[204:207], v[160:163], v[76:79]
    ds_read_b64_tr_b16 v[230:231], v50 offset:50176
    v_mfma_f32_16x16x32_bf16 v[92:95], v[204:207], v[164:167], v[92:95]
    ds_read_b128 v[188:191], v45 offset:45056
    v_mfma_f32_16x16x32_bf16 v[96:99], v[208:211], v[164:167], v[96:99]
    ds_read_b64_tr_b16 v[232:233], v51 offset:49152
    v_mfma_f32_16x16x32_bf16 v[100:103], v[212:215], v[164:167], v[100:103]
    ds_read_b64_tr_b16 v[234:235], v51 offset:50176
    v_mfma_f32_16x16x32_bf16 v[104:107], v[216:219], v[164:167], v[104:107]
    ds_read_b128 v[192:195], v45 offset:47104
    v_mfma_f32_16x16x32_bf16 v[120:123], v[216:219], v[168:171], v[120:123]
    ds_read_b128 v[196:199], v45 offset:49152
    v_mfma_f32_16x16x32_bf16 v[116:119], v[212:215], v[168:171], v[116:119]
    ds_read_b128 v[200:203], v45 offset:51200
    v_mfma_f32_16x16x32_bf16 v[112:115], v[208:211], v[168:171], v[112:115]
    v_mfma_f32_16x16x32_bf16 v[108:111], v[204:207], v[168:171], v[108:111]
    v_mfma_f32_16x16x32_bf16 v[124:127], v[204:207], v[172:175], v[124:127]
    v_mfma_f32_16x16x32_bf16 v[128:131], v[208:211], v[172:175], v[128:131]
    v_mfma_f32_16x16x32_bf16 v[132:135], v[212:215], v[172:175], v[132:135]
    v_mfma_f32_16x16x32_bf16 v[136:139], v[216:219], v[172:175], v[136:139]
    v_mfma_f32_16x16x32_bf16 v[152:155], v[216:219], v[176:179], v[152:155]
    v_mfma_f32_16x16x32_bf16 v[148:151], v[212:215], v[176:179], v[148:151]
    v_mfma_f32_16x16x32_bf16 v[144:147], v[208:211], v[176:179], v[144:147]
    v_mfma_f32_16x16x32_bf16 v[140:143], v[204:207], v[176:179], v[140:143]
    s_waitcnt lgkmcnt(0)
    s_barrier
    v_mfma_f32_16x16x32_bf16 v[60:63], v[220:223], v[180:183], v[60:63]
    ds_read_b64_tr_b16 v[204:205], v52 offset:0
    v_mfma_f32_16x16x32_bf16 v[64:67], v[224:227], v[180:183], v[64:67]
    ds_read_b64_tr_b16 v[206:207], v52 offset:1024
    v_mfma_f32_16x16x32_bf16 v[68:71], v[228:231], v[180:183], v[68:71]
    ds_read_b128 v[156:159], v46 offset:0
    v_mfma_f32_16x16x32_bf16 v[72:75], v[232:235], v[180:183], v[72:75]
    ds_read_b64_tr_b16 v[208:209], v53 offset:0
    v_mfma_f32_16x16x32_bf16 v[88:91], v[232:235], v[184:187], v[88:91]
    ds_read_b64_tr_b16 v[210:211], v53 offset:1024
    v_mfma_f32_16x16x32_bf16 v[84:87], v[228:231], v[184:187], v[84:87]
    ds_read_b128 v[160:163], v46 offset:2048
    v_mfma_f32_16x16x32_bf16 v[80:83], v[224:227], v[184:187], v[80:83]
    ds_read_b64_tr_b16 v[212:213], v54 offset:0
    v_mfma_f32_16x16x32_bf16 v[76:79], v[220:223], v[184:187], v[76:79]
    ds_read_b64_tr_b16 v[214:215], v54 offset:1024
    v_mfma_f32_16x16x32_bf16 v[92:95], v[220:223], v[188:191], v[92:95]
    ds_read_b128 v[164:167], v46 offset:4096
    v_mfma_f32_16x16x32_bf16 v[96:99], v[224:227], v[188:191], v[96:99]
    ds_read_b64_tr_b16 v[216:217], v55 offset:0
    v_mfma_f32_16x16x32_bf16 v[100:103], v[228:231], v[188:191], v[100:103]
    ds_read_b64_tr_b16 v[218:219], v55 offset:1024
    v_mfma_f32_16x16x32_bf16 v[104:107], v[232:235], v[188:191], v[104:107]
    ds_read_b128 v[168:171], v46 offset:6144
    v_mfma_f32_16x16x32_bf16 v[120:123], v[232:235], v[192:195], v[120:123]
    ds_read_b128 v[172:175], v46 offset:8192
    v_mfma_f32_16x16x32_bf16 v[116:119], v[228:231], v[192:195], v[116:119]
    ds_read_b128 v[176:179], v46 offset:10240
    v_mfma_f32_16x16x32_bf16 v[112:115], v[224:227], v[192:195], v[112:115]
    v_mfma_f32_16x16x32_bf16 v[108:111], v[220:223], v[192:195], v[108:111]
    v_mfma_f32_16x16x32_bf16 v[124:127], v[220:223], v[196:199], v[124:127]
    v_mfma_f32_16x16x32_bf16 v[128:131], v[224:227], v[196:199], v[128:131]
    v_mfma_f32_16x16x32_bf16 v[132:135], v[228:231], v[196:199], v[132:135]
    v_mfma_f32_16x16x32_bf16 v[136:139], v[232:235], v[196:199], v[136:139]
    v_mfma_f32_16x16x32_bf16 v[152:155], v[232:235], v[200:203], v[152:155]
    v_mfma_f32_16x16x32_bf16 v[148:151], v[228:231], v[200:203], v[148:151]
    v_mfma_f32_16x16x32_bf16 v[144:147], v[224:227], v[200:203], v[144:147]
    v_mfma_f32_16x16x32_bf16 v[140:143], v[220:223], v[200:203], v[140:143]
    s_waitcnt lgkmcnt(0)
    v_mfma_f32_16x16x32_bf16 v[60:63], v[204:207], v[156:159], v[60:63]
    ds_read_b64_tr_b16 v[220:221], v52 offset:8192
    v_mfma_f32_16x16x32_bf16 v[64:67], v[208:211], v[156:159], v[64:67]
    ds_read_b64_tr_b16 v[222:223], v52 offset:9216
    v_mfma_f32_16x16x32_bf16 v[68:71], v[212:215], v[156:159], v[68:71]
    ds_read_b128 v[180:183], v47 offset:0
    v_mfma_f32_16x16x32_bf16 v[72:75], v[216:219], v[156:159], v[72:75]
    ds_read_b64_tr_b16 v[224:225], v53 offset:8192
    v_mfma_f32_16x16x32_bf16 v[88:91], v[216:219], v[160:163], v[88:91]
    ds_read_b64_tr_b16 v[226:227], v53 offset:9216
    v_mfma_f32_16x16x32_bf16 v[84:87], v[212:215], v[160:163], v[84:87]
    ds_read_b128 v[184:187], v47 offset:2048
    v_mfma_f32_16x16x32_bf16 v[80:83], v[208:211], v[160:163], v[80:83]
    ds_read_b64_tr_b16 v[228:229], v54 offset:8192
    v_mfma_f32_16x16x32_bf16 v[76:79], v[204:207], v[160:163], v[76:79]
    ds_read_b64_tr_b16 v[230:231], v54 offset:9216
    v_mfma_f32_16x16x32_bf16 v[92:95], v[204:207], v[164:167], v[92:95]
    ds_read_b128 v[188:191], v47 offset:4096
    v_mfma_f32_16x16x32_bf16 v[96:99], v[208:211], v[164:167], v[96:99]
    ds_read_b64_tr_b16 v[232:233], v55 offset:8192
    v_mfma_f32_16x16x32_bf16 v[100:103], v[212:215], v[164:167], v[100:103]
    ds_read_b64_tr_b16 v[234:235], v55 offset:9216
    v_mfma_f32_16x16x32_bf16 v[104:107], v[216:219], v[164:167], v[104:107]
    ds_read_b128 v[192:195], v47 offset:6144
    v_mfma_f32_16x16x32_bf16 v[120:123], v[216:219], v[168:171], v[120:123]
    ds_read_b128 v[196:199], v47 offset:8192
    v_mfma_f32_16x16x32_bf16 v[116:119], v[212:215], v[168:171], v[116:119]
    ds_read_b128 v[200:203], v47 offset:10240
    v_mfma_f32_16x16x32_bf16 v[112:115], v[208:211], v[168:171], v[112:115]
    v_mfma_f32_16x16x32_bf16 v[108:111], v[204:207], v[168:171], v[108:111]
    v_mfma_f32_16x16x32_bf16 v[124:127], v[204:207], v[172:175], v[124:127]
    v_mfma_f32_16x16x32_bf16 v[128:131], v[208:211], v[172:175], v[128:131]
    v_mfma_f32_16x16x32_bf16 v[132:135], v[212:215], v[172:175], v[132:135]
    v_mfma_f32_16x16x32_bf16 v[136:139], v[216:219], v[172:175], v[136:139]
    v_mfma_f32_16x16x32_bf16 v[152:155], v[216:219], v[176:179], v[152:155]
    v_mfma_f32_16x16x32_bf16 v[148:151], v[212:215], v[176:179], v[148:151]
    v_mfma_f32_16x16x32_bf16 v[144:147], v[208:211], v[176:179], v[144:147]
    v_mfma_f32_16x16x32_bf16 v[140:143], v[204:207], v[176:179], v[140:143]
    s_waitcnt lgkmcnt(0)
    s_barrier
    v_mfma_f32_16x16x32_bf16 v[60:63], v[220:223], v[180:183], v[60:63]
    ds_read_b64_tr_b16 v[204:205], v48 offset:0
    v_mfma_f32_16x16x32_bf16 v[64:67], v[224:227], v[180:183], v[64:67]
    ds_read_b64_tr_b16 v[206:207], v48 offset:1024
    v_mfma_f32_16x16x32_bf16 v[68:71], v[228:231], v[180:183], v[68:71]
    ds_read_b128 v[156:159], v44 offset:0
    v_mfma_f32_16x16x32_bf16 v[72:75], v[232:235], v[180:183], v[72:75]
    ds_read_b64_tr_b16 v[208:209], v49 offset:0
    v_mfma_f32_16x16x32_bf16 v[88:91], v[232:235], v[184:187], v[88:91]
    ds_read_b64_tr_b16 v[210:211], v49 offset:1024
    v_mfma_f32_16x16x32_bf16 v[84:87], v[228:231], v[184:187], v[84:87]
    ds_read_b128 v[160:163], v44 offset:2048
    v_mfma_f32_16x16x32_bf16 v[80:83], v[224:227], v[184:187], v[80:83]
    ds_read_b64_tr_b16 v[212:213], v50 offset:0
    v_mfma_f32_16x16x32_bf16 v[76:79], v[220:223], v[184:187], v[76:79]
    ds_read_b64_tr_b16 v[214:215], v50 offset:1024
    v_mfma_f32_16x16x32_bf16 v[92:95], v[220:223], v[188:191], v[92:95]
    ds_read_b128 v[164:167], v44 offset:4096
    v_mfma_f32_16x16x32_bf16 v[96:99], v[224:227], v[188:191], v[96:99]
    ds_read_b64_tr_b16 v[216:217], v51 offset:0
    v_mfma_f32_16x16x32_bf16 v[100:103], v[228:231], v[188:191], v[100:103]
    ds_read_b64_tr_b16 v[218:219], v51 offset:1024
    v_mfma_f32_16x16x32_bf16 v[104:107], v[232:235], v[188:191], v[104:107]
    ds_read_b128 v[168:171], v44 offset:6144
    v_mfma_f32_16x16x32_bf16 v[120:123], v[232:235], v[192:195], v[120:123]
    ds_read_b128 v[172:175], v44 offset:8192
    v_mfma_f32_16x16x32_bf16 v[116:119], v[228:231], v[192:195], v[116:119]
    ds_read_b128 v[176:179], v44 offset:10240
    v_mfma_f32_16x16x32_bf16 v[112:115], v[224:227], v[192:195], v[112:115]
    v_mfma_f32_16x16x32_bf16 v[108:111], v[220:223], v[192:195], v[108:111]
    v_mfma_f32_16x16x32_bf16 v[124:127], v[220:223], v[196:199], v[124:127]
    v_mfma_f32_16x16x32_bf16 v[128:131], v[224:227], v[196:199], v[128:131]
    v_mfma_f32_16x16x32_bf16 v[132:135], v[228:231], v[196:199], v[132:135]
    v_mfma_f32_16x16x32_bf16 v[136:139], v[232:235], v[196:199], v[136:139]
    v_mfma_f32_16x16x32_bf16 v[152:155], v[232:235], v[200:203], v[152:155]
    v_mfma_f32_16x16x32_bf16 v[148:151], v[228:231], v[200:203], v[148:151]
    v_mfma_f32_16x16x32_bf16 v[144:147], v[224:227], v[200:203], v[144:147]
    v_mfma_f32_16x16x32_bf16 v[140:143], v[220:223], v[200:203], v[140:143]
    s_waitcnt lgkmcnt(0)
    v_mfma_f32_16x16x32_bf16 v[60:63], v[204:207], v[156:159], v[60:63]
    ds_read_b64_tr_b16 v[220:221], v48 offset:8192
    v_mfma_f32_16x16x32_bf16 v[64:67], v[208:211], v[156:159], v[64:67]
    ds_read_b64_tr_b16 v[222:223], v48 offset:9216
    v_mfma_f32_16x16x32_bf16 v[68:71], v[212:215], v[156:159], v[68:71]
    ds_read_b128 v[180:183], v45 offset:0
    v_mfma_f32_16x16x32_bf16 v[72:75], v[216:219], v[156:159], v[72:75]
    ds_read_b64_tr_b16 v[224:225], v49 offset:8192
    v_mfma_f32_16x16x32_bf16 v[88:91], v[216:219], v[160:163], v[88:91]
    ds_read_b64_tr_b16 v[226:227], v49 offset:9216
    v_mfma_f32_16x16x32_bf16 v[84:87], v[212:215], v[160:163], v[84:87]
    ds_read_b128 v[184:187], v45 offset:2048
    v_mfma_f32_16x16x32_bf16 v[80:83], v[208:211], v[160:163], v[80:83]
    ds_read_b64_tr_b16 v[228:229], v50 offset:8192
    v_mfma_f32_16x16x32_bf16 v[76:79], v[204:207], v[160:163], v[76:79]
    ds_read_b64_tr_b16 v[230:231], v50 offset:9216
    v_mfma_f32_16x16x32_bf16 v[92:95], v[204:207], v[164:167], v[92:95]
    ds_read_b128 v[188:191], v45 offset:4096
    v_mfma_f32_16x16x32_bf16 v[96:99], v[208:211], v[164:167], v[96:99]
    ds_read_b64_tr_b16 v[232:233], v51 offset:8192
    v_mfma_f32_16x16x32_bf16 v[100:103], v[212:215], v[164:167], v[100:103]
    ds_read_b64_tr_b16 v[234:235], v51 offset:9216
    v_mfma_f32_16x16x32_bf16 v[104:107], v[216:219], v[164:167], v[104:107]
    ds_read_b128 v[192:195], v45 offset:6144
    v_mfma_f32_16x16x32_bf16 v[120:123], v[216:219], v[168:171], v[120:123]
    ds_read_b128 v[196:199], v45 offset:8192
    v_mfma_f32_16x16x32_bf16 v[116:119], v[212:215], v[168:171], v[116:119]
    ds_read_b128 v[200:203], v45 offset:10240
    v_mfma_f32_16x16x32_bf16 v[112:115], v[208:211], v[168:171], v[112:115]
    v_mfma_f32_16x16x32_bf16 v[108:111], v[204:207], v[168:171], v[108:111]
    v_mfma_f32_16x16x32_bf16 v[124:127], v[204:207], v[172:175], v[124:127]
    v_mfma_f32_16x16x32_bf16 v[128:131], v[208:211], v[172:175], v[128:131]
    v_mfma_f32_16x16x32_bf16 v[132:135], v[212:215], v[172:175], v[132:135]
    v_mfma_f32_16x16x32_bf16 v[136:139], v[216:219], v[172:175], v[136:139]
    v_mfma_f32_16x16x32_bf16 v[152:155], v[216:219], v[176:179], v[152:155]
    v_mfma_f32_16x16x32_bf16 v[148:151], v[212:215], v[176:179], v[148:151]
    v_mfma_f32_16x16x32_bf16 v[144:147], v[208:211], v[176:179], v[144:147]
    v_mfma_f32_16x16x32_bf16 v[140:143], v[204:207], v[176:179], v[140:143]
    s_waitcnt lgkmcnt(0)
    s_barrier
    v_mfma_f32_16x16x32_bf16 v[60:63], v[220:223], v[180:183], v[60:63]
    ds_read_b64_tr_b16 v[204:205], v48 offset:40960
    v_mfma_f32_16x16x32_bf16 v[64:67], v[224:227], v[180:183], v[64:67]
    ds_read_b64_tr_b16 v[206:207], v48 offset:41984
    v_mfma_f32_16x16x32_bf16 v[68:71], v[228:231], v[180:183], v[68:71]
    ds_read_b128 v[156:159], v44 offset:40960
    v_mfma_f32_16x16x32_bf16 v[72:75], v[232:235], v[180:183], v[72:75]
    ds_read_b64_tr_b16 v[208:209], v49 offset:40960
    v_mfma_f32_16x16x32_bf16 v[88:91], v[232:235], v[184:187], v[88:91]
    ds_read_b64_tr_b16 v[210:211], v49 offset:41984
    v_mfma_f32_16x16x32_bf16 v[84:87], v[228:231], v[184:187], v[84:87]
    ds_read_b128 v[160:163], v44 offset:43008
    v_mfma_f32_16x16x32_bf16 v[80:83], v[224:227], v[184:187], v[80:83]
    ds_read_b64_tr_b16 v[212:213], v50 offset:40960
    v_mfma_f32_16x16x32_bf16 v[76:79], v[220:223], v[184:187], v[76:79]
    ds_read_b64_tr_b16 v[214:215], v50 offset:41984
    v_mfma_f32_16x16x32_bf16 v[92:95], v[220:223], v[188:191], v[92:95]
    ds_read_b128 v[164:167], v44 offset:45056
    v_mfma_f32_16x16x32_bf16 v[96:99], v[224:227], v[188:191], v[96:99]
    ds_read_b64_tr_b16 v[216:217], v51 offset:40960
    v_mfma_f32_16x16x32_bf16 v[100:103], v[228:231], v[188:191], v[100:103]
    ds_read_b64_tr_b16 v[218:219], v51 offset:41984
    v_mfma_f32_16x16x32_bf16 v[104:107], v[232:235], v[188:191], v[104:107]
    ds_read_b128 v[168:171], v44 offset:47104
    v_mfma_f32_16x16x32_bf16 v[120:123], v[232:235], v[192:195], v[120:123]
    ds_read_b128 v[172:175], v44 offset:49152
    v_mfma_f32_16x16x32_bf16 v[116:119], v[228:231], v[192:195], v[116:119]
    ds_read_b128 v[176:179], v44 offset:51200
    v_mfma_f32_16x16x32_bf16 v[112:115], v[224:227], v[192:195], v[112:115]
    s_sub_u32 s54, s54, 1
    v_mfma_f32_16x16x32_bf16 v[108:111], v[220:223], v[192:195], v[108:111]
    s_cmp_lg_u32 s54, 0
    v_mfma_f32_16x16x32_bf16 v[124:127], v[220:223], v[196:199], v[124:127]
    v_mfma_f32_16x16x32_bf16 v[128:131], v[224:227], v[196:199], v[128:131]
    v_mfma_f32_16x16x32_bf16 v[132:135], v[228:231], v[196:199], v[132:135]
    v_mfma_f32_16x16x32_bf16 v[136:139], v[232:235], v[196:199], v[136:139]
    v_mfma_f32_16x16x32_bf16 v[152:155], v[232:235], v[200:203], v[152:155]
    v_mfma_f32_16x16x32_bf16 v[148:151], v[228:231], v[200:203], v[148:151]
    v_mfma_f32_16x16x32_bf16 v[144:147], v[224:227], v[200:203], v[144:147]
    v_mfma_f32_16x16x32_bf16 v[140:143], v[220:223], v[200:203], v[140:143]
    s_cbranch_scc1 K_CLOOP
    s_waitcnt lgkmcnt(0)
    v_mfma_f32_16x16x32_bf16 v[60:63], v[204:207], v[156:159], v[60:63]
    ds_read_b128 v[180:183], v45 offset:40960
    ds_read_b64_tr_b16 v[220:221], v48 offset:49152
    v_mfma_f32_16x16x32_bf16 v[64:67], v[208:211], v[156:159], v[64:67]
    ds_read_b64_tr_b16 v[222:223], v48 offset:50176
    ds_read_b64_tr_b16 v[224:225], v49 offset:49152
    v_mfma_f32_16x16x32_bf16 v[68:71], v[212:215], v[156:159], v[68:71]
    ds_read_b64_tr_b16 v[226:227], v49 offset:50176
    ds_read_b64_tr_b16 v[228:229], v50 offset:49152
    v_mfma_f32_16x16x32_bf16 v[72:75], v[216:219], v[156:159], v[72:75]
    ds_read_b64_tr_b16 v[230:231], v50 offset:50176
    ds_read_b64_tr_b16 v[232:233], v51 offset:49152
    v_mfma_f32_16x16x32_bf16 v[76:79], v[204:207], v[160:163], v[76:79]
    ds_read_b64_tr_b16 v[234:235], v51 offset:50176
    ds_read_b128 v[184:187], v45 offset:43008
    v_mfma_f32_16x16x32_bf16 v[80:83], v[208:211], v[160:163], v[80:83]
    ds_read_b128 v[188:191], v45 offset:45056
    ds_read_b128 v[192:195], v45 offset:47104
    v_mfma_f32_16x16x32_bf16 v[84:87], v[212:215], v[160:163], v[84:87]
    ds_read_b128 v[196:199], v45 offset:49152
    ds_read_b128 v[200:203], v45 offset:51200
    v_mfma_f32_16x16x32_bf16 v[88:91], v[216:219], v[160:163], v[88:91]
    s_waitcnt lgkmcnt(11)
    v_mfma_f32_16x16x32_bf16 v[60:63], v[220:223], v[180:183], v[60:63]
    s_nop 1
    s_waitcnt lgkmcnt(9)
    v_mfma_f32_16x16x32_bf16 v[64:67], v[224:227], v[180:183], v[64:67]
    s_nop 1
    s_waitcnt lgkmcnt(7)
    v_mfma_f32_16x16x32_bf16 v[68:71], v[228:231], v[180:183], v[68:71]
    v_cvt_pk_bf16_f32 v60, v60, v61
    v_cvt_pk_bf16_f32 v61, v62, v63
    s_waitcnt lgkmcnt(5)
    v_mfma_f32_16x16x32_bf16 v[72:75], v[232:235], v[180:183], v[72:75]
    ds_write_b64 v56, v[60:61] offset:0
    s_waitcnt lgkmcnt(5)
    v_mfma_f32_16x16x32_bf16 v[76:79], v[220:223], v[184:187], v[76:79]
    v_cvt_pk_bf16_f32 v64, v64, v65
    v_cvt_pk_bf16_f32 v65, v66, v67
    v_mfma_f32_16x16x32_bf16 v[80:83], v[224:227], v[184:187], v[80:83]
    ds_write_b64 v56, v[64:65] offset:32
    v_mfma_f32_16x16x32_bf16 v[84:87], v[228:231], v[184:187], v[84:87]
    v_cvt_pk_bf16_f32 v68, v68, v69
    v_cvt_pk_bf16_f32 v69, v70, v71
    v_mfma_f32_16x16x32_bf16 v[88:91], v[232:235], v[184:187], v[88:91]
    ds_write_b64 v56, v[68:69] offset:64
    v_mfma_f32_16x16x32_bf16 v[92:95], v[204:207], v[164:167], v[92:95]
    v_cvt_pk_bf16_f32 v72, v72, v73
    v_cvt_pk_bf16_f32 v73, v74, v75
    v_mfma_f32_16x16x32_bf16 v[96:99], v[208:211], v[164:167], v[96:99]
    ds_write_b64 v56, v[72:73] offset:96
    v_mfma_f32_16x16x32_bf16 v[100:103], v[212:215], v[164:167], v[100:103]
    v_cvt_pk_bf16_f32 v76, v76, v77
    v_cvt_pk_bf16_f32 v77, v78, v79
    v_mfma_f32_16x16x32_bf16 v[104:107], v[216:219], v[164:167], v[104:107]
    ds_write_b64 v56, v[76:77] offset:4352
    s_waitcnt lgkmcnt(8)
    v_mfma_f32_16x16x32_bf16 v[92:95], v[220:223], v[188:191], v[92:95]
    v_cvt_pk_bf16_f32 v80, v80, v81
    v_cvt_pk_bf16_f32 v81, v82, v83
    v_mfma_f32_16x16x32_bf16 v[96:99], v[224:227], v[188:191], v[96:99]
    ds_write_b64 v56, v[80:81] offset:4384
    v_mfma_f32_16x16x32_bf16 v[100:103], v[228:231], v[188:191], v[100:103]
    v_cvt_pk_bf16_f32 v84, v84, v85
    v_cvt_pk_bf16_f32 v85, v86, v87
    v_mfma_f32_16x16x32_bf16 v[104:107], v[232:235], v[188:191], v[104:107]
    ds_write_b64 v56, v[84:85] offset:4416
    v_mfma_f32_16x16x32_bf16 v[108:111], v[204:207], v[168:171], v[108:111]
    v_cvt_pk_bf16_f32 v88, v88, v89
    v_cvt_pk_bf16_f32 v89, v90, v91
    v_mfma_f32_16x16x32_bf16 v[112:115], v[208:211], v[168:171], v[112:115]
    ds_write_b64 v56, v[88:89] offset:4448
    v_mfma_f32_16x16x32_bf16 v[116:119], v[212:215], v[168:171], v[116:119]
    v_cvt_pk_bf16_f32 v92, v92, v93
    v_cvt_pk_bf16_f32 v93, v94, v95
    v_mfma_f32_16x16x32_bf16 v[120:123], v[216:219], v[168:171], v[120:123]
    ds_write_b64 v56, v[92:93] offset:8704
    s_waitcnt lgkmcnt(11)
    v_mfma_f32_16x16x32_bf16 v[108:111], v[220:223], v[192:195], v[108:111]
    v_cvt_pk_bf16_f32 v96, v96, v97
    v_cvt_pk_bf16_f32 v97, v98, v99
    v_mfma_f32_16x16x32_bf16 v[112:115], v[224:227], v[192:195], v[112:115]
    ds_write_b64 v56, v[96:97] offset:8736
    v_mfma_f32_16x16x32_bf16 v[116:119], v[228:231], v[192:195], v[116:119]
    v_cvt_pk_bf16_f32 v100, v100, v101
    v_cvt_pk_bf16_f32 v101, v102, v103
    v_mfma_f32_16x16x32_bf16 v[120:123], v[232:235], v[192:195], v[120:123]
    ds_write_b64 v56, v[100:101] offset:8768
    v_mfma_f32_16x16x32_bf16 v[124:127], v[204:207], v[172:175], v[124:127]
    v_cvt_pk_bf16_f32 v104, v104, v105
    v_cvt_pk_bf16_f32 v105, v106, v107
    v_mfma_f32_16x16x32_bf16 v[128:131], v[208:211], v[172:175], v[128:131]
    ds_write_b64 v56, v[104:105] offset:8800
    v_mfma_f32_16x16x32_bf16 v[132:135], v[212:215], v[172:175], v[132:135]
    v_cvt_pk_bf16_f32 v108, v108, v109
    v_cvt_pk_bf16_f32 v109, v110, v111
    v_mfma_f32_16x16x32_bf16 v[136:139], v[216:219], v[172:175], v[136:139]
    ds_write_b64 v56, v[108:109] offset:13056
    s_waitcnt lgkmcnt(14)
    v_mfma_f32_16x16x32_bf16 v[124:127], v[220:223], v[196:199], v[124:127]
    v_cvt_pk_bf16_f32 v112, v112, v113
    v_cvt_pk_bf16_f32 v113, v114, v115
    v_mfma_f32_16x16x32_bf16 v[128:131], v[224:227], v[196:199], v[128:131]
    ds_write_b64 v56, v[112:113] offset:13088
    v_mfma_f32_16x16x32_bf16 v[132:135], v[228:231], v[196:199], v[132:135]
    v_cvt_pk_bf16_f32 v116, v116, v117
    v_cvt_pk_bf16_f32 v117, v118, v119
    v_mfma_f32_16x16x32_bf16 v[136:139], v[232:235], v[196:199], v[136:139]
    ds_write_b64 v56, v[116:117] offset:13120
    v_mfma_f32_16x16x32_bf16 v[140:143], v[204:207], v[176:179], v[140:143]
    v_cvt_pk_bf16_f32 v120, v120, v121
    v_cvt_pk_bf16_f32 v121, v122, v123
    v_mfma_f32_16x16x32_bf16 v[144:147], v[208:211], v[176:179], v[144:147]
    ds_write_b64 v56, v[120:121] offset:13152
    v_mfma_f32_16x16x32_bf16 v[148:151], v[212:215], v[176:179], v[148:151]
    v_cvt_pk_bf16_f32 v124, v124, v125
    v_cvt_pk_bf16_f32 v125, v126, v127
    v_mfma_f32_16x16x32_bf16 v[152:155], v[216:219], v[176:179], v[152:155]
    ds_write_b64 v56, v[124:125] offset:17408
    s_waitcnt lgkmcnt(15)
    v_mfma_f32_16x16x32_bf16 v[140:143], v[220:223], v[200:203], v[140:143]
    v_cvt_pk_bf16_f32 v128, v128, v129
    v_cvt_pk_bf16_f32 v129, v130, v131
    v_mfma_f32_16x16x32_bf16 v[144:147], v[224:227], v[200:203], v[144:147]
    ds_write_b64 v56, v[128:129] offset:17440
    v_mfma_f32_16x16x32_bf16 v[148:151], v[228:231], v[200:203], v[148:151]
    v_cvt_pk_bf16_f32 v132, v132, v133
    v_cvt_pk_bf16_f32 v133, v134, v135
    v_mfma_f32_16x16x32_bf16 v[152:155], v[232:235], v[200:203], v[152:155]
    ds_write_b64 v56, v[132:133] offset:17472
    v_cvt_pk_bf16_f32 v136, v136, v137
    v_cvt_pk_bf16_f32 v137, v138, v139
    v_cvt_pk_bf16_f32 v140, v140, v141
    v_cvt_pk_bf16_f32 v141, v142, v143
    v_cvt_pk_bf16_f32 v144, v144, v145
    v_cvt_pk_bf16_f32 v145, v146, v147
    v_cvt_pk_bf16_f32 v148, v148, v149
    v_cvt_pk_bf16_f32 v149, v150, v151
    v_cvt_pk_bf16_f32 v152, v152, v153
    v_cvt_pk_bf16_f32 v153, v154, v155
    ds_write_b64 v56, v[136:137] offset:17504
    ds_write_b64 v56, v[140:141] offset:21760
    ds_write_b64 v56, v[144:145] offset:21792
    ds_write_b64 v56, v[148:149] offset:21824
    ds_write_b64 v56, v[152:153] offset:21856
    s_setprio 0
    s_branch WS_attd
.p2align 12
WP_attd:
    s_setpc_b64 s[38:39]
WS_attd:
    s_waitcnt lgkmcnt(0)
    s_barrier
    ds_read_b64 v[60:61], v13 offset:80
    ds_read_b64 v[62:63], v14 offset:80
    ds_read_b64 v[44:45], v13 offset:4352
    ds_read_b64 v[46:47], v19 offset:4352
    ds_read_b64 v[64:65], v13 offset:4432
    ds_read_b64 v[66:67], v14 offset:4432
    ds_read_b64 v[72:73], v13 offset:120
    ds_read_b64 v[74:75], v14 offset:120
    ds_read_b64 v[48:49], v13 offset:4392
    ds_read_b64 v[50:51], v20 offset:4352
    ds_read_b64 v[76:77], v13 offset:4472
    ds_read_b64 v[78:79], v14 offset:4472
    ds_read_b64 v[52:53], v13 offset:8704
    ds_read_b64 v[54:55], v19 offset:8704
    ds_read_b64 v[68:69], v13 offset:8784
    ds_read_b64 v[70:71], v14 offset:8784
    s_waitcnt lgkmcnt(10)
    v_mfma_f32_16x16x32_bf16 v[116:119], v[60:63], v[44:47], v[36:39]
    v_mfma_f32_16x16x32_bf16 v[120:123], v[64:67], v[44:47], v[32:35]
    ds_read_b64 v[56:57], v13 offset:8744
    ds_read_b64 v[58:59], v20 offset:8704
    ds_read_b64 v[80:81], v13 offset:8824
    ds_read_b64 v[82:83], v14 offset:8824
    s_waitcnt lgkmcnt(8)
    v_mfma_f32_16x16x32_bf16 v[124:127], v[72:75], v[48:51], v[36:39]
    v_mfma_f32_16x16x32_bf16 v[128:131], v[76:79], v[48:51], v[32:35]
    s_waitcnt lgkmcnt(4)
    v_mfma_f32_16x16x32_bf16 v[132:135], v[64:67], v[52:55], v[28:31]
    v_mfma_f32_16x16x32_bf16 v[136:139], v[68:71], v[52:55], v[32:35]
    s_waitcnt lgkmcnt(0)
    v_mfma_f32_16x16x32_bf16 v[140:143], v[76:79], v[56:59], v[28:31]
    v_mfma_f32_16x16x32_bf16 v[144:147], v[80:83], v[56:59], v[32:35]
    ds_read_b64_tr_b16 v[84:85], v15 offset:160
    ds_read_b64_tr_b16 v[86:87], v15 offset:4512
    ds_read_b64_tr_b16 v[100:101], v21 offset:0
    ds_read_b64_tr_b16 v[102:103], v21 offset:4352
    v_max3_f32 v184, v116, v117, v120
    ds_read_b64_tr_b16 v[92:93], v15 offset:200
    v_max3_f32 v185, v118, v119, v122
    ds_read_b64_tr_b16 v[94:95], v15 offset:4552
    v_max_f32 v184, v184, v121
    ds_read_b64_tr_b16 v[104:105], v22 offset:0
    v_max_f32 v185, v185, v123
    ds_read_b64_tr_b16 v[106:107], v22 offset:4352
    v_max3_f32 v186, v124, v125, v128
    ds_read_b64_tr_b16 v[88:89], v15 offset:8864
    v_max3_f32 v187, v126, v127, v130
    ds_read_b64_tr_b16 v[108:109], v23 offset:4352
    v_max_f32 v186, v186, v129
    ds_read_b64_tr_b16 v[110:111], v23 offset:8704
    v_max_f32 v187, v187, v131
    ds_read_b64_tr_b16 v[96:97], v15 offset:8904
    v_max3_f32 v188, v132, v133, v136
    ds_read_b64_tr_b16 v[112:113], v24 offset:4352
    v_max3_f32 v189, v134, v135, v138
    ds_read_b64_tr_b16 v[114:115], v24 offset:8704
    v_max_f32 v188, v188, v137
    v_max_f32 v189, v189, v139
    v_max3_f32 v190, v140, v141, v144
    v_max3_f32 v191, v142, v143, v146
    v_max_f32 v190, v190, v145
    v_max_f32 v191, v191, v147
    v_cvt_pk_bf16_f32 v192, v184, v185
    v_cvt_pk_bf16_f32 v193, v186, v187
    v_cvt_pk_bf16_f32 v194, v188, v189
    v_cvt_pk_bf16_f32 v195, v190, v191
    v_lshlrev_b32 v184, 16, v192
    v_and_b32 v185, 0xffff0000, v192
    v_lshlrev_b32 v186, 16, v193
    v_and_b32 v187, 0xffff0000, v193
    v_lshlrev_b32 v188, 16, v194
    v_and_b32 v189, 0xffff0000, v194
    v_lshlrev_b32 v190, 16, v195
    v_and_b32 v191, 0xffff0000, v195
    v_pk_mul_f32 v[184:185], v[184:185], s[48:49]
    v_pk_mul_f32 v[186:187], v[186:187], s[48:49]
    v_pk_mul_f32 v[188:189], v[188:189], s[48:49]
    v_pk_mul_f32 v[190:191], v[190:191], s[48:49]
    v_cvt_pk_bf16_f32 v192, v184, v185
    v_cvt_pk_bf16_f32 v193, v186, v187
    v_cvt_pk_bf16_f32 v194, v188, v189
    v_cvt_pk_bf16_f32 v195, v190, v191
    v_permlane16_swap_b32 v192, v193
    s_nop 0
    v_permlane16_swap_b32 v194, v195
    s_nop 1
    v_permlane32_swap_b32 v192, v194
    v_permlane32_swap_b32 v193, v195
    v_lshlrev_b32 v184, 16, v192
    v_and_b32 v185, 0xffff0000, v192
    v_lshlrev_b32 v188, 16, v194
    v_and_b32 v189, 0xffff0000, v194
    v_lshlrev_b32 v186, 16, v193
    v_and_b32 v187, 0xffff0000, v193
    v_lshlrev_b32 v190, 16, v195
    v_and_b32 v191, 0xffff0000, v195
    v_max3_f32 v196, v184, v185, v188
    v_max3_f32 v197, v189, v186, v187
    v_max3_f32 v196, v196, v190, v191
    v_max_f32 v196, v196, v197
    v_mul_f32 v196, s46, v196
    v_pk_fma_f32 v[184:185], v[184:185], s[46:47], v[196:197] op_sel_hi:[1,1,0] neg_lo:[0,0,1] neg_hi:[0,0,1]
    v_pk_fma_f32 v[186:187], v[186:187], s[46:47], v[196:197] op_sel_hi:[1,1,0] neg_lo:[0,0,1] neg_hi:[0,0,1]
    v_pk_fma_f32 v[188:189], v[188:189], s[46:47], v[196:197] op_sel_hi:[1,1,0] neg_lo:[0,0,1] neg_hi:[0,0,1]
    v_pk_fma_f32 v[190:191], v[190:191], s[46:47], v[196:197] op_sel_hi:[1,1,0] neg_lo:[0,0,1] neg_hi:[0,0,1]
    v_exp_f32 v184, v184
    v_exp_f32 v185, v185
    v_exp_f32 v186, v186
    v_exp_f32 v187, v187
    v_exp_f32 v188, v188
    v_exp_f32 v189, v189
    v_exp_f32 v190, v190
    v_exp_f32 v191, v191
    v_pk_add_f32 v[200:201], v[184:185], v[186:187]
    v_pk_add_f32 v[202:203], v[188:189], v[190:191]
    v_pk_add_f32 v[200:201], v[200:201], v[202:203]
    v_add_f32 v200, v200, v201
    v_rcp_f32 v200, v200
    s_waitcnt lgkmcnt(0)
    v_pk_mul_f32 v[184:185], v[184:185], v[200:201] op_sel_hi:[1,0]
    v_pk_mul_f32 v[186:187], v[186:187], v[200:201] op_sel_hi:[1,0]
    v_pk_mul_f32 v[188:189], v[188:189], v[200:201] op_sel_hi:[1,0]
    v_pk_mul_f32 v[190:191], v[190:191], v[200:201] op_sel_hi:[1,0]
    v_cvt_pk_bf16_f32 v192, v184, v185
    v_cvt_pk_bf16_f32 v194, v188, v189
    v_cvt_pk_bf16_f32 v193, v186, v187
    v_cvt_pk_bf16_f32 v195, v190, v191
    v_permlane32_swap_b32 v192, v194
    s_nop 0
    v_permlane32_swap_b32 v193, v195
    s_nop 1
    v_permlane16_swap_b32 v192, v193
    v_permlane16_swap_b32 v194, v195
    v_perm_b32 v148, v192, v192, v40
    v_perm_b32 v149, v192, v192, v41
    v_perm_b32 v150, v192, v192, v42
    v_perm_b32 v151, v192, v192, v43
    v_perm_b32 v152, v193, v193, v40
    v_perm_b32 v153, v193, v193, v41
    v_perm_b32 v154, v193, v193, v42
    v_perm_b32 v155, v193, v193, v43
    v_mfma_f32_16x16x32_bf16 v[164:167], v[84:87], v[148:151], 0
    v_mfma_f32_16x16x32_bf16 v[180:183], v[100:103], v[148:151], 0
    v_perm_b32 v156, v194, v194, v40
    v_perm_b32 v157, v194, v194, v41
    v_perm_b32 v158, v194, v194, v42
    v_perm_b32 v159, v194, v194, v43
    v_mfma_f32_16x16x32_bf16 v[168:171], v[92:95], v[152:155], 0
    v_mfma_f32_16x16x32_bf16 v[180:183], v[104:107], v[152:155], v[180:183]
    v_perm_b32 v160, v195, v195, v40
    v_perm_b32 v161, v195, v195, v41
    v_perm_b32 v162, v195, v195, v42
    v_perm_b32 v163, v195, v195, v43
    v_mfma_f32_16x16x32_bf16 v[172:175], v[86:89], v[156:159], 0
    v_mfma_f32_16x16x32_bf16 v[180:183], v[108:111], v[156:159], v[180:183]
    v_mfma_f32_16x16x32_bf16 v[176:179], v[94:97], v[160:163], 0
    v_mfma_f32_16x16x32_bf16 v[180:183], v[112:115], v[160:163], v[180:183]
    v_cvt_pk_bf16_f32 v204, v164, v165
    v_cvt_pk_bf16_f32 v205, v166, v167
    v_cvt_pk_bf16_f32 v206, v168, v169
    v_cvt_pk_bf16_f32 v207, v170, v171
    buffer_store_dwordx4 v[204:207], v16, s[20:23], s50 offen sc1
    v_cvt_pk_bf16_f32 v208, v172, v173
    v_cvt_pk_bf16_f32 v209, v174, v175
    v_cvt_pk_bf16_f32 v210, v176, v177
    v_cvt_pk_bf16_f32 v211, v178, v179
    buffer_store_dwordx4 v[208:211], v16, s[20:23], s51 offen sc1
    v_cvt_pk_bf16_f32 v196, v180, v181
    v_cvt_pk_bf16_f32 v197, v182, v183
    buffer_store_dwordx2 v[196:197], v17, s[20:23], s50 offen sc1
    s_cmp_lg_u32 s34, -1
    s_cbranch_scc1 K_P2_EARLY
K_DRAIN:
    s_waitcnt vmcnt(0)
    s_barrier
    s_branch K_END
K_W7:
    s_waitcnt vmcnt(26)
    v_and_b32 v4, 7, v1
    v_lshlrev_b32 v4, 2, v4
    s_mov_b32 s3, 131072
K_ZPOLL5:
    v_cmp_eq_u32 vcc, 0, v7
    s_cbranch_vccz K_ZOK5
    s_sub_u32 s3, s3, 1
    s_cbranch_scc1 K_ZOK5
    global_load_dword v7, v4, s[8:9] offset:192 sc1
    s_waitcnt vmcnt(0)
    s_branch K_ZPOLL5
K_ZOK5:
    v_mov_b32 v4, 158720
    v_mov_b32 v3, 1
    s_mov_b64 exec, 1
    s_nop 0
    ds_add_rtn_u32 v2, v4, v3 offset:48
    s_mov_b32 exec_lo, s36
    v_mov_b32 v3, 1
    s_waitcnt lgkmcnt(0)
    v_readfirstlane_b32 s33, v2
    s_nop 3
    s_and_b32 s33, s33, 0xff
    s_cmp_lg_u32 s33, 7
    s_cbranch_scc1 K_ARR7
    global_store_dword v8, v3, s[10:11] sc1
K_ARR7:
    s_mov_b64 exec, -1
    v_mov_b32 v3, 0x100
    s_mov_b64 exec, 1
    s_waitcnt vmcnt(0)
    ds_add_u32 v4, v3 offset:48
    s_mov_b64 exec, -1
    s_branch K_P2_HELP
K_FLAG:
    s_waitcnt vmcnt(0)
    v_and_b32 v4, 7, v1
    v_lshlrev_b32 v4, 2, v4
    s_mov_b32 s3, 131072
K_ZPOLL0:
    v_cmp_eq_u32 vcc, 0, v7
    s_cbranch_vccz K_ZOK0
    s_sub_u32 s3, s3, 1
    s_cbranch_scc1 K_ZOK0
    global_load_dword v7, v4, s[8:9] offset:192 sc1
    s_waitcnt vmcnt(0)
    s_branch K_ZPOLL0
K_ZOK0:
    v_mov_b32 v3, 1
    s_mov_b32 exec_lo, s36
    s_mov_b32 exec_hi, 0
    s_setprio 3
    s_barrier
    global_store_dword v8, v3, s[10:11] sc1
    s_mov_b64 exec, -1
    s_branch K_END
WP_atts:
    s_setpc_b64 s[38:39]
K_JOIN_S:
    s_setprio 0
    s_barrier
    s_cmp_eq_u32 s30, 7
    s_cbranch_scc1 K_FLAG
    ds_read_b64 v[52:53], v13 offset:80
    ds_read_b64 v[54:55], v14 offset:80
    ds_read_b64 v[44:45], v13 offset:4352
    ds_read_b64 v[46:47], v19 offset:4352
    ds_read_b64 v[56:57], v13 offset:4432
    ds_read_b64 v[58:59], v14 offset:4432
    ds_read_b64 v[60:61], v13 offset:120
    ds_read_b64 v[62:63], v14 offset:120
    ds_read_b64 v[48:49], v13 offset:4392
    ds_read_b64 v[50:51], v20 offset:4352
    ds_read_b64 v[64:65], v13 offset:4472
    ds_read_b64 v[66:67], v14 offset:4472
    s_waitcnt lgkmcnt(6)
    v_mfma_f32_16x16x32_bf16 v[84:87], v[52:55], v[44:47], v[36:39]
    v_mfma_f32_16x16x32_bf16 v[88:91], v[56:59], v[44:47], v[32:35]
    s_waitcnt lgkmcnt(0)
    v_mfma_f32_16x16x32_bf16 v[92:95], v[60:63], v[48:51], v[36:39]
    v_mfma_f32_16x16x32_bf16 v[96:99], v[64:67], v[48:51], v[32:35]
    ds_read_b64_tr_b16 v[68:69], v15 offset:160
    ds_read_b64_tr_b16 v[70:71], v15 offset:4512
    ds_read_b64_tr_b16 v[76:77], v21 offset:0
    ds_read_b64_tr_b16 v[78:79], v21 offset:4352
    ds_read_b64_tr_b16 v[72:73], v15 offset:200
    ds_read_b64_tr_b16 v[74:75], v15 offset:4552
    ds_read_b64_tr_b16 v[80:81], v22 offset:0
    ds_read_b64_tr_b16 v[82:83], v22 offset:4352
    v_max3_f32 v120, v84, v85, v88
    v_max3_f32 v121, v86, v87, v90
    v_max_f32 v120, v120, v89
    v_max_f32 v121, v121, v91
    v_max3_f32 v122, v92, v93, v96
    v_max3_f32 v123, v94, v95, v98
    v_max_f32 v122, v122, v97
    v_max_f32 v123, v123, v99
    v_cvt_pk_bf16_f32 v124, v120, v121
    v_cvt_pk_bf16_f32 v125, v122, v123
    v_lshlrev_b32 v120, 16, v124
    v_and_b32 v121, 0xffff0000, v124
    v_lshlrev_b32 v122, 16, v125
    v_and_b32 v123, 0xffff0000, v125
    v_pk_mul_f32 v[120:121], v[120:121], s[48:49]
    v_pk_mul_f32 v[122:123], v[122:123], s[48:49]
    v_cvt_pk_bf16_f32 v124, v120, v121
    v_cvt_pk_bf16_f32 v125, v122, v123
    s_nop 1
    v_permlane16_swap_b32 v124, v125
    v_lshlrev_b32 v120, 16, v124
    v_and_b32 v121, 0xffff0000, v124
    v_lshlrev_b32 v122, 16, v125
    v_and_b32 v123, 0xffff0000, v125
    v_max3_f32 v126, v120, v121, v122
    v_max_f32 v126, v126, v123
    v_mov_b32 v127, v126
    s_nop 1
    v_permlane32_swap_b32 v126, v127
    v_max_f32 v126, v126, v127
    v_mul_f32 v126, s46, v126
    v_pk_fma_f32 v[120:121], v[120:121], s[46:47], v[126:127] op_sel_hi:[1,1,0] neg_lo:[0,0,1] neg_hi:[0,0,1]
    v_pk_fma_f32 v[122:123], v[122:123], s[46:47], v[126:127] op_sel_hi:[1,1,0] neg_lo:[0,0,1] neg_hi:[0,0,1]
    v_exp_f32 v120, v120
    v_exp_f32 v121, v121
    v_exp_f32 v122, v122
    v_exp_f32 v123, v123
    s_nop 0
    v_pk_add_f32 v[128:129], v[120:121], v[122:123]
    v_add_f32 v128, v128, v129
    v_mov_b32 v129, v128
    s_nop 1
    v_permlane32_swap_b32 v128, v129
    v_add_f32 v128, v128, v129
    v_rcp_f32 v128, v128
    s_waitcnt lgkmcnt(0)
    v_pk_mul_f32 v[120:121], v[120:121], v[128:129] op_sel_hi:[1,0]
    v_pk_mul_f32 v[122:123], v[122:123], v[128:129] op_sel_hi:[1,0]
    v_cvt_pk_bf16_f32 v124, v120, v121
    v_cvt_pk_bf16_f32 v125, v122, v123
    s_nop 1
    v_permlane16_swap_b32 v124, v125
    v_perm_b32 v100, v124, v124, v40
    v_perm_b32 v101, v124, v124, v41
    v_perm_b32 v102, v124, v124, v42
    v_perm_b32 v103, v124, v124, v43
    v_perm_b32 v104, v125, v125, v40
    v_perm_b32 v105, v125, v125, v41
    v_perm_b32 v106, v125, v125, v42
    v_perm_b32 v107, v125, v125, v43
    v_mfma_f32_16x16x32_bf16 v[108:111], v[68:71], v[100:103], 0
    v_mfma_f32_16x16x32_bf16 v[116:119], v[76:79], v[100:103], 0
    v_mfma_f32_16x16x32_bf16 v[112:115], v[72:75], v[104:107], 0
    v_mfma_f32_16x16x32_bf16 v[116:119], v[80:83], v[104:107], v[116:119]
    s_nop 4
    v_cvt_pk_bf16_f32 v132, v108, v109
    v_cvt_pk_bf16_f32 v133, v110, v111
    v_cvt_pk_bf16_f32 v134, v112, v113
    v_cvt_pk_bf16_f32 v135, v114, v115
    buffer_store_dwordx4 v[132:135], v16, s[20:23], s50 offen sc1
    v_cvt_pk_bf16_f32 v126, v116, v117
    v_cvt_pk_bf16_f32 v127, v118, v119
    buffer_store_dwordx2 v[126:127], v17, s[20:23], s50 offen sc1
    s_cmp_eq_u32 s34, -1
    s_cbranch_scc1 K_DRAIN
    s_cmp_lg_u32 s30, 6
    s_cbranch_scc1 K_NOFL
    s_waitcnt vmcnt(12)
    v_and_b32 v4, 7, v1
    v_lshlrev_b32 v4, 2, v4
    s_mov_b32 s3, 131072
K_ZPOLL2:
    v_cmp_eq_u32 vcc, 0, v7
    s_cbranch_vccz K_ZOK2
    s_sub_u32 s3, s3, 1
    s_cbranch_scc1 K_ZOK2
    global_load_dword v7, v4, s[8:9] offset:192 sc1
    s_waitcnt vmcnt(0)
    s_branch K_ZPOLL2
K_ZOK2:
    v_and_b32 v2, 1, v1
    v_lshl_add_u32 v2, v2, 2, s42
    global_load_dword v7, v2, s[10:11] offset:128 sc1
K_NOFL:
    v_mov_b32 v4, 158720
    v_mov_b32 v3, 257
    s_mov_b64 exec, 1
    s_waitcnt vmcnt(0)
    ds_add_rtn_u32 v2, v4, v3 offset:48
    s_mov_b32 exec_lo, s36
    v_mov_b32 v3, 1
    s_waitcnt lgkmcnt(0)
    v_readfirstlane_b32 s33, v2
    s_nop 3
    s_and_b32 s33, s33, 0xff
    s_cmp_lg_u32 s33, 7
    s_cbranch_scc1 K_ARRS
    global_store_dword v8, v3, s[10:11] sc1
K_ARRS:
    s_mov_b64 exec, -1
    s_cmp_ge_u32 s30, 6
    s_cbranch_scc1 K_P2_HELP
    s_branch K_LATE
WP_early:
    s_setpc_b64 s[38:39]
K_P2_EARLY:
    s_lshl_b32 s54, s40, 7
    v_lshrrev_b32 v9, 4, v1
    v_mov_b32 v12, 158720
    s_add_u32 s20, s10, 0x100000
    s_addc_u32 s21, s11, 0
    s_mov_b32 s22, 0x280000
    s_mov_b32 s23, 0x20000
    s_add_u32 s16, s10, 0x1000
    s_addc_u32 s17, s11, 0
    s_mov_b32 s18, 0x2000
    s_mov_b32 s19, 0x20000
    s_mov_b32 s48, s6
    s_mov_b32 s49, s7
    s_mov_b32 s50, 0x280000
    s_mov_b32 s51, 0x20000
    s_lshl_b32 s53, s40, 3
    s_lshl1_add_u32 s53, s30, s53
    s_mov_b32 s55, 20480
    v_bfe_u32 v20, v1, 2, 2
    v_and_b32 v21, 3, v1
    s_mul_i32 s3, s53, 20480
    v_lshl_add_u32 v25, v1, 4, s3
    v_add_u32 v26, 20480, v25
    v_and_b32 v2, 15, v1
    s_lshl_b32 s3, s53, 6
    v_lshl_add_u32 v23, v2, 2, s3
    v_lshl_add_u32 v2, v9, 2, v20
    v_bfe_u32 v3, v2, 1, 2
    v_lshlrev_b32 v2, 7, v2
    v_lshl_add_u32 v2, v21, 3, v2
    v_lshl_add_u32 v24, v3, 5, v2
    v_lshrrev_b32 v3, 1, v20
    v_mul_u32_u24 v2, 40, v9
    v_add3_u32 v2, v2, 16, v20
    v_lshlrev_b32 v2, 7, v2
    v_lshl_add_u32 v2, v21, 3, v2
    v_xor_b32 v4, 0, v3
    v_lshl_add_u32 v56, v4, 5, v2
    v_xor_b32 v4, 1, v3
    v_lshl_add_u32 v57, v4, 5, v2
    v_xor_b32 v4, 2, v3
    v_lshl_add_u32 v58, v4, 5, v2
    v_xor_b32 v4, 3, v3
    v_lshl_add_u32 v59, v4, 5, v2
    v_lshrrev_b32 v3, 4, v1
    v_and_b32 v4, 7, v1
    v_lshrrev_b32 v2, 3, v1
    v_xor_b32 v4, v4, v3
    v_mul_u32_u24 v2, 1280, v2
    v_lshl_add_u32 v27, v4, 4, v2
    v_xor_b32 v28, 64, v27
    s_lshl_b32 s71, s40, 3
    s_lshl1_add_u32 s71, s30, s71
    s_mul_i32 s71, s71, 20480
    s_lshl_b32 s33, s41, 7
    s_add_u32 s71, s71, s33
    s_add_u32 s72, s71, 10240
    s_add_u32 s73, s71, 20480
    s_add_u32 s74, s71, 30720
    s_lshl_b32 s3, s30, 12
    s_add_u32 s3, s3, 140288
    v_lshl_add_u32 v33, v1, 4, s3
    v_and_b32 v2, 15, v1
    v_lshrrev_b32 v3, 1, v2
    v_lshrrev_b32 v4, 5, v1
    v_xor_b32 v3, v3, v4
    v_lshlrev_b32 v3, 4, v3
    v_lshl_add_u32 v3, v2, 7, v3
    v_and_b32 v4, 1, v9
    v_lshl_add_u32 v3, v4, 3, v3
    v_add_u32 v29, s3, v3
    v_xor_b32 v30, 32, v29
    v_xor_b32 v31, 64, v29
    v_xor_b32 v32, 96, v29
    s_and_b32 s33, s40, 3
    s_lshl_b32 s33, s33, 3
    s_lshr_b32 s33, 0x7f06037f, s33
    s_and_b32 s33, s33, 0xff
    s_lshl_b32 s3, s30, 1
    s_cmp_ge_u32 s3, s33
    s_cselect_b32 s64, 16, 0
    s_add_u32 s3, s3, 1
    s_cmp_ge_u32 s3, s33
    s_cselect_b32 s65, 16, 0
    s_mov_b32 s63, 0
    s_mov_b32 s66, 0
    s_mov_b32 s67, 16384
    v_mov_b32 v4, 158720
    v_mov_b32 v3, 1
    s_mov_b64 exec, 1
    s_waitcnt vmcnt(0)
    ds_add_rtn_u32 v2, v4, v3 offset:48
    s_mov_b32 exec_lo, s36
    v_mov_b32 v3, 1
    s_waitcnt lgkmcnt(0)
    v_readfirstlane_b32 s33, v2
    s_nop 3
    s_and_b32 s33, s33, 0xff
    s_cmp_lg_u32 s33, 7
    s_cbranch_scc1 K_ARRD
    global_store_dword v8, v3, s[10:11] sc1
K_ARRD:
    s_mov_b64 exec, -1
    s_mov_b32 s3, 1048576
K_P2_GE:
    ds_read_b32 v2, v12 offset:48
    s_sub_u32 s3, s3, 1
    s_waitcnt lgkmcnt(0)
    v_readfirstlane_b32 s33, v2
    s_nop 3
    s_cselect_b32 s33, 1024, s33
    s_cmp_lt_u32 s33, 1024
    s_cbranch_scc1 K_P2_GE
K_P2_GEMM:
    s_setprio 2
    s_mov_b32 s3, 1048576
K_P2_GS:
    ds_read_b32 v2, v12 offset:40
    s_sub_u32 s3, s3, 1
    s_waitcnt lgkmcnt(0)
    v_readfirstlane_b32 s33, v2
    s_nop 3
    s_cselect_b32 s33, 1, s33
    s_cmp_lt_u32 s33, 1
    s_cbranch_scc1 K_P2_GS
    buffer_load_dword v60, v23, s[16:19], 0 offen offset:0 sc1
    buffer_load_dword v62, v23, s[16:19], 0 offen offset:64 sc1
    ds_read_b128 v[16:19], v12
    ds_read_b64 v[36:37], v29 offset:0
    ds_read_b64 v[38:39], v30 offset:0
    ds_read_b64 v[40:41], v31 offset:0
    ds_read_b64 v[42:43], v32 offset:0
    ds_read_b64 v[44:45], v29 offset:2048
    ds_read_b64 v[46:47], v30 offset:2048
    ds_read_b64 v[48:49], v31 offset:2048
    ds_read_b64 v[50:51], v32 offset:2048
    s_waitcnt lgkmcnt(4)
    v_lshlrev_b32 v68, 16, v36
    v_and_b32 v69, 0xffff0000, v36
    v_lshlrev_b32 v70, 16, v37
    v_and_b32 v71, 0xffff0000, v37
    v_lshlrev_b32 v72, 16, v38
    v_and_b32 v73, 0xffff0000, v38
    v_lshlrev_b32 v74, 16, v39
    v_and_b32 v75, 0xffff0000, v39
    v_lshlrev_b32 v76, 16, v40
    v_and_b32 v77, 0xffff0000, v40
    v_lshlrev_b32 v78, 16, v41
    v_and_b32 v79, 0xffff0000, v41
    v_lshlrev_b32 v80, 16, v42
    v_and_b32 v81, 0xffff0000, v42
    v_lshlrev_b32 v82, 16, v43
    v_and_b32 v83, 0xffff0000, v43
    s_waitcnt lgkmcnt(0)
    v_lshlrev_b32 v84, 16, v44
    v_and_b32 v85, 0xffff0000, v44
    v_lshlrev_b32 v86, 16, v45
    v_and_b32 v87, 0xffff0000, v45
    v_lshlrev_b32 v88, 16, v46
    v_and_b32 v89, 0xffff0000, v46
    v_lshlrev_b32 v90, 16, v47
    v_and_b32 v91, 0xffff0000, v47
    v_lshlrev_b32 v92, 16, v48
    v_and_b32 v93, 0xffff0000, v48
    v_lshlrev_b32 v94, 16, v49
    v_and_b32 v95, 0xffff0000, v49
    v_lshlrev_b32 v96, 16, v50
    v_and_b32 v97, 0xffff0000, v50
    v_lshlrev_b32 v98, 16, v51
    v_and_b32 v99, 0xffff0000, v51
    s_cmp_eq_u32 s63, 0
    s_cbranch_scc1 K_SP0
K_SPR0:
    s_ff1_i32_b32 s33, s63
    s_bitset0_b32 s63, s33
    s_lshl_b32 s75, s33, 10
    buffer_load_dwordx4 v[100:103], v25, s[20:23], s75 offen offset:0 sc1
    buffer_load_dwordx4 v[104:107], v26, s[20:23], s75 offen offset:0 sc1
    v_mad_u32_u24 v52, s75, 5, v24
    v_xor_b32 v54, 64, v52
    v_xor_b32 v53, 32, v52
    v_xor_b32 v55, 96, v52
    ds_read_b64_tr_b16 v[180:181], v52 offset:0
    ds_read_b64_tr_b16 v[182:183], v54 offset:2560
    ds_read_b64_tr_b16 v[184:185], v53 offset:0
    ds_read_b64_tr_b16 v[186:187], v55 offset:2560
    ds_read_b64_tr_b16 v[188:189], v54 offset:0
    ds_read_b64_tr_b16 v[190:191], v52 offset:2560
    ds_read_b64_tr_b16 v[192:193], v55 offset:0
    ds_read_b64_tr_b16 v[194:195], v53 offset:2560
    s_cmp_eq_u32 s63, 0
    s_cbranch_scc1 K_SP1
K_SPR1:
    s_ff1_i32_b32 s33, s63
    s_bitset0_b32 s63, s33
    s_lshl_b32 s76, s33, 10
    buffer_load_dwordx4 v[108:111], v25, s[20:23], s76 offen offset:0 sc1
    buffer_load_dwordx4 v[112:115], v26, s[20:23], s76 offen offset:0 sc1
    v_mad_u32_u24 v52, s76, 5, v24
    v_xor_b32 v54, 64, v52
    v_xor_b32 v53, 32, v52
    v_xor_b32 v55, 96, v52
    ds_read_b64_tr_b16 v[196:197], v52 offset:0
    ds_read_b64_tr_b16 v[198:199], v54 offset:2560
    ds_read_b64_tr_b16 v[200:201], v53 offset:0
    ds_read_b64_tr_b16 v[202:203], v55 offset:2560
    ds_read_b64_tr_b16 v[204:205], v54 offset:0
    ds_read_b64_tr_b16 v[206:207], v52 offset:2560
    ds_read_b64_tr_b16 v[208:209], v55 offset:0
    ds_read_b64_tr_b16 v[210:211], v53 offset:2560
    s_waitcnt vmcnt(4)
    v_sub_f32 v64, 1.0, v60
    v_cvt_pk_bf16_f32 v64, v64, v64
    v_lshlrev_b32 v64, 16, v64
    v_sub_f32 v66, 1.0, v62
    v_cvt_pk_bf16_f32 v66, v66, v66
    v_lshlrev_b32 v66, 16, v66
    v_pk_mul_f32 v[68:69], v[68:69], v[64:65] op_sel_hi:[1,0]
    v_pk_mul_f32 v[70:71], v[70:71], v[64:65] op_sel_hi:[1,0]
    v_pk_mul_f32 v[72:73], v[72:73], v[64:65] op_sel_hi:[1,0]
    v_pk_mul_f32 v[74:75], v[74:75], v[64:65] op_sel_hi:[1,0]
    v_pk_mul_f32 v[76:77], v[76:77], v[64:65] op_sel_hi:[1,0]
    v_pk_mul_f32 v[78:79], v[78:79], v[64:65] op_sel_hi:[1,0]
    v_pk_mul_f32 v[80:81], v[80:81], v[64:65] op_sel_hi:[1,0]
    v_pk_mul_f32 v[82:83], v[82:83], v[64:65] op_sel_hi:[1,0]
    v_pk_mul_f32 v[84:85], v[84:85], v[66:67] op_sel_hi:[1,0]
    v_pk_mul_f32 v[86:87], v[86:87], v[66:67] op_sel_hi:[1,0]
    v_pk_mul_f32 v[88:89], v[88:89], v[66:67] op_sel_hi:[1,0]
    v_pk_mul_f32 v[90:91], v[90:91], v[66:67] op_sel_hi:[1,0]
    v_pk_mul_f32 v[92:93], v[92:93], v[66:67] op_sel_hi:[1,0]
    v_pk_mul_f32 v[94:95], v[94:95], v[66:67] op_sel_hi:[1,0]
    v_pk_mul_f32 v[96:97], v[96:97], v[66:67] op_sel_hi:[1,0]
    v_pk_mul_f32 v[98:99], v[98:99], v[66:67] op_sel_hi:[1,0]
    s_cmp_eq_u32 s63, 0
    s_cbranch_scc1 K_SP2
K_SPR2:
    s_ff1_i32_b32 s33, s63
    s_bitset0_b32 s63, s33
    s_lshl_b32 s77, s33, 10
    buffer_load_dwordx4 v[116:119], v25, s[20:23], s77 offen offset:0 sc1
    buffer_load_dwordx4 v[120:123], v26, s[20:23], s77 offen offset:0 sc1
    s_cmp_eq_u32 s63, 0
    s_cbranch_scc1 K_SP3
K_SPR3:
    s_ff1_i32_b32 s33, s63
    s_bitset0_b32 s63, s33
    s_lshl_b32 s78, s33, 10
    buffer_load_dwordx4 v[124:127], v25, s[20:23], s78 offen offset:0 sc1
    buffer_load_dwordx4 v[128:131], v26, s[20:23], s78 offen offset:0 sc1
    s_cmp_eq_u32 s63, 0
    s_cbranch_scc1 K_SP4
K_SPR4:
    s_ff1_i32_b32 s33, s63
    s_bitset0_b32 s63, s33
    s_lshl_b32 s75, s33, 10
    buffer_load_dwordx4 v[132:135], v25, s[20:23], s75 offen offset:0 sc1
    buffer_load_dwordx4 v[136:139], v26, s[20:23], s75 offen offset:0 sc1
    s_branch WS_p2g
.p2align 12
WP_p2g:
    s_setpc_b64 s[38:39]
WS_p2g:
    s_waitcnt vmcnt(8) lgkmcnt(8)
    v_mfma_f32_16x16x32_bf16 v[148:151], v[180:183], v[100:103], 0
    v_mad_u32_u24 v52, s77, 5, v24
    v_xor_b32 v54, 64, v52
    v_xor_b32 v53, 32, v52
    v_mfma_f32_16x16x32_bf16 v[164:167], v[180:183], v[104:107], 0
    v_xor_b32 v55, 96, v52
    ds_read_b64_tr_b16 v[212:213], v52 offset:0
    ds_read_b64_tr_b16 v[214:215], v54 offset:2560
    v_mfma_f32_16x16x32_bf16 v[152:155], v[184:187], v[100:103], 0
    ds_read_b64_tr_b16 v[216:217], v53 offset:0
    ds_read_b64_tr_b16 v[218:219], v55 offset:2560
    ds_read_b64_tr_b16 v[220:221], v54 offset:0
    v_mfma_f32_16x16x32_bf16 v[168:171], v[184:187], v[104:107], 0
    ds_read_b64_tr_b16 v[222:223], v52 offset:2560
    ds_read_b64_tr_b16 v[224:225], v55 offset:0
    v_mfma_f32_16x16x32_bf16 v[156:159], v[188:191], v[100:103], 0
    ds_read_b64_tr_b16 v[226:227], v53 offset:2560
    s_cmp_eq_u32 s63, 0
    v_mfma_f32_16x16x32_bf16 v[172:175], v[188:191], v[104:107], 0
    s_cbranch_scc1 K_SP5
K_SPR5:
    s_ff1_i32_b32 s33, s63
    v_mfma_f32_16x16x32_bf16 v[160:163], v[192:195], v[100:103], 0
    s_bitset0_b32 s63, s33
    s_lshl_b32 s76, s33, 10
    v_mfma_f32_16x16x32_bf16 v[176:179], v[192:195], v[104:107], 0
    buffer_load_dwordx4 v[140:143], v25, s[20:23], s76 offen offset:0 sc1
    buffer_load_dwordx4 v[144:147], v26, s[20:23], s76 offen offset:0 sc1
    s_waitcnt vmcnt(8) lgkmcnt(8)
    v_mfma_f32_16x16x32_bf16 v[148:151], v[196:199], v[108:111], v[148:151]
    v_mad_u32_u24 v52, s78, 5, v24
    v_xor_b32 v54, 64, v52
    v_xor_b32 v53, 32, v52
    v_mfma_f32_16x16x32_bf16 v[164:167], v[196:199], v[112:115], v[164:167]
    v_xor_b32 v55, 96, v52
    ds_read_b64_tr_b16 v[180:181], v52 offset:0
    ds_read_b64_tr_b16 v[182:183], v54 offset:2560
    v_mfma_f32_16x16x32_bf16 v[152:155], v[200:203], v[108:111], v[152:155]
    ds_read_b64_tr_b16 v[184:185], v53 offset:0
    ds_read_b64_tr_b16 v[186:187], v55 offset:2560
    ds_read_b64_tr_b16 v[188:189], v54 offset:0
    v_mfma_f32_16x16x32_bf16 v[168:171], v[200:203], v[112:115], v[168:171]
    ds_read_b64_tr_b16 v[190:191], v52 offset:2560
    ds_read_b64_tr_b16 v[192:193], v55 offset:0
    v_mfma_f32_16x16x32_bf16 v[156:159], v[204:207], v[108:111], v[156:159]
    ds_read_b64_tr_b16 v[194:195], v53 offset:2560
    s_cmp_eq_u32 s63, 0
    v_mfma_f32_16x16x32_bf16 v[172:175], v[204:207], v[112:115], v[172:175]
    s_cbranch_scc1 K_SP6
K_SPR6:
    s_ff1_i32_b32 s33, s63
    v_mfma_f32_16x16x32_bf16 v[160:163], v[208:211], v[108:111], v[160:163]
    s_bitset0_b32 s63, s33
    s_lshl_b32 s77, s33, 10
    v_mfma_f32_16x16x32_bf16 v[176:179], v[208:211], v[112:115], v[176:179]
    buffer_load_dwordx4 v[100:103], v25, s[20:23], s77 offen offset:0 sc1
    buffer_load_dwordx4 v[104:107], v26, s[20:23], s77 offen offset:0 sc1
    s_waitcnt vmcnt(8) lgkmcnt(8)
    v_mfma_f32_16x16x32_bf16 v[148:151], v[212:215], v[116:119], v[148:151]
    v_mad_u32_u24 v52, s75, 5, v24
    v_xor_b32 v54, 64, v52
    v_xor_b32 v53, 32, v52
    v_mfma_f32_16x16x32_bf16 v[164:167], v[212:215], v[120:123], v[164:167]
    v_xor_b32 v55, 96, v52
    ds_read_b64_tr_b16 v[196:197], v52 offset:0
    ds_read_b64_tr_b16 v[198:199], v54 offset:2560
    v_mfma_f32_16x16x32_bf16 v[152:155], v[216:219], v[116:119], v[152:155]
    ds_read_b64_tr_b16 v[200:201], v53 offset:0
    ds_read_b64_tr_b16 v[202:203], v55 offset:2560
    ds_read_b64_tr_b16 v[204:205], v54 offset:0
    v_mfma_f32_16x16x32_bf16 v[168:171], v[216:219], v[120:123], v[168:171]
    ds_read_b64_tr_b16 v[206:207], v52 offset:2560
    ds_read_b64_tr_b16 v[208:209], v55 offset:0
    v_mfma_f32_16x16x32_bf16 v[156:159], v[220:223], v[116:119], v[156:159]
    ds_read_b64_tr_b16 v[210:211], v53 offset:2560
    s_cmp_eq_u32 s63, 0
    v_mfma_f32_16x16x32_bf16 v[172:175], v[220:223], v[120:123], v[172:175]
    s_cbranch_scc1 K_SP7
K_SPR7:
    s_ff1_i32_b32 s33, s63
    v_mfma_f32_16x16x32_bf16 v[160:163], v[224:227], v[116:119], v[160:163]
    s_bitset0_b32 s63, s33
    s_lshl_b32 s78, s33, 10
    v_mfma_f32_16x16x32_bf16 v[176:179], v[224:227], v[120:123], v[176:179]
    buffer_load_dwordx4 v[108:111], v25, s[20:23], s78 offen offset:0 sc1
    buffer_load_dwordx4 v[112:115], v26, s[20:23], s78 offen offset:0 sc1
    s_waitcnt vmcnt(8) lgkmcnt(8)
    v_mfma_f32_16x16x32_bf16 v[148:151], v[180:183], v[124:127], v[148:151]
    v_mad_u32_u24 v52, s76, 5, v24
    v_xor_b32 v54, 64, v52
    v_mfma_f32_16x16x32_bf16 v[164:167], v[180:183], v[128:131], v[164:167]
    v_xor_b32 v53, 32, v52
    v_xor_b32 v55, 96, v52
    v_mfma_f32_16x16x32_bf16 v[152:155], v[184:187], v[124:127], v[152:155]
    ds_read_b64_tr_b16 v[212:213], v52 offset:0
    ds_read_b64_tr_b16 v[214:215], v54 offset:2560
    v_mfma_f32_16x16x32_bf16 v[168:171], v[184:187], v[128:131], v[168:171]
    ds_read_b64_tr_b16 v[216:217], v53 offset:0
    ds_read_b64_tr_b16 v[218:219], v55 offset:2560
    v_mfma_f32_16x16x32_bf16 v[156:159], v[188:191], v[124:127], v[156:159]
    ds_read_b64_tr_b16 v[220:221], v54 offset:0
    ds_read_b64_tr_b16 v[222:223], v52 offset:2560
    v_mfma_f32_16x16x32_bf16 v[172:175], v[188:191], v[128:131], v[172:175]
    ds_read_b64_tr_b16 v[224:225], v55 offset:0
    ds_read_b64_tr_b16 v[226:227], v53 offset:2560
    v_mfma_f32_16x16x32_bf16 v[160:163], v[192:195], v[124:127], v[160:163]
    buffer_load_dwordx4 v[116:119], v25, s[20:23], s67 offen offset:0 sc1
    buffer_load_dwordx4 v[120:123], v26, s[20:23], s67 offen offset:0 sc1
    v_mfma_f32_16x16x32_bf16 v[176:179], v[192:195], v[128:131], v[176:179]
    s_waitcnt vmcnt(8) lgkmcnt(8)
    v_mfma_f32_16x16x32_bf16 v[148:151], v[196:199], v[132:135], v[148:151]
    v_mad_u32_u24 v52, s77, 5, v24
    v_xor_b32 v54, 64, v52
    v_mfma_f32_16x16x32_bf16 v[164:167], v[196:199], v[136:139], v[164:167]
    v_xor_b32 v53, 32, v52
    v_xor_b32 v55, 96, v52
    v_mfma_f32_16x16x32_bf16 v[152:155], v[200:203], v[132:135], v[152:155]
    ds_read_b64_tr_b16 v[180:181], v52 offset:0
    ds_read_b64_tr_b16 v[182:183], v54 offset:2560
    v_mfma_f32_16x16x32_bf16 v[168:171], v[200:203], v[136:139], v[168:171]
    ds_read_b64_tr_b16 v[184:185], v53 offset:0
    ds_read_b64_tr_b16 v[186:187], v55 offset:2560
    v_mfma_f32_16x16x32_bf16 v[156:159], v[204:207], v[132:135], v[156:159]
    ds_read_b64_tr_b16 v[188:189], v54 offset:0
    ds_read_b64_tr_b16 v[190:191], v52 offset:2560
    v_mfma_f32_16x16x32_bf16 v[172:175], v[204:207], v[136:139], v[172:175]
    ds_read_b64_tr_b16 v[192:193], v55 offset:0
    ds_read_b64_tr_b16 v[194:195], v53 offset:2560
    v_mfma_f32_16x16x32_bf16 v[160:163], v[208:211], v[132:135], v[160:163]
    buffer_load_dwordx4 v[124:127], v25, s[20:23], s67 offen offset:1024 sc1
    buffer_load_dwordx4 v[128:131], v26, s[20:23], s67 offen offset:1024 sc1
    v_mfma_f32_16x16x32_bf16 v[176:179], v[208:211], v[136:139], v[176:179]
    s_waitcnt vmcnt(8) lgkmcnt(8)
    v_mfma_f32_16x16x32_bf16 v[148:151], v[212:215], v[140:143], v[148:151]
    v_mad_u32_u24 v52, s78, 5, v24
    v_xor_b32 v54, 64, v52
    v_xor_b32 v53, 32, v52
    v_mfma_f32_16x16x32_bf16 v[164:167], v[212:215], v[144:147], v[164:167]
    v_xor_b32 v55, 96, v52
    ds_read_b64_tr_b16 v[196:197], v52 offset:0
    ds_read_b64_tr_b16 v[198:199], v54 offset:2560
    v_mfma_f32_16x16x32_bf16 v[152:155], v[216:219], v[140:143], v[152:155]
    ds_read_b64_tr_b16 v[200:201], v53 offset:0
    ds_read_b64_tr_b16 v[202:203], v55 offset:2560
    ds_read_b64_tr_b16 v[204:205], v54 offset:0
    v_mfma_f32_16x16x32_bf16 v[168:171], v[216:219], v[144:147], v[168:171]
    ds_read_b64_tr_b16 v[206:207], v52 offset:2560
    ds_read_b64_tr_b16 v[208:209], v55 offset:0
    v_mfma_f32_16x16x32_bf16 v[156:159], v[220:223], v[140:143], v[156:159]
    ds_read_b64_tr_b16 v[210:211], v53 offset:2560
    s_cmp_eq_u32 s63, 0
    v_mfma_f32_16x16x32_bf16 v[172:175], v[220:223], v[144:147], v[172:175]
    s_cbranch_scc1 K_SP10
K_SPR10:
    s_ff1_i32_b32 s33, s63
    v_mfma_f32_16x16x32_bf16 v[160:163], v[224:227], v[140:143], v[160:163]
    s_bitset0_b32 s63, s33
    s_lshl_b32 s77, s33, 10
    v_mfma_f32_16x16x32_bf16 v[176:179], v[224:227], v[144:147], v[176:179]
    buffer_load_dwordx4 v[132:135], v25, s[20:23], s77 offen offset:0 sc1
    buffer_load_dwordx4 v[136:139], v26, s[20:23], s77 offen offset:0 sc1
    s_waitcnt vmcnt(8) lgkmcnt(8)
    v_mfma_f32_16x16x32_bf16 v[148:151], v[180:183], v[100:103], v[148:151]
    ds_read_b64_tr_b16 v[212:213], v56 offset:0
    ds_read_b64_tr_b16 v[214:215], v58 offset:2560
    v_mfma_f32_16x16x32_bf16 v[164:167], v[180:183], v[104:107], v[164:167]
    ds_read_b64_tr_b16 v[216:217], v57 offset:0
    ds_read_b64_tr_b16 v[218:219], v59 offset:2560
    v_mfma_f32_16x16x32_bf16 v[152:155], v[184:187], v[100:103], v[152:155]
    ds_read_b64_tr_b16 v[220:221], v58 offset:0
    ds_read_b64_tr_b16 v[222:223], v56 offset:2560
    v_mfma_f32_16x16x32_bf16 v[168:171], v[184:187], v[104:107], v[168:171]
    ds_read_b64_tr_b16 v[224:225], v59 offset:0
    ds_read_b64_tr_b16 v[226:227], v57 offset:2560
    v_mfma_f32_16x16x32_bf16 v[156:159], v[188:191], v[100:103], v[156:159]
    s_cmp_eq_u32 s63, 0
    s_cbranch_scc1 K_SP11
K_SPR11:
    v_mfma_f32_16x16x32_bf16 v[172:175], v[188:191], v[104:107], v[172:175]
    s_ff1_i32_b32 s33, s63
    s_bitset0_b32 s63, s33
    v_mfma_f32_16x16x32_bf16 v[160:163], v[192:195], v[100:103], v[160:163]
    s_lshl_b32 s78, s33, 10
    buffer_load_dwordx4 v[140:143], v25, s[20:23], s78 offen offset:0 sc1
    v_mfma_f32_16x16x32_bf16 v[176:179], v[192:195], v[104:107], v[176:179]
    buffer_load_dwordx4 v[144:147], v26, s[20:23], s78 offen offset:0 sc1
    s_waitcnt vmcnt(8) lgkmcnt(8)
    v_mfma_f32_16x16x32_bf16 v[148:151], v[196:199], v[108:111], v[148:151]
    ds_read_b64_tr_b16 v[180:181], v56 offset:20480
    ds_read_b64_tr_b16 v[182:183], v58 offset:23040
    v_mfma_f32_16x16x32_bf16 v[164:167], v[196:199], v[112:115], v[164:167]
    ds_read_b64_tr_b16 v[184:185], v57 offset:20480
    ds_read_b64_tr_b16 v[186:187], v59 offset:23040
    v_mfma_f32_16x16x32_bf16 v[152:155], v[200:203], v[108:111], v[152:155]
    ds_read_b64_tr_b16 v[188:189], v58 offset:20480
    ds_read_b64_tr_b16 v[190:191], v56 offset:23040
    v_mfma_f32_16x16x32_bf16 v[168:171], v[200:203], v[112:115], v[168:171]
    ds_read_b64_tr_b16 v[192:193], v59 offset:20480
    ds_read_b64_tr_b16 v[194:195], v57 offset:23040
    v_mfma_f32_16x16x32_bf16 v[156:159], v[204:207], v[108:111], v[156:159]
    s_cmp_eq_u32 s63, 0
    s_cbranch_scc1 K_SP12
K_SPR12:
    v_mfma_f32_16x16x32_bf16 v[172:175], v[204:207], v[112:115], v[172:175]
    s_ff1_i32_b32 s33, s63
    s_bitset0_b32 s63, s33
    v_mfma_f32_16x16x32_bf16 v[160:163], v[208:211], v[108:111], v[160:163]
    s_lshl_b32 s75, s33, 10
    buffer_load_dwordx4 v[100:103], v25, s[20:23], s75 offen offset:0 sc1
    v_mfma_f32_16x16x32_bf16 v[176:179], v[208:211], v[112:115], v[176:179]
    buffer_load_dwordx4 v[104:107], v26, s[20:23], s75 offen offset:0 sc1
    s_mov_b32 s3, 1048576
K_P2_GW:
    ds_read_b32 v2, v12 offset:44
    s_sub_u32 s3, s3, 1
    s_waitcnt lgkmcnt(0)
    v_readfirstlane_b32 s33, v2
    s_nop 3
    s_cselect_b32 s33, 4, s33
    s_cmp_lt_u32 s33, 4
    s_cbranch_scc1 K_P2_GW
    v_readfirstlane_b32 s56, v16
    v_readfirstlane_b32 s57, v17
    s_lshl_b32 s58, s53, 4
    s_waitcnt vmcnt(8)
    v_mfma_f32_16x16x32_bf16 v[148:151], v[212:215], v[116:119], v[148:151]
    v_mad_u32_u24 v52, s77, 5, v24
    v_xor_b32 v54, 64, v52
    v_xor_b32 v53, 32, v52
    v_mfma_f32_16x16x32_bf16 v[164:167], v[212:215], v[120:123], v[164:167]
    v_xor_b32 v55, 96, v52
    ds_read_b64_tr_b16 v[196:197], v52 offset:0
    ds_read_b64_tr_b16 v[198:199], v54 offset:2560
    v_mfma_f32_16x16x32_bf16 v[152:155], v[216:219], v[116:119], v[152:155]
    ds_read_b64_tr_b16 v[200:201], v53 offset:0
    ds_read_b64_tr_b16 v[202:203], v55 offset:2560
    ds_read_b64_tr_b16 v[204:205], v54 offset:0
    v_mfma_f32_16x16x32_bf16 v[168:171], v[216:219], v[120:123], v[168:171]
    ds_read_b64_tr_b16 v[206:207], v52 offset:2560
    ds_read_b64_tr_b16 v[208:209], v55 offset:0
    v_mfma_f32_16x16x32_bf16 v[156:159], v[220:223], v[116:119], v[156:159]
    ds_read_b64_tr_b16 v[210:211], v53 offset:2560
    s_cmp_eq_u32 s63, 0
    v_mfma_f32_16x16x32_bf16 v[172:175], v[220:223], v[120:123], v[172:175]
    s_cbranch_scc1 K_SP13
K_SPR13:
    s_ff1_i32_b32 s33, s63
    v_mfma_f32_16x16x32_bf16 v[160:163], v[224:227], v[116:119], v[160:163]
    s_bitset0_b32 s63, s33
    s_lshl_b32 s76, s33, 10
    v_mfma_f32_16x16x32_bf16 v[176:179], v[224:227], v[120:123], v[176:179]
    buffer_load_dwordx4 v[108:111], v25, s[20:23], s76 offen offset:0 sc1
    buffer_load_dwordx4 v[112:115], v26, s[20:23], s76 offen offset:0 sc1
    s_waitcnt vmcnt(8)
    v_mfma_f32_16x16x32_bf16 v[148:151], v[180:183], v[124:127], v[148:151]
    v_mad_u32_u24 v52, s78, 5, v24
    v_xor_b32 v54, 64, v52
    v_xor_b32 v53, 32, v52
    v_mfma_f32_16x16x32_bf16 v[164:167], v[180:183], v[128:131], v[164:167]
    v_xor_b32 v55, 96, v52
    ds_read_b64_tr_b16 v[212:213], v52 offset:0
    ds_read_b64_tr_b16 v[214:215], v54 offset:2560
    v_mfma_f32_16x16x32_bf16 v[152:155], v[184:187], v[124:127], v[152:155]
    ds_read_b64_tr_b16 v[216:217], v53 offset:0
    ds_read_b64_tr_b16 v[218:219], v55 offset:2560
    ds_read_b64_tr_b16 v[220:221], v54 offset:0
    v_mfma_f32_16x16x32_bf16 v[168:171], v[184:187], v[128:131], v[168:171]
    ds_read_b64_tr_b16 v[222:223], v52 offset:2560
    ds_read_b64_tr_b16 v[224:225], v55 offset:0
    v_mfma_f32_16x16x32_bf16 v[156:159], v[188:191], v[124:127], v[156:159]
    ds_read_b64_tr_b16 v[226:227], v53 offset:2560
    s_cmp_eq_u32 s63, 0
    v_mfma_f32_16x16x32_bf16 v[172:175], v[188:191], v[128:131], v[172:175]
    s_cbranch_scc1 K_SP14
K_SPR14:
    s_ff1_i32_b32 s33, s63
    v_mfma_f32_16x16x32_bf16 v[160:163], v[192:195], v[124:127], v[160:163]
    s_bitset0_b32 s63, s33
    s_lshl_b32 s77, s33, 10
    v_mfma_f32_16x16x32_bf16 v[176:179], v[192:195], v[128:131], v[176:179]
    buffer_load_dwordx4 v[116:119], v25, s[20:23], s77 offen offset:0 sc1
    buffer_load_dwordx4 v[120:123], v26, s[20:23], s77 offen offset:0 sc1
    s_waitcnt vmcnt(8) lgkmcnt(8)
    v_mfma_f32_16x16x32_bf16 v[148:151], v[196:199], v[132:135], v[148:151]
    v_mad_u32_u24 v52, s75, 5, v24
    v_xor_b32 v54, 64, v52
    v_xor_b32 v53, 32, v52
    v_mfma_f32_16x16x32_bf16 v[164:167], v[196:199], v[136:139], v[164:167]
    v_xor_b32 v55, 96, v52
    ds_read_b64_tr_b16 v[180:181], v52 offset:0
    ds_read_b64_tr_b16 v[182:183], v54 offset:2560
    v_mfma_f32_16x16x32_bf16 v[152:155], v[200:203], v[132:135], v[152:155]
    ds_read_b64_tr_b16 v[184:185], v53 offset:0
    ds_read_b64_tr_b16 v[186:187], v55 offset:2560
    ds_read_b64_tr_b16 v[188:189], v54 offset:0
    v_mfma_f32_16x16x32_bf16 v[168:171], v[200:203], v[136:139], v[168:171]
    ds_read_b64_tr_b16 v[190:191], v52 offset:2560
    ds_read_b64_tr_b16 v[192:193], v55 offset:0
    v_mfma_f32_16x16x32_bf16 v[156:159], v[204:207], v[132:135], v[156:159]
    ds_read_b64_tr_b16 v[194:195], v53 offset:2560
    s_cmp_eq_u32 s63, 0
    v_mfma_f32_16x16x32_bf16 v[172:175], v[204:207], v[136:139], v[172:175]
    s_cbranch_scc1 K_SP15
K_SPR15:
    s_ff1_i32_b32 s33, s63
    v_mfma_f32_16x16x32_bf16 v[160:163], v[208:211], v[132:135], v[160:163]
    s_bitset0_b32 s63, s33
    s_lshl_b32 s78, s33, 10
    v_mfma_f32_16x16x32_bf16 v[176:179], v[208:211], v[136:139], v[176:179]
    buffer_load_dwordx4 v[124:127], v25, s[20:23], s78 offen offset:0 sc1
    buffer_load_dwordx4 v[128:131], v26, s[20:23], s78 offen offset:0 sc1
    s_waitcnt vmcnt(8) lgkmcnt(8)
    v_mfma_f32_16x16x32_bf16 v[148:151], v[212:215], v[140:143], v[148:151]
    v_mad_u32_u24 v52, s76, 5, v24
    v_xor_b32 v54, 64, v52
    v_xor_b32 v53, 32, v52
    v_mfma_f32_16x16x32_bf16 v[164:167], v[212:215], v[144:147], v[164:167]
    v_xor_b32 v55, 96, v52
    ds_read_b64_tr_b16 v[196:197], v52 offset:0
    ds_read_b64_tr_b16 v[198:199], v54 offset:2560
    v_mfma_f32_16x16x32_bf16 v[152:155], v[216:219], v[140:143], v[152:155]
    ds_read_b64_tr_b16 v[200:201], v53 offset:0
    ds_read_b64_tr_b16 v[202:203], v55 offset:2560
    ds_read_b64_tr_b16 v[204:205], v54 offset:0
    v_mfma_f32_16x16x32_bf16 v[168:171], v[216:219], v[144:147], v[168:171]
    ds_read_b64_tr_b16 v[206:207], v52 offset:2560
    ds_read_b64_tr_b16 v[208:209], v55 offset:0
    v_mfma_f32_16x16x32_bf16 v[156:159], v[220:223], v[140:143], v[156:159]
    ds_read_b64_tr_b16 v[210:211], v53 offset:2560
    s_cmp_eq_u32 s63, 0
    v_mfma_f32_16x16x32_bf16 v[172:175], v[220:223], v[144:147], v[172:175]
    s_cbranch_scc1 K_SP16
K_SPR16:
    s_ff1_i32_b32 s33, s63
    v_mfma_f32_16x16x32_bf16 v[160:163], v[224:227], v[140:143], v[160:163]
    s_bitset0_b32 s63, s33
    s_lshl_b32 s75, s33, 10
    v_mfma_f32_16x16x32_bf16 v[176:179], v[224:227], v[144:147], v[176:179]
    buffer_load_dwordx4 v[132:135], v25, s[20:23], s75 offen offset:0 sc1
    buffer_load_dwordx4 v[136:139], v26, s[20:23], s75 offen offset:0 sc1
    s_waitcnt vmcnt(8) lgkmcnt(8)
    v_mfma_f32_16x16x32_bf16 v[148:151], v[180:183], v[100:103], v[148:151]
    v_mad_u32_u24 v52, s77, 5, v24
    v_xor_b32 v54, 64, v52
    v_xor_b32 v53, 32, v52
    v_mfma_f32_16x16x32_bf16 v[164:167], v[180:183], v[104:107], v[164:167]
    v_xor_b32 v55, 96, v52
    ds_read_b64_tr_b16 v[212:213], v52 offset:0
    ds_read_b64_tr_b16 v[214:215], v54 offset:2560
    v_mfma_f32_16x16x32_bf16 v[152:155], v[184:187], v[100:103], v[152:155]
    ds_read_b64_tr_b16 v[216:217], v53 offset:0
    ds_read_b64_tr_b16 v[218:219], v55 offset:2560
    ds_read_b64_tr_b16 v[220:221], v54 offset:0
    v_mfma_f32_16x16x32_bf16 v[168:171], v[184:187], v[104:107], v[168:171]
    ds_read_b64_tr_b16 v[222:223], v52 offset:2560
    ds_read_b64_tr_b16 v[224:225], v55 offset:0
    v_mfma_f32_16x16x32_bf16 v[156:159], v[188:191], v[100:103], v[156:159]
    ds_read_b64_tr_b16 v[226:227], v53 offset:2560
    s_cmp_eq_u32 s63, 0
    v_mfma_f32_16x16x32_bf16 v[172:175], v[188:191], v[104:107], v[172:175]
    s_cbranch_scc1 K_SP17
K_SPR17:
    s_ff1_i32_b32 s33, s63
    v_mfma_f32_16x16x32_bf16 v[160:163], v[192:195], v[100:103], v[160:163]
    s_bitset0_b32 s63, s33
    s_lshl_b32 s76, s33, 10
    v_mfma_f32_16x16x32_bf16 v[176:179], v[192:195], v[104:107], v[176:179]
    buffer_load_dwordx4 v[140:143], v25, s[20:23], s76 offen offset:0 sc1
    buffer_load_dwordx4 v[144:147], v26, s[20:23], s76 offen offset:0 sc1
    s_waitcnt vmcnt(8) lgkmcnt(8)
    v_mfma_f32_16x16x32_bf16 v[148:151], v[196:199], v[108:111], v[148:151]
    v_mad_u32_u24 v52, s78, 5, v24
    v_xor_b32 v54, 64, v52
    v_mfma_f32_16x16x32_bf16 v[164:167], v[196:199], v[112:115], v[164:167]
    v_xor_b32 v53, 32, v52
    v_xor_b32 v55, 96, v52
    v_mfma_f32_16x16x32_bf16 v[152:155], v[200:203], v[108:111], v[152:155]
    ds_read_b64_tr_b16 v[180:181], v52 offset:0
    ds_read_b64_tr_b16 v[182:183], v54 offset:2560
    v_mfma_f32_16x16x32_bf16 v[168:171], v[200:203], v[112:115], v[168:171]
    ds_read_b64_tr_b16 v[184:185], v53 offset:0
    ds_read_b64_tr_b16 v[186:187], v55 offset:2560
    v_mfma_f32_16x16x32_bf16 v[156:159], v[204:207], v[108:111], v[156:159]
    ds_read_b64_tr_b16 v[188:189], v54 offset:0
    ds_read_b64_tr_b16 v[190:191], v52 offset:2560
    v_mfma_f32_16x16x32_bf16 v[172:175], v[204:207], v[112:115], v[172:175]
    ds_read_b64_tr_b16 v[192:193], v55 offset:0
    ds_read_b64_tr_b16 v[194:195], v53 offset:2560
    v_mfma_f32_16x16x32_bf16 v[160:163], v[208:211], v[108:111], v[160:163]
    buffer_load_dwordx4 v[100:103], v25, s[20:23], s67 offen offset:2048 sc1
    buffer_load_dwordx4 v[104:107], v26, s[20:23], s67 offen offset:2048 sc1
    v_mfma_f32_16x16x32_bf16 v[176:179], v[208:211], v[112:115], v[176:179]
    s_waitcnt vmcnt(8) lgkmcnt(8)
    v_mfma_f32_16x16x32_bf16 v[148:151], v[212:215], v[116:119], v[148:151]
    v_mad_u32_u24 v52, s75, 5, v24
    v_xor_b32 v54, 64, v52
    v_mfma_f32_16x16x32_bf16 v[164:167], v[212:215], v[120:123], v[164:167]
    v_xor_b32 v53, 32, v52
    v_xor_b32 v55, 96, v52
    v_mfma_f32_16x16x32_bf16 v[152:155], v[216:219], v[116:119], v[152:155]
    ds_read_b64_tr_b16 v[196:197], v52 offset:0
    ds_read_b64_tr_b16 v[198:199], v54 offset:2560
    v_mfma_f32_16x16x32_bf16 v[168:171], v[216:219], v[120:123], v[168:171]
    ds_read_b64_tr_b16 v[200:201], v53 offset:0
    ds_read_b64_tr_b16 v[202:203], v55 offset:2560
    v_mfma_f32_16x16x32_bf16 v[156:159], v[220:223], v[116:119], v[156:159]
    ds_read_b64_tr_b16 v[204:205], v54 offset:0
    ds_read_b64_tr_b16 v[206:207], v52 offset:2560
    v_mfma_f32_16x16x32_bf16 v[172:175], v[220:223], v[120:123], v[172:175]
    ds_read_b64_tr_b16 v[208:209], v55 offset:0
    ds_read_b64_tr_b16 v[210:211], v53 offset:2560
    v_mfma_f32_16x16x32_bf16 v[160:163], v[224:227], v[116:119], v[160:163]
    buffer_load_dwordx4 v[108:111], v25, s[20:23], s67 offen offset:3072 sc1
    buffer_load_dwordx4 v[112:115], v26, s[20:23], s67 offen offset:3072 sc1
    v_mfma_f32_16x16x32_bf16 v[176:179], v[224:227], v[120:123], v[176:179]
    s_waitcnt vmcnt(8) lgkmcnt(8)
    v_mfma_f32_16x16x32_bf16 v[148:151], v[180:183], v[124:127], v[148:151]
    v_mad_u32_u24 v52, s76, 5, v24
    v_xor_b32 v54, 64, v52
    v_mfma_f32_16x16x32_bf16 v[164:167], v[180:183], v[128:131], v[164:167]
    v_xor_b32 v53, 32, v52
    v_xor_b32 v55, 96, v52
    v_mfma_f32_16x16x32_bf16 v[152:155], v[184:187], v[124:127], v[152:155]
    ds_read_b64_tr_b16 v[212:213], v52 offset:0
    ds_read_b64_tr_b16 v[214:215], v54 offset:2560
    v_mfma_f32_16x16x32_bf16 v[168:171], v[184:187], v[128:131], v[168:171]
    ds_read_b64_tr_b16 v[216:217], v53 offset:0
    ds_read_b64_tr_b16 v[218:219], v55 offset:2560
    v_mfma_f32_16x16x32_bf16 v[156:159], v[188:191], v[124:127], v[156:159]
    ds_read_b64_tr_b16 v[220:221], v54 offset:0
    ds_read_b64_tr_b16 v[222:223], v52 offset:2560
    v_mfma_f32_16x16x32_bf16 v[172:175], v[188:191], v[128:131], v[172:175]
    ds_read_b64_tr_b16 v[224:225], v55 offset:0
    ds_read_b64_tr_b16 v[226:227], v53 offset:2560
    v_mfma_f32_16x16x32_bf16 v[160:163], v[192:195], v[124:127], v[160:163]
    v_mfma_f32_16x16x32_bf16 v[176:179], v[192:195], v[128:131], v[176:179]
    s_waitcnt vmcnt(6) lgkmcnt(8)
    v_mfma_f32_16x16x32_bf16 v[148:151], v[196:199], v[132:135], v[148:151]
    ds_read_b64_tr_b16 v[180:181], v56 offset:40960
    ds_read_b64_tr_b16 v[182:183], v58 offset:43520
    v_mfma_f32_16x16x32_bf16 v[164:167], v[196:199], v[136:139], v[164:167]
    ds_read_b64_tr_b16 v[184:185], v57 offset:40960
    ds_read_b64_tr_b16 v[186:187], v59 offset:43520
    v_mfma_f32_16x16x32_bf16 v[152:155], v[200:203], v[132:135], v[152:155]
    ds_read_b64_tr_b16 v[188:189], v58 offset:40960
    ds_read_b64_tr_b16 v[190:191], v56 offset:43520
    v_mfma_f32_16x16x32_bf16 v[168:171], v[200:203], v[136:139], v[168:171]
    ds_read_b64_tr_b16 v[192:193], v59 offset:40960
    ds_read_b64_tr_b16 v[194:195], v57 offset:43520
    v_mfma_f32_16x16x32_bf16 v[156:159], v[204:207], v[132:135], v[156:159]
    v_mfma_f32_16x16x32_bf16 v[172:175], v[204:207], v[136:139], v[172:175]
    v_mfma_f32_16x16x32_bf16 v[160:163], v[208:211], v[132:135], v[160:163]
    v_mfma_f32_16x16x32_bf16 v[176:179], v[208:211], v[136:139], v[176:179]
    s_waitcnt vmcnt(4) lgkmcnt(8)
    v_mfma_f32_16x16x32_bf16 v[148:151], v[212:215], v[140:143], v[148:151]
    ds_read_b64_tr_b16 v[196:197], v56 offset:61440
    ds_read_b64_tr_b16 v[198:199], v58 offset:64000
    v_mfma_f32_16x16x32_bf16 v[164:167], v[212:215], v[144:147], v[164:167]
    ds_read_b64_tr_b16 v[200:201], v57 offset:61440
    ds_read_b64_tr_b16 v[202:203], v59 offset:64000
    v_mfma_f32_16x16x32_bf16 v[152:155], v[216:219], v[140:143], v[152:155]
    ds_read_b64_tr_b16 v[204:205], v58 offset:61440
    ds_read_b64_tr_b16 v[206:207], v56 offset:64000
    v_mfma_f32_16x16x32_bf16 v[168:171], v[216:219], v[144:147], v[168:171]
    ds_read_b64_tr_b16 v[208:209], v59 offset:61440
    ds_read_b64_tr_b16 v[210:211], v57 offset:64000
    v_mfma_f32_16x16x32_bf16 v[156:159], v[220:223], v[140:143], v[156:159]
    v_mfma_f32_16x16x32_bf16 v[172:175], v[220:223], v[144:147], v[172:175]
    v_mfma_f32_16x16x32_bf16 v[160:163], v[224:227], v[140:143], v[160:163]
    v_mfma_f32_16x16x32_bf16 v[176:179], v[224:227], v[144:147], v[176:179]
    s_waitcnt vmcnt(2) lgkmcnt(8)
    v_mfma_f32_16x16x32_bf16 v[148:151], v[180:183], v[100:103], v[148:151]
    v_mfma_f32_16x16x32_bf16 v[152:155], v[184:187], v[100:103], v[152:155]
    v_mfma_f32_16x16x32_bf16 v[156:159], v[188:191], v[100:103], v[156:159]
    v_mfma_f32_16x16x32_bf16 v[160:163], v[192:195], v[100:103], v[160:163]
    s_sub_u32 s59, s56, s58
    s_cmp_lt_u32 s59, 32
    s_cbranch_scc1 K_YROW0
K_NOY0:
    s_sub_u32 s59, s57, s58
    s_cmp_lt_u32 s59, 32
    s_cbranch_scc1 K_YROW1
K_NOY1:
    s_waitcnt vmcnt(0) lgkmcnt(0)
    v_mfma_f32_16x16x32_bf16 v[148:151], v[196:199], v[108:111], v[148:151]
    v_mfma_f32_16x16x32_bf16 v[152:155], v[200:203], v[108:111], v[152:155]
    v_mfma_f32_16x16x32_bf16 v[156:159], v[204:207], v[108:111], v[156:159]
    v_mfma_f32_16x16x32_bf16 v[160:163], v[208:211], v[108:111], v[160:163]
    v_mfma_f32_16x16x32_bf16 v[164:167], v[180:183], v[104:107], v[164:167]
    v_mfma_f32_16x16x32_bf16 v[168:171], v[184:187], v[104:107], v[168:171]
    v_mfma_f32_16x16x32_bf16 v[172:175], v[188:191], v[104:107], v[172:175]
    s_nop 1
    v_fma_f32 v148, v148, v60, v68
    v_fma_f32 v149, v149, v60, v69
    v_fma_f32 v150, v150, v60, v70
    v_mfma_f32_16x16x32_bf16 v[176:179], v[192:195], v[104:107], v[176:179]
    v_fma_f32 v151, v151, v60, v71
    v_cvt_pk_bf16_f32 v36, v148, v149
    v_cvt_pk_bf16_f32 v37, v150, v151
    v_mfma_f32_16x16x32_bf16 v[164:167], v[196:199], v[112:115], v[164:167]
    v_fma_f32 v152, v152, v60, v72
    v_fma_f32 v153, v153, v60, v73
    ds_write_b64 v29, v[36:37] offset:0
    v_mfma_f32_16x16x32_bf16 v[168:171], v[200:203], v[112:115], v[168:171]
    v_fma_f32 v154, v154, v60, v74
    v_fma_f32 v155, v155, v60, v75
    v_cvt_pk_bf16_f32 v38, v152, v153
    v_mfma_f32_16x16x32_bf16 v[172:175], v[204:207], v[112:115], v[172:175]
    v_cvt_pk_bf16_f32 v39, v154, v155
    v_fma_f32 v156, v156, v60, v76
    v_fma_f32 v157, v157, v60, v77
    v_mfma_f32_16x16x32_bf16 v[176:179], v[208:211], v[112:115], v[176:179]
    ds_write_b64 v30, v[38:39] offset:0
    v_fma_f32 v158, v158, v60, v78
    v_fma_f32 v159, v159, v60, v79
    v_cvt_pk_bf16_f32 v40, v156, v157
    v_cvt_pk_bf16_f32 v41, v158, v159
    v_pk_fma_f32 v[160:161], v[160:161], v[60:61], v[80:81] op_sel_hi:[1,0,1]
    v_pk_fma_f32 v[162:163], v[162:163], v[60:61], v[82:83] op_sel_hi:[1,0,1]
    ds_write_b64 v31, v[40:41] offset:0
    v_cvt_pk_bf16_f32 v42, v160, v161
    v_cvt_pk_bf16_f32 v43, v162, v163
    ds_write_b64 v32, v[42:43] offset:0
    ds_read_b128 v[68:71], v33 offset:0
    ds_read_b128 v[72:75], v33 offset:1024
    v_pk_fma_f32 v[164:165], v[164:165], v[62:63], v[84:85] op_sel_hi:[1,0,1]
    v_pk_fma_f32 v[166:167], v[166:167], v[62:63], v[86:87] op_sel_hi:[1,0,1]
    v_cvt_pk_bf16_f32 v44, v164, v165
    v_cvt_pk_bf16_f32 v45, v166, v167
    v_pk_fma_f32 v[168:169], v[168:169], v[62:63], v[88:89] op_sel_hi:[1,0,1]
    v_pk_fma_f32 v[170:171], v[170:171], v[62:63], v[90:91] op_sel_hi:[1,0,1]
    v_cvt_pk_bf16_f32 v46, v168, v169
    v_cvt_pk_bf16_f32 v47, v170, v171
    v_pk_fma_f32 v[172:173], v[172:173], v[62:63], v[92:93] op_sel_hi:[1,0,1]
    v_pk_fma_f32 v[174:175], v[174:175], v[62:63], v[94:95] op_sel_hi:[1,0,1]
    v_cvt_pk_bf16_f32 v48, v172, v173
    v_cvt_pk_bf16_f32 v49, v174, v175
    v_pk_fma_f32 v[176:177], v[176:177], v[62:63], v[96:97] op_sel_hi:[1,0,1]
    v_pk_fma_f32 v[178:179], v[178:179], v[62:63], v[98:99] op_sel_hi:[1,0,1]
    v_cvt_pk_bf16_f32 v50, v176, v177
    v_cvt_pk_bf16_f32 v51, v178, v179
    s_waitcnt lgkmcnt(0)
    buffer_store_dwordx4 v[68:71], v27, s[48:51], s71 offen sc1
    buffer_store_dwordx4 v[72:75], v28, s[48:51], s72 offen sc1
    ds_write_b64 v29, v[44:45] offset:2048
    ds_write_b64 v30, v[46:47] offset:2048
    ds_write_b64 v31, v[48:49] offset:2048
    ds_write_b64 v32, v[50:51] offset:2048
    ds_read_b128 v[84:87], v33 offset:2048
    ds_read_b128 v[88:91], v33 offset:3072
    s_waitcnt lgkmcnt(1)
    buffer_store_dwordx4 v[84:87], v27, s[48:51], s73 offen sc1
    s_waitcnt lgkmcnt(0)
    buffer_store_dwordx4 v[88:91], v28, s[48:51], s74 offen sc1
K_END:
K_EXIT:
    s_endpgm
.p2align 12
WP_spin:
    s_setpc_b64 s[38:39]
K_SP0:
    ds_read_b32 v2, v12 offset:32
    s_waitcnt lgkmcnt(0)
    v_readfirstlane_b32 s33, v2
    s_nop 3
    s_lshr_b32 s63, s33, s64
    s_lshr_b32 s33, s33, s65
    s_and_b32 s63, s63, s33
    s_and_b32 s63, s63, 0xff
    s_andn2_b32 s63, s63, s66
    s_cbranch_scc0 K_SP0
    s_or_b32 s66, s66, s63
    s_branch K_SPR0
K_SP1:
    ds_read_b32 v2, v12 offset:32
    s_waitcnt lgkmcnt(0)
    v_readfirstlane_b32 s33, v2
    s_nop 3
    s_lshr_b32 s63, s33, s64
    s_lshr_b32 s33, s33, s65
    s_and_b32 s63, s63, s33
    s_and_b32 s63, s63, 0xff
    s_andn2_b32 s63, s63, s66
    s_cbranch_scc0 K_SP1
    s_or_b32 s66, s66, s63
    s_branch K_SPR1
K_SP2:
    ds_read_b32 v2, v12 offset:32
    s_waitcnt lgkmcnt(0)
    v_readfirstlane_b32 s33, v2
    s_nop 3
    s_lshr_b32 s63, s33, s64
    s_lshr_b32 s33, s33, s65
    s_and_b32 s63, s63, s33
    s_and_b32 s63, s63, 0xff
    s_andn2_b32 s63, s63, s66
    s_cbranch_scc0 K_SP2
    s_or_b32 s66, s66, s63
    s_branch K_SPR2
K_SP3:
    ds_read_b32 v2, v12 offset:32
    s_waitcnt lgkmcnt(0)
    v_readfirstlane_b32 s33, v2
    s_nop 3
    s_lshr_b32 s63, s33, s64
    s_lshr_b32 s33, s33, s65
    s_and_b32 s63, s63, s33
    s_and_b32 s63, s63, 0xff
    s_andn2_b32 s63, s63, s66
    s_cbranch_scc0 K_SP3
    s_or_b32 s66, s66, s63
    s_branch K_SPR3
K_SP4:
    ds_read_b32 v2, v12 offset:32
    s_waitcnt lgkmcnt(0)
    v_readfirstlane_b32 s33, v2
    s_nop 3
    s_lshr_b32 s63, s33, s64
    s_lshr_b32 s33, s33, s65
    s_and_b32 s63, s63, s33
    s_and_b32 s63, s63, 0xff
    s_andn2_b32 s63, s63, s66
    s_cbranch_scc0 K_SP4
    s_or_b32 s66, s66, s63
    s_branch K_SPR4
K_SP5:
    ds_read_b32 v2, v12 offset:32
    s_waitcnt lgkmcnt(0)
    v_readfirstlane_b32 s33, v2
    s_nop 3
    s_lshr_b32 s63, s33, s64
    s_lshr_b32 s33, s33, s65
    s_and_b32 s63, s63, s33
    s_and_b32 s63, s63, 0xff
    s_andn2_b32 s63, s63, s66
    s_cbranch_scc0 K_SP5
    s_or_b32 s66, s66, s63
    s_branch K_SPR5
K_SP6:
    ds_read_b32 v2, v12 offset:32
    s_waitcnt lgkmcnt(0)
    v_readfirstlane_b32 s33, v2
    s_nop 3
    s_lshr_b32 s63, s33, s64
    s_lshr_b32 s33, s33, s65
    s_and_b32 s63, s63, s33
    s_and_b32 s63, s63, 0xff
    s_andn2_b32 s63, s63, s66
    s_cbranch_scc0 K_SP6
    s_or_b32 s66, s66, s63
    s_branch K_SPR6
K_SP7:
    ds_read_b32 v2, v12 offset:32
    s_waitcnt lgkmcnt(0)
    v_readfirstlane_b32 s33, v2
    s_nop 3
    s_lshr_b32 s63, s33, s64
    s_lshr_b32 s33, s33, s65
    s_and_b32 s63, s63, s33
    s_and_b32 s63, s63, 0xff
    s_andn2_b32 s63, s63, s66
    s_cbranch_scc0 K_SP7
    s_or_b32 s66, s66, s63
    s_branch K_SPR7
K_SP10:
    ds_read_b32 v2, v12 offset:32
    s_waitcnt lgkmcnt(0)
    v_readfirstlane_b32 s33, v2
    s_nop 3
    s_lshr_b32 s63, s33, s64
    s_lshr_b32 s33, s33, s65
    s_and_b32 s63, s63, s33
    s_and_b32 s63, s63, 0xff00
    s_andn2_b32 s63, s63, s66
    s_cbranch_scc0 K_SP10
    s_or_b32 s66, s66, s63
    s_branch K_SPR10
K_SP11:
    ds_read_b32 v2, v12 offset:32
    s_waitcnt lgkmcnt(0)
    v_readfirstlane_b32 s33, v2
    s_nop 3
    s_lshr_b32 s63, s33, s64
    s_lshr_b32 s33, s33, s65
    s_and_b32 s63, s63, s33
    s_and_b32 s63, s63, 0xff00
    s_andn2_b32 s63, s63, s66
    s_cbranch_scc0 K_SP11
    s_or_b32 s66, s66, s63
    s_branch K_SPR11
K_SP12:
    ds_read_b32 v2, v12 offset:32
    s_waitcnt lgkmcnt(0)
    v_readfirstlane_b32 s33, v2
    s_nop 3
    s_lshr_b32 s63, s33, s64
    s_lshr_b32 s33, s33, s65
    s_and_b32 s63, s63, s33
    s_and_b32 s63, s63, 0xff00
    s_andn2_b32 s63, s63, s66
    s_cbranch_scc0 K_SP12
    s_or_b32 s66, s66, s63
    s_branch K_SPR12
K_SP13:
    ds_read_b32 v2, v12 offset:32
    s_waitcnt lgkmcnt(0)
    v_readfirstlane_b32 s33, v2
    s_nop 3
    s_lshr_b32 s63, s33, s64
    s_lshr_b32 s33, s33, s65
    s_and_b32 s63, s63, s33
    s_and_b32 s63, s63, 0xff00
    s_andn2_b32 s63, s63, s66
    s_cbranch_scc0 K_SP13
    s_or_b32 s66, s66, s63
    s_branch K_SPR13
K_SP14:
    ds_read_b32 v2, v12 offset:32
    s_waitcnt lgkmcnt(0)
    v_readfirstlane_b32 s33, v2
    s_nop 3
    s_lshr_b32 s63, s33, s64
    s_lshr_b32 s33, s33, s65
    s_and_b32 s63, s63, s33
    s_and_b32 s63, s63, 0xff00
    s_andn2_b32 s63, s63, s66
    s_cbranch_scc0 K_SP14
    s_or_b32 s66, s66, s63
    s_branch K_SPR14
K_SP15:
    ds_read_b32 v2, v12 offset:32
    s_waitcnt lgkmcnt(0)
    v_readfirstlane_b32 s33, v2
    s_nop 3
    s_lshr_b32 s63, s33, s64
    s_lshr_b32 s33, s33, s65
    s_and_b32 s63, s63, s33
    s_and_b32 s63, s63, 0xff00
    s_andn2_b32 s63, s63, s66
    s_cbranch_scc0 K_SP15
    s_or_b32 s66, s66, s63
    s_branch K_SPR15
K_SP16:
    ds_read_b32 v2, v12 offset:32
    s_waitcnt lgkmcnt(0)
    v_readfirstlane_b32 s33, v2
    s_nop 3
    s_lshr_b32 s63, s33, s64
    s_lshr_b32 s33, s33, s65
    s_and_b32 s63, s63, s33
    s_and_b32 s63, s63, 0xff00
    s_andn2_b32 s63, s63, s66
    s_cbranch_scc0 K_SP16
    s_or_b32 s66, s66, s63
    s_branch K_SPR16
K_SP17:
    ds_read_b32 v2, v12 offset:32
    s_waitcnt lgkmcnt(0)
    v_readfirstlane_b32 s33, v2
    s_nop 3
    s_lshr_b32 s63, s33, s64
    s_lshr_b32 s33, s33, s65
    s_and_b32 s63, s63, s33
    s_and_b32 s63, s63, 0xff00
    s_andn2_b32 s63, s63, s66
    s_cbranch_scc0 K_SP17
    s_or_b32 s66, s66, s63
    s_branch K_SPR17
WP_yr0:
    s_setpc_b64 s[38:39]
K_YROW0:
    v_lshlrev_b32 v5, 4, v9
    v_add_u32 v5, 158976, v5
    v_and_b32 v3, 15, v1
    s_and_b32 s33, s59, 15
    v_cmp_eq_u32 vcc, s33, v3
    s_mov_b32 s3, 1048576
K_P2_GY0:
    ds_read_b32 v2, v12 offset:64
    s_sub_u32 s3, s3, 1
    s_waitcnt lgkmcnt(0)
    v_readfirstlane_b32 s33, v2
    s_nop 3
    s_cselect_b32 s33, 1, s33
    s_cmp_lt_u32 s33, 1
    s_cbranch_scc1 K_P2_GY0
    s_mov_b64 exec, vcc
    s_cmp_ge_u32 s59, 16
    s_cbranch_scc1 K_YR1_0
    ds_read_b128 v[68:71], v5 offset:0
    ds_read_b128 v[72:75], v5 offset:64
    ds_read_b128 v[76:79], v5 offset:128
    ds_read_b128 v[80:83], v5 offset:192
    s_mov_b64 exec, -1
    s_branch K_NOY0
K_YR1_0:
    ds_read_b128 v[84:87], v5 offset:0
    ds_read_b128 v[88:91], v5 offset:64
    ds_read_b128 v[92:95], v5 offset:128
    ds_read_b128 v[96:99], v5 offset:192
    s_mov_b64 exec, -1
    s_branch K_NOY0
K_YROW1:
    v_lshlrev_b32 v5, 4, v9
    v_add_u32 v5, 159232, v5
    v_and_b32 v3, 15, v1
    s_and_b32 s33, s59, 15
    v_cmp_eq_u32 vcc, s33, v3
    s_mov_b32 s3, 1048576
K_P2_GY1:
    ds_read_b32 v2, v12 offset:68
    s_sub_u32 s3, s3, 1
    s_waitcnt lgkmcnt(0)
    v_readfirstlane_b32 s33, v2
    s_nop 3
    s_cselect_b32 s33, 1, s33
    s_cmp_lt_u32 s33, 1
    s_cbranch_scc1 K_P2_GY1
    s_mov_b64 exec, vcc
    s_cmp_ge_u32 s59, 16
    s_cbranch_scc1 K_YR1_1
    ds_read_b128 v[68:71], v5 offset:0
    ds_read_b128 v[72:75], v5 offset:64
    ds_read_b128 v[76:79], v5 offset:128
    ds_read_b128 v[80:83], v5 offset:192
    s_mov_b64 exec, -1
    s_branch K_NOY1
K_YR1_1:
    ds_read_b128 v[84:87], v5 offset:0
    ds_read_b128 v[88:91], v5 offset:64
    ds_read_b128 v[92:95], v5 offset:128
    ds_read_b128 v[96:99], v5 offset:192
    s_mov_b64 exec, -1
    s_branch K_NOY1
.p2align 12
WP_gen:
    s_setpc_b64 s[38:39]
K_P2:
    s_cmp_ge_u32 s30, 4
    s_cbranch_scc1 K_P2_HELP
    s_lshl_b32 s54, s40, 7
    v_lshrrev_b32 v9, 4, v1
    v_mov_b32 v12, 158720
    s_add_u32 s20, s10, 0x100000
    s_addc_u32 s21, s11, 0
    s_mov_b32 s22, 0x280000
    s_mov_b32 s23, 0x20000
    s_add_u32 s16, s10, 0x1000
    s_addc_u32 s17, s11, 0
    s_mov_b32 s18, 0x2000
    s_mov_b32 s19, 0x20000
    s_mov_b32 s48, s6
    s_mov_b32 s49, s7
    s_mov_b32 s50, 0x280000
    s_mov_b32 s51, 0x20000
    s_lshl_b32 s53, s40, 3
    s_lshl1_add_u32 s53, s30, s53
    s_mov_b32 s55, 20480
    v_bfe_u32 v20, v1, 2, 2
    v_and_b32 v21, 3, v1
    s_mul_i32 s3, s53, 20480
    v_lshl_add_u32 v25, v1, 4, s3
    v_add_u32 v26, 20480, v25
    v_and_b32 v2, 15, v1
    s_lshl_b32 s3, s53, 6
    v_lshl_add_u32 v23, v2, 2, s3
    v_lshl_add_u32 v2, v9, 2, v20
    v_bfe_u32 v3, v2, 1, 2
    v_lshlrev_b32 v2, 7, v2
    v_lshl_add_u32 v2, v21, 3, v2
    v_lshl_add_u32 v24, v3, 5, v2
    v_lshrrev_b32 v3, 1, v20
    v_mul_u32_u24 v2, 40, v9
    v_add3_u32 v2, v2, 16, v20
    v_lshlrev_b32 v2, 7, v2
    v_lshl_add_u32 v2, v21, 3, v2
    v_xor_b32 v4, 0, v3
    v_lshl_add_u32 v56, v4, 5, v2
    v_xor_b32 v4, 1, v3
    v_lshl_add_u32 v57, v4, 5, v2
    v_xor_b32 v4, 2, v3
    v_lshl_add_u32 v58, v4, 5, v2
    v_xor_b32 v4, 3, v3
    v_lshl_add_u32 v59, v4, 5, v2
    v_lshrrev_b32 v3, 4, v1
    v_and_b32 v4, 7, v1
    v_lshrrev_b32 v2, 3, v1
    v_xor_b32 v4, v4, v3
    v_mul_u32_u24 v2, 1280, v2
    v_lshl_add_u32 v27, v4, 4, v2
    v_xor_b32 v28, 64, v27
    s_lshl_b32 s71, s40, 3
    s_lshl1_add_u32 s71, s30, s71
    s_mul_i32 s71, s71, 20480
    s_lshl_b32 s33, s41, 7
    s_add_u32 s71, s71, s33
    s_add_u32 s72, s71, 10240
    s_add_u32 s73, s71, 20480
    s_add_u32 s74, s71, 30720
    s_lshl_b32 s3, s30, 12
    s_add_u32 s3, s3, 140288
    v_lshl_add_u32 v33, v1, 4, s3
    v_and_b32 v2, 15, v1
    v_lshrrev_b32 v3, 1, v2
    v_lshrrev_b32 v4, 5, v1
    v_xor_b32 v3, v3, v4
    v_lshlrev_b32 v3, 4, v3
    v_lshl_add_u32 v3, v2, 7, v3
    v_and_b32 v4, 1, v9
    v_lshl_add_u32 v3, v4, 3, v3
    v_add_u32 v29, s3, v3
    v_xor_b32 v30, 32, v29
    v_xor_b32 v31, 64, v29
    v_xor_b32 v32, 96, v29
    s_and_b32 s33, s40, 3
    s_lshl_b32 s33, s33, 3
    s_lshr_b32 s33, 0x7f06037f, s33
    s_and_b32 s33, s33, 0xff
    s_lshl_b32 s3, s30, 1
    s_cmp_ge_u32 s3, s33
    s_cselect_b32 s64, 16, 0
    s_add_u32 s3, s3, 1
    s_cmp_ge_u32 s3, s33
    s_cselect_b32 s65, 16, 0
    s_mov_b32 s63, 0
    s_mov_b32 s66, 0
    s_mov_b32 s67, 16384
    s_cmp_eq_u32 s30, 0
    s_cbranch_scc1 K_P2_AUXW
    v_lshrrev_b32 v2, 3, v1
    v_mul_u32_u24 v2, 1280, v2
    v_lshrrev_b32 v3, 4, v1
    v_lshlrev_b32 v3, 1, v3
    v_and_b32 v4, 7, v1
    v_xor_b32 v3, v3, v4
    v_lshl_add_u32 v2, v3, 4, v2
    s_lshl_b32 s33, s41, 7
    v_add_u32 v22, s33, v2
    s_mov_b32 s60, 0xfda87520
    s_mov_b32 s61, 0xecb96431
    s_sub_u32 s58, s30, 1
K_P2_WS:
    s_lshl_b32 s3, s58, 2
    s_lshr_b64 s[4:5], s[60:61], s3
    s_and_b32 s4, s4, 15
    s_mul_i32 s4, s4, 51200
    s_mul_i32 s59, s58, 5120
    s_add_u32 s52, s4, 0
    s_add_u32 m0, s59, 0
    s_waitcnt vmcnt(11)
    buffer_load_dwordx4 v22, s[24:27], s52 offen lds
    s_add_u32 s52, s4, 10240
    s_add_u32 m0, s59, 1024
    s_waitcnt vmcnt(11)
    buffer_load_dwordx4 v22, s[24:27], s52 offen lds
    s_add_u32 s52, s4, 20480
    s_add_u32 m0, s59, 2048
    s_waitcnt vmcnt(11)
    buffer_load_dwordx4 v22, s[24:27], s52 offen lds
    s_add_u32 s52, s4, 30720
    s_add_u32 m0, s59, 3072
    s_waitcnt vmcnt(11)
    buffer_load_dwordx4 v22, s[24:27], s52 offen lds
    s_add_u32 s52, s4, 40960
    s_add_u32 m0, s59, 4096
    s_waitcnt vmcnt(11)
    buffer_load_dwordx4 v22, s[24:27], s52 offen lds
    s_cmp_ge_u32 s58, 3
    s_cbranch_scc1 K_P2_WS1
    v_mov_b32 v3, 1
    s_waitcnt vmcnt(5)
    s_mov_b64 exec, 1
    ds_add_u32 v12, v3 offset:52
    s_mov_b64 exec, -1
K_P2_WS1:
    s_add_u32 s58, s58, 3
    s_cmp_lt_u32 s58, 16
    s_cbranch_scc1 K_P2_WS
K_P2_AUXW:
    s_lshl_b32 s33, s30, 12
    s_add_u32 m0, s33, 140288
    s_add_u32 s3, s71, 0
    buffer_load_dwordx4 v27, s[12:15], s3 offen lds
    s_add_u32 m0, s33, 141312
    s_add_u32 s3, s71, 10240
    buffer_load_dwordx4 v28, s[12:15], s3 offen lds
    s_add_u32 m0, s33, 142336
    s_add_u32 s3, s71, 20480
    buffer_load_dwordx4 v27, s[12:15], s3 offen lds
    s_add_u32 m0, s33, 143360
    s_add_u32 s3, s71, 30720
    buffer_load_dwordx4 v28, s[12:15], s3 offen lds
    v_mov_b32 v3, 1
    s_waitcnt vmcnt(0)
    s_mov_b64 exec, 1
    ds_add_u32 v12, v3 offset:44
    s_mov_b64 exec, -1
    s_mov_b32 s3, 1048576
K_P2_GWA:
    ds_read_b32 v2, v12 offset:44
    s_sub_u32 s3, s3, 1
    s_waitcnt lgkmcnt(0)
    v_readfirstlane_b32 s33, v2
    s_nop 3
    s_cselect_b32 s33, 4, s33
    s_cmp_lt_u32 s33, 4
    s_cbranch_scc1 K_P2_GWA
    s_branch K_P2_GEMM
WP_help:
    s_setpc_b64 s[38:39]
K_LATE:
    s_mov_b32 s3, 1048576
K_LG:
    ds_read_b32 v2, v4 offset:48
    s_sub_u32 s3, s3, 1
    s_waitcnt lgkmcnt(0)
    v_readfirstlane_b32 s33, v2
    s_nop 3
    s_cselect_b32 s33, 8, s33
    s_bitcmp0_b32 s33, 3
    s_cbranch_scc1 K_LG
    s_sub_u32 s44, s30, 4
K_WOL:
    s_lshl_b32 s50, s44, 2
    s_lshr_b32 s50, 0x6431, s50
    s_and_b32 s50, s50, 7
    s_mul_i32 s50, s50, 51200
    s_mul_i32 s51, s44, 5120
    s_add_u32 s3, s50, 0
    s_add_u32 m0, s51, 40960
    s_waitcnt vmcnt(13)
    buffer_load_dwordx4 v18, s[24:27], s3 offen lds
    s_add_u32 s3, s50, 10240
    s_add_u32 m0, s51, 41984
    s_waitcnt vmcnt(13)
    buffer_load_dwordx4 v18, s[24:27], s3 offen lds
    s_add_u32 s3, s50, 20480
    s_add_u32 m0, s51, 43008
    s_waitcnt vmcnt(13)
    buffer_load_dwordx4 v18, s[24:27], s3 offen lds
    s_add_u32 s3, s50, 30720
    s_add_u32 m0, s51, 44032
    s_waitcnt vmcnt(13)
    buffer_load_dwordx4 v18, s[24:27], s3 offen lds
    s_add_u32 s3, s50, 40960
    s_add_u32 m0, s51, 45056
    s_waitcnt vmcnt(13)
    buffer_load_dwordx4 v18, s[24:27], s3 offen lds
    s_add_u32 s3, s50, 409600
    s_add_u32 m0, s51, 61440
    s_waitcnt vmcnt(13)
    buffer_load_dwordx4 v18, s[24:27], s3 offen lds
    s_add_u32 s3, s50, 419840
    s_add_u32 m0, s51, 62464
    s_waitcnt vmcnt(13)
    buffer_load_dwordx4 v18, s[24:27], s3 offen lds
    s_add_u32 s3, s50, 430080
    s_add_u32 m0, s51, 63488
    s_waitcnt vmcnt(13)
    buffer_load_dwordx4 v18, s[24:27], s3 offen lds
    s_add_u32 s3, s50, 440320
    s_add_u32 m0, s51, 64512
    s_waitcnt vmcnt(13)
    buffer_load_dwordx4 v18, s[24:27], s3 offen lds
    s_add_u32 s3, s50, 450560
    s_add_u32 m0, s51, 65536
    s_waitcnt vmcnt(13)
    buffer_load_dwordx4 v18, s[24:27], s3 offen lds
    s_add_u32 s44, s44, 2
    s_cmp_lt_u32 s44, 4
    s_cbranch_scc1 K_WOL
    v_mov_b32 v2, 158720
    v_mov_b32 v3, 2
    s_waitcnt vmcnt(0)
    s_mov_b64 exec, 1
    ds_add_u32 v2, v3 offset:44
    s_mov_b64 exec, -1
K_P2_HELP:
    s_setprio 3
    s_add_u32 s59, s40, 1
    s_bitcmp1_b32 s59, 1
    s_cselect_b32 s59, 31, 15
    v_and_b32 v10, s59, v1
    v_lshl_add_u32 v10, v10, 2, s42
    s_cmp_lg_u32 s30, 7
    s_cbranch_scc1 K_P2_N7
    v_and_b32 v4, 7, v1
    v_lshlrev_b32 v4, 2, v4
    s_mov_b32 s3, 131072
K_ZPOLL1:
    v_cmp_eq_u32 vcc, 0, v7
    s_cbranch_vccz K_ZOK1
    s_sub_u32 s3, s3, 1
    s_cbranch_scc1 K_ZOK1
    global_load_dword v7, v4, s[8:9] offset:192 sc1
    s_waitcnt vmcnt(0)
    s_branch K_ZPOLL1
K_ZOK1:
    global_load_dword v7, v10, s[10:11] sc1
K_P2_N7:
    s_lshl_b32 s54, s40, 7
    v_lshrrev_b32 v9, 4, v1
    v_mov_b32 v12, 158720
    s_add_u32 s44, s10, 0x10000
    s_addc_u32 s45, s11, 0
    s_mov_b32 s46, 0x43800
    s_mov_b32 s47, 0x20000
    v_mov_b32 v80, 1
    s_cmp_eq_u32 s30, 7
    s_cbranch_scc1 K_P2_FLAGS
    s_cmp_lg_u32 s30, 6
    s_cbranch_scc1 K_P2_HW
    s_mov_b32 s3, 131072
K_P2_DPOLL:
    v_cmp_eq_u32 vcc, 0, v7
    s_cbranch_vccz K_P2_DOK
    s_cmp_eq_u32 s3, 131072
    s_cbranch_scc1 K_P2_DNS
    s_sleep 12
K_P2_DNS:
    v_and_b32 v11, 1, v1
    v_lshl_add_u32 v11, v11, 2, s42
    global_load_dword v7, v11, s[10:11] offset:128 sc1
    s_sub_u32 s3, s3, 1
    s_waitcnt vmcnt(0)
    s_cmp_lg_u32 s3, 0
    s_cbranch_scc1 K_P2_DPOLL
K_P2_DOK:
    v_readlane_b32 s58, v7, 0
    v_readlane_b32 s59, v7, 1
    s_nop 3
    s_and_b32 s3, s58, 0x7ff
    s_sub_u32 s3, 2047, s3
    v_mov_b32 v20, s3
    v_mov_b32 v4, s58
    v_and_b32 v4, 0xffff0000, v4
    v_ashrrev_i32 v5, 31, v4
    v_not_b32 v5, v5
    v_or_b32 v5, 0x80000000, v5
    v_xor_b32 v4, v4, v5
    v_and_b32 v4, 0xffff0000, v4
    v_mul_f32 v5, 0xbfb8aa3b, v4
    v_exp_f32 v5, v5
    s_nop 0
    v_add_f32 v5, 1.0, v5
    v_rcp_f32 v4, v5
    s_nop 0
    v_cvt_pk_bf16_f32 v22, v4, v4
    v_lshlrev_b32 v22, 16, v22
    s_and_b32 s3, s59, 0x7ff
    s_sub_u32 s3, 2047, s3
    v_mov_b32 v21, s3
    v_mov_b32 v4, s59
    v_and_b32 v4, 0xffff0000, v4
    v_ashrrev_i32 v5, 31, v4
    v_not_b32 v5, v5
    v_or_b32 v5, 0x80000000, v5
    v_xor_b32 v4, v4, v5
    v_and_b32 v4, 0xffff0000, v4
    v_mul_f32 v5, 0xbfb8aa3b, v4
    v_exp_f32 v5, v5
    s_nop 0
    v_add_f32 v5, 1.0, v5
    v_rcp_f32 v4, v5
    s_nop 0
    v_cvt_pk_bf16_f32 v23, v4, v4
    v_lshlrev_b32 v23, 16, v23
    ds_write_b128 v12, v[20:23]
    ds_write_b32 v12, v80 offset:40
    s_branch K_END
K_P2_HW:
    s_mov_b32 s3, 1048576
K_P2_GS2:
    ds_read_b32 v2, v12 offset:40
    s_sleep 1
    s_sub_u32 s3, s3, 1
    s_waitcnt lgkmcnt(0)
    v_readfirstlane_b32 s33, v2
    s_nop 3
    s_cselect_b32 s33, 1, s33
    s_cmp_lt_u32 s33, 1
    s_cbranch_scc1 K_P2_GS2
    ds_read_b128 v[16:19], v12
    s_waitcnt lgkmcnt(0)
    s_cmp_eq_u32 s30, 4
    s_cselect_b64 vcc, -1, 0
    s_nop 1
    v_cndmask_b32 v2, v17, v16, vcc
    v_cndmask_b32 v5, v19, v18, vcc
    s_nop 0
    v_readfirstlane_b32 s58, v2
    s_nop 3
    s_sub_u32 s3, s58, s54
    s_cmp_lt_u32 s3, 128
    s_cbranch_scc0 K_END
    s_call_b64 s[38:39], WP_yr0
    s_mul_i32 s3, s58, 1280
    s_lshl_b32 s33, s41, 7
    s_add_u32 s3, s3, s33
    v_and_b32 v2, 15, v1
    v_lshlrev_b32 v2, 3, v2
    buffer_load_dwordx2 v[84:85], v2, s[12:15], s3 offen
    s_lshl_b32 s3, s58, 2
    s_add_u32 s3, s3, 4096
    v_mov_b32 v2, s3
    global_load_dword v88, v2, s[10:11] sc1
    v_min_u32 v3, 53, v1
    v_lshlrev_b32 v3, 5, v3
    v_add_u32 v3, 565248, v3
    s_mov_b32 s3, 1048576
K_P2_GY:
    ds_read_b32 v2, v12 offset:32
    s_sleep 1
    s_sub_u32 s3, s3, 1
    s_waitcnt lgkmcnt(0)
    v_readfirstlane_b32 s33, v2
    s_nop 3
    s_cselect_b32 s33, 255, s33
    s_and_b32 s33, s33, 255
    s_cmp_lt_u32 s33, 255
    s_cbranch_scc1 K_P2_GY
    s_mov_b32 s3, 131072
K_P2_YPOLL:
    global_load_dwordx4 v[20:23], v3, s[10:11] sc1
    s_sub_u32 s3, s3, 1
    s_waitcnt vmcnt(0)
    v_and_b32 v2, v20, v21
    v_and_b32 v2, v2, v22
    v_and_b32 v2, v2, v23
    v_cmp_ne_u32 vcc, 1, v2
    s_cbranch_vccz K_P2_YGO
    s_sleep 8
    s_cmp_lg_u32 s3, 0
    s_cbranch_scc1 K_P2_YPOLL
K_P2_YGO:
    v_and_b32 v2, 15, v1
    v_lshlrev_b32 v2, 4, v2
    v_mul_u32_u24 v4, 5120, v9
    s_sub_u32 s59, s30, 4
    s_mul_i32 s33, s59, 2560
    s_lshl_b32 s3, s41, 8
    s_add_u32 s3, s3, s33
    v_add3_u32 v3, v2, v4, s3
    s_mov_b32 s52, 0
    buffer_load_dwordx4 v[24:27], v3, s[44:47], s52 offen sc1
    s_mov_b32 s52, 20480
    buffer_load_dwordx4 v[28:31], v3, s[44:47], s52 offen sc1
    s_mov_b32 s52, 40960
    buffer_load_dwordx4 v[32:35], v3, s[44:47], s52 offen sc1
    s_mov_b32 s52, 61440
    buffer_load_dwordx4 v[36:39], v3, s[44:47], s52 offen sc1
    s_mov_b32 s52, 81920
    buffer_load_dwordx4 v[40:43], v3, s[44:47], s52 offen sc1
    s_mov_b32 s52, 102400
    buffer_load_dwordx4 v[44:47], v3, s[44:47], s52 offen sc1
    s_mov_b32 s52, 122880
    buffer_load_dwordx4 v[48:51], v3, s[44:47], s52 offen sc1
    s_mov_b32 s52, 143360
    buffer_load_dwordx4 v[52:55], v3, s[44:47], s52 offen sc1
    s_mov_b32 s52, 163840
    buffer_load_dwordx4 v[56:59], v3, s[44:47], s52 offen sc1
    s_mov_b32 s52, 184320
    buffer_load_dwordx4 v[60:63], v3, s[44:47], s52 offen sc1
    s_mov_b32 s52, 204800
    buffer_load_dwordx4 v[64:67], v3, s[44:47], s52 offen sc1
    s_mov_b32 s52, 225280
    buffer_load_dwordx4 v[68:71], v3, s[44:47], s52 offen sc1
    s_mov_b32 s52, 245760
    buffer_load_dwordx4 v[72:75], v3, s[44:47], s52 offen sc1
    s_mov_b32 s52, 266240
    buffer_load_dwordx4 v[76:79], v3, s[44:47], s52 offen sc1
    v_sub_f32 v88, 1.0, v88
    v_cvt_pk_bf16_f32 v88, v88, v88
    v_lshlrev_b32 v88, 16, v88
    v_lshlrev_b32 v86, 16, v85
    v_and_b32 v87, 0xffff0000, v85
    v_and_b32 v85, 0xffff0000, v84
    v_lshlrev_b32 v84, 16, v84
    s_waitcnt vmcnt(12)
    v_add_f32 v20, v24, v28
    v_add_f32 v21, v25, v29
    v_add_f32 v22, v26, v30
    v_add_f32 v23, v27, v31
    s_waitcnt vmcnt(11)
    v_add_f32 v20, v20, v32
    v_add_f32 v21, v21, v33
    v_add_f32 v22, v22, v34
    v_add_f32 v23, v23, v35
    s_waitcnt vmcnt(10)
    v_add_f32 v20, v20, v36
    v_add_f32 v21, v21, v37
    v_add_f32 v22, v22, v38
    v_add_f32 v23, v23, v39
    s_waitcnt vmcnt(9)
    v_add_f32 v20, v20, v40
    v_add_f32 v21, v21, v41
    v_add_f32 v22, v22, v42
    v_add_f32 v23, v23, v43
    s_waitcnt vmcnt(8)
    v_add_f32 v20, v20, v44
    v_add_f32 v21, v21, v45
    v_add_f32 v22, v22, v46
    v_add_f32 v23, v23, v47
    s_waitcnt vmcnt(7)
    v_add_f32 v20, v20, v48
    v_add_f32 v21, v21, v49
    v_add_f32 v22, v22, v50
    v_add_f32 v23, v23, v51
    s_waitcnt vmcnt(6)
    v_add_f32 v20, v20, v52
    v_add_f32 v21, v21, v53
    v_add_f32 v22, v22, v54
    v_add_f32 v23, v23, v55
    s_waitcnt vmcnt(5)
    v_add_f32 v20, v20, v56
    v_add_f32 v21, v21, v57
    v_add_f32 v22, v22, v58
    v_add_f32 v23, v23, v59
    s_waitcnt vmcnt(4)
    v_add_f32 v20, v20, v60
    v_add_f32 v21, v21, v61
    v_add_f32 v22, v22, v62
    v_add_f32 v23, v23, v63
    s_waitcnt vmcnt(3)
    v_add_f32 v20, v20, v64
    v_add_f32 v21, v21, v65
    v_add_f32 v22, v22, v66
    v_add_f32 v23, v23, v67
    s_waitcnt vmcnt(2)
    v_add_f32 v20, v20, v68
    v_add_f32 v21, v21, v69
    v_add_f32 v22, v22, v70
    v_add_f32 v23, v23, v71
    s_waitcnt vmcnt(1)
    v_add_f32 v20, v20, v72
    v_add_f32 v21, v21, v73
    v_add_f32 v22, v22, v74
    v_add_f32 v23, v23, v75
    s_waitcnt vmcnt(0)
    v_add_f32 v20, v20, v76
    v_add_f32 v21, v21, v77
    v_add_f32 v22, v22, v78
    v_add_f32 v23, v23, v79
    v_mov_b32 v24, v20
    v_mov_b32 v25, v21
    v_mov_b32 v26, v22
    v_mov_b32 v27, v23
    s_nop 0
    v_permlane16_swap_b32 v20, v24
    v_permlane16_swap_b32 v21, v25
    v_permlane16_swap_b32 v22, v26
    v_permlane16_swap_b32 v23, v27
    v_add_f32 v20, v20, v24
    v_add_f32 v21, v21, v25
    v_add_f32 v22, v22, v26
    v_add_f32 v23, v23, v27
    v_mov_b32 v24, v20
    v_mov_b32 v25, v21
    v_mov_b32 v26, v22
    v_mov_b32 v27, v23
    s_nop 0
    v_permlane32_swap_b32 v20, v24
    v_permlane32_swap_b32 v21, v25
    v_permlane32_swap_b32 v22, v26
    v_permlane32_swap_b32 v23, v27
    v_add_f32 v20, v20, v24
    v_add_f32 v21, v21, v25
    v_add_f32 v22, v22, v26
    v_add_f32 v23, v23, v27
    v_cvt_pk_bf16_f32 v20, v20, v20
    v_lshlrev_b32 v20, 16, v20
    v_mul_f32 v20, v5, v20
    v_cvt_pk_bf16_f32 v20, v20, v20
    v_lshlrev_b32 v20, 16, v20
    v_add_f32 v20, v20, v84
    v_cvt_pk_bf16_f32 v20, v20, v20
    v_lshlrev_b32 v20, 16, v20
    v_mul_f32 v20, v20, v88
    v_cvt_pk_bf16_f32 v21, v21, v21
    v_lshlrev_b32 v21, 16, v21
    v_mul_f32 v21, v5, v21
    v_cvt_pk_bf16_f32 v21, v21, v21
    v_lshlrev_b32 v21, 16, v21
    v_add_f32 v21, v21, v85
    v_cvt_pk_bf16_f32 v21, v21, v21
    v_lshlrev_b32 v21, 16, v21
    v_mul_f32 v21, v21, v88
    v_cvt_pk_bf16_f32 v22, v22, v22
    v_lshlrev_b32 v22, 16, v22
    v_mul_f32 v22, v5, v22
    v_cvt_pk_bf16_f32 v22, v22, v22
    v_lshlrev_b32 v22, 16, v22
    v_add_f32 v22, v22, v86
    v_cvt_pk_bf16_f32 v22, v22, v22
    v_lshlrev_b32 v22, 16, v22
    v_mul_f32 v22, v22, v88
    v_cvt_pk_bf16_f32 v23, v23, v23
    v_lshlrev_b32 v23, 16, v23
    v_mul_f32 v23, v5, v23
    v_cvt_pk_bf16_f32 v23, v23, v23
    v_lshlrev_b32 v23, 16, v23
    v_add_f32 v23, v23, v87
    v_cvt_pk_bf16_f32 v23, v23, v23
    v_lshlrev_b32 v23, 16, v23
    v_mul_f32 v23, v23, v88
    s_lshl_b32 s3, s59, 8
    s_add_u32 s3, s3, 158976
    v_add_u32 v2, s3, v2
    ds_write_b128 v2, v[20:23]
    s_lshl_b32 s3, s59, 2
    v_add_u32 v2, s3, v12
    ds_write_b32 v2, v80 offset:64
    s_branch K_END
WP_flags:
    s_setpc_b64 s[38:39]
K_P2_FLAGS:
    s_mov_b32 exec_hi, 0
    s_waitcnt vmcnt(0)
    s_mov_b32 s3, 131072
K_P2_FCHK:
    v_cmp_eq_u32 vcc, 1, v7
    s_nop 1
    v_mov_b32 v2, vcc_lo
    ds_write_b32 v12, v2 offset:32
    s_cmp_eq_u32 vcc_lo, -1
    s_cbranch_scc1 K_P2_FGO
    s_cmp_lg_u32 vcc_lo, 0
    s_cbranch_scc1 K_P2_FS
    s_sleep 4
K_P2_FS:
    s_sleep 6
    global_load_dword v7, v10, s[10:11] sc1
    s_sub_u32 s3, s3, 1
    s_waitcnt vmcnt(0)
    s_cbranch_scc0 K_P2_FCHK
    v_mov_b32 v2, -1
    ds_write_b32 v12, v2 offset:32
K_P2_FGO:
    s_mov_b64 exec, -1
    s_branch K_END
.p2align 12
K_AUX:
    s_load_dwordx8 s[48:55], s[0:1], 32
    s_load_dwordx2 s[56:57], s[0:1], 64
    s_mul_i32 s44, s28, 7
    s_add_u32 s44, s44, s29
    s_sub_u32 s44, s44, 1
    s_cmp_lt_u32 s44, 54
    s_cselect_b32 s44, s44, 63
    s_cmp_eq_u32 s29, 0
    s_cselect_b32 s44, 63, s44
    s_lshl_b32 s74, s28, 8
    s_lshl_b32 s3, s29, 5
    s_add_u32 s74, s74, s3
    v_mov_b32 v12, 158720
    v_mov_b32 v13, 1
    s_cmp_lt_u32 s30, 4
    s_cbranch_scc1 K_AUX_LO
    s_lshl_b32 s3, s30, 3
    s_add_u32 s3, s3, s74
    s_sub_u32 s3, s3, 32
    v_lshrrev_b32 v9, 3, v1
    v_add_u32 v9, s3, v9
    v_and_b32 v11, 7, v1
    v_lshlrev_b32 v11, 4, v11
    v_mul_u32_u24 v10, 1280, v9
    v_add_u32 v10, v10, v11
    s_waitcnt lgkmcnt(0)
    buffer_load_dwordx4 v[16:19], v10, s[12:15], 0 offen offset:0
    buffer_load_dwordx4 v[20:23], v10, s[12:15], 0 offen offset:128
    buffer_load_dwordx4 v[24:27], v10, s[12:15], 0 offen offset:256
    buffer_load_dwordx4 v[28:31], v10, s[12:15], 0 offen offset:384
    buffer_load_dwordx4 v[32:35], v10, s[12:15], 0 offen offset:512
    buffer_load_dwordx4 v[36:39], v10, s[12:15], 0 offen offset:640
    buffer_load_dwordx4 v[40:43], v10, s[12:15], 0 offen offset:768
    buffer_load_dwordx4 v[44:47], v10, s[12:15], 0 offen offset:896
    buffer_load_dwordx4 v[48:51], v10, s[12:15], 0 offen offset:1024
    buffer_load_dwordx4 v[52:55], v10, s[12:15], 0 offen offset:1152
    s_mov_b32 s16, s48
    s_mov_b32 s17, s49
    s_mov_b32 s18, 0x500
    s_mov_b32 s19, 0x20000
    s_mov_b32 s20, s56
    s_mov_b32 s21, s57
    s_mov_b32 s22, 0x500
    s_mov_b32 s23, 0x20000
    buffer_load_dwordx4 v[56:59], v11, s[16:19], 0 offen offset:0
    buffer_load_dwordx4 v[60:63], v11, s[16:19], 0 offen offset:128
    buffer_load_dwordx4 v[64:67], v11, s[16:19], 0 offen offset:256
    buffer_load_dwordx4 v[68:71], v11, s[16:19], 0 offen offset:384
    buffer_load_dwordx4 v[72:75], v11, s[16:19], 0 offen offset:512
    buffer_load_dwordx4 v[76:79], v11, s[16:19], 0 offen offset:640
    buffer_load_dwordx4 v[80:83], v11, s[16:19], 0 offen offset:768
    buffer_load_dwordx4 v[84:87], v11, s[16:19], 0 offen offset:896
    buffer_load_dwordx4 v[88:91], v11, s[16:19], 0 offen offset:1024
    buffer_load_dwordx4 v[92:95], v11, s[16:19], 0 offen offset:1152
    buffer_load_dwordx4 v[96:99], v11, s[20:23], 0 offen offset:0
    buffer_load_dwordx4 v[100:103], v11, s[20:23], 0 offen offset:128
    buffer_load_dwordx4 v[104:107], v11, s[20:23], 0 offen offset:256
    buffer_load_dwordx4 v[108:111], v11, s[20:23], 0 offen offset:384
    buffer_load_dwordx4 v[112:115], v11, s[20:23], 0 offen offset:512
    buffer_load_dwordx4 v[116:119], v11, s[20:23], 0 offen offset:640
    buffer_load_dwordx4 v[120:123], v11, s[20:23], 0 offen offset:768
    buffer_load_dwordx4 v[124:127], v11, s[20:23], 0 offen offset:896
    buffer_load_dwordx4 v[128:131], v11, s[20:23], 0 offen offset:1024
    buffer_load_dwordx4 v[132:135], v11, s[20:23], 0 offen offset:1152
    s_barrier
    v_mov_b32 v180, 0
    v_mov_b32 v181, 0
    v_mov_b32 v182, 0
    v_mov_b32 v183, 0
    v_and_b32 v10, 31, v9
    v_lshlrev_b32 v10, 2, v10
    v_add_u32 v10, 122880, v10
    v_sub_u32 v4, 0x87ff, v9
    s_setprio 2
    s_waitcnt vmcnt(10)
    v_dot2c_f32_bf16 v180, v16, v56
    v_dot2c_f32_bf16 v181, v17, v57
    v_dot2c_f32_bf16 v180, v18, v58
    v_dot2c_f32_bf16 v181, v19, v59
    v_dot2c_f32_bf16 v180, v20, v60
    v_dot2c_f32_bf16 v181, v21, v61
    v_dot2c_f32_bf16 v180, v22, v62
    v_dot2c_f32_bf16 v181, v23, v63
    v_dot2c_f32_bf16 v180, v24, v64
    v_dot2c_f32_bf16 v181, v25, v65
    v_dot2c_f32_bf16 v180, v26, v66
    v_dot2c_f32_bf16 v181, v27, v67
    v_dot2c_f32_bf16 v180, v28, v68
    v_dot2c_f32_bf16 v181, v29, v69
    v_dot2c_f32_bf16 v180, v30, v70
    v_dot2c_f32_bf16 v181, v31, v71
    v_dot2c_f32_bf16 v180, v32, v72
    v_dot2c_f32_bf16 v181, v33, v73
    v_dot2c_f32_bf16 v180, v34, v74
    v_dot2c_f32_bf16 v181, v35, v75
    v_dot2c_f32_bf16 v180, v36, v76
    v_dot2c_f32_bf16 v181, v37, v77
    v_dot2c_f32_bf16 v180, v38, v78
    v_dot2c_f32_bf16 v181, v39, v79
    v_dot2c_f32_bf16 v180, v40, v80
    v_dot2c_f32_bf16 v181, v41, v81
    v_dot2c_f32_bf16 v180, v42, v82
    v_dot2c_f32_bf16 v181, v43, v83
    v_dot2c_f32_bf16 v180, v44, v84
    v_dot2c_f32_bf16 v181, v45, v85
    v_dot2c_f32_bf16 v180, v46, v86
    v_dot2c_f32_bf16 v181, v47, v87
    v_dot2c_f32_bf16 v180, v48, v88
    v_dot2c_f32_bf16 v181, v49, v89
    v_dot2c_f32_bf16 v180, v50, v90
    v_dot2c_f32_bf16 v181, v51, v91
    v_dot2c_f32_bf16 v180, v52, v92
    v_dot2c_f32_bf16 v181, v53, v93
    v_dot2c_f32_bf16 v180, v54, v94
    v_dot2c_f32_bf16 v181, v55, v95
    s_waitcnt vmcnt(0)
    v_dot2c_f32_bf16 v182, v16, v96
    v_dot2c_f32_bf16 v183, v17, v97
    v_dot2c_f32_bf16 v182, v18, v98
    v_dot2c_f32_bf16 v183, v19, v99
    v_dot2c_f32_bf16 v182, v20, v100
    v_dot2c_f32_bf16 v183, v21, v101
    v_dot2c_f32_bf16 v182, v22, v102
    v_dot2c_f32_bf16 v183, v23, v103
    v_dot2c_f32_bf16 v182, v24, v104
    v_dot2c_f32_bf16 v183, v25, v105
    v_dot2c_f32_bf16 v182, v26, v106
    v_dot2c_f32_bf16 v183, v27, v107
    v_dot2c_f32_bf16 v182, v28, v108
    v_dot2c_f32_bf16 v183, v29, v109
    v_dot2c_f32_bf16 v182, v30, v110
    v_dot2c_f32_bf16 v183, v31, v111
    v_dot2c_f32_bf16 v182, v32, v112
    v_dot2c_f32_bf16 v183, v33, v113
    v_dot2c_f32_bf16 v182, v34, v114
    v_dot2c_f32_bf16 v183, v35, v115
    v_dot2c_f32_bf16 v182, v36, v116
    v_dot2c_f32_bf16 v183, v37, v117
    v_dot2c_f32_bf16 v182, v38, v118
    v_dot2c_f32_bf16 v183, v39, v119
    v_dot2c_f32_bf16 v182, v40, v120
    v_dot2c_f32_bf16 v183, v41, v121
    v_dot2c_f32_bf16 v182, v42, v122
    v_dot2c_f32_bf16 v183, v43, v123
    v_dot2c_f32_bf16 v182, v44, v124
    v_dot2c_f32_bf16 v183, v45, v125
    v_dot2c_f32_bf16 v182, v46, v126
    v_dot2c_f32_bf16 v183, v47, v127
    v_dot2c_f32_bf16 v182, v48, v128
    v_dot2c_f32_bf16 v183, v49, v129
    v_dot2c_f32_bf16 v182, v50, v130
    v_dot2c_f32_bf16 v183, v51, v131
    v_dot2c_f32_bf16 v182, v52, v132
    v_dot2c_f32_bf16 v183, v53, v133
    v_dot2c_f32_bf16 v182, v54, v134
    v_dot2c_f32_bf16 v183, v55, v135
    s_nop 2
    v_add_f32 v180, v180, v181
    v_add_f32 v182, v182, v183
    s_nop 0
    v_add_f32_dpp v180, v180, v180 quad_perm:[1,0,3,2] row_mask:0xf bank_mask:0xf
    v_add_f32_dpp v182, v182, v182 quad_perm:[1,0,3,2] row_mask:0xf bank_mask:0xf
    s_nop 0
    v_add_f32_dpp v180, v180, v180 quad_perm:[2,3,0,1] row_mask:0xf bank_mask:0xf
    v_add_f32_dpp v182, v182, v182 quad_perm:[2,3,0,1] row_mask:0xf bank_mask:0xf
    s_nop 0
    v_add_f32_dpp v180, v180, v180 row_half_mirror row_mask:0xf bank_mask:0xf
    v_add_f32_dpp v182, v182, v182 row_half_mirror row_mask:0xf bank_mask:0xf
    v_cvt_pk_bf16_f32 v2, v180, v180
    v_lshlrev_b32 v2, 16, v2
    v_ashrrev_i32 v3, 31, v2
    v_or_b32 v3, 0x80000000, v3
    v_xor_b32 v2, v2, v3
    v_and_b32 v2, 0xffff0000, v2
    v_or_b32 v2, v2, v4
    ds_write2_b32 v10, v2, v182 offset0:0 offset1:32
    s_mov_b64 exec, 1
    ds_add_u32 v12, v13 offset:36
    s_mov_b64 exec, -1
    s_setprio 0
    s_cmp_lg_u32 s30, 4
    s_cbranch_scc1 K_WARMA0
    s_call_b64 s[38:39], WP_p2g
    s_branch K_WARMAX
K_WARMA0:
    s_cmp_lg_u32 s30, 5
    s_cbranch_scc1 K_WARMA1
    s_call_b64 s[38:39], WP_gen
    s_branch K_WARMAX
K_WARMA1:
    s_cmp_lg_u32 s30, 6
    s_cbranch_scc1 K_WARMA2
    s_call_b64 s[38:39], WP_help
    s_call_b64 s[38:39], WP_flags
    s_branch K_WARMAX
K_WARMA2:
    s_call_b64 s[38:39], WP_spin
K_WARMAX:
    s_cmp_ge_u32 s30, 6
    s_cselect_b32 s44, 63, s44
    s_cmp_lg_u32 s44, 63
    s_cbranch_scc1 K_FFN_C
    s_mov_b32 s3, 1048576
K_FGH:
    ds_read_b32 v2, v12 offset:48
    s_sleep 8
    s_sub_u32 s3, s3, 1
    s_waitcnt lgkmcnt(0)
    v_readfirstlane_b32 s33, v2
    s_nop 3
    s_cselect_b32 s33, 1, s33
    s_cmp_lt_u32 s33, 1
    s_cbranch_scc1 K_FGH
    s_cmp_eq_u32 s30, 6
    s_cbranch_scc1 K_P2_HELP
    v_mov_b32 v7, 1
    s_branch K_P2_HELP
K_AUX_LO:
    s_waitcnt lgkmcnt(0)
    s_cmp_eq_u32 s30, 0
    s_cbranch_scc1 K_AUX_PUB
    s_cmp_eq_u32 s44, 63
    s_cbranch_scc1 K_AUX_NOF
    s_and_b32 s3, s44, 1
    s_cmp_eq_u32 s3, 0
    s_cselect_b64 s[60:61], s[50:51], s[52:53]
    s_cselect_b64 s[64:65], s[52:53], s[50:51]
    s_cselect_b32 s75, 0, 40960
    s_mov_b32 s62, 0x21c000
    s_mov_b32 s63, 0x20000
    s_mov_b32 s66, 0x21c000
    s_mov_b32 s67, 0x20000
    v_lshrrev_b32 v2, 2, v1
    v_mul_u32_u24 v184, 3456, v2
    v_and_b32 v2, 3, v1
    v_lshl_add_u32 v184, v2, 4, v184
    s_lshl_b32 s72, s44, 6
    v_add_u32 v184, s72, v184
    s_sub_u32 s74, s30, 1
K_FSA0:
    s_lshl_b32 s73, s74, 10
    s_mul_i32 s72, s74, 55296
    s_add_u32 m0, s73, s75
    s_waitcnt vmcnt(5)
    buffer_load_dwordx4 v184, s[60:63], s72 offen lds
    s_add_u32 s74, s74, 3
    s_cmp_lt_u32 s74, 18
    s_cbranch_scc1 K_FSA0
    s_barrier
K_FSA:
    s_lshl_b32 s73, s74, 10
    s_mul_i32 s72, s74, 55296
    s_add_u32 m0, s73, s75
    s_waitcnt vmcnt(5)
    buffer_load_dwordx4 v184, s[60:63], s72 offen lds
    s_add_u32 s74, s74, 3
    s_cmp_lt_u32 s74, 40
    s_cbranch_scc1 K_FSA
    s_sub_u32 s74, s74, 40
    s_xor_b32 s75, s75, 40960
    s_mov_b32 s68, s54
    s_mov_b32 s69, s55
    s_mov_b32 s70, 0x21c000
    s_mov_b32 s71, 0x20000
    s_mul_i32 s3, s44, 40960
    v_lshrrev_b32 v2, 3, v1
    v_mul_u32_u24 v2, 1280, v2
    v_lshrrev_b32 v3, 4, v1
    v_lshlrev_b32 v3, 1, v3
    v_and_b32 v4, 7, v1
    v_xor_b32 v3, v3, v4
    v_lshl_add_u32 v2, v3, 4, v2
    v_add_u32 v185, s3, v2
K_FSB:
    s_lshl_b32 s73, s74, 10
    s_mul_i32 s72, s74, 55296
    s_add_u32 m0, s73, s75
    s_waitcnt vmcnt(5)
    buffer_load_dwordx4 v184, s[64:67], s72 offen lds
    s_add_u32 s74, s74, 3
    s_cmp_lt_u32 s74, 40
    s_cbranch_scc1 K_FSB
    s_sub_u32 s74, s74, 40
    s_mov_b32 s75, 81920
K_FSD0:
    s_lshl_b32 s73, s74, 10
    s_and_b32 s72, s74, 3
    s_mul_i32 s72, s72, 10208
    s_lshl_b32 s3, s74, 5
    s_add_u32 s72, s72, s3
    s_add_u32 m0, s73, s75
    s_waitcnt vmcnt(5)
    buffer_load_dwordx4 v185, s[68:71], s72 offen lds
    s_add_u32 s74, s74, 3
    s_cmp_lt_u32 s74, 18
    s_cbranch_scc1 K_FSD0
    s_waitcnt vmcnt(6)
    s_mov_b64 exec, 1
    ds_add_u32 v12, v13 offset:56
    s_mov_b64 exec, -1
K_FSD:
    s_lshl_b32 s73, s74, 10
    s_and_b32 s72, s74, 3
    s_mul_i32 s72, s72, 10208
    s_lshl_b32 s3, s74, 5
    s_add_u32 s72, s72, s3
    s_add_u32 m0, s73, s75
    s_waitcnt vmcnt(5)
    buffer_load_dwordx4 v185, s[68:71], s72 offen lds
    s_add_u32 s74, s74, 3
    s_cmp_lt_u32 s74, 40
    s_cbranch_scc1 K_FSD
    s_mul_i32 s3, s29, 96
    s_lshl_b32 s72, s30, 5
    s_add_u32 s3, s3, s72
    s_sub_u32 s3, s3, 128
    v_lshrrev_b32 v2, 1, v1
    v_add_u32 v2, s3, v2
    v_mul_u32_u24 v2, 1280, v2
    v_and_b32 v3, 1, v1
    v_lshl_add_u32 v2, v3, 7, v2
    buffer_load_dword v6, v2, s[24:27], 0 offen offset:1024
K_AUX_WR:
    s_mov_b32 s3, 1048576
K_FGR:
    ds_read_b32 v2, v12 offset:60
    s_sleep 2
    s_sub_u32 s3, s3, 1
    s_waitcnt lgkmcnt(0)
    v_readfirstlane_b32 s33, v2
    s_nop 3
    s_cselect_b32 s33, 2, s33
    s_cmp_lt_u32 s33, 2
    s_cbranch_scc1 K_FGR
    s_branch K_P2
K_AUX_NOF:
    s_cmp_lg_u32 s2, 63
    s_cbranch_scc1 K_AUX_NOZ
    s_cmp_lg_u32 s30, 1
    s_cbranch_scc1 K_AUX_NOZ
    s_add_u32 s60, s10, 0x80000
    s_addc_u32 s61, s11, 0
    s_mov_b32 s62, 0xc000
    s_mov_b32 s63, 0x20000
    s_barrier
    s_mov_b32 s3, 1048576
K_FGZ:
    ds_read_b32 v2, v12 offset:36
    s_sleep 2
    s_sub_u32 s3, s3, 1
    s_waitcnt lgkmcnt(0)
    v_readfirstlane_b32 s33, v2
    s_nop 3
    s_cselect_b32 s33, 4, s33
    s_cmp_lt_u32 s33, 4
    s_cbranch_scc1 K_FGZ
    v_and_b32 v4, 7, v1
    v_lshlrev_b32 v4, 2, v4
    s_mov_b32 s3, 131072
K_ZPOLL4:
    v_cmp_eq_u32 vcc, 0, v7
    s_cbranch_vccz K_ZOK4
    s_sub_u32 s3, s3, 1
    s_cbranch_scc1 K_ZOK4
    global_load_dword v7, v4, s[8:9] offset:192 sc1
    s_waitcnt vmcnt(0)
    s_branch K_ZPOLL4
K_ZOK4:
    v_lshlrev_b32 v4, 3, v1
    s_mov_b32 s72, 43008
    s_mov_b32 s3, 131072
    s_setprio 3
K_AGG_POLL:
    buffer_load_dwordx2 v[176:177], v4, s[60:63], s72 offen sc1
    s_waitcnt vmcnt(0)
    v_min_u32 v2, v176, v177
    v_cmp_eq_u32 vcc, 0, v2
    s_cbranch_vccz K_AGG_GOT
    s_sleep 2
    s_sub_u32 s3, s3, 1
    s_cmp_lg_u32 s3, 0
    s_cbranch_scc1 K_AGG_POLL
K_AGG_GOT:
    s_nop 1
    v_max_u32_dpp v3, v176, v176 quad_perm:[1,0,3,2] row_mask:0xf bank_mask:0xf
    s_nop 1
    v_max_u32_dpp v3, v3, v3 quad_perm:[2,3,0,1] row_mask:0xf bank_mask:0xf
    s_nop 1
    v_max_u32_dpp v3, v3, v3 row_half_mirror row_mask:0xf bank_mask:0xf
    s_nop 1
    v_max_u32_dpp v3, v3, v3 row_mirror row_mask:0xf bank_mask:0xf
    s_nop 1
    v_readlane_b32 s74, v3, 0
    v_readlane_b32 s76, v3, 16
    v_readlane_b32 s77, v3, 32
    v_readlane_b32 s78, v3, 48
    s_nop 3
    s_max_u32 s74, s74, s76
    s_max_u32 s77, s77, s78
    s_max_u32 s74, s74, s77
    v_cmp_ne_u32 vcc, s74, v176
    s_nop 1
    v_cndmask_b32 v2, v177, v176, vcc
    s_nop 1
    v_max_u32_dpp v3, v2, v2 quad_perm:[1,0,3,2] row_mask:0xf bank_mask:0xf
    s_nop 1
    v_max_u32_dpp v3, v3, v3 quad_perm:[2,3,0,1] row_mask:0xf bank_mask:0xf
    s_nop 1
    v_max_u32_dpp v3, v3, v3 row_half_mirror row_mask:0xf bank_mask:0xf
    s_nop 1
    v_max_u32_dpp v3, v3, v3 row_mirror row_mask:0xf bank_mask:0xf
    s_nop 1
    v_readlane_b32 s75, v3, 0
    v_readlane_b32 s76, v3, 16
    v_readlane_b32 s77, v3, 32
    v_readlane_b32 s78, v3, 48
    s_nop 3
    s_max_u32 s75, s75, s76
    s_max_u32 s77, s77, s78
    s_max_u32 s75, s75, s77
    v_mov_b32 v176, s74
    v_mov_b32 v177, s75
    s_mov_b32 s62, 40960
    v_lshlrev_b32 v3, 8, v1
    s_mov_b32 s3, 0
    buffer_store_dwordx2 v[176:177], v3, s[60:63], s3 offen offset:128 sc1
    s_mov_b32 s3, 16384
    buffer_store_dwordx2 v[176:177], v3, s[60:63], s3 offen offset:128 sc1
    s_mov_b32 s3, 32768
    buffer_store_dwordx2 v[176:177], v3, s[60:63], s3 offen offset:128 sc1
    s_setprio 0
    s_branch K_AUX_NOK
K_AUX_NOZ:
    s_barrier
K_AUX_NOK:
    s_mov_b32 s3, 1048576
K_FGWD:
    ds_read_b32 v2, v12 offset:48
    s_sleep 4
    s_sub_u32 s3, s3, 1
    s_waitcnt lgkmcnt(0)
    v_readfirstlane_b32 s33, v2
    s_nop 3
    s_cselect_b32 s33, 1, s33
    s_cmp_lt_u32 s33, 1
    s_cbranch_scc1 K_FGWD
    s_branch K_P2
K_AUX_PUB:
    s_add_u32 s60, s10, 0x1000
    s_addc_u32 s61, s11, 0
    s_mov_b32 s62, 0x2000
    s_mov_b32 s63, 0x20000
    v_and_b32 v3, 31, v1
    v_lshlrev_b32 v10, 2, v3
    v_add_u32 v11, 122880, v10
    s_lshl_b32 s72, s74, 2
    s_lshl_b32 s3, s2, 3
    s_add_u32 s3, s3, 567296
    v_mov_b32 v9, s3
    v_and_b32 v5, 7, v1
    v_lshlrev_b32 v5, 2, v5
    s_barrier
    s_setprio 3
    s_mov_b32 s3, 1048576
K_FGRT:
    ds_read_b32 v2, v12 offset:36
    s_sleep 0
    s_sub_u32 s3, s3, 1
    s_waitcnt lgkmcnt(0)
    v_readfirstlane_b32 s33, v2
    s_nop 3
    s_cselect_b32 s33, 4, s33
    s_cmp_lt_u32 s33, 4
    s_cbranch_scc1 K_FGRT
    ds_read2_b32 v[176:177], v11 offset0:0 offset1:32
    global_load_dword v7, v5, s[8:9] offset:192 sc1
    s_waitcnt lgkmcnt(0)
    v_cvt_pk_bf16_f32 v177, v177, v177
    v_lshlrev_b32 v177, 16, v177
    v_mul_f32 v5, 0xbfb8aa3b, v177
    v_exp_f32 v5, v5
    s_nop 0
    v_add_f32 v5, 1.0, v5
    v_rcp_f32 v177, v5
    s_nop 0
    v_cvt_pk_bf16_f32 v177, v177, v177
    v_lshlrev_b32 v177, 16, v177
    s_mov_b32 exec_hi, 0
    buffer_store_dword v177, v10, s[60:63], s72 offen sc1
    s_mov_b64 exec, -1
    s_nop 1
    v_max_u32_dpp v3, v176, v176 quad_perm:[1,0,3,2] row_mask:0xf bank_mask:0xf
    s_nop 1
    v_max_u32_dpp v3, v3, v3 quad_perm:[2,3,0,1] row_mask:0xf bank_mask:0xf
    s_nop 1
    v_max_u32_dpp v3, v3, v3 row_half_mirror row_mask:0xf bank_mask:0xf
    s_nop 1
    v_max_u32_dpp v3, v3, v3 row_mirror row_mask:0xf bank_mask:0xf
    s_nop 1
    v_readlane_b32 s74, v3, 0
    v_readlane_b32 s76, v3, 16
    v_readlane_b32 s77, v3, 32
    v_readlane_b32 s78, v3, 48
    s_nop 3
    s_max_u32 s74, s74, s76
    s_max_u32 s77, s77, s78
    s_max_u32 s74, s74, s77
    v_cmp_ne_u32 vcc, s74, v176
    s_nop 1
    v_cndmask_b32 v176, 0, v176, vcc
    s_nop 1
    v_max_u32_dpp v3, v176, v176 quad_perm:[1,0,3,2] row_mask:0xf bank_mask:0xf
    s_nop 1
    v_max_u32_dpp v3, v3, v3 quad_perm:[2,3,0,1] row_mask:0xf bank_mask:0xf
    s_nop 1
    v_max_u32_dpp v3, v3, v3 row_half_mirror row_mask:0xf bank_mask:0xf
    s_nop 1
    v_max_u32_dpp v3, v3, v3 row_mirror row_mask:0xf bank_mask:0xf
    s_nop 1
    v_readlane_b32 s75, v3, 0
    v_readlane_b32 s76, v3, 16
    v_readlane_b32 s77, v3, 32
    v_readlane_b32 s78, v3, 48
    s_nop 3
    s_max_u32 s75, s75, s76
    s_max_u32 s77, s77, s78
    s_max_u32 s75, s75, s77
    v_mov_b32 v176, s74
    v_mov_b32 v177, s75
    s_waitcnt vmcnt(0)
    v_and_b32 v4, 7, v1
    v_lshlrev_b32 v4, 2, v4
    s_mov_b32 s3, 131072
K_ZPOLL3:
    v_cmp_eq_u32 vcc, 0, v7
    s_cbranch_vccz K_ZOK3
    s_sub_u32 s3, s3, 1
    s_cbranch_scc1 K_ZOK3
    global_load_dword v7, v4, s[8:9] offset:192 sc1
    s_waitcnt vmcnt(0)
    s_branch K_ZPOLL3
K_ZOK3:
    s_mov_b64 exec, 1
    global_store_dwordx2 v9, v[176:177], s[10:11] sc1
    s_mov_b64 exec, -1
    v_and_b32 v3, 1, v1
    v_lshl_add_u32 v3, v3, 2, s42
    v_lshlrev_b32 v10, 4, v1
    s_mov_b32 s3, 131072
K_AUX_POLL:
    s_sleep 6
    global_load_dword v2, v3, s[10:11] offset:128 sc1
    s_waitcnt vmcnt(0)
    v_cmp_eq_u32 vcc, 0, v2
    s_cbranch_vccz K_AUX_GOT
    s_sub_u32 s3, s3, 1
    s_cmp_lg_u32 s3, 0
    s_cbranch_scc1 K_AUX_POLL
K_AUX_GOT:
    v_readlane_b32 s74, v2, 0
    v_readlane_b32 s75, v2, 1
    s_nop 3
    s_and_b32 s74, s74, 0x7ff
    s_sub_u32 s74, 2047, s74
    s_mul_i32 s74, s74, 1280
    s_mov_b32 m0, 125184
    s_nop 0
    buffer_load_dwordx4 v10, s[12:15], s74 offen lds
    s_mov_b64 exec, 0xffff
    buffer_load_dwordx4 v10, s[12:15], s74 offen offset:1024 lds
    s_mov_b64 exec, -1
    s_and_b32 s75, s75, 0x7ff
    s_sub_u32 s75, 2047, s75
    s_mul_i32 s75, s75, 1280
    s_mov_b32 m0, 126528
    s_nop 0
    buffer_load_dwordx4 v10, s[12:15], s75 offen lds
    s_mov_b64 exec, 0xffff
    buffer_load_dwordx4 v10, s[12:15], s75 offen offset:1024 lds
    s_mov_b64 exec, -1
    s_waitcnt vmcnt(0)
    ds_write_b32 v12, v13 offset:48
    s_setprio 0
    s_branch K_P2
.p2align 12
K_FFN_C:
    s_add_u32 s64, s10, 0x10000
    s_addc_u32 s65, s11, 0
    s_mov_b32 s66, 0x43800
    s_mov_b32 s67, 0x20000
    s_and_b32 s73, s30, 1
    v_lshrrev_b32 v232, 4, v1
    v_bfe_u32 v4, v1, 2, 2
    v_lshl_add_u32 v2, v232, 3, v4
    v_and_b32 v3, 3, v1
    v_lshlrev_b32 v3, 3, v3
    v_lshl_add_u32 v233, v2, 6, v3
    s_lshl_b32 s72, s73, 5
    v_add_u32 v233, s72, v233
    v_lshl_add_u32 v2, v232, 2, v4
    v_bfe_u32 v4, v2, 1, 2
    v_lshl_add_u32 v3, v2, 7, v3
    v_lshl_add_u32 v3, v4, 5, v3
    s_mul_i32 s3, s73, 20480
    s_add_u32 s3, s3, 81920
    v_add_u32 v238, s3, v3
    v_xor_b32 v239, 32, v238
    v_xor_b32 v240, 64, v238
    v_xor_b32 v241, 96, v238
    v_and_b32 v2, 1, v1
    v_mul_u32_u24 v234, 1344, v2
    v_lshl_add_u32 v234, v232, 4, v234
    v_add_u32 v234, 125184, v234
    v_lshlrev_b32 v236, 4, v1
    v_add_u32 v236, 124160, v236
    s_lshl_b32 s3, s73, 3
    v_add_u32 v235, s3, v236
    v_mul_u32_u24 v2, 2560, v2
    v_lshl_add_u32 v237, v232, 4, v2
    s_mul_i32 s3, s44, 5120
    s_mul_i32 s72, s73, 1280
    s_add_u32 s72, s72, s3
    v_lshlrev_b32 v2, 4, v1
    buffer_store_dwordx4 v[16:19], v2, s[64:67], s72 offen offset:0 sc1
    buffer_store_dwordx4 v[16:19], v2, s[64:67], s72 offen offset:2560 sc1
    s_mov_b64 exec, 0xffff
    buffer_store_dwordx4 v[16:19], v2, s[64:67], s72 offen offset:1024 sc1
    buffer_store_dwordx4 v[16:19], v2, s[64:67], s72 offen offset:3584 sc1
    s_mov_b64 exec, -1
    v_add_u32 v5, 40960, v233
    s_mov_b32 s3, 1048576
K_FGD:
    ds_read_b32 v2, v12 offset:56
    s_sleep 2
    s_sub_u32 s3, s3, 1
    s_waitcnt lgkmcnt(0)
    v_readfirstlane_b32 s33, v2
    s_nop 3
    s_cselect_b32 s33, 3, s33
    s_cmp_lt_u32 s33, 3
    s_cbranch_scc1 K_FGD
    s_setprio 3
    ds_read_b64_tr_b16 v[16:17], v233 offset:0
    ds_read_b64_tr_b16 v[18:19], v233 offset:256
    ds_read_b64_tr_b16 v[20:21], v233 offset:2048
    ds_read_b64_tr_b16 v[22:23], v233 offset:2304
    ds_read_b64_tr_b16 v[24:25], v233 offset:4096
    ds_read_b64_tr_b16 v[26:27], v233 offset:4352
    ds_read_b64_tr_b16 v[28:29], v233 offset:6144
    ds_read_b64_tr_b16 v[30:31], v233 offset:6400
    ds_read_b64_tr_b16 v[32:33], v233 offset:8192
    ds_read_b64_tr_b16 v[34:35], v233 offset:8448
    ds_read_b64_tr_b16 v[36:37], v233 offset:10240
    ds_read_b64_tr_b16 v[38:39], v233 offset:10496
    ds_read_b64_tr_b16 v[40:41], v233 offset:12288
    ds_read_b64_tr_b16 v[42:43], v233 offset:12544
    ds_read_b64_tr_b16 v[44:45], v233 offset:14336
    ds_read_b64_tr_b16 v[46:47], v233 offset:14592
    ds_read_b64_tr_b16 v[48:49], v233 offset:16384
    ds_read_b64_tr_b16 v[50:51], v233 offset:16640
    ds_read_b64_tr_b16 v[52:53], v233 offset:18432
    ds_read_b64_tr_b16 v[54:55], v233 offset:18688
    ds_read_b64_tr_b16 v[56:57], v233 offset:20480
    ds_read_b64_tr_b16 v[58:59], v233 offset:20736
    ds_read_b64_tr_b16 v[60:61], v233 offset:22528
    ds_read_b64_tr_b16 v[62:63], v233 offset:22784
    ds_read_b64_tr_b16 v[64:65], v233 offset:24576
    ds_read_b64_tr_b16 v[66:67], v233 offset:24832
    ds_read_b64_tr_b16 v[68:69], v233 offset:26624
    ds_read_b64_tr_b16 v[70:71], v233 offset:26880
    ds_read_b64_tr_b16 v[72:73], v233 offset:28672
    ds_read_b64_tr_b16 v[74:75], v233 offset:28928
    ds_read_b64_tr_b16 v[76:77], v233 offset:30720
    ds_read_b64_tr_b16 v[78:79], v233 offset:30976
    ds_read_b64_tr_b16 v[80:81], v233 offset:32768
    ds_read_b64_tr_b16 v[82:83], v233 offset:33024
    ds_read_b64_tr_b16 v[84:85], v233 offset:34816
    ds_read_b64_tr_b16 v[86:87], v233 offset:35072
    ds_read_b64_tr_b16 v[88:89], v233 offset:36864
    ds_read_b64_tr_b16 v[90:91], v233 offset:37120
    ds_read_b64_tr_b16 v[92:93], v233 offset:38912
    ds_read_b64_tr_b16 v[94:95], v233 offset:39168
    ds_read_b64_tr_b16 v[96:97], v5 offset:0
    ds_read_b64_tr_b16 v[98:99], v5 offset:256
    ds_read_b64_tr_b16 v[100:101], v5 offset:2048
    ds_read_b64_tr_b16 v[102:103], v5 offset:2304
    ds_read_b64_tr_b16 v[104:105], v5 offset:4096
    ds_read_b64_tr_b16 v[106:107], v5 offset:4352
    ds_read_b64_tr_b16 v[108:109], v5 offset:6144
    ds_read_b64_tr_b16 v[110:111], v5 offset:6400
    ds_read_b64_tr_b16 v[112:113], v5 offset:8192
    ds_read_b64_tr_b16 v[114:115], v5 offset:8448
    ds_read_b64_tr_b16 v[116:117], v5 offset:10240
    ds_read_b64_tr_b16 v[118:119], v5 offset:10496
    ds_read_b64_tr_b16 v[120:121], v5 offset:12288
    ds_read_b64_tr_b16 v[122:123], v5 offset:12544
    ds_read_b64_tr_b16 v[124:125], v5 offset:14336
    ds_read_b64_tr_b16 v[126:127], v5 offset:14592
    ds_read_b64_tr_b16 v[128:129], v5 offset:16384
    ds_read_b64_tr_b16 v[130:131], v5 offset:16640
    ds_read_b64_tr_b16 v[132:133], v5 offset:18432
    ds_read_b64_tr_b16 v[134:135], v5 offset:18688
    ds_read_b64_tr_b16 v[136:137], v5 offset:20480
    ds_read_b64_tr_b16 v[138:139], v5 offset:20736
    ds_read_b64_tr_b16 v[140:141], v5 offset:22528
    ds_read_b64_tr_b16 v[142:143], v5 offset:22784
    ds_read_b64_tr_b16 v[144:145], v5 offset:24576
    ds_read_b64_tr_b16 v[146:147], v5 offset:24832
    ds_read_b64_tr_b16 v[148:149], v5 offset:26624
    ds_read_b64_tr_b16 v[150:151], v5 offset:26880
    ds_read_b64_tr_b16 v[152:153], v5 offset:28672
    ds_read_b64_tr_b16 v[154:155], v5 offset:28928
    ds_read_b64_tr_b16 v[156:157], v5 offset:30720
    ds_read_b64_tr_b16 v[158:159], v5 offset:30976
    ds_read_b64_tr_b16 v[160:161], v5 offset:32768
    ds_read_b64_tr_b16 v[162:163], v5 offset:33024
    ds_read_b64_tr_b16 v[164:165], v5 offset:34816
    ds_read_b64_tr_b16 v[166:167], v5 offset:35072
    ds_read_b64_tr_b16 v[168:169], v5 offset:36864
    ds_read_b64_tr_b16 v[170:171], v5 offset:37120
    ds_read_b64_tr_b16 v[172:173], v5 offset:38912
    ds_read_b64_tr_b16 v[174:175], v5 offset:39168
    s_waitcnt vmcnt(0) lgkmcnt(0)
    s_mov_b64 exec, 1
    ds_add_u32 v12, v13 offset:60
    s_mov_b64 exec, -1
    s_mov_b32 s3, 1048576
K_FGK:
    ds_read_b32 v2, v12 offset:48
    s_sleep 1
    s_sub_u32 s3, s3, 1
    s_waitcnt lgkmcnt(0)
    v_readfirstlane_b32 s33, v2
    s_nop 3
    s_cselect_b32 s33, 1, s33
    s_cmp_lt_u32 s33, 1
    s_cbranch_scc1 K_FGK
    ds_read_b128 v[188:191], v234 offset:0
    ds_read_b128 v[192:195], v234 offset:64
    ds_read_b128 v[196:199], v234 offset:128
    ds_read_b128 v[200:203], v234 offset:192
    ds_read_b128 v[204:207], v234 offset:256
    ds_read_b128 v[208:211], v234 offset:320
    ds_read_b128 v[212:215], v234 offset:384
    ds_read_b128 v[216:219], v234 offset:448
    s_waitcnt lgkmcnt(7)
    v_mfma_f32_16x16x32_bf16 v[220:223], v[16:19], v[188:191], 0
    v_mfma_f32_16x16x32_bf16 v[224:227], v[96:99], v[188:191], 0
    ds_read_b128 v[188:191], v234 offset:512
    s_waitcnt lgkmcnt(7)
    v_mfma_f32_16x16x32_bf16 v[220:223], v[20:23], v[192:195], v[220:223]
    v_mfma_f32_16x16x32_bf16 v[224:227], v[100:103], v[192:195], v[224:227]
    ds_read_b128 v[192:195], v234 offset:576
    s_waitcnt lgkmcnt(7)
    v_mfma_f32_16x16x32_bf16 v[220:223], v[24:27], v[196:199], v[220:223]
    v_mfma_f32_16x16x32_bf16 v[224:227], v[104:107], v[196:199], v[224:227]
    ds_read_b128 v[196:199], v234 offset:640
    s_waitcnt lgkmcnt(7)
    v_mfma_f32_16x16x32_bf16 v[220:223], v[28:31], v[200:203], v[220:223]
    v_mfma_f32_16x16x32_bf16 v[224:227], v[108:111], v[200:203], v[224:227]
    ds_read_b128 v[200:203], v234 offset:704
    s_waitcnt lgkmcnt(7)
    v_mfma_f32_16x16x32_bf16 v[220:223], v[32:35], v[204:207], v[220:223]
    v_mfma_f32_16x16x32_bf16 v[224:227], v[112:115], v[204:207], v[224:227]
    ds_read_b128 v[204:207], v234 offset:768
    s_waitcnt lgkmcnt(7)
    v_mfma_f32_16x16x32_bf16 v[220:223], v[36:39], v[208:211], v[220:223]
    v_mfma_f32_16x16x32_bf16 v[224:227], v[116:119], v[208:211], v[224:227]
    ds_read_b128 v[208:211], v234 offset:832
    s_waitcnt lgkmcnt(7)
    v_mfma_f32_16x16x32_bf16 v[220:223], v[40:43], v[212:215], v[220:223]
    v_mfma_f32_16x16x32_bf16 v[224:227], v[120:123], v[212:215], v[224:227]
    ds_read_b128 v[212:215], v234 offset:896
    s_waitcnt lgkmcnt(7)
    v_mfma_f32_16x16x32_bf16 v[220:223], v[44:47], v[216:219], v[220:223]
    v_mfma_f32_16x16x32_bf16 v[224:227], v[124:127], v[216:219], v[224:227]
    ds_read_b128 v[216:219], v234 offset:960
    s_waitcnt lgkmcnt(7)
    v_mfma_f32_16x16x32_bf16 v[220:223], v[48:51], v[188:191], v[220:223]
    v_mfma_f32_16x16x32_bf16 v[224:227], v[128:131], v[188:191], v[224:227]
    ds_read_b128 v[188:191], v234 offset:1024
    s_waitcnt lgkmcnt(7)
    v_mfma_f32_16x16x32_bf16 v[220:223], v[52:55], v[192:195], v[220:223]
    v_mfma_f32_16x16x32_bf16 v[224:227], v[132:135], v[192:195], v[224:227]
    ds_read_b128 v[192:195], v234 offset:1088
    s_waitcnt lgkmcnt(7)
    v_mfma_f32_16x16x32_bf16 v[220:223], v[56:59], v[196:199], v[220:223]
    v_mfma_f32_16x16x32_bf16 v[224:227], v[136:139], v[196:199], v[224:227]
    ds_read_b128 v[196:199], v234 offset:1152
    s_waitcnt lgkmcnt(7)
    v_mfma_f32_16x16x32_bf16 v[220:223], v[60:63], v[200:203], v[220:223]
    v_mfma_f32_16x16x32_bf16 v[224:227], v[140:143], v[200:203], v[224:227]
    ds_read_b128 v[200:203], v234 offset:1216
    s_waitcnt lgkmcnt(7)
    v_mfma_f32_16x16x32_bf16 v[220:223], v[64:67], v[204:207], v[220:223]
    v_mfma_f32_16x16x32_bf16 v[224:227], v[144:147], v[204:207], v[224:227]
    s_waitcnt lgkmcnt(6)
    v_mfma_f32_16x16x32_bf16 v[220:223], v[68:71], v[208:211], v[220:223]
    v_mfma_f32_16x16x32_bf16 v[224:227], v[148:151], v[208:211], v[224:227]
    s_waitcnt lgkmcnt(5)
    v_mfma_f32_16x16x32_bf16 v[220:223], v[72:75], v[212:215], v[220:223]
    v_mfma_f32_16x16x32_bf16 v[224:227], v[152:155], v[212:215], v[224:227]
    s_waitcnt lgkmcnt(4)
    v_mfma_f32_16x16x32_bf16 v[220:223], v[76:79], v[216:219], v[220:223]
    v_mfma_f32_16x16x32_bf16 v[224:227], v[156:159], v[216:219], v[224:227]
    s_waitcnt lgkmcnt(3)
    v_mfma_f32_16x16x32_bf16 v[220:223], v[80:83], v[188:191], v[220:223]
    v_mfma_f32_16x16x32_bf16 v[224:227], v[160:163], v[188:191], v[224:227]
    s_waitcnt lgkmcnt(2)
    v_mfma_f32_16x16x32_bf16 v[220:223], v[84:87], v[192:195], v[220:223]
    v_mfma_f32_16x16x32_bf16 v[224:227], v[164:167], v[192:195], v[224:227]
    s_waitcnt lgkmcnt(1)
    v_mfma_f32_16x16x32_bf16 v[220:223], v[88:91], v[196:199], v[220:223]
    v_mfma_f32_16x16x32_bf16 v[224:227], v[168:171], v[196:199], v[224:227]
    s_waitcnt lgkmcnt(0)
    v_mfma_f32_16x16x32_bf16 v[220:223], v[92:95], v[200:203], v[220:223]
    v_mfma_f32_16x16x32_bf16 v[224:227], v[172:175], v[200:203], v[224:227]
    s_mov_b32 s3, 1048576
K_FGDN:
    ds_read_b32 v2, v12 offset:52
    s_sleep 1
    s_sub_u32 s3, s3, 1
    s_waitcnt lgkmcnt(0)
    v_readfirstlane_b32 s33, v2
    s_nop 3
    s_cselect_b32 s33, 3, s33
    s_cmp_lt_u32 s33, 3
    s_cbranch_scc1 K_FGDN
    ds_read_b64_tr_b16 v[16:17], v238 offset:0
    ds_read_b64_tr_b16 v[18:19], v238 offset:2048
    ds_read_b64_tr_b16 v[20:21], v239 offset:0
    ds_read_b64_tr_b16 v[22:23], v239 offset:2048
    ds_read_b64_tr_b16 v[24:25], v240 offset:0
    ds_read_b64_tr_b16 v[26:27], v240 offset:2048
    ds_read_b64_tr_b16 v[28:29], v241 offset:0
    ds_read_b64_tr_b16 v[30:31], v241 offset:2048
    ds_read_b64_tr_b16 v[32:33], v238 offset:4096
    ds_read_b64_tr_b16 v[34:35], v238 offset:6144
    ds_read_b64_tr_b16 v[36:37], v239 offset:4096
    ds_read_b64_tr_b16 v[38:39], v239 offset:6144
    ds_read_b64_tr_b16 v[40:41], v240 offset:4096
    ds_read_b64_tr_b16 v[42:43], v240 offset:6144
    v_cvt_pk_bf16_f32 v221, v220, v221
    v_lshlrev_b32 v220, 16, v221
    v_and_b32 v221, 0xffff0000, v221
    v_cvt_pk_bf16_f32 v223, v222, v223
    v_lshlrev_b32 v222, 16, v223
    v_and_b32 v223, 0xffff0000, v223
    v_cvt_pk_bf16_f32 v225, v224, v225
    v_lshlrev_b32 v224, 16, v225
    v_and_b32 v225, 0xffff0000, v225
    v_cvt_pk_bf16_f32 v227, v226, v227
    v_lshlrev_b32 v226, 16, v227
    v_and_b32 v227, 0xffff0000, v227
    v_mul_f32 v188, 0xbfb8aa3b, v220
    v_mul_f32 v189, 0xbfb8aa3b, v221
    v_mul_f32 v190, 0xbfb8aa3b, v222
    v_mul_f32 v191, 0xbfb8aa3b, v223
    v_exp_f32 v188, v188
    v_exp_f32 v189, v189
    v_exp_f32 v190, v190
    v_exp_f32 v191, v191
    v_add_f32 v188, 1.0, v188
    v_add_f32 v189, 1.0, v189
    v_add_f32 v190, 1.0, v190
    v_add_f32 v191, 1.0, v191
    v_rcp_f32 v188, v188
    v_rcp_f32 v189, v189
    v_rcp_f32 v190, v190
    v_rcp_f32 v191, v191
    v_mul_f32 v220, v220, v188
    v_mul_f32 v221, v221, v189
    v_mul_f32 v222, v222, v190
    v_mul_f32 v223, v223, v191
    v_cvt_pk_bf16_f32 v221, v220, v221
    v_lshlrev_b32 v220, 16, v221
    v_and_b32 v221, 0xffff0000, v221
    v_cvt_pk_bf16_f32 v223, v222, v223
    v_lshlrev_b32 v222, 16, v223
    v_and_b32 v223, 0xffff0000, v223
    v_mul_f32 v220, v220, v224
    v_mul_f32 v221, v221, v225
    v_mul_f32 v222, v222, v226
    v_mul_f32 v223, v223, v227
    v_cvt_pk_bf16_f32 v228, v220, v221
    v_cvt_pk_bf16_f32 v229, v222, v223
    ds_write_b64 v235, v[228:229]
    s_mov_b64 exec, 1
    ds_add_u32 v12, v13 offset:52
    s_mov_b64 exec, -1
    ds_read_b64_tr_b16 v[44:45], v241 offset:4096
    ds_read_b64_tr_b16 v[46:47], v241 offset:6144
    ds_read_b64_tr_b16 v[48:49], v238 offset:8192
    ds_read_b64_tr_b16 v[50:51], v238 offset:10240
    ds_read_b64_tr_b16 v[52:53], v239 offset:8192
    ds_read_b64_tr_b16 v[54:55], v239 offset:10240
    ds_read_b64_tr_b16 v[56:57], v240 offset:8192
    ds_read_b64_tr_b16 v[58:59], v240 offset:10240
    ds_read_b64_tr_b16 v[60:61], v241 offset:8192
    ds_read_b64_tr_b16 v[62:63], v241 offset:10240
    ds_read_b64_tr_b16 v[64:65], v238 offset:12288
    ds_read_b64_tr_b16 v[66:67], v238 offset:14336
    ds_read_b64_tr_b16 v[68:69], v239 offset:12288
    ds_read_b64_tr_b16 v[70:71], v239 offset:14336
    ds_read_b64_tr_b16 v[72:73], v240 offset:12288
    ds_read_b64_tr_b16 v[74:75], v240 offset:14336
    ds_read_b64_tr_b16 v[76:77], v241 offset:12288
    ds_read_b64_tr_b16 v[78:79], v241 offset:14336
    ds_read_b64_tr_b16 v[80:81], v238 offset:16384
    ds_read_b64_tr_b16 v[82:83], v238 offset:18432
    ds_read_b64_tr_b16 v[84:85], v239 offset:16384
    ds_read_b64_tr_b16 v[86:87], v239 offset:18432
    ds_read_b64_tr_b16 v[88:89], v240 offset:16384
    ds_read_b64_tr_b16 v[90:91], v240 offset:18432
    ds_read_b64_tr_b16 v[92:93], v241 offset:16384
    ds_read_b64_tr_b16 v[94:95], v241 offset:18432
    s_mov_b32 s3, 1048576
K_FGP:
    ds_read_b32 v2, v12 offset:52
    s_sleep 0
    s_sub_u32 s3, s3, 1
    s_waitcnt lgkmcnt(0)
    v_readfirstlane_b32 s33, v2
    s_nop 3
    s_cselect_b32 s33, 5, s33
    s_cmp_lt_u32 s33, 5
    s_cbranch_scc1 K_FGP
    ds_read_b128 v[228:231], v236
    s_waitcnt lgkmcnt(0)
    v_mfma_f32_16x16x32_bf16 v[96:99], v[16:19], v[228:231], 0
    v_mfma_f32_16x16x32_bf16 v[100:103], v[20:23], v[228:231], 0
    v_mfma_f32_16x16x32_bf16 v[104:107], v[24:27], v[228:231], 0
    v_mfma_f32_16x16x32_bf16 v[108:111], v[28:31], v[228:231], 0
    v_mfma_f32_16x16x32_bf16 v[112:115], v[32:35], v[228:231], 0
    v_mfma_f32_16x16x32_bf16 v[116:119], v[36:39], v[228:231], 0
    v_mfma_f32_16x16x32_bf16 v[120:123], v[40:43], v[228:231], 0
    v_mfma_f32_16x16x32_bf16 v[124:127], v[44:47], v[228:231], 0
    v_mfma_f32_16x16x32_bf16 v[128:131], v[48:51], v[228:231], 0
    v_mfma_f32_16x16x32_bf16 v[132:135], v[52:55], v[228:231], 0
    v_mfma_f32_16x16x32_bf16 v[136:139], v[56:59], v[228:231], 0
    v_mfma_f32_16x16x32_bf16 v[140:143], v[60:63], v[228:231], 0
    v_mfma_f32_16x16x32_bf16 v[144:147], v[64:67], v[228:231], 0
    v_mfma_f32_16x16x32_bf16 v[148:151], v[68:71], v[228:231], 0
    v_mfma_f32_16x16x32_bf16 v[152:155], v[72:75], v[228:231], 0
    v_mfma_f32_16x16x32_bf16 v[156:159], v[76:79], v[228:231], 0
    v_mfma_f32_16x16x32_bf16 v[160:163], v[80:83], v[228:231], 0
    v_mfma_f32_16x16x32_bf16 v[164:167], v[84:87], v[228:231], 0
    v_mfma_f32_16x16x32_bf16 v[168:171], v[88:91], v[228:231], 0
    v_mfma_f32_16x16x32_bf16 v[172:175], v[92:95], v[228:231], 0
    s_mov_b32 exec_lo, 0x00030003
    s_mov_b32 exec_hi, 0x00030003
    buffer_store_dwordx4 v[96:99], v237, s[64:67], s72 offen offset:0 sc1
    buffer_store_dwordx4 v[100:103], v237, s[64:67], s72 offen offset:64 sc1
    buffer_store_dwordx4 v[104:107], v237, s[64:67], s72 offen offset:128 sc1
    buffer_store_dwordx4 v[108:111], v237, s[64:67], s72 offen offset:192 sc1
    buffer_store_dwordx4 v[112:115], v237, s[64:67], s72 offen offset:256 sc1
    buffer_store_dwordx4 v[116:119], v237, s[64:67], s72 offen offset:320 sc1
    buffer_store_dwordx4 v[120:123], v237, s[64:67], s72 offen offset:384 sc1
    buffer_store_dwordx4 v[124:127], v237, s[64:67], s72 offen offset:448 sc1
    buffer_store_dwordx4 v[128:131], v237, s[64:67], s72 offen offset:512 sc1
    buffer_store_dwordx4 v[132:135], v237, s[64:67], s72 offen offset:576 sc1
    buffer_store_dwordx4 v[136:139], v237, s[64:67], s72 offen offset:640 sc1
    buffer_store_dwordx4 v[140:143], v237, s[64:67], s72 offen offset:704 sc1
    buffer_store_dwordx4 v[144:147], v237, s[64:67], s72 offen offset:768 sc1
    buffer_store_dwordx4 v[148:151], v237, s[64:67], s72 offen offset:832 sc1
    buffer_store_dwordx4 v[152:155], v237, s[64:67], s72 offen offset:896 sc1
    buffer_store_dwordx4 v[156:159], v237, s[64:67], s72 offen offset:960 sc1
    buffer_store_dwordx4 v[160:163], v237, s[64:67], s72 offen offset:1024 sc1
    buffer_store_dwordx4 v[164:167], v237, s[64:67], s72 offen offset:1088 sc1
    buffer_store_dwordx4 v[168:171], v237, s[64:67], s72 offen offset:1152 sc1
    buffer_store_dwordx4 v[172:175], v237, s[64:67], s72 offen offset:1216 sc1
    s_mov_b64 exec, -1
    s_lshl_b32 s3, s44, 5
    s_lshl3_add_u32 s3, s73, s3
    s_add_u32 s3, s3, 565248
    v_mov_b32 v2, s3
    v_mov_b32 v228, 1
    v_mov_b32 v229, 1
    s_waitcnt vmcnt(0)
    s_mov_b64 exec, 1
    global_store_dwordx2 v2, v[228:229], s[10:11] sc1
    s_mov_b64 exec, -1
    s_branch K_P2_HELP
K_CODE_END:
.section .rodata,"a"
.p2align 6
.amdhsa_kernel gated_mix__sliding_local_dilated__moe_arch_mod__prompt_kernel
  .amdhsa_next_free_vgpr 248
  .amdhsa_next_free_sgpr 79
  .amdhsa_accum_offset 248
  .amdhsa_group_segment_fixed_size 0
  .amdhsa_kernarg_size 96
  .amdhsa_user_sgpr_count 2
  .amdhsa_user_sgpr_kernarg_segment_ptr 1
  .amdhsa_system_sgpr_workgroup_id_x 1
.end_amdhsa_kernel
```

```asm
; @launch grid=(256,1,1) block=(512,1,1) lds=163840
.amdgcn_target "amdgcn-amd-amdhsa--gfx950"
.text
.p2align 12
.p2align 8
.globl gated_mix__sliding_local_dilated__moe_arch_mod__prompt_kernel
.type gated_mix__sliding_local_dilated__moe_arch_mod__prompt_kernel,@function
gated_mix__sliding_local_dilated__moe_arch_mod__prompt_kernel:
    s_cmp_ge_u32 s2, 256
    s_cbranch_scc1 K_EXIT
    s_load_dwordx2 s[12:13], s[0:1], 0
    s_load_dwordx2 s[16:17], s[0:1], 8
    v_readfirstlane_b32 s30, v0
    s_load_dwordx4 s[8:11], s[0:1], 80
    s_load_dwordx2 s[24:25], s[0:1], 16
    s_load_dwordx2 s[6:7], s[0:1], 72
    s_and_b32 s28, s2, 7
    v_and_b32 v1, 63, v0
    s_mov_b32 s14, 0x280000
    s_mov_b32 s15, 0x20000
    s_lshr_b32 s30, s30, 6
    s_cmp_lt_u32 s2, 64
    s_cbranch_scc1 K_SLOW
    s_cmp_lt_u32 s30, 4
    s_cbranch_scc1 K_FAST
K_SLOW:
    s_getpc_b64 s[38:39]
K_PC:
    s_bfe_u32 s3, s2, 0x30003
    s_mul_i32 s3, s3, ((K_CODE_END-gated_mix__sliding_local_dilated__moe_arch_mod__prompt_kernel+1023)/1024)
    s_sub_u32 s38, s38, K_PC-gated_mix__sliding_local_dilated__moe_arch_mod__prompt_kernel
    s_subb_u32 s39, s39, 0
    v_subrev_u32 v3, 256, v0
    v_add_u32 v2, s3, v3
    v_lshlrev_b32 v2, 7, v2
    v_min_u32 v2, K_CODE_END-gated_mix__sliding_local_dilated__moe_arch_mod__prompt_kernel-4, v2
    v_cmp_gt_u32 vcc, ((K_CODE_END-gated_mix__sliding_local_dilated__moe_arch_mod__prompt_kernel+1023)/1024), v3
    s_and_saveexec_b64 s[4:5], vcc
    s_cbranch_execz K_NOPF
    global_load_dword v6, v2, s[38:39]
K_NOPF:
    s_mov_b64 exec, -1
    v_mov_b32 v2, 0
    v_mov_b32 v3, 158752
    ds_write2_b32 v3, v2, v2 offset0:0 offset1:1
    ds_write2_b32 v3, v2, v2 offset0:2 offset1:3
    ds_write2_b32 v3, v2, v2 offset0:4 offset1:5
    ds_write2_b32 v3, v2, v2 offset0:6 offset1:7
    ds_write2_b32 v3, v2, v2 offset0:8 offset1:9
    s_mov_b32 s43, 1
    s_lshl_b32 s3, s30, 8
    s_add_u32 s3, s3, s2
    s_lshr_b32 s3, s3, 3
    s_cmp_lg_u32 s3, 160
    s_cbranch_scc1 K_COMMON
    s_mul_i32 s3, s2, 6144
    s_add_u32 s3, s3, 527360
    v_lshl_add_u32 v6, v1, 4, s3
    v_mov_b64 v[28:29], 0
    v_mov_b64 v[30:31], 0
    s_waitcnt lgkmcnt(0)
    global_store_dwordx4 v6, v[28:31], s[10:11] offset:-3072 sc1
    global_store_dwordx4 v6, v[28:31], s[10:11] offset:-2048 sc1
    global_store_dwordx4 v6, v[28:31], s[10:11] offset:-1024 sc1
    global_store_dwordx4 v6, v[28:31], s[10:11] offset:0 sc1
    global_store_dwordx4 v6, v[28:31], s[10:11] offset:1024 sc1
    global_store_dwordx4 v6, v[28:31], s[10:11] offset:2048 sc1
    s_lshl_b32 s3, s2, 2
    v_mov_b32 v2, s3
    v_mov_b32 v3, 1
    s_mov_b64 exec, 1
    s_waitcnt vmcnt(0)
    global_store_dword v2, v3, s[8:9] offset:192 sc1
    s_mov_b64 exec, -1
    s_branch K_COMMON
K_FAST:
    s_lshr_b32 s32, s2, 1
    s_and_b32 s32, s32, 28
    v_lshrrev_b32 v3, 4, v1
    s_lshr_b32 s3, s2, 6
    s_mov_b32 s59, 0x98450216
    s_cmp_eq_u32 s3, 2
    s_cselect_b32 s59, 0x70238164, s59
    v_and_b32 v4, 7, v1
    s_cmp_eq_u32 s3, 3
    s_cselect_b32 s59, 0x65703481, s59
    v_lshrrev_b32 v2, 3, v1
    s_lshr_b32 s59, s59, s32
    s_and_b32 s59, s59, 15
    v_xor_b32 v4, v4, v3
    s_add_u32 s59, s59, s28
    s_cmp_ge_u32 s59, 10
    v_mul_u32_u24 v2, 1280, v2
    s_cselect_b32 s33, 10, 0
    s_sub_u32 s59, s59, s33
    s_lshr_b32 s53, s28, 1
    v_lshl_add_u32 v44, v4, 4, v2
    s_mul_i32 s53, s53, 655360
    s_lshl2_add_u32 s62, s3, s30
    s_cmp_eq_u32 s62, 15
    s_cselect_b32 s62, 0x800000, 0
    s_add_u32 s62, s62, 40960
    s_mul_i32 s3, s3, 225280
    v_xor_b32 v45, 64, v44
    s_add_u32 s53, s53, s3
    s_mul_i32 s54, s30, 61440
    s_add_u32 s53, s53, s54
    s_sub_u32 s53, s53, 245760
    s_mul_i32 s55, s30, 6144
    s_add_u32 s55, s55, 40960
    s_lshl_b32 s57, s59, 7
    s_add_u32 s57, s57, s53
    s_waitcnt lgkmcnt(0)
    s_add_u32 m0, s55, 0
    s_max_i32 s60, s57, 0
    buffer_load_dwordx4 v44, s[12:15], s60 offen lds
    s_add_u32 s60, s57, 10240
    s_add_u32 m0, s55, 1024
    s_max_i32 s60, s60, 0
    buffer_load_dwordx4 v45, s[12:15], s60 offen lds
    s_add_u32 m0, s55, 2048
    s_add_u32 s60, s57, 20480
    buffer_load_dwordx4 v44, s[12:15], s60 offen lds
    s_add_u32 m0, s55, 3072
    s_add_u32 s60, s57, 30720
    buffer_load_dwordx4 v45, s[12:15], s60 offen lds
    s_add_u32 m0, s55, 4096
    s_add_u32 s60, s57, s62
    buffer_load_dwordx4 v44, s[12:15], s60 offen lds
    s_add_u32 m0, s55, 5120
    s_add_u32 s60, s60, 10240
    buffer_load_dwordx4 v45, s[12:15], s60 offen lds
    v_lshlrev_b32 v2, 1, v3
    s_lshr_b32 s32, 0x64317520, s32
    v_sub_u32 v2, v1, v2
    s_and_b32 s32, s32, 7
    v_and_b32 v2, 15, v2
    s_and_b32 s3, s28, 1
    v_mul_u32_u24 v3, 3840, v3
    s_lshl3_add_u32 s32, s3, s32
    v_mul_u32_u24 v4, 13, v2
    s_mul_i32 s3, s32, 80
    v_lshrrev_b32 v4, 6, v4
    s_add_u32 s54, s54, s3
    v_mul_u32_u24 v4, 1200, v4
    s_lshl_b32 s56, s30, 12
    v_lshl_add_u32 v4, v2, 4, v4
    s_add_u32 s56, s56, 65536
    v_add_u32 v5, 1, v2
    s_mov_b32 s18, 0x258000
    v_and_b32 v5, 16, v5
    s_mov_b32 s19, 0x20000
    v_lshl_add_u32 v4, v5, 24, v4
    v_add_u32 v46, v3, v4
    s_mul_i32 s58, s59, 245760
    s_add_u32 s58, s58, s54
    s_add_u32 s59, s59, 1
    s_cmp_eq_u32 s59, 10
    s_cselect_b32 s59, 0, s59
    s_add_u32 m0, s56, 0
    s_add_u32 s60, s58, 0
    buffer_load_dwordx4 v46, s[16:19], s60 offen lds
    s_add_u32 m0, s56, 1024
    s_add_u32 s60, s58, 15360
    buffer_load_dwordx4 v46, s[16:19], s60 offen lds
    v_xor_b32 v2, 8, v2
    v_mul_u32_u24 v4, 13, v2
    v_lshrrev_b32 v4, 6, v4
    v_mul_u32_u24 v4, 1200, v4
    v_lshl_add_u32 v4, v2, 4, v4
    v_add_u32 v5, 1, v2
    v_and_b32 v5, 16, v5
    v_lshl_add_u32 v4, v5, 24, v4
    v_add_u32 v47, v3, v4
    s_add_u32 m0, s56, 2048
    s_add_u32 s60, s58, 30720
    buffer_load_dwordx4 v47, s[16:19], s60 offen lds
    s_add_u32 m0, s56, 3072
    s_add_u32 s60, s58, 46080
    buffer_load_dwordx4 v47, s[16:19], s60 offen lds
    s_mov_b32 s3, 40960
    s_cmp_ge_u32 s55, 81920
    s_cselect_b32 s60, -81920, s3
    s_add_u32 s55, s55, s60
    s_add_u32 s56, s56, s60
    s_lshl_b32 s57, s59, 7
    s_add_u32 s57, s57, s53
    s_mul_i32 s58, s59, 245760
    s_add_u32 s58, s58, s54
    s_add_u32 s59, s59, 1
    s_cmp_eq_u32 s59, 10
    s_cselect_b32 s59, 0, s59
    s_add_u32 m0, s56, 0
    s_add_u32 s60, s58, 0
    buffer_load_dwordx4 v46, s[16:19], s60 offen lds
    s_add_u32 m0, s55, 0
    s_max_i32 s60, s57, 0
    buffer_load_dwordx4 v44, s[12:15], s60 offen lds
    s_add_u32 m0, s56, 1024
    s_add_u32 s60, s58, 15360
    buffer_load_dwordx4 v46, s[16:19], s60 offen lds
    s_add_u32 s60, s57, 10240
    s_add_u32 m0, s55, 1024
    s_max_i32 s60, s60, 0
    buffer_load_dwordx4 v45, s[12:15], s60 offen lds
    s_add_u32 m0, s55, 2048
    s_add_u32 s60, s57, 20480
    buffer_load_dwordx4 v44, s[12:15], s60 offen lds
    s_mov_b32 s52, s30
    s_mov_b32 s43, 0
K_COMMON:
    v_mov_b32 v7, 0
    s_lshr_b32 s29, s2, 3
    s_xor_b32 s30, s30, 4
    s_mov_b32 s26, 0xc8000
    s_mov_b32 s27, 0x20000
    s_lshr_b32 s34, s29, 3
    s_lshl_b32 s34, s34, 2
    s_and_b32 s3, s29, 3
    s_add_u32 s34, s34, s3
    s_add_u32 s34, s34, 4
    s_bitcmp1_b32 s29, 2
    s_cselect_b32 s34, -1, s34
    s_cmp_lt_u32 s29, 8
    s_cselect_b32 s34, s29, s34
    s_lshl_b32 s40, s28, 1
    s_cmp_ge_u32 s34, 10
    s_addc_u32 s40, s40, 0
    s_sub_u32 s41, s34, 10
    s_cmp_ge_u32 s34, 10
    s_cselect_b32 s41, s41, s34
    s_mul_i32 s42, s28, 20
    s_add_u32 s42, s42, s34
    s_and_b32 s42, s42, 255
    s_lshl_b32 s42, s42, 8
    s_add_u32 s42, s42, 524288
    s_cmp_lt_u32 s29, 8
    s_cbranch_scc1 K_AUX
    s_lshr_b32 s31, s29, 3
    s_sub_u32 s31, s31, 1
    s_and_b32 s35, s29, 3
    s_and_b32 s3, s29, 4
    s_lshl_b32 s3, s3, 1
    s_add_u32 s35, s35, s3
    s_and_b32 s3, s28, 1
    s_lshl_b32 s3, s3, 2
    s_add_u32 s35, s35, s3
    v_and_b32 v9, 15, v1
    v_lshrrev_b32 v10, 4, v1
    v_bfe_u32 v11, v1, 2, 2
    v_and_b32 v12, 3, v1
    s_waitcnt lgkmcnt(0)
    s_add_u32 s20, s10, 0x100000
    s_addc_u32 s21, s11, 0
    s_mov_b32 s22, 0x280000
    s_mov_b32 s23, 0x20000
    s_and_b32 s3, s30, 3
    s_mul_i32 s3, s3, 3
    s_lshr_b32 s33, s30, 2
    s_lshl1_add_u32 s3, s33, s3
    s_mul_i32 s44, s31, 11
    s_add_u32 s44, s44, s3
    s_cmp_eq_u32 s44, 31
    s_cselect_b32 s51, 4, s30
    s_lshr_b32 s33, s28, 1
    s_lshl_b32 s33, s33, 5
    s_add_u32 s44, s44, s33
    s_mul_i32 s3, s3, 4352
    s_add_u32 s3, s3, 81920
    v_mul_u32_u24 v14, 272, v9
    v_lshl_add_u32 v13, v10, 3, v14
    v_add_u32 v13, s3, v13
    v_add3_u32 v14, v14, 32, s3
    v_cmp_eq_u32 vcc, 0, v10
    v_add_u32 v2, 208, v14
    v_add_u32 v3, 0, v14
    v_add_u32 v4, 40, v14
    v_cndmask_b32 v19, v2, v3, vcc
    v_cndmask_b32 v20, v2, v4, vcc
    v_lshl_add_u32 v15, v10, 2, v11
    v_mul_u32_u24 v15, 272, v15
    v_add_u32 v5, s3, v15
    v_lshl_add_u32 v15, v12, 3, v5
    v_add_u32 v2, 240, v5
    v_add_u32 v3, 192, v5
    v_add_u32 v4, 232, v5
    v_cmp_eq_u32 vcc, 0, v12
    s_nop 1
    v_cndmask_b32 v21, v2, v3, vcc
    v_cmp_eq_u32 vcc, 1, v12
    s_nop 1
    v_cndmask_b32 v22, v2, v4, vcc
    v_cmp_eq_u32 vcc, 2, v12
    s_nop 1
    v_cndmask_b32 v23, v2, v3, vcc
    v_cmp_eq_u32 vcc, 3, v12
    s_nop 1
    v_cndmask_b32 v24, v2, v4, vcc
    s_lshl_b32 s3, s35, 10
    v_lshl_add_u32 v16, v1, 4, s3
    s_lshl_b32 s3, s35, 8
    s_add_u32 s3, s3, 16384
    v_lshl_add_u32 v17, v9, 4, s3
    v_and_b32 v2, 1, v10
    v_lshl_add_u32 v17, v2, 3, v17
    s_cmp_lt_u32 s51, 4
    s_cselect_b32 s3, 0, 0x800000
    s_add_u32 s3, s3, 20480
    v_lshrrev_b32 v2, 1, v10
    v_mad_u32_u24 v17, v2, s3, v17
    s_mul_i32 s50, s44, 20480
    s_add_u32 s51, s50, s3
    v_mov_b32 v18, 0xf149f2ca
    v_lshlrev_b32 v2, 2, v10
    v_sub_u32 v2, v9, v2
    s_cmp_eq_u32 s44, 0
    s_cselect_b32 s3, 0xf149f2ca, 0
    v_subrev_u32 v3, 0, v2
    v_and_b32 v4, 0x80000001, v3
    v_cmp_eq_u32 vcc, 0, v4
    s_nop 1
    v_cndmask_b32 v32, v18, 0, vcc
    v_cmp_eq_u32 vcc, 0x80000000, v4
    s_nop 1
    v_cndmask_b32 v28, v18, 0, vcc
    v_add_f32 v36, s3, v28
    v_subrev_u32 v3, 1, v2
    v_and_b32 v4, 0x80000001, v3
    v_cmp_eq_u32 vcc, 0, v4
    s_nop 1
    v_cndmask_b32 v33, v18, 0, vcc
    v_cmp_eq_u32 vcc, 0x80000000, v4
    s_nop 1
    v_cndmask_b32 v29, v18, 0, vcc
    v_add_f32 v37, s3, v29
    v_subrev_u32 v3, 2, v2
    v_and_b32 v4, 0x80000001, v3
    v_cmp_eq_u32 vcc, 0, v4
    s_nop 1
    v_cndmask_b32 v34, v18, 0, vcc
    v_cmp_eq_u32 vcc, 0x80000000, v4
    s_nop 1
    v_cndmask_b32 v30, v18, 0, vcc
    v_add_f32 v38, s3, v30
    v_subrev_u32 v3, 3, v2
    v_and_b32 v4, 0x80000001, v3
    v_cmp_eq_u32 vcc, 0, v4
    s_nop 1
    v_cndmask_b32 v35, v18, 0, vcc
    v_cmp_eq_u32 vcc, 0x80000000, v4
    s_nop 1
    v_cndmask_b32 v31, v18, 0, vcc
    v_add_f32 v39, s3, v31
    v_mov_b32 v3, 0x0c0c0c0c
    v_mov_b32 v4, 0xc0c0100
    v_cmp_eq_u32 vcc, 0, v28
    v_mov_b32 v5, 0x1000c0c
    s_nop 0
    v_cndmask_b32 v3, v3, v4, vcc
    v_cmp_eq_u32 vcc, 0, v29
    s_nop 1
    v_cndmask_b32 v40, v3, v5, vcc
    v_mov_b32 v3, 0x0c0c0c0c
    v_mov_b32 v4, 0xc0c0302
    v_cmp_eq_u32 vcc, 0, v30
    v_mov_b32 v5, 0x3020c0c
    s_nop 0
    v_cndmask_b32 v3, v3, v4, vcc
    v_cmp_eq_u32 vcc, 0, v31
    s_nop 1
    v_cndmask_b32 v41, v3, v5, vcc
    v_mov_b32 v3, 0x0c0c0c0c
    v_mov_b32 v4, 0xc0c0100
    v_cmp_eq_u32 vcc, 0, v32
    v_mov_b32 v5, 0x1000c0c
    s_nop 0
    v_cndmask_b32 v3, v3, v4, vcc
    v_cmp_eq_u32 vcc, 0, v33
    s_nop 1
    v_cndmask_b32 v42, v3, v5, vcc
    v_mov_b32 v3, 0x0c0c0c0c
    v_mov_b32 v4, 0xc0c0302
    v_cmp_eq_u32 vcc, 0, v34
    v_mov_b32 v5, 0x3020c0c
    s_nop 0
    v_cndmask_b32 v3, v3, v4, vcc
    v_cmp_eq_u32 vcc, 0, v35
    s_nop 1
    v_cndmask_b32 v43, v3, v5, vcc
    s_mov_b32 s46, 0x3fb8aa3b
    s_mov_b32 s47, s46
    s_mov_b32 s48, 0x3e64f92e
    s_mov_b32 s49, s48
    s_mov_b32 s36, 0xfffff
    s_cmp_lg_u32 s31, 0
    s_cselect_b32 s33, 64, 0
    v_mov_b32 v2, s33
    v_cmp_gt_u32 vcc, 10, v1
    s_lshr_b32 s3, s28, 1
    s_lshl2_add_u32 s3, s3, s31
    v_cndmask_b32 v2, 0, v2, vcc
    v_lshl_add_u32 v2, v1, 8, v2
    s_mul_i32 s3, s3, 2560
    s_lshl2_add_u32 s3, s35, s3
    s_add_u32 s3, s3, 524288
    v_add_u32 v8, s3, v2
    s_cmp_eq_u32 s43, 1
    s_cbranch_scc1 K_CONS
    v_lshrrev_b32 v2, 3, v1
    v_mul_u32_u24 v2, 1280, v2
    v_lshrrev_b32 v3, 4, v1
    v_lshlrev_b32 v3, 1, v3
    v_and_b32 v4, 7, v1
    v_xor_b32 v3, v3, v4
    v_lshl_add_u32 v2, v3, 4, v2
    s_lshl_b32 s33, s41, 7
    v_add_u32 v18, s33, v2
    s_mov_b32 s61, 9
    s_mov_b32 s3, 40960
K_LOOP0:
    s_waitcnt vmcnt(5)
    s_barrier
    s_add_u32 m0, s56, 2048
    s_add_u32 s60, s58, 30720
    buffer_load_dwordx4 v47, s[16:19], s60 offen lds
    s_add_u32 m0, s55, 3072
    s_add_u32 s60, s57, 30720
    buffer_load_dwordx4 v45, s[12:15], s60 offen lds
    s_add_u32 m0, s56, 3072
    s_add_u32 s60, s58, 46080
    buffer_load_dwordx4 v47, s[16:19], s60 offen lds
    s_add_u32 m0, s55, 4096
    s_add_u32 s60, s57, s62
    buffer_load_dwordx4 v44, s[12:15], s60 offen lds
    s_add_u32 m0, s55, 5120
    s_add_u32 s60, s60, 10240
    buffer_load_dwordx4 v45, s[12:15], s60 offen lds
    s_sub_u32 s61, s61, 1
    s_cmp_eq_u32 s61, 0
    s_cbranch_scc1 K_LOOPX
    s_cmp_ge_u32 s55, 81920
    s_cselect_b32 s60, -81920, s3
    s_add_u32 s55, s55, s60
    s_add_u32 s56, s56, s60
    s_lshl_b32 s57, s59, 7
    s_add_u32 s57, s57, s53
    s_mul_i32 s58, s59, 245760
    s_add_u32 s58, s58, s54
    s_add_u32 s59, s59, 1
    s_cmp_eq_u32 s59, 10
    s_cselect_b32 s59, 0, s59
    s_add_u32 m0, s56, 0
    s_add_u32 s60, s58, 0
    buffer_load_dwordx4 v46, s[16:19], s60 offen lds
    s_add_u32 m0, s55, 0
    s_max_i32 s60, s57, 0
    buffer_load_dwordx4 v44, s[12:15], s60 offen lds
    s_add_u32 m0, s56, 1024
    s_add_u32 s60, s58, 15360
    buffer_load_dwordx4 v46, s[16:19], s60 offen lds
    s_add_u32 s60, s57, 10240
    s_add_u32 m0, s55, 1024
    s_max_i32 s60, s60, 0
    buffer_load_dwordx4 v45, s[12:15], s60 offen lds
    s_add_u32 m0, s55, 2048
    s_add_u32 s60, s57, 20480
    buffer_load_dwordx4 v44, s[12:15], s60 offen lds
    s_branch K_LOOP0
K_LOOPX:
    v_and_b32 v2, 7, v1
    v_lshlrev_b32 v2, 2, v2
    s_waitcnt vmcnt(0)
    s_barrier
    s_cmp_lt_u32 s30, 6
    s_cbranch_scc1 K_NOSMP
    global_load_dword v7, v2, s[8:9] offset:192 sc1
K_NOSMP:
    s_cmp_eq_u32 s34, -1
    s_cbranch_scc1 K_JOIN_S
    s_cmp_lg_u32 s30, 7
    s_cbranch_scc1 K_WOE
    s_barrier
K_WOE:
    s_lshl_b32 s57, s52, 2
    s_lshr_b32 s57, 0x7520, s57
    s_and_b32 s57, s57, 7
    s_mul_i32 s57, s57, 51200
    s_mul_i32 s58, s52, 5120
    s_add_u32 s3, s57, 0
    s_add_u32 m0, s58, 0
    s_nop 0
    buffer_load_dwordx4 v18, s[24:27], s3 offen lds
    s_add_u32 s3, s57, 10240
    s_add_u32 m0, s58, 1024
    s_nop 0
    buffer_load_dwordx4 v18, s[24:27], s3 offen lds
    s_add_u32 s3, s57, 20480
    s_add_u32 m0, s58, 2048
    s_nop 0
    buffer_load_dwordx4 v18, s[24:27], s3 offen lds
    s_add_u32 s3, s57, 30720
    s_add_u32 m0, s58, 3072
    s_nop 0
    buffer_load_dwordx4 v18, s[24:27], s3 offen lds
    s_add_u32 s3, s57, 40960
    s_add_u32 m0, s58, 4096
    s_nop 0
    buffer_load_dwordx4 v18, s[24:27], s3 offen lds
    s_add_u32 s3, s57, 409600
    s_add_u32 m0, s58, 20480
    s_nop 0
    buffer_load_dwordx4 v18, s[24:27], s3 offen lds
    s_add_u32 s3, s57, 419840
    s_add_u32 m0, s58, 21504
    s_nop 0
    buffer_load_dwordx4 v18, s[24:27], s3 offen lds
    s_add_u32 s3, s57, 430080
    s_add_u32 m0, s58, 22528
    s_nop 0
    buffer_load_dwordx4 v18, s[24:27], s3 offen lds
    s_add_u32 s3, s57, 440320
    s_add_u32 m0, s58, 23552
    s_nop 0
    buffer_load_dwordx4 v18, s[24:27], s3 offen lds
    s_add_u32 s3, s57, 450560
    s_add_u32 m0, s58, 24576
    s_nop 0
    buffer_load_dwordx4 v18, s[24:27], s3 offen lds
    s_cmp_lg_u32 s30, 7
    s_cbranch_scc1 K_JOIN_S
    s_mov_b32 s52, 0
K_XD:
    s_lshl_b32 s57, s40, 3
    s_lshl1_add_u32 s57, s52, s57
    s_mul_i32 s57, s57, 20480
    s_lshl_b32 s33, s41, 7
    s_add_u32 s57, s57, s33
    s_lshl_b32 s33, s52, 12
    s_add_u32 m0, s33, 140288
    s_add_u32 s3, s57, 0
    buffer_load_dwordx4 v44, s[12:15], s3 offen lds
    s_add_u32 m0, s33, 141312
    s_add_u32 s3, s57, 10240
    buffer_load_dwordx4 v45, s[12:15], s3 offen lds
    s_add_u32 m0, s33, 142336
    s_add_u32 s3, s57, 20480
    buffer_load_dwordx4 v44, s[12:15], s3 offen lds
    s_add_u32 m0, s33, 143360
    s_add_u32 s3, s57, 30720
    buffer_load_dwordx4 v45, s[12:15], s3 offen lds
    s_add_u32 s52, s52, 1
    s_cmp_lt_u32 s52, 4
    s_cbranch_scc1 K_XD
    s_branch K_W7
.p2align 12
K_CONS:
    s_lshr_b32 s52, s30, 1
    s_and_b32 s53, s30, 1
    v_lshrrev_b32 v2, 1, v9
    v_xor_b32 v2, v2, v10
    v_lshlrev_b32 v2, 4, v2
    v_lshl_add_u32 v2, v9, 7, v2
    s_mul_i32 s3, s52, 12288
    v_add_u32 v44, s3, v2
    v_xor_b32 v45, 64, v44
    v_add_u32 v46, 81920, v44
    v_add_u32 v47, 81920, v45
    v_and_b32 v2, 1, v10
    v_lshl_or_b32 v2, v2, 2, v11
    v_lshl_add_u32 v3, v10, 3, v11
    v_lshlrev_b32 v3, 8, v3
    v_lshl_add_u32 v3, v12, 3, v3
    v_add_u32 v3, 24576, v3
    s_lshl_b32 s3, s53, 2
    v_add_u32 v2, s3, v2
    v_add_u32 v4, 0, v2
    v_and_b32 v4, 7, v4
    v_lshl_add_u32 v48, v4, 5, v3
    v_add_u32 v52, 81920, v48
    v_add_u32 v4, 1, v2
    v_and_b32 v4, 7, v4
    v_lshl_add_u32 v49, v4, 5, v3
    v_add_u32 v53, 81920, v49
    v_add_u32 v4, 2, v2
    v_and_b32 v4, 7, v4
    v_lshl_add_u32 v50, v4, 5, v3
    v_add_u32 v54, 81920, v50
    v_add_u32 v4, 3, v2
    v_and_b32 v4, 7, v4
    v_lshl_add_u32 v51, v4, 5, v3
    v_add_u32 v55, 81920, v51
    v_mul_u32_u24 v56, 272, v9
    v_lshl_add_u32 v56, v10, 3, v56
    s_mul_i32 s3, s52, 26112
    s_lshl_b32 s33, s53, 7
    s_add_u32 s3, s3, s33
    s_add_u32 s3, s3, 81920
    v_add_u32 v56, s3, v56
    v_mov_b64 v[60:61], 0
    v_mov_b64 v[62:63], 0
    v_mov_b64 v[64:65], 0
    v_mov_b64 v[66:67], 0
    v_mov_b64 v[68:69], 0
    v_mov_b64 v[70:71], 0
    v_mov_b64 v[72:73], 0
    v_mov_b64 v[74:75], 0
    v_mov_b64 v[76:77], 0
    v_mov_b64 v[78:79], 0
    v_mov_b64 v[80:81], 0
    v_mov_b64 v[82:83], 0
    v_mov_b64 v[84:85], 0
    v_mov_b64 v[86:87], 0
    v_mov_b64 v[88:89], 0
    v_mov_b64 v[90:91], 0
    v_mov_b64 v[92:93], 0
    v_mov_b64 v[94:95], 0
    v_mov_b64 v[96:97], 0
    v_mov_b64 v[98:99], 0
    v_mov_b64 v[100:101], 0
    v_mov_b64 v[102:103], 0
    v_mov_b64 v[104:105], 0
    v_mov_b64 v[106:107], 0
    v_mov_b64 v[108:109], 0
    v_mov_b64 v[110:111], 0
    v_mov_b64 v[112:113], 0
    v_mov_b64 v[114:115], 0
    v_mov_b64 v[116:117], 0
    v_mov_b64 v[118:119], 0
    v_mov_b64 v[120:121], 0
    v_mov_b64 v[122:123], 0
    v_mov_b64 v[124:125], 0
    v_mov_b64 v[126:127], 0
    v_mov_b64 v[128:129], 0
    v_mov_b64 v[130:131], 0
    v_mov_b64 v[132:133], 0
    v_mov_b64 v[134:135], 0
    v_mov_b64 v[136:137], 0
    v_mov_b64 v[138:139], 0
    v_mov_b64 v[140:141], 0
    v_mov_b64 v[142:143], 0
    v_mov_b64 v[144:145], 0
    v_mov_b64 v[146:147], 0
    v_mov_b64 v[148:149], 0
    v_mov_b64 v[150:151], 0
    v_mov_b64 v[152:153], 0
    v_mov_b64 v[154:155], 0
    s_mov_b32 s54, 3
    s_cmp_lg_u32 s30, 0
    s_cbranch_scc1 K_WARMM0
    s_call_b64 s[38:39], WP_attd
    s_call_b64 s[38:39], WP_p2g
    s_branch K_WARMMX
K_WARMM0:
    s_cmp_lg_u32 s30, 1
    s_cbranch_scc1 K_WARMM1
    s_call_b64 s[38:39], WP_atts
    s_call_b64 s[38:39], WP_early
    s_branch K_WARMMX
K_WARMM1:
    s_cmp_lg_u32 s30, 2
    s_cbranch_scc1 K_WARMM2
    s_call_b64 s[38:39], WP_help
    s_call_b64 s[38:39], WP_flags
    s_branch K_WARMMX
K_WARMM2:
    s_call_b64 s[38:39], WP_spin
K_WARMMX:
    s_setprio 2
    s_barrier
    ds_read_b64_tr_b16 v[204:205], v48 offset:40960
    ds_read_b64_tr_b16 v[206:207], v48 offset:41984
    ds_read_b128 v[156:159], v44 offset:40960
    ds_read_b64_tr_b16 v[208:209], v49 offset:40960
    ds_read_b64_tr_b16 v[210:211], v49 offset:41984
    ds_read_b128 v[160:163], v44 offset:43008
    ds_read_b64_tr_b16 v[212:213], v50 offset:40960
    ds_read_b64_tr_b16 v[214:215], v50 offset:41984
    ds_read_b128 v[164:167], v44 offset:45056
    ds_read_b64_tr_b16 v[216:217], v51 offset:40960
    ds_read_b64_tr_b16 v[218:219], v51 offset:41984
    ds_read_b128 v[168:171], v44 offset:47104
    ds_read_b128 v[172:175], v44 offset:49152
    ds_read_b128 v[176:179], v44 offset:51200
K_CLOOP:
    s_waitcnt lgkmcnt(0)
    v_mfma_f32_16x16x32_bf16 v[60:63], v[204:207], v[156:159], v[60:63]
    ds_read_b64_tr_b16 v[220:221], v48 offset:49152
    v_mfma_f32_16x16x32_bf16 v[64:67], v[208:211], v[156:159], v[64:67]
    ds_read_b64_tr_b16 v[222:223], v48 offset:50176
    v_mfma_f32_16x16x32_bf16 v[68:71], v[212:215], v[156:159], v[68:71]
    ds_read_b128 v[180:183], v45 offset:40960
    v_mfma_f32_16x16x32_bf16 v[72:75], v[216:219], v[156:159], v[72:75]
    ds_read_b64_tr_b16 v[224:225], v49 offset:49152
    v_mfma_f32_16x16x32_bf16 v[88:91], v[216:219], v[160:163], v[88:91]
    ds_read_b64_tr_b16 v[226:227], v49 offset:50176
    v_mfma_f32_16x16x32_bf16 v[84:87], v[212:215], v[160:163], v[84:87]
    ds_read_b128 v[184:187], v45 offset:43008
    v_mfma_f32_16x16x32_bf16 v[80:83], v[208:211], v[160:163], v[80:83]
    ds_read_b64_tr_b16 v[228:229], v50 offset:49152
    v_mfma_f32_16x16x32_bf16 v[76:79], v[204:207], v[160:163], v[76:79]
    ds_read_b64_tr_b16 v[230:231], v50 offset:50176
    v_mfma_f32_16x16x32_bf16 v[92:95], v[204:207], v[164:167], v[92:95]
    ds_read_b128 v[188:191], v45 offset:45056
    v_mfma_f32_16x16x32_bf16 v[96:99], v[208:211], v[164:167], v[96:99]
    ds_read_b64_tr_b16 v[232:233], v51 offset:49152
    v_mfma_f32_16x16x32_bf16 v[100:103], v[212:215], v[164:167], v[100:103]
    ds_read_b64_tr_b16 v[234:235], v51 offset:50176
    v_mfma_f32_16x16x32_bf16 v[104:107], v[216:219], v[164:167], v[104:107]
    ds_read_b128 v[192:195], v45 offset:47104
    v_mfma_f32_16x16x32_bf16 v[120:123], v[216:219], v[168:171], v[120:123]
    ds_read_b128 v[196:199], v45 offset:49152
    v_mfma_f32_16x16x32_bf16 v[116:119], v[212:215], v[168:171], v[116:119]
    ds_read_b128 v[200:203], v45 offset:51200
    v_mfma_f32_16x16x32_bf16 v[112:115], v[208:211], v[168:171], v[112:115]
    v_mfma_f32_16x16x32_bf16 v[108:111], v[204:207], v[168:171], v[108:111]
    v_mfma_f32_16x16x32_bf16 v[124:127], v[204:207], v[172:175], v[124:127]
    v_mfma_f32_16x16x32_bf16 v[128:131], v[208:211], v[172:175], v[128:131]
    v_mfma_f32_16x16x32_bf16 v[132:135], v[212:215], v[172:175], v[132:135]
    v_mfma_f32_16x16x32_bf16 v[136:139], v[216:219], v[172:175], v[136:139]
    v_mfma_f32_16x16x32_bf16 v[152:155], v[216:219], v[176:179], v[152:155]
    v_mfma_f32_16x16x32_bf16 v[148:151], v[212:215], v[176:179], v[148:151]
    v_mfma_f32_16x16x32_bf16 v[144:147], v[208:211], v[176:179], v[144:147]
    v_mfma_f32_16x16x32_bf16 v[140:143], v[204:207], v[176:179], v[140:143]
    s_waitcnt lgkmcnt(0)
    s_barrier
    v_mfma_f32_16x16x32_bf16 v[60:63], v[220:223], v[180:183], v[60:63]
    ds_read_b64_tr_b16 v[204:205], v52 offset:0
    v_mfma_f32_16x16x32_bf16 v[64:67], v[224:227], v[180:183], v[64:67]
    ds_read_b64_tr_b16 v[206:207], v52 offset:1024
    v_mfma_f32_16x16x32_bf16 v[68:71], v[228:231], v[180:183], v[68:71]
    ds_read_b128 v[156:159], v46 offset:0
    v_mfma_f32_16x16x32_bf16 v[72:75], v[232:235], v[180:183], v[72:75]
    ds_read_b64_tr_b16 v[208:209], v53 offset:0
    v_mfma_f32_16x16x32_bf16 v[88:91], v[232:235], v[184:187], v[88:91]
    ds_read_b64_tr_b16 v[210:211], v53 offset:1024
    v_mfma_f32_16x16x32_bf16 v[84:87], v[228:231], v[184:187], v[84:87]
    ds_read_b128 v[160:163], v46 offset:2048
    v_mfma_f32_16x16x32_bf16 v[80:83], v[224:227], v[184:187], v[80:83]
    ds_read_b64_tr_b16 v[212:213], v54 offset:0
    v_mfma_f32_16x16x32_bf16 v[76:79], v[220:223], v[184:187], v[76:79]
    ds_read_b64_tr_b16 v[214:215], v54 offset:1024
    v_mfma_f32_16x16x32_bf16 v[92:95], v[220:223], v[188:191], v[92:95]
    ds_read_b128 v[164:167], v46 offset:4096
    v_mfma_f32_16x16x32_bf16 v[96:99], v[224:227], v[188:191], v[96:99]
    ds_read_b64_tr_b16 v[216:217], v55 offset:0
    v_mfma_f32_16x16x32_bf16 v[100:103], v[228:231], v[188:191], v[100:103]
    ds_read_b64_tr_b16 v[218:219], v55 offset:1024
    v_mfma_f32_16x16x32_bf16 v[104:107], v[232:235], v[188:191], v[104:107]
    ds_read_b128 v[168:171], v46 offset:6144
    v_mfma_f32_16x16x32_bf16 v[120:123], v[232:235], v[192:195], v[120:123]
    ds_read_b128 v[172:175], v46 offset:8192
    v_mfma_f32_16x16x32_bf16 v[116:119], v[228:231], v[192:195], v[116:119]
    ds_read_b128 v[176:179], v46 offset:10240
    v_mfma_f32_16x16x32_bf16 v[112:115], v[224:227], v[192:195], v[112:115]
    v_mfma_f32_16x16x32_bf16 v[108:111], v[220:223], v[192:195], v[108:111]
    v_mfma_f32_16x16x32_bf16 v[124:127], v[220:223], v[196:199], v[124:127]
    v_mfma_f32_16x16x32_bf16 v[128:131], v[224:227], v[196:199], v[128:131]
    v_mfma_f32_16x16x32_bf16 v[132:135], v[228:231], v[196:199], v[132:135]
    v_mfma_f32_16x16x32_bf16 v[136:139], v[232:235], v[196:199], v[136:139]
    v_mfma_f32_16x16x32_bf16 v[152:155], v[232:235], v[200:203], v[152:155]
    v_mfma_f32_16x16x32_bf16 v[148:151], v[228:231], v[200:203], v[148:151]
    v_mfma_f32_16x16x32_bf16 v[144:147], v[224:227], v[200:203], v[144:147]
    v_mfma_f32_16x16x32_bf16 v[140:143], v[220:223], v[200:203], v[140:143]
    s_waitcnt lgkmcnt(0)
    v_mfma_f32_16x16x32_bf16 v[60:63], v[204:207], v[156:159], v[60:63]
    ds_read_b64_tr_b16 v[220:221], v52 offset:8192
    v_mfma_f32_16x16x32_bf16 v[64:67], v[208:211], v[156:159], v[64:67]
    ds_read_b64_tr_b16 v[222:223], v52 offset:9216
    v_mfma_f32_16x16x32_bf16 v[68:71], v[212:215], v[156:159], v[68:71]
    ds_read_b128 v[180:183], v47 offset:0
    v_mfma_f32_16x16x32_bf16 v[72:75], v[216:219], v[156:159], v[72:75]
    ds_read_b64_tr_b16 v[224:225], v53 offset:8192
    v_mfma_f32_16x16x32_bf16 v[88:91], v[216:219], v[160:163], v[88:91]
    ds_read_b64_tr_b16 v[226:227], v53 offset:9216
    v_mfma_f32_16x16x32_bf16 v[84:87], v[212:215], v[160:163], v[84:87]
    ds_read_b128 v[184:187], v47 offset:2048
    v_mfma_f32_16x16x32_bf16 v[80:83], v[208:211], v[160:163], v[80:83]
    ds_read_b64_tr_b16 v[228:229], v54 offset:8192
    v_mfma_f32_16x16x32_bf16 v[76:79], v[204:207], v[160:163], v[76:79]
    ds_read_b64_tr_b16 v[230:231], v54 offset:9216
    v_mfma_f32_16x16x32_bf16 v[92:95], v[204:207], v[164:167], v[92:95]
    ds_read_b128 v[188:191], v47 offset:4096
    v_mfma_f32_16x16x32_bf16 v[96:99], v[208:211], v[164:167], v[96:99]
    ds_read_b64_tr_b16 v[232:233], v55 offset:8192
    v_mfma_f32_16x16x32_bf16 v[100:103], v[212:215], v[164:167], v[100:103]
    ds_read_b64_tr_b16 v[234:235], v55 offset:9216
    v_mfma_f32_16x16x32_bf16 v[104:107], v[216:219], v[164:167], v[104:107]
    ds_read_b128 v[192:195], v47 offset:6144
    v_mfma_f32_16x16x32_bf16 v[120:123], v[216:219], v[168:171], v[120:123]
    ds_read_b128 v[196:199], v47 offset:8192
    v_mfma_f32_16x16x32_bf16 v[116:119], v[212:215], v[168:171], v[116:119]
    ds_read_b128 v[200:203], v47 offset:10240
    v_mfma_f32_16x16x32_bf16 v[112:115], v[208:211], v[168:171], v[112:115]
    v_mfma_f32_16x16x32_bf16 v[108:111], v[204:207], v[168:171], v[108:111]
    v_mfma_f32_16x16x32_bf16 v[124:127], v[204:207], v[172:175], v[124:127]
    v_mfma_f32_16x16x32_bf16 v[128:131], v[208:211], v[172:175], v[128:131]
    v_mfma_f32_16x16x32_bf16 v[132:135], v[212:215], v[172:175], v[132:135]
    v_mfma_f32_16x16x32_bf16 v[136:139], v[216:219], v[172:175], v[136:139]
    v_mfma_f32_16x16x32_bf16 v[152:155], v[216:219], v[176:179], v[152:155]
    v_mfma_f32_16x16x32_bf16 v[148:151], v[212:215], v[176:179], v[148:151]
    v_mfma_f32_16x16x32_bf16 v[144:147], v[208:211], v[176:179], v[144:147]
    v_mfma_f32_16x16x32_bf16 v[140:143], v[204:207], v[176:179], v[140:143]
    s_waitcnt lgkmcnt(0)
    s_barrier
    v_mfma_f32_16x16x32_bf16 v[60:63], v[220:223], v[180:183], v[60:63]
    ds_read_b64_tr_b16 v[204:205], v48 offset:0
    v_mfma_f32_16x16x32_bf16 v[64:67], v[224:227], v[180:183], v[64:67]
    ds_read_b64_tr_b16 v[206:207], v48 offset:1024
    v_mfma_f32_16x16x32_bf16 v[68:71], v[228:231], v[180:183], v[68:71]
    ds_read_b128 v[156:159], v44 offset:0
    v_mfma_f32_16x16x32_bf16 v[72:75], v[232:235], v[180:183], v[72:75]
    ds_read_b64_tr_b16 v[208:209], v49 offset:0
    v_mfma_f32_16x16x32_bf16 v[88:91], v[232:235], v[184:187], v[88:91]
    ds_read_b64_tr_b16 v[210:211], v49 offset:1024
    v_mfma_f32_16x16x32_bf16 v[84:87], v[228:231], v[184:187], v[84:87]
    ds_read_b128 v[160:163], v44 offset:2048
    v_mfma_f32_16x16x32_bf16 v[80:83], v[224:227], v[184:187], v[80:83]
    ds_read_b64_tr_b16 v[212:213], v50 offset:0
    v_mfma_f32_16x16x32_bf16 v[76:79], v[220:223], v[184:187], v[76:79]
    ds_read_b64_tr_b16 v[214:215], v50 offset:1024
    v_mfma_f32_16x16x32_bf16 v[92:95], v[220:223], v[188:191], v[92:95]
    ds_read_b128 v[164:167], v44 offset:4096
    v_mfma_f32_16x16x32_bf16 v[96:99], v[224:227], v[188:191], v[96:99]
    ds_read_b64_tr_b16 v[216:217], v51 offset:0
    v_mfma_f32_16x16x32_bf16 v[100:103], v[228:231], v[188:191], v[100:103]
    ds_read_b64_tr_b16 v[218:219], v51 offset:1024
    v_mfma_f32_16x16x32_bf16 v[104:107], v[232:235], v[188:191], v[104:107]
    ds_read_b128 v[168:171], v44 offset:6144
    v_mfma_f32_16x16x32_bf16 v[120:123], v[232:235], v[192:195], v[120:123]
    ds_read_b128 v[172:175], v44 offset:8192
    v_mfma_f32_16x16x32_bf16 v[116:119], v[228:231], v[192:195], v[116:119]
    ds_read_b128 v[176:179], v44 offset:10240
    v_mfma_f32_16x16x32_bf16 v[112:115], v[224:227], v[192:195], v[112:115]
    v_mfma_f32_16x16x32_bf16 v[108:111], v[220:223], v[192:195], v[108:111]
    v_mfma_f32_16x16x32_bf16 v[124:127], v[220:223], v[196:199], v[124:127]
    v_mfma_f32_16x16x32_bf16 v[128:131], v[224:227], v[196:199], v[128:131]
    v_mfma_f32_16x16x32_bf16 v[132:135], v[228:231], v[196:199], v[132:135]
    v_mfma_f32_16x16x32_bf16 v[136:139], v[232:235], v[196:199], v[136:139]
    v_mfma_f32_16x16x32_bf16 v[152:155], v[232:235], v[200:203], v[152:155]
    v_mfma_f32_16x16x32_bf16 v[148:151], v[228:231], v[200:203], v[148:151]
    v_mfma_f32_16x16x32_bf16 v[144:147], v[224:227], v[200:203], v[144:147]
    v_mfma_f32_16x16x32_bf16 v[140:143], v[220:223], v[200:203], v[140:143]
    s_waitcnt lgkmcnt(0)
    v_mfma_f32_16x16x32_bf16 v[60:63], v[204:207], v[156:159], v[60:63]
    ds_read_b64_tr_b16 v[220:221], v48 offset:8192
    v_mfma_f32_16x16x32_bf16 v[64:67], v[208:211], v[156:159], v[64:67]
    ds_read_b64_tr_b16 v[222:223], v48 offset:9216
    v_mfma_f32_16x16x32_bf16 v[68:71], v[212:215], v[156:159], v[68:71]
    ds_read_b128 v[180:183], v45 offset:0
    v_mfma_f32_16x16x32_bf16 v[72:75], v[216:219], v[156:159], v[72:75]
    ds_read_b64_tr_b16 v[224:225], v49 offset:8192
    v_mfma_f32_16x16x32_bf16 v[88:91], v[216:219], v[160:163], v[88:91]
    ds_read_b64_tr_b16 v[226:227], v49 offset:9216
    v_mfma_f32_16x16x32_bf16 v[84:87], v[212:215], v[160:163], v[84:87]
    ds_read_b128 v[184:187], v45 offset:2048
    v_mfma_f32_16x16x32_bf16 v[80:83], v[208:211], v[160:163], v[80:83]
    ds_read_b64_tr_b16 v[228:229], v50 offset:8192
    v_mfma_f32_16x16x32_bf16 v[76:79], v[204:207], v[160:163], v[76:79]
    ds_read_b64_tr_b16 v[230:231], v50 offset:9216
    v_mfma_f32_16x16x32_bf16 v[92:95], v[204:207], v[164:167], v[92:95]
    ds_read_b128 v[188:191], v45 offset:4096
    v_mfma_f32_16x16x32_bf16 v[96:99], v[208:211], v[164:167], v[96:99]
    ds_read_b64_tr_b16 v[232:233], v51 offset:8192
    v_mfma_f32_16x16x32_bf16 v[100:103], v[212:215], v[164:167], v[100:103]
    ds_read_b64_tr_b16 v[234:235], v51 offset:9216
    v_mfma_f32_16x16x32_bf16 v[104:107], v[216:219], v[164:167], v[104:107]
    ds_read_b128 v[192:195], v45 offset:6144
    v_mfma_f32_16x16x32_bf16 v[120:123], v[216:219], v[168:171], v[120:123]
    ds_read_b128 v[196:199], v45 offset:8192
    v_mfma_f32_16x16x32_bf16 v[116:119], v[212:215], v[168:171], v[116:119]
    ds_read_b128 v[200:203], v45 offset:10240
    v_mfma_f32_16x16x32_bf16 v[112:115], v[208:211], v[168:171], v[112:115]
    v_mfma_f32_16x16x32_bf16 v[108:111], v[204:207], v[168:171], v[108:111]
    v_mfma_f32_16x16x32_bf16 v[124:127], v[204:207], v[172:175], v[124:127]
    v_mfma_f32_16x16x32_bf16 v[128:131], v[208:211], v[172:175], v[128:131]
    v_mfma_f32_16x16x32_bf16 v[132:135], v[212:215], v[172:175], v[132:135]
    v_mfma_f32_16x16x32_bf16 v[136:139], v[216:219], v[172:175], v[136:139]
    v_mfma_f32_16x16x32_bf16 v[152:155], v[216:219], v[176:179], v[152:155]
    v_mfma_f32_16x16x32_bf16 v[148:151], v[212:215], v[176:179], v[148:151]
    v_mfma_f32_16x16x32_bf16 v[144:147], v[208:211], v[176:179], v[144:147]
    v_mfma_f32_16x16x32_bf16 v[140:143], v[204:207], v[176:179], v[140:143]
    s_waitcnt lgkmcnt(0)
    s_barrier
    v_mfma_f32_16x16x32_bf16 v[60:63], v[220:223], v[180:183], v[60:63]
    ds_read_b64_tr_b16 v[204:205], v48 offset:40960
    v_mfma_f32_16x16x32_bf16 v[64:67], v[224:227], v[180:183], v[64:67]
    ds_read_b64_tr_b16 v[206:207], v48 offset:41984
    v_mfma_f32_16x16x32_bf16 v[68:71], v[228:231], v[180:183], v[68:71]
    ds_read_b128 v[156:159], v44 offset:40960
    v_mfma_f32_16x16x32_bf16 v[72:75], v[232:235], v[180:183], v[72:75]
    ds_read_b64_tr_b16 v[208:209], v49 offset:40960
    v_mfma_f32_16x16x32_bf16 v[88:91], v[232:235], v[184:187], v[88:91]
    ds_read_b64_tr_b16 v[210:211], v49 offset:41984
    v_mfma_f32_16x16x32_bf16 v[84:87], v[228:231], v[184:187], v[84:87]
    ds_read_b128 v[160:163], v44 offset:43008
    v_mfma_f32_16x16x32_bf16 v[80:83], v[224:227], v[184:187], v[80:83]
    ds_read_b64_tr_b16 v[212:213], v50 offset:40960
    v_mfma_f32_16x16x32_bf16 v[76:79], v[220:223], v[184:187], v[76:79]
    ds_read_b64_tr_b16 v[214:215], v50 offset:41984
    v_mfma_f32_16x16x32_bf16 v[92:95], v[220:223], v[188:191], v[92:95]
    ds_read_b128 v[164:167], v44 offset:45056
    v_mfma_f32_16x16x32_bf16 v[96:99], v[224:227], v[188:191], v[96:99]
    ds_read_b64_tr_b16 v[216:217], v51 offset:40960
    v_mfma_f32_16x16x32_bf16 v[100:103], v[228:231], v[188:191], v[100:103]
    ds_read_b64_tr_b16 v[218:219], v51 offset:41984
    v_mfma_f32_16x16x32_bf16 v[104:107], v[232:235], v[188:191], v[104:107]
    ds_read_b128 v[168:171], v44 offset:47104
    v_mfma_f32_16x16x32_bf16 v[120:123], v[232:235], v[192:195], v[120:123]
    ds_read_b128 v[172:175], v44 offset:49152
    v_mfma_f32_16x16x32_bf16 v[116:119], v[228:231], v[192:195], v[116:119]
    ds_read_b128 v[176:179], v44 offset:51200
    v_mfma_f32_16x16x32_bf16 v[112:115], v[224:227], v[192:195], v[112:115]
    s_sub_u32 s54, s54, 1
    v_mfma_f32_16x16x32_bf16 v[108:111], v[220:223], v[192:195], v[108:111]
    s_cmp_lg_u32 s54, 0
    v_mfma_f32_16x16x32_bf16 v[124:127], v[220:223], v[196:199], v[124:127]
    v_mfma_f32_16x16x32_bf16 v[128:131], v[224:227], v[196:199], v[128:131]
    v_mfma_f32_16x16x32_bf16 v[132:135], v[228:231], v[196:199], v[132:135]
    v_mfma_f32_16x16x32_bf16 v[136:139], v[232:235], v[196:199], v[136:139]
    v_mfma_f32_16x16x32_bf16 v[152:155], v[232:235], v[200:203], v[152:155]
    v_mfma_f32_16x16x32_bf16 v[148:151], v[228:231], v[200:203], v[148:151]
    v_mfma_f32_16x16x32_bf16 v[144:147], v[224:227], v[200:203], v[144:147]
    v_mfma_f32_16x16x32_bf16 v[140:143], v[220:223], v[200:203], v[140:143]
    s_cbranch_scc1 K_CLOOP
    s_waitcnt lgkmcnt(0)
    v_mfma_f32_16x16x32_bf16 v[60:63], v[204:207], v[156:159], v[60:63]
    ds_read_b128 v[180:183], v45 offset:40960
    ds_read_b64_tr_b16 v[220:221], v48 offset:49152
    v_mfma_f32_16x16x32_bf16 v[64:67], v[208:211], v[156:159], v[64:67]
    ds_read_b64_tr_b16 v[222:223], v48 offset:50176
    ds_read_b64_tr_b16 v[224:225], v49 offset:49152
    v_mfma_f32_16x16x32_bf16 v[68:71], v[212:215], v[156:159], v[68:71]
    ds_read_b64_tr_b16 v[226:227], v49 offset:50176
    ds_read_b64_tr_b16 v[228:229], v50 offset:49152
    v_mfma_f32_16x16x32_bf16 v[72:75], v[216:219], v[156:159], v[72:75]
    ds_read_b64_tr_b16 v[230:231], v50 offset:50176
    ds_read_b64_tr_b16 v[232:233], v51 offset:49152
    v_mfma_f32_16x16x32_bf16 v[76:79], v[204:207], v[160:163], v[76:79]
    ds_read_b64_tr_b16 v[234:235], v51 offset:50176
    ds_read_b128 v[184:187], v45 offset:43008
    v_mfma_f32_16x16x32_bf16 v[80:83], v[208:211], v[160:163], v[80:83]
    ds_read_b128 v[188:191], v45 offset:45056
    ds_read_b128 v[192:195], v45 offset:47104
    v_mfma_f32_16x16x32_bf16 v[84:87], v[212:215], v[160:163], v[84:87]
    ds_read_b128 v[196:199], v45 offset:49152
    ds_read_b128 v[200:203], v45 offset:51200
    v_mfma_f32_16x16x32_bf16 v[88:91], v[216:219], v[160:163], v[88:91]
    s_waitcnt lgkmcnt(11)
    v_mfma_f32_16x16x32_bf16 v[60:63], v[220:223], v[180:183], v[60:63]
    s_nop 1
    s_waitcnt lgkmcnt(9)
    v_mfma_f32_16x16x32_bf16 v[64:67], v[224:227], v[180:183], v[64:67]
    s_nop 1
    s_waitcnt lgkmcnt(7)
    v_mfma_f32_16x16x32_bf16 v[68:71], v[228:231], v[180:183], v[68:71]
    v_cvt_pk_bf16_f32 v60, v60, v61
    v_cvt_pk_bf16_f32 v61, v62, v63
    s_waitcnt lgkmcnt(5)
    v_mfma_f32_16x16x32_bf16 v[72:75], v[232:235], v[180:183], v[72:75]
    ds_write_b64 v56, v[60:61] offset:0
    s_waitcnt lgkmcnt(5)
    v_mfma_f32_16x16x32_bf16 v[76:79], v[220:223], v[184:187], v[76:79]
    v_cvt_pk_bf16_f32 v64, v64, v65
    v_cvt_pk_bf16_f32 v65, v66, v67
    v_mfma_f32_16x16x32_bf16 v[80:83], v[224:227], v[184:187], v[80:83]
    ds_write_b64 v56, v[64:65] offset:32
    v_mfma_f32_16x16x32_bf16 v[84:87], v[228:231], v[184:187], v[84:87]
    v_cvt_pk_bf16_f32 v68, v68, v69
    v_cvt_pk_bf16_f32 v69, v70, v71
    v_mfma_f32_16x16x32_bf16 v[88:91], v[232:235], v[184:187], v[88:91]
    ds_write_b64 v56, v[68:69] offset:64
    v_mfma_f32_16x16x32_bf16 v[92:95], v[204:207], v[164:167], v[92:95]
    v_cvt_pk_bf16_f32 v72, v72, v73
    v_cvt_pk_bf16_f32 v73, v74, v75
    v_mfma_f32_16x16x32_bf16 v[96:99], v[208:211], v[164:167], v[96:99]
    ds_write_b64 v56, v[72:73] offset:96
    v_mfma_f32_16x16x32_bf16 v[100:103], v[212:215], v[164:167], v[100:103]
    v_cvt_pk_bf16_f32 v76, v76, v77
    v_cvt_pk_bf16_f32 v77, v78, v79
    v_mfma_f32_16x16x32_bf16 v[104:107], v[216:219], v[164:167], v[104:107]
    ds_write_b64 v56, v[76:77] offset:4352
    s_waitcnt lgkmcnt(8)
    v_mfma_f32_16x16x32_bf16 v[92:95], v[220:223], v[188:191], v[92:95]
    v_cvt_pk_bf16_f32 v80, v80, v81
    v_cvt_pk_bf16_f32 v81, v82, v83
    v_mfma_f32_16x16x32_bf16 v[96:99], v[224:227], v[188:191], v[96:99]
    ds_write_b64 v56, v[80:81] offset:4384
    v_mfma_f32_16x16x32_bf16 v[100:103], v[228:231], v[188:191], v[100:103]
    v_cvt_pk_bf16_f32 v84, v84, v85
    v_cvt_pk_bf16_f32 v85, v86, v87
    v_mfma_f32_16x16x32_bf16 v[104:107], v[232:235], v[188:191], v[104:107]
    ds_write_b64 v56, v[84:85] offset:4416
    v_mfma_f32_16x16x32_bf16 v[108:111], v[204:207], v[168:171], v[108:111]
    v_cvt_pk_bf16_f32 v88, v88, v89
    v_cvt_pk_bf16_f32 v89, v90, v91
    v_mfma_f32_16x16x32_bf16 v[112:115], v[208:211], v[168:171], v[112:115]
    ds_write_b64 v56, v[88:89] offset:4448
    v_mfma_f32_16x16x32_bf16 v[116:119], v[212:215], v[168:171], v[116:119]
    v_cvt_pk_bf16_f32 v92, v92, v93
    v_cvt_pk_bf16_f32 v93, v94, v95
    v_mfma_f32_16x16x32_bf16 v[120:123], v[216:219], v[168:171], v[120:123]
    ds_write_b64 v56, v[92:93] offset:8704
    s_waitcnt lgkmcnt(11)
    v_mfma_f32_16x16x32_bf16 v[108:111], v[220:223], v[192:195], v[108:111]
    v_cvt_pk_bf16_f32 v96, v96, v97
    v_cvt_pk_bf16_f32 v97, v98, v99
    v_mfma_f32_16x16x32_bf16 v[112:115], v[224:227], v[192:195], v[112:115]
    ds_write_b64 v56, v[96:97] offset:8736
    v_mfma_f32_16x16x32_bf16 v[116:119], v[228:231], v[192:195], v[116:119]
    v_cvt_pk_bf16_f32 v100, v100, v101
    v_cvt_pk_bf16_f32 v101, v102, v103
    v_mfma_f32_16x16x32_bf16 v[120:123], v[232:235], v[192:195], v[120:123]
    ds_write_b64 v56, v[100:101] offset:8768
    v_mfma_f32_16x16x32_bf16 v[124:127], v[204:207], v[172:175], v[124:127]
    v_cvt_pk_bf16_f32 v104, v104, v105
    v_cvt_pk_bf16_f32 v105, v106, v107
    v_mfma_f32_16x16x32_bf16 v[128:131], v[208:211], v[172:175], v[128:131]
    ds_write_b64 v56, v[104:105] offset:8800
    v_mfma_f32_16x16x32_bf16 v[132:135], v[212:215], v[172:175], v[132:135]
    v_cvt_pk_bf16_f32 v108, v108, v109
    v_cvt_pk_bf16_f32 v109, v110, v111
    v_mfma_f32_16x16x32_bf16 v[136:139], v[216:219], v[172:175], v[136:139]
    ds_write_b64 v56, v[108:109] offset:13056
    s_waitcnt lgkmcnt(14)
    v_mfma_f32_16x16x32_bf16 v[124:127], v[220:223], v[196:199], v[124:127]
    v_cvt_pk_bf16_f32 v112, v112, v113
    v_cvt_pk_bf16_f32 v113, v114, v115
    v_mfma_f32_16x16x32_bf16 v[128:131], v[224:227], v[196:199], v[128:131]
    ds_write_b64 v56, v[112:113] offset:13088
    v_mfma_f32_16x16x32_bf16 v[132:135], v[228:231], v[196:199], v[132:135]
    v_cvt_pk_bf16_f32 v116, v116, v117
    v_cvt_pk_bf16_f32 v117, v118, v119
    v_mfma_f32_16x16x32_bf16 v[136:139], v[232:235], v[196:199], v[136:139]
    ds_write_b64 v56, v[116:117] offset:13120
    v_mfma_f32_16x16x32_bf16 v[140:143], v[204:207], v[176:179], v[140:143]
    v_cvt_pk_bf16_f32 v120, v120, v121
    v_cvt_pk_bf16_f32 v121, v122, v123
    v_mfma_f32_16x16x32_bf16 v[144:147], v[208:211], v[176:179], v[144:147]
    ds_write_b64 v56, v[120:121] offset:13152
    v_mfma_f32_16x16x32_bf16 v[148:151], v[212:215], v[176:179], v[148:151]
    v_cvt_pk_bf16_f32 v124, v124, v125
    v_cvt_pk_bf16_f32 v125, v126, v127
    v_mfma_f32_16x16x32_bf16 v[152:155], v[216:219], v[176:179], v[152:155]
    ds_write_b64 v56, v[124:125] offset:17408
    s_waitcnt lgkmcnt(15)
    v_mfma_f32_16x16x32_bf16 v[140:143], v[220:223], v[200:203], v[140:143]
    v_cvt_pk_bf16_f32 v128, v128, v129
    v_cvt_pk_bf16_f32 v129, v130, v131
    v_mfma_f32_16x16x32_bf16 v[144:147], v[224:227], v[200:203], v[144:147]
    ds_write_b64 v56, v[128:129] offset:17440
    v_mfma_f32_16x16x32_bf16 v[148:151], v[228:231], v[200:203], v[148:151]
    v_cvt_pk_bf16_f32 v132, v132, v133
    v_cvt_pk_bf16_f32 v133, v134, v135
    v_mfma_f32_16x16x32_bf16 v[152:155], v[232:235], v[200:203], v[152:155]
    ds_write_b64 v56, v[132:133] offset:17472
    v_cvt_pk_bf16_f32 v136, v136, v137
    v_cvt_pk_bf16_f32 v137, v138, v139
    v_cvt_pk_bf16_f32 v140, v140, v141
    v_cvt_pk_bf16_f32 v141, v142, v143
    v_cvt_pk_bf16_f32 v144, v144, v145
    v_cvt_pk_bf16_f32 v145, v146, v147
    v_cvt_pk_bf16_f32 v148, v148, v149
    v_cvt_pk_bf16_f32 v149, v150, v151
    v_cvt_pk_bf16_f32 v152, v152, v153
    v_cvt_pk_bf16_f32 v153, v154, v155
    ds_write_b64 v56, v[136:137] offset:17504
    ds_write_b64 v56, v[140:141] offset:21760
    ds_write_b64 v56, v[144:145] offset:21792
    ds_write_b64 v56, v[148:149] offset:21824
    ds_write_b64 v56, v[152:153] offset:21856
    s_setprio 0
    s_branch WS_attd
.p2align 12
WP_attd:
    s_setpc_b64 s[38:39]
WS_attd:
    s_waitcnt lgkmcnt(0)
    s_barrier
    ds_read_b64 v[60:61], v13 offset:80
    ds_read_b64 v[62:63], v14 offset:80
    ds_read_b64 v[44:45], v13 offset:4352
    ds_read_b64 v[46:47], v19 offset:4352
    ds_read_b64 v[64:65], v13 offset:4432
    ds_read_b64 v[66:67], v14 offset:4432
    ds_read_b64 v[72:73], v13 offset:120
    ds_read_b64 v[74:75], v14 offset:120
    ds_read_b64 v[48:49], v13 offset:4392
    ds_read_b64 v[50:51], v20 offset:4352
    ds_read_b64 v[76:77], v13 offset:4472
    ds_read_b64 v[78:79], v14 offset:4472
    ds_read_b64 v[52:53], v13 offset:8704
    ds_read_b64 v[54:55], v19 offset:8704
    ds_read_b64 v[68:69], v13 offset:8784
    ds_read_b64 v[70:71], v14 offset:8784
    s_waitcnt lgkmcnt(10)
    v_mfma_f32_16x16x32_bf16 v[116:119], v[60:63], v[44:47], v[36:39]
    v_mfma_f32_16x16x32_bf16 v[120:123], v[64:67], v[44:47], v[32:35]
    ds_read_b64 v[56:57], v13 offset:8744
    ds_read_b64 v[58:59], v20 offset:8704
    ds_read_b64 v[80:81], v13 offset:8824
    ds_read_b64 v[82:83], v14 offset:8824
    s_waitcnt lgkmcnt(8)
    v_mfma_f32_16x16x32_bf16 v[124:127], v[72:75], v[48:51], v[36:39]
    v_mfma_f32_16x16x32_bf16 v[128:131], v[76:79], v[48:51], v[32:35]
    s_waitcnt lgkmcnt(4)
    v_mfma_f32_16x16x32_bf16 v[132:135], v[64:67], v[52:55], v[28:31]
    v_mfma_f32_16x16x32_bf16 v[136:139], v[68:71], v[52:55], v[32:35]
    s_waitcnt lgkmcnt(0)
    v_mfma_f32_16x16x32_bf16 v[140:143], v[76:79], v[56:59], v[28:31]
    v_mfma_f32_16x16x32_bf16 v[144:147], v[80:83], v[56:59], v[32:35]
    ds_read_b64_tr_b16 v[84:85], v15 offset:160
    ds_read_b64_tr_b16 v[86:87], v15 offset:4512
    ds_read_b64_tr_b16 v[100:101], v21 offset:0
    ds_read_b64_tr_b16 v[102:103], v21 offset:4352
    v_max3_f32 v184, v116, v117, v120
    ds_read_b64_tr_b16 v[92:93], v15 offset:200
    v_max3_f32 v185, v118, v119, v122
    ds_read_b64_tr_b16 v[94:95], v15 offset:4552
    v_max_f32 v184, v184, v121
    ds_read_b64_tr_b16 v[104:105], v22 offset:0
    v_max_f32 v185, v185, v123
    ds_read_b64_tr_b16 v[106:107], v22 offset:4352
    v_max3_f32 v186, v124, v125, v128
    ds_read_b64_tr_b16 v[88:89], v15 offset:8864
    v_max3_f32 v187, v126, v127, v130
    ds_read_b64_tr_b16 v[108:109], v23 offset:4352
    v_max_f32 v186, v186, v129
    ds_read_b64_tr_b16 v[110:111], v23 offset:8704
    v_max_f32 v187, v187, v131
    ds_read_b64_tr_b16 v[96:97], v15 offset:8904
    v_max3_f32 v188, v132, v133, v136
    ds_read_b64_tr_b16 v[112:113], v24 offset:4352
    v_max3_f32 v189, v134, v135, v138
    ds_read_b64_tr_b16 v[114:115], v24 offset:8704
    v_max_f32 v188, v188, v137
    v_max_f32 v189, v189, v139
    v_max3_f32 v190, v140, v141, v144
    v_max3_f32 v191, v142, v143, v146
    v_max_f32 v190, v190, v145
    v_max_f32 v191, v191, v147
    v_cvt_pk_bf16_f32 v192, v184, v185
    v_cvt_pk_bf16_f32 v193, v186, v187
    v_cvt_pk_bf16_f32 v194, v188, v189
    v_cvt_pk_bf16_f32 v195, v190, v191
    v_lshlrev_b32 v184, 16, v192
    v_and_b32 v185, 0xffff0000, v192
    v_lshlrev_b32 v186, 16, v193
    v_and_b32 v187, 0xffff0000, v193
    v_lshlrev_b32 v188, 16, v194
    v_and_b32 v189, 0xffff0000, v194
    v_lshlrev_b32 v190, 16, v195
    v_and_b32 v191, 0xffff0000, v195
    v_pk_mul_f32 v[184:185], v[184:185], s[48:49]
    v_pk_mul_f32 v[186:187], v[186:187], s[48:49]
    v_pk_mul_f32 v[188:189], v[188:189], s[48:49]
    v_pk_mul_f32 v[190:191], v[190:191], s[48:49]
    v_cvt_pk_bf16_f32 v192, v184, v185
    v_cvt_pk_bf16_f32 v193, v186, v187
    v_cvt_pk_bf16_f32 v194, v188, v189
    v_cvt_pk_bf16_f32 v195, v190, v191
    v_permlane16_swap_b32 v192, v193
    s_nop 0
    v_permlane16_swap_b32 v194, v195
    s_nop 1
    v_permlane32_swap_b32 v192, v194
    v_permlane32_swap_b32 v193, v195
    v_lshlrev_b32 v184, 16, v192
    v_and_b32 v185, 0xffff0000, v192
    v_lshlrev_b32 v188, 16, v194
    v_and_b32 v189, 0xffff0000, v194
    v_lshlrev_b32 v186, 16, v193
    v_and_b32 v187, 0xffff0000, v193
    v_lshlrev_b32 v190, 16, v195
    v_and_b32 v191, 0xffff0000, v195
    v_max3_f32 v196, v184, v185, v188
    v_max3_f32 v197, v189, v186, v187
    v_max3_f32 v196, v196, v190, v191
    v_max_f32 v196, v196, v197
    v_mul_f32 v196, s46, v196
    v_pk_fma_f32 v[184:185], v[184:185], s[46:47], v[196:197] op_sel_hi:[1,1,0] neg_lo:[0,0,1] neg_hi:[0,0,1]
    v_pk_fma_f32 v[186:187], v[186:187], s[46:47], v[196:197] op_sel_hi:[1,1,0] neg_lo:[0,0,1] neg_hi:[0,0,1]
    v_pk_fma_f32 v[188:189], v[188:189], s[46:47], v[196:197] op_sel_hi:[1,1,0] neg_lo:[0,0,1] neg_hi:[0,0,1]
    v_pk_fma_f32 v[190:191], v[190:191], s[46:47], v[196:197] op_sel_hi:[1,1,0] neg_lo:[0,0,1] neg_hi:[0,0,1]
    v_exp_f32 v184, v184
    v_exp_f32 v185, v185
    v_exp_f32 v186, v186
    v_exp_f32 v187, v187
    v_exp_f32 v188, v188
    v_exp_f32 v189, v189
    v_exp_f32 v190, v190
    v_exp_f32 v191, v191
    v_pk_add_f32 v[200:201], v[184:185], v[186:187]
    v_pk_add_f32 v[202:203], v[188:189], v[190:191]
    v_pk_add_f32 v[200:201], v[200:201], v[202:203]
    v_add_f32 v200, v200, v201
    v_rcp_f32 v200, v200
    s_waitcnt lgkmcnt(0)
    v_pk_mul_f32 v[184:185], v[184:185], v[200:201] op_sel_hi:[1,0]
    v_pk_mul_f32 v[186:187], v[186:187], v[200:201] op_sel_hi:[1,0]
    v_pk_mul_f32 v[188:189], v[188:189], v[200:201] op_sel_hi:[1,0]
    v_pk_mul_f32 v[190:191], v[190:191], v[200:201] op_sel_hi:[1,0]
    v_cvt_pk_bf16_f32 v192, v184, v185
    v_cvt_pk_bf16_f32 v194, v188, v189
    v_cvt_pk_bf16_f32 v193, v186, v187
    v_cvt_pk_bf16_f32 v195, v190, v191
    v_permlane32_swap_b32 v192, v194
    s_nop 0
    v_permlane32_swap_b32 v193, v195
    s_nop 1
    v_permlane16_swap_b32 v192, v193
    v_permlane16_swap_b32 v194, v195
    v_perm_b32 v148, v192, v192, v40
    v_perm_b32 v149, v192, v192, v41
    v_perm_b32 v150, v192, v192, v42
    v_perm_b32 v151, v192, v192, v43
    v_perm_b32 v152, v193, v193, v40
    v_perm_b32 v153, v193, v193, v41
    v_perm_b32 v154, v193, v193, v42
    v_perm_b32 v155, v193, v193, v43
    v_mfma_f32_16x16x32_bf16 v[164:167], v[84:87], v[148:151], 0
    v_mfma_f32_16x16x32_bf16 v[180:183], v[100:103], v[148:151], 0
    v_perm_b32 v156, v194, v194, v40
    v_perm_b32 v157, v194, v194, v41
    v_perm_b32 v158, v194, v194, v42
    v_perm_b32 v159, v194, v194, v43
    v_mfma_f32_16x16x32_bf16 v[168:171], v[92:95], v[152:155], 0
    v_mfma_f32_16x16x32_bf16 v[180:183], v[104:107], v[152:155], v[180:183]
    v_perm_b32 v160, v195, v195, v40
    v_perm_b32 v161, v195, v195, v41
    v_perm_b32 v162, v195, v195, v42
    v_perm_b32 v163, v195, v195, v43
    v_mfma_f32_16x16x32_bf16 v[172:175], v[86:89], v[156:159], 0
    v_mfma_f32_16x16x32_bf16 v[180:183], v[108:111], v[156:159], v[180:183]
    v_mfma_f32_16x16x32_bf16 v[176:179], v[94:97], v[160:163], 0
    v_mfma_f32_16x16x32_bf16 v[180:183], v[112:115], v[160:163], v[180:183]
    v_cvt_pk_bf16_f32 v204, v164, v165
    v_cvt_pk_bf16_f32 v205, v166, v167
    v_cvt_pk_bf16_f32 v206, v168, v169
    v_cvt_pk_bf16_f32 v207, v170, v171
    buffer_store_dwordx4 v[204:207], v16, s[20:23], s50 offen sc1
    v_cvt_pk_bf16_f32 v208, v172, v173
    v_cvt_pk_bf16_f32 v209, v174, v175
    v_cvt_pk_bf16_f32 v210, v176, v177
    v_cvt_pk_bf16_f32 v211, v178, v179
    buffer_store_dwordx4 v[208:211], v16, s[20:23], s51 offen sc1
    v_cvt_pk_bf16_f32 v196, v180, v181
    v_cvt_pk_bf16_f32 v197, v182, v183
    buffer_store_dwordx2 v[196:197], v17, s[20:23], s50 offen sc1
    s_cmp_lg_u32 s34, -1
    s_cbranch_scc1 K_P2_EARLY
K_DRAIN:
    s_waitcnt vmcnt(0)
    s_barrier
    s_branch K_END
K_W7:
    s_waitcnt vmcnt(26)
    v_and_b32 v4, 7, v1
    v_lshlrev_b32 v4, 2, v4
    s_mov_b32 s3, 131072
K_ZPOLL5:
    v_cmp_eq_u32 vcc, 0, v7
    s_cbranch_vccz K_ZOK5
    s_sub_u32 s3, s3, 1
    s_cbranch_scc1 K_ZOK5
    global_load_dword v7, v4, s[8:9] offset:192 sc1
    s_waitcnt vmcnt(0)
    s_branch K_ZPOLL5
K_ZOK5:
    v_mov_b32 v4, 158720
    v_mov_b32 v3, 1
    s_mov_b64 exec, 1
    s_nop 0
    ds_add_rtn_u32 v2, v4, v3 offset:48
    s_mov_b32 exec_lo, s36
    v_mov_b32 v3, 1
    s_waitcnt lgkmcnt(0)
    v_readfirstlane_b32 s33, v2
    s_nop 3
    s_and_b32 s33, s33, 0xff
    s_cmp_lg_u32 s33, 7
    s_cbranch_scc1 K_ARR7
    global_store_dword v8, v3, s[10:11] sc1
K_ARR7:
    s_mov_b64 exec, -1
    v_mov_b32 v3, 0x100
    s_mov_b64 exec, 1
    s_waitcnt vmcnt(0)
    ds_add_u32 v4, v3 offset:48
    s_mov_b64 exec, -1
    s_branch K_P2_HELP
K_FLAG:
    s_waitcnt vmcnt(0)
    v_and_b32 v4, 7, v1
    v_lshlrev_b32 v4, 2, v4
    s_mov_b32 s3, 131072
K_ZPOLL0:
    v_cmp_eq_u32 vcc, 0, v7
    s_cbranch_vccz K_ZOK0
    s_sub_u32 s3, s3, 1
    s_cbranch_scc1 K_ZOK0
    global_load_dword v7, v4, s[8:9] offset:192 sc1
    s_waitcnt vmcnt(0)
    s_branch K_ZPOLL0
K_ZOK0:
    v_mov_b32 v3, 1
    s_mov_b32 exec_lo, s36
    s_mov_b32 exec_hi, 0
    s_setprio 3
    s_barrier
    global_store_dword v8, v3, s[10:11] sc1
    s_mov_b64 exec, -1
    s_branch K_END
WP_atts:
    s_setpc_b64 s[38:39]
K_JOIN_S:
    s_setprio 0
    s_barrier
    s_cmp_eq_u32 s30, 7
    s_cbranch_scc1 K_FLAG
    ds_read_b64 v[52:53], v13 offset:80
    ds_read_b64 v[54:55], v14 offset:80
    ds_read_b64 v[44:45], v13 offset:4352
    ds_read_b64 v[46:47], v19 offset:4352
    ds_read_b64 v[56:57], v13 offset:4432
    ds_read_b64 v[58:59], v14 offset:4432
    ds_read_b64 v[60:61], v13 offset:120
    ds_read_b64 v[62:63], v14 offset:120
    ds_read_b64 v[48:49], v13 offset:4392
    ds_read_b64 v[50:51], v20 offset:4352
    ds_read_b64 v[64:65], v13 offset:4472
    ds_read_b64 v[66:67], v14 offset:4472
    s_waitcnt lgkmcnt(6)
    v_mfma_f32_16x16x32_bf16 v[84:87], v[52:55], v[44:47], v[36:39]
    v_mfma_f32_16x16x32_bf16 v[88:91], v[56:59], v[44:47], v[32:35]
    s_waitcnt lgkmcnt(0)
    v_mfma_f32_16x16x32_bf16 v[92:95], v[60:63], v[48:51], v[36:39]
    v_mfma_f32_16x16x32_bf16 v[96:99], v[64:67], v[48:51], v[32:35]
    ds_read_b64_tr_b16 v[68:69], v15 offset:160
    ds_read_b64_tr_b16 v[70:71], v15 offset:4512
    ds_read_b64_tr_b16 v[76:77], v21 offset:0
    ds_read_b64_tr_b16 v[78:79], v21 offset:4352
    ds_read_b64_tr_b16 v[72:73], v15 offset:200
    ds_read_b64_tr_b16 v[74:75], v15 offset:4552
    ds_read_b64_tr_b16 v[80:81], v22 offset:0
    ds_read_b64_tr_b16 v[82:83], v22 offset:4352
    v_max3_f32 v120, v84, v85, v88
    v_max3_f32 v121, v86, v87, v90
    v_max_f32 v120, v120, v89
    v_max_f32 v121, v121, v91
    v_max3_f32 v122, v92, v93, v96
    v_max3_f32 v123, v94, v95, v98
    v_max_f32 v122, v122, v97
    v_max_f32 v123, v123, v99
    v_cvt_pk_bf16_f32 v124, v120, v121
    v_cvt_pk_bf16_f32 v125, v122, v123
    v_lshlrev_b32 v120, 16, v124
    v_and_b32 v121, 0xffff0000, v124
    v_lshlrev_b32 v122, 16, v125
    v_and_b32 v123, 0xffff0000, v125
    v_pk_mul_f32 v[120:121], v[120:121], s[48:49]
    v_pk_mul_f32 v[122:123], v[122:123], s[48:49]
    v_cvt_pk_bf16_f32 v124, v120, v121
    v_cvt_pk_bf16_f32 v125, v122, v123
    s_nop 1
    v_permlane16_swap_b32 v124, v125
    v_lshlrev_b32 v120, 16, v124
    v_and_b32 v121, 0xffff0000, v124
    v_lshlrev_b32 v122, 16, v125
    v_and_b32 v123, 0xffff0000, v125
    v_max3_f32 v126, v120, v121, v122
    v_max_f32 v126, v126, v123
    v_mov_b32 v127, v126
    s_nop 1
    v_permlane32_swap_b32 v126, v127
    v_max_f32 v126, v126, v127
    v_mul_f32 v126, s46, v126
    v_pk_fma_f32 v[120:121], v[120:121], s[46:47], v[126:127] op_sel_hi:[1,1,0] neg_lo:[0,0,1] neg_hi:[0,0,1]
    v_pk_fma_f32 v[122:123], v[122:123], s[46:47], v[126:127] op_sel_hi:[1,1,0] neg_lo:[0,0,1] neg_hi:[0,0,1]
    v_exp_f32 v120, v120
    v_exp_f32 v121, v121
    v_exp_f32 v122, v122
    v_exp_f32 v123, v123
    s_nop 0
    v_pk_add_f32 v[128:129], v[120:121], v[122:123]
    v_add_f32 v128, v128, v129
    v_mov_b32 v129, v128
    s_nop 1
    v_permlane32_swap_b32 v128, v129
    v_add_f32 v128, v128, v129
    v_rcp_f32 v128, v128
    s_waitcnt lgkmcnt(0)
    v_pk_mul_f32 v[120:121], v[120:121], v[128:129] op_sel_hi:[1,0]
    v_pk_mul_f32 v[122:123], v[122:123], v[128:129] op_sel_hi:[1,0]
    v_cvt_pk_bf16_f32 v124, v120, v121
    v_cvt_pk_bf16_f32 v125, v122, v123
    s_nop 1
    v_permlane16_swap_b32 v124, v125
    v_perm_b32 v100, v124, v124, v40
    v_perm_b32 v101, v124, v124, v41
    v_perm_b32 v102, v124, v124, v42
    v_perm_b32 v103, v124, v124, v43
    v_perm_b32 v104, v125, v125, v40
    v_perm_b32 v105, v125, v125, v41
    v_perm_b32 v106, v125, v125, v42
    v_perm_b32 v107, v125, v125, v43
    v_mfma_f32_16x16x32_bf16 v[108:111], v[68:71], v[100:103], 0
    v_mfma_f32_16x16x32_bf16 v[116:119], v[76:79], v[100:103], 0
    v_mfma_f32_16x16x32_bf16 v[112:115], v[72:75], v[104:107], 0
    v_mfma_f32_16x16x32_bf16 v[116:119], v[80:83], v[104:107], v[116:119]
    s_nop 4
    v_cvt_pk_bf16_f32 v132, v108, v109
    v_cvt_pk_bf16_f32 v133, v110, v111
    v_cvt_pk_bf16_f32 v134, v112, v113
    v_cvt_pk_bf16_f32 v135, v114, v115
    buffer_store_dwordx4 v[132:135], v16, s[20:23], s50 offen sc1
    v_cvt_pk_bf16_f32 v126, v116, v117
    v_cvt_pk_bf16_f32 v127, v118, v119
    buffer_store_dwordx2 v[126:127], v17, s[20:23], s50 offen sc1
    s_cmp_eq_u32 s34, -1
    s_cbranch_scc1 K_DRAIN
    s_cmp_lg_u32 s30, 6
    s_cbranch_scc1 K_NOFL
    s_waitcnt vmcnt(12)
    v_and_b32 v4, 7, v1
    v_lshlrev_b32 v4, 2, v4
    s_mov_b32 s3, 131072
K_ZPOLL2:
    v_cmp_eq_u32 vcc, 0, v7
    s_cbranch_vccz K_ZOK2
    s_sub_u32 s3, s3, 1
    s_cbranch_scc1 K_ZOK2
    global_load_dword v7, v4, s[8:9] offset:192 sc1
    s_waitcnt vmcnt(0)
    s_branch K_ZPOLL2
K_ZOK2:
    v_and_b32 v2, 1, v1
    v_lshl_add_u32 v2, v2, 2, s42
    global_load_dword v7, v2, s[10:11] offset:128 sc1
K_NOFL:
    v_mov_b32 v4, 158720
    v_mov_b32 v3, 257
    s_mov_b64 exec, 1
    s_waitcnt vmcnt(0)
    ds_add_rtn_u32 v2, v4, v3 offset:48
    s_mov_b32 exec_lo, s36
    v_mov_b32 v3, 1
    s_waitcnt lgkmcnt(0)
    v_readfirstlane_b32 s33, v2
    s_nop 3
    s_and_b32 s33, s33, 0xff
    s_cmp_lg_u32 s33, 7
    s_cbranch_scc1 K_ARRS
    global_store_dword v8, v3, s[10:11] sc1
K_ARRS:
    s_mov_b64 exec, -1
    s_cmp_ge_u32 s30, 6
    s_cbranch_scc1 K_P2_HELP
    s_branch K_LATE
WP_early:
    s_setpc_b64 s[38:39]
K_P2_EARLY:
    s_lshl_b32 s54, s40, 7
    v_lshrrev_b32 v9, 4, v1
    v_mov_b32 v12, 158720
    s_add_u32 s20, s10, 0x100000
    s_addc_u32 s21, s11, 0
    s_mov_b32 s22, 0x280000
    s_mov_b32 s23, 0x20000
    s_add_u32 s16, s10, 0x1000
    s_addc_u32 s17, s11, 0
    s_mov_b32 s18, 0x2000
    s_mov_b32 s19, 0x20000
    s_mov_b32 s48, s6
    s_mov_b32 s49, s7
    s_mov_b32 s50, 0x280000
    s_mov_b32 s51, 0x20000
    s_lshl_b32 s53, s40, 3
    s_lshl1_add_u32 s53, s30, s53
    s_mov_b32 s55, 20480
    v_bfe_u32 v20, v1, 2, 2
    v_and_b32 v21, 3, v1
    s_mul_i32 s3, s53, 20480
    v_lshl_add_u32 v25, v1, 4, s3
    v_add_u32 v26, 20480, v25
    v_and_b32 v2, 15, v1
    s_lshl_b32 s3, s53, 6
    v_lshl_add_u32 v23, v2, 2, s3
    v_lshl_add_u32 v2, v9, 2, v20
    v_bfe_u32 v3, v2, 1, 2
    v_lshlrev_b32 v2, 7, v2
    v_lshl_add_u32 v2, v21, 3, v2
    v_lshl_add_u32 v24, v3, 5, v2
    v_lshrrev_b32 v3, 1, v20
    v_mul_u32_u24 v2, 40, v9
    v_add3_u32 v2, v2, 16, v20
    v_lshlrev_b32 v2, 7, v2
    v_lshl_add_u32 v2, v21, 3, v2
    v_xor_b32 v4, 0, v3
    v_lshl_add_u32 v56, v4, 5, v2
    v_xor_b32 v4, 1, v3
    v_lshl_add_u32 v57, v4, 5, v2
    v_xor_b32 v4, 2, v3
    v_lshl_add_u32 v58, v4, 5, v2
    v_xor_b32 v4, 3, v3
    v_lshl_add_u32 v59, v4, 5, v2
    v_lshrrev_b32 v3, 4, v1
    v_and_b32 v4, 7, v1
    v_lshrrev_b32 v2, 3, v1
    v_xor_b32 v4, v4, v3
    v_mul_u32_u24 v2, 1280, v2
    v_lshl_add_u32 v27, v4, 4, v2
    v_xor_b32 v28, 64, v27
    s_lshl_b32 s71, s40, 3
    s_lshl1_add_u32 s71, s30, s71
    s_mul_i32 s71, s71, 20480
    s_lshl_b32 s33, s41, 7
    s_add_u32 s71, s71, s33
    s_add_u32 s72, s71, 10240
    s_add_u32 s73, s71, 20480
    s_add_u32 s74, s71, 30720
    s_lshl_b32 s3, s30, 12
    s_add_u32 s3, s3, 140288
    v_lshl_add_u32 v33, v1, 4, s3
    v_and_b32 v2, 15, v1
    v_lshrrev_b32 v3, 1, v2
    v_lshrrev_b32 v4, 5, v1
    v_xor_b32 v3, v3, v4
    v_lshlrev_b32 v3, 4, v3
    v_lshl_add_u32 v3, v2, 7, v3
    v_and_b32 v4, 1, v9
    v_lshl_add_u32 v3, v4, 3, v3
    v_add_u32 v29, s3, v3
    v_xor_b32 v30, 32, v29
    v_xor_b32 v31, 64, v29
    v_xor_b32 v32, 96, v29
    s_and_b32 s33, s40, 3
    s_lshl_b32 s33, s33, 3
    s_lshr_b32 s33, 0x7f06037f, s33
    s_and_b32 s33, s33, 0xff
    s_lshl_b32 s3, s30, 1
    s_cmp_ge_u32 s3, s33
    s_cselect_b32 s64, 16, 0
    s_add_u32 s3, s3, 1
    s_cmp_ge_u32 s3, s33
    s_cselect_b32 s65, 16, 0
    s_mov_b32 s63, 0
    s_mov_b32 s66, 0
    s_mov_b32 s67, 16384
    v_mov_b32 v4, 158720
    v_mov_b32 v3, 1
    s_mov_b64 exec, 1
    s_waitcnt vmcnt(0)
    ds_add_rtn_u32 v2, v4, v3 offset:48
    s_mov_b32 exec_lo, s36
    v_mov_b32 v3, 1
    s_waitcnt lgkmcnt(0)
    v_readfirstlane_b32 s33, v2
    s_nop 3
    s_and_b32 s33, s33, 0xff
    s_cmp_lg_u32 s33, 7
    s_cbranch_scc1 K_ARRD
    global_store_dword v8, v3, s[10:11] sc1
K_ARRD:
    s_mov_b64 exec, -1
    s_mov_b32 s3, 1048576
K_P2_GE:
    ds_read_b32 v2, v12 offset:48
    s_sub_u32 s3, s3, 1
    s_waitcnt lgkmcnt(0)
    v_readfirstlane_b32 s33, v2
    s_nop 3
    s_cselect_b32 s33, 1024, s33
    s_cmp_lt_u32 s33, 1024
    s_cbranch_scc1 K_P2_GE
K_P2_GEMM:
    s_setprio 2
    s_mov_b32 s3, 1048576
K_P2_GS:
    ds_read_b32 v2, v12 offset:40
    s_sub_u32 s3, s3, 1
    s_waitcnt lgkmcnt(0)
    v_readfirstlane_b32 s33, v2
    s_nop 3
    s_cselect_b32 s33, 1, s33
    s_cmp_lt_u32 s33, 1
    s_cbranch_scc1 K_P2_GS
    buffer_load_dword v60, v23, s[16:19], 0 offen offset:0 sc1
    buffer_load_dword v62, v23, s[16:19], 0 offen offset:64 sc1
    ds_read_b128 v[16:19], v12
    ds_read_b64 v[36:37], v29 offset:0
    ds_read_b64 v[38:39], v30 offset:0
    ds_read_b64 v[40:41], v31 offset:0
    ds_read_b64 v[42:43], v32 offset:0
    ds_read_b64 v[44:45], v29 offset:2048
    ds_read_b64 v[46:47], v30 offset:2048
    ds_read_b64 v[48:49], v31 offset:2048
    ds_read_b64 v[50:51], v32 offset:2048
    s_waitcnt lgkmcnt(4)
    v_lshlrev_b32 v68, 16, v36
    v_and_b32 v69, 0xffff0000, v36
    v_lshlrev_b32 v70, 16, v37
    v_and_b32 v71, 0xffff0000, v37
    v_lshlrev_b32 v72, 16, v38
    v_and_b32 v73, 0xffff0000, v38
    v_lshlrev_b32 v74, 16, v39
    v_and_b32 v75, 0xffff0000, v39
    v_lshlrev_b32 v76, 16, v40
    v_and_b32 v77, 0xffff0000, v40
    v_lshlrev_b32 v78, 16, v41
    v_and_b32 v79, 0xffff0000, v41
    v_lshlrev_b32 v80, 16, v42
    v_and_b32 v81, 0xffff0000, v42
    v_lshlrev_b32 v82, 16, v43
    v_and_b32 v83, 0xffff0000, v43
    s_waitcnt lgkmcnt(0)
    v_lshlrev_b32 v84, 16, v44
    v_and_b32 v85, 0xffff0000, v44
    v_lshlrev_b32 v86, 16, v45
    v_and_b32 v87, 0xffff0000, v45
    v_lshlrev_b32 v88, 16, v46
    v_and_b32 v89, 0xffff0000, v46
    v_lshlrev_b32 v90, 16, v47
    v_and_b32 v91, 0xffff0000, v47
    v_lshlrev_b32 v92, 16, v48
    v_and_b32 v93, 0xffff0000, v48
    v_lshlrev_b32 v94, 16, v49
    v_and_b32 v95, 0xffff0000, v49
    v_lshlrev_b32 v96, 16, v50
    v_and_b32 v97, 0xffff0000, v50
    v_lshlrev_b32 v98, 16, v51
    v_and_b32 v99, 0xffff0000, v51
    s_cmp_eq_u32 s63, 0
    s_cbranch_scc1 K_SP0
K_SPR0:
    s_ff1_i32_b32 s33, s63
    s_bitset0_b32 s63, s33
    s_lshl_b32 s75, s33, 10
    buffer_load_dwordx4 v[100:103], v25, s[20:23], s75 offen offset:0 sc1
    buffer_load_dwordx4 v[104:107], v26, s[20:23], s75 offen offset:0 sc1
    v_mad_u32_u24 v52, s75, 5, v24
    v_xor_b32 v54, 64, v52
    v_xor_b32 v53, 32, v52
    v_xor_b32 v55, 96, v52
    ds_read_b64_tr_b16 v[180:181], v52 offset:0
    ds_read_b64_tr_b16 v[182:183], v54 offset:2560
    ds_read_b64_tr_b16 v[184:185], v53 offset:0
    ds_read_b64_tr_b16 v[186:187], v55 offset:2560
    ds_read_b64_tr_b16 v[188:189], v54 offset:0
    ds_read_b64_tr_b16 v[190:191], v52 offset:2560
    ds_read_b64_tr_b16 v[192:193], v55 offset:0
    ds_read_b64_tr_b16 v[194:195], v53 offset:2560
    s_cmp_eq_u32 s63, 0
    s_cbranch_scc1 K_SP1
K_SPR1:
    s_ff1_i32_b32 s33, s63
    s_bitset0_b32 s63, s33
    s_lshl_b32 s76, s33, 10
    buffer_load_dwordx4 v[108:111], v25, s[20:23], s76 offen offset:0 sc1
    buffer_load_dwordx4 v[112:115], v26, s[20:23], s76 offen offset:0 sc1
    v_mad_u32_u24 v52, s76, 5, v24
    v_xor_b32 v54, 64, v52
    v_xor_b32 v53, 32, v52
    v_xor_b32 v55, 96, v52
    ds_read_b64_tr_b16 v[196:197], v52 offset:0
    ds_read_b64_tr_b16 v[198:199], v54 offset:2560
    ds_read_b64_tr_b16 v[200:201], v53 offset:0
    ds_read_b64_tr_b16 v[202:203], v55 offset:2560
    ds_read_b64_tr_b16 v[204:205], v54 offset:0
    ds_read_b64_tr_b16 v[206:207], v52 offset:2560
    ds_read_b64_tr_b16 v[208:209], v55 offset:0
    ds_read_b64_tr_b16 v[210:211], v53 offset:2560
    s_waitcnt vmcnt(4)
    v_sub_f32 v64, 1.0, v60
    v_cvt_pk_bf16_f32 v64, v64, v64
    v_lshlrev_b32 v64, 16, v64
    v_sub_f32 v66, 1.0, v62
    v_cvt_pk_bf16_f32 v66, v66, v66
    v_lshlrev_b32 v66, 16, v66
    v_pk_mul_f32 v[68:69], v[68:69], v[64:65] op_sel_hi:[1,0]
    v_pk_mul_f32 v[70:71], v[70:71], v[64:65] op_sel_hi:[1,0]
    v_pk_mul_f32 v[72:73], v[72:73], v[64:65] op_sel_hi:[1,0]
    v_pk_mul_f32 v[74:75], v[74:75], v[64:65] op_sel_hi:[1,0]
    v_pk_mul_f32 v[76:77], v[76:77], v[64:65] op_sel_hi:[1,0]
    v_pk_mul_f32 v[78:79], v[78:79], v[64:65] op_sel_hi:[1,0]
    v_pk_mul_f32 v[80:81], v[80:81], v[64:65] op_sel_hi:[1,0]
    v_pk_mul_f32 v[82:83], v[82:83], v[64:65] op_sel_hi:[1,0]
    v_pk_mul_f32 v[84:85], v[84:85], v[66:67] op_sel_hi:[1,0]
    v_pk_mul_f32 v[86:87], v[86:87], v[66:67] op_sel_hi:[1,0]
    v_pk_mul_f32 v[88:89], v[88:89], v[66:67] op_sel_hi:[1,0]
    v_pk_mul_f32 v[90:91], v[90:91], v[66:67] op_sel_hi:[1,0]
    v_pk_mul_f32 v[92:93], v[92:93], v[66:67] op_sel_hi:[1,0]
    v_pk_mul_f32 v[94:95], v[94:95], v[66:67] op_sel_hi:[1,0]
    v_pk_mul_f32 v[96:97], v[96:97], v[66:67] op_sel_hi:[1,0]
    v_pk_mul_f32 v[98:99], v[98:99], v[66:67] op_sel_hi:[1,0]
    s_cmp_eq_u32 s63, 0
    s_cbranch_scc1 K_SP2
K_SPR2:
    s_ff1_i32_b32 s33, s63
    s_bitset0_b32 s63, s33
    s_lshl_b32 s77, s33, 10
    buffer_load_dwordx4 v[116:119], v25, s[20:23], s77 offen offset:0 sc1
    buffer_load_dwordx4 v[120:123], v26, s[20:23], s77 offen offset:0 sc1
    s_cmp_eq_u32 s63, 0
    s_cbranch_scc1 K_SP3
K_SPR3:
    s_ff1_i32_b32 s33, s63
    s_bitset0_b32 s63, s33
    s_lshl_b32 s78, s33, 10
    buffer_load_dwordx4 v[124:127], v25, s[20:23], s78 offen offset:0 sc1
    buffer_load_dwordx4 v[128:131], v26, s[20:23], s78 offen offset:0 sc1
    s_cmp_eq_u32 s63, 0
    s_cbranch_scc1 K_SP4
K_SPR4:
    s_ff1_i32_b32 s33, s63
    s_bitset0_b32 s63, s33
    s_lshl_b32 s75, s33, 10
    buffer_load_dwordx4 v[132:135], v25, s[20:23], s75 offen offset:0 sc1
    buffer_load_dwordx4 v[136:139], v26, s[20:23], s75 offen offset:0 sc1
    s_branch WS_p2g
.p2align 12
WP_p2g:
    s_setpc_b64 s[38:39]
WS_p2g:
    s_waitcnt vmcnt(8) lgkmcnt(8)
    v_mfma_f32_16x16x32_bf16 v[148:151], v[180:183], v[100:103], 0
    v_mad_u32_u24 v52, s77, 5, v24
    v_xor_b32 v54, 64, v52
    v_xor_b32 v53, 32, v52
    v_mfma_f32_16x16x32_bf16 v[164:167], v[180:183], v[104:107], 0
    v_xor_b32 v55, 96, v52
    ds_read_b64_tr_b16 v[212:213], v52 offset:0
    ds_read_b64_tr_b16 v[214:215], v54 offset:2560
    v_mfma_f32_16x16x32_bf16 v[152:155], v[184:187], v[100:103], 0
    ds_read_b64_tr_b16 v[216:217], v53 offset:0
    ds_read_b64_tr_b16 v[218:219], v55 offset:2560
    ds_read_b64_tr_b16 v[220:221], v54 offset:0
    v_mfma_f32_16x16x32_bf16 v[168:171], v[184:187], v[104:107], 0
    ds_read_b64_tr_b16 v[222:223], v52 offset:2560
    ds_read_b64_tr_b16 v[224:225], v55 offset:0
    v_mfma_f32_16x16x32_bf16 v[156:159], v[188:191], v[100:103], 0
    ds_read_b64_tr_b16 v[226:227], v53 offset:2560
    s_cmp_eq_u32 s63, 0
    v_mfma_f32_16x16x32_bf16 v[172:175], v[188:191], v[104:107], 0
    s_cbranch_scc1 K_SP5
K_SPR5:
    s_ff1_i32_b32 s33, s63
    v_mfma_f32_16x16x32_bf16 v[160:163], v[192:195], v[100:103], 0
    s_bitset0_b32 s63, s33
    s_lshl_b32 s76, s33, 10
    v_mfma_f32_16x16x32_bf16 v[176:179], v[192:195], v[104:107], 0
    buffer_load_dwordx4 v[140:143], v25, s[20:23], s76 offen offset:0 sc1
    buffer_load_dwordx4 v[144:147], v26, s[20:23], s76 offen offset:0 sc1
    s_waitcnt vmcnt(8) lgkmcnt(8)
    v_mfma_f32_16x16x32_bf16 v[148:151], v[196:199], v[108:111], v[148:151]
    v_mad_u32_u24 v52, s78, 5, v24
    v_xor_b32 v54, 64, v52
    v_xor_b32 v53, 32, v52
    v_mfma_f32_16x16x32_bf16 v[164:167], v[196:199], v[112:115], v[164:167]
    v_xor_b32 v55, 96, v52
    ds_read_b64_tr_b16 v[180:181], v52 offset:0
    ds_read_b64_tr_b16 v[182:183], v54 offset:2560
    v_mfma_f32_16x16x32_bf16 v[152:155], v[200:203], v[108:111], v[152:155]
    ds_read_b64_tr_b16 v[184:185], v53 offset:0
    ds_read_b64_tr_b16 v[186:187], v55 offset:2560
    ds_read_b64_tr_b16 v[188:189], v54 offset:0
    v_mfma_f32_16x16x32_bf16 v[168:171], v[200:203], v[112:115], v[168:171]
    ds_read_b64_tr_b16 v[190:191], v52 offset:2560
    ds_read_b64_tr_b16 v[192:193], v55 offset:0
    v_mfma_f32_16x16x32_bf16 v[156:159], v[204:207], v[108:111], v[156:159]
    ds_read_b64_tr_b16 v[194:195], v53 offset:2560
    s_cmp_eq_u32 s63, 0
    v_mfma_f32_16x16x32_bf16 v[172:175], v[204:207], v[112:115], v[172:175]
    s_cbranch_scc1 K_SP6
K_SPR6:
    s_ff1_i32_b32 s33, s63
    v_mfma_f32_16x16x32_bf16 v[160:163], v[208:211], v[108:111], v[160:163]
    s_bitset0_b32 s63, s33
    s_lshl_b32 s77, s33, 10
    v_mfma_f32_16x16x32_bf16 v[176:179], v[208:211], v[112:115], v[176:179]
    buffer_load_dwordx4 v[100:103], v25, s[20:23], s77 offen offset:0 sc1
    buffer_load_dwordx4 v[104:107], v26, s[20:23], s77 offen offset:0 sc1
    s_waitcnt vmcnt(8) lgkmcnt(8)
    v_mfma_f32_16x16x32_bf16 v[148:151], v[212:215], v[116:119], v[148:151]
    v_mad_u32_u24 v52, s75, 5, v24
    v_xor_b32 v54, 64, v52
    v_xor_b32 v53, 32, v52
    v_mfma_f32_16x16x32_bf16 v[164:167], v[212:215], v[120:123], v[164:167]
    v_xor_b32 v55, 96, v52
    ds_read_b64_tr_b16 v[196:197], v52 offset:0
    ds_read_b64_tr_b16 v[198:199], v54 offset:2560
    v_mfma_f32_16x16x32_bf16 v[152:155], v[216:219], v[116:119], v[152:155]
    ds_read_b64_tr_b16 v[200:201], v53 offset:0
    ds_read_b64_tr_b16 v[202:203], v55 offset:2560
    ds_read_b64_tr_b16 v[204:205], v54 offset:0
    v_mfma_f32_16x16x32_bf16 v[168:171], v[216:219], v[120:123], v[168:171]
    ds_read_b64_tr_b16 v[206:207], v52 offset:2560
    ds_read_b64_tr_b16 v[208:209], v55 offset:0
    v_mfma_f32_16x16x32_bf16 v[156:159], v[220:223], v[116:119], v[156:159]
    ds_read_b64_tr_b16 v[210:211], v53 offset:2560
    s_cmp_eq_u32 s63, 0
    v_mfma_f32_16x16x32_bf16 v[172:175], v[220:223], v[120:123], v[172:175]
    s_cbranch_scc1 K_SP7
K_SPR7:
    s_ff1_i32_b32 s33, s63
    v_mfma_f32_16x16x32_bf16 v[160:163], v[224:227], v[116:119], v[160:163]
    s_bitset0_b32 s63, s33
    s_lshl_b32 s78, s33, 10
    v_mfma_f32_16x16x32_bf16 v[176:179], v[224:227], v[120:123], v[176:179]
    buffer_load_dwordx4 v[108:111], v25, s[20:23], s78 offen offset:0 sc1
    buffer_load_dwordx4 v[112:115], v26, s[20:23], s78 offen offset:0 sc1
    s_waitcnt vmcnt(8) lgkmcnt(8)
    v_mfma_f32_16x16x32_bf16 v[148:151], v[180:183], v[124:127], v[148:151]
    v_mad_u32_u24 v52, s76, 5, v24
    v_xor_b32 v54, 64, v52
    v_mfma_f32_16x16x32_bf16 v[164:167], v[180:183], v[128:131], v[164:167]
    v_xor_b32 v53, 32, v52
    v_xor_b32 v55, 96, v52
    v_mfma_f32_16x16x32_bf16 v[152:155], v[184:187], v[124:127], v[152:155]
    ds_read_b64_tr_b16 v[212:213], v52 offset:0
    ds_read_b64_tr_b16 v[214:215], v54 offset:2560
    v_mfma_f32_16x16x32_bf16 v[168:171], v[184:187], v[128:131], v[168:171]
    ds_read_b64_tr_b16 v[216:217], v53 offset:0
    ds_read_b64_tr_b16 v[218:219], v55 offset:2560
    v_mfma_f32_16x16x32_bf16 v[156:159], v[188:191], v[124:127], v[156:159]
    ds_read_b64_tr_b16 v[220:221], v54 offset:0
    ds_read_b64_tr_b16 v[222:223], v52 offset:2560
    v_mfma_f32_16x16x32_bf16 v[172:175], v[188:191], v[128:131], v[172:175]
    ds_read_b64_tr_b16 v[224:225], v55 offset:0
    ds_read_b64_tr_b16 v[226:227], v53 offset:2560
    v_mfma_f32_16x16x32_bf16 v[160:163], v[192:195], v[124:127], v[160:163]
    buffer_load_dwordx4 v[116:119], v25, s[20:23], s67 offen offset:0 sc1
    buffer_load_dwordx4 v[120:123], v26, s[20:23], s67 offen offset:0 sc1
    v_mfma_f32_16x16x32_bf16 v[176:179], v[192:195], v[128:131], v[176:179]
    s_waitcnt vmcnt(8) lgkmcnt(8)
    v_mfma_f32_16x16x32_bf16 v[148:151], v[196:199], v[132:135], v[148:151]
    v_mad_u32_u24 v52, s77, 5, v24
    v_xor_b32 v54, 64, v52
    v_mfma_f32_16x16x32_bf16 v[164:167], v[196:199], v[136:139], v[164:167]
    v_xor_b32 v53, 32, v52
    v_xor_b32 v55, 96, v52
    v_mfma_f32_16x16x32_bf16 v[152:155], v[200:203], v[132:135], v[152:155]
    ds_read_b64_tr_b16 v[180:181], v52 offset:0
    ds_read_b64_tr_b16 v[182:183], v54 offset:2560
    v_mfma_f32_16x16x32_bf16 v[168:171], v[200:203], v[136:139], v[168:171]
    ds_read_b64_tr_b16 v[184:185], v53 offset:0
    ds_read_b64_tr_b16 v[186:187], v55 offset:2560
    v_mfma_f32_16x16x32_bf16 v[156:159], v[204:207], v[132:135], v[156:159]
    ds_read_b64_tr_b16 v[188:189], v54 offset:0
    ds_read_b64_tr_b16 v[190:191], v52 offset:2560
    v_mfma_f32_16x16x32_bf16 v[172:175], v[204:207], v[136:139], v[172:175]
    ds_read_b64_tr_b16 v[192:193], v55 offset:0
    ds_read_b64_tr_b16 v[194:195], v53 offset:2560
    v_mfma_f32_16x16x32_bf16 v[160:163], v[208:211], v[132:135], v[160:163]
    buffer_load_dwordx4 v[124:127], v25, s[20:23], s67 offen offset:1024 sc1
    buffer_load_dwordx4 v[128:131], v26, s[20:23], s67 offen offset:1024 sc1
    v_mfma_f32_16x16x32_bf16 v[176:179], v[208:211], v[136:139], v[176:179]
    s_waitcnt vmcnt(8) lgkmcnt(8)
    v_mfma_f32_16x16x32_bf16 v[148:151], v[212:215], v[140:143], v[148:151]
    v_mad_u32_u24 v52, s78, 5, v24
    v_xor_b32 v54, 64, v52
    v_xor_b32 v53, 32, v52
    v_mfma_f32_16x16x32_bf16 v[164:167], v[212:215], v[144:147], v[164:167]
    v_xor_b32 v55, 96, v52
    ds_read_b64_tr_b16 v[196:197], v52 offset:0
    ds_read_b64_tr_b16 v[198:199], v54 offset:2560
    v_mfma_f32_16x16x32_bf16 v[152:155], v[216:219], v[140:143], v[152:155]
    ds_read_b64_tr_b16 v[200:201], v53 offset:0
    ds_read_b64_tr_b16 v[202:203], v55 offset:2560
    ds_read_b64_tr_b16 v[204:205], v54 offset:0
    v_mfma_f32_16x16x32_bf16 v[168:171], v[216:219], v[144:147], v[168:171]
    ds_read_b64_tr_b16 v[206:207], v52 offset:2560
    ds_read_b64_tr_b16 v[208:209], v55 offset:0
    v_mfma_f32_16x16x32_bf16 v[156:159], v[220:223], v[140:143], v[156:159]
    ds_read_b64_tr_b16 v[210:211], v53 offset:2560
    s_cmp_eq_u32 s63, 0
    v_mfma_f32_16x16x32_bf16 v[172:175], v[220:223], v[144:147], v[172:175]
    s_cbranch_scc1 K_SP10
K_SPR10:
    s_ff1_i32_b32 s33, s63
    v_mfma_f32_16x16x32_bf16 v[160:163], v[224:227], v[140:143], v[160:163]
    s_bitset0_b32 s63, s33
    s_lshl_b32 s77, s33, 10
    v_mfma_f32_16x16x32_bf16 v[176:179], v[224:227], v[144:147], v[176:179]
    buffer_load_dwordx4 v[132:135], v25, s[20:23], s77 offen offset:0 sc1
    buffer_load_dwordx4 v[136:139], v26, s[20:23], s77 offen offset:0 sc1
    s_waitcnt vmcnt(8) lgkmcnt(8)
    v_mfma_f32_16x16x32_bf16 v[148:151], v[180:183], v[100:103], v[148:151]
    ds_read_b64_tr_b16 v[212:213], v56 offset:0
    ds_read_b64_tr_b16 v[214:215], v58 offset:2560
    v_mfma_f32_16x16x32_bf16 v[164:167], v[180:183], v[104:107], v[164:167]
    ds_read_b64_tr_b16 v[216:217], v57 offset:0
    ds_read_b64_tr_b16 v[218:219], v59 offset:2560
    v_mfma_f32_16x16x32_bf16 v[152:155], v[184:187], v[100:103], v[152:155]
    ds_read_b64_tr_b16 v[220:221], v58 offset:0
    ds_read_b64_tr_b16 v[222:223], v56 offset:2560
    v_mfma_f32_16x16x32_bf16 v[168:171], v[184:187], v[104:107], v[168:171]
    ds_read_b64_tr_b16 v[224:225], v59 offset:0
    ds_read_b64_tr_b16 v[226:227], v57 offset:2560
    v_mfma_f32_16x16x32_bf16 v[156:159], v[188:191], v[100:103], v[156:159]
    s_cmp_eq_u32 s63, 0
    s_cbranch_scc1 K_SP11
K_SPR11:
    v_mfma_f32_16x16x32_bf16 v[172:175], v[188:191], v[104:107], v[172:175]
    s_ff1_i32_b32 s33, s63
    s_bitset0_b32 s63, s33
    v_mfma_f32_16x16x32_bf16 v[160:163], v[192:195], v[100:103], v[160:163]
    s_lshl_b32 s78, s33, 10
    buffer_load_dwordx4 v[140:143], v25, s[20:23], s78 offen offset:0 sc1
    v_mfma_f32_16x16x32_bf16 v[176:179], v[192:195], v[104:107], v[176:179]
    buffer_load_dwordx4 v[144:147], v26, s[20:23], s78 offen offset:0 sc1
    s_waitcnt vmcnt(8) lgkmcnt(8)
    v_mfma_f32_16x16x32_bf16 v[148:151], v[196:199], v[108:111], v[148:151]
    ds_read_b64_tr_b16 v[180:181], v56 offset:20480
    ds_read_b64_tr_b16 v[182:183], v58 offset:23040
    v_mfma_f32_16x16x32_bf16 v[164:167], v[196:199], v[112:115], v[164:167]
    ds_read_b64_tr_b16 v[184:185], v57 offset:20480
    ds_read_b64_tr_b16 v[186:187], v59 offset:23040
    v_mfma_f32_16x16x32_bf16 v[152:155], v[200:203], v[108:111], v[152:155]
    ds_read_b64_tr_b16 v[188:189], v58 offset:20480
    ds_read_b64_tr_b16 v[190:191], v56 offset:23040
    v_mfma_f32_16x16x32_bf16 v[168:171], v[200:203], v[112:115], v[168:171]
    ds_read_b64_tr_b16 v[192:193], v59 offset:20480
    ds_read_b64_tr_b16 v[194:195], v57 offset:23040
    v_mfma_f32_16x16x32_bf16 v[156:159], v[204:207], v[108:111], v[156:159]
    s_cmp_eq_u32 s63, 0
    s_cbranch_scc1 K_SP12
K_SPR12:
    v_mfma_f32_16x16x32_bf16 v[172:175], v[204:207], v[112:115], v[172:175]
    s_ff1_i32_b32 s33, s63
    s_bitset0_b32 s63, s33
    v_mfma_f32_16x16x32_bf16 v[160:163], v[208:211], v[108:111], v[160:163]
    s_lshl_b32 s75, s33, 10
    buffer_load_dwordx4 v[100:103], v25, s[20:23], s75 offen offset:0 sc1
    v_mfma_f32_16x16x32_bf16 v[176:179], v[208:211], v[112:115], v[176:179]
    buffer_load_dwordx4 v[104:107], v26, s[20:23], s75 offen offset:0 sc1
    s_mov_b32 s3, 1048576
K_P2_GW:
    ds_read_b32 v2, v12 offset:44
    s_sub_u32 s3, s3, 1
    s_waitcnt lgkmcnt(0)
    v_readfirstlane_b32 s33, v2
    s_nop 3
    s_cselect_b32 s33, 4, s33
    s_cmp_lt_u32 s33, 4
    s_cbranch_scc1 K_P2_GW
    v_readfirstlane_b32 s56, v16
    v_readfirstlane_b32 s57, v17
    s_lshl_b32 s58, s53, 4
    s_waitcnt vmcnt(8)
    v_mfma_f32_16x16x32_bf16 v[148:151], v[212:215], v[116:119], v[148:151]
    v_mad_u32_u24 v52, s77, 5, v24
    v_xor_b32 v54, 64, v52
    v_xor_b32 v53, 32, v52
    v_mfma_f32_16x16x32_bf16 v[164:167], v[212:215], v[120:123], v[164:167]
    v_xor_b32 v55, 96, v52
    ds_read_b64_tr_b16 v[196:197], v52 offset:0
    ds_read_b64_tr_b16 v[198:199], v54 offset:2560
    v_mfma_f32_16x16x32_bf16 v[152:155], v[216:219], v[116:119], v[152:155]
    ds_read_b64_tr_b16 v[200:201], v53 offset:0
    ds_read_b64_tr_b16 v[202:203], v55 offset:2560
    ds_read_b64_tr_b16 v[204:205], v54 offset:0
    v_mfma_f32_16x16x32_bf16 v[168:171], v[216:219], v[120:123], v[168:171]
    ds_read_b64_tr_b16 v[206:207], v52 offset:2560
    ds_read_b64_tr_b16 v[208:209], v55 offset:0
    v_mfma_f32_16x16x32_bf16 v[156:159], v[220:223], v[116:119], v[156:159]
    ds_read_b64_tr_b16 v[210:211], v53 offset:2560
    s_cmp_eq_u32 s63, 0
    v_mfma_f32_16x16x32_bf16 v[172:175], v[220:223], v[120:123], v[172:175]
    s_cbranch_scc1 K_SP13
K_SPR13:
    s_ff1_i32_b32 s33, s63
    v_mfma_f32_16x16x32_bf16 v[160:163], v[224:227], v[116:119], v[160:163]
    s_bitset0_b32 s63, s33
    s_lshl_b32 s76, s33, 10
    v_mfma_f32_16x16x32_bf16 v[176:179], v[224:227], v[120:123], v[176:179]
    buffer_load_dwordx4 v[108:111], v25, s[20:23], s76 offen offset:0 sc1
    buffer_load_dwordx4 v[112:115], v26, s[20:23], s76 offen offset:0 sc1
    s_waitcnt vmcnt(8)
    v_mfma_f32_16x16x32_bf16 v[148:151], v[180:183], v[124:127], v[148:151]
    v_mad_u32_u24 v52, s78, 5, v24
    v_xor_b32 v54, 64, v52
    v_xor_b32 v53, 32, v52
    v_mfma_f32_16x16x32_bf16 v[164:167], v[180:183], v[128:131], v[164:167]
    v_xor_b32 v55, 96, v52
    ds_read_b64_tr_b16 v[212:213], v52 offset:0
    ds_read_b64_tr_b16 v[214:215], v54 offset:2560
    v_mfma_f32_16x16x32_bf16 v[152:155], v[184:187], v[124:127], v[152:155]
    ds_read_b64_tr_b16 v[216:217], v53 offset:0
    ds_read_b64_tr_b16 v[218:219], v55 offset:2560
    ds_read_b64_tr_b16 v[220:221], v54 offset:0
    v_mfma_f32_16x16x32_bf16 v[168:171], v[184:187], v[128:131], v[168:171]
    ds_read_b64_tr_b16 v[222:223], v52 offset:2560
    ds_read_b64_tr_b16 v[224:225], v55 offset:0
    v_mfma_f32_16x16x32_bf16 v[156:159], v[188:191], v[124:127], v[156:159]
    ds_read_b64_tr_b16 v[226:227], v53 offset:2560
    s_cmp_eq_u32 s63, 0
    v_mfma_f32_16x16x32_bf16 v[172:175], v[188:191], v[128:131], v[172:175]
    s_cbranch_scc1 K_SP14
K_SPR14:
    s_ff1_i32_b32 s33, s63
    v_mfma_f32_16x16x32_bf16 v[160:163], v[192:195], v[124:127], v[160:163]
    s_bitset0_b32 s63, s33
    s_lshl_b32 s77, s33, 10
    v_mfma_f32_16x16x32_bf16 v[176:179], v[192:195], v[128:131], v[176:179]
    buffer_load_dwordx4 v[116:119], v25, s[20:23], s77 offen offset:0 sc1
    buffer_load_dwordx4 v[120:123], v26, s[20:23], s77 offen offset:0 sc1
    s_waitcnt vmcnt(8) lgkmcnt(8)
    v_mfma_f32_16x16x32_bf16 v[148:151], v[196:199], v[132:135], v[148:151]
    v_mad_u32_u24 v52, s75, 5, v24
    v_xor_b32 v54, 64, v52
    v_xor_b32 v53, 32, v52
    v_mfma_f32_16x16x32_bf16 v[164:167], v[196:199], v[136:139], v[164:167]
    v_xor_b32 v55, 96, v52
    ds_read_b64_tr_b16 v[180:181], v52 offset:0
    ds_read_b64_tr_b16 v[182:183], v54 offset:2560
    v_mfma_f32_16x16x32_bf16 v[152:155], v[200:203], v[132:135], v[152:155]
    ds_read_b64_tr_b16 v[184:185], v53 offset:0
    ds_read_b64_tr_b16 v[186:187], v55 offset:2560
    ds_read_b64_tr_b16 v[188:189], v54 offset:0
    v_mfma_f32_16x16x32_bf16 v[168:171], v[200:203], v[136:139], v[168:171]
    ds_read_b64_tr_b16 v[190:191], v52 offset:2560
    ds_read_b64_tr_b16 v[192:193], v55 offset:0
    v_mfma_f32_16x16x32_bf16 v[156:159], v[204:207], v[132:135], v[156:159]
    ds_read_b64_tr_b16 v[194:195], v53 offset:2560
    s_cmp_eq_u32 s63, 0
    v_mfma_f32_16x16x32_bf16 v[172:175], v[204:207], v[136:139], v[172:175]
    s_cbranch_scc1 K_SP15
K_SPR15:
    s_ff1_i32_b32 s33, s63
    v_mfma_f32_16x16x32_bf16 v[160:163], v[208:211], v[132:135], v[160:163]
    s_bitset0_b32 s63, s33
    s_lshl_b32 s78, s33, 10
    v_mfma_f32_16x16x32_bf16 v[176:179], v[208:211], v[136:139], v[176:179]
    buffer_load_dwordx4 v[124:127], v25, s[20:23], s78 offen offset:0 sc1
    buffer_load_dwordx4 v[128:131], v26, s[20:23], s78 offen offset:0 sc1
    s_waitcnt vmcnt(8) lgkmcnt(8)
    v_mfma_f32_16x16x32_bf16 v[148:151], v[212:215], v[140:143], v[148:151]
    v_mad_u32_u24 v52, s76, 5, v24
    v_xor_b32 v54, 64, v52
    v_xor_b32 v53, 32, v52
    v_mfma_f32_16x16x32_bf16 v[164:167], v[212:215], v[144:147], v[164:167]
    v_xor_b32 v55, 96, v52
    ds_read_b64_tr_b16 v[196:197], v52 offset:0
    ds_read_b64_tr_b16 v[198:199], v54 offset:2560
    v_mfma_f32_16x16x32_bf16 v[152:155], v[216:219], v[140:143], v[152:155]
    ds_read_b64_tr_b16 v[200:201], v53 offset:0
    ds_read_b64_tr_b16 v[202:203], v55 offset:2560
    ds_read_b64_tr_b16 v[204:205], v54 offset:0
    v_mfma_f32_16x16x32_bf16 v[168:171], v[216:219], v[144:147], v[168:171]
    ds_read_b64_tr_b16 v[206:207], v52 offset:2560
    ds_read_b64_tr_b16 v[208:209], v55 offset:0
    v_mfma_f32_16x16x32_bf16 v[156:159], v[220:223], v[140:143], v[156:159]
    ds_read_b64_tr_b16 v[210:211], v53 offset:2560
    s_cmp_eq_u32 s63, 0
    v_mfma_f32_16x16x32_bf16 v[172:175], v[220:223], v[144:147], v[172:175]
    s_cbranch_scc1 K_SP16
K_SPR16:
    s_ff1_i32_b32 s33, s63
    v_mfma_f32_16x16x32_bf16 v[160:163], v[224:227], v[140:143], v[160:163]
    s_bitset0_b32 s63, s33
    s_lshl_b32 s75, s33, 10
    v_mfma_f32_16x16x32_bf16 v[176:179], v[224:227], v[144:147], v[176:179]
    buffer_load_dwordx4 v[132:135], v25, s[20:23], s75 offen offset:0 sc1
    buffer_load_dwordx4 v[136:139], v26, s[20:23], s75 offen offset:0 sc1
    s_waitcnt vmcnt(8) lgkmcnt(8)
    v_mfma_f32_16x16x32_bf16 v[148:151], v[180:183], v[100:103], v[148:151]
    v_mad_u32_u24 v52, s77, 5, v24
    v_xor_b32 v54, 64, v52
    v_xor_b32 v53, 32, v52
    v_mfma_f32_16x16x32_bf16 v[164:167], v[180:183], v[104:107], v[164:167]
    v_xor_b32 v55, 96, v52
    ds_read_b64_tr_b16 v[212:213], v52 offset:0
    ds_read_b64_tr_b16 v[214:215], v54 offset:2560
    v_mfma_f32_16x16x32_bf16 v[152:155], v[184:187], v[100:103], v[152:155]
    ds_read_b64_tr_b16 v[216:217], v53 offset:0
    ds_read_b64_tr_b16 v[218:219], v55 offset:2560
    ds_read_b64_tr_b16 v[220:221], v54 offset:0
    v_mfma_f32_16x16x32_bf16 v[168:171], v[184:187], v[104:107], v[168:171]
    ds_read_b64_tr_b16 v[222:223], v52 offset:2560
    ds_read_b64_tr_b16 v[224:225], v55 offset:0
    v_mfma_f32_16x16x32_bf16 v[156:159], v[188:191], v[100:103], v[156:159]
    ds_read_b64_tr_b16 v[226:227], v53 offset:2560
    s_cmp_eq_u32 s63, 0
    v_mfma_f32_16x16x32_bf16 v[172:175], v[188:191], v[104:107], v[172:175]
    s_cbranch_scc1 K_SP17
K_SPR17:
    s_ff1_i32_b32 s33, s63
    v_mfma_f32_16x16x32_bf16 v[160:163], v[192:195], v[100:103], v[160:163]
    s_bitset0_b32 s63, s33
    s_lshl_b32 s76, s33, 10
    v_mfma_f32_16x16x32_bf16 v[176:179], v[192:195], v[104:107], v[176:179]
    buffer_load_dwordx4 v[140:143], v25, s[20:23], s76 offen offset:0 sc1
    buffer_load_dwordx4 v[144:147], v26, s[20:23], s76 offen offset:0 sc1
    s_waitcnt vmcnt(8) lgkmcnt(8)
    v_mfma_f32_16x16x32_bf16 v[148:151], v[196:199], v[108:111], v[148:151]
    v_mad_u32_u24 v52, s78, 5, v24
    v_xor_b32 v54, 64, v52
    v_mfma_f32_16x16x32_bf16 v[164:167], v[196:199], v[112:115], v[164:167]
    v_xor_b32 v53, 32, v52
    v_xor_b32 v55, 96, v52
    v_mfma_f32_16x16x32_bf16 v[152:155], v[200:203], v[108:111], v[152:155]
    ds_read_b64_tr_b16 v[180:181], v52 offset:0
    ds_read_b64_tr_b16 v[182:183], v54 offset:2560
    v_mfma_f32_16x16x32_bf16 v[168:171], v[200:203], v[112:115], v[168:171]
    ds_read_b64_tr_b16 v[184:185], v53 offset:0
    ds_read_b64_tr_b16 v[186:187], v55 offset:2560
    v_mfma_f32_16x16x32_bf16 v[156:159], v[204:207], v[108:111], v[156:159]
    ds_read_b64_tr_b16 v[188:189], v54 offset:0
    ds_read_b64_tr_b16 v[190:191], v52 offset:2560
    v_mfma_f32_16x16x32_bf16 v[172:175], v[204:207], v[112:115], v[172:175]
    ds_read_b64_tr_b16 v[192:193], v55 offset:0
    ds_read_b64_tr_b16 v[194:195], v53 offset:2560
    v_mfma_f32_16x16x32_bf16 v[160:163], v[208:211], v[108:111], v[160:163]
    buffer_load_dwordx4 v[100:103], v25, s[20:23], s67 offen offset:2048 sc1
    buffer_load_dwordx4 v[104:107], v26, s[20:23], s67 offen offset:2048 sc1
    v_mfma_f32_16x16x32_bf16 v[176:179], v[208:211], v[112:115], v[176:179]
    s_waitcnt vmcnt(8) lgkmcnt(8)
    v_mfma_f32_16x16x32_bf16 v[148:151], v[212:215], v[116:119], v[148:151]
    v_mad_u32_u24 v52, s75, 5, v24
    v_xor_b32 v54, 64, v52
    v_mfma_f32_16x16x32_bf16 v[164:167], v[212:215], v[120:123], v[164:167]
    v_xor_b32 v53, 32, v52
    v_xor_b32 v55, 96, v52
    v_mfma_f32_16x16x32_bf16 v[152:155], v[216:219], v[116:119], v[152:155]
    ds_read_b64_tr_b16 v[196:197], v52 offset:0
    ds_read_b64_tr_b16 v[198:199], v54 offset:2560
    v_mfma_f32_16x16x32_bf16 v[168:171], v[216:219], v[120:123], v[168:171]
    ds_read_b64_tr_b16 v[200:201], v53 offset:0
    ds_read_b64_tr_b16 v[202:203], v55 offset:2560
    v_mfma_f32_16x16x32_bf16 v[156:159], v[220:223], v[116:119], v[156:159]
    ds_read_b64_tr_b16 v[204:205], v54 offset:0
    ds_read_b64_tr_b16 v[206:207], v52 offset:2560
    v_mfma_f32_16x16x32_bf16 v[172:175], v[220:223], v[120:123], v[172:175]
    ds_read_b64_tr_b16 v[208:209], v55 offset:0
    ds_read_b64_tr_b16 v[210:211], v53 offset:2560
    v_mfma_f32_16x16x32_bf16 v[160:163], v[224:227], v[116:119], v[160:163]
    buffer_load_dwordx4 v[108:111], v25, s[20:23], s67 offen offset:3072 sc1
    buffer_load_dwordx4 v[112:115], v26, s[20:23], s67 offen offset:3072 sc1
    v_mfma_f32_16x16x32_bf16 v[176:179], v[224:227], v[120:123], v[176:179]
    s_waitcnt vmcnt(8) lgkmcnt(8)
    v_mfma_f32_16x16x32_bf16 v[148:151], v[180:183], v[124:127], v[148:151]
    v_mad_u32_u24 v52, s76, 5, v24
    v_xor_b32 v54, 64, v52
    v_mfma_f32_16x16x32_bf16 v[164:167], v[180:183], v[128:131], v[164:167]
    v_xor_b32 v53, 32, v52
    v_xor_b32 v55, 96, v52
    v_mfma_f32_16x16x32_bf16 v[152:155], v[184:187], v[124:127], v[152:155]
    ds_read_b64_tr_b16 v[212:213], v52 offset:0
    ds_read_b64_tr_b16 v[214:215], v54 offset:2560
    v_mfma_f32_16x16x32_bf16 v[168:171], v[184:187], v[128:131], v[168:171]
    ds_read_b64_tr_b16 v[216:217], v53 offset:0
    ds_read_b64_tr_b16 v[218:219], v55 offset:2560
    v_mfma_f32_16x16x32_bf16 v[156:159], v[188:191], v[124:127], v[156:159]
    ds_read_b64_tr_b16 v[220:221], v54 offset:0
    ds_read_b64_tr_b16 v[222:223], v52 offset:2560
    v_mfma_f32_16x16x32_bf16 v[172:175], v[188:191], v[128:131], v[172:175]
    ds_read_b64_tr_b16 v[224:225], v55 offset:0
    ds_read_b64_tr_b16 v[226:227], v53 offset:2560
    v_mfma_f32_16x16x32_bf16 v[160:163], v[192:195], v[124:127], v[160:163]
    v_mfma_f32_16x16x32_bf16 v[176:179], v[192:195], v[128:131], v[176:179]
    s_waitcnt vmcnt(6) lgkmcnt(8)
    v_mfma_f32_16x16x32_bf16 v[148:151], v[196:199], v[132:135], v[148:151]
    ds_read_b64_tr_b16 v[180:181], v56 offset:40960
    ds_read_b64_tr_b16 v[182:183], v58 offset:43520
    v_mfma_f32_16x16x32_bf16 v[164:167], v[196:199], v[136:139], v[164:167]
    ds_read_b64_tr_b16 v[184:185], v57 offset:40960
    ds_read_b64_tr_b16 v[186:187], v59 offset:43520
    v_mfma_f32_16x16x32_bf16 v[152:155], v[200:203], v[132:135], v[152:155]
    ds_read_b64_tr_b16 v[188:189], v58 offset:40960
    ds_read_b64_tr_b16 v[190:191], v56 offset:43520
    v_mfma_f32_16x16x32_bf16 v[168:171], v[200:203], v[136:139], v[168:171]
    ds_read_b64_tr_b16 v[192:193], v59 offset:40960
    ds_read_b64_tr_b16 v[194:195], v57 offset:43520
    v_mfma_f32_16x16x32_bf16 v[156:159], v[204:207], v[132:135], v[156:159]
    v_mfma_f32_16x16x32_bf16 v[172:175], v[204:207], v[136:139], v[172:175]
    v_mfma_f32_16x16x32_bf16 v[160:163], v[208:211], v[132:135], v[160:163]
    v_mfma_f32_16x16x32_bf16 v[176:179], v[208:211], v[136:139], v[176:179]
    s_waitcnt vmcnt(4) lgkmcnt(8)
    v_mfma_f32_16x16x32_bf16 v[148:151], v[212:215], v[140:143], v[148:151]
    ds_read_b64_tr_b16 v[196:197], v56 offset:61440
    ds_read_b64_tr_b16 v[198:199], v58 offset:64000
    v_mfma_f32_16x16x32_bf16 v[164:167], v[212:215], v[144:147], v[164:167]
    ds_read_b64_tr_b16 v[200:201], v57 offset:61440
    ds_read_b64_tr_b16 v[202:203], v59 offset:64000
    v_mfma_f32_16x16x32_bf16 v[152:155], v[216:219], v[140:143], v[152:155]
    ds_read_b64_tr_b16 v[204:205], v58 offset:61440
    ds_read_b64_tr_b16 v[206:207], v56 offset:64000
    v_mfma_f32_16x16x32_bf16 v[168:171], v[216:219], v[144:147], v[168:171]
    ds_read_b64_tr_b16 v[208:209], v59 offset:61440
    ds_read_b64_tr_b16 v[210:211], v57 offset:64000
    v_mfma_f32_16x16x32_bf16 v[156:159], v[220:223], v[140:143], v[156:159]
    v_mfma_f32_16x16x32_bf16 v[172:175], v[220:223], v[144:147], v[172:175]
    v_mfma_f32_16x16x32_bf16 v[160:163], v[224:227], v[140:143], v[160:163]
    v_mfma_f32_16x16x32_bf16 v[176:179], v[224:227], v[144:147], v[176:179]
    s_waitcnt vmcnt(2) lgkmcnt(8)
    v_mfma_f32_16x16x32_bf16 v[148:151], v[180:183], v[100:103], v[148:151]
    v_mfma_f32_16x16x32_bf16 v[152:155], v[184:187], v[100:103], v[152:155]
    v_mfma_f32_16x16x32_bf16 v[156:159], v[188:191], v[100:103], v[156:159]
    v_mfma_f32_16x16x32_bf16 v[160:163], v[192:195], v[100:103], v[160:163]
    s_sub_u32 s59, s56, s58
    s_cmp_lt_u32 s59, 32
    s_cbranch_scc1 K_YROW0
K_NOY0:
    s_sub_u32 s59, s57, s58
    s_cmp_lt_u32 s59, 32
    s_cbranch_scc1 K_YROW1
K_NOY1:
    s_waitcnt vmcnt(0) lgkmcnt(0)
    v_mfma_f32_16x16x32_bf16 v[148:151], v[196:199], v[108:111], v[148:151]
    v_mfma_f32_16x16x32_bf16 v[152:155], v[200:203], v[108:111], v[152:155]
    v_mfma_f32_16x16x32_bf16 v[156:159], v[204:207], v[108:111], v[156:159]
    v_mfma_f32_16x16x32_bf16 v[160:163], v[208:211], v[108:111], v[160:163]
    v_mfma_f32_16x16x32_bf16 v[164:167], v[180:183], v[104:107], v[164:167]
    v_mfma_f32_16x16x32_bf16 v[168:171], v[184:187], v[104:107], v[168:171]
    v_mfma_f32_16x16x32_bf16 v[172:175], v[188:191], v[104:107], v[172:175]
    s_nop 1
    v_fma_f32 v148, v148, v60, v68
    v_fma_f32 v149, v149, v60, v69
    v_fma_f32 v150, v150, v60, v70
    v_mfma_f32_16x16x32_bf16 v[176:179], v[192:195], v[104:107], v[176:179]
    v_fma_f32 v151, v151, v60, v71
    v_cvt_pk_bf16_f32 v36, v148, v149
    v_cvt_pk_bf16_f32 v37, v150, v151
    v_mfma_f32_16x16x32_bf16 v[164:167], v[196:199], v[112:115], v[164:167]
    v_fma_f32 v152, v152, v60, v72
    v_fma_f32 v153, v153, v60, v73
    ds_write_b64 v29, v[36:37] offset:0
    v_mfma_f32_16x16x32_bf16 v[168:171], v[200:203], v[112:115], v[168:171]
    v_fma_f32 v154, v154, v60, v74
    v_fma_f32 v155, v155, v60, v75
    v_cvt_pk_bf16_f32 v38, v152, v153
    v_mfma_f32_16x16x32_bf16 v[172:175], v[204:207], v[112:115], v[172:175]
    v_cvt_pk_bf16_f32 v39, v154, v155
    v_fma_f32 v156, v156, v60, v76
    v_fma_f32 v157, v157, v60, v77
    v_mfma_f32_16x16x32_bf16 v[176:179], v[208:211], v[112:115], v[176:179]
    ds_write_b64 v30, v[38:39] offset:0
    v_fma_f32 v158, v158, v60, v78
    v_fma_f32 v159, v159, v60, v79
    v_cvt_pk_bf16_f32 v40, v156, v157
    v_cvt_pk_bf16_f32 v41, v158, v159
    v_pk_fma_f32 v[160:161], v[160:161], v[60:61], v[80:81] op_sel_hi:[1,0,1]
    v_pk_fma_f32 v[162:163], v[162:163], v[60:61], v[82:83] op_sel_hi:[1,0,1]
    ds_write_b64 v31, v[40:41] offset:0
    v_cvt_pk_bf16_f32 v42, v160, v161
    v_cvt_pk_bf16_f32 v43, v162, v163
    ds_write_b64 v32, v[42:43] offset:0
    ds_read_b128 v[68:71], v33 offset:0
    ds_read_b128 v[72:75], v33 offset:1024
    v_pk_fma_f32 v[164:165], v[164:165], v[62:63], v[84:85] op_sel_hi:[1,0,1]
    v_pk_fma_f32 v[166:167], v[166:167], v[62:63], v[86:87] op_sel_hi:[1,0,1]
    v_cvt_pk_bf16_f32 v44, v164, v165
    v_cvt_pk_bf16_f32 v45, v166, v167
    v_pk_fma_f32 v[168:169], v[168:169], v[62:63], v[88:89] op_sel_hi:[1,0,1]
    v_pk_fma_f32 v[170:171], v[170:171], v[62:63], v[90:91] op_sel_hi:[1,0,1]
    v_cvt_pk_bf16_f32 v46, v168, v169
    v_cvt_pk_bf16_f32 v47, v170, v171
    v_pk_fma_f32 v[172:173], v[172:173], v[62:63], v[92:93] op_sel_hi:[1,0,1]
    v_pk_fma_f32 v[174:175], v[174:175], v[62:63], v[94:95] op_sel_hi:[1,0,1]
    v_cvt_pk_bf16_f32 v48, v172, v173
    v_cvt_pk_bf16_f32 v49, v174, v175
    v_pk_fma_f32 v[176:177], v[176:177], v[62:63], v[96:97] op_sel_hi:[1,0,1]
    v_pk_fma_f32 v[178:179], v[178:179], v[62:63], v[98:99] op_sel_hi:[1,0,1]
    v_cvt_pk_bf16_f32 v50, v176, v177
    v_cvt_pk_bf16_f32 v51, v178, v179
    s_waitcnt lgkmcnt(0)
    buffer_store_dwordx4 v[68:71], v27, s[48:51], s71 offen sc1
    buffer_store_dwordx4 v[72:75], v28, s[48:51], s72 offen sc1
    ds_write_b64 v29, v[44:45] offset:2048
    ds_write_b64 v30, v[46:47] offset:2048
    ds_write_b64 v31, v[48:49] offset:2048
    ds_write_b64 v32, v[50:51] offset:2048
    ds_read_b128 v[84:87], v33 offset:2048
    ds_read_b128 v[88:91], v33 offset:3072
    s_waitcnt lgkmcnt(1)
    buffer_store_dwordx4 v[84:87], v27, s[48:51], s73 offen sc1
    s_waitcnt lgkmcnt(0)
    buffer_store_dwordx4 v[88:91], v28, s[48:51], s74 offen sc1
K_END:
K_EXIT:
    s_endpgm
.p2align 12
WP_spin:
    s_setpc_b64 s[38:39]
K_SP0:
    ds_read_b32 v2, v12 offset:32
    s_waitcnt lgkmcnt(0)
    v_readfirstlane_b32 s33, v2
    s_nop 3
    s_lshr_b32 s63, s33, s64
    s_lshr_b32 s33, s33, s65
    s_and_b32 s63, s63, s33
    s_and_b32 s63, s63, 0xff
    s_andn2_b32 s63, s63, s66
    s_cbranch_scc0 K_SP0
    s_or_b32 s66, s66, s63
    s_branch K_SPR0
K_SP1:
    ds_read_b32 v2, v12 offset:32
    s_waitcnt lgkmcnt(0)
    v_readfirstlane_b32 s33, v2
    s_nop 3
    s_lshr_b32 s63, s33, s64
    s_lshr_b32 s33, s33, s65
    s_and_b32 s63, s63, s33
    s_and_b32 s63, s63, 0xff
    s_andn2_b32 s63, s63, s66
    s_cbranch_scc0 K_SP1
    s_or_b32 s66, s66, s63
    s_branch K_SPR1
K_SP2:
    ds_read_b32 v2, v12 offset:32
    s_waitcnt lgkmcnt(0)
    v_readfirstlane_b32 s33, v2
    s_nop 3
    s_lshr_b32 s63, s33, s64
    s_lshr_b32 s33, s33, s65
    s_and_b32 s63, s63, s33
    s_and_b32 s63, s63, 0xff
    s_andn2_b32 s63, s63, s66
    s_cbranch_scc0 K_SP2
    s_or_b32 s66, s66, s63
    s_branch K_SPR2
K_SP3:
    ds_read_b32 v2, v12 offset:32
    s_waitcnt lgkmcnt(0)
    v_readfirstlane_b32 s33, v2
    s_nop 3
    s_lshr_b32 s63, s33, s64
    s_lshr_b32 s33, s33, s65
    s_and_b32 s63, s63, s33
    s_and_b32 s63, s63, 0xff
    s_andn2_b32 s63, s63, s66
    s_cbranch_scc0 K_SP3
    s_or_b32 s66, s66, s63
    s_branch K_SPR3
K_SP4:
    ds_read_b32 v2, v12 offset:32
    s_waitcnt lgkmcnt(0)
    v_readfirstlane_b32 s33, v2
    s_nop 3
    s_lshr_b32 s63, s33, s64
    s_lshr_b32 s33, s33, s65
    s_and_b32 s63, s63, s33
    s_and_b32 s63, s63, 0xff
    s_andn2_b32 s63, s63, s66
    s_cbranch_scc0 K_SP4
    s_or_b32 s66, s66, s63
    s_branch K_SPR4
K_SP5:
    ds_read_b32 v2, v12 offset:32
    s_waitcnt lgkmcnt(0)
    v_readfirstlane_b32 s33, v2
    s_nop 3
    s_lshr_b32 s63, s33, s64
    s_lshr_b32 s33, s33, s65
    s_and_b32 s63, s63, s33
    s_and_b32 s63, s63, 0xff
    s_andn2_b32 s63, s63, s66
    s_cbranch_scc0 K_SP5
    s_or_b32 s66, s66, s63
    s_branch K_SPR5
K_SP6:
    ds_read_b32 v2, v12 offset:32
    s_waitcnt lgkmcnt(0)
    v_readfirstlane_b32 s33, v2
    s_nop 3
    s_lshr_b32 s63, s33, s64
    s_lshr_b32 s33, s33, s65
    s_and_b32 s63, s63, s33
    s_and_b32 s63, s63, 0xff
    s_andn2_b32 s63, s63, s66
    s_cbranch_scc0 K_SP6
    s_or_b32 s66, s66, s63
    s_branch K_SPR6
K_SP7:
    ds_read_b32 v2, v12 offset:32
    s_waitcnt lgkmcnt(0)
    v_readfirstlane_b32 s33, v2
    s_nop 3
    s_lshr_b32 s63, s33, s64
    s_lshr_b32 s33, s33, s65
    s_and_b32 s63, s63, s33
    s_and_b32 s63, s63, 0xff
    s_andn2_b32 s63, s63, s66
    s_cbranch_scc0 K_SP7
    s_or_b32 s66, s66, s63
    s_branch K_SPR7
K_SP10:
    ds_read_b32 v2, v12 offset:32
    s_waitcnt lgkmcnt(0)
    v_readfirstlane_b32 s33, v2
    s_nop 3
    s_lshr_b32 s63, s33, s64
    s_lshr_b32 s33, s33, s65
    s_and_b32 s63, s63, s33
    s_and_b32 s63, s63, 0xff00
    s_andn2_b32 s63, s63, s66
    s_cbranch_scc0 K_SP10
    s_or_b32 s66, s66, s63
    s_branch K_SPR10
K_SP11:
    ds_read_b32 v2, v12 offset:32
    s_waitcnt lgkmcnt(0)
    v_readfirstlane_b32 s33, v2
    s_nop 3
    s_lshr_b32 s63, s33, s64
    s_lshr_b32 s33, s33, s65
    s_and_b32 s63, s63, s33
    s_and_b32 s63, s63, 0xff00
    s_andn2_b32 s63, s63, s66
    s_cbranch_scc0 K_SP11
    s_or_b32 s66, s66, s63
    s_branch K_SPR11
K_SP12:
    ds_read_b32 v2, v12 offset:32
    s_waitcnt lgkmcnt(0)
    v_readfirstlane_b32 s33, v2
    s_nop 3
    s_lshr_b32 s63, s33, s64
    s_lshr_b32 s33, s33, s65
    s_and_b32 s63, s63, s33
    s_and_b32 s63, s63, 0xff00
    s_andn2_b32 s63, s63, s66
    s_cbranch_scc0 K_SP12
    s_or_b32 s66, s66, s63
    s_branch K_SPR12
K_SP13:
    ds_read_b32 v2, v12 offset:32
    s_waitcnt lgkmcnt(0)
    v_readfirstlane_b32 s33, v2
    s_nop 3
    s_lshr_b32 s63, s33, s64
    s_lshr_b32 s33, s33, s65
    s_and_b32 s63, s63, s33
    s_and_b32 s63, s63, 0xff00
    s_andn2_b32 s63, s63, s66
    s_cbranch_scc0 K_SP13
    s_or_b32 s66, s66, s63
    s_branch K_SPR13
K_SP14:
    ds_read_b32 v2, v12 offset:32
    s_waitcnt lgkmcnt(0)
    v_readfirstlane_b32 s33, v2
    s_nop 3
    s_lshr_b32 s63, s33, s64
    s_lshr_b32 s33, s33, s65
    s_and_b32 s63, s63, s33
    s_and_b32 s63, s63, 0xff00
    s_andn2_b32 s63, s63, s66
    s_cbranch_scc0 K_SP14
    s_or_b32 s66, s66, s63
    s_branch K_SPR14
K_SP15:
    ds_read_b32 v2, v12 offset:32
    s_waitcnt lgkmcnt(0)
    v_readfirstlane_b32 s33, v2
    s_nop 3
    s_lshr_b32 s63, s33, s64
    s_lshr_b32 s33, s33, s65
    s_and_b32 s63, s63, s33
    s_and_b32 s63, s63, 0xff00
    s_andn2_b32 s63, s63, s66
    s_cbranch_scc0 K_SP15
    s_or_b32 s66, s66, s63
    s_branch K_SPR15
K_SP16:
    ds_read_b32 v2, v12 offset:32
    s_waitcnt lgkmcnt(0)
    v_readfirstlane_b32 s33, v2
    s_nop 3
    s_lshr_b32 s63, s33, s64
    s_lshr_b32 s33, s33, s65
    s_and_b32 s63, s63, s33
    s_and_b32 s63, s63, 0xff00
    s_andn2_b32 s63, s63, s66
    s_cbranch_scc0 K_SP16
    s_or_b32 s66, s66, s63
    s_branch K_SPR16
K_SP17:
    ds_read_b32 v2, v12 offset:32
    s_waitcnt lgkmcnt(0)
    v_readfirstlane_b32 s33, v2
    s_nop 3
    s_lshr_b32 s63, s33, s64
    s_lshr_b32 s33, s33, s65
    s_and_b32 s63, s63, s33
    s_and_b32 s63, s63, 0xff00
    s_andn2_b32 s63, s63, s66
    s_cbranch_scc0 K_SP17
    s_or_b32 s66, s66, s63
    s_branch K_SPR17
WP_yr0:
    s_setpc_b64 s[38:39]
K_YROW0:
    v_lshlrev_b32 v5, 4, v9
    v_add_u32 v5, 158976, v5
    v_and_b32 v3, 15, v1
    s_and_b32 s33, s59, 15
    v_cmp_eq_u32 vcc, s33, v3
    s_mov_b32 s3, 1048576
K_P2_GY0:
    ds_read_b32 v2, v12 offset:64
    s_sub_u32 s3, s3, 1
    s_waitcnt lgkmcnt(0)
    v_readfirstlane_b32 s33, v2
    s_nop 3
    s_cselect_b32 s33, 1, s33
    s_cmp_lt_u32 s33, 1
    s_cbranch_scc1 K_P2_GY0
    s_mov_b64 exec, vcc
    s_cmp_ge_u32 s59, 16
    s_cbranch_scc1 K_YR1_0
    ds_read_b128 v[68:71], v5 offset:0
    ds_read_b128 v[72:75], v5 offset:64
    ds_read_b128 v[76:79], v5 offset:128
    ds_read_b128 v[80:83], v5 offset:192
    s_mov_b64 exec, -1
    s_branch K_NOY0
K_YR1_0:
    ds_read_b128 v[84:87], v5 offset:0
    ds_read_b128 v[88:91], v5 offset:64
    ds_read_b128 v[92:95], v5 offset:128
    ds_read_b128 v[96:99], v5 offset:192
    s_mov_b64 exec, -1
    s_branch K_NOY0
K_YROW1:
    v_lshlrev_b32 v5, 4, v9
    v_add_u32 v5, 159232, v5
    v_and_b32 v3, 15, v1
    s_and_b32 s33, s59, 15
    v_cmp_eq_u32 vcc, s33, v3
    s_mov_b32 s3, 1048576
K_P2_GY1:
    ds_read_b32 v2, v12 offset:68
    s_sub_u32 s3, s3, 1
    s_waitcnt lgkmcnt(0)
    v_readfirstlane_b32 s33, v2
    s_nop 3
    s_cselect_b32 s33, 1, s33
    s_cmp_lt_u32 s33, 1
    s_cbranch_scc1 K_P2_GY1
    s_mov_b64 exec, vcc
    s_cmp_ge_u32 s59, 16
    s_cbranch_scc1 K_YR1_1
    ds_read_b128 v[68:71], v5 offset:0
    ds_read_b128 v[72:75], v5 offset:64
    ds_read_b128 v[76:79], v5 offset:128
    ds_read_b128 v[80:83], v5 offset:192
    s_mov_b64 exec, -1
    s_branch K_NOY1
K_YR1_1:
    ds_read_b128 v[84:87], v5 offset:0
    ds_read_b128 v[88:91], v5 offset:64
    ds_read_b128 v[92:95], v5 offset:128
    ds_read_b128 v[96:99], v5 offset:192
    s_mov_b64 exec, -1
    s_branch K_NOY1
.p2align 12
WP_gen:
    s_setpc_b64 s[38:39]
K_P2:
    s_cmp_ge_u32 s30, 4
    s_cbranch_scc1 K_P2_HELP
    s_lshl_b32 s54, s40, 7
    v_lshrrev_b32 v9, 4, v1
    v_mov_b32 v12, 158720
    s_add_u32 s20, s10, 0x100000
    s_addc_u32 s21, s11, 0
    s_mov_b32 s22, 0x280000
    s_mov_b32 s23, 0x20000
    s_add_u32 s16, s10, 0x1000
    s_addc_u32 s17, s11, 0
    s_mov_b32 s18, 0x2000
    s_mov_b32 s19, 0x20000
    s_mov_b32 s48, s6
    s_mov_b32 s49, s7
    s_mov_b32 s50, 0x280000
    s_mov_b32 s51, 0x20000
    s_lshl_b32 s53, s40, 3
    s_lshl1_add_u32 s53, s30, s53
    s_mov_b32 s55, 20480
    v_bfe_u32 v20, v1, 2, 2
    v_and_b32 v21, 3, v1
    s_mul_i32 s3, s53, 20480
    v_lshl_add_u32 v25, v1, 4, s3
    v_add_u32 v26, 20480, v25
    v_and_b32 v2, 15, v1
    s_lshl_b32 s3, s53, 6
    v_lshl_add_u32 v23, v2, 2, s3
    v_lshl_add_u32 v2, v9, 2, v20
    v_bfe_u32 v3, v2, 1, 2
    v_lshlrev_b32 v2, 7, v2
    v_lshl_add_u32 v2, v21, 3, v2
    v_lshl_add_u32 v24, v3, 5, v2
    v_lshrrev_b32 v3, 1, v20
    v_mul_u32_u24 v2, 40, v9
    v_add3_u32 v2, v2, 16, v20
    v_lshlrev_b32 v2, 7, v2
    v_lshl_add_u32 v2, v21, 3, v2
    v_xor_b32 v4, 0, v3
    v_lshl_add_u32 v56, v4, 5, v2
    v_xor_b32 v4, 1, v3
    v_lshl_add_u32 v57, v4, 5, v2
    v_xor_b32 v4, 2, v3
    v_lshl_add_u32 v58, v4, 5, v2
    v_xor_b32 v4, 3, v3
    v_lshl_add_u32 v59, v4, 5, v2
    v_lshrrev_b32 v3, 4, v1
    v_and_b32 v4, 7, v1
    v_lshrrev_b32 v2, 3, v1
    v_xor_b32 v4, v4, v3
    v_mul_u32_u24 v2, 1280, v2
    v_lshl_add_u32 v27, v4, 4, v2
    v_xor_b32 v28, 64, v27
    s_lshl_b32 s71, s40, 3
    s_lshl1_add_u32 s71, s30, s71
    s_mul_i32 s71, s71, 20480
    s_lshl_b32 s33, s41, 7
    s_add_u32 s71, s71, s33
    s_add_u32 s72, s71, 10240
    s_add_u32 s73, s71, 20480
    s_add_u32 s74, s71, 30720
    s_lshl_b32 s3, s30, 12
    s_add_u32 s3, s3, 140288
    v_lshl_add_u32 v33, v1, 4, s3
    v_and_b32 v2, 15, v1
    v_lshrrev_b32 v3, 1, v2
    v_lshrrev_b32 v4, 5, v1
    v_xor_b32 v3, v3, v4
    v_lshlrev_b32 v3, 4, v3
    v_lshl_add_u32 v3, v2, 7, v3
    v_and_b32 v4, 1, v9
    v_lshl_add_u32 v3, v4, 3, v3
    v_add_u32 v29, s3, v3
    v_xor_b32 v30, 32, v29
    v_xor_b32 v31, 64, v29
    v_xor_b32 v32, 96, v29
    s_and_b32 s33, s40, 3
    s_lshl_b32 s33, s33, 3
    s_lshr_b32 s33, 0x7f06037f, s33
    s_and_b32 s33, s33, 0xff
    s_lshl_b32 s3, s30, 1
    s_cmp_ge_u32 s3, s33
    s_cselect_b32 s64, 16, 0
    s_add_u32 s3, s3, 1
    s_cmp_ge_u32 s3, s33
    s_cselect_b32 s65, 16, 0
    s_mov_b32 s63, 0
    s_mov_b32 s66, 0
    s_mov_b32 s67, 16384
    s_cmp_eq_u32 s30, 0
    s_cbranch_scc1 K_P2_AUXW
    v_lshrrev_b32 v2, 3, v1
    v_mul_u32_u24 v2, 1280, v2
    v_lshrrev_b32 v3, 4, v1
    v_lshlrev_b32 v3, 1, v3
    v_and_b32 v4, 7, v1
    v_xor_b32 v3, v3, v4
    v_lshl_add_u32 v2, v3, 4, v2
    s_lshl_b32 s33, s41, 7
    v_add_u32 v22, s33, v2
    s_mov_b32 s60, 0xfda87520
    s_mov_b32 s61, 0xecb96431
    s_sub_u32 s58, s30, 1
K_P2_WS:
    s_lshl_b32 s3, s58, 2
    s_lshr_b64 s[4:5], s[60:61], s3
    s_and_b32 s4, s4, 15
    s_mul_i32 s4, s4, 51200
    s_mul_i32 s59, s58, 5120
    s_add_u32 s52, s4, 0
    s_add_u32 m0, s59, 0
    s_waitcnt vmcnt(11)
    buffer_load_dwordx4 v22, s[24:27], s52 offen lds
    s_add_u32 s52, s4, 10240
    s_add_u32 m0, s59, 1024
    s_waitcnt vmcnt(11)
    buffer_load_dwordx4 v22, s[24:27], s52 offen lds
    s_add_u32 s52, s4, 20480
    s_add_u32 m0, s59, 2048
    s_waitcnt vmcnt(11)
    buffer_load_dwordx4 v22, s[24:27], s52 offen lds
    s_add_u32 s52, s4, 30720
    s_add_u32 m0, s59, 3072
    s_waitcnt vmcnt(11)
    buffer_load_dwordx4 v22, s[24:27], s52 offen lds
    s_add_u32 s52, s4, 40960
    s_add_u32 m0, s59, 4096
    s_waitcnt vmcnt(11)
    buffer_load_dwordx4 v22, s[24:27], s52 offen lds
    s_cmp_ge_u32 s58, 3
    s_cbranch_scc1 K_P2_WS1
    v_mov_b32 v3, 1
    s_waitcnt vmcnt(5)
    s_mov_b64 exec, 1
    ds_add_u32 v12, v3 offset:52
    s_mov_b64 exec, -1
K_P2_WS1:
    s_add_u32 s58, s58, 3
    s_cmp_lt_u32 s58, 16
    s_cbranch_scc1 K_P2_WS
K_P2_AUXW:
    s_lshl_b32 s33, s30, 12
    s_add_u32 m0, s33, 140288
    s_add_u32 s3, s71, 0
    buffer_load_dwordx4 v27, s[12:15], s3 offen lds
    s_add_u32 m0, s33, 141312
    s_add_u32 s3, s71, 10240
    buffer_load_dwordx4 v28, s[12:15], s3 offen lds
    s_add_u32 m0, s33, 142336
    s_add_u32 s3, s71, 20480
    buffer_load_dwordx4 v27, s[12:15], s3 offen lds
    s_add_u32 m0, s33, 143360
    s_add_u32 s3, s71, 30720
    buffer_load_dwordx4 v28, s[12:15], s3 offen lds
    v_mov_b32 v3, 1
    s_waitcnt vmcnt(0)
    s_mov_b64 exec, 1
    ds_add_u32 v12, v3 offset:44
    s_mov_b64 exec, -1
    s_mov_b32 s3, 1048576
K_P2_GWA:
    ds_read_b32 v2, v12 offset:44
    s_sub_u32 s3, s3, 1
    s_waitcnt lgkmcnt(0)
    v_readfirstlane_b32 s33, v2
    s_nop 3
    s_cselect_b32 s33, 4, s33
    s_cmp_lt_u32 s33, 4
    s_cbranch_scc1 K_P2_GWA
    s_branch K_P2_GEMM
WP_help:
    s_setpc_b64 s[38:39]
K_LATE:
    s_mov_b32 s3, 1048576
K_LG:
    ds_read_b32 v2, v4 offset:48
    s_sub_u32 s3, s3, 1
    s_waitcnt lgkmcnt(0)
    v_readfirstlane_b32 s33, v2
    s_nop 3
    s_cselect_b32 s33, 8, s33
    s_bitcmp0_b32 s33, 3
    s_cbranch_scc1 K_LG
    s_sub_u32 s44, s30, 4
K_WOL:
    s_lshl_b32 s50, s44, 2
    s_lshr_b32 s50, 0x6431, s50
    s_and_b32 s50, s50, 7
    s_mul_i32 s50, s50, 51200
    s_mul_i32 s51, s44, 5120
    s_add_u32 s3, s50, 0
    s_add_u32 m0, s51, 40960
    s_waitcnt vmcnt(13)
    buffer_load_dwordx4 v18, s[24:27], s3 offen lds
    s_add_u32 s3, s50, 10240
    s_add_u32 m0, s51, 41984
    s_waitcnt vmcnt(13)
    buffer_load_dwordx4 v18, s[24:27], s3 offen lds
    s_add_u32 s3, s50, 20480
    s_add_u32 m0, s51, 43008
    s_waitcnt vmcnt(13)
    buffer_load_dwordx4 v18, s[24:27], s3 offen lds
    s_add_u32 s3, s50, 30720
    s_add_u32 m0, s51, 44032
    s_waitcnt vmcnt(13)
    buffer_load_dwordx4 v18, s[24:27], s3 offen lds
    s_add_u32 s3, s50, 40960
    s_add_u32 m0, s51, 45056
    s_waitcnt vmcnt(13)
    buffer_load_dwordx4 v18, s[24:27], s3 offen lds
    s_add_u32 s3, s50, 409600
    s_add_u32 m0, s51, 61440
    s_waitcnt vmcnt(13)
    buffer_load_dwordx4 v18, s[24:27], s3 offen lds
    s_add_u32 s3, s50, 419840
    s_add_u32 m0, s51, 62464
    s_waitcnt vmcnt(13)
    buffer_load_dwordx4 v18, s[24:27], s3 offen lds
    s_add_u32 s3, s50, 430080
    s_add_u32 m0, s51, 63488
    s_waitcnt vmcnt(13)
    buffer_load_dwordx4 v18, s[24:27], s3 offen lds
    s_add_u32 s3, s50, 440320
    s_add_u32 m0, s51, 64512
    s_waitcnt vmcnt(13)
    buffer_load_dwordx4 v18, s[24:27], s3 offen lds
    s_add_u32 s3, s50, 450560
    s_add_u32 m0, s51, 65536
    s_waitcnt vmcnt(13)
    buffer_load_dwordx4 v18, s[24:27], s3 offen lds
    s_add_u32 s44, s44, 2
    s_cmp_lt_u32 s44, 4
    s_cbranch_scc1 K_WOL
    v_mov_b32 v2, 158720
    v_mov_b32 v3, 2
    s_waitcnt vmcnt(0)
    s_mov_b64 exec, 1
    ds_add_u32 v2, v3 offset:44
    s_mov_b64 exec, -1
K_P2_HELP:
    s_setprio 3
    s_add_u32 s59, s40, 1
    s_bitcmp1_b32 s59, 1
    s_cselect_b32 s59, 31, 15
    v_and_b32 v10, s59, v1
    v_lshl_add_u32 v10, v10, 2, s42
    s_cmp_lg_u32 s30, 7
    s_cbranch_scc1 K_P2_N7
    v_and_b32 v4, 7, v1
    v_lshlrev_b32 v4, 2, v4
    s_mov_b32 s3, 131072
K_ZPOLL1:
    v_cmp_eq_u32 vcc, 0, v7
    s_cbranch_vccz K_ZOK1
    s_sub_u32 s3, s3, 1
    s_cbranch_scc1 K_ZOK1
    global_load_dword v7, v4, s[8:9] offset:192 sc1
    s_waitcnt vmcnt(0)
    s_branch K_ZPOLL1
K_ZOK1:
    global_load_dword v7, v10, s[10:11] sc1
K_P2_N7:
    s_lshl_b32 s54, s40, 7
    v_lshrrev_b32 v9, 4, v1
    v_mov_b32 v12, 158720
    s_add_u32 s44, s10, 0x10000
    s_addc_u32 s45, s11, 0
    s_mov_b32 s46, 0x43800
    s_mov_b32 s47, 0x20000
    v_mov_b32 v80, 1
    s_cmp_eq_u32 s30, 7
    s_cbranch_scc1 K_P2_FLAGS
    s_cmp_lg_u32 s30, 6
    s_cbranch_scc1 K_END
    s_mov_b32 s3, 131072
K_P2_DPOLL:
    v_cmp_eq_u32 vcc, 0, v7
    s_cbranch_vccz K_P2_DOK
    s_cmp_eq_u32 s3, 131072
    s_cbranch_scc1 K_P2_DNS
    s_sleep 12
K_P2_DNS:
    v_and_b32 v11, 1, v1
    v_lshl_add_u32 v11, v11, 2, s42
    global_load_dword v7, v11, s[10:11] offset:128 sc1
    s_sub_u32 s3, s3, 1
    s_waitcnt vmcnt(0)
    s_cmp_lg_u32 s3, 0
    s_cbranch_scc1 K_P2_DPOLL
K_P2_DOK:
    v_readlane_b32 s58, v7, 0
    v_readlane_b32 s59, v7, 1
    s_nop 3
    s_and_b32 s3, s58, 0x7ff
    s_sub_u32 s3, 2047, s3
    v_mov_b32 v20, s3
    v_mov_b32 v4, s58
    v_and_b32 v4, 0xffff0000, v4
    v_ashrrev_i32 v5, 31, v4
    v_not_b32 v5, v5
    v_or_b32 v5, 0x80000000, v5
    v_xor_b32 v4, v4, v5
    v_and_b32 v4, 0xffff0000, v4
    v_mul_f32 v5, 0xbfb8aa3b, v4
    v_exp_f32 v5, v5
    s_nop 0
    v_add_f32 v5, 1.0, v5
    v_rcp_f32 v4, v5
    s_nop 0
    v_cvt_pk_bf16_f32 v22, v4, v4
    v_lshlrev_b32 v22, 16, v22
    s_and_b32 s3, s59, 0x7ff
    s_sub_u32 s3, 2047, s3
    v_mov_b32 v21, s3
    v_mov_b32 v4, s59
    v_and_b32 v4, 0xffff0000, v4
    v_ashrrev_i32 v5, 31, v4
    v_not_b32 v5, v5
    v_or_b32 v5, 0x80000000, v5
    v_xor_b32 v4, v4, v5
    v_and_b32 v4, 0xffff0000, v4
    v_mul_f32 v5, 0xbfb8aa3b, v4
    v_exp_f32 v5, v5
    s_nop 0
    v_add_f32 v5, 1.0, v5
    v_rcp_f32 v4, v5
    s_nop 0
    v_cvt_pk_bf16_f32 v23, v4, v4
    v_lshlrev_b32 v23, 16, v23
    ds_write_b128 v12, v[20:23]
    ds_write_b32 v12, v80 offset:40
    s_mov_b32 s53, 0
    v_mov_b32 v16, v20
    v_mov_b32 v17, v21
    v_mov_b32 v18, v22
    v_mov_b32 v19, v23
K_P2_HW:
    s_cmp_eq_u32 s53, 0
    s_cselect_b64 vcc, -1, 0
    s_nop 1
    v_cndmask_b32 v2, v17, v16, vcc
    v_cndmask_b32 v5, v19, v18, vcc
    s_nop 0
    v_readfirstlane_b32 s58, v2
    s_nop 3
    s_sub_u32 s3, s58, s54
    s_cmp_lt_u32 s3, 128
    s_cbranch_scc0 K_P2_YN
    s_call_b64 s[38:39], WP_yr0
    s_mul_i32 s3, s58, 1280
    s_lshl_b32 s33, s41, 7
    s_add_u32 s3, s3, s33
    v_and_b32 v2, 15, v1
    v_lshlrev_b32 v2, 3, v2
    buffer_load_dwordx2 v[84:85], v2, s[12:15], s3 offen
    s_lshl_b32 s3, s58, 2
    s_add_u32 s3, s3, 4096
    v_mov_b32 v2, s3
    global_load_dword v88, v2, s[10:11] sc1
    s_lshl1_add_u32 s3, s41, s53
    s_lshl_b32 s3, s3, 8
    s_add_u32 s3, s3, 568320
    v_min_u32 v3, 53, v1
    v_lshl_add_u32 v3, v3, 2, s3
    s_mov_b32 s3, 131072
K_P2_YPOLL:
    global_load_dword v2, v3, s[10:11] sc1
    s_sub_u32 s3, s3, 1
    s_waitcnt vmcnt(0)
    v_cmp_ne_u32 vcc, 1, v2
    s_cbranch_vccz K_P2_YGO
    s_sleep 16
    s_cmp_lg_u32 s3, 0
    s_cbranch_scc1 K_P2_YPOLL
K_P2_YGO:
    v_and_b32 v2, 15, v1
    v_lshlrev_b32 v2, 4, v2
    v_mul_u32_u24 v4, 5120, v9
    s_mov_b32 s59, s53
    s_mul_i32 s33, s59, 2560
    s_lshl_b32 s3, s41, 8
    s_add_u32 s3, s3, s33
    v_add3_u32 v3, v2, v4, s3
    s_mov_b32 s52, 0
    buffer_load_dwordx4 v[24:27], v3, s[44:47], s52 offen sc1
    s_mov_b32 s52, 20480
    buffer_load_dwordx4 v[28:31], v3, s[44:47], s52 offen sc1
    s_mov_b32 s52, 40960
    buffer_load_dwordx4 v[32:35], v3, s[44:47], s52 offen sc1
    s_mov_b32 s52, 61440
    buffer_load_dwordx4 v[36:39], v3, s[44:47], s52 offen sc1
    s_mov_b32 s52, 81920
    buffer_load_dwordx4 v[40:43], v3, s[44:47], s52 offen sc1
    s_mov_b32 s52, 102400
    buffer_load_dwordx4 v[44:47], v3, s[44:47], s52 offen sc1
    s_mov_b32 s52, 122880
    buffer_load_dwordx4 v[48:51], v3, s[44:47], s52 offen sc1
    s_mov_b32 s52, 143360
    buffer_load_dwordx4 v[52:55], v3, s[44:47], s52 offen sc1
    s_mov_b32 s52, 163840
    buffer_load_dwordx4 v[56:59], v3, s[44:47], s52 offen sc1
    s_mov_b32 s52, 184320
    buffer_load_dwordx4 v[60:63], v3, s[44:47], s52 offen sc1
    s_mov_b32 s52, 204800
    buffer_load_dwordx4 v[64:67], v3, s[44:47], s52 offen sc1
    s_mov_b32 s52, 225280
    buffer_load_dwordx4 v[68:71], v3, s[44:47], s52 offen sc1
    s_mov_b32 s52, 245760
    buffer_load_dwordx4 v[72:75], v3, s[44:47], s52 offen sc1
    s_mov_b32 s52, 266240
    buffer_load_dwordx4 v[76:79], v3, s[44:47], s52 offen sc1
    v_sub_f32 v88, 1.0, v88
    v_cvt_pk_bf16_f32 v88, v88, v88
    v_lshlrev_b32 v88, 16, v88
    v_lshlrev_b32 v86, 16, v85
    v_and_b32 v87, 0xffff0000, v85
    v_and_b32 v85, 0xffff0000, v84
    v_lshlrev_b32 v84, 16, v84
    s_waitcnt vmcnt(12)
    v_add_f32 v20, v24, v28
    v_add_f32 v21, v25, v29
    v_add_f32 v22, v26, v30
    v_add_f32 v23, v27, v31
    s_waitcnt vmcnt(11)
    v_add_f32 v20, v20, v32
    v_add_f32 v21, v21, v33
    v_add_f32 v22, v22, v34
    v_add_f32 v23, v23, v35
    s_waitcnt vmcnt(10)
    v_add_f32 v20, v20, v36
    v_add_f32 v21, v21, v37
    v_add_f32 v22, v22, v38
    v_add_f32 v23, v23, v39
    s_waitcnt vmcnt(9)
    v_add_f32 v20, v20, v40
    v_add_f32 v21, v21, v41
    v_add_f32 v22, v22, v42
    v_add_f32 v23, v23, v43
    s_waitcnt vmcnt(8)
    v_add_f32 v20, v20, v44
    v_add_f32 v21, v21, v45
    v_add_f32 v22, v22, v46
    v_add_f32 v23, v23, v47
    s_waitcnt vmcnt(7)
    v_add_f32 v20, v20, v48
    v_add_f32 v21, v21, v49
    v_add_f32 v22, v22, v50
    v_add_f32 v23, v23, v51
    s_waitcnt vmcnt(6)
    v_add_f32 v20, v20, v52
    v_add_f32 v21, v21, v53
    v_add_f32 v22, v22, v54
    v_add_f32 v23, v23, v55
    s_waitcnt vmcnt(5)
    v_add_f32 v20, v20, v56
    v_add_f32 v21, v21, v57
    v_add_f32 v22, v22, v58
    v_add_f32 v23, v23, v59
    s_waitcnt vmcnt(4)
    v_add_f32 v20, v20, v60
    v_add_f32 v21, v21, v61
    v_add_f32 v22, v22, v62
    v_add_f32 v23, v23, v63
    s_waitcnt vmcnt(3)
    v_add_f32 v20, v20, v64
    v_add_f32 v21, v21, v65
    v_add_f32 v22, v22, v66
    v_add_f32 v23, v23, v67
    s_waitcnt vmcnt(2)
    v_add_f32 v20, v20, v68
    v_add_f32 v21, v21, v69
    v_add_f32 v22, v22, v70
    v_add_f32 v23, v23, v71
    s_waitcnt vmcnt(1)
    v_add_f32 v20, v20, v72
    v_add_f32 v21, v21, v73
    v_add_f32 v22, v22, v74
    v_add_f32 v23, v23, v75
    s_waitcnt vmcnt(0)
    v_add_f32 v20, v20, v76
    v_add_f32 v21, v21, v77
    v_add_f32 v22, v22, v78
    v_add_f32 v23, v23, v79
    v_mov_b32 v24, v20
    v_mov_b32 v25, v21
    v_mov_b32 v26, v22
    v_mov_b32 v27, v23
    s_nop 0
    v_permlane16_swap_b32 v20, v24
    v_permlane16_swap_b32 v21, v25
    v_permlane16_swap_b32 v22, v26
    v_permlane16_swap_b32 v23, v27
    v_add_f32 v20, v20, v24
    v_add_f32 v21, v21, v25
    v_add_f32 v22, v22, v26
    v_add_f32 v23, v23, v27
    v_mov_b32 v24, v20
    v_mov_b32 v25, v21
    v_mov_b32 v26, v22
    v_mov_b32 v27, v23
    s_nop 0
    v_permlane32_swap_b32 v20, v24
    v_permlane32_swap_b32 v21, v25
    v_permlane32_swap_b32 v22, v26
    v_permlane32_swap_b32 v23, v27
    v_add_f32 v20, v20, v24
    v_add_f32 v21, v21, v25
    v_add_f32 v22, v22, v26
    v_add_f32 v23, v23, v27
    v_cvt_pk_bf16_f32 v20, v20, v20
    v_lshlrev_b32 v20, 16, v20
    v_mul_f32 v20, v5, v20
    v_cvt_pk_bf16_f32 v20, v20, v20
    v_lshlrev_b32 v20, 16, v20
    v_add_f32 v20, v20, v84
    v_cvt_pk_bf16_f32 v20, v20, v20
    v_lshlrev_b32 v20, 16, v20
    v_mul_f32 v20, v20, v88
    v_cvt_pk_bf16_f32 v21, v21, v21
    v_lshlrev_b32 v21, 16, v21
    v_mul_f32 v21, v5, v21
    v_cvt_pk_bf16_f32 v21, v21, v21
    v_lshlrev_b32 v21, 16, v21
    v_add_f32 v21, v21, v85
    v_cvt_pk_bf16_f32 v21, v21, v21
    v_lshlrev_b32 v21, 16, v21
    v_mul_f32 v21, v21, v88
    v_cvt_pk_bf16_f32 v22, v22, v22
    v_lshlrev_b32 v22, 16, v22
    v_mul_f32 v22, v5, v22
    v_cvt_pk_bf16_f32 v22, v22, v22
    v_lshlrev_b32 v22, 16, v22
    v_add_f32 v22, v22, v86
    v_cvt_pk_bf16_f32 v22, v22, v22
    v_lshlrev_b32 v22, 16, v22
    v_mul_f32 v22, v22, v88
    v_cvt_pk_bf16_f32 v23, v23, v23
    v_lshlrev_b32 v23, 16, v23
    v_mul_f32 v23, v5, v23
    v_cvt_pk_bf16_f32 v23, v23, v23
    v_lshlrev_b32 v23, 16, v23
    v_add_f32 v23, v23, v87
    v_cvt_pk_bf16_f32 v23, v23, v23
    v_lshlrev_b32 v23, 16, v23
    v_mul_f32 v23, v23, v88
    s_lshl_b32 s3, s59, 8
    s_add_u32 s3, s3, 158976
    v_add_u32 v2, s3, v2
    ds_write_b128 v2, v[20:23]
    s_lshl_b32 s3, s59, 2
    v_add_u32 v2, s3, v12
    ds_write_b32 v2, v80 offset:64
K_P2_YN:
    s_add_u32 s53, s53, 1
    s_cmp_lt_u32 s53, 2
    s_cbranch_scc1 K_P2_HW
    s_branch K_END
WP_flags:
    s_setpc_b64 s[38:39]
K_P2_FLAGS:
    s_mov_b32 exec_hi, 0
    s_waitcnt vmcnt(0)
    s_mov_b32 s3, 131072
K_P2_FCHK:
    v_cmp_eq_u32 vcc, 1, v7
    s_nop 1
    v_mov_b32 v2, vcc_lo
    ds_write_b32 v12, v2 offset:32
    s_cmp_eq_u32 vcc_lo, -1
    s_cbranch_scc1 K_P2_FGO
    s_cmp_lg_u32 vcc_lo, 0
    s_cbranch_scc1 K_P2_FS
    s_sleep 4
K_P2_FS:
    s_sleep 6
    global_load_dword v7, v10, s[10:11] sc1
    s_sub_u32 s3, s3, 1
    s_waitcnt vmcnt(0)
    s_cbranch_scc0 K_P2_FCHK
    v_mov_b32 v2, -1
    ds_write_b32 v12, v2 offset:32
K_P2_FGO:
    s_mov_b64 exec, -1
    s_branch K_END
.p2align 12
K_AUX:
    s_load_dwordx8 s[48:55], s[0:1], 32
    s_load_dwordx2 s[56:57], s[0:1], 64
    s_mul_i32 s44, s28, 7
    s_add_u32 s44, s44, s29
    s_sub_u32 s44, s44, 1
    s_cmp_lt_u32 s44, 54
    s_cselect_b32 s44, s44, 63
    s_cmp_eq_u32 s29, 0
    s_cselect_b32 s44, 63, s44
    s_lshl_b32 s74, s28, 8
    s_lshl_b32 s3, s29, 5
    s_add_u32 s74, s74, s3
    v_mov_b32 v12, 158720
    v_mov_b32 v13, 1
    s_cmp_lt_u32 s30, 4
    s_cbranch_scc1 K_AUX_LO
    s_lshl_b32 s3, s30, 3
    s_add_u32 s3, s3, s74
    s_sub_u32 s3, s3, 32
    v_lshrrev_b32 v9, 3, v1
    v_add_u32 v9, s3, v9
    v_and_b32 v11, 7, v1
    v_lshlrev_b32 v11, 4, v11
    v_mul_u32_u24 v10, 1280, v9
    v_add_u32 v10, v10, v11
    s_waitcnt lgkmcnt(0)
    buffer_load_dwordx4 v[16:19], v10, s[12:15], 0 offen offset:0
    buffer_load_dwordx4 v[20:23], v10, s[12:15], 0 offen offset:128
    buffer_load_dwordx4 v[24:27], v10, s[12:15], 0 offen offset:256
    buffer_load_dwordx4 v[28:31], v10, s[12:15], 0 offen offset:384
    buffer_load_dwordx4 v[32:35], v10, s[12:15], 0 offen offset:512
    buffer_load_dwordx4 v[36:39], v10, s[12:15], 0 offen offset:640
    buffer_load_dwordx4 v[40:43], v10, s[12:15], 0 offen offset:768
    buffer_load_dwordx4 v[44:47], v10, s[12:15], 0 offen offset:896
    buffer_load_dwordx4 v[48:51], v10, s[12:15], 0 offen offset:1024
    buffer_load_dwordx4 v[52:55], v10, s[12:15], 0 offen offset:1152
    s_mov_b32 s16, s48
    s_mov_b32 s17, s49
    s_mov_b32 s18, 0x500
    s_mov_b32 s19, 0x20000
    s_mov_b32 s20, s56
    s_mov_b32 s21, s57
    s_mov_b32 s22, 0x500
    s_mov_b32 s23, 0x20000
    buffer_load_dwordx4 v[56:59], v11, s[16:19], 0 offen offset:0
    buffer_load_dwordx4 v[60:63], v11, s[16:19], 0 offen offset:128
    buffer_load_dwordx4 v[64:67], v11, s[16:19], 0 offen offset:256
    buffer_load_dwordx4 v[68:71], v11, s[16:19], 0 offen offset:384
    buffer_load_dwordx4 v[72:75], v11, s[16:19], 0 offen offset:512
    buffer_load_dwordx4 v[76:79], v11, s[16:19], 0 offen offset:640
    buffer_load_dwordx4 v[80:83], v11, s[16:19], 0 offen offset:768
    buffer_load_dwordx4 v[84:87], v11, s[16:19], 0 offen offset:896
    buffer_load_dwordx4 v[88:91], v11, s[16:19], 0 offen offset:1024
    buffer_load_dwordx4 v[92:95], v11, s[16:19], 0 offen offset:1152
    buffer_load_dwordx4 v[96:99], v11, s[20:23], 0 offen offset:0
    buffer_load_dwordx4 v[100:103], v11, s[20:23], 0 offen offset:128
    buffer_load_dwordx4 v[104:107], v11, s[20:23], 0 offen offset:256
    buffer_load_dwordx4 v[108:111], v11, s[20:23], 0 offen offset:384
    buffer_load_dwordx4 v[112:115], v11, s[20:23], 0 offen offset:512
    buffer_load_dwordx4 v[116:119], v11, s[20:23], 0 offen offset:640
    buffer_load_dwordx4 v[120:123], v11, s[20:23], 0 offen offset:768
    buffer_load_dwordx4 v[124:127], v11, s[20:23], 0 offen offset:896
    buffer_load_dwordx4 v[128:131], v11, s[20:23], 0 offen offset:1024
    buffer_load_dwordx4 v[132:135], v11, s[20:23], 0 offen offset:1152
    s_barrier
    v_mov_b32 v180, 0
    v_mov_b32 v181, 0
    v_mov_b32 v182, 0
    v_mov_b32 v183, 0
    v_and_b32 v10, 31, v9
    v_lshlrev_b32 v10, 2, v10
    v_add_u32 v10, 122880, v10
    v_sub_u32 v4, 0x87ff, v9
    s_setprio 2
    s_waitcnt vmcnt(10)
    v_dot2c_f32_bf16 v180, v16, v56
    v_dot2c_f32_bf16 v181, v17, v57
    v_dot2c_f32_bf16 v180, v18, v58
    v_dot2c_f32_bf16 v181, v19, v59
    v_dot2c_f32_bf16 v180, v20, v60
    v_dot2c_f32_bf16 v181, v21, v61
    v_dot2c_f32_bf16 v180, v22, v62
    v_dot2c_f32_bf16 v181, v23, v63
    v_dot2c_f32_bf16 v180, v24, v64
    v_dot2c_f32_bf16 v181, v25, v65
    v_dot2c_f32_bf16 v180, v26, v66
    v_dot2c_f32_bf16 v181, v27, v67
    v_dot2c_f32_bf16 v180, v28, v68
    v_dot2c_f32_bf16 v181, v29, v69
    v_dot2c_f32_bf16 v180, v30, v70
    v_dot2c_f32_bf16 v181, v31, v71
    v_dot2c_f32_bf16 v180, v32, v72
    v_dot2c_f32_bf16 v181, v33, v73
    v_dot2c_f32_bf16 v180, v34, v74
    v_dot2c_f32_bf16 v181, v35, v75
    v_dot2c_f32_bf16 v180, v36, v76
    v_dot2c_f32_bf16 v181, v37, v77
    v_dot2c_f32_bf16 v180, v38, v78
    v_dot2c_f32_bf16 v181, v39, v79
    v_dot2c_f32_bf16 v180, v40, v80
    v_dot2c_f32_bf16 v181, v41, v81
    v_dot2c_f32_bf16 v180, v42, v82
    v_dot2c_f32_bf16 v181, v43, v83
    v_dot2c_f32_bf16 v180, v44, v84
    v_dot2c_f32_bf16 v181, v45, v85
    v_dot2c_f32_bf16 v180, v46, v86
    v_dot2c_f32_bf16 v181, v47, v87
    v_dot2c_f32_bf16 v180, v48, v88
    v_dot2c_f32_bf16 v181, v49, v89
    v_dot2c_f32_bf16 v180, v50, v90
    v_dot2c_f32_bf16 v181, v51, v91
    v_dot2c_f32_bf16 v180, v52, v92
    v_dot2c_f32_bf16 v181, v53, v93
    v_dot2c_f32_bf16 v180, v54, v94
    v_dot2c_f32_bf16 v181, v55, v95
    s_waitcnt vmcnt(0)
    v_dot2c_f32_bf16 v182, v16, v96
    v_dot2c_f32_bf16 v183, v17, v97
    v_dot2c_f32_bf16 v182, v18, v98
    v_dot2c_f32_bf16 v183, v19, v99
    v_dot2c_f32_bf16 v182, v20, v100
    v_dot2c_f32_bf16 v183, v21, v101
    v_dot2c_f32_bf16 v182, v22, v102
    v_dot2c_f32_bf16 v183, v23, v103
    v_dot2c_f32_bf16 v182, v24, v104
    v_dot2c_f32_bf16 v183, v25, v105
    v_dot2c_f32_bf16 v182, v26, v106
    v_dot2c_f32_bf16 v183, v27, v107
    v_dot2c_f32_bf16 v182, v28, v108
    v_dot2c_f32_bf16 v183, v29, v109
    v_dot2c_f32_bf16 v182, v30, v110
    v_dot2c_f32_bf16 v183, v31, v111
    v_dot2c_f32_bf16 v182, v32, v112
    v_dot2c_f32_bf16 v183, v33, v113
    v_dot2c_f32_bf16 v182, v34, v114
    v_dot2c_f32_bf16 v183, v35, v115
    v_dot2c_f32_bf16 v182, v36, v116
    v_dot2c_f32_bf16 v183, v37, v117
    v_dot2c_f32_bf16 v182, v38, v118
    v_dot2c_f32_bf16 v183, v39, v119
    v_dot2c_f32_bf16 v182, v40, v120
    v_dot2c_f32_bf16 v183, v41, v121
    v_dot2c_f32_bf16 v182, v42, v122
    v_dot2c_f32_bf16 v183, v43, v123
    v_dot2c_f32_bf16 v182, v44, v124
    v_dot2c_f32_bf16 v183, v45, v125
    v_dot2c_f32_bf16 v182, v46, v126
    v_dot2c_f32_bf16 v183, v47, v127
    v_dot2c_f32_bf16 v182, v48, v128
    v_dot2c_f32_bf16 v183, v49, v129
    v_dot2c_f32_bf16 v182, v50, v130
    v_dot2c_f32_bf16 v183, v51, v131
    v_dot2c_f32_bf16 v182, v52, v132
    v_dot2c_f32_bf16 v183, v53, v133
    v_dot2c_f32_bf16 v182, v54, v134
    v_dot2c_f32_bf16 v183, v55, v135
    s_nop 2
    v_add_f32 v180, v180, v181
    v_add_f32 v182, v182, v183
    s_nop 0
    v_add_f32_dpp v180, v180, v180 quad_perm:[1,0,3,2] row_mask:0xf bank_mask:0xf
    v_add_f32_dpp v182, v182, v182 quad_perm:[1,0,3,2] row_mask:0xf bank_mask:0xf
    s_nop 0
    v_add_f32_dpp v180, v180, v180 quad_perm:[2,3,0,1] row_mask:0xf bank_mask:0xf
    v_add_f32_dpp v182, v182, v182 quad_perm:[2,3,0,1] row_mask:0xf bank_mask:0xf
    s_nop 0
    v_add_f32_dpp v180, v180, v180 row_half_mirror row_mask:0xf bank_mask:0xf
    v_add_f32_dpp v182, v182, v182 row_half_mirror row_mask:0xf bank_mask:0xf
    v_cvt_pk_bf16_f32 v2, v180, v180
    v_lshlrev_b32 v2, 16, v2
    v_ashrrev_i32 v3, 31, v2
    v_or_b32 v3, 0x80000000, v3
    v_xor_b32 v2, v2, v3
    v_and_b32 v2, 0xffff0000, v2
    v_or_b32 v2, v2, v4
    ds_write2_b32 v10, v2, v182 offset0:0 offset1:32
    s_mov_b64 exec, 1
    ds_add_u32 v12, v13 offset:36
    s_mov_b64 exec, -1
    s_setprio 0
    s_cmp_lg_u32 s30, 4
    s_cbranch_scc1 K_WARMA0
    s_call_b64 s[38:39], WP_p2g
    s_branch K_WARMAX
K_WARMA0:
    s_cmp_lg_u32 s30, 5
    s_cbranch_scc1 K_WARMA1
    s_call_b64 s[38:39], WP_gen
    s_branch K_WARMAX
K_WARMA1:
    s_cmp_lg_u32 s30, 6
    s_cbranch_scc1 K_WARMA2
    s_call_b64 s[38:39], WP_help
    s_call_b64 s[38:39], WP_flags
    s_branch K_WARMAX
K_WARMA2:
    s_call_b64 s[38:39], WP_spin
K_WARMAX:
    s_cmp_ge_u32 s30, 6
    s_cselect_b32 s44, 63, s44
    s_cmp_lg_u32 s44, 63
    s_cbranch_scc1 K_FFN_C
    s_mov_b32 s3, 1048576
K_FGH:
    ds_read_b32 v2, v12 offset:48
    s_sleep 8
    s_sub_u32 s3, s3, 1
    s_waitcnt lgkmcnt(0)
    v_readfirstlane_b32 s33, v2
    s_nop 3
    s_cselect_b32 s33, 1, s33
    s_cmp_lt_u32 s33, 1
    s_cbranch_scc1 K_FGH
    s_cmp_eq_u32 s30, 6
    s_cbranch_scc1 K_P2_HELP
    v_mov_b32 v7, 1
    s_branch K_P2_HELP
K_AUX_LO:
    s_waitcnt lgkmcnt(0)
    s_cmp_eq_u32 s30, 0
    s_cbranch_scc1 K_AUX_PUB
    s_cmp_eq_u32 s44, 63
    s_cbranch_scc1 K_AUX_NOF
    s_and_b32 s3, s44, 1
    s_cmp_eq_u32 s3, 0
    s_cselect_b64 s[60:61], s[50:51], s[52:53]
    s_cselect_b64 s[64:65], s[52:53], s[50:51]
    s_cselect_b32 s75, 0, 40960
    s_mov_b32 s62, 0x21c000
    s_mov_b32 s63, 0x20000
    s_mov_b32 s66, 0x21c000
    s_mov_b32 s67, 0x20000
    v_lshrrev_b32 v2, 2, v1
    v_mul_u32_u24 v184, 3456, v2
    v_and_b32 v2, 3, v1
    v_lshl_add_u32 v184, v2, 4, v184
    s_lshl_b32 s72, s44, 6
    v_add_u32 v184, s72, v184
    s_sub_u32 s74, s30, 1
K_FSA0:
    s_lshl_b32 s73, s74, 10
    s_mul_i32 s72, s74, 55296
    s_add_u32 m0, s73, s75
    s_waitcnt vmcnt(7)
    buffer_load_dwordx4 v184, s[60:63], s72 offen lds
    s_add_u32 s74, s74, 3
    s_cmp_lt_u32 s74, 24
    s_cbranch_scc1 K_FSA0
    s_barrier
    s_mov_b32 s3, 1048576
K_FGPB:
    ds_read_b32 v2, v12 offset:36
    s_sleep 1
    s_sub_u32 s3, s3, 1
    s_waitcnt lgkmcnt(0)
    v_readfirstlane_b32 s33, v2
    s_nop 3
    s_cselect_b32 s33, 5, s33
    s_cmp_lt_u32 s33, 5
    s_cbranch_scc1 K_FGPB
K_FSA:
    s_lshl_b32 s73, s74, 10
    s_mul_i32 s72, s74, 55296
    s_add_u32 m0, s73, s75
    s_waitcnt vmcnt(7)
    buffer_load_dwordx4 v184, s[60:63], s72 offen lds
    s_add_u32 s74, s74, 3
    s_cmp_lt_u32 s74, 40
    s_cbranch_scc1 K_FSA
    s_sub_u32 s74, s74, 40
    s_xor_b32 s75, s75, 40960
    s_mov_b32 s68, s54
    s_mov_b32 s69, s55
    s_mov_b32 s70, 0x21c000
    s_mov_b32 s71, 0x20000
    s_mul_i32 s3, s44, 40960
    v_lshrrev_b32 v2, 3, v1
    v_mul_u32_u24 v2, 1280, v2
    v_lshrrev_b32 v3, 4, v1
    v_lshlrev_b32 v3, 1, v3
    v_and_b32 v4, 7, v1
    v_xor_b32 v3, v3, v4
    v_lshl_add_u32 v2, v3, 4, v2
    v_add_u32 v185, s3, v2
K_FSB:
    s_lshl_b32 s73, s74, 10
    s_mul_i32 s72, s74, 55296
    s_add_u32 m0, s73, s75
    s_waitcnt vmcnt(7)
    buffer_load_dwordx4 v184, s[64:67], s72 offen lds
    s_add_u32 s74, s74, 3
    s_cmp_lt_u32 s74, 40
    s_cbranch_scc1 K_FSB
    s_sub_u32 s74, s74, 40
    s_mov_b32 s75, 81920
K_FSD0:
    s_lshl_b32 s73, s74, 10
    s_and_b32 s72, s74, 3
    s_mul_i32 s72, s72, 10208
    s_lshl_b32 s3, s74, 5
    s_add_u32 s72, s72, s3
    s_add_u32 m0, s73, s75
    s_waitcnt vmcnt(7)
    buffer_load_dwordx4 v185, s[68:71], s72 offen lds
    s_add_u32 s74, s74, 3
    s_cmp_lt_u32 s74, 24
    s_cbranch_scc1 K_FSD0
    s_waitcnt vmcnt(8)
    s_mov_b64 exec, 1
    ds_add_u32 v12, v13 offset:56
    s_mov_b64 exec, -1
K_FSD:
    s_lshl_b32 s73, s74, 10
    s_and_b32 s72, s74, 3
    s_mul_i32 s72, s72, 10208
    s_lshl_b32 s3, s74, 5
    s_add_u32 s72, s72, s3
    s_add_u32 m0, s73, s75
    s_waitcnt vmcnt(7)
    buffer_load_dwordx4 v185, s[68:71], s72 offen lds
    s_add_u32 s74, s74, 3
    s_cmp_lt_u32 s74, 40
    s_cbranch_scc1 K_FSD
    s_mul_i32 s3, s29, 96
    s_lshl_b32 s72, s30, 5
    s_add_u32 s3, s3, s72
    s_sub_u32 s3, s3, 128
    v_lshrrev_b32 v2, 1, v1
    v_add_u32 v2, s3, v2
    v_mul_u32_u24 v2, 1280, v2
    v_and_b32 v3, 1, v1
    v_lshl_add_u32 v2, v3, 7, v2
    buffer_load_dword v6, v2, s[24:27], 0 offen offset:1024
K_AUX_WR:
    s_mov_b32 s3, 1048576
K_FGR:
    ds_read_b32 v2, v12 offset:60
    s_sleep 2
    s_sub_u32 s3, s3, 1
    s_waitcnt lgkmcnt(0)
    v_readfirstlane_b32 s33, v2
    s_nop 3
    s_cselect_b32 s33, 2, s33
    s_cmp_lt_u32 s33, 2
    s_cbranch_scc1 K_FGR
    s_branch K_P2
K_AUX_NOF:
    s_cmp_lg_u32 s2, 63
    s_cbranch_scc1 K_AUX_NOZ
    s_cmp_lg_u32 s30, 1
    s_cbranch_scc1 K_AUX_NOZ
    s_add_u32 s60, s10, 0x80000
    s_addc_u32 s61, s11, 0
    s_mov_b32 s62, 0xc000
    s_mov_b32 s63, 0x20000
    v_mov_b32 v9, 786432
    global_load_dword v10, v9, s[10:11] sc1
    v_lshlrev_b32 v11, 4, v1
    v_add_u32 v11, 790528, v11
    global_load_dword v6, v11, s[10:11] sc1
    s_barrier
    s_mov_b32 s3, 1048576
K_FGZ:
    ds_read_b32 v2, v12 offset:36
    s_sleep 2
    s_sub_u32 s3, s3, 1
    s_waitcnt lgkmcnt(0)
    v_readfirstlane_b32 s33, v2
    s_nop 3
    s_cselect_b32 s33, 4, s33
    s_cmp_lt_u32 s33, 4
    s_cbranch_scc1 K_FGZ
    v_and_b32 v4, 7, v1
    v_lshlrev_b32 v4, 2, v4
    global_load_dword v7, v4, s[8:9] offset:192 sc1
    s_waitcnt vmcnt(1)
    v_add_u32 v10, 1, v10
    s_mov_b32 s3, 131072
    s_setprio 3
K_AG2_POLL:
    global_load_dwordx4 v[16:19], v11, s[10:11] sc1
    s_waitcnt vmcnt(0)
    v_xor_b32 v2, v10, v17
    v_xor_b32 v3, v10, v19
    v_or_b32 v2, v2, v3
    v_cmp_ne_u32 vcc, 0, v2
    s_cbranch_vccz K_AG2_GOT
    s_sleep 2
    s_sub_u32 s3, s3, 1
    s_cmp_lg_u32 s3, 0
    s_cbranch_scc1 K_AG2_POLL
K_AG2_GOT:
    s_nop 1
    v_max_u32_dpp v3, v16, v16 quad_perm:[1,0,3,2] row_mask:0xf bank_mask:0xf
    s_nop 1
    v_max_u32_dpp v3, v3, v3 quad_perm:[2,3,0,1] row_mask:0xf bank_mask:0xf
    s_nop 1
    v_max_u32_dpp v3, v3, v3 row_half_mirror row_mask:0xf bank_mask:0xf
    s_nop 1
    v_max_u32_dpp v3, v3, v3 row_mirror row_mask:0xf bank_mask:0xf
    s_nop 1
    v_readlane_b32 s74, v3, 0
    v_readlane_b32 s76, v3, 16
    v_readlane_b32 s77, v3, 32
    v_readlane_b32 s78, v3, 48
    s_nop 3
    s_max_u32 s74, s74, s76
    s_max_u32 s77, s77, s78
    s_max_u32 s74, s74, s77
    v_cmp_ne_u32 vcc, s74, v16
    s_nop 1
    v_cndmask_b32 v2, v18, v16, vcc
    s_nop 1
    v_max_u32_dpp v3, v2, v2 quad_perm:[1,0,3,2] row_mask:0xf bank_mask:0xf
    s_nop 1
    v_max_u32_dpp v3, v3, v3 quad_perm:[2,3,0,1] row_mask:0xf bank_mask:0xf
    s_nop 1
    v_max_u32_dpp v3, v3, v3 row_half_mirror row_mask:0xf bank_mask:0xf
    s_nop 1
    v_max_u32_dpp v3, v3, v3 row_mirror row_mask:0xf bank_mask:0xf
    s_nop 1
    v_readlane_b32 s75, v3, 0
    v_readlane_b32 s76, v3, 16
    v_readlane_b32 s77, v3, 32
    v_readlane_b32 s78, v3, 48
    s_nop 3
    s_max_u32 s75, s75, s76
    s_max_u32 s77, s77, s78
    s_max_u32 s75, s75, s77
    v_mov_b32 v176, s74
    v_mov_b32 v177, s75
    v_and_b32 v4, 7, v1
    v_lshlrev_b32 v4, 2, v4
    s_mov_b32 s3, 131072
K_ZPOLL4:
    v_cmp_eq_u32 vcc, 0, v7
    s_cbranch_vccz K_ZOK4
    s_sub_u32 s3, s3, 1
    s_cbranch_scc1 K_ZOK4
    global_load_dword v7, v4, s[8:9] offset:192 sc1
    s_waitcnt vmcnt(0)
    s_branch K_ZPOLL4
K_ZOK4:
    v_and_b32 v2, 7, v1
    v_mul_u32_u24 v2, 20, v2
    v_lshrrev_b32 v3, 3, v1
    v_add_lshl_u32 v2, v2, v3, 8
    buffer_store_dwordx2 v[176:177], v2, s[60:63], 0 offen offset:136 sc1
    s_mov_b64 exec, 1
    global_store_dword v9, v10, s[10:11] sc1
    s_mov_b64 exec, -1
    v_lshlrev_b32 v4, 2, v1
    s_mov_b32 s72, 43008
    s_mov_b32 s3, 131072
K_AGG_POLL:
    s_sleep 8
    buffer_load_dword v2, v4, s[60:63], s72 offen sc1
    s_waitcnt vmcnt(0)
    v_cmp_eq_u32 vcc, 0, v2
    s_cbranch_vccz K_AGG_GOT
    s_sub_u32 s3, s3, 1
    s_cmp_lg_u32 s3, 0
    s_cbranch_scc1 K_AGG_POLL
K_AGG_GOT:
    s_mov_b32 s62, 40960
    v_lshlrev_b32 v3, 8, v1
    s_mov_b32 s3, 0
    buffer_store_dwordx2 v[176:177], v3, s[60:63], s3 offen offset:128 sc1
    s_mov_b32 s3, 16384
    buffer_store_dwordx2 v[176:177], v3, s[60:63], s3 offen offset:128 sc1
    s_mov_b32 s3, 32768
    buffer_store_dwordx2 v[176:177], v3, s[60:63], s3 offen offset:128 sc1
    s_setprio 0
    s_branch K_AUX_NOK
K_AUX_NOZ:
    s_barrier
K_AUX_NOK:
    s_mov_b32 s3, 1048576
K_FGWD:
    ds_read_b32 v2, v12 offset:48
    s_sleep 4
    s_sub_u32 s3, s3, 1
    s_waitcnt lgkmcnt(0)
    v_readfirstlane_b32 s33, v2
    s_nop 3
    s_cselect_b32 s33, 1, s33
    s_cmp_lt_u32 s33, 1
    s_cbranch_scc1 K_FGWD
    s_branch K_P2
K_AUX_PUB:
    s_add_u32 s60, s10, 0x1000
    s_addc_u32 s61, s11, 0
    s_mov_b32 s62, 0x2000
    s_mov_b32 s63, 0x20000
    v_and_b32 v3, 31, v1
    v_lshlrev_b32 v10, 2, v3
    v_add_u32 v11, 122880, v10
    s_lshl_b32 s72, s74, 2
    v_mov_b32 v2, 786432
    global_load_dword v17, v2, s[10:11] sc1
    s_lshl_b32 s3, s2, 2
    s_add_u32 s3, s3, 567296
    v_mov_b32 v9, s3
    s_lshl_b32 s3, s2, 4
    s_add_u32 s3, s3, 790528
    v_lshl_add_u32 v20, v1, 4, s3
    v_and_b32 v5, 7, v1
    v_lshlrev_b32 v5, 2, v5
    s_barrier
    s_setprio 3
    s_waitcnt vmcnt(0)
    v_add_u32 v17, 1, v17
    v_mov_b32 v19, v17
    s_mov_b32 s3, 1048576
K_FGRT:
    ds_read_b32 v2, v12 offset:36
    s_sleep 0
    s_sub_u32 s3, s3, 1
    s_waitcnt lgkmcnt(0)
    v_readfirstlane_b32 s33, v2
    s_nop 3
    s_cselect_b32 s33, 4, s33
    s_cmp_lt_u32 s33, 4
    s_cbranch_scc1 K_FGRT
    ds_read2_b32 v[176:177], v11 offset0:0 offset1:32
    s_waitcnt lgkmcnt(0)
    s_nop 1
    v_max_u32_dpp v3, v176, v176 quad_perm:[1,0,3,2] row_mask:0xf bank_mask:0xf
    s_nop 1
    v_max_u32_dpp v3, v3, v3 quad_perm:[2,3,0,1] row_mask:0xf bank_mask:0xf
    s_nop 1
    v_max_u32_dpp v3, v3, v3 row_half_mirror row_mask:0xf bank_mask:0xf
    s_nop 1
    v_max_u32_dpp v3, v3, v3 row_mirror row_mask:0xf bank_mask:0xf
    s_nop 1
    v_readlane_b32 s74, v3, 0
    v_readlane_b32 s76, v3, 16
    v_readlane_b32 s77, v3, 32
    v_readlane_b32 s78, v3, 48
    s_nop 3
    s_max_u32 s74, s74, s76
    s_max_u32 s77, s77, s78
    s_max_u32 s74, s74, s77
    v_cmp_ne_u32 vcc, s74, v176
    s_nop 1
    v_cndmask_b32 v176, 0, v176, vcc
    s_nop 1
    v_max_u32_dpp v3, v176, v176 quad_perm:[1,0,3,2] row_mask:0xf bank_mask:0xf
    s_nop 1
    v_max_u32_dpp v3, v3, v3 quad_perm:[2,3,0,1] row_mask:0xf bank_mask:0xf
    s_nop 1
    v_max_u32_dpp v3, v3, v3 row_half_mirror row_mask:0xf bank_mask:0xf
    s_nop 1
    v_max_u32_dpp v3, v3, v3 row_mirror row_mask:0xf bank_mask:0xf
    s_nop 1
    v_readlane_b32 s75, v3, 0
    v_readlane_b32 s76, v3, 16
    v_readlane_b32 s77, v3, 32
    v_readlane_b32 s78, v3, 48
    s_nop 3
    s_max_u32 s75, s75, s76
    s_max_u32 s77, s77, s78
    s_max_u32 s75, s75, s77
    v_mov_b32 v16, s74
    v_mov_b32 v18, s75
    s_mov_b64 exec, 1
    global_store_dwordx4 v20, v[16:19], s[10:11] sc1
    s_mov_b64 exec, -1
    s_mov_b64 exec, 1
    ds_add_u32 v12, v13 offset:36
    s_mov_b64 exec, -1
    global_load_dword v7, v5, s[8:9] offset:192 sc1
    v_cvt_pk_bf16_f32 v177, v177, v177
    v_lshlrev_b32 v177, 16, v177
    v_mul_f32 v3, 0xbfb8aa3b, v177
    v_exp_f32 v3, v3
    s_nop 0
    v_add_f32 v3, 1.0, v3
    v_rcp_f32 v177, v3
    s_nop 0
    v_cvt_pk_bf16_f32 v177, v177, v177
    v_lshlrev_b32 v177, 16, v177
    s_mov_b32 exec_hi, 0
    buffer_store_dword v177, v10, s[60:63], s72 offen sc1
    s_mov_b64 exec, -1
    s_waitcnt vmcnt(0)
    v_and_b32 v4, 7, v1
    v_lshlrev_b32 v4, 2, v4
    s_mov_b32 s3, 131072
K_ZPOLL3:
    v_cmp_eq_u32 vcc, 0, v7
    s_cbranch_vccz K_ZOK3
    s_sub_u32 s3, s3, 1
    s_cbranch_scc1 K_ZOK3
    global_load_dword v7, v4, s[8:9] offset:192 sc1
    s_waitcnt vmcnt(0)
    s_branch K_ZPOLL3
K_ZOK3:
    s_mov_b64 exec, 1
    global_store_dword v9, v13, s[10:11] sc1
    s_mov_b64 exec, -1
    v_and_b32 v3, 1, v1
    v_lshl_add_u32 v3, v3, 2, s42
    v_lshlrev_b32 v10, 4, v1
    s_mov_b32 s3, 131072
K_AUX_POLL:
    s_sleep 6
    global_load_dword v2, v3, s[10:11] offset:136 sc1
    s_waitcnt vmcnt(0)
    v_cmp_eq_u32 vcc, 0, v2
    s_cbranch_vccz K_AUX_GOT
    s_sub_u32 s3, s3, 1
    s_cmp_lg_u32 s3, 0
    s_cbranch_scc1 K_AUX_POLL
K_AUX_GOT:
    v_readlane_b32 s74, v2, 0
    v_readlane_b32 s75, v2, 1
    s_nop 3
    s_and_b32 s74, s74, 0x7ff
    s_sub_u32 s74, 2047, s74
    s_mul_i32 s74, s74, 1280
    s_mov_b32 m0, 125184
    s_nop 0
    buffer_load_dwordx4 v10, s[12:15], s74 offen lds
    s_mov_b64 exec, 0xffff
    buffer_load_dwordx4 v10, s[12:15], s74 offen offset:1024 lds
    s_mov_b64 exec, -1
    s_and_b32 s75, s75, 0x7ff
    s_sub_u32 s75, 2047, s75
    s_mul_i32 s75, s75, 1280
    s_mov_b32 m0, 126528
    s_nop 0
    buffer_load_dwordx4 v10, s[12:15], s75 offen lds
    s_mov_b64 exec, 0xffff
    buffer_load_dwordx4 v10, s[12:15], s75 offen offset:1024 lds
    s_mov_b64 exec, -1
    s_waitcnt vmcnt(0)
    ds_write_b32 v12, v13 offset:48
    s_setprio 0
    s_branch K_P2
.p2align 12
K_FFN_C:
    s_add_u32 s64, s10, 0x10000
    s_addc_u32 s65, s11, 0
    s_mov_b32 s66, 0x43800
    s_mov_b32 s67, 0x20000
    s_and_b32 s73, s30, 1
    v_lshrrev_b32 v232, 4, v1
    v_bfe_u32 v4, v1, 2, 2
    v_lshl_add_u32 v2, v232, 3, v4
    v_and_b32 v3, 3, v1
    v_lshlrev_b32 v3, 3, v3
    v_lshl_add_u32 v233, v2, 6, v3
    s_lshl_b32 s72, s73, 5
    v_add_u32 v233, s72, v233
    v_lshl_add_u32 v2, v232, 2, v4
    v_bfe_u32 v4, v2, 1, 2
    v_lshl_add_u32 v3, v2, 7, v3
    v_lshl_add_u32 v3, v4, 5, v3
    s_mul_i32 s3, s73, 20480
    s_add_u32 s3, s3, 81920
    v_add_u32 v238, s3, v3
    v_xor_b32 v239, 32, v238
    v_xor_b32 v240, 64, v238
    v_xor_b32 v241, 96, v238
    v_and_b32 v2, 1, v1
    v_mul_u32_u24 v234, 1344, v2
    v_lshl_add_u32 v234, v232, 4, v234
    v_add_u32 v234, 125184, v234
    v_lshlrev_b32 v236, 4, v1
    v_add_u32 v236, 124160, v236
    s_lshl_b32 s3, s73, 3
    v_add_u32 v235, s3, v236
    v_mul_u32_u24 v2, 2560, v2
    v_lshl_add_u32 v237, v232, 4, v2
    s_mul_i32 s3, s44, 5120
    s_mul_i32 s72, s73, 1280
    s_add_u32 s72, s72, s3
    v_lshlrev_b32 v2, 4, v1
    buffer_store_dwordx4 v[16:19], v2, s[64:67], s72 offen offset:0 sc1
    buffer_store_dwordx4 v[16:19], v2, s[64:67], s72 offen offset:2560 sc1
    s_mov_b64 exec, 0xffff
    buffer_store_dwordx4 v[16:19], v2, s[64:67], s72 offen offset:1024 sc1
    buffer_store_dwordx4 v[16:19], v2, s[64:67], s72 offen offset:3584 sc1
    s_mov_b64 exec, -1
    v_add_u32 v5, 40960, v233
    s_mov_b32 s3, 1048576
K_FGD:
    ds_read_b32 v2, v12 offset:56
    s_sleep 2
    s_sub_u32 s3, s3, 1
    s_waitcnt lgkmcnt(0)
    v_readfirstlane_b32 s33, v2
    s_nop 3
    s_cselect_b32 s33, 3, s33
    s_cmp_lt_u32 s33, 3
    s_cbranch_scc1 K_FGD
    s_setprio 3
    ds_read_b64_tr_b16 v[16:17], v233 offset:0
    ds_read_b64_tr_b16 v[18:19], v233 offset:256
    ds_read_b64_tr_b16 v[20:21], v233 offset:2048
    ds_read_b64_tr_b16 v[22:23], v233 offset:2304
    ds_read_b64_tr_b16 v[24:25], v233 offset:4096
    ds_read_b64_tr_b16 v[26:27], v233 offset:4352
    ds_read_b64_tr_b16 v[28:29], v233 offset:6144
    ds_read_b64_tr_b16 v[30:31], v233 offset:6400
    ds_read_b64_tr_b16 v[32:33], v233 offset:8192
    ds_read_b64_tr_b16 v[34:35], v233 offset:8448
    ds_read_b64_tr_b16 v[36:37], v233 offset:10240
    ds_read_b64_tr_b16 v[38:39], v233 offset:10496
    ds_read_b64_tr_b16 v[40:41], v233 offset:12288
    ds_read_b64_tr_b16 v[42:43], v233 offset:12544
    ds_read_b64_tr_b16 v[44:45], v233 offset:14336
    ds_read_b64_tr_b16 v[46:47], v233 offset:14592
    ds_read_b64_tr_b16 v[48:49], v233 offset:16384
    ds_read_b64_tr_b16 v[50:51], v233 offset:16640
    ds_read_b64_tr_b16 v[52:53], v233 offset:18432
    ds_read_b64_tr_b16 v[54:55], v233 offset:18688
    ds_read_b64_tr_b16 v[56:57], v233 offset:20480
    ds_read_b64_tr_b16 v[58:59], v233 offset:20736
    ds_read_b64_tr_b16 v[60:61], v233 offset:22528
    ds_read_b64_tr_b16 v[62:63], v233 offset:22784
    ds_read_b64_tr_b16 v[64:65], v233 offset:24576
    ds_read_b64_tr_b16 v[66:67], v233 offset:24832
    ds_read_b64_tr_b16 v[68:69], v233 offset:26624
    ds_read_b64_tr_b16 v[70:71], v233 offset:26880
    ds_read_b64_tr_b16 v[72:73], v233 offset:28672
    ds_read_b64_tr_b16 v[74:75], v233 offset:28928
    ds_read_b64_tr_b16 v[76:77], v233 offset:30720
    ds_read_b64_tr_b16 v[78:79], v233 offset:30976
    ds_read_b64_tr_b16 v[80:81], v233 offset:32768
    ds_read_b64_tr_b16 v[82:83], v233 offset:33024
    ds_read_b64_tr_b16 v[84:85], v233 offset:34816
    ds_read_b64_tr_b16 v[86:87], v233 offset:35072
    ds_read_b64_tr_b16 v[88:89], v233 offset:36864
    ds_read_b64_tr_b16 v[90:91], v233 offset:37120
    ds_read_b64_tr_b16 v[92:93], v233 offset:38912
    ds_read_b64_tr_b16 v[94:95], v233 offset:39168
    ds_read_b64_tr_b16 v[96:97], v5 offset:0
    ds_read_b64_tr_b16 v[98:99], v5 offset:256
    ds_read_b64_tr_b16 v[100:101], v5 offset:2048
    ds_read_b64_tr_b16 v[102:103], v5 offset:2304
    ds_read_b64_tr_b16 v[104:105], v5 offset:4096
    ds_read_b64_tr_b16 v[106:107], v5 offset:4352
    ds_read_b64_tr_b16 v[108:109], v5 offset:6144
    ds_read_b64_tr_b16 v[110:111], v5 offset:6400
    ds_read_b64_tr_b16 v[112:113], v5 offset:8192
    ds_read_b64_tr_b16 v[114:115], v5 offset:8448
    ds_read_b64_tr_b16 v[116:117], v5 offset:10240
    ds_read_b64_tr_b16 v[118:119], v5 offset:10496
    ds_read_b64_tr_b16 v[120:121], v5 offset:12288
    ds_read_b64_tr_b16 v[122:123], v5 offset:12544
    ds_read_b64_tr_b16 v[124:125], v5 offset:14336
    ds_read_b64_tr_b16 v[126:127], v5 offset:14592
    ds_read_b64_tr_b16 v[128:129], v5 offset:16384
    ds_read_b64_tr_b16 v[130:131], v5 offset:16640
    ds_read_b64_tr_b16 v[132:133], v5 offset:18432
    ds_read_b64_tr_b16 v[134:135], v5 offset:18688
    ds_read_b64_tr_b16 v[136:137], v5 offset:20480
    ds_read_b64_tr_b16 v[138:139], v5 offset:20736
    ds_read_b64_tr_b16 v[140:141], v5 offset:22528
    ds_read_b64_tr_b16 v[142:143], v5 offset:22784
    ds_read_b64_tr_b16 v[144:145], v5 offset:24576
    ds_read_b64_tr_b16 v[146:147], v5 offset:24832
    ds_read_b64_tr_b16 v[148:149], v5 offset:26624
    ds_read_b64_tr_b16 v[150:151], v5 offset:26880
    ds_read_b64_tr_b16 v[152:153], v5 offset:28672
    ds_read_b64_tr_b16 v[154:155], v5 offset:28928
    ds_read_b64_tr_b16 v[156:157], v5 offset:30720
    ds_read_b64_tr_b16 v[158:159], v5 offset:30976
    ds_read_b64_tr_b16 v[160:161], v5 offset:32768
    ds_read_b64_tr_b16 v[162:163], v5 offset:33024
    ds_read_b64_tr_b16 v[164:165], v5 offset:34816
    ds_read_b64_tr_b16 v[166:167], v5 offset:35072
    ds_read_b64_tr_b16 v[168:169], v5 offset:36864
    ds_read_b64_tr_b16 v[170:171], v5 offset:37120
    ds_read_b64_tr_b16 v[172:173], v5 offset:38912
    ds_read_b64_tr_b16 v[174:175], v5 offset:39168
    s_waitcnt vmcnt(0) lgkmcnt(0)
    s_mov_b64 exec, 1
    ds_add_u32 v12, v13 offset:60
    s_mov_b64 exec, -1
    s_mov_b32 s3, 1048576
K_FGK:
    ds_read_b32 v2, v12 offset:48
    s_sleep 1
    s_sub_u32 s3, s3, 1
    s_waitcnt lgkmcnt(0)
    v_readfirstlane_b32 s33, v2
    s_nop 3
    s_cselect_b32 s33, 1, s33
    s_cmp_lt_u32 s33, 1
    s_cbranch_scc1 K_FGK
    ds_read_b128 v[188:191], v234 offset:0
    ds_read_b128 v[192:195], v234 offset:64
    ds_read_b128 v[196:199], v234 offset:128
    ds_read_b128 v[200:203], v234 offset:192
    ds_read_b128 v[204:207], v234 offset:256
    ds_read_b128 v[208:211], v234 offset:320
    ds_read_b128 v[212:215], v234 offset:384
    ds_read_b128 v[216:219], v234 offset:448
    s_waitcnt lgkmcnt(7)
    v_mfma_f32_16x16x32_bf16 v[220:223], v[16:19], v[188:191], 0
    v_mfma_f32_16x16x32_bf16 v[224:227], v[96:99], v[188:191], 0
    ds_read_b128 v[188:191], v234 offset:512
    s_waitcnt lgkmcnt(7)
    v_mfma_f32_16x16x32_bf16 v[220:223], v[20:23], v[192:195], v[220:223]
    v_mfma_f32_16x16x32_bf16 v[224:227], v[100:103], v[192:195], v[224:227]
    ds_read_b128 v[192:195], v234 offset:576
    s_waitcnt lgkmcnt(7)
    v_mfma_f32_16x16x32_bf16 v[220:223], v[24:27], v[196:199], v[220:223]
    v_mfma_f32_16x16x32_bf16 v[224:227], v[104:107], v[196:199], v[224:227]
    ds_read_b128 v[196:199], v234 offset:640
    s_waitcnt lgkmcnt(7)
    v_mfma_f32_16x16x32_bf16 v[220:223], v[28:31], v[200:203], v[220:223]
    v_mfma_f32_16x16x32_bf16 v[224:227], v[108:111], v[200:203], v[224:227]
    ds_read_b128 v[200:203], v234 offset:704
    s_waitcnt lgkmcnt(7)
    v_mfma_f32_16x16x32_bf16 v[220:223], v[32:35], v[204:207], v[220:223]
    v_mfma_f32_16x16x32_bf16 v[224:227], v[112:115], v[204:207], v[224:227]
    ds_read_b128 v[204:207], v234 offset:768
    s_waitcnt lgkmcnt(7)
    v_mfma_f32_16x16x32_bf16 v[220:223], v[36:39], v[208:211], v[220:223]
    v_mfma_f32_16x16x32_bf16 v[224:227], v[116:119], v[208:211], v[224:227]
    ds_read_b128 v[208:211], v234 offset:832
    s_waitcnt lgkmcnt(7)
    v_mfma_f32_16x16x32_bf16 v[220:223], v[40:43], v[212:215], v[220:223]
    v_mfma_f32_16x16x32_bf16 v[224:227], v[120:123], v[212:215], v[224:227]
    ds_read_b128 v[212:215], v234 offset:896
    s_waitcnt lgkmcnt(7)
    v_mfma_f32_16x16x32_bf16 v[220:223], v[44:47], v[216:219], v[220:223]
    v_mfma_f32_16x16x32_bf16 v[224:227], v[124:127], v[216:219], v[224:227]
    ds_read_b128 v[216:219], v234 offset:960
    s_waitcnt lgkmcnt(7)
    v_mfma_f32_16x16x32_bf16 v[220:223], v[48:51], v[188:191], v[220:223]
    v_mfma_f32_16x16x32_bf16 v[224:227], v[128:131], v[188:191], v[224:227]
    ds_read_b128 v[188:191], v234 offset:1024
    s_waitcnt lgkmcnt(7)
    v_mfma_f32_16x16x32_bf16 v[220:223], v[52:55], v[192:195], v[220:223]
    v_mfma_f32_16x16x32_bf16 v[224:227], v[132:135], v[192:195], v[224:227]
    ds_read_b128 v[192:195], v234 offset:1088
    s_waitcnt lgkmcnt(7)
    v_mfma_f32_16x16x32_bf16 v[220:223], v[56:59], v[196:199], v[220:223]
    v_mfma_f32_16x16x32_bf16 v[224:227], v[136:139], v[196:199], v[224:227]
    ds_read_b128 v[196:199], v234 offset:1152
    s_waitcnt lgkmcnt(7)
    v_mfma_f32_16x16x32_bf16 v[220:223], v[60:63], v[200:203], v[220:223]
    v_mfma_f32_16x16x32_bf16 v[224:227], v[140:143], v[200:203], v[224:227]
    ds_read_b128 v[200:203], v234 offset:1216
    s_waitcnt lgkmcnt(7)
    v_mfma_f32_16x16x32_bf16 v[220:223], v[64:67], v[204:207], v[220:223]
    v_mfma_f32_16x16x32_bf16 v[224:227], v[144:147], v[204:207], v[224:227]
    s_waitcnt lgkmcnt(6)
    v_mfma_f32_16x16x32_bf16 v[220:223], v[68:71], v[208:211], v[220:223]
    v_mfma_f32_16x16x32_bf16 v[224:227], v[148:151], v[208:211], v[224:227]
    s_waitcnt lgkmcnt(5)
    v_mfma_f32_16x16x32_bf16 v[220:223], v[72:75], v[212:215], v[220:223]
    v_mfma_f32_16x16x32_bf16 v[224:227], v[152:155], v[212:215], v[224:227]
    s_waitcnt lgkmcnt(4)
    v_mfma_f32_16x16x32_bf16 v[220:223], v[76:79], v[216:219], v[220:223]
    v_mfma_f32_16x16x32_bf16 v[224:227], v[156:159], v[216:219], v[224:227]
    s_waitcnt lgkmcnt(3)
    v_mfma_f32_16x16x32_bf16 v[220:223], v[80:83], v[188:191], v[220:223]
    v_mfma_f32_16x16x32_bf16 v[224:227], v[160:163], v[188:191], v[224:227]
    s_waitcnt lgkmcnt(2)
    v_mfma_f32_16x16x32_bf16 v[220:223], v[84:87], v[192:195], v[220:223]
    v_mfma_f32_16x16x32_bf16 v[224:227], v[164:167], v[192:195], v[224:227]
    s_waitcnt lgkmcnt(1)
    v_mfma_f32_16x16x32_bf16 v[220:223], v[88:91], v[196:199], v[220:223]
    v_mfma_f32_16x16x32_bf16 v[224:227], v[168:171], v[196:199], v[224:227]
    s_waitcnt lgkmcnt(0)
    v_mfma_f32_16x16x32_bf16 v[220:223], v[92:95], v[200:203], v[220:223]
    v_mfma_f32_16x16x32_bf16 v[224:227], v[172:175], v[200:203], v[224:227]
    s_mov_b32 s3, 1048576
K_FGDN:
    ds_read_b32 v2, v12 offset:52
    s_sleep 1
    s_sub_u32 s3, s3, 1
    s_waitcnt lgkmcnt(0)
    v_readfirstlane_b32 s33, v2
    s_nop 3
    s_cselect_b32 s33, 3, s33
    s_cmp_lt_u32 s33, 3
    s_cbranch_scc1 K_FGDN
    ds_read_b64_tr_b16 v[16:17], v238 offset:0
    ds_read_b64_tr_b16 v[18:19], v238 offset:2048
    ds_read_b64_tr_b16 v[20:21], v239 offset:0
    ds_read_b64_tr_b16 v[22:23], v239 offset:2048
    ds_read_b64_tr_b16 v[24:25], v240 offset:0
    ds_read_b64_tr_b16 v[26:27], v240 offset:2048
    ds_read_b64_tr_b16 v[28:29], v241 offset:0
    ds_read_b64_tr_b16 v[30:31], v241 offset:2048
    ds_read_b64_tr_b16 v[32:33], v238 offset:4096
    ds_read_b64_tr_b16 v[34:35], v238 offset:6144
    ds_read_b64_tr_b16 v[36:37], v239 offset:4096
    ds_read_b64_tr_b16 v[38:39], v239 offset:6144
    ds_read_b64_tr_b16 v[40:41], v240 offset:4096
    ds_read_b64_tr_b16 v[42:43], v240 offset:6144
    v_cvt_pk_bf16_f32 v221, v220, v221
    v_lshlrev_b32 v220, 16, v221
    v_and_b32 v221, 0xffff0000, v221
    v_cvt_pk_bf16_f32 v223, v222, v223
    v_lshlrev_b32 v222, 16, v223
    v_and_b32 v223, 0xffff0000, v223
    v_cvt_pk_bf16_f32 v225, v224, v225
    v_lshlrev_b32 v224, 16, v225
    v_and_b32 v225, 0xffff0000, v225
    v_cvt_pk_bf16_f32 v227, v226, v227
    v_lshlrev_b32 v226, 16, v227
    v_and_b32 v227, 0xffff0000, v227
    v_mul_f32 v188, 0xbfb8aa3b, v220
    v_mul_f32 v189, 0xbfb8aa3b, v221
    v_mul_f32 v190, 0xbfb8aa3b, v222
    v_mul_f32 v191, 0xbfb8aa3b, v223
    v_exp_f32 v188, v188
    v_exp_f32 v189, v189
    v_exp_f32 v190, v190
    v_exp_f32 v191, v191
    v_add_f32 v188, 1.0, v188
    v_add_f32 v189, 1.0, v189
    v_add_f32 v190, 1.0, v190
    v_add_f32 v191, 1.0, v191
    v_rcp_f32 v188, v188
    v_rcp_f32 v189, v189
    v_rcp_f32 v190, v190
    v_rcp_f32 v191, v191
    v_mul_f32 v220, v220, v188
    v_mul_f32 v221, v221, v189
    v_mul_f32 v222, v222, v190
    v_mul_f32 v223, v223, v191
    v_cvt_pk_bf16_f32 v221, v220, v221
    v_lshlrev_b32 v220, 16, v221
    v_and_b32 v221, 0xffff0000, v221
    v_cvt_pk_bf16_f32 v223, v222, v223
    v_lshlrev_b32 v222, 16, v223
    v_and_b32 v223, 0xffff0000, v223
    v_mul_f32 v220, v220, v224
    v_mul_f32 v221, v221, v225
    v_mul_f32 v222, v222, v226
    v_mul_f32 v223, v223, v227
    v_cvt_pk_bf16_f32 v228, v220, v221
    v_cvt_pk_bf16_f32 v229, v222, v223
    ds_write_b64 v235, v[228:229]
    s_mov_b64 exec, 1
    ds_add_u32 v12, v13 offset:52
    s_mov_b64 exec, -1
    ds_read_b64_tr_b16 v[44:45], v241 offset:4096
    ds_read_b64_tr_b16 v[46:47], v241 offset:6144
    ds_read_b64_tr_b16 v[48:49], v238 offset:8192
    ds_read_b64_tr_b16 v[50:51], v238 offset:10240
    ds_read_b64_tr_b16 v[52:53], v239 offset:8192
    ds_read_b64_tr_b16 v[54:55], v239 offset:10240
    ds_read_b64_tr_b16 v[56:57], v240 offset:8192
    ds_read_b64_tr_b16 v[58:59], v240 offset:10240
    ds_read_b64_tr_b16 v[60:61], v241 offset:8192
    ds_read_b64_tr_b16 v[62:63], v241 offset:10240
    ds_read_b64_tr_b16 v[64:65], v238 offset:12288
    ds_read_b64_tr_b16 v[66:67], v238 offset:14336
    ds_read_b64_tr_b16 v[68:69], v239 offset:12288
    ds_read_b64_tr_b16 v[70:71], v239 offset:14336
    ds_read_b64_tr_b16 v[72:73], v240 offset:12288
    ds_read_b64_tr_b16 v[74:75], v240 offset:14336
    ds_read_b64_tr_b16 v[76:77], v241 offset:12288
    ds_read_b64_tr_b16 v[78:79], v241 offset:14336
    ds_read_b64_tr_b16 v[80:81], v238 offset:16384
    ds_read_b64_tr_b16 v[82:83], v238 offset:18432
    ds_read_b64_tr_b16 v[84:85], v239 offset:16384
    ds_read_b64_tr_b16 v[86:87], v239 offset:18432
    ds_read_b64_tr_b16 v[88:89], v240 offset:16384
    ds_read_b64_tr_b16 v[90:91], v240 offset:18432
    ds_read_b64_tr_b16 v[92:93], v241 offset:16384
    ds_read_b64_tr_b16 v[94:95], v241 offset:18432
    s_mov_b32 s3, 1048576
K_FGP:
    ds_read_b32 v2, v12 offset:52
    s_sleep 0
    s_sub_u32 s3, s3, 1
    s_waitcnt lgkmcnt(0)
    v_readfirstlane_b32 s33, v2
    s_nop 3
    s_cselect_b32 s33, 5, s33
    s_cmp_lt_u32 s33, 5
    s_cbranch_scc1 K_FGP
    ds_read_b128 v[228:231], v236
    s_waitcnt lgkmcnt(0)
    v_mfma_f32_16x16x32_bf16 v[96:99], v[16:19], v[228:231], 0
    v_mfma_f32_16x16x32_bf16 v[100:103], v[20:23], v[228:231], 0
    v_mfma_f32_16x16x32_bf16 v[104:107], v[24:27], v[228:231], 0
    v_mfma_f32_16x16x32_bf16 v[108:111], v[28:31], v[228:231], 0
    v_mfma_f32_16x16x32_bf16 v[112:115], v[32:35], v[228:231], 0
    v_mfma_f32_16x16x32_bf16 v[116:119], v[36:39], v[228:231], 0
    v_mfma_f32_16x16x32_bf16 v[120:123], v[40:43], v[228:231], 0
    v_mfma_f32_16x16x32_bf16 v[124:127], v[44:47], v[228:231], 0
    v_mfma_f32_16x16x32_bf16 v[128:131], v[48:51], v[228:231], 0
    v_mfma_f32_16x16x32_bf16 v[132:135], v[52:55], v[228:231], 0
    v_mfma_f32_16x16x32_bf16 v[136:139], v[56:59], v[228:231], 0
    v_mfma_f32_16x16x32_bf16 v[140:143], v[60:63], v[228:231], 0
    v_mfma_f32_16x16x32_bf16 v[144:147], v[64:67], v[228:231], 0
    v_mfma_f32_16x16x32_bf16 v[148:151], v[68:71], v[228:231], 0
    v_mfma_f32_16x16x32_bf16 v[152:155], v[72:75], v[228:231], 0
    v_mfma_f32_16x16x32_bf16 v[156:159], v[76:79], v[228:231], 0
    v_mfma_f32_16x16x32_bf16 v[160:163], v[80:83], v[228:231], 0
    v_mfma_f32_16x16x32_bf16 v[164:167], v[84:87], v[228:231], 0
    v_mfma_f32_16x16x32_bf16 v[168:171], v[88:91], v[228:231], 0
    v_mfma_f32_16x16x32_bf16 v[172:175], v[92:95], v[228:231], 0
    s_mov_b32 exec_lo, 0x00030003
    s_mov_b32 exec_hi, 0x00030003
    buffer_store_dwordx4 v[96:99], v237, s[64:67], s72 offen offset:0 sc1
    buffer_store_dwordx4 v[100:103], v237, s[64:67], s72 offen offset:64 sc1
    buffer_store_dwordx4 v[104:107], v237, s[64:67], s72 offen offset:128 sc1
    buffer_store_dwordx4 v[108:111], v237, s[64:67], s72 offen offset:192 sc1
    buffer_store_dwordx4 v[112:115], v237, s[64:67], s72 offen offset:256 sc1
    buffer_store_dwordx4 v[116:119], v237, s[64:67], s72 offen offset:320 sc1
    buffer_store_dwordx4 v[120:123], v237, s[64:67], s72 offen offset:384 sc1
    buffer_store_dwordx4 v[124:127], v237, s[64:67], s72 offen offset:448 sc1
    buffer_store_dwordx4 v[128:131], v237, s[64:67], s72 offen offset:512 sc1
    buffer_store_dwordx4 v[132:135], v237, s[64:67], s72 offen offset:576 sc1
    buffer_store_dwordx4 v[136:139], v237, s[64:67], s72 offen offset:640 sc1
    buffer_store_dwordx4 v[140:143], v237, s[64:67], s72 offen offset:704 sc1
    buffer_store_dwordx4 v[144:147], v237, s[64:67], s72 offen offset:768 sc1
    buffer_store_dwordx4 v[148:151], v237, s[64:67], s72 offen offset:832 sc1
    buffer_store_dwordx4 v[152:155], v237, s[64:67], s72 offen offset:896 sc1
    buffer_store_dwordx4 v[156:159], v237, s[64:67], s72 offen offset:960 sc1
    buffer_store_dwordx4 v[160:163], v237, s[64:67], s72 offen offset:1024 sc1
    buffer_store_dwordx4 v[164:167], v237, s[64:67], s72 offen offset:1088 sc1
    buffer_store_dwordx4 v[168:171], v237, s[64:67], s72 offen offset:1152 sc1
    buffer_store_dwordx4 v[172:175], v237, s[64:67], s72 offen offset:1216 sc1
    s_mov_b64 exec, -1
    s_mul_i32 s3, s73, 2560
    s_lshl2_add_u32 s3, s44, s3
    s_add_u32 s3, s3, 568320
    v_lshl_add_u32 v2, v1, 8, s3
    s_mov_b64 exec, 0x3ff
    s_waitcnt vmcnt(0)
    global_store_dword v2, v13, s[10:11] sc1
    s_mov_b64 exec, -1
    s_branch K_P2_HELP
K_CODE_END:
.section .rodata,"a"
.p2align 6
.amdhsa_kernel gated_mix__sliding_local_dilated__moe_arch_mod__prompt_kernel
  .amdhsa_next_free_vgpr 248
  .amdhsa_next_free_sgpr 79
  .amdhsa_accum_offset 248
  .amdhsa_group_segment_fixed_size 0
  .amdhsa_kernarg_size 96
  .amdhsa_user_sgpr_count 2
  .amdhsa_user_sgpr_kernarg_segment_ptr 1
  .amdhsa_system_sgpr_workgroup_id_x 1
.end_amdhsa_kernel
```

```asm
; @launch grid=(256,1,1) block=(512,1,1) lds=163840
.amdgcn_target "amdgcn-amd-amdhsa--gfx950"
.text
.p2align 12
.p2align 8
.globl gated_mix__sliding_local_dilated__moe_arch_mod__prompt_kernel
.type gated_mix__sliding_local_dilated__moe_arch_mod__prompt_kernel,@function
gated_mix__sliding_local_dilated__moe_arch_mod__prompt_kernel:
    s_cmp_ge_u32 s2, 256
    s_cbranch_scc1 K_EXIT
    s_load_dwordx2 s[12:13], s[0:1], 0
    s_load_dwordx2 s[16:17], s[0:1], 8
    v_readfirstlane_b32 s30, v0
    s_load_dwordx4 s[8:11], s[0:1], 80
    s_load_dwordx2 s[24:25], s[0:1], 16
    s_load_dwordx2 s[6:7], s[0:1], 72
    s_and_b32 s28, s2, 7
    v_and_b32 v1, 63, v0
    s_mov_b32 s14, 0x280000
    s_mov_b32 s15, 0x20000
    s_lshr_b32 s30, s30, 6
    s_cmp_lt_u32 s2, 64
    s_cbranch_scc1 K_SLOW
    s_cmp_lt_u32 s30, 4
    s_cbranch_scc1 K_FAST
K_SLOW:
    s_getpc_b64 s[38:39]
K_PC:
    s_bfe_u32 s3, s2, 0x30003
    s_mul_i32 s3, s3, ((K_CODE_END-gated_mix__sliding_local_dilated__moe_arch_mod__prompt_kernel+1023)/1024)
    s_sub_u32 s38, s38, K_PC-gated_mix__sliding_local_dilated__moe_arch_mod__prompt_kernel
    s_subb_u32 s39, s39, 0
    v_subrev_u32 v3, 256, v0
    v_add_u32 v2, s3, v3
    v_lshlrev_b32 v2, 7, v2
    v_min_u32 v2, K_CODE_END-gated_mix__sliding_local_dilated__moe_arch_mod__prompt_kernel-4, v2
    v_cmp_gt_u32 vcc, ((K_CODE_END-gated_mix__sliding_local_dilated__moe_arch_mod__prompt_kernel+1023)/1024), v3
    s_and_saveexec_b64 s[4:5], vcc
    s_cbranch_execz K_NOPF
    global_load_dword v6, v2, s[38:39]
K_NOPF:
    s_mov_b64 exec, -1
    v_mov_b32 v2, 0
    v_mov_b32 v3, 158752
    ds_write2_b32 v3, v2, v2 offset0:0 offset1:1
    ds_write2_b32 v3, v2, v2 offset0:2 offset1:3
    ds_write2_b32 v3, v2, v2 offset0:4 offset1:5
    ds_write2_b32 v3, v2, v2 offset0:6 offset1:7
    ds_write2_b32 v3, v2, v2 offset0:8 offset1:9
    ds_write2_b32 v3, v2, v2 offset0:10 offset1:11
    s_mov_b32 s43, 1
    s_lshl_b32 s3, s30, 8
    s_add_u32 s3, s3, s2
    s_lshr_b32 s3, s3, 3
    s_cmp_lg_u32 s3, 160
    s_cbranch_scc1 K_COMMON
    s_mul_i32 s3, s2, 6144
    s_add_u32 s3, s3, 527360
    v_lshl_add_u32 v6, v1, 4, s3
    v_mov_b64 v[28:29], 0
    v_mov_b64 v[30:31], 0
    s_waitcnt lgkmcnt(0)
    global_store_dwordx4 v6, v[28:31], s[10:11] offset:-3072 sc1
    global_store_dwordx4 v6, v[28:31], s[10:11] offset:-2048 sc1
    global_store_dwordx4 v6, v[28:31], s[10:11] offset:-1024 sc1
    global_store_dwordx4 v6, v[28:31], s[10:11] offset:0 sc1
    global_store_dwordx4 v6, v[28:31], s[10:11] offset:1024 sc1
    global_store_dwordx4 v6, v[28:31], s[10:11] offset:2048 sc1
    s_lshl_b32 s3, s2, 2
    v_mov_b32 v2, s3
    v_mov_b32 v3, 1
    s_mov_b64 exec, 1
    s_waitcnt vmcnt(0)
    global_store_dword v2, v3, s[8:9] offset:192 sc1
    s_mov_b64 exec, -1
    s_branch K_COMMON
K_FAST:
    s_lshr_b32 s32, s2, 1
    s_and_b32 s32, s32, 28
    v_lshrrev_b32 v3, 4, v1
    s_lshr_b32 s3, s2, 6
    s_mov_b32 s59, 0x98450216
    s_cmp_eq_u32 s3, 2
    s_cselect_b32 s59, 0x70238164, s59
    v_and_b32 v4, 7, v1
    s_cmp_eq_u32 s3, 3
    s_cselect_b32 s59, 0x65703481, s59
    v_lshrrev_b32 v2, 3, v1
    s_lshr_b32 s59, s59, s32
    s_and_b32 s59, s59, 15
    v_xor_b32 v4, v4, v3
    s_add_u32 s59, s59, s28
    s_cmp_ge_u32 s59, 10
    v_mul_u32_u24 v2, 1280, v2
    s_cselect_b32 s33, 10, 0
    s_sub_u32 s59, s59, s33
    s_lshr_b32 s53, s28, 1
    v_lshl_add_u32 v44, v4, 4, v2
    s_mul_i32 s53, s53, 655360
    s_lshl2_add_u32 s62, s3, s30
    s_cmp_eq_u32 s62, 15
    s_cselect_b32 s62, 0x800000, 0
    s_add_u32 s62, s62, 40960
    s_mul_i32 s3, s3, 225280
    v_xor_b32 v45, 64, v44
    s_add_u32 s53, s53, s3
    s_mul_i32 s54, s30, 61440
    s_add_u32 s53, s53, s54
    s_sub_u32 s53, s53, 245760
    s_mul_i32 s55, s30, 6144
    s_add_u32 s55, s55, 40960
    s_lshl_b32 s57, s59, 7
    s_add_u32 s57, s57, s53
    s_waitcnt lgkmcnt(0)
    s_add_u32 m0, s55, 0
    s_max_i32 s60, s57, 0
    buffer_load_dwordx4 v44, s[12:15], s60 offen lds
    s_add_u32 s60, s57, 10240
    s_add_u32 m0, s55, 1024
    s_max_i32 s60, s60, 0
    buffer_load_dwordx4 v45, s[12:15], s60 offen lds
    s_add_u32 m0, s55, 2048
    s_add_u32 s60, s57, 20480
    buffer_load_dwordx4 v44, s[12:15], s60 offen lds
    s_add_u32 m0, s55, 3072
    s_add_u32 s60, s57, 30720
    buffer_load_dwordx4 v45, s[12:15], s60 offen lds
    s_add_u32 m0, s55, 4096
    s_add_u32 s60, s57, s62
    buffer_load_dwordx4 v44, s[12:15], s60 offen lds
    s_add_u32 m0, s55, 5120
    s_add_u32 s60, s60, 10240
    buffer_load_dwordx4 v45, s[12:15], s60 offen lds
    v_lshlrev_b32 v2, 1, v3
    s_lshr_b32 s32, 0x64317520, s32
    v_sub_u32 v2, v1, v2
    s_and_b32 s32, s32, 7
    v_and_b32 v2, 15, v2
    s_and_b32 s3, s28, 1
    v_mul_u32_u24 v3, 3840, v3
    s_lshl3_add_u32 s32, s3, s32
    v_mul_u32_u24 v4, 13, v2
    s_mul_i32 s3, s32, 80
    v_lshrrev_b32 v4, 6, v4
    s_add_u32 s54, s54, s3
    v_mul_u32_u24 v4, 1200, v4
    s_lshl_b32 s56, s30, 12
    v_lshl_add_u32 v4, v2, 4, v4
    s_add_u32 s56, s56, 65536
    v_add_u32 v5, 1, v2
    s_mov_b32 s18, 0x258000
    v_and_b32 v5, 16, v5
    s_mov_b32 s19, 0x20000
    v_lshl_add_u32 v4, v5, 24, v4
    v_add_u32 v46, v3, v4
    s_mul_i32 s58, s59, 245760
    s_add_u32 s58, s58, s54
    s_add_u32 s59, s59, 1
    s_cmp_eq_u32 s59, 10
    s_cselect_b32 s59, 0, s59
    s_add_u32 m0, s56, 0
    s_add_u32 s60, s58, 0
    buffer_load_dwordx4 v46, s[16:19], s60 offen lds
    s_add_u32 m0, s56, 1024
    s_add_u32 s60, s58, 15360
    buffer_load_dwordx4 v46, s[16:19], s60 offen lds
    v_xor_b32 v2, 8, v2
    v_mul_u32_u24 v4, 13, v2
    v_lshrrev_b32 v4, 6, v4
    v_mul_u32_u24 v4, 1200, v4
    v_lshl_add_u32 v4, v2, 4, v4
    v_add_u32 v5, 1, v2
    v_and_b32 v5, 16, v5
    v_lshl_add_u32 v4, v5, 24, v4
    v_add_u32 v47, v3, v4
    s_add_u32 m0, s56, 2048
    s_add_u32 s60, s58, 30720
    buffer_load_dwordx4 v47, s[16:19], s60 offen lds
    s_add_u32 m0, s56, 3072
    s_add_u32 s60, s58, 46080
    buffer_load_dwordx4 v47, s[16:19], s60 offen lds
    s_mov_b32 s3, 40960
    s_cmp_ge_u32 s55, 81920
    s_cselect_b32 s60, -81920, s3
    s_add_u32 s55, s55, s60
    s_add_u32 s56, s56, s60
    s_lshl_b32 s57, s59, 7
    s_add_u32 s57, s57, s53
    s_mul_i32 s58, s59, 245760
    s_add_u32 s58, s58, s54
    s_add_u32 s59, s59, 1
    s_cmp_eq_u32 s59, 10
    s_cselect_b32 s59, 0, s59
    s_add_u32 m0, s56, 0
    s_add_u32 s60, s58, 0
    buffer_load_dwordx4 v46, s[16:19], s60 offen lds
    s_add_u32 m0, s55, 0
    s_max_i32 s60, s57, 0
    buffer_load_dwordx4 v44, s[12:15], s60 offen lds
    s_add_u32 m0, s56, 1024
    s_add_u32 s60, s58, 15360
    buffer_load_dwordx4 v46, s[16:19], s60 offen lds
    s_add_u32 s60, s57, 10240
    s_add_u32 m0, s55, 1024
    s_max_i32 s60, s60, 0
    buffer_load_dwordx4 v45, s[12:15], s60 offen lds
    s_add_u32 m0, s55, 2048
    s_add_u32 s60, s57, 20480
    buffer_load_dwordx4 v44, s[12:15], s60 offen lds
    s_mov_b32 s52, s30
    s_mov_b32 s43, 0
K_COMMON:
    v_mov_b32 v7, 0
    s_lshr_b32 s29, s2, 3
    s_xor_b32 s30, s30, 4
    s_mov_b32 s26, 0xc8000
    s_mov_b32 s27, 0x20000
    s_lshr_b32 s34, s29, 3
    s_lshl_b32 s34, s34, 2
    s_and_b32 s3, s29, 3
    s_add_u32 s34, s34, s3
    s_add_u32 s34, s34, 4
    s_bitcmp1_b32 s29, 2
    s_cselect_b32 s34, -1, s34
    s_cmp_lt_u32 s29, 8
    s_cselect_b32 s34, s29, s34
    s_lshl_b32 s40, s28, 1
    s_cmp_ge_u32 s34, 10
    s_addc_u32 s40, s40, 0
    s_sub_u32 s41, s34, 10
    s_cmp_ge_u32 s34, 10
    s_cselect_b32 s41, s41, s34
    s_mul_i32 s42, s28, 20
    s_add_u32 s42, s42, s34
    s_and_b32 s42, s42, 255
    s_lshl_b32 s42, s42, 8
    s_add_u32 s42, s42, 524288
    s_cmp_lt_u32 s29, 8
    s_cbranch_scc1 K_AUX
    s_lshr_b32 s31, s29, 3
    s_sub_u32 s31, s31, 1
    s_and_b32 s35, s29, 3
    s_and_b32 s3, s29, 4
    s_lshl_b32 s3, s3, 1
    s_add_u32 s35, s35, s3
    s_and_b32 s3, s28, 1
    s_lshl_b32 s3, s3, 2
    s_add_u32 s35, s35, s3
    v_and_b32 v9, 15, v1
    v_lshrrev_b32 v10, 4, v1
    v_bfe_u32 v11, v1, 2, 2
    v_and_b32 v12, 3, v1
    s_waitcnt lgkmcnt(0)
    s_add_u32 s20, s10, 0x100000
    s_addc_u32 s21, s11, 0
    s_mov_b32 s22, 0x280000
    s_mov_b32 s23, 0x20000
    s_and_b32 s3, s30, 3
    s_mul_i32 s3, s3, 3
    s_lshr_b32 s33, s30, 2
    s_lshl1_add_u32 s3, s33, s3
    s_mul_i32 s44, s31, 11
    s_add_u32 s44, s44, s3
    s_cmp_eq_u32 s44, 31
    s_cselect_b32 s51, 4, s30
    s_lshr_b32 s33, s28, 1
    s_lshl_b32 s33, s33, 5
    s_add_u32 s44, s44, s33
    s_mul_i32 s3, s3, 4352
    s_add_u32 s3, s3, 81920
    v_mul_u32_u24 v14, 272, v9
    v_lshl_add_u32 v13, v10, 3, v14
    v_add_u32 v13, s3, v13
    v_add3_u32 v14, v14, 32, s3
    v_cmp_eq_u32 vcc, 0, v10
    v_add_u32 v2, 208, v14
    v_add_u32 v3, 0, v14
    v_add_u32 v4, 40, v14
    v_cndmask_b32 v19, v2, v3, vcc
    v_cndmask_b32 v20, v2, v4, vcc
    v_lshl_add_u32 v15, v10, 2, v11
    v_mul_u32_u24 v15, 272, v15
    v_add_u32 v5, s3, v15
    v_lshl_add_u32 v15, v12, 3, v5
    v_add_u32 v2, 240, v5
    v_add_u32 v3, 192, v5
    v_add_u32 v4, 232, v5
    v_cmp_eq_u32 vcc, 0, v12
    s_nop 1
    v_cndmask_b32 v21, v2, v3, vcc
    v_cmp_eq_u32 vcc, 1, v12
    s_nop 1
    v_cndmask_b32 v22, v2, v4, vcc
    v_cmp_eq_u32 vcc, 2, v12
    s_nop 1
    v_cndmask_b32 v23, v2, v3, vcc
    v_cmp_eq_u32 vcc, 3, v12
    s_nop 1
    v_cndmask_b32 v24, v2, v4, vcc
    s_lshl_b32 s3, s35, 10
    v_lshl_add_u32 v16, v1, 4, s3
    s_lshl_b32 s3, s35, 8
    s_add_u32 s3, s3, 16384
    v_lshl_add_u32 v17, v9, 4, s3
    v_and_b32 v2, 1, v10
    v_lshl_add_u32 v17, v2, 3, v17
    s_cmp_lt_u32 s51, 4
    s_cselect_b32 s3, 0, 0x800000
    s_add_u32 s3, s3, 20480
    v_lshrrev_b32 v2, 1, v10
    v_mad_u32_u24 v17, v2, s3, v17
    s_mul_i32 s50, s44, 20480
    s_add_u32 s51, s50, s3
    v_mov_b32 v18, 0xf149f2ca
    v_lshlrev_b32 v2, 2, v10
    v_sub_u32 v2, v9, v2
    s_cmp_eq_u32 s44, 0
    s_cselect_b32 s3, 0xf149f2ca, 0
    v_subrev_u32 v3, 0, v2
    v_and_b32 v4, 0x80000001, v3
    v_cmp_eq_u32 vcc, 0, v4
    s_nop 1
    v_cndmask_b32 v32, v18, 0, vcc
    v_cmp_eq_u32 vcc, 0x80000000, v4
    s_nop 1
    v_cndmask_b32 v28, v18, 0, vcc
    v_add_f32 v36, s3, v28
    v_subrev_u32 v3, 1, v2
    v_and_b32 v4, 0x80000001, v3
    v_cmp_eq_u32 vcc, 0, v4
    s_nop 1
    v_cndmask_b32 v33, v18, 0, vcc
    v_cmp_eq_u32 vcc, 0x80000000, v4
    s_nop 1
    v_cndmask_b32 v29, v18, 0, vcc
    v_add_f32 v37, s3, v29
    v_subrev_u32 v3, 2, v2
    v_and_b32 v4, 0x80000001, v3
    v_cmp_eq_u32 vcc, 0, v4
    s_nop 1
    v_cndmask_b32 v34, v18, 0, vcc
    v_cmp_eq_u32 vcc, 0x80000000, v4
    s_nop 1
    v_cndmask_b32 v30, v18, 0, vcc
    v_add_f32 v38, s3, v30
    v_subrev_u32 v3, 3, v2
    v_and_b32 v4, 0x80000001, v3
    v_cmp_eq_u32 vcc, 0, v4
    s_nop 1
    v_cndmask_b32 v35, v18, 0, vcc
    v_cmp_eq_u32 vcc, 0x80000000, v4
    s_nop 1
    v_cndmask_b32 v31, v18, 0, vcc
    v_add_f32 v39, s3, v31
    v_mov_b32 v3, 0x0c0c0c0c
    v_mov_b32 v4, 0xc0c0100
    v_cmp_eq_u32 vcc, 0, v28
    v_mov_b32 v5, 0x1000c0c
    s_nop 0
    v_cndmask_b32 v3, v3, v4, vcc
    v_cmp_eq_u32 vcc, 0, v29
    s_nop 1
    v_cndmask_b32 v40, v3, v5, vcc
    v_mov_b32 v3, 0x0c0c0c0c
    v_mov_b32 v4, 0xc0c0302
    v_cmp_eq_u32 vcc, 0, v30
    v_mov_b32 v5, 0x3020c0c
    s_nop 0
    v_cndmask_b32 v3, v3, v4, vcc
    v_cmp_eq_u32 vcc, 0, v31
    s_nop 1
    v_cndmask_b32 v41, v3, v5, vcc
    v_mov_b32 v3, 0x0c0c0c0c
    v_mov_b32 v4, 0xc0c0100
    v_cmp_eq_u32 vcc, 0, v32
    v_mov_b32 v5, 0x1000c0c
    s_nop 0
    v_cndmask_b32 v3, v3, v4, vcc
    v_cmp_eq_u32 vcc, 0, v33
    s_nop 1
    v_cndmask_b32 v42, v3, v5, vcc
    v_mov_b32 v3, 0x0c0c0c0c
    v_mov_b32 v4, 0xc0c0302
    v_cmp_eq_u32 vcc, 0, v34
    v_mov_b32 v5, 0x3020c0c
    s_nop 0
    v_cndmask_b32 v3, v3, v4, vcc
    v_cmp_eq_u32 vcc, 0, v35
    s_nop 1
    v_cndmask_b32 v43, v3, v5, vcc
    s_mov_b32 s46, 0x3fb8aa3b
    s_mov_b32 s47, s46
    s_mov_b32 s48, 0x3e64f92e
    s_mov_b32 s49, s48
    s_mov_b32 s36, 0xfffff
    s_cmp_lg_u32 s31, 0
    s_cselect_b32 s33, 64, 0
    v_mov_b32 v2, s33
    v_cmp_gt_u32 vcc, 10, v1
    s_lshr_b32 s3, s28, 1
    s_lshl2_add_u32 s3, s3, s31
    v_cndmask_b32 v2, 0, v2, vcc
    v_lshl_add_u32 v2, v1, 8, v2
    s_mul_i32 s3, s3, 2560
    s_lshl2_add_u32 s3, s35, s3
    s_add_u32 s3, s3, 524288
    v_add_u32 v8, s3, v2
    s_cmp_eq_u32 s43, 1
    s_cbranch_scc1 K_CONS
    v_lshrrev_b32 v2, 3, v1
    v_mul_u32_u24 v2, 1280, v2
    v_lshrrev_b32 v3, 4, v1
    v_lshlrev_b32 v3, 1, v3
    v_and_b32 v4, 7, v1
    v_xor_b32 v3, v3, v4
    v_lshl_add_u32 v2, v3, 4, v2
    s_lshl_b32 s33, s41, 7
    v_add_u32 v18, s33, v2
    s_mov_b32 s61, 9
    s_mov_b32 s3, 40960
K_LOOP0:
    s_waitcnt vmcnt(5)
    s_barrier
    s_add_u32 m0, s56, 2048
    s_add_u32 s60, s58, 30720
    buffer_load_dwordx4 v47, s[16:19], s60 offen lds
    s_add_u32 m0, s55, 3072
    s_add_u32 s60, s57, 30720
    buffer_load_dwordx4 v45, s[12:15], s60 offen lds
    s_add_u32 m0, s56, 3072
    s_add_u32 s60, s58, 46080
    buffer_load_dwordx4 v47, s[16:19], s60 offen lds
    s_add_u32 m0, s55, 4096
    s_add_u32 s60, s57, s62
    buffer_load_dwordx4 v44, s[12:15], s60 offen lds
    s_add_u32 m0, s55, 5120
    s_add_u32 s60, s60, 10240
    buffer_load_dwordx4 v45, s[12:15], s60 offen lds
    s_sub_u32 s61, s61, 1
    s_cmp_eq_u32 s61, 0
    s_cbranch_scc1 K_LOOPX
    s_cmp_ge_u32 s55, 81920
    s_cselect_b32 s60, -81920, s3
    s_add_u32 s55, s55, s60
    s_add_u32 s56, s56, s60
    s_lshl_b32 s57, s59, 7
    s_add_u32 s57, s57, s53
    s_mul_i32 s58, s59, 245760
    s_add_u32 s58, s58, s54
    s_add_u32 s59, s59, 1
    s_cmp_eq_u32 s59, 10
    s_cselect_b32 s59, 0, s59
    s_add_u32 m0, s56, 0
    s_add_u32 s60, s58, 0
    buffer_load_dwordx4 v46, s[16:19], s60 offen lds
    s_add_u32 m0, s55, 0
    s_max_i32 s60, s57, 0
    buffer_load_dwordx4 v44, s[12:15], s60 offen lds
    s_add_u32 m0, s56, 1024
    s_add_u32 s60, s58, 15360
    buffer_load_dwordx4 v46, s[16:19], s60 offen lds
    s_add_u32 s60, s57, 10240
    s_add_u32 m0, s55, 1024
    s_max_i32 s60, s60, 0
    buffer_load_dwordx4 v45, s[12:15], s60 offen lds
    s_add_u32 m0, s55, 2048
    s_add_u32 s60, s57, 20480
    buffer_load_dwordx4 v44, s[12:15], s60 offen lds
    s_branch K_LOOP0
K_LOOPX:
    v_and_b32 v2, 7, v1
    v_lshlrev_b32 v2, 2, v2
    s_waitcnt vmcnt(0)
    s_barrier
    s_cmp_lt_u32 s30, 6
    s_cbranch_scc1 K_NOSMP
    global_load_dword v7, v2, s[8:9] offset:192 sc1
K_NOSMP:
    s_cmp_eq_u32 s34, -1
    s_cbranch_scc1 K_JOIN_S
    s_cmp_lg_u32 s30, 7
    s_cbranch_scc1 K_WOE
    s_barrier
K_WOE:
    s_lshl_b32 s57, s52, 2
    s_lshr_b32 s57, 0x7520, s57
    s_and_b32 s57, s57, 7
    s_mul_i32 s57, s57, 51200
    s_mul_i32 s58, s52, 5120
    s_add_u32 s3, s57, 0
    s_add_u32 m0, s58, 0
    s_nop 0
    buffer_load_dwordx4 v18, s[24:27], s3 offen lds
    s_add_u32 s3, s57, 10240
    s_add_u32 m0, s58, 1024
    s_nop 0
    buffer_load_dwordx4 v18, s[24:27], s3 offen lds
    s_add_u32 s3, s57, 20480
    s_add_u32 m0, s58, 2048
    s_nop 0
    buffer_load_dwordx4 v18, s[24:27], s3 offen lds
    s_add_u32 s3, s57, 30720
    s_add_u32 m0, s58, 3072
    s_nop 0
    buffer_load_dwordx4 v18, s[24:27], s3 offen lds
    s_add_u32 s3, s57, 40960
    s_add_u32 m0, s58, 4096
    s_nop 0
    buffer_load_dwordx4 v18, s[24:27], s3 offen lds
    s_add_u32 s3, s57, 409600
    s_add_u32 m0, s58, 20480
    s_nop 0
    buffer_load_dwordx4 v18, s[24:27], s3 offen lds
    s_add_u32 s3, s57, 419840
    s_add_u32 m0, s58, 21504
    s_nop 0
    buffer_load_dwordx4 v18, s[24:27], s3 offen lds
    s_add_u32 s3, s57, 430080
    s_add_u32 m0, s58, 22528
    s_nop 0
    buffer_load_dwordx4 v18, s[24:27], s3 offen lds
    s_add_u32 s3, s57, 440320
    s_add_u32 m0, s58, 23552
    s_nop 0
    buffer_load_dwordx4 v18, s[24:27], s3 offen lds
    s_add_u32 s3, s57, 450560
    s_add_u32 m0, s58, 24576
    s_nop 0
    buffer_load_dwordx4 v18, s[24:27], s3 offen lds
    s_cmp_lg_u32 s30, 7
    s_cbranch_scc1 K_JOIN_S
    s_mov_b32 s52, 0
K_XD:
    s_lshl_b32 s57, s40, 3
    s_lshl1_add_u32 s57, s52, s57
    s_mul_i32 s57, s57, 20480
    s_lshl_b32 s33, s41, 7
    s_add_u32 s57, s57, s33
    s_lshl_b32 s33, s52, 12
    s_add_u32 m0, s33, 140288
    s_add_u32 s3, s57, 0
    buffer_load_dwordx4 v44, s[12:15], s3 offen lds
    s_add_u32 m0, s33, 141312
    s_add_u32 s3, s57, 10240
    buffer_load_dwordx4 v45, s[12:15], s3 offen lds
    s_add_u32 m0, s33, 142336
    s_add_u32 s3, s57, 20480
    buffer_load_dwordx4 v44, s[12:15], s3 offen lds
    s_add_u32 m0, s33, 143360
    s_add_u32 s3, s57, 30720
    buffer_load_dwordx4 v45, s[12:15], s3 offen lds
    s_add_u32 s52, s52, 1
    s_cmp_lt_u32 s52, 4
    s_cbranch_scc1 K_XD
    s_branch K_W7
.p2align 12
K_CONS:
    s_lshr_b32 s52, s30, 1
    s_and_b32 s53, s30, 1
    v_lshrrev_b32 v2, 1, v9
    v_xor_b32 v2, v2, v10
    v_lshlrev_b32 v2, 4, v2
    v_lshl_add_u32 v2, v9, 7, v2
    s_mul_i32 s3, s52, 12288
    v_add_u32 v44, s3, v2
    v_xor_b32 v45, 64, v44
    v_add_u32 v46, 81920, v44
    v_add_u32 v47, 81920, v45
    v_and_b32 v2, 1, v10
    v_lshl_or_b32 v2, v2, 2, v11
    v_lshl_add_u32 v3, v10, 3, v11
    v_lshlrev_b32 v3, 8, v3
    v_lshl_add_u32 v3, v12, 3, v3
    v_add_u32 v3, 24576, v3
    s_lshl_b32 s3, s53, 2
    v_add_u32 v2, s3, v2
    v_add_u32 v4, 0, v2
    v_and_b32 v4, 7, v4
    v_lshl_add_u32 v48, v4, 5, v3
    v_add_u32 v52, 81920, v48
    v_add_u32 v4, 1, v2
    v_and_b32 v4, 7, v4
    v_lshl_add_u32 v49, v4, 5, v3
    v_add_u32 v53, 81920, v49
    v_add_u32 v4, 2, v2
    v_and_b32 v4, 7, v4
    v_lshl_add_u32 v50, v4, 5, v3
    v_add_u32 v54, 81920, v50
    v_add_u32 v4, 3, v2
    v_and_b32 v4, 7, v4
    v_lshl_add_u32 v51, v4, 5, v3
    v_add_u32 v55, 81920, v51
    v_mul_u32_u24 v56, 272, v9
    v_lshl_add_u32 v56, v10, 3, v56
    s_mul_i32 s3, s52, 26112
    s_lshl_b32 s33, s53, 7
    s_add_u32 s3, s3, s33
    s_add_u32 s3, s3, 81920
    v_add_u32 v56, s3, v56
    v_mov_b64 v[60:61], 0
    v_mov_b64 v[62:63], 0
    v_mov_b64 v[64:65], 0
    v_mov_b64 v[66:67], 0
    v_mov_b64 v[68:69], 0
    v_mov_b64 v[70:71], 0
    v_mov_b64 v[72:73], 0
    v_mov_b64 v[74:75], 0
    v_mov_b64 v[76:77], 0
    v_mov_b64 v[78:79], 0
    v_mov_b64 v[80:81], 0
    v_mov_b64 v[82:83], 0
    v_mov_b64 v[84:85], 0
    v_mov_b64 v[86:87], 0
    v_mov_b64 v[88:89], 0
    v_mov_b64 v[90:91], 0
    v_mov_b64 v[92:93], 0
    v_mov_b64 v[94:95], 0
    v_mov_b64 v[96:97], 0
    v_mov_b64 v[98:99], 0
    v_mov_b64 v[100:101], 0
    v_mov_b64 v[102:103], 0
    v_mov_b64 v[104:105], 0
    v_mov_b64 v[106:107], 0
    v_mov_b64 v[108:109], 0
    v_mov_b64 v[110:111], 0
    v_mov_b64 v[112:113], 0
    v_mov_b64 v[114:115], 0
    v_mov_b64 v[116:117], 0
    v_mov_b64 v[118:119], 0
    v_mov_b64 v[120:121], 0
    v_mov_b64 v[122:123], 0
    v_mov_b64 v[124:125], 0
    v_mov_b64 v[126:127], 0
    v_mov_b64 v[128:129], 0
    v_mov_b64 v[130:131], 0
    v_mov_b64 v[132:133], 0
    v_mov_b64 v[134:135], 0
    v_mov_b64 v[136:137], 0
    v_mov_b64 v[138:139], 0
    v_mov_b64 v[140:141], 0
    v_mov_b64 v[142:143], 0
    v_mov_b64 v[144:145], 0
    v_mov_b64 v[146:147], 0
    v_mov_b64 v[148:149], 0
    v_mov_b64 v[150:151], 0
    v_mov_b64 v[152:153], 0
    v_mov_b64 v[154:155], 0
    s_mov_b32 s54, 3
    s_cmp_lg_u32 s30, 0
    s_cbranch_scc1 K_WARMM0
    s_call_b64 s[38:39], WP_attd
    s_call_b64 s[38:39], WP_p2g
    s_branch K_WARMMX
K_WARMM0:
    s_cmp_lg_u32 s30, 1
    s_cbranch_scc1 K_WARMM1
    s_call_b64 s[38:39], WP_atts
    s_call_b64 s[38:39], WP_early
    s_branch K_WARMMX
K_WARMM1:
    s_cmp_lg_u32 s30, 2
    s_cbranch_scc1 K_WARMM2
    s_call_b64 s[38:39], WP_help
    s_call_b64 s[38:39], WP_flags
    s_branch K_WARMMX
K_WARMM2:
    s_call_b64 s[38:39], WP_spin
K_WARMMX:
    s_barrier
    ds_read_b64_tr_b16 v[204:205], v48 offset:40960
    ds_read_b64_tr_b16 v[206:207], v48 offset:41984
    ds_read_b128 v[156:159], v44 offset:40960
    ds_read_b64_tr_b16 v[208:209], v49 offset:40960
    ds_read_b64_tr_b16 v[210:211], v49 offset:41984
    ds_read_b128 v[160:163], v44 offset:43008
    ds_read_b64_tr_b16 v[212:213], v50 offset:40960
    ds_read_b64_tr_b16 v[214:215], v50 offset:41984
    ds_read_b128 v[164:167], v44 offset:45056
    ds_read_b64_tr_b16 v[216:217], v51 offset:40960
    ds_read_b64_tr_b16 v[218:219], v51 offset:41984
    ds_read_b128 v[168:171], v44 offset:47104
    ds_read_b128 v[172:175], v44 offset:49152
    ds_read_b128 v[176:179], v44 offset:51200
K_CLOOP:
    s_waitcnt lgkmcnt(0)
    v_mfma_f32_16x16x32_bf16 v[60:63], v[204:207], v[156:159], v[60:63]
    ds_read_b64_tr_b16 v[220:221], v48 offset:49152
    v_mfma_f32_16x16x32_bf16 v[64:67], v[208:211], v[156:159], v[64:67]
    ds_read_b64_tr_b16 v[222:223], v48 offset:50176
    v_mfma_f32_16x16x32_bf16 v[68:71], v[212:215], v[156:159], v[68:71]
    ds_read_b128 v[180:183], v45 offset:40960
    v_mfma_f32_16x16x32_bf16 v[72:75], v[216:219], v[156:159], v[72:75]
    ds_read_b64_tr_b16 v[224:225], v49 offset:49152
    v_mfma_f32_16x16x32_bf16 v[88:91], v[216:219], v[160:163], v[88:91]
    ds_read_b64_tr_b16 v[226:227], v49 offset:50176
    v_mfma_f32_16x16x32_bf16 v[84:87], v[212:215], v[160:163], v[84:87]
    ds_read_b128 v[184:187], v45 offset:43008
    v_mfma_f32_16x16x32_bf16 v[80:83], v[208:211], v[160:163], v[80:83]
    ds_read_b64_tr_b16 v[228:229], v50 offset:49152
    v_mfma_f32_16x16x32_bf16 v[76:79], v[204:207], v[160:163], v[76:79]
    ds_read_b64_tr_b16 v[230:231], v50 offset:50176
    v_mfma_f32_16x16x32_bf16 v[92:95], v[204:207], v[164:167], v[92:95]
    ds_read_b128 v[188:191], v45 offset:45056
    v_mfma_f32_16x16x32_bf16 v[96:99], v[208:211], v[164:167], v[96:99]
    ds_read_b64_tr_b16 v[232:233], v51 offset:49152
    v_mfma_f32_16x16x32_bf16 v[100:103], v[212:215], v[164:167], v[100:103]
    ds_read_b64_tr_b16 v[234:235], v51 offset:50176
    v_mfma_f32_16x16x32_bf16 v[104:107], v[216:219], v[164:167], v[104:107]
    ds_read_b128 v[192:195], v45 offset:47104
    v_mfma_f32_16x16x32_bf16 v[120:123], v[216:219], v[168:171], v[120:123]
    ds_read_b128 v[196:199], v45 offset:49152
    v_mfma_f32_16x16x32_bf16 v[116:119], v[212:215], v[168:171], v[116:119]
    ds_read_b128 v[200:203], v45 offset:51200
    v_mfma_f32_16x16x32_bf16 v[112:115], v[208:211], v[168:171], v[112:115]
    v_mfma_f32_16x16x32_bf16 v[108:111], v[204:207], v[168:171], v[108:111]
    v_mfma_f32_16x16x32_bf16 v[124:127], v[204:207], v[172:175], v[124:127]
    v_mfma_f32_16x16x32_bf16 v[128:131], v[208:211], v[172:175], v[128:131]
    v_mfma_f32_16x16x32_bf16 v[132:135], v[212:215], v[172:175], v[132:135]
    v_mfma_f32_16x16x32_bf16 v[136:139], v[216:219], v[172:175], v[136:139]
    v_mfma_f32_16x16x32_bf16 v[152:155], v[216:219], v[176:179], v[152:155]
    v_mfma_f32_16x16x32_bf16 v[148:151], v[212:215], v[176:179], v[148:151]
    v_mfma_f32_16x16x32_bf16 v[144:147], v[208:211], v[176:179], v[144:147]
    v_mfma_f32_16x16x32_bf16 v[140:143], v[204:207], v[176:179], v[140:143]
    s_waitcnt lgkmcnt(0)
    s_barrier
    v_mfma_f32_16x16x32_bf16 v[60:63], v[220:223], v[180:183], v[60:63]
    ds_read_b64_tr_b16 v[204:205], v52 offset:0
    v_mfma_f32_16x16x32_bf16 v[64:67], v[224:227], v[180:183], v[64:67]
    ds_read_b64_tr_b16 v[206:207], v52 offset:1024
    v_mfma_f32_16x16x32_bf16 v[68:71], v[228:231], v[180:183], v[68:71]
    ds_read_b128 v[156:159], v46 offset:0
    v_mfma_f32_16x16x32_bf16 v[72:75], v[232:235], v[180:183], v[72:75]
    ds_read_b64_tr_b16 v[208:209], v53 offset:0
    v_mfma_f32_16x16x32_bf16 v[88:91], v[232:235], v[184:187], v[88:91]
    ds_read_b64_tr_b16 v[210:211], v53 offset:1024
    v_mfma_f32_16x16x32_bf16 v[84:87], v[228:231], v[184:187], v[84:87]
    ds_read_b128 v[160:163], v46 offset:2048
    v_mfma_f32_16x16x32_bf16 v[80:83], v[224:227], v[184:187], v[80:83]
    ds_read_b64_tr_b16 v[212:213], v54 offset:0
    v_mfma_f32_16x16x32_bf16 v[76:79], v[220:223], v[184:187], v[76:79]
    ds_read_b64_tr_b16 v[214:215], v54 offset:1024
    v_mfma_f32_16x16x32_bf16 v[92:95], v[220:223], v[188:191], v[92:95]
    ds_read_b128 v[164:167], v46 offset:4096
    v_mfma_f32_16x16x32_bf16 v[96:99], v[224:227], v[188:191], v[96:99]
    ds_read_b64_tr_b16 v[216:217], v55 offset:0
    v_mfma_f32_16x16x32_bf16 v[100:103], v[228:231], v[188:191], v[100:103]
    ds_read_b64_tr_b16 v[218:219], v55 offset:1024
    v_mfma_f32_16x16x32_bf16 v[104:107], v[232:235], v[188:191], v[104:107]
    ds_read_b128 v[168:171], v46 offset:6144
    v_mfma_f32_16x16x32_bf16 v[120:123], v[232:235], v[192:195], v[120:123]
    ds_read_b128 v[172:175], v46 offset:8192
    v_mfma_f32_16x16x32_bf16 v[116:119], v[228:231], v[192:195], v[116:119]
    ds_read_b128 v[176:179], v46 offset:10240
    v_mfma_f32_16x16x32_bf16 v[112:115], v[224:227], v[192:195], v[112:115]
    v_mfma_f32_16x16x32_bf16 v[108:111], v[220:223], v[192:195], v[108:111]
    v_mfma_f32_16x16x32_bf16 v[124:127], v[220:223], v[196:199], v[124:127]
    v_mfma_f32_16x16x32_bf16 v[128:131], v[224:227], v[196:199], v[128:131]
    v_mfma_f32_16x16x32_bf16 v[132:135], v[228:231], v[196:199], v[132:135]
    v_mfma_f32_16x16x32_bf16 v[136:139], v[232:235], v[196:199], v[136:139]
    v_mfma_f32_16x16x32_bf16 v[152:155], v[232:235], v[200:203], v[152:155]
    v_mfma_f32_16x16x32_bf16 v[148:151], v[228:231], v[200:203], v[148:151]
    v_mfma_f32_16x16x32_bf16 v[144:147], v[224:227], v[200:203], v[144:147]
    v_mfma_f32_16x16x32_bf16 v[140:143], v[220:223], v[200:203], v[140:143]
    s_waitcnt lgkmcnt(0)
    v_mfma_f32_16x16x32_bf16 v[60:63], v[204:207], v[156:159], v[60:63]
    ds_read_b64_tr_b16 v[220:221], v52 offset:8192
    v_mfma_f32_16x16x32_bf16 v[64:67], v[208:211], v[156:159], v[64:67]
    ds_read_b64_tr_b16 v[222:223], v52 offset:9216
    v_mfma_f32_16x16x32_bf16 v[68:71], v[212:215], v[156:159], v[68:71]
    ds_read_b128 v[180:183], v47 offset:0
    v_mfma_f32_16x16x32_bf16 v[72:75], v[216:219], v[156:159], v[72:75]
    ds_read_b64_tr_b16 v[224:225], v53 offset:8192
    v_mfma_f32_16x16x32_bf16 v[88:91], v[216:219], v[160:163], v[88:91]
    ds_read_b64_tr_b16 v[226:227], v53 offset:9216
    v_mfma_f32_16x16x32_bf16 v[84:87], v[212:215], v[160:163], v[84:87]
    ds_read_b128 v[184:187], v47 offset:2048
    v_mfma_f32_16x16x32_bf16 v[80:83], v[208:211], v[160:163], v[80:83]
    ds_read_b64_tr_b16 v[228:229], v54 offset:8192
    v_mfma_f32_16x16x32_bf16 v[76:79], v[204:207], v[160:163], v[76:79]
    ds_read_b64_tr_b16 v[230:231], v54 offset:9216
    v_mfma_f32_16x16x32_bf16 v[92:95], v[204:207], v[164:167], v[92:95]
    ds_read_b128 v[188:191], v47 offset:4096
    v_mfma_f32_16x16x32_bf16 v[96:99], v[208:211], v[164:167], v[96:99]
    ds_read_b64_tr_b16 v[232:233], v55 offset:8192
    v_mfma_f32_16x16x32_bf16 v[100:103], v[212:215], v[164:167], v[100:103]
    ds_read_b64_tr_b16 v[234:235], v55 offset:9216
    v_mfma_f32_16x16x32_bf16 v[104:107], v[216:219], v[164:167], v[104:107]
    ds_read_b128 v[192:195], v47 offset:6144
    v_mfma_f32_16x16x32_bf16 v[120:123], v[216:219], v[168:171], v[120:123]
    ds_read_b128 v[196:199], v47 offset:8192
    v_mfma_f32_16x16x32_bf16 v[116:119], v[212:215], v[168:171], v[116:119]
    ds_read_b128 v[200:203], v47 offset:10240
    v_mfma_f32_16x16x32_bf16 v[112:115], v[208:211], v[168:171], v[112:115]
    v_mfma_f32_16x16x32_bf16 v[108:111], v[204:207], v[168:171], v[108:111]
    v_mfma_f32_16x16x32_bf16 v[124:127], v[204:207], v[172:175], v[124:127]
    v_mfma_f32_16x16x32_bf16 v[128:131], v[208:211], v[172:175], v[128:131]
    v_mfma_f32_16x16x32_bf16 v[132:135], v[212:215], v[172:175], v[132:135]
    v_mfma_f32_16x16x32_bf16 v[136:139], v[216:219], v[172:175], v[136:139]
    v_mfma_f32_16x16x32_bf16 v[152:155], v[216:219], v[176:179], v[152:155]
    v_mfma_f32_16x16x32_bf16 v[148:151], v[212:215], v[176:179], v[148:151]
    v_mfma_f32_16x16x32_bf16 v[144:147], v[208:211], v[176:179], v[144:147]
    v_mfma_f32_16x16x32_bf16 v[140:143], v[204:207], v[176:179], v[140:143]
    s_waitcnt lgkmcnt(0)
    s_barrier
    v_mfma_f32_16x16x32_bf16 v[60:63], v[220:223], v[180:183], v[60:63]
    ds_read_b64_tr_b16 v[204:205], v48 offset:0
    v_mfma_f32_16x16x32_bf16 v[64:67], v[224:227], v[180:183], v[64:67]
    ds_read_b64_tr_b16 v[206:207], v48 offset:1024
    v_mfma_f32_16x16x32_bf16 v[68:71], v[228:231], v[180:183], v[68:71]
    ds_read_b128 v[156:159], v44 offset:0
    v_mfma_f32_16x16x32_bf16 v[72:75], v[232:235], v[180:183], v[72:75]
    ds_read_b64_tr_b16 v[208:209], v49 offset:0
    v_mfma_f32_16x16x32_bf16 v[88:91], v[232:235], v[184:187], v[88:91]
    ds_read_b64_tr_b16 v[210:211], v49 offset:1024
    v_mfma_f32_16x16x32_bf16 v[84:87], v[228:231], v[184:187], v[84:87]
    ds_read_b128 v[160:163], v44 offset:2048
    v_mfma_f32_16x16x32_bf16 v[80:83], v[224:227], v[184:187], v[80:83]
    ds_read_b64_tr_b16 v[212:213], v50 offset:0
    v_mfma_f32_16x16x32_bf16 v[76:79], v[220:223], v[184:187], v[76:79]
    ds_read_b64_tr_b16 v[214:215], v50 offset:1024
    v_mfma_f32_16x16x32_bf16 v[92:95], v[220:223], v[188:191], v[92:95]
    ds_read_b128 v[164:167], v44 offset:4096
    v_mfma_f32_16x16x32_bf16 v[96:99], v[224:227], v[188:191], v[96:99]
    ds_read_b64_tr_b16 v[216:217], v51 offset:0
    v_mfma_f32_16x16x32_bf16 v[100:103], v[228:231], v[188:191], v[100:103]
    ds_read_b64_tr_b16 v[218:219], v51 offset:1024
    v_mfma_f32_16x16x32_bf16 v[104:107], v[232:235], v[188:191], v[104:107]
    ds_read_b128 v[168:171], v44 offset:6144
    v_mfma_f32_16x16x32_bf16 v[120:123], v[232:235], v[192:195], v[120:123]
    ds_read_b128 v[172:175], v44 offset:8192
    v_mfma_f32_16x16x32_bf16 v[116:119], v[228:231], v[192:195], v[116:119]
    ds_read_b128 v[176:179], v44 offset:10240
    v_mfma_f32_16x16x32_bf16 v[112:115], v[224:227], v[192:195], v[112:115]
    v_mfma_f32_16x16x32_bf16 v[108:111], v[220:223], v[192:195], v[108:111]
    v_mfma_f32_16x16x32_bf16 v[124:127], v[220:223], v[196:199], v[124:127]
    v_mfma_f32_16x16x32_bf16 v[128:131], v[224:227], v[196:199], v[128:131]
    v_mfma_f32_16x16x32_bf16 v[132:135], v[228:231], v[196:199], v[132:135]
    v_mfma_f32_16x16x32_bf16 v[136:139], v[232:235], v[196:199], v[136:139]
    v_mfma_f32_16x16x32_bf16 v[152:155], v[232:235], v[200:203], v[152:155]
    v_mfma_f32_16x16x32_bf16 v[148:151], v[228:231], v[200:203], v[148:151]
    v_mfma_f32_16x16x32_bf16 v[144:147], v[224:227], v[200:203], v[144:147]
    v_mfma_f32_16x16x32_bf16 v[140:143], v[220:223], v[200:203], v[140:143]
    s_waitcnt lgkmcnt(0)
    v_mfma_f32_16x16x32_bf16 v[60:63], v[204:207], v[156:159], v[60:63]
    ds_read_b64_tr_b16 v[220:221], v48 offset:8192
    v_mfma_f32_16x16x32_bf16 v[64:67], v[208:211], v[156:159], v[64:67]
    ds_read_b64_tr_b16 v[222:223], v48 offset:9216
    v_mfma_f32_16x16x32_bf16 v[68:71], v[212:215], v[156:159], v[68:71]
    ds_read_b128 v[180:183], v45 offset:0
    v_mfma_f32_16x16x32_bf16 v[72:75], v[216:219], v[156:159], v[72:75]
    ds_read_b64_tr_b16 v[224:225], v49 offset:8192
    v_mfma_f32_16x16x32_bf16 v[88:91], v[216:219], v[160:163], v[88:91]
    ds_read_b64_tr_b16 v[226:227], v49 offset:9216
    v_mfma_f32_16x16x32_bf16 v[84:87], v[212:215], v[160:163], v[84:87]
    ds_read_b128 v[184:187], v45 offset:2048
    v_mfma_f32_16x16x32_bf16 v[80:83], v[208:211], v[160:163], v[80:83]
    ds_read_b64_tr_b16 v[228:229], v50 offset:8192
    v_mfma_f32_16x16x32_bf16 v[76:79], v[204:207], v[160:163], v[76:79]
    ds_read_b64_tr_b16 v[230:231], v50 offset:9216
    v_mfma_f32_16x16x32_bf16 v[92:95], v[204:207], v[164:167], v[92:95]
    ds_read_b128 v[188:191], v45 offset:4096
    v_mfma_f32_16x16x32_bf16 v[96:99], v[208:211], v[164:167], v[96:99]
    ds_read_b64_tr_b16 v[232:233], v51 offset:8192
    v_mfma_f32_16x16x32_bf16 v[100:103], v[212:215], v[164:167], v[100:103]
    ds_read_b64_tr_b16 v[234:235], v51 offset:9216
    v_mfma_f32_16x16x32_bf16 v[104:107], v[216:219], v[164:167], v[104:107]
    ds_read_b128 v[192:195], v45 offset:6144
    v_mfma_f32_16x16x32_bf16 v[120:123], v[216:219], v[168:171], v[120:123]
    ds_read_b128 v[196:199], v45 offset:8192
    v_mfma_f32_16x16x32_bf16 v[116:119], v[212:215], v[168:171], v[116:119]
    ds_read_b128 v[200:203], v45 offset:10240
    v_mfma_f32_16x16x32_bf16 v[112:115], v[208:211], v[168:171], v[112:115]
    v_mfma_f32_16x16x32_bf16 v[108:111], v[204:207], v[168:171], v[108:111]
    v_mfma_f32_16x16x32_bf16 v[124:127], v[204:207], v[172:175], v[124:127]
    v_mfma_f32_16x16x32_bf16 v[128:131], v[208:211], v[172:175], v[128:131]
    v_mfma_f32_16x16x32_bf16 v[132:135], v[212:215], v[172:175], v[132:135]
    v_mfma_f32_16x16x32_bf16 v[136:139], v[216:219], v[172:175], v[136:139]
    v_mfma_f32_16x16x32_bf16 v[152:155], v[216:219], v[176:179], v[152:155]
    v_mfma_f32_16x16x32_bf16 v[148:151], v[212:215], v[176:179], v[148:151]
    v_mfma_f32_16x16x32_bf16 v[144:147], v[208:211], v[176:179], v[144:147]
    v_mfma_f32_16x16x32_bf16 v[140:143], v[204:207], v[176:179], v[140:143]
    s_waitcnt lgkmcnt(0)
    s_barrier
    v_mfma_f32_16x16x32_bf16 v[60:63], v[220:223], v[180:183], v[60:63]
    ds_read_b64_tr_b16 v[204:205], v48 offset:40960
    v_mfma_f32_16x16x32_bf16 v[64:67], v[224:227], v[180:183], v[64:67]
    ds_read_b64_tr_b16 v[206:207], v48 offset:41984
    v_mfma_f32_16x16x32_bf16 v[68:71], v[228:231], v[180:183], v[68:71]
    ds_read_b128 v[156:159], v44 offset:40960
    v_mfma_f32_16x16x32_bf16 v[72:75], v[232:235], v[180:183], v[72:75]
    ds_read_b64_tr_b16 v[208:209], v49 offset:40960
    v_mfma_f32_16x16x32_bf16 v[88:91], v[232:235], v[184:187], v[88:91]
    ds_read_b64_tr_b16 v[210:211], v49 offset:41984
    v_mfma_f32_16x16x32_bf16 v[84:87], v[228:231], v[184:187], v[84:87]
    ds_read_b128 v[160:163], v44 offset:43008
    v_mfma_f32_16x16x32_bf16 v[80:83], v[224:227], v[184:187], v[80:83]
    ds_read_b64_tr_b16 v[212:213], v50 offset:40960
    v_mfma_f32_16x16x32_bf16 v[76:79], v[220:223], v[184:187], v[76:79]
    ds_read_b64_tr_b16 v[214:215], v50 offset:41984
    v_mfma_f32_16x16x32_bf16 v[92:95], v[220:223], v[188:191], v[92:95]
    ds_read_b128 v[164:167], v44 offset:45056
    v_mfma_f32_16x16x32_bf16 v[96:99], v[224:227], v[188:191], v[96:99]
    ds_read_b64_tr_b16 v[216:217], v51 offset:40960
    v_mfma_f32_16x16x32_bf16 v[100:103], v[228:231], v[188:191], v[100:103]
    ds_read_b64_tr_b16 v[218:219], v51 offset:41984
    v_mfma_f32_16x16x32_bf16 v[104:107], v[232:235], v[188:191], v[104:107]
    ds_read_b128 v[168:171], v44 offset:47104
    v_mfma_f32_16x16x32_bf16 v[120:123], v[232:235], v[192:195], v[120:123]
    ds_read_b128 v[172:175], v44 offset:49152
    v_mfma_f32_16x16x32_bf16 v[116:119], v[228:231], v[192:195], v[116:119]
    ds_read_b128 v[176:179], v44 offset:51200
    v_mfma_f32_16x16x32_bf16 v[112:115], v[224:227], v[192:195], v[112:115]
    s_sub_u32 s54, s54, 1
    v_mfma_f32_16x16x32_bf16 v[108:111], v[220:223], v[192:195], v[108:111]
    s_cmp_lg_u32 s54, 0
    v_mfma_f32_16x16x32_bf16 v[124:127], v[220:223], v[196:199], v[124:127]
    v_mfma_f32_16x16x32_bf16 v[128:131], v[224:227], v[196:199], v[128:131]
    v_mfma_f32_16x16x32_bf16 v[132:135], v[228:231], v[196:199], v[132:135]
    v_mfma_f32_16x16x32_bf16 v[136:139], v[232:235], v[196:199], v[136:139]
    v_mfma_f32_16x16x32_bf16 v[152:155], v[232:235], v[200:203], v[152:155]
    v_mfma_f32_16x16x32_bf16 v[148:151], v[228:231], v[200:203], v[148:151]
    v_mfma_f32_16x16x32_bf16 v[144:147], v[224:227], v[200:203], v[144:147]
    v_mfma_f32_16x16x32_bf16 v[140:143], v[220:223], v[200:203], v[140:143]
    s_cbranch_scc1 K_CLOOP
    s_waitcnt lgkmcnt(0)
    v_mfma_f32_16x16x32_bf16 v[60:63], v[204:207], v[156:159], v[60:63]
    ds_read_b128 v[180:183], v45 offset:40960
    ds_read_b64_tr_b16 v[220:221], v48 offset:49152
    v_mfma_f32_16x16x32_bf16 v[64:67], v[208:211], v[156:159], v[64:67]
    ds_read_b64_tr_b16 v[222:223], v48 offset:50176
    ds_read_b64_tr_b16 v[224:225], v49 offset:49152
    v_mfma_f32_16x16x32_bf16 v[68:71], v[212:215], v[156:159], v[68:71]
    ds_read_b64_tr_b16 v[226:227], v49 offset:50176
    ds_read_b64_tr_b16 v[228:229], v50 offset:49152
    v_mfma_f32_16x16x32_bf16 v[72:75], v[216:219], v[156:159], v[72:75]
    ds_read_b64_tr_b16 v[230:231], v50 offset:50176
    ds_read_b64_tr_b16 v[232:233], v51 offset:49152
    v_mfma_f32_16x16x32_bf16 v[76:79], v[204:207], v[160:163], v[76:79]
    ds_read_b64_tr_b16 v[234:235], v51 offset:50176
    ds_read_b128 v[184:187], v45 offset:43008
    v_mfma_f32_16x16x32_bf16 v[80:83], v[208:211], v[160:163], v[80:83]
    ds_read_b128 v[188:191], v45 offset:45056
    ds_read_b128 v[192:195], v45 offset:47104
    v_mfma_f32_16x16x32_bf16 v[84:87], v[212:215], v[160:163], v[84:87]
    ds_read_b128 v[196:199], v45 offset:49152
    ds_read_b128 v[200:203], v45 offset:51200
    v_mfma_f32_16x16x32_bf16 v[88:91], v[216:219], v[160:163], v[88:91]
    s_waitcnt lgkmcnt(11)
    v_mfma_f32_16x16x32_bf16 v[60:63], v[220:223], v[180:183], v[60:63]
    s_nop 1
    s_waitcnt lgkmcnt(9)
    v_mfma_f32_16x16x32_bf16 v[64:67], v[224:227], v[180:183], v[64:67]
    s_nop 1
    s_waitcnt lgkmcnt(7)
    v_mfma_f32_16x16x32_bf16 v[68:71], v[228:231], v[180:183], v[68:71]
    v_cvt_pk_bf16_f32 v60, v60, v61
    v_cvt_pk_bf16_f32 v61, v62, v63
    s_waitcnt lgkmcnt(5)
    v_mfma_f32_16x16x32_bf16 v[72:75], v[232:235], v[180:183], v[72:75]
    ds_write_b64 v56, v[60:61] offset:0
    s_waitcnt lgkmcnt(5)
    v_mfma_f32_16x16x32_bf16 v[76:79], v[220:223], v[184:187], v[76:79]
    v_cvt_pk_bf16_f32 v64, v64, v65
    v_cvt_pk_bf16_f32 v65, v66, v67
    v_mfma_f32_16x16x32_bf16 v[80:83], v[224:227], v[184:187], v[80:83]
    ds_write_b64 v56, v[64:65] offset:32
    v_mfma_f32_16x16x32_bf16 v[84:87], v[228:231], v[184:187], v[84:87]
    v_cvt_pk_bf16_f32 v68, v68, v69
    v_cvt_pk_bf16_f32 v69, v70, v71
    v_mfma_f32_16x16x32_bf16 v[88:91], v[232:235], v[184:187], v[88:91]
    ds_write_b64 v56, v[68:69] offset:64
    v_mfma_f32_16x16x32_bf16 v[92:95], v[204:207], v[164:167], v[92:95]
    v_cvt_pk_bf16_f32 v72, v72, v73
    v_cvt_pk_bf16_f32 v73, v74, v75
    v_mfma_f32_16x16x32_bf16 v[96:99], v[208:211], v[164:167], v[96:99]
    ds_write_b64 v56, v[72:73] offset:96
    v_mfma_f32_16x16x32_bf16 v[100:103], v[212:215], v[164:167], v[100:103]
    v_cvt_pk_bf16_f32 v76, v76, v77
    v_cvt_pk_bf16_f32 v77, v78, v79
    v_mfma_f32_16x16x32_bf16 v[104:107], v[216:219], v[164:167], v[104:107]
    ds_write_b64 v56, v[76:77] offset:4352
    s_waitcnt lgkmcnt(8)
    v_mfma_f32_16x16x32_bf16 v[92:95], v[220:223], v[188:191], v[92:95]
    v_cvt_pk_bf16_f32 v80, v80, v81
    v_cvt_pk_bf16_f32 v81, v82, v83
    v_mfma_f32_16x16x32_bf16 v[96:99], v[224:227], v[188:191], v[96:99]
    ds_write_b64 v56, v[80:81] offset:4384
    v_mfma_f32_16x16x32_bf16 v[100:103], v[228:231], v[188:191], v[100:103]
    v_cvt_pk_bf16_f32 v84, v84, v85
    v_cvt_pk_bf16_f32 v85, v86, v87
    v_mfma_f32_16x16x32_bf16 v[104:107], v[232:235], v[188:191], v[104:107]
    ds_write_b64 v56, v[84:85] offset:4416
    v_mfma_f32_16x16x32_bf16 v[108:111], v[204:207], v[168:171], v[108:111]
    v_cvt_pk_bf16_f32 v88, v88, v89
    v_cvt_pk_bf16_f32 v89, v90, v91
    v_mfma_f32_16x16x32_bf16 v[112:115], v[208:211], v[168:171], v[112:115]
    ds_write_b64 v56, v[88:89] offset:4448
    v_mfma_f32_16x16x32_bf16 v[116:119], v[212:215], v[168:171], v[116:119]
    v_cvt_pk_bf16_f32 v92, v92, v93
    v_cvt_pk_bf16_f32 v93, v94, v95
    v_mfma_f32_16x16x32_bf16 v[120:123], v[216:219], v[168:171], v[120:123]
    ds_write_b64 v56, v[92:93] offset:8704
    s_waitcnt lgkmcnt(11)
    v_mfma_f32_16x16x32_bf16 v[108:111], v[220:223], v[192:195], v[108:111]
    v_cvt_pk_bf16_f32 v96, v96, v97
    v_cvt_pk_bf16_f32 v97, v98, v99
    v_mfma_f32_16x16x32_bf16 v[112:115], v[224:227], v[192:195], v[112:115]
    ds_write_b64 v56, v[96:97] offset:8736
    v_mfma_f32_16x16x32_bf16 v[116:119], v[228:231], v[192:195], v[116:119]
    v_cvt_pk_bf16_f32 v100, v100, v101
    v_cvt_pk_bf16_f32 v101, v102, v103
    v_mfma_f32_16x16x32_bf16 v[120:123], v[232:235], v[192:195], v[120:123]
    ds_write_b64 v56, v[100:101] offset:8768
    v_mfma_f32_16x16x32_bf16 v[124:127], v[204:207], v[172:175], v[124:127]
    v_cvt_pk_bf16_f32 v104, v104, v105
    v_cvt_pk_bf16_f32 v105, v106, v107
    v_mfma_f32_16x16x32_bf16 v[128:131], v[208:211], v[172:175], v[128:131]
    ds_write_b64 v56, v[104:105] offset:8800
    v_mfma_f32_16x16x32_bf16 v[132:135], v[212:215], v[172:175], v[132:135]
    v_cvt_pk_bf16_f32 v108, v108, v109
    v_cvt_pk_bf16_f32 v109, v110, v111
    v_mfma_f32_16x16x32_bf16 v[136:139], v[216:219], v[172:175], v[136:139]
    ds_write_b64 v56, v[108:109] offset:13056
    s_waitcnt lgkmcnt(14)
    v_mfma_f32_16x16x32_bf16 v[124:127], v[220:223], v[196:199], v[124:127]
    v_cvt_pk_bf16_f32 v112, v112, v113
    v_cvt_pk_bf16_f32 v113, v114, v115
    v_mfma_f32_16x16x32_bf16 v[128:131], v[224:227], v[196:199], v[128:131]
    ds_write_b64 v56, v[112:113] offset:13088
    v_mfma_f32_16x16x32_bf16 v[132:135], v[228:231], v[196:199], v[132:135]
    v_cvt_pk_bf16_f32 v116, v116, v117
    v_cvt_pk_bf16_f32 v117, v118, v119
    v_mfma_f32_16x16x32_bf16 v[136:139], v[232:235], v[196:199], v[136:139]
    ds_write_b64 v56, v[116:117] offset:13120
    v_mfma_f32_16x16x32_bf16 v[140:143], v[204:207], v[176:179], v[140:143]
    v_cvt_pk_bf16_f32 v120, v120, v121
    v_cvt_pk_bf16_f32 v121, v122, v123
    v_mfma_f32_16x16x32_bf16 v[144:147], v[208:211], v[176:179], v[144:147]
    ds_write_b64 v56, v[120:121] offset:13152
    v_mfma_f32_16x16x32_bf16 v[148:151], v[212:215], v[176:179], v[148:151]
    v_cvt_pk_bf16_f32 v124, v124, v125
    v_cvt_pk_bf16_f32 v125, v126, v127
    v_mfma_f32_16x16x32_bf16 v[152:155], v[216:219], v[176:179], v[152:155]
    ds_write_b64 v56, v[124:125] offset:17408
    s_waitcnt lgkmcnt(15)
    v_mfma_f32_16x16x32_bf16 v[140:143], v[220:223], v[200:203], v[140:143]
    v_cvt_pk_bf16_f32 v128, v128, v129
    v_cvt_pk_bf16_f32 v129, v130, v131
    v_mfma_f32_16x16x32_bf16 v[144:147], v[224:227], v[200:203], v[144:147]
    ds_write_b64 v56, v[128:129] offset:17440
    v_mfma_f32_16x16x32_bf16 v[148:151], v[228:231], v[200:203], v[148:151]
    v_cvt_pk_bf16_f32 v132, v132, v133
    v_cvt_pk_bf16_f32 v133, v134, v135
    v_mfma_f32_16x16x32_bf16 v[152:155], v[232:235], v[200:203], v[152:155]
    ds_write_b64 v56, v[132:133] offset:17472
    v_cvt_pk_bf16_f32 v136, v136, v137
    v_cvt_pk_bf16_f32 v137, v138, v139
    v_cvt_pk_bf16_f32 v140, v140, v141
    v_cvt_pk_bf16_f32 v141, v142, v143
    v_cvt_pk_bf16_f32 v144, v144, v145
    v_cvt_pk_bf16_f32 v145, v146, v147
    v_cvt_pk_bf16_f32 v148, v148, v149
    v_cvt_pk_bf16_f32 v149, v150, v151
    v_cvt_pk_bf16_f32 v152, v152, v153
    v_cvt_pk_bf16_f32 v153, v154, v155
    ds_write_b64 v56, v[136:137] offset:17504
    ds_write_b64 v56, v[140:141] offset:21760
    ds_write_b64 v56, v[144:145] offset:21792
    ds_write_b64 v56, v[148:149] offset:21824
    ds_write_b64 v56, v[152:153] offset:21856
    s_setprio 0
    s_branch WS_attd
.p2align 12
WP_attd:
    s_setpc_b64 s[38:39]
WS_attd:
    s_waitcnt lgkmcnt(0)
    s_barrier
    ds_read_b64 v[60:61], v13 offset:80
    ds_read_b64 v[62:63], v14 offset:80
    ds_read_b64 v[44:45], v13 offset:4352
    ds_read_b64 v[46:47], v19 offset:4352
    ds_read_b64 v[64:65], v13 offset:4432
    ds_read_b64 v[66:67], v14 offset:4432
    ds_read_b64 v[72:73], v13 offset:120
    ds_read_b64 v[74:75], v14 offset:120
    ds_read_b64 v[48:49], v13 offset:4392
    ds_read_b64 v[50:51], v20 offset:4352
    ds_read_b64 v[76:77], v13 offset:4472
    ds_read_b64 v[78:79], v14 offset:4472
    ds_read_b64 v[52:53], v13 offset:8704
    ds_read_b64 v[54:55], v19 offset:8704
    ds_read_b64 v[68:69], v13 offset:8784
    ds_read_b64 v[70:71], v14 offset:8784
    s_waitcnt lgkmcnt(10)
    v_mfma_f32_16x16x32_bf16 v[116:119], v[60:63], v[44:47], v[36:39]
    v_mfma_f32_16x16x32_bf16 v[120:123], v[64:67], v[44:47], v[32:35]
    ds_read_b64 v[56:57], v13 offset:8744
    ds_read_b64 v[58:59], v20 offset:8704
    ds_read_b64 v[80:81], v13 offset:8824
    ds_read_b64 v[82:83], v14 offset:8824
    s_waitcnt lgkmcnt(8)
    v_mfma_f32_16x16x32_bf16 v[124:127], v[72:75], v[48:51], v[36:39]
    v_mfma_f32_16x16x32_bf16 v[128:131], v[76:79], v[48:51], v[32:35]
    s_waitcnt lgkmcnt(4)
    v_mfma_f32_16x16x32_bf16 v[132:135], v[64:67], v[52:55], v[28:31]
    v_mfma_f32_16x16x32_bf16 v[136:139], v[68:71], v[52:55], v[32:35]
    s_waitcnt lgkmcnt(0)
    v_mfma_f32_16x16x32_bf16 v[140:143], v[76:79], v[56:59], v[28:31]
    v_mfma_f32_16x16x32_bf16 v[144:147], v[80:83], v[56:59], v[32:35]
    ds_read_b64_tr_b16 v[84:85], v15 offset:160
    ds_read_b64_tr_b16 v[86:87], v15 offset:4512
    ds_read_b64_tr_b16 v[100:101], v21 offset:0
    ds_read_b64_tr_b16 v[102:103], v21 offset:4352
    v_max3_f32 v184, v116, v117, v120
    ds_read_b64_tr_b16 v[92:93], v15 offset:200
    v_max3_f32 v185, v118, v119, v122
    ds_read_b64_tr_b16 v[94:95], v15 offset:4552
    v_max_f32 v184, v184, v121
    ds_read_b64_tr_b16 v[104:105], v22 offset:0
    v_max_f32 v185, v185, v123
    ds_read_b64_tr_b16 v[106:107], v22 offset:4352
    v_max3_f32 v186, v124, v125, v128
    ds_read_b64_tr_b16 v[88:89], v15 offset:8864
    v_max3_f32 v187, v126, v127, v130
    ds_read_b64_tr_b16 v[108:109], v23 offset:4352
    v_max_f32 v186, v186, v129
    ds_read_b64_tr_b16 v[110:111], v23 offset:8704
    v_max_f32 v187, v187, v131
    ds_read_b64_tr_b16 v[96:97], v15 offset:8904
    v_max3_f32 v188, v132, v133, v136
    ds_read_b64_tr_b16 v[112:113], v24 offset:4352
    v_max3_f32 v189, v134, v135, v138
    ds_read_b64_tr_b16 v[114:115], v24 offset:8704
    v_max_f32 v188, v188, v137
    v_max_f32 v189, v189, v139
    v_max3_f32 v190, v140, v141, v144
    v_max3_f32 v191, v142, v143, v146
    v_max_f32 v190, v190, v145
    v_max_f32 v191, v191, v147
    v_cvt_pk_bf16_f32 v192, v184, v185
    v_cvt_pk_bf16_f32 v193, v186, v187
    v_cvt_pk_bf16_f32 v194, v188, v189
    v_cvt_pk_bf16_f32 v195, v190, v191
    v_lshlrev_b32 v184, 16, v192
    v_and_b32 v185, 0xffff0000, v192
    v_lshlrev_b32 v186, 16, v193
    v_and_b32 v187, 0xffff0000, v193
    v_lshlrev_b32 v188, 16, v194
    v_and_b32 v189, 0xffff0000, v194
    v_lshlrev_b32 v190, 16, v195
    v_and_b32 v191, 0xffff0000, v195
    v_pk_mul_f32 v[184:185], v[184:185], s[48:49]
    v_pk_mul_f32 v[186:187], v[186:187], s[48:49]
    v_pk_mul_f32 v[188:189], v[188:189], s[48:49]
    v_pk_mul_f32 v[190:191], v[190:191], s[48:49]
    v_cvt_pk_bf16_f32 v192, v184, v185
    v_cvt_pk_bf16_f32 v193, v186, v187
    v_cvt_pk_bf16_f32 v194, v188, v189
    v_cvt_pk_bf16_f32 v195, v190, v191
    v_permlane16_swap_b32 v192, v193
    s_nop 0
    v_permlane16_swap_b32 v194, v195
    s_nop 1
    v_permlane32_swap_b32 v192, v194
    v_permlane32_swap_b32 v193, v195
    v_lshlrev_b32 v184, 16, v192
    v_and_b32 v185, 0xffff0000, v192
    v_lshlrev_b32 v188, 16, v194
    v_and_b32 v189, 0xffff0000, v194
    v_lshlrev_b32 v186, 16, v193
    v_and_b32 v187, 0xffff0000, v193
    v_lshlrev_b32 v190, 16, v195
    v_and_b32 v191, 0xffff0000, v195
    v_max3_f32 v196, v184, v185, v188
    v_max3_f32 v197, v189, v186, v187
    v_max3_f32 v196, v196, v190, v191
    v_max_f32 v196, v196, v197
    v_mul_f32 v196, s46, v196
    v_pk_fma_f32 v[184:185], v[184:185], s[46:47], v[196:197] op_sel_hi:[1,1,0] neg_lo:[0,0,1] neg_hi:[0,0,1]
    v_pk_fma_f32 v[186:187], v[186:187], s[46:47], v[196:197] op_sel_hi:[1,1,0] neg_lo:[0,0,1] neg_hi:[0,0,1]
    v_pk_fma_f32 v[188:189], v[188:189], s[46:47], v[196:197] op_sel_hi:[1,1,0] neg_lo:[0,0,1] neg_hi:[0,0,1]
    v_pk_fma_f32 v[190:191], v[190:191], s[46:47], v[196:197] op_sel_hi:[1,1,0] neg_lo:[0,0,1] neg_hi:[0,0,1]
    v_exp_f32 v184, v184
    v_exp_f32 v185, v185
    v_exp_f32 v186, v186
    v_exp_f32 v187, v187
    v_exp_f32 v188, v188
    v_exp_f32 v189, v189
    v_exp_f32 v190, v190
    v_exp_f32 v191, v191
    v_pk_add_f32 v[200:201], v[184:185], v[186:187]
    v_pk_add_f32 v[202:203], v[188:189], v[190:191]
    v_pk_add_f32 v[200:201], v[200:201], v[202:203]
    v_add_f32 v200, v200, v201
    v_rcp_f32 v200, v200
    s_waitcnt lgkmcnt(0)
    v_pk_mul_f32 v[184:185], v[184:185], v[200:201] op_sel_hi:[1,0]
    v_pk_mul_f32 v[186:187], v[186:187], v[200:201] op_sel_hi:[1,0]
    v_pk_mul_f32 v[188:189], v[188:189], v[200:201] op_sel_hi:[1,0]
    v_pk_mul_f32 v[190:191], v[190:191], v[200:201] op_sel_hi:[1,0]
    v_cvt_pk_bf16_f32 v192, v184, v185
    v_cvt_pk_bf16_f32 v194, v188, v189
    v_cvt_pk_bf16_f32 v193, v186, v187
    v_cvt_pk_bf16_f32 v195, v190, v191
    v_permlane32_swap_b32 v192, v194
    s_nop 0
    v_permlane32_swap_b32 v193, v195
    s_nop 1
    v_permlane16_swap_b32 v192, v193
    v_permlane16_swap_b32 v194, v195
    v_perm_b32 v148, v192, v192, v40
    v_perm_b32 v149, v192, v192, v41
    v_perm_b32 v150, v192, v192, v42
    v_perm_b32 v151, v192, v192, v43
    v_perm_b32 v152, v193, v193, v40
    v_perm_b32 v153, v193, v193, v41
    v_perm_b32 v154, v193, v193, v42
    v_perm_b32 v155, v193, v193, v43
    v_mfma_f32_16x16x32_bf16 v[164:167], v[84:87], v[148:151], 0
    v_mfma_f32_16x16x32_bf16 v[180:183], v[100:103], v[148:151], 0
    v_perm_b32 v156, v194, v194, v40
    v_perm_b32 v157, v194, v194, v41
    v_perm_b32 v158, v194, v194, v42
    v_perm_b32 v159, v194, v194, v43
    v_mfma_f32_16x16x32_bf16 v[168:171], v[92:95], v[152:155], 0
    v_mfma_f32_16x16x32_bf16 v[180:183], v[104:107], v[152:155], v[180:183]
    v_perm_b32 v160, v195, v195, v40
    v_perm_b32 v161, v195, v195, v41
    v_perm_b32 v162, v195, v195, v42
    v_perm_b32 v163, v195, v195, v43
    v_mfma_f32_16x16x32_bf16 v[172:175], v[86:89], v[156:159], 0
    v_mfma_f32_16x16x32_bf16 v[180:183], v[108:111], v[156:159], v[180:183]
    v_mfma_f32_16x16x32_bf16 v[176:179], v[94:97], v[160:163], 0
    v_mfma_f32_16x16x32_bf16 v[180:183], v[112:115], v[160:163], v[180:183]
    v_cvt_pk_bf16_f32 v204, v164, v165
    v_cvt_pk_bf16_f32 v205, v166, v167
    v_cvt_pk_bf16_f32 v206, v168, v169
    v_cvt_pk_bf16_f32 v207, v170, v171
    buffer_store_dwordx4 v[204:207], v16, s[20:23], s50 offen sc1
    v_cvt_pk_bf16_f32 v208, v172, v173
    v_cvt_pk_bf16_f32 v209, v174, v175
    v_cvt_pk_bf16_f32 v210, v176, v177
    v_cvt_pk_bf16_f32 v211, v178, v179
    buffer_store_dwordx4 v[208:211], v16, s[20:23], s51 offen sc1
    v_cvt_pk_bf16_f32 v196, v180, v181
    v_cvt_pk_bf16_f32 v197, v182, v183
    buffer_store_dwordx2 v[196:197], v17, s[20:23], s50 offen sc1
    s_cmp_lg_u32 s34, -1
    s_cbranch_scc1 K_P2_EARLY
K_DRAIN:
    s_waitcnt vmcnt(0)
    s_barrier
    s_branch K_END
K_W7:
    s_waitcnt vmcnt(26)
    v_and_b32 v4, 7, v1
    v_lshlrev_b32 v4, 2, v4
    s_mov_b32 s3, 131072
K_ZPOLL5:
    v_cmp_eq_u32 vcc, 0, v7
    s_cbranch_vccz K_ZOK5
    s_sub_u32 s3, s3, 1
    s_cbranch_scc1 K_ZOK5
    global_load_dword v7, v4, s[8:9] offset:192 sc1
    s_waitcnt vmcnt(0)
    s_branch K_ZPOLL5
K_ZOK5:
    v_mov_b32 v4, 158720
    v_mov_b32 v3, 1
    s_mov_b64 exec, 1
    s_nop 0
    ds_add_rtn_u32 v2, v4, v3 offset:48
    s_mov_b32 exec_lo, s36
    v_mov_b32 v3, 1
    s_waitcnt lgkmcnt(0)
    v_readfirstlane_b32 s33, v2
    s_nop 3
    s_and_b32 s33, s33, 0xff
    s_cmp_lg_u32 s33, 7
    s_cbranch_scc1 K_ARR7
    global_store_dword v8, v3, s[10:11] sc1
K_ARR7:
    s_mov_b64 exec, -1
    v_mov_b32 v3, 0x100
    s_mov_b64 exec, 1
    s_waitcnt vmcnt(0)
    ds_add_u32 v4, v3 offset:48
    s_mov_b64 exec, -1
    s_branch K_P2_HELP
K_FLAG:
    s_waitcnt vmcnt(0)
    v_and_b32 v4, 7, v1
    v_lshlrev_b32 v4, 2, v4
    s_mov_b32 s3, 131072
K_ZPOLL0:
    v_cmp_eq_u32 vcc, 0, v7
    s_cbranch_vccz K_ZOK0
    s_sub_u32 s3, s3, 1
    s_cbranch_scc1 K_ZOK0
    global_load_dword v7, v4, s[8:9] offset:192 sc1
    s_waitcnt vmcnt(0)
    s_branch K_ZPOLL0
K_ZOK0:
    v_mov_b32 v3, 1
    s_mov_b32 exec_lo, s36
    s_mov_b32 exec_hi, 0
    s_setprio 3
    s_barrier
    global_store_dword v8, v3, s[10:11] sc1
    s_mov_b64 exec, -1
    s_branch K_END
WP_atts:
    s_setpc_b64 s[38:39]
K_JOIN_S:
    s_setprio 0
    s_barrier
    s_cmp_eq_u32 s30, 7
    s_cbranch_scc1 K_FLAG
    ds_read_b64 v[52:53], v13 offset:80
    ds_read_b64 v[54:55], v14 offset:80
    ds_read_b64 v[44:45], v13 offset:4352
    ds_read_b64 v[46:47], v19 offset:4352
    ds_read_b64 v[56:57], v13 offset:4432
    ds_read_b64 v[58:59], v14 offset:4432
    ds_read_b64 v[60:61], v13 offset:120
    ds_read_b64 v[62:63], v14 offset:120
    ds_read_b64 v[48:49], v13 offset:4392
    ds_read_b64 v[50:51], v20 offset:4352
    ds_read_b64 v[64:65], v13 offset:4472
    ds_read_b64 v[66:67], v14 offset:4472
    s_waitcnt lgkmcnt(6)
    v_mfma_f32_16x16x32_bf16 v[84:87], v[52:55], v[44:47], v[36:39]
    v_mfma_f32_16x16x32_bf16 v[88:91], v[56:59], v[44:47], v[32:35]
    s_waitcnt lgkmcnt(0)
    v_mfma_f32_16x16x32_bf16 v[92:95], v[60:63], v[48:51], v[36:39]
    v_mfma_f32_16x16x32_bf16 v[96:99], v[64:67], v[48:51], v[32:35]
    ds_read_b64_tr_b16 v[68:69], v15 offset:160
    ds_read_b64_tr_b16 v[70:71], v15 offset:4512
    ds_read_b64_tr_b16 v[76:77], v21 offset:0
    ds_read_b64_tr_b16 v[78:79], v21 offset:4352
    ds_read_b64_tr_b16 v[72:73], v15 offset:200
    ds_read_b64_tr_b16 v[74:75], v15 offset:4552
    ds_read_b64_tr_b16 v[80:81], v22 offset:0
    ds_read_b64_tr_b16 v[82:83], v22 offset:4352
    v_max3_f32 v120, v84, v85, v88
    v_max3_f32 v121, v86, v87, v90
    v_max_f32 v120, v120, v89
    v_max_f32 v121, v121, v91
    v_max3_f32 v122, v92, v93, v96
    v_max3_f32 v123, v94, v95, v98
    v_max_f32 v122, v122, v97
    v_max_f32 v123, v123, v99
    v_cvt_pk_bf16_f32 v124, v120, v121
    v_cvt_pk_bf16_f32 v125, v122, v123
    v_lshlrev_b32 v120, 16, v124
    v_and_b32 v121, 0xffff0000, v124
    v_lshlrev_b32 v122, 16, v125
    v_and_b32 v123, 0xffff0000, v125
    v_pk_mul_f32 v[120:121], v[120:121], s[48:49]
    v_pk_mul_f32 v[122:123], v[122:123], s[48:49]
    v_cvt_pk_bf16_f32 v124, v120, v121
    v_cvt_pk_bf16_f32 v125, v122, v123
    s_nop 1
    v_permlane16_swap_b32 v124, v125
    v_lshlrev_b32 v120, 16, v124
    v_and_b32 v121, 0xffff0000, v124
    v_lshlrev_b32 v122, 16, v125
    v_and_b32 v123, 0xffff0000, v125
    v_max3_f32 v126, v120, v121, v122
    v_max_f32 v126, v126, v123
    v_mov_b32 v127, v126
    s_nop 1
    v_permlane32_swap_b32 v126, v127
    v_max_f32 v126, v126, v127
    v_mul_f32 v126, s46, v126
    v_pk_fma_f32 v[120:121], v[120:121], s[46:47], v[126:127] op_sel_hi:[1,1,0] neg_lo:[0,0,1] neg_hi:[0,0,1]
    v_pk_fma_f32 v[122:123], v[122:123], s[46:47], v[126:127] op_sel_hi:[1,1,0] neg_lo:[0,0,1] neg_hi:[0,0,1]
    v_exp_f32 v120, v120
    v_exp_f32 v121, v121
    v_exp_f32 v122, v122
    v_exp_f32 v123, v123
    s_nop 0
    v_pk_add_f32 v[128:129], v[120:121], v[122:123]
    v_add_f32 v128, v128, v129
    v_mov_b32 v129, v128
    s_nop 1
    v_permlane32_swap_b32 v128, v129
    v_add_f32 v128, v128, v129
    v_rcp_f32 v128, v128
    s_waitcnt lgkmcnt(0)
    v_pk_mul_f32 v[120:121], v[120:121], v[128:129] op_sel_hi:[1,0]
    v_pk_mul_f32 v[122:123], v[122:123], v[128:129] op_sel_hi:[1,0]
    v_cvt_pk_bf16_f32 v124, v120, v121
    v_cvt_pk_bf16_f32 v125, v122, v123
    s_nop 1
    v_permlane16_swap_b32 v124, v125
    v_perm_b32 v100, v124, v124, v40
    v_perm_b32 v101, v124, v124, v41
    v_perm_b32 v102, v124, v124, v42
    v_perm_b32 v103, v124, v124, v43
    v_perm_b32 v104, v125, v125, v40
    v_perm_b32 v105, v125, v125, v41
    v_perm_b32 v106, v125, v125, v42
    v_perm_b32 v107, v125, v125, v43
    v_mfma_f32_16x16x32_bf16 v[108:111], v[68:71], v[100:103], 0
    v_mfma_f32_16x16x32_bf16 v[116:119], v[76:79], v[100:103], 0
    v_mfma_f32_16x16x32_bf16 v[112:115], v[72:75], v[104:107], 0
    v_mfma_f32_16x16x32_bf16 v[116:119], v[80:83], v[104:107], v[116:119]
    s_nop 4
    v_cvt_pk_bf16_f32 v132, v108, v109
    v_cvt_pk_bf16_f32 v133, v110, v111
    v_cvt_pk_bf16_f32 v134, v112, v113
    v_cvt_pk_bf16_f32 v135, v114, v115
    buffer_store_dwordx4 v[132:135], v16, s[20:23], s50 offen sc1
    v_cvt_pk_bf16_f32 v126, v116, v117
    v_cvt_pk_bf16_f32 v127, v118, v119
    buffer_store_dwordx2 v[126:127], v17, s[20:23], s50 offen sc1
    s_cmp_eq_u32 s34, -1
    s_cbranch_scc1 K_DRAIN
    s_cmp_lg_u32 s30, 6
    s_cbranch_scc1 K_NOFL
    s_waitcnt vmcnt(12)
    v_and_b32 v4, 7, v1
    v_lshlrev_b32 v4, 2, v4
    s_mov_b32 s3, 131072
K_ZPOLL2:
    v_cmp_eq_u32 vcc, 0, v7
    s_cbranch_vccz K_ZOK2
    s_sub_u32 s3, s3, 1
    s_cbranch_scc1 K_ZOK2
    global_load_dword v7, v4, s[8:9] offset:192 sc1
    s_waitcnt vmcnt(0)
    s_branch K_ZPOLL2
K_ZOK2:
    v_and_b32 v2, 1, v1
    v_lshl_add_u32 v2, v2, 2, s42
    global_load_dword v7, v2, s[10:11] offset:128 sc1
K_NOFL:
    v_mov_b32 v4, 158720
    v_mov_b32 v3, 257
    s_mov_b64 exec, 1
    s_waitcnt vmcnt(0)
    ds_add_rtn_u32 v2, v4, v3 offset:48
    s_mov_b32 exec_lo, s36
    v_mov_b32 v3, 1
    s_waitcnt lgkmcnt(0)
    v_readfirstlane_b32 s33, v2
    s_nop 3
    s_and_b32 s33, s33, 0xff
    s_cmp_lg_u32 s33, 7
    s_cbranch_scc1 K_ARRS
    global_store_dword v8, v3, s[10:11] sc1
K_ARRS:
    s_mov_b64 exec, -1
    s_cmp_ge_u32 s30, 6
    s_cbranch_scc1 K_P2_HELP
    s_branch K_LATE
WP_early:
    s_setpc_b64 s[38:39]
K_P2_EARLY:
    s_lshl_b32 s54, s40, 7
    v_lshrrev_b32 v9, 4, v1
    v_mov_b32 v12, 158720
    s_add_u32 s20, s10, 0x100000
    s_addc_u32 s21, s11, 0
    s_mov_b32 s22, 0x280000
    s_mov_b32 s23, 0x20000
    s_add_u32 s16, s10, 0x1000
    s_addc_u32 s17, s11, 0
    s_mov_b32 s18, 0x2000
    s_mov_b32 s19, 0x20000
    s_mov_b32 s48, s6
    s_mov_b32 s49, s7
    s_mov_b32 s50, 0x280000
    s_mov_b32 s51, 0x20000
    s_lshl_b32 s53, s40, 3
    s_lshl1_add_u32 s53, s30, s53
    s_mov_b32 s55, 20480
    v_bfe_u32 v20, v1, 2, 2
    v_and_b32 v21, 3, v1
    s_mul_i32 s3, s53, 20480
    v_lshl_add_u32 v25, v1, 4, s3
    v_add_u32 v26, 20480, v25
    v_and_b32 v2, 15, v1
    s_lshl_b32 s3, s53, 6
    v_lshl_add_u32 v23, v2, 2, s3
    v_lshl_add_u32 v2, v9, 2, v20
    v_bfe_u32 v3, v2, 1, 2
    v_lshlrev_b32 v2, 7, v2
    v_lshl_add_u32 v2, v21, 3, v2
    v_lshl_add_u32 v24, v3, 5, v2
    v_lshrrev_b32 v3, 1, v20
    v_mul_u32_u24 v2, 40, v9
    v_add3_u32 v2, v2, 16, v20
    v_lshlrev_b32 v2, 7, v2
    v_lshl_add_u32 v2, v21, 3, v2
    v_xor_b32 v4, 0, v3
    v_lshl_add_u32 v56, v4, 5, v2
    v_xor_b32 v4, 1, v3
    v_lshl_add_u32 v57, v4, 5, v2
    v_xor_b32 v4, 2, v3
    v_lshl_add_u32 v58, v4, 5, v2
    v_xor_b32 v4, 3, v3
    v_lshl_add_u32 v59, v4, 5, v2
    v_lshrrev_b32 v3, 4, v1
    v_and_b32 v4, 7, v1
    v_lshrrev_b32 v2, 3, v1
    v_xor_b32 v4, v4, v3
    v_mul_u32_u24 v2, 1280, v2
    v_lshl_add_u32 v27, v4, 4, v2
    v_xor_b32 v28, 64, v27
    s_lshl_b32 s71, s40, 3
    s_lshl1_add_u32 s71, s30, s71
    s_mul_i32 s71, s71, 20480
    s_lshl_b32 s33, s41, 7
    s_add_u32 s71, s71, s33
    s_add_u32 s72, s71, 10240
    s_add_u32 s73, s71, 20480
    s_add_u32 s74, s71, 30720
    s_lshl_b32 s3, s30, 12
    s_add_u32 s3, s3, 140288
    v_lshl_add_u32 v33, v1, 4, s3
    v_and_b32 v2, 15, v1
    v_lshrrev_b32 v3, 1, v2
    v_lshrrev_b32 v4, 5, v1
    v_xor_b32 v3, v3, v4
    v_lshlrev_b32 v3, 4, v3
    v_lshl_add_u32 v3, v2, 7, v3
    v_and_b32 v4, 1, v9
    v_lshl_add_u32 v3, v4, 3, v3
    v_add_u32 v29, s3, v3
    v_xor_b32 v30, 32, v29
    v_xor_b32 v31, 64, v29
    v_xor_b32 v32, 96, v29
    s_and_b32 s33, s40, 3
    s_lshl_b32 s33, s33, 3
    s_lshr_b32 s33, 0x7f06037f, s33
    s_and_b32 s33, s33, 0xff
    s_lshl_b32 s3, s30, 1
    s_cmp_ge_u32 s3, s33
    s_cselect_b32 s64, 16, 0
    s_add_u32 s3, s3, 1
    s_cmp_ge_u32 s3, s33
    s_cselect_b32 s65, 16, 0
    s_mov_b32 s63, 0
    s_mov_b32 s66, 0
    s_mov_b32 s67, 16384
    v_mov_b32 v34, 0
    v_mov_b32 v4, 158720
    v_mov_b32 v3, 1
    s_mov_b64 exec, 1
    s_waitcnt vmcnt(0)
    ds_add_rtn_u32 v2, v4, v3 offset:48
    s_mov_b32 exec_lo, s36
    v_mov_b32 v3, 1
    s_waitcnt lgkmcnt(0)
    v_readfirstlane_b32 s33, v2
    s_nop 3
    s_and_b32 s33, s33, 0xff
    s_cmp_lg_u32 s33, 7
    s_cbranch_scc1 K_ARRD
    global_store_dword v8, v3, s[10:11] sc1
K_ARRD:
    s_mov_b64 exec, -1
    s_mov_b32 s3, 1048576
K_P2_GE:
    ds_read_b32 v2, v12 offset:48
    s_sub_u32 s3, s3, 1
    s_waitcnt lgkmcnt(0)
    v_readfirstlane_b32 s33, v2
    s_nop 3
    s_cselect_b32 s33, 1024, s33
    s_cmp_lt_u32 s33, 1024
    s_cbranch_scc1 K_P2_GE
K_P2_GEMM:
    s_setprio 0
    s_mov_b32 s3, 1048576
K_P2_GS:
    ds_read_b32 v2, v12 offset:40
    s_sub_u32 s3, s3, 1
    s_waitcnt lgkmcnt(0)
    v_readfirstlane_b32 s33, v2
    s_nop 3
    s_cselect_b32 s33, 1, s33
    s_cmp_lt_u32 s33, 1
    s_cbranch_scc1 K_P2_GS
    buffer_load_dword v60, v23, s[16:19], 0 offen offset:0 sc1
    buffer_load_dword v62, v23, s[16:19], 0 offen offset:64 sc1
    ds_read_b128 v[16:19], v12
    ds_read_b64 v[36:37], v29 offset:0
    ds_read_b64 v[38:39], v30 offset:0
    ds_read_b64 v[40:41], v31 offset:0
    ds_read_b64 v[42:43], v32 offset:0
    ds_read_b64 v[44:45], v29 offset:2048
    ds_read_b64 v[46:47], v30 offset:2048
    ds_read_b64 v[48:49], v31 offset:2048
    ds_read_b64 v[50:51], v32 offset:2048
    s_waitcnt lgkmcnt(4)
    v_lshlrev_b32 v68, 16, v36
    v_and_b32 v69, 0xffff0000, v36
    v_lshlrev_b32 v70, 16, v37
    v_and_b32 v71, 0xffff0000, v37
    v_lshlrev_b32 v72, 16, v38
    v_and_b32 v73, 0xffff0000, v38
    v_lshlrev_b32 v74, 16, v39
    v_and_b32 v75, 0xffff0000, v39
    v_lshlrev_b32 v76, 16, v40
    v_and_b32 v77, 0xffff0000, v40
    v_lshlrev_b32 v78, 16, v41
    v_and_b32 v79, 0xffff0000, v41
    v_lshlrev_b32 v80, 16, v42
    v_and_b32 v81, 0xffff0000, v42
    v_lshlrev_b32 v82, 16, v43
    v_and_b32 v83, 0xffff0000, v43
    s_waitcnt lgkmcnt(0)
    v_lshlrev_b32 v84, 16, v44
    v_and_b32 v85, 0xffff0000, v44
    v_lshlrev_b32 v86, 16, v45
    v_and_b32 v87, 0xffff0000, v45
    v_lshlrev_b32 v88, 16, v46
    v_and_b32 v89, 0xffff0000, v46
    v_lshlrev_b32 v90, 16, v47
    v_and_b32 v91, 0xffff0000, v47
    v_lshlrev_b32 v92, 16, v48
    v_and_b32 v93, 0xffff0000, v48
    v_lshlrev_b32 v94, 16, v49
    v_and_b32 v95, 0xffff0000, v49
    v_lshlrev_b32 v96, 16, v50
    v_and_b32 v97, 0xffff0000, v50
    v_lshlrev_b32 v98, 16, v51
    v_and_b32 v99, 0xffff0000, v51
    s_cmp_eq_u32 s63, 0
    s_cbranch_scc1 K_SP0
K_SPR0:
    s_ff1_i32_b32 s33, s63
    s_bitset0_b32 s63, s33
    s_lshl_b32 s75, s33, 10
    buffer_load_dwordx4 v[100:103], v25, s[20:23], s75 offen offset:0 sc1
    buffer_load_dwordx4 v[104:107], v26, s[20:23], s75 offen offset:0 sc1
    v_mad_u32_u24 v52, s75, 5, v24
    v_xor_b32 v54, 64, v52
    v_xor_b32 v53, 32, v52
    v_xor_b32 v55, 96, v52
    ds_read_b64_tr_b16 v[180:181], v52 offset:0
    ds_read_b64_tr_b16 v[182:183], v54 offset:2560
    ds_read_b64_tr_b16 v[184:185], v53 offset:0
    ds_read_b64_tr_b16 v[186:187], v55 offset:2560
    ds_read_b64_tr_b16 v[188:189], v54 offset:0
    ds_read_b64_tr_b16 v[190:191], v52 offset:2560
    ds_read_b64_tr_b16 v[192:193], v55 offset:0
    ds_read_b64_tr_b16 v[194:195], v53 offset:2560
    s_cmp_eq_u32 s63, 0
    s_cbranch_scc1 K_SP1
K_SPR1:
    s_ff1_i32_b32 s33, s63
    s_bitset0_b32 s63, s33
    s_lshl_b32 s76, s33, 10
    buffer_load_dwordx4 v[108:111], v25, s[20:23], s76 offen offset:0 sc1
    buffer_load_dwordx4 v[112:115], v26, s[20:23], s76 offen offset:0 sc1
    v_mad_u32_u24 v52, s76, 5, v24
    v_xor_b32 v54, 64, v52
    v_xor_b32 v53, 32, v52
    v_xor_b32 v55, 96, v52
    ds_read_b64_tr_b16 v[196:197], v52 offset:0
    ds_read_b64_tr_b16 v[198:199], v54 offset:2560
    ds_read_b64_tr_b16 v[200:201], v53 offset:0
    ds_read_b64_tr_b16 v[202:203], v55 offset:2560
    ds_read_b64_tr_b16 v[204:205], v54 offset:0
    ds_read_b64_tr_b16 v[206:207], v52 offset:2560
    ds_read_b64_tr_b16 v[208:209], v55 offset:0
    ds_read_b64_tr_b16 v[210:211], v53 offset:2560
    s_waitcnt vmcnt(4)
    s_mov_b64 exec, 1
    ds_add_u32 v12, v34 offset:44
    s_mov_b64 exec, -1
    v_sub_f32 v64, 1.0, v60
    v_cvt_pk_bf16_f32 v64, v64, v64
    v_lshlrev_b32 v64, 16, v64
    v_sub_f32 v66, 1.0, v62
    v_cvt_pk_bf16_f32 v66, v66, v66
    v_lshlrev_b32 v66, 16, v66
    v_pk_mul_f32 v[68:69], v[68:69], v[64:65] op_sel_hi:[1,0]
    v_pk_mul_f32 v[70:71], v[70:71], v[64:65] op_sel_hi:[1,0]
    v_pk_mul_f32 v[72:73], v[72:73], v[64:65] op_sel_hi:[1,0]
    v_pk_mul_f32 v[74:75], v[74:75], v[64:65] op_sel_hi:[1,0]
    v_pk_mul_f32 v[76:77], v[76:77], v[64:65] op_sel_hi:[1,0]
    v_pk_mul_f32 v[78:79], v[78:79], v[64:65] op_sel_hi:[1,0]
    v_pk_mul_f32 v[80:81], v[80:81], v[64:65] op_sel_hi:[1,0]
    v_pk_mul_f32 v[82:83], v[82:83], v[64:65] op_sel_hi:[1,0]
    v_pk_mul_f32 v[84:85], v[84:85], v[66:67] op_sel_hi:[1,0]
    v_pk_mul_f32 v[86:87], v[86:87], v[66:67] op_sel_hi:[1,0]
    v_pk_mul_f32 v[88:89], v[88:89], v[66:67] op_sel_hi:[1,0]
    v_pk_mul_f32 v[90:91], v[90:91], v[66:67] op_sel_hi:[1,0]
    v_pk_mul_f32 v[92:93], v[92:93], v[66:67] op_sel_hi:[1,0]
    v_pk_mul_f32 v[94:95], v[94:95], v[66:67] op_sel_hi:[1,0]
    v_pk_mul_f32 v[96:97], v[96:97], v[66:67] op_sel_hi:[1,0]
    v_pk_mul_f32 v[98:99], v[98:99], v[66:67] op_sel_hi:[1,0]
    s_cmp_eq_u32 s63, 0
    s_cbranch_scc1 K_SP2
K_SPR2:
    s_ff1_i32_b32 s33, s63
    s_bitset0_b32 s63, s33
    s_lshl_b32 s77, s33, 10
    buffer_load_dwordx4 v[116:119], v25, s[20:23], s77 offen offset:0 sc1
    buffer_load_dwordx4 v[120:123], v26, s[20:23], s77 offen offset:0 sc1
    s_cmp_eq_u32 s63, 0
    s_cbranch_scc1 K_SP3
K_SPR3:
    s_ff1_i32_b32 s33, s63
    s_bitset0_b32 s63, s33
    s_lshl_b32 s78, s33, 10
    buffer_load_dwordx4 v[124:127], v25, s[20:23], s78 offen offset:0 sc1
    buffer_load_dwordx4 v[128:131], v26, s[20:23], s78 offen offset:0 sc1
    s_cmp_eq_u32 s63, 0
    s_cbranch_scc1 K_SP4
K_SPR4:
    s_ff1_i32_b32 s33, s63
    s_bitset0_b32 s63, s33
    s_lshl_b32 s75, s33, 10
    buffer_load_dwordx4 v[132:135], v25, s[20:23], s75 offen offset:0 sc1
    buffer_load_dwordx4 v[136:139], v26, s[20:23], s75 offen offset:0 sc1
    s_branch WS_p2g
.p2align 12
WP_p2g:
    s_setpc_b64 s[38:39]
WS_p2g:
    s_waitcnt vmcnt(8) lgkmcnt(9)
    v_mfma_f32_16x16x32_bf16 v[148:151], v[180:183], v[100:103], 0
    v_mad_u32_u24 v52, s77, 5, v24
    v_xor_b32 v54, 64, v52
    v_xor_b32 v53, 32, v52
    v_mfma_f32_16x16x32_bf16 v[164:167], v[180:183], v[104:107], 0
    v_xor_b32 v55, 96, v52
    ds_read_b64_tr_b16 v[212:213], v52 offset:0
    ds_read_b64_tr_b16 v[214:215], v54 offset:2560
    v_mfma_f32_16x16x32_bf16 v[152:155], v[184:187], v[100:103], 0
    ds_read_b64_tr_b16 v[216:217], v53 offset:0
    ds_read_b64_tr_b16 v[218:219], v55 offset:2560
    ds_read_b64_tr_b16 v[220:221], v54 offset:0
    v_mfma_f32_16x16x32_bf16 v[168:171], v[184:187], v[104:107], 0
    ds_read_b64_tr_b16 v[222:223], v52 offset:2560
    ds_read_b64_tr_b16 v[224:225], v55 offset:0
    v_mfma_f32_16x16x32_bf16 v[156:159], v[188:191], v[100:103], 0
    ds_read_b64_tr_b16 v[226:227], v53 offset:2560
    s_cmp_eq_u32 s63, 0
    v_mfma_f32_16x16x32_bf16 v[172:175], v[188:191], v[104:107], 0
    s_cbranch_scc1 K_SP5
K_SPR5:
    s_ff1_i32_b32 s33, s63
    v_mfma_f32_16x16x32_bf16 v[160:163], v[192:195], v[100:103], 0
    s_bitset0_b32 s63, s33
    s_lshl_b32 s76, s33, 10
    v_mfma_f32_16x16x32_bf16 v[176:179], v[192:195], v[104:107], 0
    buffer_load_dwordx4 v[140:143], v25, s[20:23], s76 offen offset:0 sc1
    buffer_load_dwordx4 v[144:147], v26, s[20:23], s76 offen offset:0 sc1
    s_waitcnt vmcnt(8) lgkmcnt(9)
    v_mfma_f32_16x16x32_bf16 v[148:151], v[196:199], v[108:111], v[148:151]
    v_mad_u32_u24 v52, s78, 5, v24
    v_xor_b32 v54, 64, v52
    v_xor_b32 v53, 32, v52
    v_mfma_f32_16x16x32_bf16 v[164:167], v[196:199], v[112:115], v[164:167]
    v_xor_b32 v55, 96, v52
    ds_read_b64_tr_b16 v[180:181], v52 offset:0
    ds_read_b64_tr_b16 v[182:183], v54 offset:2560
    v_mfma_f32_16x16x32_bf16 v[152:155], v[200:203], v[108:111], v[152:155]
    ds_read_b64_tr_b16 v[184:185], v53 offset:0
    ds_read_b64_tr_b16 v[186:187], v55 offset:2560
    ds_read_b64_tr_b16 v[188:189], v54 offset:0
    v_mfma_f32_16x16x32_bf16 v[168:171], v[200:203], v[112:115], v[168:171]
    ds_read_b64_tr_b16 v[190:191], v52 offset:2560
    ds_read_b64_tr_b16 v[192:193], v55 offset:0
    v_mfma_f32_16x16x32_bf16 v[156:159], v[204:207], v[108:111], v[156:159]
    ds_read_b64_tr_b16 v[194:195], v53 offset:2560
    s_cmp_eq_u32 s63, 0
    v_mfma_f32_16x16x32_bf16 v[172:175], v[204:207], v[112:115], v[172:175]
    s_cbranch_scc1 K_SP6
K_SPR6:
    s_ff1_i32_b32 s33, s63
    v_mfma_f32_16x16x32_bf16 v[160:163], v[208:211], v[108:111], v[160:163]
    s_bitset0_b32 s63, s33
    s_lshl_b32 s77, s33, 10
    v_mfma_f32_16x16x32_bf16 v[176:179], v[208:211], v[112:115], v[176:179]
    buffer_load_dwordx4 v[100:103], v25, s[20:23], s77 offen offset:0 sc1
    buffer_load_dwordx4 v[104:107], v26, s[20:23], s77 offen offset:0 sc1
    s_waitcnt vmcnt(8) lgkmcnt(8)
    v_mfma_f32_16x16x32_bf16 v[148:151], v[212:215], v[116:119], v[148:151]
    v_mad_u32_u24 v52, s75, 5, v24
    v_xor_b32 v54, 64, v52
    v_xor_b32 v53, 32, v52
    v_mfma_f32_16x16x32_bf16 v[164:167], v[212:215], v[120:123], v[164:167]
    v_xor_b32 v55, 96, v52
    ds_read_b64_tr_b16 v[196:197], v52 offset:0
    ds_read_b64_tr_b16 v[198:199], v54 offset:2560
    v_mfma_f32_16x16x32_bf16 v[152:155], v[216:219], v[116:119], v[152:155]
    ds_read_b64_tr_b16 v[200:201], v53 offset:0
    ds_read_b64_tr_b16 v[202:203], v55 offset:2560
    ds_read_b64_tr_b16 v[204:205], v54 offset:0
    v_mfma_f32_16x16x32_bf16 v[168:171], v[216:219], v[120:123], v[168:171]
    ds_read_b64_tr_b16 v[206:207], v52 offset:2560
    ds_read_b64_tr_b16 v[208:209], v55 offset:0
    v_mfma_f32_16x16x32_bf16 v[156:159], v[220:223], v[116:119], v[156:159]
    ds_read_b64_tr_b16 v[210:211], v53 offset:2560
    s_cmp_eq_u32 s63, 0
    v_mfma_f32_16x16x32_bf16 v[172:175], v[220:223], v[120:123], v[172:175]
    s_cbranch_scc1 K_SP7
K_SPR7:
    s_ff1_i32_b32 s33, s63
    v_mfma_f32_16x16x32_bf16 v[160:163], v[224:227], v[116:119], v[160:163]
    s_bitset0_b32 s63, s33
    s_lshl_b32 s78, s33, 10
    v_mfma_f32_16x16x32_bf16 v[176:179], v[224:227], v[120:123], v[176:179]
    buffer_load_dwordx4 v[108:111], v25, s[20:23], s78 offen offset:0 sc1
    buffer_load_dwordx4 v[112:115], v26, s[20:23], s78 offen offset:0 sc1
    s_waitcnt vmcnt(8) lgkmcnt(8)
    v_mfma_f32_16x16x32_bf16 v[148:151], v[180:183], v[124:127], v[148:151]
    v_mad_u32_u24 v52, s76, 5, v24
    v_xor_b32 v54, 64, v52
    v_mfma_f32_16x16x32_bf16 v[164:167], v[180:183], v[128:131], v[164:167]
    v_xor_b32 v53, 32, v52
    v_xor_b32 v55, 96, v52
    v_mfma_f32_16x16x32_bf16 v[152:155], v[184:187], v[124:127], v[152:155]
    ds_read_b64_tr_b16 v[212:213], v52 offset:0
    ds_read_b64_tr_b16 v[214:215], v54 offset:2560
    v_mfma_f32_16x16x32_bf16 v[168:171], v[184:187], v[128:131], v[168:171]
    ds_read_b64_tr_b16 v[216:217], v53 offset:0
    ds_read_b64_tr_b16 v[218:219], v55 offset:2560
    v_mfma_f32_16x16x32_bf16 v[156:159], v[188:191], v[124:127], v[156:159]
    ds_read_b64_tr_b16 v[220:221], v54 offset:0
    ds_read_b64_tr_b16 v[222:223], v52 offset:2560
    v_mfma_f32_16x16x32_bf16 v[172:175], v[188:191], v[128:131], v[172:175]
    ds_read_b64_tr_b16 v[224:225], v55 offset:0
    ds_read_b64_tr_b16 v[226:227], v53 offset:2560
    v_mfma_f32_16x16x32_bf16 v[160:163], v[192:195], v[124:127], v[160:163]
    buffer_load_dwordx4 v[116:119], v25, s[20:23], s67 offen offset:0 sc1
    buffer_load_dwordx4 v[120:123], v26, s[20:23], s67 offen offset:0 sc1
    v_mfma_f32_16x16x32_bf16 v[176:179], v[192:195], v[128:131], v[176:179]
    s_waitcnt vmcnt(8) lgkmcnt(8)
    v_mfma_f32_16x16x32_bf16 v[148:151], v[196:199], v[132:135], v[148:151]
    v_mad_u32_u24 v52, s77, 5, v24
    v_xor_b32 v54, 64, v52
    v_mfma_f32_16x16x32_bf16 v[164:167], v[196:199], v[136:139], v[164:167]
    v_xor_b32 v53, 32, v52
    v_xor_b32 v55, 96, v52
    v_mfma_f32_16x16x32_bf16 v[152:155], v[200:203], v[132:135], v[152:155]
    ds_read_b64_tr_b16 v[180:181], v52 offset:0
    ds_read_b64_tr_b16 v[182:183], v54 offset:2560
    v_mfma_f32_16x16x32_bf16 v[168:171], v[200:203], v[136:139], v[168:171]
    ds_read_b64_tr_b16 v[184:185], v53 offset:0
    ds_read_b64_tr_b16 v[186:187], v55 offset:2560
    v_mfma_f32_16x16x32_bf16 v[156:159], v[204:207], v[132:135], v[156:159]
    ds_read_b64_tr_b16 v[188:189], v54 offset:0
    ds_read_b64_tr_b16 v[190:191], v52 offset:2560
    v_mfma_f32_16x16x32_bf16 v[172:175], v[204:207], v[136:139], v[172:175]
    ds_read_b64_tr_b16 v[192:193], v55 offset:0
    ds_read_b64_tr_b16 v[194:195], v53 offset:2560
    v_mfma_f32_16x16x32_bf16 v[160:163], v[208:211], v[132:135], v[160:163]
    buffer_load_dwordx4 v[124:127], v25, s[20:23], s67 offen offset:1024 sc1
    buffer_load_dwordx4 v[128:131], v26, s[20:23], s67 offen offset:1024 sc1
    v_mfma_f32_16x16x32_bf16 v[176:179], v[208:211], v[136:139], v[176:179]
    s_waitcnt vmcnt(8) lgkmcnt(8)
    v_mfma_f32_16x16x32_bf16 v[148:151], v[212:215], v[140:143], v[148:151]
    v_mad_u32_u24 v52, s78, 5, v24
    v_xor_b32 v54, 64, v52
    v_xor_b32 v53, 32, v52
    v_mfma_f32_16x16x32_bf16 v[164:167], v[212:215], v[144:147], v[164:167]
    v_xor_b32 v55, 96, v52
    ds_read_b64_tr_b16 v[196:197], v52 offset:0
    ds_read_b64_tr_b16 v[198:199], v54 offset:2560
    v_mfma_f32_16x16x32_bf16 v[152:155], v[216:219], v[140:143], v[152:155]
    ds_read_b64_tr_b16 v[200:201], v53 offset:0
    ds_read_b64_tr_b16 v[202:203], v55 offset:2560
    ds_read_b64_tr_b16 v[204:205], v54 offset:0
    v_mfma_f32_16x16x32_bf16 v[168:171], v[216:219], v[144:147], v[168:171]
    ds_read_b64_tr_b16 v[206:207], v52 offset:2560
    ds_read_b64_tr_b16 v[208:209], v55 offset:0
    v_mfma_f32_16x16x32_bf16 v[156:159], v[220:223], v[140:143], v[156:159]
    ds_read_b64_tr_b16 v[210:211], v53 offset:2560
    s_cmp_eq_u32 s63, 0
    v_mfma_f32_16x16x32_bf16 v[172:175], v[220:223], v[144:147], v[172:175]
    s_cbranch_scc1 K_SP10
K_SPR10:
    s_ff1_i32_b32 s33, s63
    v_mfma_f32_16x16x32_bf16 v[160:163], v[224:227], v[140:143], v[160:163]
    s_bitset0_b32 s63, s33
    s_lshl_b32 s77, s33, 10
    v_mfma_f32_16x16x32_bf16 v[176:179], v[224:227], v[144:147], v[176:179]
    buffer_load_dwordx4 v[132:135], v25, s[20:23], s77 offen offset:0 sc1
    buffer_load_dwordx4 v[136:139], v26, s[20:23], s77 offen offset:0 sc1
    s_waitcnt vmcnt(8) lgkmcnt(8)
    v_mfma_f32_16x16x32_bf16 v[148:151], v[180:183], v[100:103], v[148:151]
    ds_read_b64_tr_b16 v[212:213], v56 offset:0
    ds_read_b64_tr_b16 v[214:215], v58 offset:2560
    v_mfma_f32_16x16x32_bf16 v[164:167], v[180:183], v[104:107], v[164:167]
    ds_read_b64_tr_b16 v[216:217], v57 offset:0
    ds_read_b64_tr_b16 v[218:219], v59 offset:2560
    v_mfma_f32_16x16x32_bf16 v[152:155], v[184:187], v[100:103], v[152:155]
    ds_read_b64_tr_b16 v[220:221], v58 offset:0
    ds_read_b64_tr_b16 v[222:223], v56 offset:2560
    v_mfma_f32_16x16x32_bf16 v[168:171], v[184:187], v[104:107], v[168:171]
    ds_read_b64_tr_b16 v[224:225], v59 offset:0
    ds_read_b64_tr_b16 v[226:227], v57 offset:2560
    v_mfma_f32_16x16x32_bf16 v[156:159], v[188:191], v[100:103], v[156:159]
    s_cmp_eq_u32 s63, 0
    s_cbranch_scc1 K_SP11
K_SPR11:
    v_mfma_f32_16x16x32_bf16 v[172:175], v[188:191], v[104:107], v[172:175]
    s_ff1_i32_b32 s33, s63
    s_bitset0_b32 s63, s33
    v_mfma_f32_16x16x32_bf16 v[160:163], v[192:195], v[100:103], v[160:163]
    s_lshl_b32 s78, s33, 10
    buffer_load_dwordx4 v[140:143], v25, s[20:23], s78 offen offset:0 sc1
    v_mfma_f32_16x16x32_bf16 v[176:179], v[192:195], v[104:107], v[176:179]
    buffer_load_dwordx4 v[144:147], v26, s[20:23], s78 offen offset:0 sc1
    s_waitcnt vmcnt(8) lgkmcnt(8)
    v_mfma_f32_16x16x32_bf16 v[148:151], v[196:199], v[108:111], v[148:151]
    ds_read_b64_tr_b16 v[180:181], v56 offset:20480
    ds_read_b64_tr_b16 v[182:183], v58 offset:23040
    v_mfma_f32_16x16x32_bf16 v[164:167], v[196:199], v[112:115], v[164:167]
    ds_read_b64_tr_b16 v[184:185], v57 offset:20480
    ds_read_b64_tr_b16 v[186:187], v59 offset:23040
    v_mfma_f32_16x16x32_bf16 v[152:155], v[200:203], v[108:111], v[152:155]
    ds_read_b64_tr_b16 v[188:189], v58 offset:20480
    ds_read_b64_tr_b16 v[190:191], v56 offset:23040
    v_mfma_f32_16x16x32_bf16 v[168:171], v[200:203], v[112:115], v[168:171]
    ds_read_b64_tr_b16 v[192:193], v59 offset:20480
    ds_read_b64_tr_b16 v[194:195], v57 offset:23040
    v_mfma_f32_16x16x32_bf16 v[156:159], v[204:207], v[108:111], v[156:159]
    s_cmp_eq_u32 s63, 0
    s_cbranch_scc1 K_SP12
K_SPR12:
    v_mfma_f32_16x16x32_bf16 v[172:175], v[204:207], v[112:115], v[172:175]
    s_ff1_i32_b32 s33, s63
    s_bitset0_b32 s63, s33
    v_mfma_f32_16x16x32_bf16 v[160:163], v[208:211], v[108:111], v[160:163]
    s_lshl_b32 s75, s33, 10
    buffer_load_dwordx4 v[100:103], v25, s[20:23], s75 offen offset:0 sc1
    v_mfma_f32_16x16x32_bf16 v[176:179], v[208:211], v[112:115], v[176:179]
    buffer_load_dwordx4 v[104:107], v26, s[20:23], s75 offen offset:0 sc1
    s_mov_b32 s3, 1048576
K_P2_GW:
    ds_read_b32 v2, v12 offset:44
    s_sub_u32 s3, s3, 1
    s_waitcnt lgkmcnt(0)
    v_readfirstlane_b32 s33, v2
    s_nop 3
    s_cselect_b32 s33, 4, s33
    s_cmp_lt_u32 s33, 4
    s_cbranch_scc1 K_P2_GW
    v_readfirstlane_b32 s56, v16
    v_readfirstlane_b32 s57, v17
    s_lshl_b32 s58, s53, 4
    s_waitcnt vmcnt(8)
    v_mfma_f32_16x16x32_bf16 v[148:151], v[212:215], v[116:119], v[148:151]
    v_mad_u32_u24 v52, s77, 5, v24
    v_xor_b32 v54, 64, v52
    v_xor_b32 v53, 32, v52
    v_mfma_f32_16x16x32_bf16 v[164:167], v[212:215], v[120:123], v[164:167]
    v_xor_b32 v55, 96, v52
    ds_read_b64_tr_b16 v[196:197], v52 offset:0
    ds_read_b64_tr_b16 v[198:199], v54 offset:2560
    v_mfma_f32_16x16x32_bf16 v[152:155], v[216:219], v[116:119], v[152:155]
    ds_read_b64_tr_b16 v[200:201], v53 offset:0
    ds_read_b64_tr_b16 v[202:203], v55 offset:2560
    ds_read_b64_tr_b16 v[204:205], v54 offset:0
    v_mfma_f32_16x16x32_bf16 v[168:171], v[216:219], v[120:123], v[168:171]
    ds_read_b64_tr_b16 v[206:207], v52 offset:2560
    ds_read_b64_tr_b16 v[208:209], v55 offset:0
    v_mfma_f32_16x16x32_bf16 v[156:159], v[220:223], v[116:119], v[156:159]
    ds_read_b64_tr_b16 v[210:211], v53 offset:2560
    s_cmp_eq_u32 s63, 0
    v_mfma_f32_16x16x32_bf16 v[172:175], v[220:223], v[120:123], v[172:175]
    s_cbranch_scc1 K_SP13
K_SPR13:
    s_ff1_i32_b32 s33, s63
    v_mfma_f32_16x16x32_bf16 v[160:163], v[224:227], v[116:119], v[160:163]
    s_bitset0_b32 s63, s33
    s_lshl_b32 s76, s33, 10
    v_mfma_f32_16x16x32_bf16 v[176:179], v[224:227], v[120:123], v[176:179]
    buffer_load_dwordx4 v[108:111], v25, s[20:23], s76 offen offset:0 sc1
    buffer_load_dwordx4 v[112:115], v26, s[20:23], s76 offen offset:0 sc1
    s_waitcnt vmcnt(8)
    v_mfma_f32_16x16x32_bf16 v[148:151], v[180:183], v[124:127], v[148:151]
    v_mad_u32_u24 v52, s78, 5, v24
    v_xor_b32 v54, 64, v52
    v_xor_b32 v53, 32, v52
    v_mfma_f32_16x16x32_bf16 v[164:167], v[180:183], v[128:131], v[164:167]
    v_xor_b32 v55, 96, v52
    ds_read_b64_tr_b16 v[212:213], v52 offset:0
    ds_read_b64_tr_b16 v[214:215], v54 offset:2560
    v_mfma_f32_16x16x32_bf16 v[152:155], v[184:187], v[124:127], v[152:155]
    ds_read_b64_tr_b16 v[216:217], v53 offset:0
    ds_read_b64_tr_b16 v[218:219], v55 offset:2560
    ds_read_b64_tr_b16 v[220:221], v54 offset:0
    v_mfma_f32_16x16x32_bf16 v[168:171], v[184:187], v[128:131], v[168:171]
    ds_read_b64_tr_b16 v[222:223], v52 offset:2560
    ds_read_b64_tr_b16 v[224:225], v55 offset:0
    v_mfma_f32_16x16x32_bf16 v[156:159], v[188:191], v[124:127], v[156:159]
    ds_read_b64_tr_b16 v[226:227], v53 offset:2560
    s_cmp_eq_u32 s63, 0
    v_mfma_f32_16x16x32_bf16 v[172:175], v[188:191], v[128:131], v[172:175]
    s_cbranch_scc1 K_SP14
K_SPR14:
    s_ff1_i32_b32 s33, s63
    v_mfma_f32_16x16x32_bf16 v[160:163], v[192:195], v[124:127], v[160:163]
    s_bitset0_b32 s63, s33
    s_lshl_b32 s77, s33, 10
    v_mfma_f32_16x16x32_bf16 v[176:179], v[192:195], v[128:131], v[176:179]
    buffer_load_dwordx4 v[116:119], v25, s[20:23], s77 offen offset:0 sc1
    buffer_load_dwordx4 v[120:123], v26, s[20:23], s77 offen offset:0 sc1
    s_waitcnt vmcnt(8) lgkmcnt(8)
    v_mfma_f32_16x16x32_bf16 v[148:151], v[196:199], v[132:135], v[148:151]
    v_mad_u32_u24 v52, s75, 5, v24
    v_xor_b32 v54, 64, v52
    v_xor_b32 v53, 32, v52
    v_mfma_f32_16x16x32_bf16 v[164:167], v[196:199], v[136:139], v[164:167]
    v_xor_b32 v55, 96, v52
    ds_read_b64_tr_b16 v[180:181], v52 offset:0
    ds_read_b64_tr_b16 v[182:183], v54 offset:2560
    v_mfma_f32_16x16x32_bf16 v[152:155], v[200:203], v[132:135], v[152:155]
    ds_read_b64_tr_b16 v[184:185], v53 offset:0
    ds_read_b64_tr_b16 v[186:187], v55 offset:2560
    ds_read_b64_tr_b16 v[188:189], v54 offset:0
    v_mfma_f32_16x16x32_bf16 v[168:171], v[200:203], v[136:139], v[168:171]
    ds_read_b64_tr_b16 v[190:191], v52 offset:2560
    ds_read_b64_tr_b16 v[192:193], v55 offset:0
    v_mfma_f32_16x16x32_bf16 v[156:159], v[204:207], v[132:135], v[156:159]
    ds_read_b64_tr_b16 v[194:195], v53 offset:2560
    s_cmp_eq_u32 s63, 0
    v_mfma_f32_16x16x32_bf16 v[172:175], v[204:207], v[136:139], v[172:175]
    s_cbranch_scc1 K_SP15
K_SPR15:
    s_ff1_i32_b32 s33, s63
    v_mfma_f32_16x16x32_bf16 v[160:163], v[208:211], v[132:135], v[160:163]
    s_bitset0_b32 s63, s33
    s_lshl_b32 s78, s33, 10
    v_mfma_f32_16x16x32_bf16 v[176:179], v[208:211], v[136:139], v[176:179]
    buffer_load_dwordx4 v[124:127], v25, s[20:23], s78 offen offset:0 sc1
    buffer_load_dwordx4 v[128:131], v26, s[20:23], s78 offen offset:0 sc1
    s_waitcnt vmcnt(8) lgkmcnt(8)
    v_mfma_f32_16x16x32_bf16 v[148:151], v[212:215], v[140:143], v[148:151]
    v_mad_u32_u24 v52, s76, 5, v24
    v_xor_b32 v54, 64, v52
    v_xor_b32 v53, 32, v52
    v_mfma_f32_16x16x32_bf16 v[164:167], v[212:215], v[144:147], v[164:167]
    v_xor_b32 v55, 96, v52
    ds_read_b64_tr_b16 v[196:197], v52 offset:0
    ds_read_b64_tr_b16 v[198:199], v54 offset:2560
    v_mfma_f32_16x16x32_bf16 v[152:155], v[216:219], v[140:143], v[152:155]
    ds_read_b64_tr_b16 v[200:201], v53 offset:0
    ds_read_b64_tr_b16 v[202:203], v55 offset:2560
    ds_read_b64_tr_b16 v[204:205], v54 offset:0
    v_mfma_f32_16x16x32_bf16 v[168:171], v[216:219], v[144:147], v[168:171]
    ds_read_b64_tr_b16 v[206:207], v52 offset:2560
    ds_read_b64_tr_b16 v[208:209], v55 offset:0
    v_mfma_f32_16x16x32_bf16 v[156:159], v[220:223], v[140:143], v[156:159]
    ds_read_b64_tr_b16 v[210:211], v53 offset:2560
    s_cmp_eq_u32 s63, 0
    v_mfma_f32_16x16x32_bf16 v[172:175], v[220:223], v[144:147], v[172:175]
    s_cbranch_scc1 K_SP16
K_SPR16:
    s_ff1_i32_b32 s33, s63
    v_mfma_f32_16x16x32_bf16 v[160:163], v[224:227], v[140:143], v[160:163]
    s_bitset0_b32 s63, s33
    s_lshl_b32 s75, s33, 10
    v_mfma_f32_16x16x32_bf16 v[176:179], v[224:227], v[144:147], v[176:179]
    buffer_load_dwordx4 v[132:135], v25, s[20:23], s75 offen offset:0 sc1
    buffer_load_dwordx4 v[136:139], v26, s[20:23], s75 offen offset:0 sc1
    s_waitcnt vmcnt(8) lgkmcnt(8)
    v_mfma_f32_16x16x32_bf16 v[148:151], v[180:183], v[100:103], v[148:151]
    v_mad_u32_u24 v52, s77, 5, v24
    v_xor_b32 v54, 64, v52
    v_xor_b32 v53, 32, v52
    v_mfma_f32_16x16x32_bf16 v[164:167], v[180:183], v[104:107], v[164:167]
    v_xor_b32 v55, 96, v52
    ds_read_b64_tr_b16 v[212:213], v52 offset:0
    ds_read_b64_tr_b16 v[214:215], v54 offset:2560
    v_mfma_f32_16x16x32_bf16 v[152:155], v[184:187], v[100:103], v[152:155]
    ds_read_b64_tr_b16 v[216:217], v53 offset:0
    ds_read_b64_tr_b16 v[218:219], v55 offset:2560
    ds_read_b64_tr_b16 v[220:221], v54 offset:0
    v_mfma_f32_16x16x32_bf16 v[168:171], v[184:187], v[104:107], v[168:171]
    ds_read_b64_tr_b16 v[222:223], v52 offset:2560
    ds_read_b64_tr_b16 v[224:225], v55 offset:0
    v_mfma_f32_16x16x32_bf16 v[156:159], v[188:191], v[100:103], v[156:159]
    ds_read_b64_tr_b16 v[226:227], v53 offset:2560
    s_cmp_eq_u32 s63, 0
    v_mfma_f32_16x16x32_bf16 v[172:175], v[188:191], v[104:107], v[172:175]
    s_cbranch_scc1 K_SP17
K_SPR17:
    s_ff1_i32_b32 s33, s63
    v_mfma_f32_16x16x32_bf16 v[160:163], v[192:195], v[100:103], v[160:163]
    s_bitset0_b32 s63, s33
    s_lshl_b32 s76, s33, 10
    v_mfma_f32_16x16x32_bf16 v[176:179], v[192:195], v[104:107], v[176:179]
    buffer_load_dwordx4 v[140:143], v25, s[20:23], s76 offen offset:0 sc1
    buffer_load_dwordx4 v[144:147], v26, s[20:23], s76 offen offset:0 sc1
    s_waitcnt vmcnt(8) lgkmcnt(8)
    v_mfma_f32_16x16x32_bf16 v[148:151], v[196:199], v[108:111], v[148:151]
    v_mad_u32_u24 v52, s78, 5, v24
    v_xor_b32 v54, 64, v52
    v_mfma_f32_16x16x32_bf16 v[164:167], v[196:199], v[112:115], v[164:167]
    v_xor_b32 v53, 32, v52
    v_xor_b32 v55, 96, v52
    v_mfma_f32_16x16x32_bf16 v[152:155], v[200:203], v[108:111], v[152:155]
    ds_read_b64_tr_b16 v[180:181], v52 offset:0
    ds_read_b64_tr_b16 v[182:183], v54 offset:2560
    v_mfma_f32_16x16x32_bf16 v[168:171], v[200:203], v[112:115], v[168:171]
    ds_read_b64_tr_b16 v[184:185], v53 offset:0
    ds_read_b64_tr_b16 v[186:187], v55 offset:2560
    v_mfma_f32_16x16x32_bf16 v[156:159], v[204:207], v[108:111], v[156:159]
    ds_read_b64_tr_b16 v[188:189], v54 offset:0
    ds_read_b64_tr_b16 v[190:191], v52 offset:2560
    v_mfma_f32_16x16x32_bf16 v[172:175], v[204:207], v[112:115], v[172:175]
    ds_read_b64_tr_b16 v[192:193], v55 offset:0
    ds_read_b64_tr_b16 v[194:195], v53 offset:2560
    v_mfma_f32_16x16x32_bf16 v[160:163], v[208:211], v[108:111], v[160:163]
    buffer_load_dwordx4 v[100:103], v25, s[20:23], s67 offen offset:2048 sc1
    buffer_load_dwordx4 v[104:107], v26, s[20:23], s67 offen offset:2048 sc1
    v_mfma_f32_16x16x32_bf16 v[176:179], v[208:211], v[112:115], v[176:179]
    s_waitcnt vmcnt(8) lgkmcnt(8)
    v_mfma_f32_16x16x32_bf16 v[148:151], v[212:215], v[116:119], v[148:151]
    v_mad_u32_u24 v52, s75, 5, v24
    v_xor_b32 v54, 64, v52
    v_mfma_f32_16x16x32_bf16 v[164:167], v[212:215], v[120:123], v[164:167]
    v_xor_b32 v53, 32, v52
    v_xor_b32 v55, 96, v52
    v_mfma_f32_16x16x32_bf16 v[152:155], v[216:219], v[116:119], v[152:155]
    ds_read_b64_tr_b16 v[196:197], v52 offset:0
    ds_read_b64_tr_b16 v[198:199], v54 offset:2560
    v_mfma_f32_16x16x32_bf16 v[168:171], v[216:219], v[120:123], v[168:171]
    ds_read_b64_tr_b16 v[200:201], v53 offset:0
    ds_read_b64_tr_b16 v[202:203], v55 offset:2560
    v_mfma_f32_16x16x32_bf16 v[156:159], v[220:223], v[116:119], v[156:159]
    ds_read_b64_tr_b16 v[204:205], v54 offset:0
    ds_read_b64_tr_b16 v[206:207], v52 offset:2560
    v_mfma_f32_16x16x32_bf16 v[172:175], v[220:223], v[120:123], v[172:175]
    ds_read_b64_tr_b16 v[208:209], v55 offset:0
    ds_read_b64_tr_b16 v[210:211], v53 offset:2560
    v_mfma_f32_16x16x32_bf16 v[160:163], v[224:227], v[116:119], v[160:163]
    buffer_load_dwordx4 v[108:111], v25, s[20:23], s67 offen offset:3072 sc1
    buffer_load_dwordx4 v[112:115], v26, s[20:23], s67 offen offset:3072 sc1
    v_mfma_f32_16x16x32_bf16 v[176:179], v[224:227], v[120:123], v[176:179]
    s_waitcnt vmcnt(8) lgkmcnt(8)
    v_mfma_f32_16x16x32_bf16 v[148:151], v[180:183], v[124:127], v[148:151]
    v_mad_u32_u24 v52, s76, 5, v24
    v_xor_b32 v54, 64, v52
    v_mfma_f32_16x16x32_bf16 v[164:167], v[180:183], v[128:131], v[164:167]
    v_xor_b32 v53, 32, v52
    v_xor_b32 v55, 96, v52
    v_mfma_f32_16x16x32_bf16 v[152:155], v[184:187], v[124:127], v[152:155]
    ds_read_b64_tr_b16 v[212:213], v52 offset:0
    ds_read_b64_tr_b16 v[214:215], v54 offset:2560
    v_mfma_f32_16x16x32_bf16 v[168:171], v[184:187], v[128:131], v[168:171]
    ds_read_b64_tr_b16 v[216:217], v53 offset:0
    ds_read_b64_tr_b16 v[218:219], v55 offset:2560
    v_mfma_f32_16x16x32_bf16 v[156:159], v[188:191], v[124:127], v[156:159]
    ds_read_b64_tr_b16 v[220:221], v54 offset:0
    ds_read_b64_tr_b16 v[222:223], v52 offset:2560
    v_mfma_f32_16x16x32_bf16 v[172:175], v[188:191], v[128:131], v[172:175]
    ds_read_b64_tr_b16 v[224:225], v55 offset:0
    ds_read_b64_tr_b16 v[226:227], v53 offset:2560
    v_mfma_f32_16x16x32_bf16 v[160:163], v[192:195], v[124:127], v[160:163]
    v_mfma_f32_16x16x32_bf16 v[176:179], v[192:195], v[128:131], v[176:179]
    s_waitcnt vmcnt(6) lgkmcnt(8)
    v_mfma_f32_16x16x32_bf16 v[148:151], v[196:199], v[132:135], v[148:151]
    ds_read_b64_tr_b16 v[180:181], v56 offset:40960
    ds_read_b64_tr_b16 v[182:183], v58 offset:43520
    v_mfma_f32_16x16x32_bf16 v[164:167], v[196:199], v[136:139], v[164:167]
    ds_read_b64_tr_b16 v[184:185], v57 offset:40960
    ds_read_b64_tr_b16 v[186:187], v59 offset:43520
    v_mfma_f32_16x16x32_bf16 v[152:155], v[200:203], v[132:135], v[152:155]
    ds_read_b64_tr_b16 v[188:189], v58 offset:40960
    ds_read_b64_tr_b16 v[190:191], v56 offset:43520
    v_mfma_f32_16x16x32_bf16 v[168:171], v[200:203], v[136:139], v[168:171]
    ds_read_b64_tr_b16 v[192:193], v59 offset:40960
    ds_read_b64_tr_b16 v[194:195], v57 offset:43520
    v_mfma_f32_16x16x32_bf16 v[156:159], v[204:207], v[132:135], v[156:159]
    v_mfma_f32_16x16x32_bf16 v[172:175], v[204:207], v[136:139], v[172:175]
    v_mfma_f32_16x16x32_bf16 v[160:163], v[208:211], v[132:135], v[160:163]
    v_mfma_f32_16x16x32_bf16 v[176:179], v[208:211], v[136:139], v[176:179]
    s_waitcnt vmcnt(4) lgkmcnt(8)
    v_mfma_f32_16x16x32_bf16 v[148:151], v[212:215], v[140:143], v[148:151]
    ds_read_b64_tr_b16 v[196:197], v56 offset:61440
    ds_read_b64_tr_b16 v[198:199], v58 offset:64000
    v_mfma_f32_16x16x32_bf16 v[164:167], v[212:215], v[144:147], v[164:167]
    ds_read_b64_tr_b16 v[200:201], v57 offset:61440
    ds_read_b64_tr_b16 v[202:203], v59 offset:64000
    v_mfma_f32_16x16x32_bf16 v[152:155], v[216:219], v[140:143], v[152:155]
    ds_read_b64_tr_b16 v[204:205], v58 offset:61440
    ds_read_b64_tr_b16 v[206:207], v56 offset:64000
    v_mfma_f32_16x16x32_bf16 v[168:171], v[216:219], v[144:147], v[168:171]
    ds_read_b64_tr_b16 v[208:209], v59 offset:61440
    ds_read_b64_tr_b16 v[210:211], v57 offset:64000
    v_mfma_f32_16x16x32_bf16 v[156:159], v[220:223], v[140:143], v[156:159]
    v_mfma_f32_16x16x32_bf16 v[172:175], v[220:223], v[144:147], v[172:175]
    v_mfma_f32_16x16x32_bf16 v[160:163], v[224:227], v[140:143], v[160:163]
    v_mfma_f32_16x16x32_bf16 v[176:179], v[224:227], v[144:147], v[176:179]
    s_waitcnt vmcnt(2) lgkmcnt(8)
    v_mfma_f32_16x16x32_bf16 v[148:151], v[180:183], v[100:103], v[148:151]
    v_mfma_f32_16x16x32_bf16 v[152:155], v[184:187], v[100:103], v[152:155]
    v_mfma_f32_16x16x32_bf16 v[156:159], v[188:191], v[100:103], v[156:159]
    v_mfma_f32_16x16x32_bf16 v[160:163], v[192:195], v[100:103], v[160:163]
    s_sub_u32 s59, s56, s58
    s_cmp_lt_u32 s59, 32
    s_cbranch_scc1 K_YROW0
K_NOY0:
    s_sub_u32 s59, s57, s58
    s_cmp_lt_u32 s59, 32
    s_cbranch_scc1 K_YROW1
K_NOY1:
    s_waitcnt vmcnt(0) lgkmcnt(0)
    v_mfma_f32_16x16x32_bf16 v[148:151], v[196:199], v[108:111], v[148:151]
    v_mfma_f32_16x16x32_bf16 v[152:155], v[200:203], v[108:111], v[152:155]
    v_mfma_f32_16x16x32_bf16 v[156:159], v[204:207], v[108:111], v[156:159]
    v_mfma_f32_16x16x32_bf16 v[160:163], v[208:211], v[108:111], v[160:163]
    v_mfma_f32_16x16x32_bf16 v[164:167], v[180:183], v[104:107], v[164:167]
    v_mfma_f32_16x16x32_bf16 v[168:171], v[184:187], v[104:107], v[168:171]
    v_mfma_f32_16x16x32_bf16 v[172:175], v[188:191], v[104:107], v[172:175]
    s_nop 1
    v_fma_f32 v148, v148, v60, v68
    v_fma_f32 v149, v149, v60, v69
    v_fma_f32 v150, v150, v60, v70
    v_mfma_f32_16x16x32_bf16 v[176:179], v[192:195], v[104:107], v[176:179]
    v_fma_f32 v151, v151, v60, v71
    v_cvt_pk_bf16_f32 v36, v148, v149
    v_cvt_pk_bf16_f32 v37, v150, v151
    v_mfma_f32_16x16x32_bf16 v[164:167], v[196:199], v[112:115], v[164:167]
    v_fma_f32 v152, v152, v60, v72
    v_fma_f32 v153, v153, v60, v73
    ds_write_b64 v29, v[36:37] offset:0
    v_mfma_f32_16x16x32_bf16 v[168:171], v[200:203], v[112:115], v[168:171]
    v_fma_f32 v154, v154, v60, v74
    v_fma_f32 v155, v155, v60, v75
    v_cvt_pk_bf16_f32 v38, v152, v153
    v_mfma_f32_16x16x32_bf16 v[172:175], v[204:207], v[112:115], v[172:175]
    v_cvt_pk_bf16_f32 v39, v154, v155
    v_fma_f32 v156, v156, v60, v76
    v_fma_f32 v157, v157, v60, v77
    v_mfma_f32_16x16x32_bf16 v[176:179], v[208:211], v[112:115], v[176:179]
    ds_write_b64 v30, v[38:39] offset:0
    v_fma_f32 v158, v158, v60, v78
    v_fma_f32 v159, v159, v60, v79
    v_cvt_pk_bf16_f32 v40, v156, v157
    v_cvt_pk_bf16_f32 v41, v158, v159
    v_pk_fma_f32 v[160:161], v[160:161], v[60:61], v[80:81] op_sel_hi:[1,0,1]
    v_pk_fma_f32 v[162:163], v[162:163], v[60:61], v[82:83] op_sel_hi:[1,0,1]
    ds_write_b64 v31, v[40:41] offset:0
    v_cvt_pk_bf16_f32 v42, v160, v161
    v_cvt_pk_bf16_f32 v43, v162, v163
    ds_write_b64 v32, v[42:43] offset:0
    ds_read_b128 v[68:71], v33 offset:0
    ds_read_b128 v[72:75], v33 offset:1024
    v_pk_fma_f32 v[164:165], v[164:165], v[62:63], v[84:85] op_sel_hi:[1,0,1]
    v_pk_fma_f32 v[166:167], v[166:167], v[62:63], v[86:87] op_sel_hi:[1,0,1]
    v_cvt_pk_bf16_f32 v44, v164, v165
    v_cvt_pk_bf16_f32 v45, v166, v167
    v_pk_fma_f32 v[168:169], v[168:169], v[62:63], v[88:89] op_sel_hi:[1,0,1]
    v_pk_fma_f32 v[170:171], v[170:171], v[62:63], v[90:91] op_sel_hi:[1,0,1]
    v_cvt_pk_bf16_f32 v46, v168, v169
    v_cvt_pk_bf16_f32 v47, v170, v171
    v_pk_fma_f32 v[172:173], v[172:173], v[62:63], v[92:93] op_sel_hi:[1,0,1]
    v_pk_fma_f32 v[174:175], v[174:175], v[62:63], v[94:95] op_sel_hi:[1,0,1]
    v_cvt_pk_bf16_f32 v48, v172, v173
    v_cvt_pk_bf16_f32 v49, v174, v175
    v_pk_fma_f32 v[176:177], v[176:177], v[62:63], v[96:97] op_sel_hi:[1,0,1]
    v_pk_fma_f32 v[178:179], v[178:179], v[62:63], v[98:99] op_sel_hi:[1,0,1]
    v_cvt_pk_bf16_f32 v50, v176, v177
    v_cvt_pk_bf16_f32 v51, v178, v179
    s_waitcnt lgkmcnt(0)
    buffer_store_dwordx4 v[68:71], v27, s[48:51], s71 offen sc1
    buffer_store_dwordx4 v[72:75], v28, s[48:51], s72 offen sc1
    ds_write_b64 v29, v[44:45] offset:2048
    ds_write_b64 v30, v[46:47] offset:2048
    ds_write_b64 v31, v[48:49] offset:2048
    ds_write_b64 v32, v[50:51] offset:2048
    ds_read_b128 v[84:87], v33 offset:2048
    ds_read_b128 v[88:91], v33 offset:3072
    s_waitcnt lgkmcnt(1)
    buffer_store_dwordx4 v[84:87], v27, s[48:51], s73 offen sc1
    s_waitcnt lgkmcnt(0)
    buffer_store_dwordx4 v[88:91], v28, s[48:51], s74 offen sc1
K_END:
K_EXIT:
    s_endpgm
.p2align 12
WP_spin:
    s_setpc_b64 s[38:39]
K_SP0:
    ds_read_b32 v2, v12 offset:32
    s_waitcnt lgkmcnt(0)
    v_readfirstlane_b32 s33, v2
    s_nop 3
    s_lshr_b32 s63, s33, s64
    s_lshr_b32 s33, s33, s65
    s_and_b32 s63, s63, s33
    s_and_b32 s63, s63, 0xff
    s_andn2_b32 s63, s63, s66
    s_cbranch_scc0 K_SP0
    s_or_b32 s66, s66, s63
    s_branch K_SPR0
K_SP1:
    ds_read_b32 v2, v12 offset:32
    s_waitcnt lgkmcnt(0)
    v_readfirstlane_b32 s33, v2
    s_nop 3
    s_lshr_b32 s63, s33, s64
    s_lshr_b32 s33, s33, s65
    s_and_b32 s63, s63, s33
    s_and_b32 s63, s63, 0xff
    s_andn2_b32 s63, s63, s66
    s_cbranch_scc0 K_SP1
    s_or_b32 s66, s66, s63
    s_branch K_SPR1
K_SP2:
    ds_read_b32 v2, v12 offset:32
    s_waitcnt lgkmcnt(0)
    v_readfirstlane_b32 s33, v2
    s_nop 3
    s_lshr_b32 s63, s33, s64
    s_lshr_b32 s33, s33, s65
    s_and_b32 s63, s63, s33
    s_and_b32 s63, s63, 0xff
    s_andn2_b32 s63, s63, s66
    s_cbranch_scc0 K_SP2
    s_or_b32 s66, s66, s63
    s_branch K_SPR2
K_SP3:
    ds_read_b32 v2, v12 offset:32
    s_waitcnt lgkmcnt(0)
    v_readfirstlane_b32 s33, v2
    s_nop 3
    s_lshr_b32 s63, s33, s64
    s_lshr_b32 s33, s33, s65
    s_and_b32 s63, s63, s33
    s_and_b32 s63, s63, 0xff
    s_andn2_b32 s63, s63, s66
    s_cbranch_scc0 K_SP3
    s_or_b32 s66, s66, s63
    s_branch K_SPR3
K_SP4:
    ds_read_b32 v2, v12 offset:32
    s_waitcnt lgkmcnt(0)
    v_readfirstlane_b32 s33, v2
    s_nop 3
    s_lshr_b32 s63, s33, s64
    s_lshr_b32 s33, s33, s65
    s_and_b32 s63, s63, s33
    s_and_b32 s63, s63, 0xff
    s_andn2_b32 s63, s63, s66
    s_cbranch_scc0 K_SP4
    s_or_b32 s66, s66, s63
    s_branch K_SPR4
K_SP5:
    ds_read_b32 v2, v12 offset:32
    s_waitcnt lgkmcnt(0)
    v_readfirstlane_b32 s33, v2
    s_nop 3
    s_lshr_b32 s63, s33, s64
    s_lshr_b32 s33, s33, s65
    s_and_b32 s63, s63, s33
    s_and_b32 s63, s63, 0xff
    s_andn2_b32 s63, s63, s66
    s_cbranch_scc0 K_SP5
    s_or_b32 s66, s66, s63
    s_branch K_SPR5
K_SP6:
    ds_read_b32 v2, v12 offset:32
    s_waitcnt lgkmcnt(0)
    v_readfirstlane_b32 s33, v2
    s_nop 3
    s_lshr_b32 s63, s33, s64
    s_lshr_b32 s33, s33, s65
    s_and_b32 s63, s63, s33
    s_and_b32 s63, s63, 0xff
    s_andn2_b32 s63, s63, s66
    s_cbranch_scc0 K_SP6
    s_or_b32 s66, s66, s63
    s_branch K_SPR6
K_SP7:
    ds_read_b32 v2, v12 offset:32
    s_waitcnt lgkmcnt(0)
    v_readfirstlane_b32 s33, v2
    s_nop 3
    s_lshr_b32 s63, s33, s64
    s_lshr_b32 s33, s33, s65
    s_and_b32 s63, s63, s33
    s_and_b32 s63, s63, 0xff
    s_andn2_b32 s63, s63, s66
    s_cbranch_scc0 K_SP7
    s_or_b32 s66, s66, s63
    s_branch K_SPR7
K_SP10:
    ds_read_b32 v2, v12 offset:32
    s_waitcnt lgkmcnt(0)
    v_readfirstlane_b32 s33, v2
    s_nop 3
    s_lshr_b32 s63, s33, s64
    s_lshr_b32 s33, s33, s65
    s_and_b32 s63, s63, s33
    s_and_b32 s63, s63, 0xff00
    s_andn2_b32 s63, s63, s66
    s_cbranch_scc0 K_SP10
    s_or_b32 s66, s66, s63
    s_branch K_SPR10
K_SP11:
    ds_read_b32 v2, v12 offset:32
    s_waitcnt lgkmcnt(0)
    v_readfirstlane_b32 s33, v2
    s_nop 3
    s_lshr_b32 s63, s33, s64
    s_lshr_b32 s33, s33, s65
    s_and_b32 s63, s63, s33
    s_and_b32 s63, s63, 0xff00
    s_andn2_b32 s63, s63, s66
    s_cbranch_scc0 K_SP11
    s_or_b32 s66, s66, s63
    s_branch K_SPR11
K_SP12:
    ds_read_b32 v2, v12 offset:32
    s_waitcnt lgkmcnt(0)
    v_readfirstlane_b32 s33, v2
    s_nop 3
    s_lshr_b32 s63, s33, s64
    s_lshr_b32 s33, s33, s65
    s_and_b32 s63, s63, s33
    s_and_b32 s63, s63, 0xff00
    s_andn2_b32 s63, s63, s66
    s_cbranch_scc0 K_SP12
    s_or_b32 s66, s66, s63
    s_branch K_SPR12
K_SP13:
    ds_read_b32 v2, v12 offset:32
    s_waitcnt lgkmcnt(0)
    v_readfirstlane_b32 s33, v2
    s_nop 3
    s_lshr_b32 s63, s33, s64
    s_lshr_b32 s33, s33, s65
    s_and_b32 s63, s63, s33
    s_and_b32 s63, s63, 0xff00
    s_andn2_b32 s63, s63, s66
    s_cbranch_scc0 K_SP13
    s_or_b32 s66, s66, s63
    s_branch K_SPR13
K_SP14:
    ds_read_b32 v2, v12 offset:32
    s_waitcnt lgkmcnt(0)
    v_readfirstlane_b32 s33, v2
    s_nop 3
    s_lshr_b32 s63, s33, s64
    s_lshr_b32 s33, s33, s65
    s_and_b32 s63, s63, s33
    s_and_b32 s63, s63, 0xff00
    s_andn2_b32 s63, s63, s66
    s_cbranch_scc0 K_SP14
    s_or_b32 s66, s66, s63
    s_branch K_SPR14
K_SP15:
    ds_read_b32 v2, v12 offset:32
    s_waitcnt lgkmcnt(0)
    v_readfirstlane_b32 s33, v2
    s_nop 3
    s_lshr_b32 s63, s33, s64
    s_lshr_b32 s33, s33, s65
    s_and_b32 s63, s63, s33
    s_and_b32 s63, s63, 0xff00
    s_andn2_b32 s63, s63, s66
    s_cbranch_scc0 K_SP15
    s_or_b32 s66, s66, s63
    s_branch K_SPR15
K_SP16:
    ds_read_b32 v2, v12 offset:32
    s_waitcnt lgkmcnt(0)
    v_readfirstlane_b32 s33, v2
    s_nop 3
    s_lshr_b32 s63, s33, s64
    s_lshr_b32 s33, s33, s65
    s_and_b32 s63, s63, s33
    s_and_b32 s63, s63, 0xff00
    s_andn2_b32 s63, s63, s66
    s_cbranch_scc0 K_SP16
    s_or_b32 s66, s66, s63
    s_branch K_SPR16
K_SP17:
    ds_read_b32 v2, v12 offset:32
    s_waitcnt lgkmcnt(0)
    v_readfirstlane_b32 s33, v2
    s_nop 3
    s_lshr_b32 s63, s33, s64
    s_lshr_b32 s33, s33, s65
    s_and_b32 s63, s63, s33
    s_and_b32 s63, s63, 0xff00
    s_andn2_b32 s63, s63, s66
    s_cbranch_scc0 K_SP17
    s_or_b32 s66, s66, s63
    s_branch K_SPR17
WP_yr0:
    s_setpc_b64 s[38:39]
K_YROW0:
    v_lshlrev_b32 v5, 4, v9
    v_add_u32 v5, 158976, v5
    v_and_b32 v3, 15, v1
    s_and_b32 s33, s59, 15
    v_cmp_eq_u32 vcc, s33, v3
    s_mov_b32 s3, 1048576
K_P2_GY0:
    ds_read_b32 v2, v12 offset:64
    s_sub_u32 s3, s3, 1
    s_waitcnt lgkmcnt(0)
    v_readfirstlane_b32 s33, v2
    s_nop 3
    s_cselect_b32 s33, 1, s33
    s_cmp_lt_u32 s33, 1
    s_cbranch_scc1 K_P2_GY0
    s_mov_b64 exec, vcc
    s_cmp_ge_u32 s59, 16
    s_cbranch_scc1 K_YR1_0
    ds_read_b128 v[68:71], v5 offset:0
    ds_read_b128 v[72:75], v5 offset:64
    ds_read_b128 v[76:79], v5 offset:128
    ds_read_b128 v[80:83], v5 offset:192
    s_mov_b64 exec, -1
    s_branch K_NOY0
K_YR1_0:
    ds_read_b128 v[84:87], v5 offset:0
    ds_read_b128 v[88:91], v5 offset:64
    ds_read_b128 v[92:95], v5 offset:128
    ds_read_b128 v[96:99], v5 offset:192
    s_mov_b64 exec, -1
    s_branch K_NOY0
K_YROW1:
    v_lshlrev_b32 v5, 4, v9
    v_add_u32 v5, 159232, v5
    v_and_b32 v3, 15, v1
    s_and_b32 s33, s59, 15
    v_cmp_eq_u32 vcc, s33, v3
    s_mov_b32 s3, 1048576
K_P2_GY1:
    ds_read_b32 v2, v12 offset:68
    s_sub_u32 s3, s3, 1
    s_waitcnt lgkmcnt(0)
    v_readfirstlane_b32 s33, v2
    s_nop 3
    s_cselect_b32 s33, 1, s33
    s_cmp_lt_u32 s33, 1
    s_cbranch_scc1 K_P2_GY1
    s_mov_b64 exec, vcc
    s_cmp_ge_u32 s59, 16
    s_cbranch_scc1 K_YR1_1
    ds_read_b128 v[68:71], v5 offset:0
    ds_read_b128 v[72:75], v5 offset:64
    ds_read_b128 v[76:79], v5 offset:128
    ds_read_b128 v[80:83], v5 offset:192
    s_mov_b64 exec, -1
    s_branch K_NOY1
K_YR1_1:
    ds_read_b128 v[84:87], v5 offset:0
    ds_read_b128 v[88:91], v5 offset:64
    ds_read_b128 v[92:95], v5 offset:128
    ds_read_b128 v[96:99], v5 offset:192
    s_mov_b64 exec, -1
    s_branch K_NOY1
.p2align 12
WP_gen:
    s_setpc_b64 s[38:39]
K_P2:
    s_cmp_ge_u32 s30, 4
    s_cbranch_scc1 K_P2_HELP
    v_mov_b32 v12, 158720
    s_cmp_lg_u32 s30, 0
    s_cbranch_scc1 K_P2_W13
    v_lshrrev_b32 v3, 4, v1
    v_and_b32 v4, 7, v1
    v_lshrrev_b32 v2, 3, v1
    v_xor_b32 v4, v4, v3
    v_mul_u32_u24 v2, 1280, v2
    v_lshl_add_u32 v27, v4, 4, v2
    v_xor_b32 v28, 64, v27
    s_mov_b32 s58, 0
K_P2_XD:
    s_lshl_b32 s59, s40, 3
    s_lshl1_add_u32 s59, s58, s59
    s_mul_i32 s59, s59, 20480
    s_lshl_b32 s33, s41, 7
    s_add_u32 s59, s59, s33
    s_lshl_b32 s33, s58, 12
    s_add_u32 m0, s33, 140288
    s_add_u32 s3, s59, 0
    buffer_load_dwordx4 v27, s[12:15], s3 offen lds
    s_add_u32 m0, s33, 141312
    s_add_u32 s3, s59, 10240
    buffer_load_dwordx4 v28, s[12:15], s3 offen lds
    s_add_u32 m0, s33, 142336
    s_add_u32 s3, s59, 20480
    buffer_load_dwordx4 v27, s[12:15], s3 offen lds
    s_add_u32 m0, s33, 143360
    s_add_u32 s3, s59, 30720
    buffer_load_dwordx4 v28, s[12:15], s3 offen lds
    s_add_u32 s58, s58, 1
    s_cmp_lt_u32 s58, 4
    s_cbranch_scc1 K_P2_XD
    s_waitcnt vmcnt(0)
    s_branch K_P2_AUXW
K_P2_W13:
    v_lshrrev_b32 v2, 3, v1
    v_mul_u32_u24 v2, 1280, v2
    v_lshrrev_b32 v3, 4, v1
    v_lshlrev_b32 v3, 1, v3
    v_and_b32 v4, 7, v1
    v_xor_b32 v3, v3, v4
    v_lshl_add_u32 v2, v3, 4, v2
    s_lshl_b32 s33, s41, 7
    v_add_u32 v22, s33, v2
    s_mov_b32 s60, 0xfda87520
    s_mov_b32 s61, 0xecb96431
    s_sub_u32 s58, s30, 1
K_P2_WS:
    s_lshl_b32 s3, s58, 2
    s_lshr_b64 s[4:5], s[60:61], s3
    s_and_b32 s4, s4, 15
    s_mul_i32 s4, s4, 51200
    s_mul_i32 s59, s58, 5120
    s_add_u32 s52, s4, 0
    s_add_u32 m0, s59, 0
    s_waitcnt vmcnt(11)
    buffer_load_dwordx4 v22, s[24:27], s52 offen lds
    s_add_u32 s52, s4, 10240
    s_add_u32 m0, s59, 1024
    s_waitcnt vmcnt(11)
    buffer_load_dwordx4 v22, s[24:27], s52 offen lds
    s_add_u32 s52, s4, 20480
    s_add_u32 m0, s59, 2048
    s_waitcnt vmcnt(11)
    buffer_load_dwordx4 v22, s[24:27], s52 offen lds
    s_add_u32 s52, s4, 30720
    s_add_u32 m0, s59, 3072
    s_waitcnt vmcnt(11)
    buffer_load_dwordx4 v22, s[24:27], s52 offen lds
    s_add_u32 s52, s4, 40960
    s_add_u32 m0, s59, 4096
    s_waitcnt vmcnt(11)
    buffer_load_dwordx4 v22, s[24:27], s52 offen lds
    s_cmp_ge_u32 s58, 3
    s_cbranch_scc1 K_P2_WS1
    v_mov_b32 v3, 1
    s_waitcnt vmcnt(5)
    s_mov_b64 exec, 1
    ds_add_u32 v12, v3 offset:52
    s_mov_b64 exec, -1
K_P2_WS1:
    s_add_u32 s58, s58, 3
    s_cmp_lt_u32 s58, 16
    s_cbranch_scc1 K_P2_WS
K_P2_AUXW:
    v_mov_b32 v34, 1
    s_waitcnt vmcnt(10)
    s_mov_b64 exec, 1
    ds_add_u32 v12, v34 offset:72
    s_mov_b64 exec, -1
    s_lshl_b32 s54, s40, 7
    v_lshrrev_b32 v9, 4, v1
    v_mov_b32 v12, 158720
    s_add_u32 s20, s10, 0x100000
    s_addc_u32 s21, s11, 0
    s_mov_b32 s22, 0x280000
    s_mov_b32 s23, 0x20000
    s_add_u32 s16, s10, 0x1000
    s_addc_u32 s17, s11, 0
    s_mov_b32 s18, 0x2000
    s_mov_b32 s19, 0x20000
    s_mov_b32 s48, s6
    s_mov_b32 s49, s7
    s_mov_b32 s50, 0x280000
    s_mov_b32 s51, 0x20000
    s_lshl_b32 s53, s40, 3
    s_lshl1_add_u32 s53, s30, s53
    s_mov_b32 s55, 20480
    v_bfe_u32 v20, v1, 2, 2
    v_and_b32 v21, 3, v1
    s_mul_i32 s3, s53, 20480
    v_lshl_add_u32 v25, v1, 4, s3
    v_add_u32 v26, 20480, v25
    v_and_b32 v2, 15, v1
    s_lshl_b32 s3, s53, 6
    v_lshl_add_u32 v23, v2, 2, s3
    v_lshl_add_u32 v2, v9, 2, v20
    v_bfe_u32 v3, v2, 1, 2
    v_lshlrev_b32 v2, 7, v2
    v_lshl_add_u32 v2, v21, 3, v2
    v_lshl_add_u32 v24, v3, 5, v2
    v_lshrrev_b32 v3, 1, v20
    v_mul_u32_u24 v2, 40, v9
    v_add3_u32 v2, v2, 16, v20
    v_lshlrev_b32 v2, 7, v2
    v_lshl_add_u32 v2, v21, 3, v2
    v_xor_b32 v4, 0, v3
    v_lshl_add_u32 v56, v4, 5, v2
    v_xor_b32 v4, 1, v3
    v_lshl_add_u32 v57, v4, 5, v2
    v_xor_b32 v4, 2, v3
    v_lshl_add_u32 v58, v4, 5, v2
    v_xor_b32 v4, 3, v3
    v_lshl_add_u32 v59, v4, 5, v2
    v_lshrrev_b32 v3, 4, v1
    v_and_b32 v4, 7, v1
    v_lshrrev_b32 v2, 3, v1
    v_xor_b32 v4, v4, v3
    v_mul_u32_u24 v2, 1280, v2
    v_lshl_add_u32 v27, v4, 4, v2
    v_xor_b32 v28, 64, v27
    s_lshl_b32 s71, s40, 3
    s_lshl1_add_u32 s71, s30, s71
    s_mul_i32 s71, s71, 20480
    s_lshl_b32 s33, s41, 7
    s_add_u32 s71, s71, s33
    s_add_u32 s72, s71, 10240
    s_add_u32 s73, s71, 20480
    s_add_u32 s74, s71, 30720
    s_lshl_b32 s3, s30, 12
    s_add_u32 s3, s3, 140288
    v_lshl_add_u32 v33, v1, 4, s3
    v_and_b32 v2, 15, v1
    v_lshrrev_b32 v3, 1, v2
    v_lshrrev_b32 v4, 5, v1
    v_xor_b32 v3, v3, v4
    v_lshlrev_b32 v3, 4, v3
    v_lshl_add_u32 v3, v2, 7, v3
    v_and_b32 v4, 1, v9
    v_lshl_add_u32 v3, v4, 3, v3
    v_add_u32 v29, s3, v3
    v_xor_b32 v30, 32, v29
    v_xor_b32 v31, 64, v29
    v_xor_b32 v32, 96, v29
    s_and_b32 s33, s40, 3
    s_lshl_b32 s33, s33, 3
    s_lshr_b32 s33, 0x7f06037f, s33
    s_and_b32 s33, s33, 0xff
    s_lshl_b32 s3, s30, 1
    s_cmp_ge_u32 s3, s33
    s_cselect_b32 s64, 16, 0
    s_add_u32 s3, s3, 1
    s_cmp_ge_u32 s3, s33
    s_cselect_b32 s65, 16, 0
    s_mov_b32 s63, 0
    s_mov_b32 s66, 0
    s_mov_b32 s67, 16384
    s_mov_b32 s3, 1048576
K_P2_GWA:
    ds_read_b32 v2, v12 offset:72
    s_sub_u32 s3, s3, 1
    s_waitcnt lgkmcnt(0)
    v_readfirstlane_b32 s33, v2
    s_nop 3
    s_cselect_b32 s33, 4, s33
    s_cmp_lt_u32 s33, 4
    s_cbranch_scc1 K_P2_GWA
    s_branch K_P2_GEMM
WP_help:
    s_setpc_b64 s[38:39]
K_LATE:
    s_sub_u32 s44, s30, 4
K_WOL:
    s_lshl_b32 s50, s44, 2
    s_lshr_b32 s50, 0x6431, s50
    s_and_b32 s50, s50, 7
    s_mul_i32 s50, s50, 51200
    s_mul_i32 s51, s44, 5120
    s_add_u32 s3, s50, 0
    s_add_u32 m0, s51, 40960
    s_waitcnt vmcnt(13)
    buffer_load_dwordx4 v18, s[24:27], s3 offen lds
    s_add_u32 s3, s50, 10240
    s_add_u32 m0, s51, 41984
    s_waitcnt vmcnt(13)
    buffer_load_dwordx4 v18, s[24:27], s3 offen lds
    s_add_u32 s3, s50, 20480
    s_add_u32 m0, s51, 43008
    s_waitcnt vmcnt(13)
    buffer_load_dwordx4 v18, s[24:27], s3 offen lds
    s_add_u32 s3, s50, 30720
    s_add_u32 m0, s51, 44032
    s_waitcnt vmcnt(13)
    buffer_load_dwordx4 v18, s[24:27], s3 offen lds
    s_add_u32 s3, s50, 40960
    s_add_u32 m0, s51, 45056
    s_waitcnt vmcnt(13)
    buffer_load_dwordx4 v18, s[24:27], s3 offen lds
    s_add_u32 s3, s50, 409600
    s_add_u32 m0, s51, 61440
    s_waitcnt vmcnt(13)
    buffer_load_dwordx4 v18, s[24:27], s3 offen lds
    s_add_u32 s3, s50, 419840
    s_add_u32 m0, s51, 62464
    s_waitcnt vmcnt(13)
    buffer_load_dwordx4 v18, s[24:27], s3 offen lds
    s_add_u32 s3, s50, 430080
    s_add_u32 m0, s51, 63488
    s_waitcnt vmcnt(13)
    buffer_load_dwordx4 v18, s[24:27], s3 offen lds
    s_add_u32 s3, s50, 440320
    s_add_u32 m0, s51, 64512
    s_waitcnt vmcnt(13)
    buffer_load_dwordx4 v18, s[24:27], s3 offen lds
    s_add_u32 s3, s50, 450560
    s_add_u32 m0, s51, 65536
    s_waitcnt vmcnt(13)
    buffer_load_dwordx4 v18, s[24:27], s3 offen lds
    s_add_u32 s44, s44, 2
    s_cmp_lt_u32 s44, 4
    s_cbranch_scc1 K_WOL
    v_mov_b32 v2, 158720
    v_mov_b32 v3, 2
    s_waitcnt vmcnt(0)
    s_mov_b64 exec, 1
    ds_add_u32 v2, v3 offset:44
    s_mov_b64 exec, -1
K_P2_HELP:
    s_setprio 3
    s_add_u32 s59, s40, 1
    s_bitcmp1_b32 s59, 1
    s_cselect_b32 s59, 31, 15
    v_and_b32 v10, s59, v1
    v_lshl_add_u32 v10, v10, 2, s42
    s_cmp_lg_u32 s30, 7
    s_cbranch_scc1 K_P2_N7
    v_and_b32 v4, 7, v1
    v_lshlrev_b32 v4, 2, v4
    s_mov_b32 s3, 131072
K_ZPOLL1:
    v_cmp_eq_u32 vcc, 0, v7
    s_cbranch_vccz K_ZOK1
    s_sub_u32 s3, s3, 1
    s_cbranch_scc1 K_ZOK1
    global_load_dword v7, v4, s[8:9] offset:192 sc1
    s_waitcnt vmcnt(0)
    s_branch K_ZPOLL1
K_ZOK1:
    global_load_dword v7, v10, s[10:11] sc1
K_P2_N7:
    s_lshl_b32 s54, s40, 7
    v_lshrrev_b32 v9, 4, v1
    v_mov_b32 v12, 158720
    s_add_u32 s44, s10, 0x10000
    s_addc_u32 s45, s11, 0
    s_mov_b32 s46, 0x43800
    s_mov_b32 s47, 0x20000
    v_mov_b32 v80, 1
    s_cmp_eq_u32 s30, 7
    s_cbranch_scc1 K_P2_FLAGS
    s_cmp_lg_u32 s30, 6
    s_cbranch_scc1 K_END
    s_mov_b32 s3, 131072
K_P2_DPOLL:
    v_cmp_eq_u32 vcc, 0, v7
    s_cbranch_vccz K_P2_DOK
    s_cmp_eq_u32 s3, 131072
    s_cbranch_scc1 K_P2_DNS
    s_sleep 12
K_P2_DNS:
    v_and_b32 v11, 1, v1
    v_lshl_add_u32 v11, v11, 2, s42
    global_load_dword v7, v11, s[10:11] offset:128 sc1
    s_sub_u32 s3, s3, 1
    s_waitcnt vmcnt(0)
    s_cmp_lg_u32 s3, 0
    s_cbranch_scc1 K_P2_DPOLL
K_P2_DOK:
    v_readlane_b32 s58, v7, 0
    v_readlane_b32 s59, v7, 1
    s_nop 3
    s_and_b32 s3, s58, 0x7ff
    s_sub_u32 s3, 2047, s3
    v_mov_b32 v20, s3
    v_mov_b32 v4, s58
    v_and_b32 v4, 0xffff0000, v4
    v_ashrrev_i32 v5, 31, v4
    v_not_b32 v5, v5
    v_or_b32 v5, 0x80000000, v5
    v_xor_b32 v4, v4, v5
    v_and_b32 v4, 0xffff0000, v4
    v_mul_f32 v5, 0xbfb8aa3b, v4
    v_exp_f32 v5, v5
    s_nop 0
    v_add_f32 v5, 1.0, v5
    v_rcp_f32 v4, v5
    s_nop 0
    v_cvt_pk_bf16_f32 v22, v4, v4
    v_lshlrev_b32 v22, 16, v22
    s_and_b32 s3, s59, 0x7ff
    s_sub_u32 s3, 2047, s3
    v_mov_b32 v21, s3
    v_mov_b32 v4, s59
    v_and_b32 v4, 0xffff0000, v4
    v_ashrrev_i32 v5, 31, v4
    v_not_b32 v5, v5
    v_or_b32 v5, 0x80000000, v5
    v_xor_b32 v4, v4, v5
    v_and_b32 v4, 0xffff0000, v4
    v_mul_f32 v5, 0xbfb8aa3b, v4
    v_exp_f32 v5, v5
    s_nop 0
    v_add_f32 v5, 1.0, v5
    v_rcp_f32 v4, v5
    s_nop 0
    v_cvt_pk_bf16_f32 v23, v4, v4
    v_lshlrev_b32 v23, 16, v23
    ds_write_b128 v12, v[20:23]
    ds_write_b32 v12, v80 offset:40
    s_mov_b32 s53, 0
    v_mov_b32 v16, v20
    v_mov_b32 v17, v21
    v_mov_b32 v18, v22
    v_mov_b32 v19, v23
K_P2_HW:
    s_cmp_eq_u32 s53, 0
    s_cselect_b64 vcc, -1, 0
    s_nop 1
    v_cndmask_b32 v2, v17, v16, vcc
    v_cndmask_b32 v5, v19, v18, vcc
    s_nop 0
    v_readfirstlane_b32 s58, v2
    s_nop 3
    s_sub_u32 s3, s58, s54
    s_cmp_lt_u32 s3, 128
    s_cbranch_scc0 K_P2_YN
    s_call_b64 s[38:39], WP_yr0
    s_mul_i32 s3, s58, 1280
    s_lshl_b32 s33, s41, 7
    s_add_u32 s3, s3, s33
    v_and_b32 v2, 15, v1
    v_lshlrev_b32 v2, 3, v2
    buffer_load_dwordx2 v[84:85], v2, s[12:15], s3 offen
    s_lshl_b32 s3, s58, 2
    s_add_u32 s3, s3, 4096
    v_mov_b32 v2, s3
    global_load_dword v88, v2, s[10:11] sc1
    s_lshl1_add_u32 s3, s41, s53
    s_lshl_b32 s3, s3, 8
    s_add_u32 s3, s3, 568320
    v_min_u32 v3, 53, v1
    v_lshl_add_u32 v3, v3, 2, s3
    s_mov_b32 s3, 131072
K_P2_YPOLL:
    global_load_dword v2, v3, s[10:11] sc1
    s_sub_u32 s3, s3, 1
    s_waitcnt vmcnt(0)
    v_cmp_ne_u32 vcc, 1, v2
    s_cbranch_vccz K_P2_YGO
    s_sleep 16
    s_cmp_lg_u32 s3, 0
    s_cbranch_scc1 K_P2_YPOLL
K_P2_YGO:
    v_and_b32 v2, 15, v1
    v_lshlrev_b32 v2, 4, v2
    v_mul_u32_u24 v4, 5120, v9
    s_mov_b32 s59, s53
    s_mul_i32 s33, s59, 2560
    s_lshl_b32 s3, s41, 8
    s_add_u32 s3, s3, s33
    v_add3_u32 v3, v2, v4, s3
    s_mov_b32 s52, 0
    buffer_load_dwordx4 v[24:27], v3, s[44:47], s52 offen sc1
    s_mov_b32 s52, 20480
    buffer_load_dwordx4 v[28:31], v3, s[44:47], s52 offen sc1
    s_mov_b32 s52, 40960
    buffer_load_dwordx4 v[32:35], v3, s[44:47], s52 offen sc1
    s_mov_b32 s52, 61440
    buffer_load_dwordx4 v[36:39], v3, s[44:47], s52 offen sc1
    s_mov_b32 s52, 81920
    buffer_load_dwordx4 v[40:43], v3, s[44:47], s52 offen sc1
    s_mov_b32 s52, 102400
    buffer_load_dwordx4 v[44:47], v3, s[44:47], s52 offen sc1
    s_mov_b32 s52, 122880
    buffer_load_dwordx4 v[48:51], v3, s[44:47], s52 offen sc1
    s_mov_b32 s52, 143360
    buffer_load_dwordx4 v[52:55], v3, s[44:47], s52 offen sc1
    s_mov_b32 s52, 163840
    buffer_load_dwordx4 v[56:59], v3, s[44:47], s52 offen sc1
    s_mov_b32 s52, 184320
    buffer_load_dwordx4 v[60:63], v3, s[44:47], s52 offen sc1
    s_mov_b32 s52, 204800
    buffer_load_dwordx4 v[64:67], v3, s[44:47], s52 offen sc1
    s_mov_b32 s52, 225280
    buffer_load_dwordx4 v[68:71], v3, s[44:47], s52 offen sc1
    s_mov_b32 s52, 245760
    buffer_load_dwordx4 v[72:75], v3, s[44:47], s52 offen sc1
    s_mov_b32 s52, 266240
    buffer_load_dwordx4 v[76:79], v3, s[44:47], s52 offen sc1
    v_sub_f32 v88, 1.0, v88
    v_cvt_pk_bf16_f32 v88, v88, v88
    v_lshlrev_b32 v88, 16, v88
    v_lshlrev_b32 v86, 16, v85
    v_and_b32 v87, 0xffff0000, v85
    v_and_b32 v85, 0xffff0000, v84
    v_lshlrev_b32 v84, 16, v84
    s_waitcnt vmcnt(12)
    v_add_f32 v20, v24, v28
    v_add_f32 v21, v25, v29
    v_add_f32 v22, v26, v30
    v_add_f32 v23, v27, v31
    s_waitcnt vmcnt(11)
    v_add_f32 v20, v20, v32
    v_add_f32 v21, v21, v33
    v_add_f32 v22, v22, v34
    v_add_f32 v23, v23, v35
    s_waitcnt vmcnt(10)
    v_add_f32 v20, v20, v36
    v_add_f32 v21, v21, v37
    v_add_f32 v22, v22, v38
    v_add_f32 v23, v23, v39
    s_waitcnt vmcnt(9)
    v_add_f32 v20, v20, v40
    v_add_f32 v21, v21, v41
    v_add_f32 v22, v22, v42
    v_add_f32 v23, v23, v43
    s_waitcnt vmcnt(8)
    v_add_f32 v20, v20, v44
    v_add_f32 v21, v21, v45
    v_add_f32 v22, v22, v46
    v_add_f32 v23, v23, v47
    s_waitcnt vmcnt(7)
    v_add_f32 v20, v20, v48
    v_add_f32 v21, v21, v49
    v_add_f32 v22, v22, v50
    v_add_f32 v23, v23, v51
    s_waitcnt vmcnt(6)
    v_add_f32 v20, v20, v52
    v_add_f32 v21, v21, v53
    v_add_f32 v22, v22, v54
    v_add_f32 v23, v23, v55
    s_waitcnt vmcnt(5)
    v_add_f32 v20, v20, v56
    v_add_f32 v21, v21, v57
    v_add_f32 v22, v22, v58
    v_add_f32 v23, v23, v59
    s_waitcnt vmcnt(4)
    v_add_f32 v20, v20, v60
    v_add_f32 v21, v21, v61
    v_add_f32 v22, v22, v62
    v_add_f32 v23, v23, v63
    s_waitcnt vmcnt(3)
    v_add_f32 v20, v20, v64
    v_add_f32 v21, v21, v65
    v_add_f32 v22, v22, v66
    v_add_f32 v23, v23, v67
    s_waitcnt vmcnt(2)
    v_add_f32 v20, v20, v68
    v_add_f32 v21, v21, v69
    v_add_f32 v22, v22, v70
    v_add_f32 v23, v23, v71
    s_waitcnt vmcnt(1)
    v_add_f32 v20, v20, v72
    v_add_f32 v21, v21, v73
    v_add_f32 v22, v22, v74
    v_add_f32 v23, v23, v75
    s_waitcnt vmcnt(0)
    v_add_f32 v20, v20, v76
    v_add_f32 v21, v21, v77
    v_add_f32 v22, v22, v78
    v_add_f32 v23, v23, v79
    v_mov_b32 v24, v20
    v_mov_b32 v25, v21
    v_mov_b32 v26, v22
    v_mov_b32 v27, v23
    s_nop 0
    v_permlane16_swap_b32 v20, v24
    v_permlane16_swap_b32 v21, v25
    v_permlane16_swap_b32 v22, v26
    v_permlane16_swap_b32 v23, v27
    v_add_f32 v20, v20, v24
    v_add_f32 v21, v21, v25
    v_add_f32 v22, v22, v26
    v_add_f32 v23, v23, v27
    v_mov_b32 v24, v20
    v_mov_b32 v25, v21
    v_mov_b32 v26, v22
    v_mov_b32 v27, v23
    s_nop 0
    v_permlane32_swap_b32 v20, v24
    v_permlane32_swap_b32 v21, v25
    v_permlane32_swap_b32 v22, v26
    v_permlane32_swap_b32 v23, v27
    v_add_f32 v20, v20, v24
    v_add_f32 v21, v21, v25
    v_add_f32 v22, v22, v26
    v_add_f32 v23, v23, v27
    v_cvt_pk_bf16_f32 v20, v20, v20
    v_lshlrev_b32 v20, 16, v20
    v_mul_f32 v20, v5, v20
    v_cvt_pk_bf16_f32 v20, v20, v20
    v_lshlrev_b32 v20, 16, v20
    v_add_f32 v20, v20, v84
    v_cvt_pk_bf16_f32 v20, v20, v20
    v_lshlrev_b32 v20, 16, v20
    v_mul_f32 v20, v20, v88
    v_cvt_pk_bf16_f32 v21, v21, v21
    v_lshlrev_b32 v21, 16, v21
    v_mul_f32 v21, v5, v21
    v_cvt_pk_bf16_f32 v21, v21, v21
    v_lshlrev_b32 v21, 16, v21
    v_add_f32 v21, v21, v85
    v_cvt_pk_bf16_f32 v21, v21, v21
    v_lshlrev_b32 v21, 16, v21
    v_mul_f32 v21, v21, v88
    v_cvt_pk_bf16_f32 v22, v22, v22
    v_lshlrev_b32 v22, 16, v22
    v_mul_f32 v22, v5, v22
    v_cvt_pk_bf16_f32 v22, v22, v22
    v_lshlrev_b32 v22, 16, v22
    v_add_f32 v22, v22, v86
    v_cvt_pk_bf16_f32 v22, v22, v22
    v_lshlrev_b32 v22, 16, v22
    v_mul_f32 v22, v22, v88
    v_cvt_pk_bf16_f32 v23, v23, v23
    v_lshlrev_b32 v23, 16, v23
    v_mul_f32 v23, v5, v23
    v_cvt_pk_bf16_f32 v23, v23, v23
    v_lshlrev_b32 v23, 16, v23
    v_add_f32 v23, v23, v87
    v_cvt_pk_bf16_f32 v23, v23, v23
    v_lshlrev_b32 v23, 16, v23
    v_mul_f32 v23, v23, v88
    s_lshl_b32 s3, s59, 8
    s_add_u32 s3, s3, 158976
    v_add_u32 v2, s3, v2
    ds_write_b128 v2, v[20:23]
    s_lshl_b32 s3, s59, 2
    v_add_u32 v2, s3, v12
    ds_write_b32 v2, v80 offset:64
K_P2_YN:
    s_add_u32 s53, s53, 1
    s_cmp_lt_u32 s53, 2
    s_cbranch_scc1 K_P2_HW
    s_branch K_END
WP_flags:
    s_setpc_b64 s[38:39]
K_P2_FLAGS:
    s_mov_b32 exec_hi, 0
    s_waitcnt vmcnt(0)
    s_mov_b32 s3, 131072
K_P2_FCHK:
    v_cmp_eq_u32 vcc, 1, v7
    s_nop 1
    v_mov_b32 v2, vcc_lo
    ds_write_b32 v12, v2 offset:32
    s_cmp_eq_u32 vcc_lo, -1
    s_cbranch_scc1 K_P2_FGO
    s_cmp_lg_u32 vcc_lo, 0
    s_cbranch_scc1 K_P2_FS
    s_sleep 4
K_P2_FS:
    s_sleep 6
    global_load_dword v7, v10, s[10:11] sc1
    s_sub_u32 s3, s3, 1
    s_waitcnt vmcnt(0)
    s_cbranch_scc0 K_P2_FCHK
    v_mov_b32 v2, -1
    ds_write_b32 v12, v2 offset:32
K_P2_FGO:
    s_mov_b64 exec, -1
    s_branch K_END
.p2align 12
K_AUX:
    s_load_dwordx8 s[48:55], s[0:1], 32
    s_load_dwordx2 s[56:57], s[0:1], 64
    s_mul_i32 s44, s28, 7
    s_add_u32 s44, s44, s29
    s_sub_u32 s44, s44, 1
    s_cmp_lt_u32 s44, 54
    s_cselect_b32 s44, s44, 63
    s_cmp_eq_u32 s29, 0
    s_cselect_b32 s44, 63, s44
    s_lshl_b32 s74, s28, 8
    s_lshl_b32 s3, s29, 5
    s_add_u32 s74, s74, s3
    v_mov_b32 v12, 158720
    v_mov_b32 v13, 1
    s_cmp_lt_u32 s30, 4
    s_cbranch_scc1 K_AUX_LO
    s_lshl_b32 s3, s30, 3
    s_add_u32 s3, s3, s74
    s_sub_u32 s3, s3, 32
    v_lshrrev_b32 v9, 3, v1
    v_add_u32 v9, s3, v9
    v_and_b32 v11, 7, v1
    v_lshlrev_b32 v11, 4, v11
    v_mul_u32_u24 v10, 1280, v9
    v_add_u32 v10, v10, v11
    s_waitcnt lgkmcnt(0)
    buffer_load_dwordx4 v[16:19], v10, s[12:15], 0 offen offset:0
    buffer_load_dwordx4 v[20:23], v10, s[12:15], 0 offen offset:128
    buffer_load_dwordx4 v[24:27], v10, s[12:15], 0 offen offset:256
    buffer_load_dwordx4 v[28:31], v10, s[12:15], 0 offen offset:384
    buffer_load_dwordx4 v[32:35], v10, s[12:15], 0 offen offset:512
    buffer_load_dwordx4 v[36:39], v10, s[12:15], 0 offen offset:640
    buffer_load_dwordx4 v[40:43], v10, s[12:15], 0 offen offset:768
    buffer_load_dwordx4 v[44:47], v10, s[12:15], 0 offen offset:896
    buffer_load_dwordx4 v[48:51], v10, s[12:15], 0 offen offset:1024
    buffer_load_dwordx4 v[52:55], v10, s[12:15], 0 offen offset:1152
    s_mov_b32 s16, s48
    s_mov_b32 s17, s49
    s_mov_b32 s18, 0x500
    s_mov_b32 s19, 0x20000
    s_mov_b32 s20, s56
    s_mov_b32 s21, s57
    s_mov_b32 s22, 0x500
    s_mov_b32 s23, 0x20000
    buffer_load_dwordx4 v[56:59], v11, s[16:19], 0 offen offset:0
    buffer_load_dwordx4 v[60:63], v11, s[16:19], 0 offen offset:128
    buffer_load_dwordx4 v[64:67], v11, s[16:19], 0 offen offset:256
    buffer_load_dwordx4 v[68:71], v11, s[16:19], 0 offen offset:384
    buffer_load_dwordx4 v[72:75], v11, s[16:19], 0 offen offset:512
    buffer_load_dwordx4 v[76:79], v11, s[16:19], 0 offen offset:640
    buffer_load_dwordx4 v[80:83], v11, s[16:19], 0 offen offset:768
    buffer_load_dwordx4 v[84:87], v11, s[16:19], 0 offen offset:896
    buffer_load_dwordx4 v[88:91], v11, s[16:19], 0 offen offset:1024
    buffer_load_dwordx4 v[92:95], v11, s[16:19], 0 offen offset:1152
    buffer_load_dwordx4 v[96:99], v11, s[20:23], 0 offen offset:0
    buffer_load_dwordx4 v[100:103], v11, s[20:23], 0 offen offset:128
    buffer_load_dwordx4 v[104:107], v11, s[20:23], 0 offen offset:256
    buffer_load_dwordx4 v[108:111], v11, s[20:23], 0 offen offset:384
    buffer_load_dwordx4 v[112:115], v11, s[20:23], 0 offen offset:512
    buffer_load_dwordx4 v[116:119], v11, s[20:23], 0 offen offset:640
    buffer_load_dwordx4 v[120:123], v11, s[20:23], 0 offen offset:768
    buffer_load_dwordx4 v[124:127], v11, s[20:23], 0 offen offset:896
    buffer_load_dwordx4 v[128:131], v11, s[20:23], 0 offen offset:1024
    buffer_load_dwordx4 v[132:135], v11, s[20:23], 0 offen offset:1152
    s_barrier
    v_mov_b32 v180, 0
    v_mov_b32 v181, 0
    v_mov_b32 v182, 0
    v_mov_b32 v183, 0
    v_and_b32 v10, 31, v9
    v_lshlrev_b32 v10, 2, v10
    v_add_u32 v10, 122880, v10
    v_sub_u32 v4, 0x87ff, v9
    s_setprio 2
    s_waitcnt vmcnt(10)
    v_dot2c_f32_bf16 v180, v16, v56
    v_dot2c_f32_bf16 v181, v17, v57
    v_dot2c_f32_bf16 v180, v18, v58
    v_dot2c_f32_bf16 v181, v19, v59
    v_dot2c_f32_bf16 v180, v20, v60
    v_dot2c_f32_bf16 v181, v21, v61
    v_dot2c_f32_bf16 v180, v22, v62
    v_dot2c_f32_bf16 v181, v23, v63
    v_dot2c_f32_bf16 v180, v24, v64
    v_dot2c_f32_bf16 v181, v25, v65
    v_dot2c_f32_bf16 v180, v26, v66
    v_dot2c_f32_bf16 v181, v27, v67
    v_dot2c_f32_bf16 v180, v28, v68
    v_dot2c_f32_bf16 v181, v29, v69
    v_dot2c_f32_bf16 v180, v30, v70
    v_dot2c_f32_bf16 v181, v31, v71
    v_dot2c_f32_bf16 v180, v32, v72
    v_dot2c_f32_bf16 v181, v33, v73
    v_dot2c_f32_bf16 v180, v34, v74
    v_dot2c_f32_bf16 v181, v35, v75
    v_dot2c_f32_bf16 v180, v36, v76
    v_dot2c_f32_bf16 v181, v37, v77
    v_dot2c_f32_bf16 v180, v38, v78
    v_dot2c_f32_bf16 v181, v39, v79
    v_dot2c_f32_bf16 v180, v40, v80
    v_dot2c_f32_bf16 v181, v41, v81
    v_dot2c_f32_bf16 v180, v42, v82
    v_dot2c_f32_bf16 v181, v43, v83
    v_dot2c_f32_bf16 v180, v44, v84
    v_dot2c_f32_bf16 v181, v45, v85
    v_dot2c_f32_bf16 v180, v46, v86
    v_dot2c_f32_bf16 v181, v47, v87
    v_dot2c_f32_bf16 v180, v48, v88
    v_dot2c_f32_bf16 v181, v49, v89
    v_dot2c_f32_bf16 v180, v50, v90
    v_dot2c_f32_bf16 v181, v51, v91
    v_dot2c_f32_bf16 v180, v52, v92
    v_dot2c_f32_bf16 v181, v53, v93
    v_dot2c_f32_bf16 v180, v54, v94
    v_dot2c_f32_bf16 v181, v55, v95
    s_waitcnt vmcnt(0)
    v_dot2c_f32_bf16 v182, v16, v96
    v_dot2c_f32_bf16 v183, v17, v97
    v_dot2c_f32_bf16 v182, v18, v98
    v_dot2c_f32_bf16 v183, v19, v99
    v_dot2c_f32_bf16 v182, v20, v100
    v_dot2c_f32_bf16 v183, v21, v101
    v_dot2c_f32_bf16 v182, v22, v102
    v_dot2c_f32_bf16 v183, v23, v103
    v_dot2c_f32_bf16 v182, v24, v104
    v_dot2c_f32_bf16 v183, v25, v105
    v_dot2c_f32_bf16 v182, v26, v106
    v_dot2c_f32_bf16 v183, v27, v107
    v_dot2c_f32_bf16 v182, v28, v108
    v_dot2c_f32_bf16 v183, v29, v109
    v_dot2c_f32_bf16 v182, v30, v110
    v_dot2c_f32_bf16 v183, v31, v111
    v_dot2c_f32_bf16 v182, v32, v112
    v_dot2c_f32_bf16 v183, v33, v113
    v_dot2c_f32_bf16 v182, v34, v114
    v_dot2c_f32_bf16 v183, v35, v115
    v_dot2c_f32_bf16 v182, v36, v116
    v_dot2c_f32_bf16 v183, v37, v117
    v_dot2c_f32_bf16 v182, v38, v118
    v_dot2c_f32_bf16 v183, v39, v119
    v_dot2c_f32_bf16 v182, v40, v120
    v_dot2c_f32_bf16 v183, v41, v121
    v_dot2c_f32_bf16 v182, v42, v122
    v_dot2c_f32_bf16 v183, v43, v123
    v_dot2c_f32_bf16 v182, v44, v124
    v_dot2c_f32_bf16 v183, v45, v125
    v_dot2c_f32_bf16 v182, v46, v126
    v_dot2c_f32_bf16 v183, v47, v127
    v_dot2c_f32_bf16 v182, v48, v128
    v_dot2c_f32_bf16 v183, v49, v129
    v_dot2c_f32_bf16 v182, v50, v130
    v_dot2c_f32_bf16 v183, v51, v131
    v_dot2c_f32_bf16 v182, v52, v132
    v_dot2c_f32_bf16 v183, v53, v133
    v_dot2c_f32_bf16 v182, v54, v134
    v_dot2c_f32_bf16 v183, v55, v135
    s_nop 2
    v_add_f32 v180, v180, v181
    v_add_f32 v182, v182, v183
    s_nop 0
    v_add_f32_dpp v180, v180, v180 quad_perm:[1,0,3,2] row_mask:0xf bank_mask:0xf
    v_add_f32_dpp v182, v182, v182 quad_perm:[1,0,3,2] row_mask:0xf bank_mask:0xf
    s_nop 0
    v_add_f32_dpp v180, v180, v180 quad_perm:[2,3,0,1] row_mask:0xf bank_mask:0xf
    v_add_f32_dpp v182, v182, v182 quad_perm:[2,3,0,1] row_mask:0xf bank_mask:0xf
    s_nop 0
    v_add_f32_dpp v180, v180, v180 row_half_mirror row_mask:0xf bank_mask:0xf
    v_add_f32_dpp v182, v182, v182 row_half_mirror row_mask:0xf bank_mask:0xf
    v_cvt_pk_bf16_f32 v2, v180, v180
    v_lshlrev_b32 v2, 16, v2
    v_ashrrev_i32 v3, 31, v2
    v_or_b32 v3, 0x80000000, v3
    v_xor_b32 v2, v2, v3
    v_and_b32 v2, 0xffff0000, v2
    v_or_b32 v2, v2, v4
    ds_write2_b32 v10, v2, v182 offset0:0 offset1:32
    s_mov_b64 exec, 1
    ds_add_u32 v12, v13 offset:36
    s_mov_b64 exec, -1
    s_setprio 0
    s_cmp_lg_u32 s30, 4
    s_cbranch_scc1 K_WARMA0
    s_call_b64 s[38:39], WP_p2g
    s_branch K_WARMAX
K_WARMA0:
    s_cmp_lg_u32 s30, 5
    s_cbranch_scc1 K_WARMA1
    s_call_b64 s[38:39], WP_gen
    s_branch K_WARMAX
K_WARMA1:
    s_cmp_lg_u32 s30, 6
    s_cbranch_scc1 K_WARMA2
    s_call_b64 s[38:39], WP_help
    s_call_b64 s[38:39], WP_flags
    s_branch K_WARMAX
K_WARMA2:
    s_call_b64 s[38:39], WP_spin
K_WARMAX:
    s_cmp_ge_u32 s30, 6
    s_cselect_b32 s44, 63, s44
    s_cmp_lg_u32 s44, 63
    s_cbranch_scc1 K_FFN_C
    s_mov_b32 s3, 1048576
K_FGH:
    ds_read_b32 v2, v12 offset:48
    s_sleep 8
    s_sub_u32 s3, s3, 1
    s_waitcnt lgkmcnt(0)
    v_readfirstlane_b32 s33, v2
    s_nop 3
    s_cselect_b32 s33, 1, s33
    s_cmp_lt_u32 s33, 1
    s_cbranch_scc1 K_FGH
    s_cmp_eq_u32 s30, 6
    s_cbranch_scc1 K_P2_HELP
    v_mov_b32 v7, 1
    s_branch K_P2_HELP
K_AUX_LO:
    s_waitcnt lgkmcnt(0)
    s_cmp_eq_u32 s30, 0
    s_cbranch_scc1 K_AUX_PUB
    s_cmp_eq_u32 s44, 63
    s_cbranch_scc1 K_AUX_NOF
    s_and_b32 s3, s44, 1
    s_cmp_eq_u32 s3, 0
    s_cselect_b64 s[60:61], s[50:51], s[52:53]
    s_cselect_b64 s[64:65], s[52:53], s[50:51]
    s_cselect_b32 s75, 0, 40960
    s_mov_b32 s62, 0x21c000
    s_mov_b32 s63, 0x20000
    s_mov_b32 s66, 0x21c000
    s_mov_b32 s67, 0x20000
    v_lshrrev_b32 v2, 2, v1
    v_mul_u32_u24 v184, 3456, v2
    v_and_b32 v2, 3, v1
    v_lshl_add_u32 v184, v2, 4, v184
    s_lshl_b32 s72, s44, 6
    v_add_u32 v184, s72, v184
    s_sub_u32 s74, s30, 1
K_FSA0:
    s_lshl_b32 s73, s74, 10
    s_mul_i32 s72, s74, 55296
    s_add_u32 m0, s73, s75
    s_waitcnt vmcnt(7)
    buffer_load_dwordx4 v184, s[60:63], s72 offen lds
    s_add_u32 s74, s74, 3
    s_cmp_lt_u32 s74, 24
    s_cbranch_scc1 K_FSA0
    s_barrier
    s_mov_b32 s3, 1048576
K_FGPB:
    ds_read_b32 v2, v12 offset:36
    s_sleep 1
    s_sub_u32 s3, s3, 1
    s_waitcnt lgkmcnt(0)
    v_readfirstlane_b32 s33, v2
    s_nop 3
    s_cselect_b32 s33, 5, s33
    s_cmp_lt_u32 s33, 5
    s_cbranch_scc1 K_FGPB
K_FSA:
    s_lshl_b32 s73, s74, 10
    s_mul_i32 s72, s74, 55296
    s_add_u32 m0, s73, s75
    s_waitcnt vmcnt(7)
    buffer_load_dwordx4 v184, s[60:63], s72 offen lds
    s_add_u32 s74, s74, 3
    s_cmp_lt_u32 s74, 40
    s_cbranch_scc1 K_FSA
    s_sub_u32 s74, s74, 40
    s_xor_b32 s75, s75, 40960
    s_mov_b32 s68, s54
    s_mov_b32 s69, s55
    s_mov_b32 s70, 0x21c000
    s_mov_b32 s71, 0x20000
    s_mul_i32 s3, s44, 40960
    v_lshrrev_b32 v2, 3, v1
    v_mul_u32_u24 v2, 1280, v2
    v_lshrrev_b32 v3, 4, v1
    v_lshlrev_b32 v3, 1, v3
    v_and_b32 v4, 7, v1
    v_xor_b32 v3, v3, v4
    v_lshl_add_u32 v2, v3, 4, v2
    v_add_u32 v185, s3, v2
K_FSB:
    s_lshl_b32 s73, s74, 10
    s_mul_i32 s72, s74, 55296
    s_add_u32 m0, s73, s75
    s_waitcnt vmcnt(7)
    buffer_load_dwordx4 v184, s[64:67], s72 offen lds
    s_add_u32 s74, s74, 3
    s_cmp_lt_u32 s74, 40
    s_cbranch_scc1 K_FSB
    s_sub_u32 s74, s74, 40
    s_mov_b32 s75, 81920
K_FSD0:
    s_lshl_b32 s73, s74, 10
    s_and_b32 s72, s74, 3
    s_mul_i32 s72, s72, 10208
    s_lshl_b32 s3, s74, 5
    s_add_u32 s72, s72, s3
    s_add_u32 m0, s73, s75
    s_waitcnt vmcnt(7)
    buffer_load_dwordx4 v185, s[68:71], s72 offen lds
    s_add_u32 s74, s74, 3
    s_cmp_lt_u32 s74, 24
    s_cbranch_scc1 K_FSD0
    s_waitcnt vmcnt(8)
    s_mov_b64 exec, 1
    ds_add_u32 v12, v13 offset:56
    s_mov_b64 exec, -1
K_FSD:
    s_lshl_b32 s73, s74, 10
    s_and_b32 s72, s74, 3
    s_mul_i32 s72, s72, 10208
    s_lshl_b32 s3, s74, 5
    s_add_u32 s72, s72, s3
    s_add_u32 m0, s73, s75
    s_waitcnt vmcnt(7)
    buffer_load_dwordx4 v185, s[68:71], s72 offen lds
    s_add_u32 s74, s74, 3
    s_cmp_lt_u32 s74, 40
    s_cbranch_scc1 K_FSD
    s_mul_i32 s3, s29, 96
    s_lshl_b32 s72, s30, 5
    s_add_u32 s3, s3, s72
    s_sub_u32 s3, s3, 128
    v_lshrrev_b32 v2, 1, v1
    v_add_u32 v2, s3, v2
    v_mul_u32_u24 v2, 1280, v2
    v_and_b32 v3, 1, v1
    v_lshl_add_u32 v2, v3, 7, v2
    buffer_load_dword v6, v2, s[24:27], 0 offen offset:1024
K_AUX_WR:
    s_mov_b32 s3, 1048576
K_FGR:
    ds_read_b32 v2, v12 offset:60
    s_sleep 2
    s_sub_u32 s3, s3, 1
    s_waitcnt lgkmcnt(0)
    v_readfirstlane_b32 s33, v2
    s_nop 3
    s_cselect_b32 s33, 2, s33
    s_cmp_lt_u32 s33, 2
    s_cbranch_scc1 K_FGR
    s_branch K_P2
K_AUX_NOF:
    s_cmp_lg_u32 s2, 63
    s_cbranch_scc1 K_AUX_NOZ
    s_cmp_lg_u32 s30, 1
    s_cbranch_scc1 K_AUX_NOZ
    s_add_u32 s60, s10, 0x80000
    s_addc_u32 s61, s11, 0
    s_mov_b32 s62, 0xc000
    s_mov_b32 s63, 0x20000
    v_mov_b32 v9, 786432
    global_load_dword v10, v9, s[10:11] sc1
    v_lshlrev_b32 v11, 4, v1
    v_add_u32 v11, 790528, v11
    global_load_dword v6, v11, s[10:11] sc1
    s_barrier
    s_mov_b32 s3, 1048576
K_FGZ:
    ds_read_b32 v2, v12 offset:36
    s_sleep 2
    s_sub_u32 s3, s3, 1
    s_waitcnt lgkmcnt(0)
    v_readfirstlane_b32 s33, v2
    s_nop 3
    s_cselect_b32 s33, 4, s33
    s_cmp_lt_u32 s33, 4
    s_cbranch_scc1 K_FGZ
    v_and_b32 v4, 7, v1
    v_lshlrev_b32 v4, 2, v4
    global_load_dword v7, v4, s[8:9] offset:192 sc1
    s_waitcnt vmcnt(1)
    v_add_u32 v10, 1, v10
    s_mov_b32 s3, 131072
    s_setprio 3
K_AG2_POLL:
    global_load_dwordx4 v[16:19], v11, s[10:11] sc1
    s_waitcnt vmcnt(0)
    v_xor_b32 v2, v10, v17
    v_xor_b32 v3, v10, v19
    v_or_b32 v2, v2, v3
    v_cmp_ne_u32 vcc, 0, v2
    s_cbranch_vccz K_AG2_GOT
    s_sleep 2
    s_sub_u32 s3, s3, 1
    s_cmp_lg_u32 s3, 0
    s_cbranch_scc1 K_AG2_POLL
K_AG2_GOT:
    s_nop 1
    v_max_u32_dpp v3, v16, v16 quad_perm:[1,0,3,2] row_mask:0xf bank_mask:0xf
    s_nop 1
    v_max_u32_dpp v3, v3, v3 quad_perm:[2,3,0,1] row_mask:0xf bank_mask:0xf
    s_nop 1
    v_max_u32_dpp v3, v3, v3 row_half_mirror row_mask:0xf bank_mask:0xf
    s_nop 1
    v_max_u32_dpp v3, v3, v3 row_mirror row_mask:0xf bank_mask:0xf
    s_nop 1
    v_readlane_b32 s74, v3, 0
    v_readlane_b32 s76, v3, 16
    v_readlane_b32 s77, v3, 32
    v_readlane_b32 s78, v3, 48
    s_nop 3
    s_max_u32 s74, s74, s76
    s_max_u32 s77, s77, s78
    s_max_u32 s74, s74, s77
    v_cmp_ne_u32 vcc, s74, v16
    s_nop 1
    v_cndmask_b32 v2, v18, v16, vcc
    s_nop 1
    v_max_u32_dpp v3, v2, v2 quad_perm:[1,0,3,2] row_mask:0xf bank_mask:0xf
    s_nop 1
    v_max_u32_dpp v3, v3, v3 quad_perm:[2,3,0,1] row_mask:0xf bank_mask:0xf
    s_nop 1
    v_max_u32_dpp v3, v3, v3 row_half_mirror row_mask:0xf bank_mask:0xf
    s_nop 1
    v_max_u32_dpp v3, v3, v3 row_mirror row_mask:0xf bank_mask:0xf
    s_nop 1
    v_readlane_b32 s75, v3, 0
    v_readlane_b32 s76, v3, 16
    v_readlane_b32 s77, v3, 32
    v_readlane_b32 s78, v3, 48
    s_nop 3
    s_max_u32 s75, s75, s76
    s_max_u32 s77, s77, s78
    s_max_u32 s75, s75, s77
    v_mov_b32 v176, s74
    v_mov_b32 v177, s75
    v_and_b32 v4, 7, v1
    v_lshlrev_b32 v4, 2, v4
    s_mov_b32 s3, 131072
K_ZPOLL4:
    v_cmp_eq_u32 vcc, 0, v7
    s_cbranch_vccz K_ZOK4
    s_sub_u32 s3, s3, 1
    s_cbranch_scc1 K_ZOK4
    global_load_dword v7, v4, s[8:9] offset:192 sc1
    s_waitcnt vmcnt(0)
    s_branch K_ZPOLL4
K_ZOK4:
    v_and_b32 v2, 7, v1
    v_mul_u32_u24 v2, 20, v2
    v_lshrrev_b32 v3, 3, v1
    v_add_lshl_u32 v2, v2, v3, 8
    buffer_store_dwordx2 v[176:177], v2, s[60:63], 0 offen offset:136 sc1
    s_mov_b64 exec, 1
    global_store_dword v9, v10, s[10:11] sc1
    s_mov_b64 exec, -1
    v_lshlrev_b32 v4, 2, v1
    s_mov_b32 s72, 43008
    s_mov_b32 s3, 131072
K_AGG_POLL:
    s_sleep 8
    buffer_load_dword v2, v4, s[60:63], s72 offen sc1
    s_waitcnt vmcnt(0)
    v_cmp_eq_u32 vcc, 0, v2
    s_cbranch_vccz K_AGG_GOT
    s_sub_u32 s3, s3, 1
    s_cmp_lg_u32 s3, 0
    s_cbranch_scc1 K_AGG_POLL
K_AGG_GOT:
    s_mov_b32 s62, 40960
    v_lshlrev_b32 v3, 8, v1
    s_mov_b32 s3, 0
    buffer_store_dwordx2 v[176:177], v3, s[60:63], s3 offen offset:128 sc1
    s_mov_b32 s3, 16384
    buffer_store_dwordx2 v[176:177], v3, s[60:63], s3 offen offset:128 sc1
    s_mov_b32 s3, 32768
    buffer_store_dwordx2 v[176:177], v3, s[60:63], s3 offen offset:128 sc1
    s_setprio 0
    s_branch K_AUX_NOK
K_AUX_NOZ:
    s_barrier
K_AUX_NOK:
    s_mov_b32 s3, 1048576
K_FGWD:
    ds_read_b32 v2, v12 offset:48
    s_sleep 4
    s_sub_u32 s3, s3, 1
    s_waitcnt lgkmcnt(0)
    v_readfirstlane_b32 s33, v2
    s_nop 3
    s_cselect_b32 s33, 1, s33
    s_cmp_lt_u32 s33, 1
    s_cbranch_scc1 K_FGWD
    s_branch K_P2
K_AUX_PUB:
    s_add_u32 s60, s10, 0x1000
    s_addc_u32 s61, s11, 0
    s_mov_b32 s62, 0x2000
    s_mov_b32 s63, 0x20000
    v_and_b32 v3, 31, v1
    v_lshlrev_b32 v10, 2, v3
    v_add_u32 v11, 122880, v10
    s_lshl_b32 s72, s74, 2
    v_mov_b32 v2, 786432
    global_load_dword v17, v2, s[10:11] sc1
    s_lshl_b32 s3, s2, 2
    s_add_u32 s3, s3, 567296
    v_mov_b32 v9, s3
    s_lshl_b32 s3, s2, 4
    s_add_u32 s3, s3, 790528
    v_lshl_add_u32 v20, v1, 4, s3
    v_and_b32 v5, 7, v1
    v_lshlrev_b32 v5, 2, v5
    s_barrier
    s_setprio 3
    s_waitcnt vmcnt(0)
    v_add_u32 v17, 1, v17
    v_mov_b32 v19, v17
    s_mov_b32 s3, 1048576
K_FGRT:
    ds_read_b32 v2, v12 offset:36
    s_sleep 0
    s_sub_u32 s3, s3, 1
    s_waitcnt lgkmcnt(0)
    v_readfirstlane_b32 s33, v2
    s_nop 3
    s_cselect_b32 s33, 4, s33
    s_cmp_lt_u32 s33, 4
    s_cbranch_scc1 K_FGRT
    ds_read2_b32 v[176:177], v11 offset0:0 offset1:32
    s_waitcnt lgkmcnt(0)
    s_nop 1
    v_max_u32_dpp v3, v176, v176 quad_perm:[1,0,3,2] row_mask:0xf bank_mask:0xf
    s_nop 1
    v_max_u32_dpp v3, v3, v3 quad_perm:[2,3,0,1] row_mask:0xf bank_mask:0xf
    s_nop 1
    v_max_u32_dpp v3, v3, v3 row_half_mirror row_mask:0xf bank_mask:0xf
    s_nop 1
    v_max_u32_dpp v3, v3, v3 row_mirror row_mask:0xf bank_mask:0xf
    s_nop 1
    v_readlane_b32 s74, v3, 0
    v_readlane_b32 s76, v3, 16
    v_readlane_b32 s77, v3, 32
    v_readlane_b32 s78, v3, 48
    s_nop 3
    s_max_u32 s74, s74, s76
    s_max_u32 s77, s77, s78
    s_max_u32 s74, s74, s77
    v_cmp_ne_u32 vcc, s74, v176
    s_nop 1
    v_cndmask_b32 v176, 0, v176, vcc
    s_nop 1
    v_max_u32_dpp v3, v176, v176 quad_perm:[1,0,3,2] row_mask:0xf bank_mask:0xf
    s_nop 1
    v_max_u32_dpp v3, v3, v3 quad_perm:[2,3,0,1] row_mask:0xf bank_mask:0xf
    s_nop 1
    v_max_u32_dpp v3, v3, v3 row_half_mirror row_mask:0xf bank_mask:0xf
    s_nop 1
    v_max_u32_dpp v3, v3, v3 row_mirror row_mask:0xf bank_mask:0xf
    s_nop 1
    v_readlane_b32 s75, v3, 0
    v_readlane_b32 s76, v3, 16
    v_readlane_b32 s77, v3, 32
    v_readlane_b32 s78, v3, 48
    s_nop 3
    s_max_u32 s75, s75, s76
    s_max_u32 s77, s77, s78
    s_max_u32 s75, s75, s77
    v_mov_b32 v16, s74
    v_mov_b32 v18, s75
    s_mov_b64 exec, 1
    global_store_dwordx4 v20, v[16:19], s[10:11] sc1
    s_mov_b64 exec, -1
    s_mov_b64 exec, 1
    ds_add_u32 v12, v13 offset:36
    s_mov_b64 exec, -1
    global_load_dword v7, v5, s[8:9] offset:192 sc1
    v_cvt_pk_bf16_f32 v177, v177, v177
    v_lshlrev_b32 v177, 16, v177
    v_mul_f32 v3, 0xbfb8aa3b, v177
    v_exp_f32 v3, v3
    s_nop 0
    v_add_f32 v3, 1.0, v3
    v_rcp_f32 v177, v3
    s_nop 0
    v_cvt_pk_bf16_f32 v177, v177, v177
    v_lshlrev_b32 v177, 16, v177
    s_mov_b32 exec_hi, 0
    buffer_store_dword v177, v10, s[60:63], s72 offen sc1
    s_mov_b64 exec, -1
    s_waitcnt vmcnt(0)
    v_and_b32 v4, 7, v1
    v_lshlrev_b32 v4, 2, v4
    s_mov_b32 s3, 131072
K_ZPOLL3:
    v_cmp_eq_u32 vcc, 0, v7
    s_cbranch_vccz K_ZOK3
    s_sub_u32 s3, s3, 1
    s_cbranch_scc1 K_ZOK3
    global_load_dword v7, v4, s[8:9] offset:192 sc1
    s_waitcnt vmcnt(0)
    s_branch K_ZPOLL3
K_ZOK3:
    s_mov_b64 exec, 1
    global_store_dword v9, v13, s[10:11] sc1
    s_mov_b64 exec, -1
    v_and_b32 v3, 1, v1
    v_lshl_add_u32 v3, v3, 2, s42
    v_lshlrev_b32 v10, 4, v1
    s_mov_b32 s3, 131072
K_AUX_POLL:
    s_sleep 6
    global_load_dword v2, v3, s[10:11] offset:136 sc1
    s_waitcnt vmcnt(0)
    v_cmp_eq_u32 vcc, 0, v2
    s_cbranch_vccz K_AUX_GOT
    s_sub_u32 s3, s3, 1
    s_cmp_lg_u32 s3, 0
    s_cbranch_scc1 K_AUX_POLL
K_AUX_GOT:
    v_readlane_b32 s74, v2, 0
    v_readlane_b32 s75, v2, 1
    s_nop 3
    s_and_b32 s74, s74, 0x7ff
    s_sub_u32 s74, 2047, s74
    s_mul_i32 s74, s74, 1280
    s_mov_b32 m0, 125184
    s_nop 0
    buffer_load_dwordx4 v10, s[12:15], s74 offen lds
    s_mov_b64 exec, 0xffff
    buffer_load_dwordx4 v10, s[12:15], s74 offen offset:1024 lds
    s_mov_b64 exec, -1
    s_and_b32 s75, s75, 0x7ff
    s_sub_u32 s75, 2047, s75
    s_mul_i32 s75, s75, 1280
    s_mov_b32 m0, 126528
    s_nop 0
    buffer_load_dwordx4 v10, s[12:15], s75 offen lds
    s_mov_b64 exec, 0xffff
    buffer_load_dwordx4 v10, s[12:15], s75 offen offset:1024 lds
    s_mov_b64 exec, -1
    s_waitcnt vmcnt(0)
    ds_write_b32 v12, v13 offset:48
    s_setprio 0
    s_branch K_P2
.p2align 12
K_FFN_C:
    s_add_u32 s64, s10, 0x10000
    s_addc_u32 s65, s11, 0
    s_mov_b32 s66, 0x43800
    s_mov_b32 s67, 0x20000
    s_and_b32 s73, s30, 1
    v_lshrrev_b32 v232, 4, v1
    v_bfe_u32 v4, v1, 2, 2
    v_lshl_add_u32 v2, v232, 3, v4
    v_and_b32 v3, 3, v1
    v_lshlrev_b32 v3, 3, v3
    v_lshl_add_u32 v233, v2, 6, v3
    s_lshl_b32 s72, s73, 5
    v_add_u32 v233, s72, v233
    v_lshl_add_u32 v2, v232, 2, v4
    v_bfe_u32 v4, v2, 1, 2
    v_lshl_add_u32 v3, v2, 7, v3
    v_lshl_add_u32 v3, v4, 5, v3
    s_mul_i32 s3, s73, 20480
    s_add_u32 s3, s3, 81920
    v_add_u32 v238, s3, v3
    v_xor_b32 v239, 32, v238
    v_xor_b32 v240, 64, v238
    v_xor_b32 v241, 96, v238
    v_and_b32 v2, 1, v1
    v_mul_u32_u24 v234, 1344, v2
    v_lshl_add_u32 v234, v232, 4, v234
    v_add_u32 v234, 125184, v234
    v_lshlrev_b32 v236, 4, v1
    v_add_u32 v236, 124160, v236
    s_lshl_b32 s3, s73, 3
    v_add_u32 v235, s3, v236
    v_mul_u32_u24 v2, 2560, v2
    v_lshl_add_u32 v237, v232, 4, v2
    s_mul_i32 s3, s44, 5120
    s_mul_i32 s72, s73, 1280
    s_add_u32 s72, s72, s3
    v_lshlrev_b32 v2, 4, v1
    buffer_store_dwordx4 v[16:19], v2, s[64:67], s72 offen offset:0 sc1
    buffer_store_dwordx4 v[16:19], v2, s[64:67], s72 offen offset:2560 sc1
    s_mov_b64 exec, 0xffff
    buffer_store_dwordx4 v[16:19], v2, s[64:67], s72 offen offset:1024 sc1
    buffer_store_dwordx4 v[16:19], v2, s[64:67], s72 offen offset:3584 sc1
    s_mov_b64 exec, -1
    v_add_u32 v5, 40960, v233
    s_mov_b32 s3, 1048576
K_FGD:
    ds_read_b32 v2, v12 offset:56
    s_sleep 2
    s_sub_u32 s3, s3, 1
    s_waitcnt lgkmcnt(0)
    v_readfirstlane_b32 s33, v2
    s_nop 3
    s_cselect_b32 s33, 3, s33
    s_cmp_lt_u32 s33, 3
    s_cbranch_scc1 K_FGD
    s_setprio 3
    ds_read_b64_tr_b16 v[16:17], v233 offset:0
    ds_read_b64_tr_b16 v[18:19], v233 offset:256
    ds_read_b64_tr_b16 v[20:21], v233 offset:2048
    ds_read_b64_tr_b16 v[22:23], v233 offset:2304
    ds_read_b64_tr_b16 v[24:25], v233 offset:4096
    ds_read_b64_tr_b16 v[26:27], v233 offset:4352
    ds_read_b64_tr_b16 v[28:29], v233 offset:6144
    ds_read_b64_tr_b16 v[30:31], v233 offset:6400
    ds_read_b64_tr_b16 v[32:33], v233 offset:8192
    ds_read_b64_tr_b16 v[34:35], v233 offset:8448
    ds_read_b64_tr_b16 v[36:37], v233 offset:10240
    ds_read_b64_tr_b16 v[38:39], v233 offset:10496
    ds_read_b64_tr_b16 v[40:41], v233 offset:12288
    ds_read_b64_tr_b16 v[42:43], v233 offset:12544
    ds_read_b64_tr_b16 v[44:45], v233 offset:14336
    ds_read_b64_tr_b16 v[46:47], v233 offset:14592
    ds_read_b64_tr_b16 v[48:49], v233 offset:16384
    ds_read_b64_tr_b16 v[50:51], v233 offset:16640
    ds_read_b64_tr_b16 v[52:53], v233 offset:18432
    ds_read_b64_tr_b16 v[54:55], v233 offset:18688
    ds_read_b64_tr_b16 v[56:57], v233 offset:20480
    ds_read_b64_tr_b16 v[58:59], v233 offset:20736
    ds_read_b64_tr_b16 v[60:61], v233 offset:22528
    ds_read_b64_tr_b16 v[62:63], v233 offset:22784
    ds_read_b64_tr_b16 v[64:65], v233 offset:24576
    ds_read_b64_tr_b16 v[66:67], v233 offset:24832
    ds_read_b64_tr_b16 v[68:69], v233 offset:26624
    ds_read_b64_tr_b16 v[70:71], v233 offset:26880
    ds_read_b64_tr_b16 v[72:73], v233 offset:28672
    ds_read_b64_tr_b16 v[74:75], v233 offset:28928
    ds_read_b64_tr_b16 v[76:77], v233 offset:30720
    ds_read_b64_tr_b16 v[78:79], v233 offset:30976
    ds_read_b64_tr_b16 v[80:81], v233 offset:32768
    ds_read_b64_tr_b16 v[82:83], v233 offset:33024
    ds_read_b64_tr_b16 v[84:85], v233 offset:34816
    ds_read_b64_tr_b16 v[86:87], v233 offset:35072
    ds_read_b64_tr_b16 v[88:89], v233 offset:36864
    ds_read_b64_tr_b16 v[90:91], v233 offset:37120
    ds_read_b64_tr_b16 v[92:93], v233 offset:38912
    ds_read_b64_tr_b16 v[94:95], v233 offset:39168
    ds_read_b64_tr_b16 v[96:97], v5 offset:0
    ds_read_b64_tr_b16 v[98:99], v5 offset:256
    ds_read_b64_tr_b16 v[100:101], v5 offset:2048
    ds_read_b64_tr_b16 v[102:103], v5 offset:2304
    ds_read_b64_tr_b16 v[104:105], v5 offset:4096
    ds_read_b64_tr_b16 v[106:107], v5 offset:4352
    ds_read_b64_tr_b16 v[108:109], v5 offset:6144
    ds_read_b64_tr_b16 v[110:111], v5 offset:6400
    ds_read_b64_tr_b16 v[112:113], v5 offset:8192
    ds_read_b64_tr_b16 v[114:115], v5 offset:8448
    ds_read_b64_tr_b16 v[116:117], v5 offset:10240
    ds_read_b64_tr_b16 v[118:119], v5 offset:10496
    ds_read_b64_tr_b16 v[120:121], v5 offset:12288
    ds_read_b64_tr_b16 v[122:123], v5 offset:12544
    ds_read_b64_tr_b16 v[124:125], v5 offset:14336
    ds_read_b64_tr_b16 v[126:127], v5 offset:14592
    ds_read_b64_tr_b16 v[128:129], v5 offset:16384
    ds_read_b64_tr_b16 v[130:131], v5 offset:16640
    ds_read_b64_tr_b16 v[132:133], v5 offset:18432
    ds_read_b64_tr_b16 v[134:135], v5 offset:18688
    ds_read_b64_tr_b16 v[136:137], v5 offset:20480
    ds_read_b64_tr_b16 v[138:139], v5 offset:20736
    ds_read_b64_tr_b16 v[140:141], v5 offset:22528
    ds_read_b64_tr_b16 v[142:143], v5 offset:22784
    ds_read_b64_tr_b16 v[144:145], v5 offset:24576
    ds_read_b64_tr_b16 v[146:147], v5 offset:24832
    ds_read_b64_tr_b16 v[148:149], v5 offset:26624
    ds_read_b64_tr_b16 v[150:151], v5 offset:26880
    ds_read_b64_tr_b16 v[152:153], v5 offset:28672
    ds_read_b64_tr_b16 v[154:155], v5 offset:28928
    ds_read_b64_tr_b16 v[156:157], v5 offset:30720
    ds_read_b64_tr_b16 v[158:159], v5 offset:30976
    ds_read_b64_tr_b16 v[160:161], v5 offset:32768
    ds_read_b64_tr_b16 v[162:163], v5 offset:33024
    ds_read_b64_tr_b16 v[164:165], v5 offset:34816
    ds_read_b64_tr_b16 v[166:167], v5 offset:35072
    ds_read_b64_tr_b16 v[168:169], v5 offset:36864
    ds_read_b64_tr_b16 v[170:171], v5 offset:37120
    ds_read_b64_tr_b16 v[172:173], v5 offset:38912
    ds_read_b64_tr_b16 v[174:175], v5 offset:39168
    s_waitcnt vmcnt(0) lgkmcnt(0)
    s_mov_b64 exec, 1
    ds_add_u32 v12, v13 offset:60
    s_mov_b64 exec, -1
    s_mov_b32 s3, 1048576
K_FGK:
    ds_read_b32 v2, v12 offset:48
    s_sleep 1
    s_sub_u32 s3, s3, 1
    s_waitcnt lgkmcnt(0)
    v_readfirstlane_b32 s33, v2
    s_nop 3
    s_cselect_b32 s33, 1, s33
    s_cmp_lt_u32 s33, 1
    s_cbranch_scc1 K_FGK
    ds_read_b128 v[188:191], v234 offset:0
    ds_read_b128 v[192:195], v234 offset:64
    ds_read_b128 v[196:199], v234 offset:128
    ds_read_b128 v[200:203], v234 offset:192
    ds_read_b128 v[204:207], v234 offset:256
    ds_read_b128 v[208:211], v234 offset:320
    ds_read_b128 v[212:215], v234 offset:384
    ds_read_b128 v[216:219], v234 offset:448
    s_waitcnt lgkmcnt(7)
    v_mfma_f32_16x16x32_bf16 v[220:223], v[16:19], v[188:191], 0
    v_mfma_f32_16x16x32_bf16 v[224:227], v[96:99], v[188:191], 0
    ds_read_b128 v[188:191], v234 offset:512
    s_waitcnt lgkmcnt(7)
    v_mfma_f32_16x16x32_bf16 v[220:223], v[20:23], v[192:195], v[220:223]
    v_mfma_f32_16x16x32_bf16 v[224:227], v[100:103], v[192:195], v[224:227]
    ds_read_b128 v[192:195], v234 offset:576
    s_waitcnt lgkmcnt(7)
    v_mfma_f32_16x16x32_bf16 v[220:223], v[24:27], v[196:199], v[220:223]
    v_mfma_f32_16x16x32_bf16 v[224:227], v[104:107], v[196:199], v[224:227]
    ds_read_b128 v[196:199], v234 offset:640
    s_waitcnt lgkmcnt(7)
    v_mfma_f32_16x16x32_bf16 v[220:223], v[28:31], v[200:203], v[220:223]
    v_mfma_f32_16x16x32_bf16 v[224:227], v[108:111], v[200:203], v[224:227]
    ds_read_b128 v[200:203], v234 offset:704
    s_waitcnt lgkmcnt(7)
    v_mfma_f32_16x16x32_bf16 v[220:223], v[32:35], v[204:207], v[220:223]
    v_mfma_f32_16x16x32_bf16 v[224:227], v[112:115], v[204:207], v[224:227]
    ds_read_b128 v[204:207], v234 offset:768
    s_waitcnt lgkmcnt(7)
    v_mfma_f32_16x16x32_bf16 v[220:223], v[36:39], v[208:211], v[220:223]
    v_mfma_f32_16x16x32_bf16 v[224:227], v[116:119], v[208:211], v[224:227]
    ds_read_b128 v[208:211], v234 offset:832
    s_waitcnt lgkmcnt(7)
    v_mfma_f32_16x16x32_bf16 v[220:223], v[40:43], v[212:215], v[220:223]
    v_mfma_f32_16x16x32_bf16 v[224:227], v[120:123], v[212:215], v[224:227]
    ds_read_b128 v[212:215], v234 offset:896
    s_waitcnt lgkmcnt(7)
    v_mfma_f32_16x16x32_bf16 v[220:223], v[44:47], v[216:219], v[220:223]
    v_mfma_f32_16x16x32_bf16 v[224:227], v[124:127], v[216:219], v[224:227]
    ds_read_b128 v[216:219], v234 offset:960
    s_waitcnt lgkmcnt(7)
    v_mfma_f32_16x16x32_bf16 v[220:223], v[48:51], v[188:191], v[220:223]
    v_mfma_f32_16x16x32_bf16 v[224:227], v[128:131], v[188:191], v[224:227]
    ds_read_b128 v[188:191], v234 offset:1024
    s_waitcnt lgkmcnt(7)
    v_mfma_f32_16x16x32_bf16 v[220:223], v[52:55], v[192:195], v[220:223]
    v_mfma_f32_16x16x32_bf16 v[224:227], v[132:135], v[192:195], v[224:227]
    ds_read_b128 v[192:195], v234 offset:1088
    s_waitcnt lgkmcnt(7)
    v_mfma_f32_16x16x32_bf16 v[220:223], v[56:59], v[196:199], v[220:223]
    v_mfma_f32_16x16x32_bf16 v[224:227], v[136:139], v[196:199], v[224:227]
    ds_read_b128 v[196:199], v234 offset:1152
    s_waitcnt lgkmcnt(7)
    v_mfma_f32_16x16x32_bf16 v[220:223], v[60:63], v[200:203], v[220:223]
    v_mfma_f32_16x16x32_bf16 v[224:227], v[140:143], v[200:203], v[224:227]
    ds_read_b128 v[200:203], v234 offset:1216
    s_waitcnt lgkmcnt(7)
    v_mfma_f32_16x16x32_bf16 v[220:223], v[64:67], v[204:207], v[220:223]
    v_mfma_f32_16x16x32_bf16 v[224:227], v[144:147], v[204:207], v[224:227]
    s_waitcnt lgkmcnt(6)
    v_mfma_f32_16x16x32_bf16 v[220:223], v[68:71], v[208:211], v[220:223]
    v_mfma_f32_16x16x32_bf16 v[224:227], v[148:151], v[208:211], v[224:227]
    s_waitcnt lgkmcnt(5)
    v_mfma_f32_16x16x32_bf16 v[220:223], v[72:75], v[212:215], v[220:223]
    v_mfma_f32_16x16x32_bf16 v[224:227], v[152:155], v[212:215], v[224:227]
    s_waitcnt lgkmcnt(4)
    v_mfma_f32_16x16x32_bf16 v[220:223], v[76:79], v[216:219], v[220:223]
    v_mfma_f32_16x16x32_bf16 v[224:227], v[156:159], v[216:219], v[224:227]
    s_waitcnt lgkmcnt(3)
    v_mfma_f32_16x16x32_bf16 v[220:223], v[80:83], v[188:191], v[220:223]
    v_mfma_f32_16x16x32_bf16 v[224:227], v[160:163], v[188:191], v[224:227]
    s_waitcnt lgkmcnt(2)
    v_mfma_f32_16x16x32_bf16 v[220:223], v[84:87], v[192:195], v[220:223]
    v_mfma_f32_16x16x32_bf16 v[224:227], v[164:167], v[192:195], v[224:227]
    s_waitcnt lgkmcnt(1)
    v_mfma_f32_16x16x32_bf16 v[220:223], v[88:91], v[196:199], v[220:223]
    v_mfma_f32_16x16x32_bf16 v[224:227], v[168:171], v[196:199], v[224:227]
    s_waitcnt lgkmcnt(0)
    v_mfma_f32_16x16x32_bf16 v[220:223], v[92:95], v[200:203], v[220:223]
    v_mfma_f32_16x16x32_bf16 v[224:227], v[172:175], v[200:203], v[224:227]
    s_mov_b32 s3, 1048576
K_FGDN:
    ds_read_b32 v2, v12 offset:52
    s_sleep 1
    s_sub_u32 s3, s3, 1
    s_waitcnt lgkmcnt(0)
    v_readfirstlane_b32 s33, v2
    s_nop 3
    s_cselect_b32 s33, 3, s33
    s_cmp_lt_u32 s33, 3
    s_cbranch_scc1 K_FGDN
    ds_read_b64_tr_b16 v[16:17], v238 offset:0
    ds_read_b64_tr_b16 v[18:19], v238 offset:2048
    ds_read_b64_tr_b16 v[20:21], v239 offset:0
    ds_read_b64_tr_b16 v[22:23], v239 offset:2048
    ds_read_b64_tr_b16 v[24:25], v240 offset:0
    ds_read_b64_tr_b16 v[26:27], v240 offset:2048
    ds_read_b64_tr_b16 v[28:29], v241 offset:0
    ds_read_b64_tr_b16 v[30:31], v241 offset:2048
    ds_read_b64_tr_b16 v[32:33], v238 offset:4096
    ds_read_b64_tr_b16 v[34:35], v238 offset:6144
    ds_read_b64_tr_b16 v[36:37], v239 offset:4096
    ds_read_b64_tr_b16 v[38:39], v239 offset:6144
    ds_read_b64_tr_b16 v[40:41], v240 offset:4096
    ds_read_b64_tr_b16 v[42:43], v240 offset:6144
    v_cvt_pk_bf16_f32 v221, v220, v221
    v_lshlrev_b32 v220, 16, v221
    v_and_b32 v221, 0xffff0000, v221
    v_cvt_pk_bf16_f32 v223, v222, v223
    v_lshlrev_b32 v222, 16, v223
    v_and_b32 v223, 0xffff0000, v223
    v_cvt_pk_bf16_f32 v225, v224, v225
    v_lshlrev_b32 v224, 16, v225
    v_and_b32 v225, 0xffff0000, v225
    v_cvt_pk_bf16_f32 v227, v226, v227
    v_lshlrev_b32 v226, 16, v227
    v_and_b32 v227, 0xffff0000, v227
    v_mul_f32 v188, 0xbfb8aa3b, v220
    v_mul_f32 v189, 0xbfb8aa3b, v221
    v_mul_f32 v190, 0xbfb8aa3b, v222
    v_mul_f32 v191, 0xbfb8aa3b, v223
    v_exp_f32 v188, v188
    v_exp_f32 v189, v189
    v_exp_f32 v190, v190
    v_exp_f32 v191, v191
    v_add_f32 v188, 1.0, v188
    v_add_f32 v189, 1.0, v189
    v_add_f32 v190, 1.0, v190
    v_add_f32 v191, 1.0, v191
    v_rcp_f32 v188, v188
    v_rcp_f32 v189, v189
    v_rcp_f32 v190, v190
    v_rcp_f32 v191, v191
    v_mul_f32 v220, v220, v188
    v_mul_f32 v221, v221, v189
    v_mul_f32 v222, v222, v190
    v_mul_f32 v223, v223, v191
    v_cvt_pk_bf16_f32 v221, v220, v221
    v_lshlrev_b32 v220, 16, v221
    v_and_b32 v221, 0xffff0000, v221
    v_cvt_pk_bf16_f32 v223, v222, v223
    v_lshlrev_b32 v222, 16, v223
    v_and_b32 v223, 0xffff0000, v223
    v_mul_f32 v220, v220, v224
    v_mul_f32 v221, v221, v225
    v_mul_f32 v222, v222, v226
    v_mul_f32 v223, v223, v227
    v_cvt_pk_bf16_f32 v228, v220, v221
    v_cvt_pk_bf16_f32 v229, v222, v223
    ds_write_b64 v235, v[228:229]
    s_mov_b64 exec, 1
    ds_add_u32 v12, v13 offset:52
    s_mov_b64 exec, -1
    ds_read_b64_tr_b16 v[44:45], v241 offset:4096
    ds_read_b64_tr_b16 v[46:47], v241 offset:6144
    ds_read_b64_tr_b16 v[48:49], v238 offset:8192
    ds_read_b64_tr_b16 v[50:51], v238 offset:10240
    ds_read_b64_tr_b16 v[52:53], v239 offset:8192
    ds_read_b64_tr_b16 v[54:55], v239 offset:10240
    ds_read_b64_tr_b16 v[56:57], v240 offset:8192
    ds_read_b64_tr_b16 v[58:59], v240 offset:10240
    ds_read_b64_tr_b16 v[60:61], v241 offset:8192
    ds_read_b64_tr_b16 v[62:63], v241 offset:10240
    ds_read_b64_tr_b16 v[64:65], v238 offset:12288
    ds_read_b64_tr_b16 v[66:67], v238 offset:14336
    ds_read_b64_tr_b16 v[68:69], v239 offset:12288
    ds_read_b64_tr_b16 v[70:71], v239 offset:14336
    ds_read_b64_tr_b16 v[72:73], v240 offset:12288
    ds_read_b64_tr_b16 v[74:75], v240 offset:14336
    ds_read_b64_tr_b16 v[76:77], v241 offset:12288
    ds_read_b64_tr_b16 v[78:79], v241 offset:14336
    ds_read_b64_tr_b16 v[80:81], v238 offset:16384
    ds_read_b64_tr_b16 v[82:83], v238 offset:18432
    ds_read_b64_tr_b16 v[84:85], v239 offset:16384
    ds_read_b64_tr_b16 v[86:87], v239 offset:18432
    ds_read_b64_tr_b16 v[88:89], v240 offset:16384
    ds_read_b64_tr_b16 v[90:91], v240 offset:18432
    ds_read_b64_tr_b16 v[92:93], v241 offset:16384
    ds_read_b64_tr_b16 v[94:95], v241 offset:18432
    s_mov_b32 s3, 1048576
K_FGP:
    ds_read_b32 v2, v12 offset:52
    s_sleep 0
    s_sub_u32 s3, s3, 1
    s_waitcnt lgkmcnt(0)
    v_readfirstlane_b32 s33, v2
    s_nop 3
    s_cselect_b32 s33, 5, s33
    s_cmp_lt_u32 s33, 5
    s_cbranch_scc1 K_FGP
    ds_read_b128 v[228:231], v236
    s_waitcnt lgkmcnt(0)
    v_mfma_f32_16x16x32_bf16 v[96:99], v[16:19], v[228:231], 0
    v_mfma_f32_16x16x32_bf16 v[100:103], v[20:23], v[228:231], 0
    v_mfma_f32_16x16x32_bf16 v[104:107], v[24:27], v[228:231], 0
    v_mfma_f32_16x16x32_bf16 v[108:111], v[28:31], v[228:231], 0
    v_mfma_f32_16x16x32_bf16 v[112:115], v[32:35], v[228:231], 0
    v_mfma_f32_16x16x32_bf16 v[116:119], v[36:39], v[228:231], 0
    v_mfma_f32_16x16x32_bf16 v[120:123], v[40:43], v[228:231], 0
    v_mfma_f32_16x16x32_bf16 v[124:127], v[44:47], v[228:231], 0
    v_mfma_f32_16x16x32_bf16 v[128:131], v[48:51], v[228:231], 0
    v_mfma_f32_16x16x32_bf16 v[132:135], v[52:55], v[228:231], 0
    v_mfma_f32_16x16x32_bf16 v[136:139], v[56:59], v[228:231], 0
    v_mfma_f32_16x16x32_bf16 v[140:143], v[60:63], v[228:231], 0
    v_mfma_f32_16x16x32_bf16 v[144:147], v[64:67], v[228:231], 0
    v_mfma_f32_16x16x32_bf16 v[148:151], v[68:71], v[228:231], 0
    v_mfma_f32_16x16x32_bf16 v[152:155], v[72:75], v[228:231], 0
    v_mfma_f32_16x16x32_bf16 v[156:159], v[76:79], v[228:231], 0
    v_mfma_f32_16x16x32_bf16 v[160:163], v[80:83], v[228:231], 0
    v_mfma_f32_16x16x32_bf16 v[164:167], v[84:87], v[228:231], 0
    v_mfma_f32_16x16x32_bf16 v[168:171], v[88:91], v[228:231], 0
    v_mfma_f32_16x16x32_bf16 v[172:175], v[92:95], v[228:231], 0
    s_mov_b32 exec_lo, 0x00030003
    s_mov_b32 exec_hi, 0x00030003
    buffer_store_dwordx4 v[96:99], v237, s[64:67], s72 offen offset:0 sc1
    buffer_store_dwordx4 v[100:103], v237, s[64:67], s72 offen offset:64 sc1
    buffer_store_dwordx4 v[104:107], v237, s[64:67], s72 offen offset:128 sc1
    buffer_store_dwordx4 v[108:111], v237, s[64:67], s72 offen offset:192 sc1
    buffer_store_dwordx4 v[112:115], v237, s[64:67], s72 offen offset:256 sc1
    buffer_store_dwordx4 v[116:119], v237, s[64:67], s72 offen offset:320 sc1
    buffer_store_dwordx4 v[120:123], v237, s[64:67], s72 offen offset:384 sc1
    buffer_store_dwordx4 v[124:127], v237, s[64:67], s72 offen offset:448 sc1
    buffer_store_dwordx4 v[128:131], v237, s[64:67], s72 offen offset:512 sc1
    buffer_store_dwordx4 v[132:135], v237, s[64:67], s72 offen offset:576 sc1
    buffer_store_dwordx4 v[136:139], v237, s[64:67], s72 offen offset:640 sc1
    buffer_store_dwordx4 v[140:143], v237, s[64:67], s72 offen offset:704 sc1
    buffer_store_dwordx4 v[144:147], v237, s[64:67], s72 offen offset:768 sc1
    buffer_store_dwordx4 v[148:151], v237, s[64:67], s72 offen offset:832 sc1
    buffer_store_dwordx4 v[152:155], v237, s[64:67], s72 offen offset:896 sc1
    buffer_store_dwordx4 v[156:159], v237, s[64:67], s72 offen offset:960 sc1
    buffer_store_dwordx4 v[160:163], v237, s[64:67], s72 offen offset:1024 sc1
    buffer_store_dwordx4 v[164:167], v237, s[64:67], s72 offen offset:1088 sc1
    buffer_store_dwordx4 v[168:171], v237, s[64:67], s72 offen offset:1152 sc1
    buffer_store_dwordx4 v[172:175], v237, s[64:67], s72 offen offset:1216 sc1
    s_mov_b64 exec, -1
    s_mul_i32 s3, s73, 2560
    s_lshl2_add_u32 s3, s44, s3
    s_add_u32 s3, s3, 568320
    v_lshl_add_u32 v2, v1, 8, s3
    s_mov_b64 exec, 0x3ff
    s_waitcnt vmcnt(0)
    global_store_dword v2, v13, s[10:11] sc1
    s_mov_b64 exec, -1
    s_branch K_P2_HELP
K_CODE_END:
.section .rodata,"a"
.p2align 6
.amdhsa_kernel gated_mix__sliding_local_dilated__moe_arch_mod__prompt_kernel
  .amdhsa_next_free_vgpr 248
  .amdhsa_next_free_sgpr 79
  .amdhsa_accum_offset 248
  .amdhsa_group_segment_fixed_size 0
  .amdhsa_kernarg_size 96
  .amdhsa_user_sgpr_count 2
  .amdhsa_user_sgpr_kernarg_segment_ptr 1
  .amdhsa_system_sgpr_workgroup_id_x 1
.end_amdhsa_kernel
```

```asm
; @launch grid=(256,1,1) block=(512,1,1) lds=163840
.amdgcn_target "amdgcn-amd-amdhsa--gfx950"
.text
.p2align 12
.p2align 8
.globl gated_mix__sliding_local_dilated__moe_arch_mod__prompt_kernel
.type gated_mix__sliding_local_dilated__moe_arch_mod__prompt_kernel,@function
gated_mix__sliding_local_dilated__moe_arch_mod__prompt_kernel:
    s_cmp_ge_u32 s2, 256
    s_cbranch_scc1 K_EXIT
    s_load_dwordx2 s[12:13], s[0:1], 0
    s_load_dwordx2 s[16:17], s[0:1], 8
    v_readfirstlane_b32 s30, v0
    s_load_dwordx4 s[8:11], s[0:1], 80
    s_load_dwordx2 s[24:25], s[0:1], 16
    s_load_dwordx2 s[6:7], s[0:1], 72
    s_and_b32 s28, s2, 7
    v_and_b32 v1, 63, v0
    s_mov_b32 s14, 0x280000
    s_mov_b32 s15, 0x20000
    s_lshr_b32 s30, s30, 6
    s_cmp_lt_u32 s2, 64
    s_cbranch_scc1 K_SLOW
    s_cmp_lt_u32 s30, 4
    s_cbranch_scc1 K_FAST
K_SLOW:
    s_getpc_b64 s[38:39]
K_PC:
    s_bfe_u32 s3, s2, 0x30003
    s_mul_i32 s3, s3, ((K_CODE_END-gated_mix__sliding_local_dilated__moe_arch_mod__prompt_kernel+1023)/1024)
    s_sub_u32 s38, s38, K_PC-gated_mix__sliding_local_dilated__moe_arch_mod__prompt_kernel
    s_subb_u32 s39, s39, 0
    v_subrev_u32 v3, 256, v0
    v_add_u32 v2, s3, v3
    v_lshlrev_b32 v2, 7, v2
    v_min_u32 v2, K_CODE_END-gated_mix__sliding_local_dilated__moe_arch_mod__prompt_kernel-4, v2
    v_cmp_gt_u32 vcc, ((K_CODE_END-gated_mix__sliding_local_dilated__moe_arch_mod__prompt_kernel+1023)/1024), v3
    s_and_saveexec_b64 s[4:5], vcc
    s_cbranch_execz K_NOPF
    global_load_dword v6, v2, s[38:39]
K_NOPF:
    s_mov_b64 exec, -1
    v_mov_b32 v2, 0
    v_mov_b32 v3, 158752
    ds_write2_b32 v3, v2, v2 offset0:0 offset1:1
    ds_write2_b32 v3, v2, v2 offset0:2 offset1:3
    ds_write2_b32 v3, v2, v2 offset0:4 offset1:5
    ds_write2_b32 v3, v2, v2 offset0:6 offset1:7
    ds_write2_b32 v3, v2, v2 offset0:8 offset1:9
    ds_write2_b32 v3, v2, v2 offset0:10 offset1:11
    s_mov_b32 s43, 1
    s_lshl_b32 s3, s30, 8
    s_add_u32 s3, s3, s2
    s_lshr_b32 s3, s3, 3
    s_cmp_lg_u32 s3, 160
    s_cbranch_scc1 K_COMMON
    s_mul_i32 s3, s2, 6144
    s_add_u32 s3, s3, 527360
    v_lshl_add_u32 v6, v1, 4, s3
    v_mov_b64 v[28:29], 0
    v_mov_b64 v[30:31], 0
    s_waitcnt lgkmcnt(0)
    global_store_dwordx4 v6, v[28:31], s[10:11] offset:-3072 sc1
    global_store_dwordx4 v6, v[28:31], s[10:11] offset:-2048 sc1
    global_store_dwordx4 v6, v[28:31], s[10:11] offset:-1024 sc1
    global_store_dwordx4 v6, v[28:31], s[10:11] offset:0 sc1
    global_store_dwordx4 v6, v[28:31], s[10:11] offset:1024 sc1
    global_store_dwordx4 v6, v[28:31], s[10:11] offset:2048 sc1
    s_lshl_b32 s3, s2, 2
    v_mov_b32 v2, s3
    v_mov_b32 v3, 1
    s_mov_b64 exec, 1
    s_waitcnt vmcnt(0)
    global_store_dword v2, v3, s[8:9] offset:192 sc1
    s_mov_b64 exec, -1
    s_branch K_COMMON
K_FAST:
    s_lshr_b32 s32, s2, 1
    s_and_b32 s32, s32, 28
    v_lshrrev_b32 v3, 4, v1
    s_lshr_b32 s3, s2, 6
    s_mov_b32 s59, 0x98450216
    s_cmp_eq_u32 s3, 2
    s_cselect_b32 s59, 0x70238164, s59
    v_and_b32 v4, 7, v1
    s_cmp_eq_u32 s3, 3
    s_cselect_b32 s59, 0x65703481, s59
    v_lshrrev_b32 v2, 3, v1
    s_lshr_b32 s59, s59, s32
    s_and_b32 s59, s59, 15
    v_xor_b32 v4, v4, v3
    s_add_u32 s59, s59, s28
    s_cmp_ge_u32 s59, 10
    v_mul_u32_u24 v2, 1280, v2
    s_cselect_b32 s33, 10, 0
    s_sub_u32 s59, s59, s33
    s_lshr_b32 s53, s28, 1
    v_lshl_add_u32 v44, v4, 4, v2
    s_mul_i32 s53, s53, 655360
    s_lshl2_add_u32 s62, s3, s30
    s_cmp_eq_u32 s62, 15
    s_cselect_b32 s62, 0x800000, 0
    s_add_u32 s62, s62, 40960
    s_mul_i32 s3, s3, 225280
    v_xor_b32 v45, 64, v44
    s_add_u32 s53, s53, s3
    s_mul_i32 s54, s30, 61440
    s_add_u32 s53, s53, s54
    s_sub_u32 s53, s53, 245760
    s_mul_i32 s55, s30, 6144
    s_add_u32 s55, s55, 40960
    s_lshl_b32 s57, s59, 7
    s_add_u32 s57, s57, s53
    s_waitcnt lgkmcnt(0)
    s_add_u32 m0, s55, 0
    s_max_i32 s60, s57, 0
    buffer_load_dwordx4 v44, s[12:15], s60 offen lds
    s_add_u32 s60, s57, 10240
    s_add_u32 m0, s55, 1024
    s_max_i32 s60, s60, 0
    buffer_load_dwordx4 v45, s[12:15], s60 offen lds
    s_add_u32 m0, s55, 2048
    s_add_u32 s60, s57, 20480
    buffer_load_dwordx4 v44, s[12:15], s60 offen lds
    s_add_u32 m0, s55, 3072
    s_add_u32 s60, s57, 30720
    buffer_load_dwordx4 v45, s[12:15], s60 offen lds
    s_add_u32 m0, s55, 4096
    s_add_u32 s60, s57, s62
    buffer_load_dwordx4 v44, s[12:15], s60 offen lds
    s_add_u32 m0, s55, 5120
    s_add_u32 s60, s60, 10240
    buffer_load_dwordx4 v45, s[12:15], s60 offen lds
    v_lshlrev_b32 v2, 1, v3
    s_lshr_b32 s32, 0x64317520, s32
    v_sub_u32 v2, v1, v2
    s_and_b32 s32, s32, 7
    v_and_b32 v2, 15, v2
    s_and_b32 s3, s28, 1
    v_mul_u32_u24 v3, 3840, v3
    s_lshl3_add_u32 s32, s3, s32
    v_mul_u32_u24 v4, 13, v2
    s_mul_i32 s3, s32, 80
    v_lshrrev_b32 v4, 6, v4
    s_add_u32 s54, s54, s3
    v_mul_u32_u24 v4, 1200, v4
    s_lshl_b32 s56, s30, 12
    v_lshl_add_u32 v4, v2, 4, v4
    s_add_u32 s56, s56, 65536
    v_add_u32 v5, 1, v2
    s_mov_b32 s18, 0x258000
    v_and_b32 v5, 16, v5
    s_mov_b32 s19, 0x20000
    v_lshl_add_u32 v4, v5, 24, v4
    v_add_u32 v46, v3, v4
    s_mul_i32 s58, s59, 245760
    s_add_u32 s58, s58, s54
    s_add_u32 s59, s59, 1
    s_cmp_eq_u32 s59, 10
    s_cselect_b32 s59, 0, s59
    s_add_u32 m0, s56, 0
    s_add_u32 s60, s58, 0
    buffer_load_dwordx4 v46, s[16:19], s60 offen lds
    s_add_u32 m0, s56, 1024
    s_add_u32 s60, s58, 15360
    buffer_load_dwordx4 v46, s[16:19], s60 offen lds
    v_xor_b32 v2, 8, v2
    v_mul_u32_u24 v4, 13, v2
    v_lshrrev_b32 v4, 6, v4
    v_mul_u32_u24 v4, 1200, v4
    v_lshl_add_u32 v4, v2, 4, v4
    v_add_u32 v5, 1, v2
    v_and_b32 v5, 16, v5
    v_lshl_add_u32 v4, v5, 24, v4
    v_add_u32 v47, v3, v4
    s_add_u32 m0, s56, 2048
    s_add_u32 s60, s58, 30720
    buffer_load_dwordx4 v47, s[16:19], s60 offen lds
    s_add_u32 m0, s56, 3072
    s_add_u32 s60, s58, 46080
    buffer_load_dwordx4 v47, s[16:19], s60 offen lds
    s_mov_b32 s3, 40960
    s_cmp_ge_u32 s55, 81920
    s_cselect_b32 s60, -81920, s3
    s_add_u32 s55, s55, s60
    s_add_u32 s56, s56, s60
    s_lshl_b32 s57, s59, 7
    s_add_u32 s57, s57, s53
    s_mul_i32 s58, s59, 245760
    s_add_u32 s58, s58, s54
    s_add_u32 s59, s59, 1
    s_cmp_eq_u32 s59, 10
    s_cselect_b32 s59, 0, s59
    s_add_u32 m0, s56, 0
    s_add_u32 s60, s58, 0
    buffer_load_dwordx4 v46, s[16:19], s60 offen lds
    s_add_u32 m0, s55, 0
    s_max_i32 s60, s57, 0
    buffer_load_dwordx4 v44, s[12:15], s60 offen lds
    s_add_u32 m0, s56, 1024
    s_add_u32 s60, s58, 15360
    buffer_load_dwordx4 v46, s[16:19], s60 offen lds
    s_add_u32 s60, s57, 10240
    s_add_u32 m0, s55, 1024
    s_max_i32 s60, s60, 0
    buffer_load_dwordx4 v45, s[12:15], s60 offen lds
    s_add_u32 m0, s55, 2048
    s_add_u32 s60, s57, 20480
    buffer_load_dwordx4 v44, s[12:15], s60 offen lds
    s_mov_b32 s52, s30
    s_mov_b32 s43, 0
K_COMMON:
    v_mov_b32 v7, 0
    s_lshr_b32 s29, s2, 3
    s_xor_b32 s30, s30, 4
    s_mov_b32 s26, 0xc8000
    s_mov_b32 s27, 0x20000
    s_lshr_b32 s34, s29, 3
    s_lshl_b32 s34, s34, 2
    s_and_b32 s3, s29, 3
    s_add_u32 s34, s34, s3
    s_add_u32 s34, s34, 4
    s_bitcmp1_b32 s29, 2
    s_cselect_b32 s34, -1, s34
    s_cmp_lt_u32 s29, 8
    s_cselect_b32 s34, s29, s34
    s_lshl_b32 s40, s28, 1
    s_cmp_ge_u32 s34, 10
    s_addc_u32 s40, s40, 0
    s_sub_u32 s41, s34, 10
    s_cmp_ge_u32 s34, 10
    s_cselect_b32 s41, s41, s34
    s_mul_i32 s42, s28, 20
    s_add_u32 s42, s42, s34
    s_and_b32 s42, s42, 255
    s_lshl_b32 s42, s42, 8
    s_add_u32 s42, s42, 524288
    s_cmp_lt_u32 s29, 8
    s_cbranch_scc1 K_AUX
    s_lshr_b32 s31, s29, 3
    s_sub_u32 s31, s31, 1
    s_and_b32 s35, s29, 3
    s_and_b32 s3, s29, 4
    s_lshl_b32 s3, s3, 1
    s_add_u32 s35, s35, s3
    s_and_b32 s3, s28, 1
    s_lshl_b32 s3, s3, 2
    s_add_u32 s35, s35, s3
    v_and_b32 v9, 15, v1
    v_lshrrev_b32 v10, 4, v1
    v_bfe_u32 v11, v1, 2, 2
    v_and_b32 v12, 3, v1
    s_waitcnt lgkmcnt(0)
    s_add_u32 s20, s10, 0x100000
    s_addc_u32 s21, s11, 0
    s_mov_b32 s22, 0x280000
    s_mov_b32 s23, 0x20000
    s_and_b32 s3, s30, 3
    s_mul_i32 s3, s3, 3
    s_lshr_b32 s33, s30, 2
    s_lshl1_add_u32 s3, s33, s3
    s_mul_i32 s44, s31, 11
    s_add_u32 s44, s44, s3
    s_cmp_eq_u32 s44, 31
    s_cselect_b32 s51, 4, s30
    s_lshr_b32 s33, s28, 1
    s_lshl_b32 s33, s33, 5
    s_add_u32 s44, s44, s33
    s_mul_i32 s3, s3, 4352
    s_add_u32 s3, s3, 81920
    v_mul_u32_u24 v14, 272, v9
    v_lshl_add_u32 v13, v10, 3, v14
    v_add_u32 v13, s3, v13
    v_add3_u32 v14, v14, 32, s3
    v_cmp_eq_u32 vcc, 0, v10
    v_add_u32 v2, 208, v14
    v_add_u32 v3, 0, v14
    v_add_u32 v4, 40, v14
    v_cndmask_b32 v19, v2, v3, vcc
    v_cndmask_b32 v20, v2, v4, vcc
    v_lshl_add_u32 v15, v10, 2, v11
    v_mul_u32_u24 v15, 272, v15
    v_add_u32 v5, s3, v15
    v_lshl_add_u32 v15, v12, 3, v5
    v_add_u32 v2, 240, v5
    v_add_u32 v3, 192, v5
    v_add_u32 v4, 232, v5
    v_cmp_eq_u32 vcc, 0, v12
    s_nop 1
    v_cndmask_b32 v21, v2, v3, vcc
    v_cmp_eq_u32 vcc, 1, v12
    s_nop 1
    v_cndmask_b32 v22, v2, v4, vcc
    v_cmp_eq_u32 vcc, 2, v12
    s_nop 1
    v_cndmask_b32 v23, v2, v3, vcc
    v_cmp_eq_u32 vcc, 3, v12
    s_nop 1
    v_cndmask_b32 v24, v2, v4, vcc
    s_lshl_b32 s3, s35, 10
    v_lshl_add_u32 v16, v1, 4, s3
    s_lshl_b32 s3, s35, 8
    s_add_u32 s3, s3, 16384
    v_lshl_add_u32 v17, v9, 4, s3
    v_and_b32 v2, 1, v10
    v_lshl_add_u32 v17, v2, 3, v17
    s_cmp_lt_u32 s51, 4
    s_cselect_b32 s3, 0, 0x800000
    s_add_u32 s3, s3, 20480
    v_lshrrev_b32 v2, 1, v10
    v_mad_u32_u24 v17, v2, s3, v17
    s_mul_i32 s50, s44, 20480
    s_add_u32 s51, s50, s3
    v_mov_b32 v18, 0xf149f2ca
    v_lshlrev_b32 v2, 2, v10
    v_sub_u32 v2, v9, v2
    s_cmp_eq_u32 s44, 0
    s_cselect_b32 s3, 0xf149f2ca, 0
    v_subrev_u32 v3, 0, v2
    v_and_b32 v4, 0x80000001, v3
    v_cmp_eq_u32 vcc, 0, v4
    s_nop 1
    v_cndmask_b32 v32, v18, 0, vcc
    v_cmp_eq_u32 vcc, 0x80000000, v4
    s_nop 1
    v_cndmask_b32 v28, v18, 0, vcc
    v_add_f32 v36, s3, v28
    v_subrev_u32 v3, 1, v2
    v_and_b32 v4, 0x80000001, v3
    v_cmp_eq_u32 vcc, 0, v4
    s_nop 1
    v_cndmask_b32 v33, v18, 0, vcc
    v_cmp_eq_u32 vcc, 0x80000000, v4
    s_nop 1
    v_cndmask_b32 v29, v18, 0, vcc
    v_add_f32 v37, s3, v29
    v_subrev_u32 v3, 2, v2
    v_and_b32 v4, 0x80000001, v3
    v_cmp_eq_u32 vcc, 0, v4
    s_nop 1
    v_cndmask_b32 v34, v18, 0, vcc
    v_cmp_eq_u32 vcc, 0x80000000, v4
    s_nop 1
    v_cndmask_b32 v30, v18, 0, vcc
    v_add_f32 v38, s3, v30
    v_subrev_u32 v3, 3, v2
    v_and_b32 v4, 0x80000001, v3
    v_cmp_eq_u32 vcc, 0, v4
    s_nop 1
    v_cndmask_b32 v35, v18, 0, vcc
    v_cmp_eq_u32 vcc, 0x80000000, v4
    s_nop 1
    v_cndmask_b32 v31, v18, 0, vcc
    v_add_f32 v39, s3, v31
    v_mov_b32 v3, 0x0c0c0c0c
    v_mov_b32 v4, 0xc0c0100
    v_cmp_eq_u32 vcc, 0, v28
    v_mov_b32 v5, 0x1000c0c
    s_nop 0
    v_cndmask_b32 v3, v3, v4, vcc
    v_cmp_eq_u32 vcc, 0, v29
    s_nop 1
    v_cndmask_b32 v40, v3, v5, vcc
    v_mov_b32 v3, 0x0c0c0c0c
    v_mov_b32 v4, 0xc0c0302
    v_cmp_eq_u32 vcc, 0, v30
    v_mov_b32 v5, 0x3020c0c
    s_nop 0
    v_cndmask_b32 v3, v3, v4, vcc
    v_cmp_eq_u32 vcc, 0, v31
    s_nop 1
    v_cndmask_b32 v41, v3, v5, vcc
    v_mov_b32 v3, 0x0c0c0c0c
    v_mov_b32 v4, 0xc0c0100
    v_cmp_eq_u32 vcc, 0, v32
    v_mov_b32 v5, 0x1000c0c
    s_nop 0
    v_cndmask_b32 v3, v3, v4, vcc
    v_cmp_eq_u32 vcc, 0, v33
    s_nop 1
    v_cndmask_b32 v42, v3, v5, vcc
    v_mov_b32 v3, 0x0c0c0c0c
    v_mov_b32 v4, 0xc0c0302
    v_cmp_eq_u32 vcc, 0, v34
    v_mov_b32 v5, 0x3020c0c
    s_nop 0
    v_cndmask_b32 v3, v3, v4, vcc
    v_cmp_eq_u32 vcc, 0, v35
    s_nop 1
    v_cndmask_b32 v43, v3, v5, vcc
    s_mov_b32 s46, 0x3fb8aa3b
    s_mov_b32 s47, s46
    s_mov_b32 s48, 0x3e64f92e
    s_mov_b32 s49, s48
    s_mov_b32 s36, 0xfffff
    s_cmp_lg_u32 s31, 0
    s_cselect_b32 s33, 64, 0
    v_mov_b32 v2, s33
    v_cmp_gt_u32 vcc, 10, v1
    s_lshr_b32 s3, s28, 1
    s_lshl2_add_u32 s3, s3, s31
    v_cndmask_b32 v2, 0, v2, vcc
    v_lshl_add_u32 v2, v1, 8, v2
    s_mul_i32 s3, s3, 2560
    s_lshl2_add_u32 s3, s35, s3
    s_add_u32 s3, s3, 524288
    v_add_u32 v8, s3, v2
    s_cmp_eq_u32 s43, 1
    s_cbranch_scc1 K_CONS
    v_lshrrev_b32 v2, 3, v1
    v_mul_u32_u24 v2, 1280, v2
    v_lshrrev_b32 v3, 4, v1
    v_lshlrev_b32 v3, 1, v3
    v_and_b32 v4, 7, v1
    v_xor_b32 v3, v3, v4
    v_lshl_add_u32 v2, v3, 4, v2
    s_lshl_b32 s33, s41, 7
    v_add_u32 v18, s33, v2
    s_mov_b32 s61, 9
    s_mov_b32 s3, 40960
K_LOOP0:
    s_waitcnt vmcnt(5)
    s_barrier
    s_add_u32 m0, s56, 2048
    s_add_u32 s60, s58, 30720
    buffer_load_dwordx4 v47, s[16:19], s60 offen lds
    s_add_u32 m0, s55, 3072
    s_add_u32 s60, s57, 30720
    buffer_load_dwordx4 v45, s[12:15], s60 offen lds
    s_add_u32 m0, s56, 3072
    s_add_u32 s60, s58, 46080
    buffer_load_dwordx4 v47, s[16:19], s60 offen lds
    s_add_u32 m0, s55, 4096
    s_add_u32 s60, s57, s62
    buffer_load_dwordx4 v44, s[12:15], s60 offen lds
    s_add_u32 m0, s55, 5120
    s_add_u32 s60, s60, 10240
    buffer_load_dwordx4 v45, s[12:15], s60 offen lds
    s_sub_u32 s61, s61, 1
    s_cmp_eq_u32 s61, 0
    s_cbranch_scc1 K_LOOPX
    s_cmp_ge_u32 s55, 81920
    s_cselect_b32 s60, -81920, s3
    s_add_u32 s55, s55, s60
    s_add_u32 s56, s56, s60
    s_lshl_b32 s57, s59, 7
    s_add_u32 s57, s57, s53
    s_mul_i32 s58, s59, 245760
    s_add_u32 s58, s58, s54
    s_add_u32 s59, s59, 1
    s_cmp_eq_u32 s59, 10
    s_cselect_b32 s59, 0, s59
    s_add_u32 m0, s56, 0
    s_add_u32 s60, s58, 0
    buffer_load_dwordx4 v46, s[16:19], s60 offen lds
    s_add_u32 m0, s55, 0
    s_max_i32 s60, s57, 0
    buffer_load_dwordx4 v44, s[12:15], s60 offen lds
    s_add_u32 m0, s56, 1024
    s_add_u32 s60, s58, 15360
    buffer_load_dwordx4 v46, s[16:19], s60 offen lds
    s_add_u32 s60, s57, 10240
    s_add_u32 m0, s55, 1024
    s_max_i32 s60, s60, 0
    buffer_load_dwordx4 v45, s[12:15], s60 offen lds
    s_add_u32 m0, s55, 2048
    s_add_u32 s60, s57, 20480
    buffer_load_dwordx4 v44, s[12:15], s60 offen lds
    s_branch K_LOOP0
K_LOOPX:
    v_and_b32 v2, 7, v1
    v_lshlrev_b32 v2, 2, v2
    s_waitcnt vmcnt(0)
    s_barrier
    s_cmp_lt_u32 s30, 6
    s_cbranch_scc1 K_NOSMP
    global_load_dword v7, v2, s[8:9] offset:192 sc1
K_NOSMP:
    s_cmp_eq_u32 s34, -1
    s_cbranch_scc1 K_JOIN_S
    s_cmp_lt_u32 s52, 2
    s_cbranch_scc1 K_WOE
    s_cmp_lg_u32 s30, 7
    s_cbranch_scc1 K_JOIN_S
    s_mov_b32 s52, 2
    s_branch K_W7A
K_WOE:
    s_lshl_b32 s57, s52, 2
    s_lshr_b32 s57, 0x7520, s57
    s_and_b32 s57, s57, 7
    s_mul_i32 s57, s57, 51200
    s_mul_i32 s58, s52, 5120
    s_add_u32 s3, s57, 0
    s_add_u32 m0, s58, 0
    s_nop 0
    buffer_load_dwordx4 v18, s[24:27], s3 offen lds
    s_add_u32 s3, s57, 10240
    s_add_u32 m0, s58, 1024
    s_nop 0
    buffer_load_dwordx4 v18, s[24:27], s3 offen lds
    s_add_u32 s3, s57, 20480
    s_add_u32 m0, s58, 2048
    s_nop 0
    buffer_load_dwordx4 v18, s[24:27], s3 offen lds
    s_add_u32 s3, s57, 30720
    s_add_u32 m0, s58, 3072
    s_nop 0
    buffer_load_dwordx4 v18, s[24:27], s3 offen lds
    s_add_u32 s3, s57, 40960
    s_add_u32 m0, s58, 4096
    s_nop 0
    buffer_load_dwordx4 v18, s[24:27], s3 offen lds
    s_add_u32 s3, s57, 409600
    s_add_u32 m0, s58, 20480
    s_nop 0
    buffer_load_dwordx4 v18, s[24:27], s3 offen lds
    s_add_u32 s3, s57, 419840
    s_add_u32 m0, s58, 21504
    s_nop 0
    buffer_load_dwordx4 v18, s[24:27], s3 offen lds
    s_add_u32 s3, s57, 430080
    s_add_u32 m0, s58, 22528
    s_nop 0
    buffer_load_dwordx4 v18, s[24:27], s3 offen lds
    s_add_u32 s3, s57, 440320
    s_add_u32 m0, s58, 23552
    s_nop 0
    buffer_load_dwordx4 v18, s[24:27], s3 offen lds
    s_add_u32 s3, s57, 450560
    s_add_u32 m0, s58, 24576
    s_nop 0
    buffer_load_dwordx4 v18, s[24:27], s3 offen lds
    s_cmp_lg_u32 s30, 7
    s_cbranch_scc1 K_JOIN_S
    s_add_u32 s52, s52, 1
    s_cmp_lt_u32 s52, 4
    s_cbranch_scc1 K_WOE
    s_mov_b32 s52, 0
K_XD:
    s_lshl_b32 s57, s40, 3
    s_lshl1_add_u32 s57, s52, s57
    s_mul_i32 s57, s57, 20480
    s_lshl_b32 s33, s41, 7
    s_add_u32 s57, s57, s33
    s_lshl_b32 s33, s52, 12
    s_add_u32 m0, s33, 140288
    s_add_u32 s3, s57, 0
    buffer_load_dwordx4 v44, s[12:15], s3 offen lds
    s_add_u32 m0, s33, 141312
    s_add_u32 s3, s57, 10240
    buffer_load_dwordx4 v45, s[12:15], s3 offen lds
    s_add_u32 m0, s33, 142336
    s_add_u32 s3, s57, 20480
    buffer_load_dwordx4 v44, s[12:15], s3 offen lds
    s_add_u32 m0, s33, 143360
    s_add_u32 s3, s57, 30720
    buffer_load_dwordx4 v45, s[12:15], s3 offen lds
    s_add_u32 s52, s52, 1
    s_cmp_lt_u32 s52, 4
    s_cbranch_scc1 K_XD
    s_branch K_W7
.p2align 12
K_CONS:
    s_lshr_b32 s52, s30, 1
    s_and_b32 s53, s30, 1
    v_lshrrev_b32 v2, 1, v9
    v_xor_b32 v2, v2, v10
    v_lshlrev_b32 v2, 4, v2
    v_lshl_add_u32 v2, v9, 7, v2
    s_mul_i32 s3, s52, 12288
    v_add_u32 v44, s3, v2
    v_xor_b32 v45, 64, v44
    v_add_u32 v46, 81920, v44
    v_add_u32 v47, 81920, v45
    v_and_b32 v2, 1, v10
    v_lshl_or_b32 v2, v2, 2, v11
    v_lshl_add_u32 v3, v10, 3, v11
    v_lshlrev_b32 v3, 8, v3
    v_lshl_add_u32 v3, v12, 3, v3
    v_add_u32 v3, 24576, v3
    s_lshl_b32 s3, s53, 2
    v_add_u32 v2, s3, v2
    v_add_u32 v4, 0, v2
    v_and_b32 v4, 7, v4
    v_lshl_add_u32 v48, v4, 5, v3
    v_add_u32 v52, 81920, v48
    v_add_u32 v4, 1, v2
    v_and_b32 v4, 7, v4
    v_lshl_add_u32 v49, v4, 5, v3
    v_add_u32 v53, 81920, v49
    v_add_u32 v4, 2, v2
    v_and_b32 v4, 7, v4
    v_lshl_add_u32 v50, v4, 5, v3
    v_add_u32 v54, 81920, v50
    v_add_u32 v4, 3, v2
    v_and_b32 v4, 7, v4
    v_lshl_add_u32 v51, v4, 5, v3
    v_add_u32 v55, 81920, v51
    v_mul_u32_u24 v56, 272, v9
    v_lshl_add_u32 v56, v10, 3, v56
    s_mul_i32 s3, s52, 26112
    s_lshl_b32 s33, s53, 7
    s_add_u32 s3, s3, s33
    s_add_u32 s3, s3, 81920
    v_add_u32 v56, s3, v56
    v_mov_b64 v[60:61], 0
    v_mov_b64 v[62:63], 0
    v_mov_b64 v[64:65], 0
    v_mov_b64 v[66:67], 0
    v_mov_b64 v[68:69], 0
    v_mov_b64 v[70:71], 0
    v_mov_b64 v[72:73], 0
    v_mov_b64 v[74:75], 0
    v_mov_b64 v[76:77], 0
    v_mov_b64 v[78:79], 0
    v_mov_b64 v[80:81], 0
    v_mov_b64 v[82:83], 0
    v_mov_b64 v[84:85], 0
    v_mov_b64 v[86:87], 0
    v_mov_b64 v[88:89], 0
    v_mov_b64 v[90:91], 0
    v_mov_b64 v[92:93], 0
    v_mov_b64 v[94:95], 0
    v_mov_b64 v[96:97], 0
    v_mov_b64 v[98:99], 0
    v_mov_b64 v[100:101], 0
    v_mov_b64 v[102:103], 0
    v_mov_b64 v[104:105], 0
    v_mov_b64 v[106:107], 0
    v_mov_b64 v[108:109], 0
    v_mov_b64 v[110:111], 0
    v_mov_b64 v[112:113], 0
    v_mov_b64 v[114:115], 0
    v_mov_b64 v[116:117], 0
    v_mov_b64 v[118:119], 0
    v_mov_b64 v[120:121], 0
    v_mov_b64 v[122:123], 0
    v_mov_b64 v[124:125], 0
    v_mov_b64 v[126:127], 0
    v_mov_b64 v[128:129], 0
    v_mov_b64 v[130:131], 0
    v_mov_b64 v[132:133], 0
    v_mov_b64 v[134:135], 0
    v_mov_b64 v[136:137], 0
    v_mov_b64 v[138:139], 0
    v_mov_b64 v[140:141], 0
    v_mov_b64 v[142:143], 0
    v_mov_b64 v[144:145], 0
    v_mov_b64 v[146:147], 0
    v_mov_b64 v[148:149], 0
    v_mov_b64 v[150:151], 0
    v_mov_b64 v[152:153], 0
    v_mov_b64 v[154:155], 0
    s_mov_b32 s54, 3
    s_cmp_lg_u32 s30, 0
    s_cbranch_scc1 K_WARMM0
    s_call_b64 s[38:39], WP_attd
    s_call_b64 s[38:39], WP_p2g
    s_branch K_WARMMX
K_WARMM0:
    s_cmp_lg_u32 s30, 1
    s_cbranch_scc1 K_WARMM1
    s_call_b64 s[38:39], WP_atts
    s_call_b64 s[38:39], WP_early
    s_branch K_WARMMX
K_WARMM1:
    s_cmp_lg_u32 s30, 2
    s_cbranch_scc1 K_WARMM2
    s_call_b64 s[38:39], WP_help
    s_call_b64 s[38:39], WP_flags
    s_branch K_WARMMX
K_WARMM2:
    s_call_b64 s[38:39], WP_spin
K_WARMMX:
    s_barrier
    ds_read_b64_tr_b16 v[204:205], v48 offset:40960
    ds_read_b64_tr_b16 v[206:207], v48 offset:41984
    ds_read_b128 v[156:159], v44 offset:40960
    ds_read_b64_tr_b16 v[208:209], v49 offset:40960
    ds_read_b64_tr_b16 v[210:211], v49 offset:41984
    ds_read_b128 v[160:163], v44 offset:43008
    ds_read_b64_tr_b16 v[212:213], v50 offset:40960
    ds_read_b64_tr_b16 v[214:215], v50 offset:41984
    ds_read_b128 v[164:167], v44 offset:45056
    ds_read_b64_tr_b16 v[216:217], v51 offset:40960
    ds_read_b64_tr_b16 v[218:219], v51 offset:41984
    ds_read_b128 v[168:171], v44 offset:47104
    ds_read_b128 v[172:175], v44 offset:49152
    ds_read_b128 v[176:179], v44 offset:51200
K_CLOOP:
    s_waitcnt lgkmcnt(0)
    v_mfma_f32_16x16x32_bf16 v[60:63], v[204:207], v[156:159], v[60:63]
    ds_read_b64_tr_b16 v[220:221], v48 offset:49152
    v_mfma_f32_16x16x32_bf16 v[64:67], v[208:211], v[156:159], v[64:67]
    ds_read_b64_tr_b16 v[222:223], v48 offset:50176
    v_mfma_f32_16x16x32_bf16 v[68:71], v[212:215], v[156:159], v[68:71]
    ds_read_b128 v[180:183], v45 offset:40960
    v_mfma_f32_16x16x32_bf16 v[72:75], v[216:219], v[156:159], v[72:75]
    ds_read_b64_tr_b16 v[224:225], v49 offset:49152
    v_mfma_f32_16x16x32_bf16 v[88:91], v[216:219], v[160:163], v[88:91]
    ds_read_b64_tr_b16 v[226:227], v49 offset:50176
    v_mfma_f32_16x16x32_bf16 v[84:87], v[212:215], v[160:163], v[84:87]
    ds_read_b128 v[184:187], v45 offset:43008
    v_mfma_f32_16x16x32_bf16 v[80:83], v[208:211], v[160:163], v[80:83]
    ds_read_b64_tr_b16 v[228:229], v50 offset:49152
    v_mfma_f32_16x16x32_bf16 v[76:79], v[204:207], v[160:163], v[76:79]
    ds_read_b64_tr_b16 v[230:231], v50 offset:50176
    v_mfma_f32_16x16x32_bf16 v[92:95], v[204:207], v[164:167], v[92:95]
    ds_read_b128 v[188:191], v45 offset:45056
    v_mfma_f32_16x16x32_bf16 v[96:99], v[208:211], v[164:167], v[96:99]
    ds_read_b64_tr_b16 v[232:233], v51 offset:49152
    v_mfma_f32_16x16x32_bf16 v[100:103], v[212:215], v[164:167], v[100:103]
    ds_read_b64_tr_b16 v[234:235], v51 offset:50176
    v_mfma_f32_16x16x32_bf16 v[104:107], v[216:219], v[164:167], v[104:107]
    ds_read_b128 v[192:195], v45 offset:47104
    v_mfma_f32_16x16x32_bf16 v[120:123], v[216:219], v[168:171], v[120:123]
    ds_read_b128 v[196:199], v45 offset:49152
    v_mfma_f32_16x16x32_bf16 v[116:119], v[212:215], v[168:171], v[116:119]
    ds_read_b128 v[200:203], v45 offset:51200
    v_mfma_f32_16x16x32_bf16 v[112:115], v[208:211], v[168:171], v[112:115]
    v_mfma_f32_16x16x32_bf16 v[108:111], v[204:207], v[168:171], v[108:111]
    v_mfma_f32_16x16x32_bf16 v[124:127], v[204:207], v[172:175], v[124:127]
    v_mfma_f32_16x16x32_bf16 v[128:131], v[208:211], v[172:175], v[128:131]
    v_mfma_f32_16x16x32_bf16 v[132:135], v[212:215], v[172:175], v[132:135]
    v_mfma_f32_16x16x32_bf16 v[136:139], v[216:219], v[172:175], v[136:139]
    v_mfma_f32_16x16x32_bf16 v[152:155], v[216:219], v[176:179], v[152:155]
    v_mfma_f32_16x16x32_bf16 v[148:151], v[212:215], v[176:179], v[148:151]
    v_mfma_f32_16x16x32_bf16 v[144:147], v[208:211], v[176:179], v[144:147]
    v_mfma_f32_16x16x32_bf16 v[140:143], v[204:207], v[176:179], v[140:143]
    s_waitcnt lgkmcnt(0)
    s_barrier
    v_mfma_f32_16x16x32_bf16 v[60:63], v[220:223], v[180:183], v[60:63]
    ds_read_b64_tr_b16 v[204:205], v52 offset:0
    v_mfma_f32_16x16x32_bf16 v[64:67], v[224:227], v[180:183], v[64:67]
    ds_read_b64_tr_b16 v[206:207], v52 offset:1024
    v_mfma_f32_16x16x32_bf16 v[68:71], v[228:231], v[180:183], v[68:71]
    ds_read_b128 v[156:159], v46 offset:0
    v_mfma_f32_16x16x32_bf16 v[72:75], v[232:235], v[180:183], v[72:75]
    ds_read_b64_tr_b16 v[208:209], v53 offset:0
    v_mfma_f32_16x16x32_bf16 v[88:91], v[232:235], v[184:187], v[88:91]
    ds_read_b64_tr_b16 v[210:211], v53 offset:1024
    v_mfma_f32_16x16x32_bf16 v[84:87], v[228:231], v[184:187], v[84:87]
    ds_read_b128 v[160:163], v46 offset:2048
    v_mfma_f32_16x16x32_bf16 v[80:83], v[224:227], v[184:187], v[80:83]
    ds_read_b64_tr_b16 v[212:213], v54 offset:0
    v_mfma_f32_16x16x32_bf16 v[76:79], v[220:223], v[184:187], v[76:79]
    ds_read_b64_tr_b16 v[214:215], v54 offset:1024
    v_mfma_f32_16x16x32_bf16 v[92:95], v[220:223], v[188:191], v[92:95]
    ds_read_b128 v[164:167], v46 offset:4096
    v_mfma_f32_16x16x32_bf16 v[96:99], v[224:227], v[188:191], v[96:99]
    ds_read_b64_tr_b16 v[216:217], v55 offset:0
    v_mfma_f32_16x16x32_bf16 v[100:103], v[228:231], v[188:191], v[100:103]
    ds_read_b64_tr_b16 v[218:219], v55 offset:1024
    v_mfma_f32_16x16x32_bf16 v[104:107], v[232:235], v[188:191], v[104:107]
    ds_read_b128 v[168:171], v46 offset:6144
    v_mfma_f32_16x16x32_bf16 v[120:123], v[232:235], v[192:195], v[120:123]
    ds_read_b128 v[172:175], v46 offset:8192
    v_mfma_f32_16x16x32_bf16 v[116:119], v[228:231], v[192:195], v[116:119]
    ds_read_b128 v[176:179], v46 offset:10240
    v_mfma_f32_16x16x32_bf16 v[112:115], v[224:227], v[192:195], v[112:115]
    v_mfma_f32_16x16x32_bf16 v[108:111], v[220:223], v[192:195], v[108:111]
    v_mfma_f32_16x16x32_bf16 v[124:127], v[220:223], v[196:199], v[124:127]
    v_mfma_f32_16x16x32_bf16 v[128:131], v[224:227], v[196:199], v[128:131]
    v_mfma_f32_16x16x32_bf16 v[132:135], v[228:231], v[196:199], v[132:135]
    v_mfma_f32_16x16x32_bf16 v[136:139], v[232:235], v[196:199], v[136:139]
    v_mfma_f32_16x16x32_bf16 v[152:155], v[232:235], v[200:203], v[152:155]
    v_mfma_f32_16x16x32_bf16 v[148:151], v[228:231], v[200:203], v[148:151]
    v_mfma_f32_16x16x32_bf16 v[144:147], v[224:227], v[200:203], v[144:147]
    v_mfma_f32_16x16x32_bf16 v[140:143], v[220:223], v[200:203], v[140:143]
    s_waitcnt lgkmcnt(0)
    v_mfma_f32_16x16x32_bf16 v[60:63], v[204:207], v[156:159], v[60:63]
    ds_read_b64_tr_b16 v[220:221], v52 offset:8192
    v_mfma_f32_16x16x32_bf16 v[64:67], v[208:211], v[156:159], v[64:67]
    ds_read_b64_tr_b16 v[222:223], v52 offset:9216
    v_mfma_f32_16x16x32_bf16 v[68:71], v[212:215], v[156:159], v[68:71]
    ds_read_b128 v[180:183], v47 offset:0
    v_mfma_f32_16x16x32_bf16 v[72:75], v[216:219], v[156:159], v[72:75]
    ds_read_b64_tr_b16 v[224:225], v53 offset:8192
    v_mfma_f32_16x16x32_bf16 v[88:91], v[216:219], v[160:163], v[88:91]
    ds_read_b64_tr_b16 v[226:227], v53 offset:9216
    v_mfma_f32_16x16x32_bf16 v[84:87], v[212:215], v[160:163], v[84:87]
    ds_read_b128 v[184:187], v47 offset:2048
    v_mfma_f32_16x16x32_bf16 v[80:83], v[208:211], v[160:163], v[80:83]
    ds_read_b64_tr_b16 v[228:229], v54 offset:8192
    v_mfma_f32_16x16x32_bf16 v[76:79], v[204:207], v[160:163], v[76:79]
    ds_read_b64_tr_b16 v[230:231], v54 offset:9216
    v_mfma_f32_16x16x32_bf16 v[92:95], v[204:207], v[164:167], v[92:95]
    ds_read_b128 v[188:191], v47 offset:4096
    v_mfma_f32_16x16x32_bf16 v[96:99], v[208:211], v[164:167], v[96:99]
    ds_read_b64_tr_b16 v[232:233], v55 offset:8192
    v_mfma_f32_16x16x32_bf16 v[100:103], v[212:215], v[164:167], v[100:103]
    ds_read_b64_tr_b16 v[234:235], v55 offset:9216
    v_mfma_f32_16x16x32_bf16 v[104:107], v[216:219], v[164:167], v[104:107]
    ds_read_b128 v[192:195], v47 offset:6144
    v_mfma_f32_16x16x32_bf16 v[120:123], v[216:219], v[168:171], v[120:123]
    ds_read_b128 v[196:199], v47 offset:8192
    v_mfma_f32_16x16x32_bf16 v[116:119], v[212:215], v[168:171], v[116:119]
    ds_read_b128 v[200:203], v47 offset:10240
    v_mfma_f32_16x16x32_bf16 v[112:115], v[208:211], v[168:171], v[112:115]
    v_mfma_f32_16x16x32_bf16 v[108:111], v[204:207], v[168:171], v[108:111]
    v_mfma_f32_16x16x32_bf16 v[124:127], v[204:207], v[172:175], v[124:127]
    v_mfma_f32_16x16x32_bf16 v[128:131], v[208:211], v[172:175], v[128:131]
    v_mfma_f32_16x16x32_bf16 v[132:135], v[212:215], v[172:175], v[132:135]
    v_mfma_f32_16x16x32_bf16 v[136:139], v[216:219], v[172:175], v[136:139]
    v_mfma_f32_16x16x32_bf16 v[152:155], v[216:219], v[176:179], v[152:155]
    v_mfma_f32_16x16x32_bf16 v[148:151], v[212:215], v[176:179], v[148:151]
    v_mfma_f32_16x16x32_bf16 v[144:147], v[208:211], v[176:179], v[144:147]
    v_mfma_f32_16x16x32_bf16 v[140:143], v[204:207], v[176:179], v[140:143]
    s_waitcnt lgkmcnt(0)
    s_barrier
    v_mfma_f32_16x16x32_bf16 v[60:63], v[220:223], v[180:183], v[60:63]
    ds_read_b64_tr_b16 v[204:205], v48 offset:0
    v_mfma_f32_16x16x32_bf16 v[64:67], v[224:227], v[180:183], v[64:67]
    ds_read_b64_tr_b16 v[206:207], v48 offset:1024
    v_mfma_f32_16x16x32_bf16 v[68:71], v[228:231], v[180:183], v[68:71]
    ds_read_b128 v[156:159], v44 offset:0
    v_mfma_f32_16x16x32_bf16 v[72:75], v[232:235], v[180:183], v[72:75]
    ds_read_b64_tr_b16 v[208:209], v49 offset:0
    v_mfma_f32_16x16x32_bf16 v[88:91], v[232:235], v[184:187], v[88:91]
    ds_read_b64_tr_b16 v[210:211], v49 offset:1024
    v_mfma_f32_16x16x32_bf16 v[84:87], v[228:231], v[184:187], v[84:87]
    ds_read_b128 v[160:163], v44 offset:2048
    v_mfma_f32_16x16x32_bf16 v[80:83], v[224:227], v[184:187], v[80:83]
    ds_read_b64_tr_b16 v[212:213], v50 offset:0
    v_mfma_f32_16x16x32_bf16 v[76:79], v[220:223], v[184:187], v[76:79]
    ds_read_b64_tr_b16 v[214:215], v50 offset:1024
    v_mfma_f32_16x16x32_bf16 v[92:95], v[220:223], v[188:191], v[92:95]
    ds_read_b128 v[164:167], v44 offset:4096
    v_mfma_f32_16x16x32_bf16 v[96:99], v[224:227], v[188:191], v[96:99]
    ds_read_b64_tr_b16 v[216:217], v51 offset:0
    v_mfma_f32_16x16x32_bf16 v[100:103], v[228:231], v[188:191], v[100:103]
    ds_read_b64_tr_b16 v[218:219], v51 offset:1024
    v_mfma_f32_16x16x32_bf16 v[104:107], v[232:235], v[188:191], v[104:107]
    ds_read_b128 v[168:171], v44 offset:6144
    v_mfma_f32_16x16x32_bf16 v[120:123], v[232:235], v[192:195], v[120:123]
    ds_read_b128 v[172:175], v44 offset:8192
    v_mfma_f32_16x16x32_bf16 v[116:119], v[228:231], v[192:195], v[116:119]
    ds_read_b128 v[176:179], v44 offset:10240
    v_mfma_f32_16x16x32_bf16 v[112:115], v[224:227], v[192:195], v[112:115]
    v_mfma_f32_16x16x32_bf16 v[108:111], v[220:223], v[192:195], v[108:111]
    v_mfma_f32_16x16x32_bf16 v[124:127], v[220:223], v[196:199], v[124:127]
    v_mfma_f32_16x16x32_bf16 v[128:131], v[224:227], v[196:199], v[128:131]
    v_mfma_f32_16x16x32_bf16 v[132:135], v[228:231], v[196:199], v[132:135]
    v_mfma_f32_16x16x32_bf16 v[136:139], v[232:235], v[196:199], v[136:139]
    v_mfma_f32_16x16x32_bf16 v[152:155], v[232:235], v[200:203], v[152:155]
    v_mfma_f32_16x16x32_bf16 v[148:151], v[228:231], v[200:203], v[148:151]
    v_mfma_f32_16x16x32_bf16 v[144:147], v[224:227], v[200:203], v[144:147]
    v_mfma_f32_16x16x32_bf16 v[140:143], v[220:223], v[200:203], v[140:143]
    s_waitcnt lgkmcnt(0)
    v_mfma_f32_16x16x32_bf16 v[60:63], v[204:207], v[156:159], v[60:63]
    ds_read_b64_tr_b16 v[220:221], v48 offset:8192
    v_mfma_f32_16x16x32_bf16 v[64:67], v[208:211], v[156:159], v[64:67]
    ds_read_b64_tr_b16 v[222:223], v48 offset:9216
    v_mfma_f32_16x16x32_bf16 v[68:71], v[212:215], v[156:159], v[68:71]
    ds_read_b128 v[180:183], v45 offset:0
    v_mfma_f32_16x16x32_bf16 v[72:75], v[216:219], v[156:159], v[72:75]
    ds_read_b64_tr_b16 v[224:225], v49 offset:8192
    v_mfma_f32_16x16x32_bf16 v[88:91], v[216:219], v[160:163], v[88:91]
    ds_read_b64_tr_b16 v[226:227], v49 offset:9216
    v_mfma_f32_16x16x32_bf16 v[84:87], v[212:215], v[160:163], v[84:87]
    ds_read_b128 v[184:187], v45 offset:2048
    v_mfma_f32_16x16x32_bf16 v[80:83], v[208:211], v[160:163], v[80:83]
    ds_read_b64_tr_b16 v[228:229], v50 offset:8192
    v_mfma_f32_16x16x32_bf16 v[76:79], v[204:207], v[160:163], v[76:79]
    ds_read_b64_tr_b16 v[230:231], v50 offset:9216
    v_mfma_f32_16x16x32_bf16 v[92:95], v[204:207], v[164:167], v[92:95]
    ds_read_b128 v[188:191], v45 offset:4096
    v_mfma_f32_16x16x32_bf16 v[96:99], v[208:211], v[164:167], v[96:99]
    ds_read_b64_tr_b16 v[232:233], v51 offset:8192
    v_mfma_f32_16x16x32_bf16 v[100:103], v[212:215], v[164:167], v[100:103]
    ds_read_b64_tr_b16 v[234:235], v51 offset:9216
    v_mfma_f32_16x16x32_bf16 v[104:107], v[216:219], v[164:167], v[104:107]
    ds_read_b128 v[192:195], v45 offset:6144
    v_mfma_f32_16x16x32_bf16 v[120:123], v[216:219], v[168:171], v[120:123]
    ds_read_b128 v[196:199], v45 offset:8192
    v_mfma_f32_16x16x32_bf16 v[116:119], v[212:215], v[168:171], v[116:119]
    ds_read_b128 v[200:203], v45 offset:10240
    v_mfma_f32_16x16x32_bf16 v[112:115], v[208:211], v[168:171], v[112:115]
    v_mfma_f32_16x16x32_bf16 v[108:111], v[204:207], v[168:171], v[108:111]
    v_mfma_f32_16x16x32_bf16 v[124:127], v[204:207], v[172:175], v[124:127]
    v_mfma_f32_16x16x32_bf16 v[128:131], v[208:211], v[172:175], v[128:131]
    v_mfma_f32_16x16x32_bf16 v[132:135], v[212:215], v[172:175], v[132:135]
    v_mfma_f32_16x16x32_bf16 v[136:139], v[216:219], v[172:175], v[136:139]
    v_mfma_f32_16x16x32_bf16 v[152:155], v[216:219], v[176:179], v[152:155]
    v_mfma_f32_16x16x32_bf16 v[148:151], v[212:215], v[176:179], v[148:151]
    v_mfma_f32_16x16x32_bf16 v[144:147], v[208:211], v[176:179], v[144:147]
    v_mfma_f32_16x16x32_bf16 v[140:143], v[204:207], v[176:179], v[140:143]
    s_waitcnt lgkmcnt(0)
    s_barrier
    v_mfma_f32_16x16x32_bf16 v[60:63], v[220:223], v[180:183], v[60:63]
    ds_read_b64_tr_b16 v[204:205], v48 offset:40960
    v_mfma_f32_16x16x32_bf16 v[64:67], v[224:227], v[180:183], v[64:67]
    ds_read_b64_tr_b16 v[206:207], v48 offset:41984
    v_mfma_f32_16x16x32_bf16 v[68:71], v[228:231], v[180:183], v[68:71]
    ds_read_b128 v[156:159], v44 offset:40960
    v_mfma_f32_16x16x32_bf16 v[72:75], v[232:235], v[180:183], v[72:75]
    ds_read_b64_tr_b16 v[208:209], v49 offset:40960
    v_mfma_f32_16x16x32_bf16 v[88:91], v[232:235], v[184:187], v[88:91]
    ds_read_b64_tr_b16 v[210:211], v49 offset:41984
    v_mfma_f32_16x16x32_bf16 v[84:87], v[228:231], v[184:187], v[84:87]
    ds_read_b128 v[160:163], v44 offset:43008
    v_mfma_f32_16x16x32_bf16 v[80:83], v[224:227], v[184:187], v[80:83]
    ds_read_b64_tr_b16 v[212:213], v50 offset:40960
    v_mfma_f32_16x16x32_bf16 v[76:79], v[220:223], v[184:187], v[76:79]
    ds_read_b64_tr_b16 v[214:215], v50 offset:41984
    v_mfma_f32_16x16x32_bf16 v[92:95], v[220:223], v[188:191], v[92:95]
    ds_read_b128 v[164:167], v44 offset:45056
    v_mfma_f32_16x16x32_bf16 v[96:99], v[224:227], v[188:191], v[96:99]
    ds_read_b64_tr_b16 v[216:217], v51 offset:40960
    v_mfma_f32_16x16x32_bf16 v[100:103], v[228:231], v[188:191], v[100:103]
    ds_read_b64_tr_b16 v[218:219], v51 offset:41984
    v_mfma_f32_16x16x32_bf16 v[104:107], v[232:235], v[188:191], v[104:107]
    ds_read_b128 v[168:171], v44 offset:47104
    v_mfma_f32_16x16x32_bf16 v[120:123], v[232:235], v[192:195], v[120:123]
    ds_read_b128 v[172:175], v44 offset:49152
    v_mfma_f32_16x16x32_bf16 v[116:119], v[228:231], v[192:195], v[116:119]
    ds_read_b128 v[176:179], v44 offset:51200
    v_mfma_f32_16x16x32_bf16 v[112:115], v[224:227], v[192:195], v[112:115]
    s_sub_u32 s54, s54, 1
    v_mfma_f32_16x16x32_bf16 v[108:111], v[220:223], v[192:195], v[108:111]
    s_cmp_lg_u32 s54, 0
    v_mfma_f32_16x16x32_bf16 v[124:127], v[220:223], v[196:199], v[124:127]
    v_mfma_f32_16x16x32_bf16 v[128:131], v[224:227], v[196:199], v[128:131]
    v_mfma_f32_16x16x32_bf16 v[132:135], v[228:231], v[196:199], v[132:135]
    v_mfma_f32_16x16x32_bf16 v[136:139], v[232:235], v[196:199], v[136:139]
    v_mfma_f32_16x16x32_bf16 v[152:155], v[232:235], v[200:203], v[152:155]
    v_mfma_f32_16x16x32_bf16 v[148:151], v[228:231], v[200:203], v[148:151]
    v_mfma_f32_16x16x32_bf16 v[144:147], v[224:227], v[200:203], v[144:147]
    v_mfma_f32_16x16x32_bf16 v[140:143], v[220:223], v[200:203], v[140:143]
    s_cbranch_scc1 K_CLOOP
    s_waitcnt lgkmcnt(0)
    v_mfma_f32_16x16x32_bf16 v[60:63], v[204:207], v[156:159], v[60:63]
    ds_read_b128 v[180:183], v45 offset:40960
    ds_read_b64_tr_b16 v[220:221], v48 offset:49152
    v_mfma_f32_16x16x32_bf16 v[64:67], v[208:211], v[156:159], v[64:67]
    ds_read_b64_tr_b16 v[222:223], v48 offset:50176
    ds_read_b64_tr_b16 v[224:225], v49 offset:49152
    v_mfma_f32_16x16x32_bf16 v[68:71], v[212:215], v[156:159], v[68:71]
    ds_read_b64_tr_b16 v[226:227], v49 offset:50176
    ds_read_b64_tr_b16 v[228:229], v50 offset:49152
    v_mfma_f32_16x16x32_bf16 v[72:75], v[216:219], v[156:159], v[72:75]
    ds_read_b64_tr_b16 v[230:231], v50 offset:50176
    ds_read_b64_tr_b16 v[232:233], v51 offset:49152
    v_mfma_f32_16x16x32_bf16 v[76:79], v[204:207], v[160:163], v[76:79]
    ds_read_b64_tr_b16 v[234:235], v51 offset:50176
    ds_read_b128 v[184:187], v45 offset:43008
    v_mfma_f32_16x16x32_bf16 v[80:83], v[208:211], v[160:163], v[80:83]
    ds_read_b128 v[188:191], v45 offset:45056
    ds_read_b128 v[192:195], v45 offset:47104
    v_mfma_f32_16x16x32_bf16 v[84:87], v[212:215], v[160:163], v[84:87]
    ds_read_b128 v[196:199], v45 offset:49152
    ds_read_b128 v[200:203], v45 offset:51200
    v_mfma_f32_16x16x32_bf16 v[88:91], v[216:219], v[160:163], v[88:91]
    s_waitcnt lgkmcnt(11)
    v_mfma_f32_16x16x32_bf16 v[60:63], v[220:223], v[180:183], v[60:63]
    s_nop 1
    s_waitcnt lgkmcnt(9)
    v_mfma_f32_16x16x32_bf16 v[64:67], v[224:227], v[180:183], v[64:67]
    s_nop 1
    s_waitcnt lgkmcnt(7)
    v_mfma_f32_16x16x32_bf16 v[68:71], v[228:231], v[180:183], v[68:71]
    v_cvt_pk_bf16_f32 v60, v60, v61
    v_cvt_pk_bf16_f32 v61, v62, v63
    s_waitcnt lgkmcnt(5)
    v_mfma_f32_16x16x32_bf16 v[72:75], v[232:235], v[180:183], v[72:75]
    ds_write_b64 v56, v[60:61] offset:0
    s_waitcnt lgkmcnt(5)
    v_mfma_f32_16x16x32_bf16 v[76:79], v[220:223], v[184:187], v[76:79]
    v_cvt_pk_bf16_f32 v64, v64, v65
    v_cvt_pk_bf16_f32 v65, v66, v67
    v_mfma_f32_16x16x32_bf16 v[80:83], v[224:227], v[184:187], v[80:83]
    ds_write_b64 v56, v[64:65] offset:32
    v_mfma_f32_16x16x32_bf16 v[84:87], v[228:231], v[184:187], v[84:87]
    v_cvt_pk_bf16_f32 v68, v68, v69
    v_cvt_pk_bf16_f32 v69, v70, v71
    v_mfma_f32_16x16x32_bf16 v[88:91], v[232:235], v[184:187], v[88:91]
    ds_write_b64 v56, v[68:69] offset:64
    v_mfma_f32_16x16x32_bf16 v[92:95], v[204:207], v[164:167], v[92:95]
    v_cvt_pk_bf16_f32 v72, v72, v73
    v_cvt_pk_bf16_f32 v73, v74, v75
    v_mfma_f32_16x16x32_bf16 v[96:99], v[208:211], v[164:167], v[96:99]
    ds_write_b64 v56, v[72:73] offset:96
    v_mfma_f32_16x16x32_bf16 v[100:103], v[212:215], v[164:167], v[100:103]
    v_cvt_pk_bf16_f32 v76, v76, v77
    v_cvt_pk_bf16_f32 v77, v78, v79
    v_mfma_f32_16x16x32_bf16 v[104:107], v[216:219], v[164:167], v[104:107]
    ds_write_b64 v56, v[76:77] offset:4352
    s_waitcnt lgkmcnt(8)
    v_mfma_f32_16x16x32_bf16 v[92:95], v[220:223], v[188:191], v[92:95]
    v_cvt_pk_bf16_f32 v80, v80, v81
    v_cvt_pk_bf16_f32 v81, v82, v83
    v_mfma_f32_16x16x32_bf16 v[96:99], v[224:227], v[188:191], v[96:99]
    ds_write_b64 v56, v[80:81] offset:4384
    v_mfma_f32_16x16x32_bf16 v[100:103], v[228:231], v[188:191], v[100:103]
    v_cvt_pk_bf16_f32 v84, v84, v85
    v_cvt_pk_bf16_f32 v85, v86, v87
    v_mfma_f32_16x16x32_bf16 v[104:107], v[232:235], v[188:191], v[104:107]
    ds_write_b64 v56, v[84:85] offset:4416
    v_mfma_f32_16x16x32_bf16 v[108:111], v[204:207], v[168:171], v[108:111]
    v_cvt_pk_bf16_f32 v88, v88, v89
    v_cvt_pk_bf16_f32 v89, v90, v91
    v_mfma_f32_16x16x32_bf16 v[112:115], v[208:211], v[168:171], v[112:115]
    ds_write_b64 v56, v[88:89] offset:4448
    v_mfma_f32_16x16x32_bf16 v[116:119], v[212:215], v[168:171], v[116:119]
    v_cvt_pk_bf16_f32 v92, v92, v93
    v_cvt_pk_bf16_f32 v93, v94, v95
    v_mfma_f32_16x16x32_bf16 v[120:123], v[216:219], v[168:171], v[120:123]
    ds_write_b64 v56, v[92:93] offset:8704
    s_waitcnt lgkmcnt(11)
    v_mfma_f32_16x16x32_bf16 v[108:111], v[220:223], v[192:195], v[108:111]
    v_cvt_pk_bf16_f32 v96, v96, v97
    v_cvt_pk_bf16_f32 v97, v98, v99
    v_mfma_f32_16x16x32_bf16 v[112:115], v[224:227], v[192:195], v[112:115]
    ds_write_b64 v56, v[96:97] offset:8736
    v_mfma_f32_16x16x32_bf16 v[116:119], v[228:231], v[192:195], v[116:119]
    v_cvt_pk_bf16_f32 v100, v100, v101
    v_cvt_pk_bf16_f32 v101, v102, v103
    v_mfma_f32_16x16x32_bf16 v[120:123], v[232:235], v[192:195], v[120:123]
    ds_write_b64 v56, v[100:101] offset:8768
    v_mfma_f32_16x16x32_bf16 v[124:127], v[204:207], v[172:175], v[124:127]
    v_cvt_pk_bf16_f32 v104, v104, v105
    v_cvt_pk_bf16_f32 v105, v106, v107
    v_mfma_f32_16x16x32_bf16 v[128:131], v[208:211], v[172:175], v[128:131]
    ds_write_b64 v56, v[104:105] offset:8800
    v_mfma_f32_16x16x32_bf16 v[132:135], v[212:215], v[172:175], v[132:135]
    v_cvt_pk_bf16_f32 v108, v108, v109
    v_cvt_pk_bf16_f32 v109, v110, v111
    v_mfma_f32_16x16x32_bf16 v[136:139], v[216:219], v[172:175], v[136:139]
    ds_write_b64 v56, v[108:109] offset:13056
    s_waitcnt lgkmcnt(14)
    v_mfma_f32_16x16x32_bf16 v[124:127], v[220:223], v[196:199], v[124:127]
    v_cvt_pk_bf16_f32 v112, v112, v113
    v_cvt_pk_bf16_f32 v113, v114, v115
    v_mfma_f32_16x16x32_bf16 v[128:131], v[224:227], v[196:199], v[128:131]
    ds_write_b64 v56, v[112:113] offset:13088
    v_mfma_f32_16x16x32_bf16 v[132:135], v[228:231], v[196:199], v[132:135]
    v_cvt_pk_bf16_f32 v116, v116, v117
    v_cvt_pk_bf16_f32 v117, v118, v119
    v_mfma_f32_16x16x32_bf16 v[136:139], v[232:235], v[196:199], v[136:139]
    ds_write_b64 v56, v[116:117] offset:13120
    v_mfma_f32_16x16x32_bf16 v[140:143], v[204:207], v[176:179], v[140:143]
    v_cvt_pk_bf16_f32 v120, v120, v121
    v_cvt_pk_bf16_f32 v121, v122, v123
    v_mfma_f32_16x16x32_bf16 v[144:147], v[208:211], v[176:179], v[144:147]
    ds_write_b64 v56, v[120:121] offset:13152
    v_mfma_f32_16x16x32_bf16 v[148:151], v[212:215], v[176:179], v[148:151]
    v_cvt_pk_bf16_f32 v124, v124, v125
    v_cvt_pk_bf16_f32 v125, v126, v127
    v_mfma_f32_16x16x32_bf16 v[152:155], v[216:219], v[176:179], v[152:155]
    ds_write_b64 v56, v[124:125] offset:17408
    s_waitcnt lgkmcnt(15)
    v_mfma_f32_16x16x32_bf16 v[140:143], v[220:223], v[200:203], v[140:143]
    v_cvt_pk_bf16_f32 v128, v128, v129
    v_cvt_pk_bf16_f32 v129, v130, v131
    v_mfma_f32_16x16x32_bf16 v[144:147], v[224:227], v[200:203], v[144:147]
    ds_write_b64 v56, v[128:129] offset:17440
    v_mfma_f32_16x16x32_bf16 v[148:151], v[228:231], v[200:203], v[148:151]
    v_cvt_pk_bf16_f32 v132, v132, v133
    v_cvt_pk_bf16_f32 v133, v134, v135
    v_mfma_f32_16x16x32_bf16 v[152:155], v[232:235], v[200:203], v[152:155]
    ds_write_b64 v56, v[132:133] offset:17472
    v_cvt_pk_bf16_f32 v136, v136, v137
    v_cvt_pk_bf16_f32 v137, v138, v139
    v_cvt_pk_bf16_f32 v140, v140, v141
    v_cvt_pk_bf16_f32 v141, v142, v143
    v_cvt_pk_bf16_f32 v144, v144, v145
    v_cvt_pk_bf16_f32 v145, v146, v147
    v_cvt_pk_bf16_f32 v148, v148, v149
    v_cvt_pk_bf16_f32 v149, v150, v151
    v_cvt_pk_bf16_f32 v152, v152, v153
    v_cvt_pk_bf16_f32 v153, v154, v155
    ds_write_b64 v56, v[136:137] offset:17504
    ds_write_b64 v56, v[140:141] offset:21760
    ds_write_b64 v56, v[144:145] offset:21792
    ds_write_b64 v56, v[148:149] offset:21824
    ds_write_b64 v56, v[152:153] offset:21856
    s_setprio 0
    s_branch WS_attd
.p2align 12
WP_attd:
    s_setpc_b64 s[38:39]
WS_attd:
    s_waitcnt lgkmcnt(0)
    s_barrier
    ds_read_b64 v[60:61], v13 offset:80
    ds_read_b64 v[62:63], v14 offset:80
    ds_read_b64 v[44:45], v13 offset:4352
    ds_read_b64 v[46:47], v19 offset:4352
    ds_read_b64 v[64:65], v13 offset:4432
    ds_read_b64 v[66:67], v14 offset:4432
    ds_read_b64 v[72:73], v13 offset:120
    ds_read_b64 v[74:75], v14 offset:120
    ds_read_b64 v[48:49], v13 offset:4392
    ds_read_b64 v[50:51], v20 offset:4352
    ds_read_b64 v[76:77], v13 offset:4472
    ds_read_b64 v[78:79], v14 offset:4472
    ds_read_b64 v[52:53], v13 offset:8704
    ds_read_b64 v[54:55], v19 offset:8704
    ds_read_b64 v[68:69], v13 offset:8784
    ds_read_b64 v[70:71], v14 offset:8784
    s_waitcnt lgkmcnt(10)
    v_mfma_f32_16x16x32_bf16 v[116:119], v[60:63], v[44:47], v[36:39]
    v_mfma_f32_16x16x32_bf16 v[120:123], v[64:67], v[44:47], v[32:35]
    ds_read_b64 v[56:57], v13 offset:8744
    ds_read_b64 v[58:59], v20 offset:8704
    ds_read_b64 v[80:81], v13 offset:8824
    ds_read_b64 v[82:83], v14 offset:8824
    s_waitcnt lgkmcnt(8)
    v_mfma_f32_16x16x32_bf16 v[124:127], v[72:75], v[48:51], v[36:39]
    v_mfma_f32_16x16x32_bf16 v[128:131], v[76:79], v[48:51], v[32:35]
    s_waitcnt lgkmcnt(4)
    v_mfma_f32_16x16x32_bf16 v[132:135], v[64:67], v[52:55], v[28:31]
    v_mfma_f32_16x16x32_bf16 v[136:139], v[68:71], v[52:55], v[32:35]
    s_waitcnt lgkmcnt(0)
    v_mfma_f32_16x16x32_bf16 v[140:143], v[76:79], v[56:59], v[28:31]
    v_mfma_f32_16x16x32_bf16 v[144:147], v[80:83], v[56:59], v[32:35]
    ds_read_b64_tr_b16 v[84:85], v15 offset:160
    ds_read_b64_tr_b16 v[86:87], v15 offset:4512
    ds_read_b64_tr_b16 v[100:101], v21 offset:0
    ds_read_b64_tr_b16 v[102:103], v21 offset:4352
    v_max3_f32 v184, v116, v117, v120
    ds_read_b64_tr_b16 v[92:93], v15 offset:200
    v_max3_f32 v185, v118, v119, v122
    ds_read_b64_tr_b16 v[94:95], v15 offset:4552
    v_max_f32 v184, v184, v121
    ds_read_b64_tr_b16 v[104:105], v22 offset:0
    v_max_f32 v185, v185, v123
    ds_read_b64_tr_b16 v[106:107], v22 offset:4352
    v_max3_f32 v186, v124, v125, v128
    ds_read_b64_tr_b16 v[88:89], v15 offset:8864
    v_max3_f32 v187, v126, v127, v130
    ds_read_b64_tr_b16 v[108:109], v23 offset:4352
    v_max_f32 v186, v186, v129
    ds_read_b64_tr_b16 v[110:111], v23 offset:8704
    v_max_f32 v187, v187, v131
    ds_read_b64_tr_b16 v[96:97], v15 offset:8904
    v_max3_f32 v188, v132, v133, v136
    ds_read_b64_tr_b16 v[112:113], v24 offset:4352
    v_max3_f32 v189, v134, v135, v138
    ds_read_b64_tr_b16 v[114:115], v24 offset:8704
    v_max_f32 v188, v188, v137
    v_max_f32 v189, v189, v139
    v_max3_f32 v190, v140, v141, v144
    v_max3_f32 v191, v142, v143, v146
    v_max_f32 v190, v190, v145
    v_max_f32 v191, v191, v147
    v_cvt_pk_bf16_f32 v192, v184, v185
    v_cvt_pk_bf16_f32 v193, v186, v187
    v_cvt_pk_bf16_f32 v194, v188, v189
    v_cvt_pk_bf16_f32 v195, v190, v191
    v_lshlrev_b32 v184, 16, v192
    v_and_b32 v185, 0xffff0000, v192
    v_lshlrev_b32 v186, 16, v193
    v_and_b32 v187, 0xffff0000, v193
    v_lshlrev_b32 v188, 16, v194
    v_and_b32 v189, 0xffff0000, v194
    v_lshlrev_b32 v190, 16, v195
    v_and_b32 v191, 0xffff0000, v195
    v_pk_mul_f32 v[184:185], v[184:185], s[48:49]
    v_pk_mul_f32 v[186:187], v[186:187], s[48:49]
    v_pk_mul_f32 v[188:189], v[188:189], s[48:49]
    v_pk_mul_f32 v[190:191], v[190:191], s[48:49]
    v_cvt_pk_bf16_f32 v192, v184, v185
    v_cvt_pk_bf16_f32 v193, v186, v187
    v_cvt_pk_bf16_f32 v194, v188, v189
    v_cvt_pk_bf16_f32 v195, v190, v191
    v_permlane16_swap_b32 v192, v193
    s_nop 0
    v_permlane16_swap_b32 v194, v195
    s_nop 1
    v_permlane32_swap_b32 v192, v194
    v_permlane32_swap_b32 v193, v195
    v_lshlrev_b32 v184, 16, v192
    v_and_b32 v185, 0xffff0000, v192
    v_lshlrev_b32 v188, 16, v194
    v_and_b32 v189, 0xffff0000, v194
    v_lshlrev_b32 v186, 16, v193
    v_and_b32 v187, 0xffff0000, v193
    v_lshlrev_b32 v190, 16, v195
    v_and_b32 v191, 0xffff0000, v195
    v_max3_f32 v196, v184, v185, v188
    v_max3_f32 v197, v189, v186, v187
    v_max3_f32 v196, v196, v190, v191
    v_max_f32 v196, v196, v197
    v_mul_f32 v196, s46, v196
    v_pk_fma_f32 v[184:185], v[184:185], s[46:47], v[196:197] op_sel_hi:[1,1,0] neg_lo:[0,0,1] neg_hi:[0,0,1]
    v_pk_fma_f32 v[186:187], v[186:187], s[46:47], v[196:197] op_sel_hi:[1,1,0] neg_lo:[0,0,1] neg_hi:[0,0,1]
    v_pk_fma_f32 v[188:189], v[188:189], s[46:47], v[196:197] op_sel_hi:[1,1,0] neg_lo:[0,0,1] neg_hi:[0,0,1]
    v_pk_fma_f32 v[190:191], v[190:191], s[46:47], v[196:197] op_sel_hi:[1,1,0] neg_lo:[0,0,1] neg_hi:[0,0,1]
    v_exp_f32 v184, v184
    v_exp_f32 v185, v185
    v_exp_f32 v186, v186
    v_exp_f32 v187, v187
    v_exp_f32 v188, v188
    v_exp_f32 v189, v189
    v_exp_f32 v190, v190
    v_exp_f32 v191, v191
    v_pk_add_f32 v[200:201], v[184:185], v[186:187]
    v_pk_add_f32 v[202:203], v[188:189], v[190:191]
    v_pk_add_f32 v[200:201], v[200:201], v[202:203]
    v_add_f32 v200, v200, v201
    v_rcp_f32 v200, v200
    s_waitcnt lgkmcnt(0)
    v_pk_mul_f32 v[184:185], v[184:185], v[200:201] op_sel_hi:[1,0]
    v_pk_mul_f32 v[186:187], v[186:187], v[200:201] op_sel_hi:[1,0]
    v_pk_mul_f32 v[188:189], v[188:189], v[200:201] op_sel_hi:[1,0]
    v_pk_mul_f32 v[190:191], v[190:191], v[200:201] op_sel_hi:[1,0]
    v_cvt_pk_bf16_f32 v192, v184, v185
    v_cvt_pk_bf16_f32 v194, v188, v189
    v_cvt_pk_bf16_f32 v193, v186, v187
    v_cvt_pk_bf16_f32 v195, v190, v191
    v_permlane32_swap_b32 v192, v194
    s_nop 0
    v_permlane32_swap_b32 v193, v195
    s_nop 1
    v_permlane16_swap_b32 v192, v193
    v_permlane16_swap_b32 v194, v195
    v_perm_b32 v148, v192, v192, v40
    v_perm_b32 v149, v192, v192, v41
    v_perm_b32 v150, v192, v192, v42
    v_perm_b32 v151, v192, v192, v43
    v_perm_b32 v152, v193, v193, v40
    v_perm_b32 v153, v193, v193, v41
    v_perm_b32 v154, v193, v193, v42
    v_perm_b32 v155, v193, v193, v43
    v_mfma_f32_16x16x32_bf16 v[164:167], v[84:87], v[148:151], 0
    v_mfma_f32_16x16x32_bf16 v[180:183], v[100:103], v[148:151], 0
    v_perm_b32 v156, v194, v194, v40
    v_perm_b32 v157, v194, v194, v41
    v_perm_b32 v158, v194, v194, v42
    v_perm_b32 v159, v194, v194, v43
    v_mfma_f32_16x16x32_bf16 v[168:171], v[92:95], v[152:155], 0
    v_mfma_f32_16x16x32_bf16 v[180:183], v[104:107], v[152:155], v[180:183]
    v_perm_b32 v160, v195, v195, v40
    v_perm_b32 v161, v195, v195, v41
    v_perm_b32 v162, v195, v195, v42
    v_perm_b32 v163, v195, v195, v43
    v_mfma_f32_16x16x32_bf16 v[172:175], v[86:89], v[156:159], 0
    v_mfma_f32_16x16x32_bf16 v[180:183], v[108:111], v[156:159], v[180:183]
    v_mfma_f32_16x16x32_bf16 v[176:179], v[94:97], v[160:163], 0
    v_mfma_f32_16x16x32_bf16 v[180:183], v[112:115], v[160:163], v[180:183]
    v_cvt_pk_bf16_f32 v204, v164, v165
    v_cvt_pk_bf16_f32 v205, v166, v167
    v_cvt_pk_bf16_f32 v206, v168, v169
    v_cvt_pk_bf16_f32 v207, v170, v171
    buffer_store_dwordx4 v[204:207], v16, s[20:23], s50 offen sc1
    v_cvt_pk_bf16_f32 v208, v172, v173
    v_cvt_pk_bf16_f32 v209, v174, v175
    v_cvt_pk_bf16_f32 v210, v176, v177
    v_cvt_pk_bf16_f32 v211, v178, v179
    buffer_store_dwordx4 v[208:211], v16, s[20:23], s51 offen sc1
    v_cvt_pk_bf16_f32 v196, v180, v181
    v_cvt_pk_bf16_f32 v197, v182, v183
    buffer_store_dwordx2 v[196:197], v17, s[20:23], s50 offen sc1
    s_cmp_lg_u32 s34, -1
    s_cbranch_scc1 K_P2_EARLY
K_DRAIN:
    s_waitcnt vmcnt(0)
    s_barrier
    s_branch K_END
K_W7A:
    s_waitcnt vmcnt(0)
    v_and_b32 v4, 7, v1
    v_lshlrev_b32 v4, 2, v4
    s_mov_b32 s3, 131072
K_ZPOLL5:
    v_cmp_eq_u32 vcc, 0, v7
    s_cbranch_vccz K_ZOK5
    s_sub_u32 s3, s3, 1
    s_cbranch_scc1 K_ZOK5
    global_load_dword v7, v4, s[8:9] offset:192 sc1
    s_waitcnt vmcnt(0)
    s_branch K_ZPOLL5
K_ZOK5:
    v_mov_b32 v4, 158720
    v_mov_b32 v3, 1
    s_mov_b64 exec, 1
    s_nop 0
    ds_add_rtn_u32 v2, v4, v3 offset:48
    s_mov_b32 exec_lo, s36
    v_mov_b32 v3, 1
    s_waitcnt lgkmcnt(0)
    v_readfirstlane_b32 s33, v2
    s_nop 3
    s_and_b32 s33, s33, 0xff
    s_cmp_lg_u32 s33, 7
    s_cbranch_scc1 K_ARR7
    global_store_dword v8, v3, s[10:11] sc1
K_ARR7:
    s_mov_b64 exec, -1
    s_barrier
    s_branch K_WOE
K_W7:
    v_mov_b32 v3, 0x100
    s_mov_b64 exec, 1
    s_waitcnt vmcnt(0)
    ds_add_u32 v4, v3 offset:48
    s_mov_b64 exec, -1
    s_branch K_P2_HELP
K_FLAG:
    s_waitcnt vmcnt(0)
    v_and_b32 v4, 7, v1
    v_lshlrev_b32 v4, 2, v4
    s_mov_b32 s3, 131072
K_ZPOLL0:
    v_cmp_eq_u32 vcc, 0, v7
    s_cbranch_vccz K_ZOK0
    s_sub_u32 s3, s3, 1
    s_cbranch_scc1 K_ZOK0
    global_load_dword v7, v4, s[8:9] offset:192 sc1
    s_waitcnt vmcnt(0)
    s_branch K_ZPOLL0
K_ZOK0:
    v_mov_b32 v3, 1
    s_mov_b32 exec_lo, s36
    s_mov_b32 exec_hi, 0
    s_setprio 3
    s_barrier
    global_store_dword v8, v3, s[10:11] sc1
    s_mov_b64 exec, -1
    s_branch K_END
WP_atts:
    s_setpc_b64 s[38:39]
K_JOIN_S:
    s_setprio 0
    s_barrier
    s_cmp_eq_u32 s30, 7
    s_cbranch_scc1 K_FLAG
    ds_read_b64 v[52:53], v13 offset:80
    ds_read_b64 v[54:55], v14 offset:80
    ds_read_b64 v[44:45], v13 offset:4352
    ds_read_b64 v[46:47], v19 offset:4352
    ds_read_b64 v[56:57], v13 offset:4432
    ds_read_b64 v[58:59], v14 offset:4432
    ds_read_b64 v[60:61], v13 offset:120
    ds_read_b64 v[62:63], v14 offset:120
    ds_read_b64 v[48:49], v13 offset:4392
    ds_read_b64 v[50:51], v20 offset:4352
    ds_read_b64 v[64:65], v13 offset:4472
    ds_read_b64 v[66:67], v14 offset:4472
    s_waitcnt lgkmcnt(6)
    v_mfma_f32_16x16x32_bf16 v[84:87], v[52:55], v[44:47], v[36:39]
    v_mfma_f32_16x16x32_bf16 v[88:91], v[56:59], v[44:47], v[32:35]
    s_waitcnt lgkmcnt(0)
    v_mfma_f32_16x16x32_bf16 v[92:95], v[60:63], v[48:51], v[36:39]
    v_mfma_f32_16x16x32_bf16 v[96:99], v[64:67], v[48:51], v[32:35]
    ds_read_b64_tr_b16 v[68:69], v15 offset:160
    ds_read_b64_tr_b16 v[70:71], v15 offset:4512
    ds_read_b64_tr_b16 v[76:77], v21 offset:0
    ds_read_b64_tr_b16 v[78:79], v21 offset:4352
    ds_read_b64_tr_b16 v[72:73], v15 offset:200
    ds_read_b64_tr_b16 v[74:75], v15 offset:4552
    ds_read_b64_tr_b16 v[80:81], v22 offset:0
    ds_read_b64_tr_b16 v[82:83], v22 offset:4352
    v_max3_f32 v120, v84, v85, v88
    v_max3_f32 v121, v86, v87, v90
    v_max_f32 v120, v120, v89
    v_max_f32 v121, v121, v91
    v_max3_f32 v122, v92, v93, v96
    v_max3_f32 v123, v94, v95, v98
    v_max_f32 v122, v122, v97
    v_max_f32 v123, v123, v99
    v_cvt_pk_bf16_f32 v124, v120, v121
    v_cvt_pk_bf16_f32 v125, v122, v123
    v_lshlrev_b32 v120, 16, v124
    v_and_b32 v121, 0xffff0000, v124
    v_lshlrev_b32 v122, 16, v125
    v_and_b32 v123, 0xffff0000, v125
    v_pk_mul_f32 v[120:121], v[120:121], s[48:49]
    v_pk_mul_f32 v[122:123], v[122:123], s[48:49]
    v_cvt_pk_bf16_f32 v124, v120, v121
    v_cvt_pk_bf16_f32 v125, v122, v123
    s_nop 1
    v_permlane16_swap_b32 v124, v125
    v_lshlrev_b32 v120, 16, v124
    v_and_b32 v121, 0xffff0000, v124
    v_lshlrev_b32 v122, 16, v125
    v_and_b32 v123, 0xffff0000, v125
    v_max3_f32 v126, v120, v121, v122
    v_max_f32 v126, v126, v123
    v_mov_b32 v127, v126
    s_nop 1
    v_permlane32_swap_b32 v126, v127
    v_max_f32 v126, v126, v127
    v_mul_f32 v126, s46, v126
    v_pk_fma_f32 v[120:121], v[120:121], s[46:47], v[126:127] op_sel_hi:[1,1,0] neg_lo:[0,0,1] neg_hi:[0,0,1]
    v_pk_fma_f32 v[122:123], v[122:123], s[46:47], v[126:127] op_sel_hi:[1,1,0] neg_lo:[0,0,1] neg_hi:[0,0,1]
    v_exp_f32 v120, v120
    v_exp_f32 v121, v121
    v_exp_f32 v122, v122
    v_exp_f32 v123, v123
    s_nop 0
    v_pk_add_f32 v[128:129], v[120:121], v[122:123]
    v_add_f32 v128, v128, v129
    v_mov_b32 v129, v128
    s_nop 1
    v_permlane32_swap_b32 v128, v129
    v_add_f32 v128, v128, v129
    v_rcp_f32 v128, v128
    s_waitcnt lgkmcnt(0)
    v_pk_mul_f32 v[120:121], v[120:121], v[128:129] op_sel_hi:[1,0]
    v_pk_mul_f32 v[122:123], v[122:123], v[128:129] op_sel_hi:[1,0]
    v_cvt_pk_bf16_f32 v124, v120, v121
    v_cvt_pk_bf16_f32 v125, v122, v123
    s_nop 1
    v_permlane16_swap_b32 v124, v125
    v_perm_b32 v100, v124, v124, v40
    v_perm_b32 v101, v124, v124, v41
    v_perm_b32 v102, v124, v124, v42
    v_perm_b32 v103, v124, v124, v43
    v_perm_b32 v104, v125, v125, v40
    v_perm_b32 v105, v125, v125, v41
    v_perm_b32 v106, v125, v125, v42
    v_perm_b32 v107, v125, v125, v43
    v_mfma_f32_16x16x32_bf16 v[108:111], v[68:71], v[100:103], 0
    v_mfma_f32_16x16x32_bf16 v[116:119], v[76:79], v[100:103], 0
    v_mfma_f32_16x16x32_bf16 v[112:115], v[72:75], v[104:107], 0
    v_mfma_f32_16x16x32_bf16 v[116:119], v[80:83], v[104:107], v[116:119]
    s_nop 4
    v_cvt_pk_bf16_f32 v132, v108, v109
    v_cvt_pk_bf16_f32 v133, v110, v111
    v_cvt_pk_bf16_f32 v134, v112, v113
    v_cvt_pk_bf16_f32 v135, v114, v115
    buffer_store_dwordx4 v[132:135], v16, s[20:23], s50 offen sc1
    v_cvt_pk_bf16_f32 v126, v116, v117
    v_cvt_pk_bf16_f32 v127, v118, v119
    buffer_store_dwordx2 v[126:127], v17, s[20:23], s50 offen sc1
    s_cmp_eq_u32 s34, -1
    s_cbranch_scc1 K_DRAIN
    s_cmp_lg_u32 s30, 6
    s_cbranch_scc1 K_NOFL
    s_waitcnt vmcnt(2)
    v_and_b32 v4, 7, v1
    v_lshlrev_b32 v4, 2, v4
    s_mov_b32 s3, 131072
K_ZPOLL2:
    v_cmp_eq_u32 vcc, 0, v7
    s_cbranch_vccz K_ZOK2
    s_sub_u32 s3, s3, 1
    s_cbranch_scc1 K_ZOK2
    global_load_dword v7, v4, s[8:9] offset:192 sc1
    s_waitcnt vmcnt(0)
    s_branch K_ZPOLL2
K_ZOK2:
    v_and_b32 v2, 1, v1
    v_lshl_add_u32 v2, v2, 2, s42
    global_load_dword v7, v2, s[10:11] offset:128 sc1
K_NOFL:
    v_mov_b32 v4, 158720
    v_mov_b32 v3, 257
    s_mov_b64 exec, 1
    s_waitcnt vmcnt(0)
    ds_add_rtn_u32 v2, v4, v3 offset:48
    s_mov_b32 exec_lo, s36
    v_mov_b32 v3, 1
    s_waitcnt lgkmcnt(0)
    v_readfirstlane_b32 s33, v2
    s_nop 3
    s_and_b32 s33, s33, 0xff
    s_cmp_lg_u32 s33, 7
    s_cbranch_scc1 K_ARRS
    global_store_dword v8, v3, s[10:11] sc1
K_ARRS:
    s_mov_b64 exec, -1
    s_cmp_ge_u32 s30, 6
    s_cbranch_scc1 K_P2_HELP
    s_branch K_LATE
WP_early:
    s_setpc_b64 s[38:39]
K_P2_EARLY:
    s_lshl_b32 s54, s40, 7
    v_lshrrev_b32 v9, 4, v1
    v_mov_b32 v12, 158720
    s_add_u32 s20, s10, 0x100000
    s_addc_u32 s21, s11, 0
    s_mov_b32 s22, 0x280000
    s_mov_b32 s23, 0x20000
    s_add_u32 s16, s10, 0x1000
    s_addc_u32 s17, s11, 0
    s_mov_b32 s18, 0x2000
    s_mov_b32 s19, 0x20000
    s_mov_b32 s48, s6
    s_mov_b32 s49, s7
    s_mov_b32 s50, 0x280000
    s_mov_b32 s51, 0x20000
    s_lshl_b32 s53, s40, 3
    s_lshl1_add_u32 s53, s30, s53
    s_mov_b32 s55, 20480
    v_bfe_u32 v20, v1, 2, 2
    v_and_b32 v21, 3, v1
    s_mul_i32 s3, s53, 20480
    v_lshl_add_u32 v25, v1, 4, s3
    v_add_u32 v26, 20480, v25
    v_add_u32 v35, 16384, v25
    v_add_u32 v36, 16384, v26
    v_and_b32 v2, 15, v1
    s_lshl_b32 s3, s53, 6
    v_lshl_add_u32 v23, v2, 2, s3
    v_lshl_add_u32 v2, v9, 2, v20
    v_bfe_u32 v3, v2, 1, 2
    v_lshlrev_b32 v2, 7, v2
    v_lshl_add_u32 v2, v21, 3, v2
    v_lshl_add_u32 v24, v3, 5, v2
    v_lshrrev_b32 v3, 1, v20
    v_mul_u32_u24 v2, 40, v9
    v_add3_u32 v2, v2, 16, v20
    v_lshlrev_b32 v2, 7, v2
    v_lshl_add_u32 v2, v21, 3, v2
    v_xor_b32 v4, 0, v3
    v_lshl_add_u32 v60, v4, 5, v2
    v_xor_b32 v4, 1, v3
    v_lshl_add_u32 v61, v4, 5, v2
    v_xor_b32 v4, 2, v3
    v_lshl_add_u32 v62, v4, 5, v2
    v_xor_b32 v4, 3, v3
    v_lshl_add_u32 v63, v4, 5, v2
    v_lshrrev_b32 v3, 4, v1
    v_and_b32 v4, 7, v1
    v_lshrrev_b32 v2, 3, v1
    v_xor_b32 v4, v4, v3
    v_mul_u32_u24 v2, 1280, v2
    v_lshl_add_u32 v27, v4, 4, v2
    v_xor_b32 v28, 64, v27
    s_lshl_b32 s71, s40, 3
    s_lshl1_add_u32 s71, s30, s71
    s_mul_i32 s71, s71, 20480
    s_lshl_b32 s33, s41, 7
    s_add_u32 s71, s71, s33
    s_add_u32 s72, s71, 10240
    s_add_u32 s73, s71, 20480
    s_add_u32 s74, s71, 30720
    s_lshl_b32 s3, s30, 12
    s_add_u32 s3, s3, 140288
    v_lshl_add_u32 v33, v1, 4, s3
    v_and_b32 v2, 15, v1
    v_lshrrev_b32 v3, 1, v2
    v_lshrrev_b32 v4, 5, v1
    v_xor_b32 v3, v3, v4
    v_lshlrev_b32 v3, 4, v3
    v_lshl_add_u32 v3, v2, 7, v3
    v_and_b32 v4, 1, v9
    v_lshl_add_u32 v3, v4, 3, v3
    v_add_u32 v29, s3, v3
    v_xor_b32 v30, 32, v29
    v_xor_b32 v31, 64, v29
    v_xor_b32 v32, 96, v29
    s_and_b32 s33, s40, 3
    s_lshl_b32 s33, s33, 3
    s_lshr_b32 s33, 0x7f06037f, s33
    s_and_b32 s33, s33, 0xff
    s_lshl_b32 s3, s30, 1
    s_cmp_ge_u32 s3, s33
    s_cselect_b32 s64, 16, 0
    s_add_u32 s3, s3, 1
    s_cmp_ge_u32 s3, s33
    s_cselect_b32 s65, 16, 0
    s_mov_b32 s63, 0
    s_mov_b32 s66, 0
    s_mov_b32 s67, 16384
    v_mov_b32 v34, 0
    v_mov_b32 v4, 158720
    v_mov_b32 v3, 1
    s_mov_b64 exec, 1
    s_waitcnt vmcnt(0)
    ds_add_rtn_u32 v2, v4, v3 offset:48
    s_mov_b32 exec_lo, s36
    v_mov_b32 v3, 1
    s_waitcnt lgkmcnt(0)
    v_readfirstlane_b32 s33, v2
    s_nop 3
    s_and_b32 s33, s33, 0xff
    s_cmp_lg_u32 s33, 7
    s_cbranch_scc1 K_ARRD
    global_store_dword v8, v3, s[10:11] sc1
K_ARRD:
    s_mov_b64 exec, -1
    s_mov_b32 s3, 1048576
K_P2_GE:
    ds_read_b32 v2, v12 offset:48
    s_sub_u32 s3, s3, 1
    s_waitcnt lgkmcnt(0)
    v_readfirstlane_b32 s33, v2
    s_nop 3
    s_cselect_b32 s33, 1024, s33
    s_cmp_lt_u32 s33, 1024
    s_cbranch_scc1 K_P2_GE
K_P2_GEMM:
    s_setprio 0
    s_mov_b32 s3, 1048576
K_P2_GS:
    ds_read_b32 v2, v12 offset:40
    s_sub_u32 s3, s3, 1
    s_waitcnt lgkmcnt(0)
    v_readfirstlane_b32 s33, v2
    s_nop 3
    s_cselect_b32 s33, 1, s33
    s_cmp_lt_u32 s33, 1
    s_cbranch_scc1 K_P2_GS
    buffer_load_dword v64, v23, s[16:19], 0 offen offset:0 sc1
    buffer_load_dword v66, v23, s[16:19], 0 offen offset:64 sc1
    ds_read_b128 v[16:19], v12
    ds_read_b64 v[40:41], v29 offset:0
    ds_read_b64 v[42:43], v30 offset:0
    ds_read_b64 v[44:45], v31 offset:0
    ds_read_b64 v[46:47], v32 offset:0
    ds_read_b64 v[48:49], v29 offset:2048
    ds_read_b64 v[50:51], v30 offset:2048
    ds_read_b64 v[52:53], v31 offset:2048
    ds_read_b64 v[54:55], v32 offset:2048
    s_waitcnt lgkmcnt(4)
    v_lshlrev_b32 v72, 16, v40
    v_and_b32 v73, 0xffff0000, v40
    v_lshlrev_b32 v74, 16, v41
    v_and_b32 v75, 0xffff0000, v41
    v_lshlrev_b32 v76, 16, v42
    v_and_b32 v77, 0xffff0000, v42
    v_lshlrev_b32 v78, 16, v43
    v_and_b32 v79, 0xffff0000, v43
    v_lshlrev_b32 v80, 16, v44
    v_and_b32 v81, 0xffff0000, v44
    v_lshlrev_b32 v82, 16, v45
    v_and_b32 v83, 0xffff0000, v45
    v_lshlrev_b32 v84, 16, v46
    v_and_b32 v85, 0xffff0000, v46
    v_lshlrev_b32 v86, 16, v47
    v_and_b32 v87, 0xffff0000, v47
    s_waitcnt lgkmcnt(0)
    v_lshlrev_b32 v88, 16, v48
    v_and_b32 v89, 0xffff0000, v48
    v_lshlrev_b32 v90, 16, v49
    v_and_b32 v91, 0xffff0000, v49
    v_lshlrev_b32 v92, 16, v50
    v_and_b32 v93, 0xffff0000, v50
    v_lshlrev_b32 v94, 16, v51
    v_and_b32 v95, 0xffff0000, v51
    v_lshlrev_b32 v96, 16, v52
    v_and_b32 v97, 0xffff0000, v52
    v_lshlrev_b32 v98, 16, v53
    v_and_b32 v99, 0xffff0000, v53
    v_lshlrev_b32 v100, 16, v54
    v_and_b32 v101, 0xffff0000, v54
    v_lshlrev_b32 v102, 16, v55
    v_and_b32 v103, 0xffff0000, v55
    s_cmp_eq_u32 s63, 0
    s_cbranch_scc1 K_SP0
K_SPR0:
    s_ff1_i32_b32 s33, s63
    s_bitset0_b32 s63, s33
    s_lshl_b32 s75, s33, 10
    buffer_load_dwordx4 v[104:107], v25, s[20:23], s75 offen offset:0 sc1
    buffer_load_dwordx4 v[108:111], v26, s[20:23], s75 offen offset:0 sc1
    v_mad_u32_u24 v56, s75, 5, v24
    v_xor_b32 v58, 64, v56
    v_xor_b32 v57, 32, v56
    v_xor_b32 v59, 96, v56
    ds_read_b64_tr_b16 v[184:185], v56 offset:0
    ds_read_b64_tr_b16 v[186:187], v58 offset:2560
    ds_read_b64_tr_b16 v[188:189], v57 offset:0
    ds_read_b64_tr_b16 v[190:191], v59 offset:2560
    ds_read_b64_tr_b16 v[192:193], v58 offset:0
    ds_read_b64_tr_b16 v[194:195], v56 offset:2560
    ds_read_b64_tr_b16 v[196:197], v59 offset:0
    ds_read_b64_tr_b16 v[198:199], v57 offset:2560
    s_cmp_eq_u32 s63, 0
    s_cbranch_scc1 K_SP1
K_SPR1:
    s_ff1_i32_b32 s33, s63
    s_bitset0_b32 s63, s33
    s_lshl_b32 s76, s33, 10
    buffer_load_dwordx4 v[112:115], v25, s[20:23], s76 offen offset:0 sc1
    buffer_load_dwordx4 v[116:119], v26, s[20:23], s76 offen offset:0 sc1
    v_mad_u32_u24 v56, s76, 5, v24
    v_xor_b32 v58, 64, v56
    v_xor_b32 v57, 32, v56
    v_xor_b32 v59, 96, v56
    ds_read_b64_tr_b16 v[200:201], v56 offset:0
    ds_read_b64_tr_b16 v[202:203], v58 offset:2560
    ds_read_b64_tr_b16 v[204:205], v57 offset:0
    ds_read_b64_tr_b16 v[206:207], v59 offset:2560
    ds_read_b64_tr_b16 v[208:209], v58 offset:0
    ds_read_b64_tr_b16 v[210:211], v56 offset:2560
    ds_read_b64_tr_b16 v[212:213], v59 offset:0
    ds_read_b64_tr_b16 v[214:215], v57 offset:2560
    s_waitcnt vmcnt(4)
    s_mov_b64 exec, 1
    ds_add_u32 v12, v34 offset:44
    s_mov_b64 exec, -1
    v_sub_f32 v68, 1.0, v64
    v_cvt_pk_bf16_f32 v68, v68, v68
    v_lshlrev_b32 v68, 16, v68
    v_sub_f32 v70, 1.0, v66
    v_cvt_pk_bf16_f32 v70, v70, v70
    v_lshlrev_b32 v70, 16, v70
    v_pk_mul_f32 v[72:73], v[72:73], v[68:69] op_sel_hi:[1,0]
    v_pk_mul_f32 v[74:75], v[74:75], v[68:69] op_sel_hi:[1,0]
    v_pk_mul_f32 v[76:77], v[76:77], v[68:69] op_sel_hi:[1,0]
    v_pk_mul_f32 v[78:79], v[78:79], v[68:69] op_sel_hi:[1,0]
    v_pk_mul_f32 v[80:81], v[80:81], v[68:69] op_sel_hi:[1,0]
    v_pk_mul_f32 v[82:83], v[82:83], v[68:69] op_sel_hi:[1,0]
    v_pk_mul_f32 v[84:85], v[84:85], v[68:69] op_sel_hi:[1,0]
    v_pk_mul_f32 v[86:87], v[86:87], v[68:69] op_sel_hi:[1,0]
    v_pk_mul_f32 v[88:89], v[88:89], v[70:71] op_sel_hi:[1,0]
    v_pk_mul_f32 v[90:91], v[90:91], v[70:71] op_sel_hi:[1,0]
    v_pk_mul_f32 v[92:93], v[92:93], v[70:71] op_sel_hi:[1,0]
    v_pk_mul_f32 v[94:95], v[94:95], v[70:71] op_sel_hi:[1,0]
    v_pk_mul_f32 v[96:97], v[96:97], v[70:71] op_sel_hi:[1,0]
    v_pk_mul_f32 v[98:99], v[98:99], v[70:71] op_sel_hi:[1,0]
    v_pk_mul_f32 v[100:101], v[100:101], v[70:71] op_sel_hi:[1,0]
    v_pk_mul_f32 v[102:103], v[102:103], v[70:71] op_sel_hi:[1,0]
    s_cmp_eq_u32 s63, 0
    s_cbranch_scc1 K_SP2
K_SPR2:
    s_ff1_i32_b32 s33, s63
    s_bitset0_b32 s63, s33
    s_lshl_b32 s77, s33, 10
    buffer_load_dwordx4 v[120:123], v25, s[20:23], s77 offen offset:0 sc1
    buffer_load_dwordx4 v[124:127], v26, s[20:23], s77 offen offset:0 sc1
    s_cmp_eq_u32 s63, 0
    s_cbranch_scc1 K_SP3
K_SPR3:
    s_ff1_i32_b32 s33, s63
    s_bitset0_b32 s63, s33
    s_lshl_b32 s78, s33, 10
    buffer_load_dwordx4 v[128:131], v25, s[20:23], s78 offen offset:0 sc1
    buffer_load_dwordx4 v[132:135], v26, s[20:23], s78 offen offset:0 sc1
    s_cmp_eq_u32 s63, 0
    s_cbranch_scc1 K_SP4
K_SPR4:
    s_ff1_i32_b32 s33, s63
    s_bitset0_b32 s63, s33
    s_lshl_b32 s75, s33, 10
    buffer_load_dwordx4 v[136:139], v25, s[20:23], s75 offen offset:0 sc1
    buffer_load_dwordx4 v[140:143], v26, s[20:23], s75 offen offset:0 sc1
    s_branch WS_p2g
.p2align 12
WP_p2g:
    s_setpc_b64 s[38:39]
WS_p2g:
    s_waitcnt vmcnt(8) lgkmcnt(9)
    v_mfma_f32_16x16x32_bf16 v[152:155], v[184:187], v[104:107], 0
    v_mad_u32_u24 v56, s77, 5, v24
    v_xor_b32 v58, 64, v56
    v_xor_b32 v57, 32, v56
    v_mfma_f32_16x16x32_bf16 v[168:171], v[184:187], v[108:111], 0
    v_xor_b32 v59, 96, v56
    ds_read_b64_tr_b16 v[216:217], v56 offset:0
    ds_read_b64_tr_b16 v[218:219], v58 offset:2560
    v_mfma_f32_16x16x32_bf16 v[156:159], v[188:191], v[104:107], 0
    ds_read_b64_tr_b16 v[220:221], v57 offset:0
    ds_read_b64_tr_b16 v[222:223], v59 offset:2560
    ds_read_b64_tr_b16 v[224:225], v58 offset:0
    v_mfma_f32_16x16x32_bf16 v[172:175], v[188:191], v[108:111], 0
    ds_read_b64_tr_b16 v[226:227], v56 offset:2560
    ds_read_b64_tr_b16 v[228:229], v59 offset:0
    v_mfma_f32_16x16x32_bf16 v[160:163], v[192:195], v[104:107], 0
    ds_read_b64_tr_b16 v[230:231], v57 offset:2560
    s_cmp_eq_u32 s63, 0
    v_mfma_f32_16x16x32_bf16 v[176:179], v[192:195], v[108:111], 0
    s_cbranch_scc1 K_SP5
K_SPR5:
    s_ff1_i32_b32 s33, s63
    v_mfma_f32_16x16x32_bf16 v[164:167], v[196:199], v[104:107], 0
    s_bitset0_b32 s63, s33
    s_lshl_b32 s76, s33, 10
    v_mfma_f32_16x16x32_bf16 v[180:183], v[196:199], v[108:111], 0
    buffer_load_dwordx4 v[144:147], v25, s[20:23], s76 offen offset:0 sc1
    buffer_load_dwordx4 v[148:151], v26, s[20:23], s76 offen offset:0 sc1
    s_waitcnt vmcnt(8) lgkmcnt(9)
    v_mfma_f32_16x16x32_bf16 v[152:155], v[200:203], v[112:115], v[152:155]
    v_mad_u32_u24 v56, s78, 5, v24
    v_xor_b32 v58, 64, v56
    v_xor_b32 v57, 32, v56
    v_mfma_f32_16x16x32_bf16 v[168:171], v[200:203], v[116:119], v[168:171]
    v_xor_b32 v59, 96, v56
    ds_read_b64_tr_b16 v[184:185], v56 offset:0
    ds_read_b64_tr_b16 v[186:187], v58 offset:2560
    v_mfma_f32_16x16x32_bf16 v[156:159], v[204:207], v[112:115], v[156:159]
    ds_read_b64_tr_b16 v[188:189], v57 offset:0
    ds_read_b64_tr_b16 v[190:191], v59 offset:2560
    ds_read_b64_tr_b16 v[192:193], v58 offset:0
    v_mfma_f32_16x16x32_bf16 v[172:175], v[204:207], v[116:119], v[172:175]
    ds_read_b64_tr_b16 v[194:195], v56 offset:2560
    ds_read_b64_tr_b16 v[196:197], v59 offset:0
    v_mfma_f32_16x16x32_bf16 v[160:163], v[208:211], v[112:115], v[160:163]
    ds_read_b64_tr_b16 v[198:199], v57 offset:2560
    s_cmp_eq_u32 s63, 0
    v_mfma_f32_16x16x32_bf16 v[176:179], v[208:211], v[116:119], v[176:179]
    s_cbranch_scc1 K_SP6
K_SPR6:
    s_ff1_i32_b32 s33, s63
    v_mfma_f32_16x16x32_bf16 v[164:167], v[212:215], v[112:115], v[164:167]
    s_bitset0_b32 s63, s33
    s_lshl_b32 s77, s33, 10
    v_mfma_f32_16x16x32_bf16 v[180:183], v[212:215], v[116:119], v[180:183]
    buffer_load_dwordx4 v[104:107], v25, s[20:23], s77 offen offset:0 sc1
    buffer_load_dwordx4 v[108:111], v26, s[20:23], s77 offen offset:0 sc1
    s_waitcnt vmcnt(8) lgkmcnt(8)
    v_mfma_f32_16x16x32_bf16 v[152:155], v[216:219], v[120:123], v[152:155]
    v_mad_u32_u24 v56, s75, 5, v24
    v_xor_b32 v58, 64, v56
    v_xor_b32 v57, 32, v56
    v_mfma_f32_16x16x32_bf16 v[168:171], v[216:219], v[124:127], v[168:171]
    v_xor_b32 v59, 96, v56
    ds_read_b64_tr_b16 v[200:201], v56 offset:0
    ds_read_b64_tr_b16 v[202:203], v58 offset:2560
    v_mfma_f32_16x16x32_bf16 v[156:159], v[220:223], v[120:123], v[156:159]
    ds_read_b64_tr_b16 v[204:205], v57 offset:0
    ds_read_b64_tr_b16 v[206:207], v59 offset:2560
    ds_read_b64_tr_b16 v[208:209], v58 offset:0
    v_mfma_f32_16x16x32_bf16 v[172:175], v[220:223], v[124:127], v[172:175]
    ds_read_b64_tr_b16 v[210:211], v56 offset:2560
    ds_read_b64_tr_b16 v[212:213], v59 offset:0
    v_mfma_f32_16x16x32_bf16 v[160:163], v[224:227], v[120:123], v[160:163]
    ds_read_b64_tr_b16 v[214:215], v57 offset:2560
    s_andn2_b32 s33, s66, s63
    v_mfma_f32_16x16x32_bf16 v[176:179], v[224:227], v[124:127], v[176:179]
    s_bfe_u32 s33, s33, 0x40000
    s_cmp_eq_u32 s33, 15
    v_mfma_f32_16x16x32_bf16 v[164:167], v[228:231], v[120:123], v[164:167]
    s_cselect_b32 s78, 0, 1024
    s_xor_b32 s69, s78, 1024
    v_mfma_f32_16x16x32_bf16 v[180:183], v[228:231], v[124:127], v[180:183]
    buffer_load_dwordx4 v[112:115], v35, s[20:23], s78 offen offset:0 sc1
    buffer_load_dwordx4 v[116:119], v36, s[20:23], s78 offen offset:0 sc1
    s_waitcnt vmcnt(8) lgkmcnt(8)
    v_mfma_f32_16x16x32_bf16 v[152:155], v[184:187], v[128:131], v[152:155]
    v_mad_u32_u24 v56, s76, 5, v24
    v_xor_b32 v58, 64, v56
    v_xor_b32 v57, 32, v56
    v_mfma_f32_16x16x32_bf16 v[168:171], v[184:187], v[132:135], v[168:171]
    v_xor_b32 v59, 96, v56
    ds_read_b64_tr_b16 v[216:217], v56 offset:0
    ds_read_b64_tr_b16 v[218:219], v58 offset:2560
    v_mfma_f32_16x16x32_bf16 v[156:159], v[188:191], v[128:131], v[156:159]
    ds_read_b64_tr_b16 v[220:221], v57 offset:0
    ds_read_b64_tr_b16 v[222:223], v59 offset:2560
    ds_read_b64_tr_b16 v[224:225], v58 offset:0
    v_mfma_f32_16x16x32_bf16 v[172:175], v[188:191], v[132:135], v[172:175]
    ds_read_b64_tr_b16 v[226:227], v56 offset:2560
    ds_read_b64_tr_b16 v[228:229], v59 offset:0
    v_mfma_f32_16x16x32_bf16 v[160:163], v[192:195], v[128:131], v[160:163]
    ds_read_b64_tr_b16 v[230:231], v57 offset:2560
    s_cmp_eq_u32 s63, 0
    v_mfma_f32_16x16x32_bf16 v[176:179], v[192:195], v[132:135], v[176:179]
    s_cbranch_scc1 K_SP8
K_SPR8:
    s_ff1_i32_b32 s33, s63
    v_mfma_f32_16x16x32_bf16 v[164:167], v[196:199], v[128:131], v[164:167]
    s_bitset0_b32 s63, s33
    s_lshl_b32 s75, s33, 10
    v_mfma_f32_16x16x32_bf16 v[180:183], v[196:199], v[132:135], v[180:183]
    buffer_load_dwordx4 v[120:123], v25, s[20:23], s75 offen offset:0 sc1
    buffer_load_dwordx4 v[124:127], v26, s[20:23], s75 offen offset:0 sc1
    s_waitcnt vmcnt(8) lgkmcnt(8)
    v_mfma_f32_16x16x32_bf16 v[152:155], v[200:203], v[136:139], v[152:155]
    v_mad_u32_u24 v56, s77, 5, v24
    v_xor_b32 v58, 64, v56
    v_mfma_f32_16x16x32_bf16 v[168:171], v[200:203], v[140:143], v[168:171]
    v_xor_b32 v57, 32, v56
    v_xor_b32 v59, 96, v56
    v_mfma_f32_16x16x32_bf16 v[156:159], v[204:207], v[136:139], v[156:159]
    ds_read_b64_tr_b16 v[184:185], v56 offset:0
    ds_read_b64_tr_b16 v[186:187], v58 offset:2560
    v_mfma_f32_16x16x32_bf16 v[172:175], v[204:207], v[140:143], v[172:175]
    ds_read_b64_tr_b16 v[188:189], v57 offset:0
    ds_read_b64_tr_b16 v[190:191], v59 offset:2560
    v_mfma_f32_16x16x32_bf16 v[160:163], v[208:211], v[136:139], v[160:163]
    ds_read_b64_tr_b16 v[192:193], v58 offset:0
    ds_read_b64_tr_b16 v[194:195], v56 offset:2560
    v_mfma_f32_16x16x32_bf16 v[176:179], v[208:211], v[140:143], v[176:179]
    ds_read_b64_tr_b16 v[196:197], v59 offset:0
    ds_read_b64_tr_b16 v[198:199], v57 offset:2560
    v_mfma_f32_16x16x32_bf16 v[164:167], v[212:215], v[136:139], v[164:167]
    buffer_load_dwordx4 v[128:131], v35, s[20:23], s69 offen offset:0 sc1
    buffer_load_dwordx4 v[132:135], v36, s[20:23], s69 offen offset:0 sc1
    v_mfma_f32_16x16x32_bf16 v[180:183], v[212:215], v[140:143], v[180:183]
    s_waitcnt vmcnt(8) lgkmcnt(8)
    v_mfma_f32_16x16x32_bf16 v[152:155], v[216:219], v[144:147], v[152:155]
    v_mad_u32_u24 v56, s78, 20, v60
    v_xor_b32 v58, 64, v56
    v_xor_b32 v57, 32, v56
    v_mfma_f32_16x16x32_bf16 v[168:171], v[216:219], v[148:151], v[168:171]
    v_xor_b32 v59, 96, v56
    ds_read_b64_tr_b16 v[200:201], v56 offset:0
    ds_read_b64_tr_b16 v[202:203], v58 offset:2560
    v_mfma_f32_16x16x32_bf16 v[156:159], v[220:223], v[144:147], v[156:159]
    ds_read_b64_tr_b16 v[204:205], v57 offset:0
    ds_read_b64_tr_b16 v[206:207], v59 offset:2560
    ds_read_b64_tr_b16 v[208:209], v58 offset:0
    v_mfma_f32_16x16x32_bf16 v[172:175], v[220:223], v[148:151], v[172:175]
    ds_read_b64_tr_b16 v[210:211], v56 offset:2560
    ds_read_b64_tr_b16 v[212:213], v59 offset:0
    v_mfma_f32_16x16x32_bf16 v[160:163], v[224:227], v[144:147], v[160:163]
    ds_read_b64_tr_b16 v[214:215], v57 offset:2560
    s_cmp_eq_u32 s63, 0
    v_mfma_f32_16x16x32_bf16 v[176:179], v[224:227], v[148:151], v[176:179]
    s_cbranch_scc1 K_SP10
K_SPR10:
    s_ff1_i32_b32 s33, s63
    v_mfma_f32_16x16x32_bf16 v[164:167], v[228:231], v[144:147], v[164:167]
    s_bitset0_b32 s63, s33
    s_lshl_b32 s77, s33, 10
    v_mfma_f32_16x16x32_bf16 v[180:183], v[228:231], v[148:151], v[180:183]
    buffer_load_dwordx4 v[136:139], v25, s[20:23], s77 offen offset:0 sc1
    buffer_load_dwordx4 v[140:143], v26, s[20:23], s77 offen offset:0 sc1
    s_waitcnt vmcnt(8) lgkmcnt(8)
    v_mfma_f32_16x16x32_bf16 v[152:155], v[184:187], v[104:107], v[152:155]
    v_mad_u32_u24 v56, s75, 5, v24
    v_xor_b32 v58, 64, v56
    v_xor_b32 v57, 32, v56
    v_mfma_f32_16x16x32_bf16 v[168:171], v[184:187], v[108:111], v[168:171]
    v_xor_b32 v59, 96, v56
    ds_read_b64_tr_b16 v[216:217], v56 offset:0
    ds_read_b64_tr_b16 v[218:219], v58 offset:2560
    v_mfma_f32_16x16x32_bf16 v[156:159], v[188:191], v[104:107], v[156:159]
    ds_read_b64_tr_b16 v[220:221], v57 offset:0
    ds_read_b64_tr_b16 v[222:223], v59 offset:2560
    ds_read_b64_tr_b16 v[224:225], v58 offset:0
    v_mfma_f32_16x16x32_bf16 v[172:175], v[188:191], v[108:111], v[172:175]
    ds_read_b64_tr_b16 v[226:227], v56 offset:2560
    ds_read_b64_tr_b16 v[228:229], v59 offset:0
    v_mfma_f32_16x16x32_bf16 v[160:163], v[192:195], v[104:107], v[160:163]
    ds_read_b64_tr_b16 v[230:231], v57 offset:2560
    s_cmp_eq_u32 s63, 0
    v_mfma_f32_16x16x32_bf16 v[176:179], v[192:195], v[108:111], v[176:179]
    s_cbranch_scc1 K_SP11
K_SPR11:
    s_ff1_i32_b32 s33, s63
    v_mfma_f32_16x16x32_bf16 v[164:167], v[196:199], v[104:107], v[164:167]
    s_bitset0_b32 s63, s33
    s_lshl_b32 s78, s33, 10
    v_mfma_f32_16x16x32_bf16 v[180:183], v[196:199], v[108:111], v[180:183]
    buffer_load_dwordx4 v[144:147], v25, s[20:23], s78 offen offset:0 sc1
    buffer_load_dwordx4 v[148:151], v26, s[20:23], s78 offen offset:0 sc1
    s_waitcnt vmcnt(8) lgkmcnt(8)
    v_mfma_f32_16x16x32_bf16 v[152:155], v[200:203], v[112:115], v[152:155]
    v_mad_u32_u24 v56, s69, 20, v60
    v_xor_b32 v58, 64, v56
    v_xor_b32 v57, 32, v56
    v_mfma_f32_16x16x32_bf16 v[168:171], v[200:203], v[116:119], v[168:171]
    v_xor_b32 v59, 96, v56
    ds_read_b64_tr_b16 v[184:185], v56 offset:0
    ds_read_b64_tr_b16 v[186:187], v58 offset:2560
    v_mfma_f32_16x16x32_bf16 v[156:159], v[204:207], v[112:115], v[156:159]
    ds_read_b64_tr_b16 v[188:189], v57 offset:0
    ds_read_b64_tr_b16 v[190:191], v59 offset:2560
    ds_read_b64_tr_b16 v[192:193], v58 offset:0
    v_mfma_f32_16x16x32_bf16 v[172:175], v[204:207], v[116:119], v[172:175]
    ds_read_b64_tr_b16 v[194:195], v56 offset:2560
    ds_read_b64_tr_b16 v[196:197], v59 offset:0
    v_mfma_f32_16x16x32_bf16 v[160:163], v[208:211], v[112:115], v[160:163]
    ds_read_b64_tr_b16 v[198:199], v57 offset:2560
    s_cmp_eq_u32 s63, 0
    v_mfma_f32_16x16x32_bf16 v[176:179], v[208:211], v[116:119], v[176:179]
    s_cbranch_scc1 K_SP12
K_SPR12:
    s_ff1_i32_b32 s33, s63
    v_mfma_f32_16x16x32_bf16 v[164:167], v[212:215], v[112:115], v[164:167]
    s_bitset0_b32 s63, s33
    s_lshl_b32 s75, s33, 10
    v_mfma_f32_16x16x32_bf16 v[180:183], v[212:215], v[116:119], v[180:183]
    buffer_load_dwordx4 v[104:107], v25, s[20:23], s75 offen offset:0 sc1
    buffer_load_dwordx4 v[108:111], v26, s[20:23], s75 offen offset:0 sc1
    s_mov_b32 s3, 1048576
K_P2_GW:
    ds_read_b32 v2, v12 offset:44
    s_sub_u32 s3, s3, 1
    s_waitcnt lgkmcnt(0)
    v_readfirstlane_b32 s33, v2
    s_nop 3
    s_cselect_b32 s33, 4, s33
    s_cmp_lt_u32 s33, 4
    s_cbranch_scc1 K_P2_GW
    v_readfirstlane_b32 s56, v16
    v_readfirstlane_b32 s57, v17
    s_lshl_b32 s58, s53, 4
    s_waitcnt vmcnt(8)
    v_mfma_f32_16x16x32_bf16 v[152:155], v[216:219], v[120:123], v[152:155]
    v_mad_u32_u24 v56, s77, 5, v24
    v_xor_b32 v58, 64, v56
    v_xor_b32 v57, 32, v56
    v_mfma_f32_16x16x32_bf16 v[168:171], v[216:219], v[124:127], v[168:171]
    v_xor_b32 v59, 96, v56
    ds_read_b64_tr_b16 v[200:201], v56 offset:0
    ds_read_b64_tr_b16 v[202:203], v58 offset:2560
    v_mfma_f32_16x16x32_bf16 v[156:159], v[220:223], v[120:123], v[156:159]
    ds_read_b64_tr_b16 v[204:205], v57 offset:0
    ds_read_b64_tr_b16 v[206:207], v59 offset:2560
    ds_read_b64_tr_b16 v[208:209], v58 offset:0
    v_mfma_f32_16x16x32_bf16 v[172:175], v[220:223], v[124:127], v[172:175]
    ds_read_b64_tr_b16 v[210:211], v56 offset:2560
    ds_read_b64_tr_b16 v[212:213], v59 offset:0
    v_mfma_f32_16x16x32_bf16 v[160:163], v[224:227], v[120:123], v[160:163]
    ds_read_b64_tr_b16 v[214:215], v57 offset:2560
    s_cmp_eq_u32 s63, 0
    v_mfma_f32_16x16x32_bf16 v[176:179], v[224:227], v[124:127], v[176:179]
    s_cbranch_scc1 K_SP13
K_SPR13:
    s_ff1_i32_b32 s33, s63
    v_mfma_f32_16x16x32_bf16 v[164:167], v[228:231], v[120:123], v[164:167]
    s_bitset0_b32 s63, s33
    s_lshl_b32 s76, s33, 10
    v_mfma_f32_16x16x32_bf16 v[180:183], v[228:231], v[124:127], v[180:183]
    buffer_load_dwordx4 v[112:115], v25, s[20:23], s76 offen offset:0 sc1
    buffer_load_dwordx4 v[116:119], v26, s[20:23], s76 offen offset:0 sc1
    s_waitcnt vmcnt(8)
    v_mfma_f32_16x16x32_bf16 v[152:155], v[184:187], v[128:131], v[152:155]
    v_mad_u32_u24 v56, s78, 5, v24
    v_xor_b32 v58, 64, v56
    v_xor_b32 v57, 32, v56
    v_mfma_f32_16x16x32_bf16 v[168:171], v[184:187], v[132:135], v[168:171]
    v_xor_b32 v59, 96, v56
    ds_read_b64_tr_b16 v[216:217], v56 offset:0
    ds_read_b64_tr_b16 v[218:219], v58 offset:2560
    v_mfma_f32_16x16x32_bf16 v[156:159], v[188:191], v[128:131], v[156:159]
    ds_read_b64_tr_b16 v[220:221], v57 offset:0
    ds_read_b64_tr_b16 v[222:223], v59 offset:2560
    ds_read_b64_tr_b16 v[224:225], v58 offset:0
    v_mfma_f32_16x16x32_bf16 v[172:175], v[188:191], v[132:135], v[172:175]
    ds_read_b64_tr_b16 v[226:227], v56 offset:2560
    ds_read_b64_tr_b16 v[228:229], v59 offset:0
    v_mfma_f32_16x16x32_bf16 v[160:163], v[192:195], v[128:131], v[160:163]
    ds_read_b64_tr_b16 v[230:231], v57 offset:2560
    s_cmp_eq_u32 s63, 0
    v_mfma_f32_16x16x32_bf16 v[176:179], v[192:195], v[132:135], v[176:179]
    s_cbranch_scc1 K_SP14
K_SPR14:
    s_ff1_i32_b32 s33, s63
    v_mfma_f32_16x16x32_bf16 v[164:167], v[196:199], v[128:131], v[164:167]
    s_bitset0_b32 s63, s33
    s_lshl_b32 s77, s33, 10
    v_mfma_f32_16x16x32_bf16 v[180:183], v[196:199], v[132:135], v[180:183]
    buffer_load_dwordx4 v[120:123], v25, s[20:23], s77 offen offset:0 sc1
    buffer_load_dwordx4 v[124:127], v26, s[20:23], s77 offen offset:0 sc1
    s_waitcnt vmcnt(8) lgkmcnt(8)
    v_mfma_f32_16x16x32_bf16 v[152:155], v[200:203], v[136:139], v[152:155]
    v_mad_u32_u24 v56, s75, 5, v24
    v_xor_b32 v58, 64, v56
    v_xor_b32 v57, 32, v56
    v_mfma_f32_16x16x32_bf16 v[168:171], v[200:203], v[140:143], v[168:171]
    v_xor_b32 v59, 96, v56
    ds_read_b64_tr_b16 v[184:185], v56 offset:0
    ds_read_b64_tr_b16 v[186:187], v58 offset:2560
    v_mfma_f32_16x16x32_bf16 v[156:159], v[204:207], v[136:139], v[156:159]
    ds_read_b64_tr_b16 v[188:189], v57 offset:0
    ds_read_b64_tr_b16 v[190:191], v59 offset:2560
    ds_read_b64_tr_b16 v[192:193], v58 offset:0
    v_mfma_f32_16x16x32_bf16 v[172:175], v[204:207], v[140:143], v[172:175]
    ds_read_b64_tr_b16 v[194:195], v56 offset:2560
    ds_read_b64_tr_b16 v[196:197], v59 offset:0
    v_mfma_f32_16x16x32_bf16 v[160:163], v[208:211], v[136:139], v[160:163]
    ds_read_b64_tr_b16 v[198:199], v57 offset:2560
    s_cmp_eq_u32 s63, 0
    v_mfma_f32_16x16x32_bf16 v[176:179], v[208:211], v[140:143], v[176:179]
    s_cbranch_scc1 K_SP15
K_SPR15:
    s_ff1_i32_b32 s33, s63
    v_mfma_f32_16x16x32_bf16 v[164:167], v[212:215], v[136:139], v[164:167]
    s_bitset0_b32 s63, s33
    s_lshl_b32 s78, s33, 10
    v_mfma_f32_16x16x32_bf16 v[180:183], v[212:215], v[140:143], v[180:183]
    buffer_load_dwordx4 v[128:131], v25, s[20:23], s78 offen offset:0 sc1
    buffer_load_dwordx4 v[132:135], v26, s[20:23], s78 offen offset:0 sc1
    s_waitcnt vmcnt(8) lgkmcnt(8)
    v_mfma_f32_16x16x32_bf16 v[152:155], v[216:219], v[144:147], v[152:155]
    v_mad_u32_u24 v56, s76, 5, v24
    v_xor_b32 v58, 64, v56
    v_xor_b32 v57, 32, v56
    v_mfma_f32_16x16x32_bf16 v[168:171], v[216:219], v[148:151], v[168:171]
    v_xor_b32 v59, 96, v56
    ds_read_b64_tr_b16 v[200:201], v56 offset:0
    ds_read_b64_tr_b16 v[202:203], v58 offset:2560
    v_mfma_f32_16x16x32_bf16 v[156:159], v[220:223], v[144:147], v[156:159]
    ds_read_b64_tr_b16 v[204:205], v57 offset:0
    ds_read_b64_tr_b16 v[206:207], v59 offset:2560
    ds_read_b64_tr_b16 v[208:209], v58 offset:0
    v_mfma_f32_16x16x32_bf16 v[172:175], v[220:223], v[148:151], v[172:175]
    ds_read_b64_tr_b16 v[210:211], v56 offset:2560
    ds_read_b64_tr_b16 v[212:213], v59 offset:0
    v_mfma_f32_16x16x32_bf16 v[160:163], v[224:227], v[144:147], v[160:163]
    ds_read_b64_tr_b16 v[214:215], v57 offset:2560
    s_cmp_eq_u32 s63, 0
    v_mfma_f32_16x16x32_bf16 v[176:179], v[224:227], v[148:151], v[176:179]
    s_cbranch_scc1 K_SP16
K_SPR16:
    s_ff1_i32_b32 s33, s63
    v_mfma_f32_16x16x32_bf16 v[164:167], v[228:231], v[144:147], v[164:167]
    s_bitset0_b32 s63, s33
    s_lshl_b32 s75, s33, 10
    v_mfma_f32_16x16x32_bf16 v[180:183], v[228:231], v[148:151], v[180:183]
    buffer_load_dwordx4 v[136:139], v25, s[20:23], s75 offen offset:0 sc1
    buffer_load_dwordx4 v[140:143], v26, s[20:23], s75 offen offset:0 sc1
    s_waitcnt vmcnt(8) lgkmcnt(8)
    v_mfma_f32_16x16x32_bf16 v[152:155], v[184:187], v[104:107], v[152:155]
    v_mad_u32_u24 v56, s77, 5, v24
    v_xor_b32 v58, 64, v56
    v_xor_b32 v57, 32, v56
    v_mfma_f32_16x16x32_bf16 v[168:171], v[184:187], v[108:111], v[168:171]
    v_xor_b32 v59, 96, v56
    ds_read_b64_tr_b16 v[216:217], v56 offset:0
    ds_read_b64_tr_b16 v[218:219], v58 offset:2560
    v_mfma_f32_16x16x32_bf16 v[156:159], v[188:191], v[104:107], v[156:159]
    ds_read_b64_tr_b16 v[220:221], v57 offset:0
    ds_read_b64_tr_b16 v[222:223], v59 offset:2560
    ds_read_b64_tr_b16 v[224:225], v58 offset:0
    v_mfma_f32_16x16x32_bf16 v[172:175], v[188:191], v[108:111], v[172:175]
    ds_read_b64_tr_b16 v[226:227], v56 offset:2560
    ds_read_b64_tr_b16 v[228:229], v59 offset:0
    v_mfma_f32_16x16x32_bf16 v[160:163], v[192:195], v[104:107], v[160:163]
    ds_read_b64_tr_b16 v[230:231], v57 offset:2560
    s_andn2_b32 s33, s66, s63
    v_mfma_f32_16x16x32_bf16 v[176:179], v[192:195], v[108:111], v[176:179]
    s_bfe_u32 s33, s33, 0x40008
    s_cmp_eq_u32 s33, 15
    v_mfma_f32_16x16x32_bf16 v[164:167], v[196:199], v[104:107], v[164:167]
    s_cselect_b32 s76, 0, 1024
    s_xor_b32 s69, s76, 1024
    v_mfma_f32_16x16x32_bf16 v[180:183], v[196:199], v[108:111], v[180:183]
    buffer_load_dwordx4 v[144:147], v35, s[20:23], s76 offen offset:2048 sc1
    buffer_load_dwordx4 v[148:151], v36, s[20:23], s76 offen offset:2048 sc1
    s_waitcnt vmcnt(8) lgkmcnt(8)
    v_mfma_f32_16x16x32_bf16 v[152:155], v[200:203], v[112:115], v[152:155]
    v_mad_u32_u24 v56, s78, 5, v24
    v_xor_b32 v58, 64, v56
    v_xor_b32 v57, 32, v56
    v_mfma_f32_16x16x32_bf16 v[168:171], v[200:203], v[116:119], v[168:171]
    v_xor_b32 v59, 96, v56
    ds_read_b64_tr_b16 v[184:185], v56 offset:0
    ds_read_b64_tr_b16 v[186:187], v58 offset:2560
    v_mfma_f32_16x16x32_bf16 v[156:159], v[204:207], v[112:115], v[156:159]
    ds_read_b64_tr_b16 v[188:189], v57 offset:0
    ds_read_b64_tr_b16 v[190:191], v59 offset:2560
    ds_read_b64_tr_b16 v[192:193], v58 offset:0
    v_mfma_f32_16x16x32_bf16 v[172:175], v[204:207], v[116:119], v[172:175]
    ds_read_b64_tr_b16 v[194:195], v56 offset:2560
    ds_read_b64_tr_b16 v[196:197], v59 offset:0
    v_mfma_f32_16x16x32_bf16 v[160:163], v[208:211], v[112:115], v[160:163]
    ds_read_b64_tr_b16 v[198:199], v57 offset:2560
    s_cmp_eq_u32 s63, 0
    v_mfma_f32_16x16x32_bf16 v[176:179], v[208:211], v[116:119], v[176:179]
    s_cbranch_scc1 K_SP18
K_SPR18:
    s_ff1_i32_b32 s33, s63
    v_mfma_f32_16x16x32_bf16 v[164:167], v[212:215], v[112:115], v[164:167]
    s_bitset0_b32 s63, s33
    s_lshl_b32 s77, s33, 10
    v_mfma_f32_16x16x32_bf16 v[180:183], v[212:215], v[116:119], v[180:183]
    buffer_load_dwordx4 v[104:107], v25, s[20:23], s77 offen offset:0 sc1
    buffer_load_dwordx4 v[108:111], v26, s[20:23], s77 offen offset:0 sc1
    s_waitcnt vmcnt(8) lgkmcnt(8)
    v_mfma_f32_16x16x32_bf16 v[152:155], v[216:219], v[120:123], v[152:155]
    v_mad_u32_u24 v56, s75, 5, v24
    v_xor_b32 v58, 64, v56
    v_mfma_f32_16x16x32_bf16 v[168:171], v[216:219], v[124:127], v[168:171]
    v_xor_b32 v57, 32, v56
    v_xor_b32 v59, 96, v56
    v_mfma_f32_16x16x32_bf16 v[156:159], v[220:223], v[120:123], v[156:159]
    ds_read_b64_tr_b16 v[200:201], v56 offset:0
    ds_read_b64_tr_b16 v[202:203], v58 offset:2560
    v_mfma_f32_16x16x32_bf16 v[172:175], v[220:223], v[124:127], v[172:175]
    ds_read_b64_tr_b16 v[204:205], v57 offset:0
    ds_read_b64_tr_b16 v[206:207], v59 offset:2560
    v_mfma_f32_16x16x32_bf16 v[160:163], v[224:227], v[120:123], v[160:163]
    ds_read_b64_tr_b16 v[208:209], v58 offset:0
    ds_read_b64_tr_b16 v[210:211], v56 offset:2560
    v_mfma_f32_16x16x32_bf16 v[176:179], v[224:227], v[124:127], v[176:179]
    ds_read_b64_tr_b16 v[212:213], v59 offset:0
    ds_read_b64_tr_b16 v[214:215], v57 offset:2560
    v_mfma_f32_16x16x32_bf16 v[164:167], v[228:231], v[120:123], v[164:167]
    buffer_load_dwordx4 v[112:115], v35, s[20:23], s69 offen offset:2048 sc1
    buffer_load_dwordx4 v[116:119], v36, s[20:23], s69 offen offset:2048 sc1
    v_mfma_f32_16x16x32_bf16 v[180:183], v[228:231], v[124:127], v[180:183]
    s_waitcnt vmcnt(8) lgkmcnt(8)
    v_mfma_f32_16x16x32_bf16 v[152:155], v[184:187], v[128:131], v[152:155]
    v_mad_u32_u24 v56, s76, 20, v60
    v_xor_b32 v58, 64, v56
    v_mfma_f32_16x16x32_bf16 v[168:171], v[184:187], v[132:135], v[168:171]
    v_xor_b32 v57, 32, v56
    v_xor_b32 v59, 96, v56
    v_mfma_f32_16x16x32_bf16 v[156:159], v[188:191], v[128:131], v[156:159]
    ds_read_b64_tr_b16 v[216:217], v56 offset:40960
    ds_read_b64_tr_b16 v[218:219], v58 offset:43520
    v_mfma_f32_16x16x32_bf16 v[172:175], v[188:191], v[132:135], v[172:175]
    ds_read_b64_tr_b16 v[220:221], v57 offset:40960
    ds_read_b64_tr_b16 v[222:223], v59 offset:43520
    v_mfma_f32_16x16x32_bf16 v[160:163], v[192:195], v[128:131], v[160:163]
    ds_read_b64_tr_b16 v[224:225], v58 offset:40960
    ds_read_b64_tr_b16 v[226:227], v56 offset:43520
    v_mfma_f32_16x16x32_bf16 v[176:179], v[192:195], v[132:135], v[176:179]
    ds_read_b64_tr_b16 v[228:229], v59 offset:40960
    ds_read_b64_tr_b16 v[230:231], v57 offset:43520
    v_mfma_f32_16x16x32_bf16 v[164:167], v[196:199], v[128:131], v[164:167]
    v_mfma_f32_16x16x32_bf16 v[180:183], v[196:199], v[132:135], v[180:183]
    s_waitcnt vmcnt(6) lgkmcnt(8)
    v_mfma_f32_16x16x32_bf16 v[152:155], v[200:203], v[136:139], v[152:155]
    v_mad_u32_u24 v56, s77, 5, v24
    v_xor_b32 v58, 64, v56
    v_mfma_f32_16x16x32_bf16 v[168:171], v[200:203], v[140:143], v[168:171]
    v_xor_b32 v57, 32, v56
    v_xor_b32 v59, 96, v56
    v_mfma_f32_16x16x32_bf16 v[156:159], v[204:207], v[136:139], v[156:159]
    ds_read_b64_tr_b16 v[184:185], v56 offset:0
    ds_read_b64_tr_b16 v[186:187], v58 offset:2560
    v_mfma_f32_16x16x32_bf16 v[172:175], v[204:207], v[140:143], v[172:175]
    ds_read_b64_tr_b16 v[188:189], v57 offset:0
    ds_read_b64_tr_b16 v[190:191], v59 offset:2560
    v_mfma_f32_16x16x32_bf16 v[160:163], v[208:211], v[136:139], v[160:163]
    ds_read_b64_tr_b16 v[192:193], v58 offset:0
    ds_read_b64_tr_b16 v[194:195], v56 offset:2560
    v_mfma_f32_16x16x32_bf16 v[176:179], v[208:211], v[140:143], v[176:179]
    ds_read_b64_tr_b16 v[196:197], v59 offset:0
    ds_read_b64_tr_b16 v[198:199], v57 offset:2560
    v_mfma_f32_16x16x32_bf16 v[164:167], v[212:215], v[136:139], v[164:167]
    v_mfma_f32_16x16x32_bf16 v[180:183], v[212:215], v[140:143], v[180:183]
    s_waitcnt vmcnt(4) lgkmcnt(8)
    v_mfma_f32_16x16x32_bf16 v[152:155], v[216:219], v[144:147], v[152:155]
    v_mad_u32_u24 v56, s69, 20, v60
    v_xor_b32 v58, 64, v56
    v_mfma_f32_16x16x32_bf16 v[168:171], v[216:219], v[148:151], v[168:171]
    v_xor_b32 v57, 32, v56
    v_xor_b32 v59, 96, v56
    v_mfma_f32_16x16x32_bf16 v[156:159], v[220:223], v[144:147], v[156:159]
    ds_read_b64_tr_b16 v[200:201], v56 offset:40960
    ds_read_b64_tr_b16 v[202:203], v58 offset:43520
    v_mfma_f32_16x16x32_bf16 v[172:175], v[220:223], v[148:151], v[172:175]
    ds_read_b64_tr_b16 v[204:205], v57 offset:40960
    ds_read_b64_tr_b16 v[206:207], v59 offset:43520
    v_mfma_f32_16x16x32_bf16 v[160:163], v[224:227], v[144:147], v[160:163]
    ds_read_b64_tr_b16 v[208:209], v58 offset:40960
    ds_read_b64_tr_b16 v[210:211], v56 offset:43520
    v_mfma_f32_16x16x32_bf16 v[176:179], v[224:227], v[148:151], v[176:179]
    ds_read_b64_tr_b16 v[212:213], v59 offset:40960
    ds_read_b64_tr_b16 v[214:215], v57 offset:43520
    v_mfma_f32_16x16x32_bf16 v[164:167], v[228:231], v[144:147], v[164:167]
    v_mfma_f32_16x16x32_bf16 v[180:183], v[228:231], v[148:151], v[180:183]
    s_waitcnt vmcnt(2) lgkmcnt(8)
    v_mfma_f32_16x16x32_bf16 v[152:155], v[184:187], v[104:107], v[152:155]
    v_mfma_f32_16x16x32_bf16 v[156:159], v[188:191], v[104:107], v[156:159]
    v_mfma_f32_16x16x32_bf16 v[160:163], v[192:195], v[104:107], v[160:163]
    v_mfma_f32_16x16x32_bf16 v[164:167], v[196:199], v[104:107], v[164:167]
    s_sub_u32 s59, s56, s58
    s_cmp_lt_u32 s59, 32
    s_cbranch_scc1 K_YROW0
K_NOY0:
    s_sub_u32 s59, s57, s58
    s_cmp_lt_u32 s59, 32
    s_cbranch_scc1 K_YROW1
K_NOY1:
    s_waitcnt vmcnt(0) lgkmcnt(0)
    v_mfma_f32_16x16x32_bf16 v[152:155], v[200:203], v[112:115], v[152:155]
    v_mfma_f32_16x16x32_bf16 v[156:159], v[204:207], v[112:115], v[156:159]
    v_mfma_f32_16x16x32_bf16 v[160:163], v[208:211], v[112:115], v[160:163]
    v_mfma_f32_16x16x32_bf16 v[164:167], v[212:215], v[112:115], v[164:167]
    v_mfma_f32_16x16x32_bf16 v[168:171], v[184:187], v[108:111], v[168:171]
    v_mfma_f32_16x16x32_bf16 v[172:175], v[188:191], v[108:111], v[172:175]
    v_mfma_f32_16x16x32_bf16 v[176:179], v[192:195], v[108:111], v[176:179]
    s_nop 1
    v_fma_f32 v152, v152, v64, v72
    v_fma_f32 v153, v153, v64, v73
    v_fma_f32 v154, v154, v64, v74
    v_mfma_f32_16x16x32_bf16 v[180:183], v[196:199], v[108:111], v[180:183]
    v_fma_f32 v155, v155, v64, v75
    v_cvt_pk_bf16_f32 v40, v152, v153
    v_cvt_pk_bf16_f32 v41, v154, v155
    v_mfma_f32_16x16x32_bf16 v[168:171], v[200:203], v[116:119], v[168:171]
    v_fma_f32 v156, v156, v64, v76
    v_fma_f32 v157, v157, v64, v77
    ds_write_b64 v29, v[40:41] offset:0
    v_mfma_f32_16x16x32_bf16 v[172:175], v[204:207], v[116:119], v[172:175]
    v_fma_f32 v158, v158, v64, v78
    v_fma_f32 v159, v159, v64, v79
    v_cvt_pk_bf16_f32 v42, v156, v157
    v_mfma_f32_16x16x32_bf16 v[176:179], v[208:211], v[116:119], v[176:179]
    v_cvt_pk_bf16_f32 v43, v158, v159
    v_fma_f32 v160, v160, v64, v80
    v_fma_f32 v161, v161, v64, v81
    v_mfma_f32_16x16x32_bf16 v[180:183], v[212:215], v[116:119], v[180:183]
    ds_write_b64 v30, v[42:43] offset:0
    v_fma_f32 v162, v162, v64, v82
    v_fma_f32 v163, v163, v64, v83
    v_cvt_pk_bf16_f32 v44, v160, v161
    v_cvt_pk_bf16_f32 v45, v162, v163
    v_pk_fma_f32 v[164:165], v[164:165], v[64:65], v[84:85] op_sel_hi:[1,0,1]
    v_pk_fma_f32 v[166:167], v[166:167], v[64:65], v[86:87] op_sel_hi:[1,0,1]
    ds_write_b64 v31, v[44:45] offset:0
    v_cvt_pk_bf16_f32 v46, v164, v165
    v_cvt_pk_bf16_f32 v47, v166, v167
    ds_write_b64 v32, v[46:47] offset:0
    ds_read_b128 v[72:75], v33 offset:0
    ds_read_b128 v[76:79], v33 offset:1024
    v_pk_fma_f32 v[168:169], v[168:169], v[66:67], v[88:89] op_sel_hi:[1,0,1]
    v_pk_fma_f32 v[170:171], v[170:171], v[66:67], v[90:91] op_sel_hi:[1,0,1]
    v_cvt_pk_bf16_f32 v48, v168, v169
    v_cvt_pk_bf16_f32 v49, v170, v171
    v_pk_fma_f32 v[172:173], v[172:173], v[66:67], v[92:93] op_sel_hi:[1,0,1]
    v_pk_fma_f32 v[174:175], v[174:175], v[66:67], v[94:95] op_sel_hi:[1,0,1]
    v_cvt_pk_bf16_f32 v50, v172, v173
    v_cvt_pk_bf16_f32 v51, v174, v175
    v_pk_fma_f32 v[176:177], v[176:177], v[66:67], v[96:97] op_sel_hi:[1,0,1]
    v_pk_fma_f32 v[178:179], v[178:179], v[66:67], v[98:99] op_sel_hi:[1,0,1]
    v_cvt_pk_bf16_f32 v52, v176, v177
    v_cvt_pk_bf16_f32 v53, v178, v179
    v_pk_fma_f32 v[180:181], v[180:181], v[66:67], v[100:101] op_sel_hi:[1,0,1]
    v_pk_fma_f32 v[182:183], v[182:183], v[66:67], v[102:103] op_sel_hi:[1,0,1]
    v_cvt_pk_bf16_f32 v54, v180, v181
    v_cvt_pk_bf16_f32 v55, v182, v183
    s_waitcnt lgkmcnt(0)
    buffer_store_dwordx4 v[72:75], v27, s[48:51], s71 offen sc1
    buffer_store_dwordx4 v[76:79], v28, s[48:51], s72 offen sc1
    ds_write_b64 v29, v[48:49] offset:2048
    ds_write_b64 v30, v[50:51] offset:2048
    ds_write_b64 v31, v[52:53] offset:2048
    ds_write_b64 v32, v[54:55] offset:2048
    ds_read_b128 v[88:91], v33 offset:2048
    ds_read_b128 v[92:95], v33 offset:3072
    s_waitcnt lgkmcnt(1)
    buffer_store_dwordx4 v[88:91], v27, s[48:51], s73 offen sc1
    s_waitcnt lgkmcnt(0)
    buffer_store_dwordx4 v[92:95], v28, s[48:51], s74 offen sc1
K_END:
K_EXIT:
    s_endpgm
.p2align 12
WP_spin:
    s_setpc_b64 s[38:39]
K_SP0:
    ds_read_b32 v2, v12 offset:32
    s_waitcnt lgkmcnt(0)
    v_readfirstlane_b32 s33, v2
    s_nop 3
    s_lshr_b32 s63, s33, s64
    s_lshr_b32 s33, s33, s65
    s_and_b32 s63, s63, s33
    s_and_b32 s63, s63, 0xff
    s_andn2_b32 s63, s63, s66
    s_cbranch_scc0 K_SP0
    s_or_b32 s66, s66, s63
    s_branch K_SPR0
K_SP1:
    ds_read_b32 v2, v12 offset:32
    s_waitcnt lgkmcnt(0)
    v_readfirstlane_b32 s33, v2
    s_nop 3
    s_lshr_b32 s63, s33, s64
    s_lshr_b32 s33, s33, s65
    s_and_b32 s63, s63, s33
    s_and_b32 s63, s63, 0xff
    s_andn2_b32 s63, s63, s66
    s_cbranch_scc0 K_SP1
    s_or_b32 s66, s66, s63
    s_branch K_SPR1
K_SP2:
    ds_read_b32 v2, v12 offset:32
    s_waitcnt lgkmcnt(0)
    v_readfirstlane_b32 s33, v2
    s_nop 3
    s_lshr_b32 s63, s33, s64
    s_lshr_b32 s33, s33, s65
    s_and_b32 s63, s63, s33
    s_and_b32 s63, s63, 0xff
    s_andn2_b32 s63, s63, s66
    s_cbranch_scc0 K_SP2
    s_or_b32 s66, s66, s63
    s_branch K_SPR2
K_SP3:
    ds_read_b32 v2, v12 offset:32
    s_waitcnt lgkmcnt(0)
    v_readfirstlane_b32 s33, v2
    s_nop 3
    s_lshr_b32 s63, s33, s64
    s_lshr_b32 s33, s33, s65
    s_and_b32 s63, s63, s33
    s_and_b32 s63, s63, 0xff
    s_andn2_b32 s63, s63, s66
    s_cbranch_scc0 K_SP3
    s_or_b32 s66, s66, s63
    s_branch K_SPR3
K_SP4:
    ds_read_b32 v2, v12 offset:32
    s_waitcnt lgkmcnt(0)
    v_readfirstlane_b32 s33, v2
    s_nop 3
    s_lshr_b32 s63, s33, s64
    s_lshr_b32 s33, s33, s65
    s_and_b32 s63, s63, s33
    s_and_b32 s63, s63, 0xff
    s_andn2_b32 s63, s63, s66
    s_cbranch_scc0 K_SP4
    s_or_b32 s66, s66, s63
    s_branch K_SPR4
K_SP5:
    ds_read_b32 v2, v12 offset:32
    s_waitcnt lgkmcnt(0)
    v_readfirstlane_b32 s33, v2
    s_nop 3
    s_lshr_b32 s63, s33, s64
    s_lshr_b32 s33, s33, s65
    s_and_b32 s63, s63, s33
    s_and_b32 s63, s63, 0xff
    s_andn2_b32 s63, s63, s66
    s_cbranch_scc0 K_SP5
    s_or_b32 s66, s66, s63
    s_branch K_SPR5
K_SP6:
    ds_read_b32 v2, v12 offset:32
    s_waitcnt lgkmcnt(0)
    v_readfirstlane_b32 s33, v2
    s_nop 3
    s_lshr_b32 s63, s33, s64
    s_lshr_b32 s33, s33, s65
    s_and_b32 s63, s63, s33
    s_and_b32 s63, s63, 0xff
    s_andn2_b32 s63, s63, s66
    s_cbranch_scc0 K_SP6
    s_or_b32 s66, s66, s63
    s_branch K_SPR6
K_SP8:
    ds_read_b32 v2, v12 offset:32
    s_waitcnt lgkmcnt(0)
    v_readfirstlane_b32 s33, v2
    s_nop 3
    s_lshr_b32 s63, s33, s64
    s_lshr_b32 s33, s33, s65
    s_and_b32 s63, s63, s33
    s_and_b32 s63, s63, 0xff
    s_andn2_b32 s63, s63, s66
    s_cbranch_scc0 K_SP8
    s_or_b32 s66, s66, s63
    s_branch K_SPR8
K_SP10:
    ds_read_b32 v2, v12 offset:32
    s_waitcnt lgkmcnt(0)
    v_readfirstlane_b32 s33, v2
    s_nop 3
    s_lshr_b32 s63, s33, s64
    s_lshr_b32 s33, s33, s65
    s_and_b32 s63, s63, s33
    s_and_b32 s63, s63, 0xff00
    s_andn2_b32 s63, s63, s66
    s_cbranch_scc0 K_SP10
    s_or_b32 s66, s66, s63
    s_branch K_SPR10
K_SP11:
    ds_read_b32 v2, v12 offset:32
    s_waitcnt lgkmcnt(0)
    v_readfirstlane_b32 s33, v2
    s_nop 3
    s_lshr_b32 s63, s33, s64
    s_lshr_b32 s33, s33, s65
    s_and_b32 s63, s63, s33
    s_and_b32 s63, s63, 0xff00
    s_andn2_b32 s63, s63, s66
    s_cbranch_scc0 K_SP11
    s_or_b32 s66, s66, s63
    s_branch K_SPR11
K_SP12:
    ds_read_b32 v2, v12 offset:32
    s_waitcnt lgkmcnt(0)
    v_readfirstlane_b32 s33, v2
    s_nop 3
    s_lshr_b32 s63, s33, s64
    s_lshr_b32 s33, s33, s65
    s_and_b32 s63, s63, s33
    s_and_b32 s63, s63, 0xff00
    s_andn2_b32 s63, s63, s66
    s_cbranch_scc0 K_SP12
    s_or_b32 s66, s66, s63
    s_branch K_SPR12
K_SP13:
    ds_read_b32 v2, v12 offset:32
    s_waitcnt lgkmcnt(0)
    v_readfirstlane_b32 s33, v2
    s_nop 3
    s_lshr_b32 s63, s33, s64
    s_lshr_b32 s33, s33, s65
    s_and_b32 s63, s63, s33
    s_and_b32 s63, s63, 0xff00
    s_andn2_b32 s63, s63, s66
    s_cbranch_scc0 K_SP13
    s_or_b32 s66, s66, s63
    s_branch K_SPR13
K_SP14:
    ds_read_b32 v2, v12 offset:32
    s_waitcnt lgkmcnt(0)
    v_readfirstlane_b32 s33, v2
    s_nop 3
    s_lshr_b32 s63, s33, s64
    s_lshr_b32 s33, s33, s65
    s_and_b32 s63, s63, s33
    s_and_b32 s63, s63, 0xff00
    s_andn2_b32 s63, s63, s66
    s_cbranch_scc0 K_SP14
    s_or_b32 s66, s66, s63
    s_branch K_SPR14
K_SP15:
    ds_read_b32 v2, v12 offset:32
    s_waitcnt lgkmcnt(0)
    v_readfirstlane_b32 s33, v2
    s_nop 3
    s_lshr_b32 s63, s33, s64
    s_lshr_b32 s33, s33, s65
    s_and_b32 s63, s63, s33
    s_and_b32 s63, s63, 0xff00
    s_andn2_b32 s63, s63, s66
    s_cbranch_scc0 K_SP15
    s_or_b32 s66, s66, s63
    s_branch K_SPR15
K_SP16:
    ds_read_b32 v2, v12 offset:32
    s_waitcnt lgkmcnt(0)
    v_readfirstlane_b32 s33, v2
    s_nop 3
    s_lshr_b32 s63, s33, s64
    s_lshr_b32 s33, s33, s65
    s_and_b32 s63, s63, s33
    s_and_b32 s63, s63, 0xff00
    s_andn2_b32 s63, s63, s66
    s_cbranch_scc0 K_SP16
    s_or_b32 s66, s66, s63
    s_branch K_SPR16
K_SP18:
    ds_read_b32 v2, v12 offset:32
    s_waitcnt lgkmcnt(0)
    v_readfirstlane_b32 s33, v2
    s_nop 3
    s_lshr_b32 s63, s33, s64
    s_lshr_b32 s33, s33, s65
    s_and_b32 s63, s63, s33
    s_and_b32 s63, s63, 0xff00
    s_andn2_b32 s63, s63, s66
    s_cbranch_scc0 K_SP18
    s_or_b32 s66, s66, s63
    s_branch K_SPR18
WP_yr0:
    s_setpc_b64 s[38:39]
K_YROW0:
    v_lshlrev_b32 v5, 4, v9
    v_add_u32 v5, 158976, v5
    v_and_b32 v3, 15, v1
    s_and_b32 s33, s59, 15
    v_cmp_eq_u32 vcc, s33, v3
    s_mov_b32 s3, 1048576
K_P2_GY0:
    ds_read_b32 v2, v12 offset:64
    s_sub_u32 s3, s3, 1
    s_waitcnt lgkmcnt(0)
    v_readfirstlane_b32 s33, v2
    s_nop 3
    s_cselect_b32 s33, 1, s33
    s_cmp_lt_u32 s33, 1
    s_cbranch_scc1 K_P2_GY0
    s_mov_b64 exec, vcc
    s_cmp_ge_u32 s59, 16
    s_cbranch_scc1 K_YR1_0
    ds_read_b128 v[72:75], v5 offset:0
    ds_read_b128 v[76:79], v5 offset:64
    ds_read_b128 v[80:83], v5 offset:128
    ds_read_b128 v[84:87], v5 offset:192
    s_mov_b64 exec, -1
    s_branch K_NOY0
K_YR1_0:
    ds_read_b128 v[88:91], v5 offset:0
    ds_read_b128 v[92:95], v5 offset:64
    ds_read_b128 v[96:99], v5 offset:128
    ds_read_b128 v[100:103], v5 offset:192
    s_mov_b64 exec, -1
    s_branch K_NOY0
K_YROW1:
    v_lshlrev_b32 v5, 4, v9
    v_add_u32 v5, 159232, v5
    v_and_b32 v3, 15, v1
    s_and_b32 s33, s59, 15
    v_cmp_eq_u32 vcc, s33, v3
    s_mov_b32 s3, 1048576
K_P2_GY1:
    ds_read_b32 v2, v12 offset:68
    s_sub_u32 s3, s3, 1
    s_waitcnt lgkmcnt(0)
    v_readfirstlane_b32 s33, v2
    s_nop 3
    s_cselect_b32 s33, 1, s33
    s_cmp_lt_u32 s33, 1
    s_cbranch_scc1 K_P2_GY1
    s_mov_b64 exec, vcc
    s_cmp_ge_u32 s59, 16
    s_cbranch_scc1 K_YR1_1
    ds_read_b128 v[72:75], v5 offset:0
    ds_read_b128 v[76:79], v5 offset:64
    ds_read_b128 v[80:83], v5 offset:128
    ds_read_b128 v[84:87], v5 offset:192
    s_mov_b64 exec, -1
    s_branch K_NOY1
K_YR1_1:
    ds_read_b128 v[88:91], v5 offset:0
    ds_read_b128 v[92:95], v5 offset:64
    ds_read_b128 v[96:99], v5 offset:128
    ds_read_b128 v[100:103], v5 offset:192
    s_mov_b64 exec, -1
    s_branch K_NOY1
.p2align 12
WP_gen:
    s_setpc_b64 s[38:39]
K_P2:
    s_cmp_ge_u32 s30, 4
    s_cbranch_scc1 K_P2_HELP
    v_mov_b32 v12, 158720
    s_cmp_lg_u32 s30, 0
    s_cbranch_scc1 K_P2_W13
    v_lshrrev_b32 v3, 4, v1
    v_and_b32 v4, 7, v1
    v_lshrrev_b32 v2, 3, v1
    v_xor_b32 v4, v4, v3
    v_mul_u32_u24 v2, 1280, v2
    v_lshl_add_u32 v27, v4, 4, v2
    v_xor_b32 v28, 64, v27
    s_mov_b32 s58, 0
K_P2_XD:
    s_lshl_b32 s59, s40, 3
    s_lshl1_add_u32 s59, s58, s59
    s_mul_i32 s59, s59, 20480
    s_lshl_b32 s33, s41, 7
    s_add_u32 s59, s59, s33
    s_lshl_b32 s33, s58, 12
    s_add_u32 m0, s33, 140288
    s_add_u32 s3, s59, 0
    buffer_load_dwordx4 v27, s[12:15], s3 offen lds
    s_add_u32 m0, s33, 141312
    s_add_u32 s3, s59, 10240
    buffer_load_dwordx4 v28, s[12:15], s3 offen lds
    s_add_u32 m0, s33, 142336
    s_add_u32 s3, s59, 20480
    buffer_load_dwordx4 v27, s[12:15], s3 offen lds
    s_add_u32 m0, s33, 143360
    s_add_u32 s3, s59, 30720
    buffer_load_dwordx4 v28, s[12:15], s3 offen lds
    s_add_u32 s58, s58, 1
    s_cmp_lt_u32 s58, 4
    s_cbranch_scc1 K_P2_XD
    s_waitcnt vmcnt(0)
    s_branch K_P2_AUXW
K_P2_W13:
    v_lshrrev_b32 v2, 3, v1
    v_mul_u32_u24 v2, 1280, v2
    v_lshrrev_b32 v3, 4, v1
    v_lshlrev_b32 v3, 1, v3
    v_and_b32 v4, 7, v1
    v_xor_b32 v3, v3, v4
    v_lshl_add_u32 v2, v3, 4, v2
    s_lshl_b32 s33, s41, 7
    v_add_u32 v22, s33, v2
    s_mov_b32 s60, 0xfda87520
    s_mov_b32 s61, 0xecb96431
    s_sub_u32 s58, s30, 1
K_P2_WS:
    s_lshl_b32 s3, s58, 2
    s_lshr_b64 s[4:5], s[60:61], s3
    s_and_b32 s4, s4, 15
    s_mul_i32 s4, s4, 51200
    s_mul_i32 s59, s58, 5120
    s_add_u32 s52, s4, 0
    s_add_u32 m0, s59, 0
    s_waitcnt vmcnt(11)
    buffer_load_dwordx4 v22, s[24:27], s52 offen lds
    s_add_u32 s52, s4, 10240
    s_add_u32 m0, s59, 1024
    s_waitcnt vmcnt(11)
    buffer_load_dwordx4 v22, s[24:27], s52 offen lds
    s_add_u32 s52, s4, 20480
    s_add_u32 m0, s59, 2048
    s_waitcnt vmcnt(11)
    buffer_load_dwordx4 v22, s[24:27], s52 offen lds
    s_add_u32 s52, s4, 30720
    s_add_u32 m0, s59, 3072
    s_waitcnt vmcnt(11)
    buffer_load_dwordx4 v22, s[24:27], s52 offen lds
    s_add_u32 s52, s4, 40960
    s_add_u32 m0, s59, 4096
    s_waitcnt vmcnt(11)
    buffer_load_dwordx4 v22, s[24:27], s52 offen lds
    s_cmp_ge_u32 s58, 3
    s_cbranch_scc1 K_P2_WS1
    v_mov_b32 v3, 1
    s_waitcnt vmcnt(5)
    s_mov_b64 exec, 1
    ds_add_u32 v12, v3 offset:52
    s_mov_b64 exec, -1
K_P2_WS1:
    s_add_u32 s58, s58, 3
    s_cmp_lt_u32 s58, 16
    s_cbranch_scc1 K_P2_WS
K_P2_AUXW:
    v_mov_b32 v34, 1
    s_waitcnt vmcnt(10)
    s_mov_b64 exec, 1
    ds_add_u32 v12, v34 offset:72
    s_mov_b64 exec, -1
    s_lshl_b32 s54, s40, 7
    v_lshrrev_b32 v9, 4, v1
    v_mov_b32 v12, 158720
    s_add_u32 s20, s10, 0x100000
    s_addc_u32 s21, s11, 0
    s_mov_b32 s22, 0x280000
    s_mov_b32 s23, 0x20000
    s_add_u32 s16, s10, 0x1000
    s_addc_u32 s17, s11, 0
    s_mov_b32 s18, 0x2000
    s_mov_b32 s19, 0x20000
    s_mov_b32 s48, s6
    s_mov_b32 s49, s7
    s_mov_b32 s50, 0x280000
    s_mov_b32 s51, 0x20000
    s_lshl_b32 s53, s40, 3
    s_lshl1_add_u32 s53, s30, s53
    s_mov_b32 s55, 20480
    v_bfe_u32 v20, v1, 2, 2
    v_and_b32 v21, 3, v1
    s_mul_i32 s3, s53, 20480
    v_lshl_add_u32 v25, v1, 4, s3
    v_add_u32 v26, 20480, v25
    v_add_u32 v35, 16384, v25
    v_add_u32 v36, 16384, v26
    v_and_b32 v2, 15, v1
    s_lshl_b32 s3, s53, 6
    v_lshl_add_u32 v23, v2, 2, s3
    v_lshl_add_u32 v2, v9, 2, v20
    v_bfe_u32 v3, v2, 1, 2
    v_lshlrev_b32 v2, 7, v2
    v_lshl_add_u32 v2, v21, 3, v2
    v_lshl_add_u32 v24, v3, 5, v2
    v_lshrrev_b32 v3, 1, v20
    v_mul_u32_u24 v2, 40, v9
    v_add3_u32 v2, v2, 16, v20
    v_lshlrev_b32 v2, 7, v2
    v_lshl_add_u32 v2, v21, 3, v2
    v_xor_b32 v4, 0, v3
    v_lshl_add_u32 v60, v4, 5, v2
    v_xor_b32 v4, 1, v3
    v_lshl_add_u32 v61, v4, 5, v2
    v_xor_b32 v4, 2, v3
    v_lshl_add_u32 v62, v4, 5, v2
    v_xor_b32 v4, 3, v3
    v_lshl_add_u32 v63, v4, 5, v2
    v_lshrrev_b32 v3, 4, v1
    v_and_b32 v4, 7, v1
    v_lshrrev_b32 v2, 3, v1
    v_xor_b32 v4, v4, v3
    v_mul_u32_u24 v2, 1280, v2
    v_lshl_add_u32 v27, v4, 4, v2
    v_xor_b32 v28, 64, v27
    s_lshl_b32 s71, s40, 3
    s_lshl1_add_u32 s71, s30, s71
    s_mul_i32 s71, s71, 20480
    s_lshl_b32 s33, s41, 7
    s_add_u32 s71, s71, s33
    s_add_u32 s72, s71, 10240
    s_add_u32 s73, s71, 20480
    s_add_u32 s74, s71, 30720
    s_lshl_b32 s3, s30, 12
    s_add_u32 s3, s3, 140288
    v_lshl_add_u32 v33, v1, 4, s3
    v_and_b32 v2, 15, v1
    v_lshrrev_b32 v3, 1, v2
    v_lshrrev_b32 v4, 5, v1
    v_xor_b32 v3, v3, v4
    v_lshlrev_b32 v3, 4, v3
    v_lshl_add_u32 v3, v2, 7, v3
    v_and_b32 v4, 1, v9
    v_lshl_add_u32 v3, v4, 3, v3
    v_add_u32 v29, s3, v3
    v_xor_b32 v30, 32, v29
    v_xor_b32 v31, 64, v29
    v_xor_b32 v32, 96, v29
    s_and_b32 s33, s40, 3
    s_lshl_b32 s33, s33, 3
    s_lshr_b32 s33, 0x7f06037f, s33
    s_and_b32 s33, s33, 0xff
    s_lshl_b32 s3, s30, 1
    s_cmp_ge_u32 s3, s33
    s_cselect_b32 s64, 16, 0
    s_add_u32 s3, s3, 1
    s_cmp_ge_u32 s3, s33
    s_cselect_b32 s65, 16, 0
    s_mov_b32 s63, 0
    s_mov_b32 s66, 0
    s_mov_b32 s67, 16384
    s_mov_b32 s3, 1048576
K_P2_GWA:
    ds_read_b32 v2, v12 offset:72
    s_sub_u32 s3, s3, 1
    s_waitcnt lgkmcnt(0)
    v_readfirstlane_b32 s33, v2
    s_nop 3
    s_cselect_b32 s33, 4, s33
    s_cmp_lt_u32 s33, 4
    s_cbranch_scc1 K_P2_GWA
    s_branch K_P2_GEMM
WP_help:
    s_setpc_b64 s[38:39]
K_LATE:
    s_sub_u32 s44, s30, 4
K_WOL:
    s_lshl_b32 s50, s44, 2
    s_lshr_b32 s50, 0x6431, s50
    s_and_b32 s50, s50, 7
    s_mul_i32 s50, s50, 51200
    s_mul_i32 s51, s44, 5120
    s_add_u32 s3, s50, 0
    s_add_u32 m0, s51, 40960
    s_waitcnt vmcnt(13)
    buffer_load_dwordx4 v18, s[24:27], s3 offen lds
    s_add_u32 s3, s50, 10240
    s_add_u32 m0, s51, 41984
    s_waitcnt vmcnt(13)
    buffer_load_dwordx4 v18, s[24:27], s3 offen lds
    s_add_u32 s3, s50, 20480
    s_add_u32 m0, s51, 43008
    s_waitcnt vmcnt(13)
    buffer_load_dwordx4 v18, s[24:27], s3 offen lds
    s_add_u32 s3, s50, 30720
    s_add_u32 m0, s51, 44032
    s_waitcnt vmcnt(13)
    buffer_load_dwordx4 v18, s[24:27], s3 offen lds
    s_add_u32 s3, s50, 40960
    s_add_u32 m0, s51, 45056
    s_waitcnt vmcnt(13)
    buffer_load_dwordx4 v18, s[24:27], s3 offen lds
    s_add_u32 s3, s50, 409600
    s_add_u32 m0, s51, 61440
    s_waitcnt vmcnt(13)
    buffer_load_dwordx4 v18, s[24:27], s3 offen lds
    s_add_u32 s3, s50, 419840
    s_add_u32 m0, s51, 62464
    s_waitcnt vmcnt(13)
    buffer_load_dwordx4 v18, s[24:27], s3 offen lds
    s_add_u32 s3, s50, 430080
    s_add_u32 m0, s51, 63488
    s_waitcnt vmcnt(13)
    buffer_load_dwordx4 v18, s[24:27], s3 offen lds
    s_add_u32 s3, s50, 440320
    s_add_u32 m0, s51, 64512
    s_waitcnt vmcnt(13)
    buffer_load_dwordx4 v18, s[24:27], s3 offen lds
    s_add_u32 s3, s50, 450560
    s_add_u32 m0, s51, 65536
    s_waitcnt vmcnt(13)
    buffer_load_dwordx4 v18, s[24:27], s3 offen lds
    s_add_u32 s44, s44, 2
    s_cmp_lt_u32 s44, 4
    s_cbranch_scc1 K_WOL
    v_mov_b32 v2, 158720
    v_mov_b32 v3, 2
    s_waitcnt vmcnt(0)
    s_mov_b64 exec, 1
    ds_add_u32 v2, v3 offset:44
    s_mov_b64 exec, -1
K_P2_HELP:
    s_setprio 3
    s_add_u32 s59, s40, 1
    s_bitcmp1_b32 s59, 1
    s_cselect_b32 s59, 31, 15
    v_and_b32 v10, s59, v1
    v_lshl_add_u32 v10, v10, 2, s42
    s_cmp_lg_u32 s30, 7
    s_cbranch_scc1 K_P2_N7
    v_and_b32 v4, 7, v1
    v_lshlrev_b32 v4, 2, v4
    s_mov_b32 s3, 131072
K_ZPOLL1:
    v_cmp_eq_u32 vcc, 0, v7
    s_cbranch_vccz K_ZOK1
    s_sub_u32 s3, s3, 1
    s_cbranch_scc1 K_ZOK1
    global_load_dword v7, v4, s[8:9] offset:192 sc1
    s_waitcnt vmcnt(0)
    s_branch K_ZPOLL1
K_ZOK1:
    global_load_dword v7, v10, s[10:11] sc1
K_P2_N7:
    s_lshl_b32 s54, s40, 7
    v_lshrrev_b32 v9, 4, v1
    v_mov_b32 v12, 158720
    s_add_u32 s44, s10, 0x10000
    s_addc_u32 s45, s11, 0
    s_mov_b32 s46, 0x43800
    s_mov_b32 s47, 0x20000
    v_mov_b32 v80, 1
    s_cmp_eq_u32 s30, 7
    s_cbranch_scc1 K_P2_FLAGS
    s_cmp_lg_u32 s30, 6
    s_cbranch_scc1 K_END
    s_mov_b32 s3, 131072
K_P2_DPOLL:
    v_cmp_eq_u32 vcc, 0, v7
    s_cbranch_vccz K_P2_DOK
    s_cmp_eq_u32 s3, 131072
    s_cbranch_scc1 K_P2_DNS
    s_sleep 12
K_P2_DNS:
    v_and_b32 v11, 1, v1
    v_lshl_add_u32 v11, v11, 2, s42
    global_load_dword v7, v11, s[10:11] offset:128 sc1
    s_sub_u32 s3, s3, 1
    s_waitcnt vmcnt(0)
    s_cmp_lg_u32 s3, 0
    s_cbranch_scc1 K_P2_DPOLL
K_P2_DOK:
    v_readlane_b32 s58, v7, 0
    v_readlane_b32 s59, v7, 1
    s_nop 3
    s_and_b32 s3, s58, 0x7ff
    s_sub_u32 s3, 2047, s3
    v_mov_b32 v20, s3
    v_mov_b32 v4, s58
    v_and_b32 v4, 0xffff0000, v4
    v_ashrrev_i32 v5, 31, v4
    v_not_b32 v5, v5
    v_or_b32 v5, 0x80000000, v5
    v_xor_b32 v4, v4, v5
    v_and_b32 v4, 0xffff0000, v4
    v_mul_f32 v5, 0xbfb8aa3b, v4
    v_exp_f32 v5, v5
    s_nop 0
    v_add_f32 v5, 1.0, v5
    v_rcp_f32 v4, v5
    s_nop 0
    v_cvt_pk_bf16_f32 v22, v4, v4
    v_lshlrev_b32 v22, 16, v22
    s_and_b32 s3, s59, 0x7ff
    s_sub_u32 s3, 2047, s3
    v_mov_b32 v21, s3
    v_mov_b32 v4, s59
    v_and_b32 v4, 0xffff0000, v4
    v_ashrrev_i32 v5, 31, v4
    v_not_b32 v5, v5
    v_or_b32 v5, 0x80000000, v5
    v_xor_b32 v4, v4, v5
    v_and_b32 v4, 0xffff0000, v4
    v_mul_f32 v5, 0xbfb8aa3b, v4
    v_exp_f32 v5, v5
    s_nop 0
    v_add_f32 v5, 1.0, v5
    v_rcp_f32 v4, v5
    s_nop 0
    v_cvt_pk_bf16_f32 v23, v4, v4
    v_lshlrev_b32 v23, 16, v23
    ds_write_b128 v12, v[20:23]
    ds_write_b32 v12, v80 offset:40
    s_mov_b32 s53, 0
    v_mov_b32 v16, v20
    v_mov_b32 v17, v21
    v_mov_b32 v18, v22
    v_mov_b32 v19, v23
K_P2_HW:
    s_cmp_eq_u32 s53, 0
    s_cselect_b64 vcc, -1, 0
    s_nop 1
    v_cndmask_b32 v2, v17, v16, vcc
    v_cndmask_b32 v5, v19, v18, vcc
    s_nop 0
    v_readfirstlane_b32 s58, v2
    s_nop 3
    s_sub_u32 s3, s58, s54
    s_cmp_lt_u32 s3, 128
    s_cbranch_scc0 K_P2_YN
    s_call_b64 s[38:39], WP_yr0
    s_mul_i32 s3, s58, 1280
    s_lshl_b32 s33, s41, 7
    s_add_u32 s3, s3, s33
    v_and_b32 v2, 15, v1
    v_lshlrev_b32 v2, 3, v2
    buffer_load_dwordx2 v[84:85], v2, s[12:15], s3 offen
    s_lshl_b32 s3, s58, 2
    s_add_u32 s3, s3, 4096
    v_mov_b32 v2, s3
    global_load_dword v88, v2, s[10:11] sc1
    s_lshl1_add_u32 s3, s41, s53
    s_lshl_b32 s3, s3, 8
    s_add_u32 s3, s3, 568320
    v_min_u32 v3, 53, v1
    v_lshl_add_u32 v3, v3, 2, s3
    s_mov_b32 s3, 131072
K_P2_YPOLL:
    global_load_dword v2, v3, s[10:11] sc1
    s_sub_u32 s3, s3, 1
    s_waitcnt vmcnt(0)
    v_cmp_ne_u32 vcc, 1, v2
    s_cbranch_vccz K_P2_YGO
    s_sleep 16
    s_cmp_lg_u32 s3, 0
    s_cbranch_scc1 K_P2_YPOLL
K_P2_YGO:
    v_and_b32 v2, 15, v1
    v_lshlrev_b32 v2, 4, v2
    v_mul_u32_u24 v4, 5120, v9
    s_mov_b32 s59, s53
    s_mul_i32 s33, s59, 2560
    s_lshl_b32 s3, s41, 8
    s_add_u32 s3, s3, s33
    v_add3_u32 v3, v2, v4, s3
    s_mov_b32 s52, 0
    buffer_load_dwordx4 v[24:27], v3, s[44:47], s52 offen sc1
    s_mov_b32 s52, 20480
    buffer_load_dwordx4 v[28:31], v3, s[44:47], s52 offen sc1
    s_mov_b32 s52, 40960
    buffer_load_dwordx4 v[32:35], v3, s[44:47], s52 offen sc1
    s_mov_b32 s52, 61440
    buffer_load_dwordx4 v[36:39], v3, s[44:47], s52 offen sc1
    s_mov_b32 s52, 81920
    buffer_load_dwordx4 v[40:43], v3, s[44:47], s52 offen sc1
    s_mov_b32 s52, 102400
    buffer_load_dwordx4 v[44:47], v3, s[44:47], s52 offen sc1
    s_mov_b32 s52, 122880
    buffer_load_dwordx4 v[48:51], v3, s[44:47], s52 offen sc1
    s_mov_b32 s52, 143360
    buffer_load_dwordx4 v[52:55], v3, s[44:47], s52 offen sc1
    s_mov_b32 s52, 163840
    buffer_load_dwordx4 v[56:59], v3, s[44:47], s52 offen sc1
    s_mov_b32 s52, 184320
    buffer_load_dwordx4 v[60:63], v3, s[44:47], s52 offen sc1
    s_mov_b32 s52, 204800
    buffer_load_dwordx4 v[64:67], v3, s[44:47], s52 offen sc1
    s_mov_b32 s52, 225280
    buffer_load_dwordx4 v[68:71], v3, s[44:47], s52 offen sc1
    s_mov_b32 s52, 245760
    buffer_load_dwordx4 v[72:75], v3, s[44:47], s52 offen sc1
    s_mov_b32 s52, 266240
    buffer_load_dwordx4 v[76:79], v3, s[44:47], s52 offen sc1
    v_sub_f32 v88, 1.0, v88
    v_cvt_pk_bf16_f32 v88, v88, v88
    v_lshlrev_b32 v88, 16, v88
    v_lshlrev_b32 v86, 16, v85
    v_and_b32 v87, 0xffff0000, v85
    v_and_b32 v85, 0xffff0000, v84
    v_lshlrev_b32 v84, 16, v84
    s_waitcnt vmcnt(12)
    v_add_f32 v20, v24, v28
    v_add_f32 v21, v25, v29
    v_add_f32 v22, v26, v30
    v_add_f32 v23, v27, v31
    s_waitcnt vmcnt(11)
    v_add_f32 v20, v20, v32
    v_add_f32 v21, v21, v33
    v_add_f32 v22, v22, v34
    v_add_f32 v23, v23, v35
    s_waitcnt vmcnt(10)
    v_add_f32 v20, v20, v36
    v_add_f32 v21, v21, v37
    v_add_f32 v22, v22, v38
    v_add_f32 v23, v23, v39
    s_waitcnt vmcnt(9)
    v_add_f32 v20, v20, v40
    v_add_f32 v21, v21, v41
    v_add_f32 v22, v22, v42
    v_add_f32 v23, v23, v43
    s_waitcnt vmcnt(8)
    v_add_f32 v20, v20, v44
    v_add_f32 v21, v21, v45
    v_add_f32 v22, v22, v46
    v_add_f32 v23, v23, v47
    s_waitcnt vmcnt(7)
    v_add_f32 v20, v20, v48
    v_add_f32 v21, v21, v49
    v_add_f32 v22, v22, v50
    v_add_f32 v23, v23, v51
    s_waitcnt vmcnt(6)
    v_add_f32 v20, v20, v52
    v_add_f32 v21, v21, v53
    v_add_f32 v22, v22, v54
    v_add_f32 v23, v23, v55
    s_waitcnt vmcnt(5)
    v_add_f32 v20, v20, v56
    v_add_f32 v21, v21, v57
    v_add_f32 v22, v22, v58
    v_add_f32 v23, v23, v59
    s_waitcnt vmcnt(4)
    v_add_f32 v20, v20, v60
    v_add_f32 v21, v21, v61
    v_add_f32 v22, v22, v62
    v_add_f32 v23, v23, v63
    s_waitcnt vmcnt(3)
    v_add_f32 v20, v20, v64
    v_add_f32 v21, v21, v65
    v_add_f32 v22, v22, v66
    v_add_f32 v23, v23, v67
    s_waitcnt vmcnt(2)
    v_add_f32 v20, v20, v68
    v_add_f32 v21, v21, v69
    v_add_f32 v22, v22, v70
    v_add_f32 v23, v23, v71
    s_waitcnt vmcnt(1)
    v_add_f32 v20, v20, v72
    v_add_f32 v21, v21, v73
    v_add_f32 v22, v22, v74
    v_add_f32 v23, v23, v75
    s_waitcnt vmcnt(0)
    v_add_f32 v20, v20, v76
    v_add_f32 v21, v21, v77
    v_add_f32 v22, v22, v78
    v_add_f32 v23, v23, v79
    v_mov_b32 v24, v20
    v_mov_b32 v25, v21
    v_mov_b32 v26, v22
    v_mov_b32 v27, v23
    s_nop 0
    v_permlane16_swap_b32 v20, v24
    v_permlane16_swap_b32 v21, v25
    v_permlane16_swap_b32 v22, v26
    v_permlane16_swap_b32 v23, v27
    v_add_f32 v20, v20, v24
    v_add_f32 v21, v21, v25
    v_add_f32 v22, v22, v26
    v_add_f32 v23, v23, v27
    v_mov_b32 v24, v20
    v_mov_b32 v25, v21
    v_mov_b32 v26, v22
    v_mov_b32 v27, v23
    s_nop 0
    v_permlane32_swap_b32 v20, v24
    v_permlane32_swap_b32 v21, v25
    v_permlane32_swap_b32 v22, v26
    v_permlane32_swap_b32 v23, v27
    v_add_f32 v20, v20, v24
    v_add_f32 v21, v21, v25
    v_add_f32 v22, v22, v26
    v_add_f32 v23, v23, v27
    v_cvt_pk_bf16_f32 v20, v20, v20
    v_lshlrev_b32 v20, 16, v20
    v_mul_f32 v20, v5, v20
    v_cvt_pk_bf16_f32 v20, v20, v20
    v_lshlrev_b32 v20, 16, v20
    v_add_f32 v20, v20, v84
    v_cvt_pk_bf16_f32 v20, v20, v20
    v_lshlrev_b32 v20, 16, v20
    v_mul_f32 v20, v20, v88
    v_cvt_pk_bf16_f32 v21, v21, v21
    v_lshlrev_b32 v21, 16, v21
    v_mul_f32 v21, v5, v21
    v_cvt_pk_bf16_f32 v21, v21, v21
    v_lshlrev_b32 v21, 16, v21
    v_add_f32 v21, v21, v85
    v_cvt_pk_bf16_f32 v21, v21, v21
    v_lshlrev_b32 v21, 16, v21
    v_mul_f32 v21, v21, v88
    v_cvt_pk_bf16_f32 v22, v22, v22
    v_lshlrev_b32 v22, 16, v22
    v_mul_f32 v22, v5, v22
    v_cvt_pk_bf16_f32 v22, v22, v22
    v_lshlrev_b32 v22, 16, v22
    v_add_f32 v22, v22, v86
    v_cvt_pk_bf16_f32 v22, v22, v22
    v_lshlrev_b32 v22, 16, v22
    v_mul_f32 v22, v22, v88
    v_cvt_pk_bf16_f32 v23, v23, v23
    v_lshlrev_b32 v23, 16, v23
    v_mul_f32 v23, v5, v23
    v_cvt_pk_bf16_f32 v23, v23, v23
    v_lshlrev_b32 v23, 16, v23
    v_add_f32 v23, v23, v87
    v_cvt_pk_bf16_f32 v23, v23, v23
    v_lshlrev_b32 v23, 16, v23
    v_mul_f32 v23, v23, v88
    s_lshl_b32 s3, s59, 8
    s_add_u32 s3, s3, 158976
    v_add_u32 v2, s3, v2
    ds_write_b128 v2, v[20:23]
    s_lshl_b32 s3, s59, 2
    v_add_u32 v2, s3, v12
    ds_write_b32 v2, v80 offset:64
K_P2_YN:
    s_add_u32 s53, s53, 1
    s_cmp_lt_u32 s53, 2
    s_cbranch_scc1 K_P2_HW
    s_branch K_END
WP_flags:
    s_setpc_b64 s[38:39]
K_P2_FLAGS:
    s_mov_b32 exec_hi, 0
    s_waitcnt vmcnt(0)
    s_mov_b32 s3, 131072
K_P2_FCHK:
    v_cmp_eq_u32 vcc, 1, v7
    s_nop 1
    v_mov_b32 v2, vcc_lo
    ds_write_b32 v12, v2 offset:32
    s_cmp_eq_u32 vcc_lo, -1
    s_cbranch_scc1 K_P2_FGO
    s_cmp_lg_u32 vcc_lo, 0
    s_cbranch_scc1 K_P2_FS
    s_sleep 4
K_P2_FS:
    s_sleep 6
    global_load_dword v7, v10, s[10:11] sc1
    s_sub_u32 s3, s3, 1
    s_waitcnt vmcnt(0)
    s_cbranch_scc0 K_P2_FCHK
    v_mov_b32 v2, -1
    ds_write_b32 v12, v2 offset:32
K_P2_FGO:
    s_mov_b64 exec, -1
    s_branch K_END
.p2align 12
K_AUX:
    s_load_dwordx8 s[48:55], s[0:1], 32
    s_load_dwordx2 s[56:57], s[0:1], 64
    s_mul_i32 s44, s28, 7
    s_add_u32 s44, s44, s29
    s_sub_u32 s44, s44, 1
    s_cmp_lt_u32 s44, 54
    s_cselect_b32 s44, s44, 63
    s_cmp_eq_u32 s29, 0
    s_cselect_b32 s44, 63, s44
    s_lshl_b32 s74, s28, 8
    s_lshl_b32 s3, s29, 5
    s_add_u32 s74, s74, s3
    v_mov_b32 v12, 158720
    v_mov_b32 v13, 1
    s_cmp_lt_u32 s30, 4
    s_cbranch_scc1 K_AUX_LO
    s_lshl_b32 s3, s30, 3
    s_add_u32 s3, s3, s74
    s_sub_u32 s3, s3, 32
    v_lshrrev_b32 v9, 3, v1
    v_add_u32 v9, s3, v9
    v_and_b32 v11, 7, v1
    v_lshlrev_b32 v11, 4, v11
    v_mul_u32_u24 v10, 1280, v9
    v_add_u32 v10, v10, v11
    s_waitcnt lgkmcnt(0)
    buffer_load_dwordx4 v[16:19], v10, s[12:15], 0 offen offset:0
    buffer_load_dwordx4 v[20:23], v10, s[12:15], 0 offen offset:128
    buffer_load_dwordx4 v[24:27], v10, s[12:15], 0 offen offset:256
    buffer_load_dwordx4 v[28:31], v10, s[12:15], 0 offen offset:384
    buffer_load_dwordx4 v[32:35], v10, s[12:15], 0 offen offset:512
    buffer_load_dwordx4 v[36:39], v10, s[12:15], 0 offen offset:640
    buffer_load_dwordx4 v[40:43], v10, s[12:15], 0 offen offset:768
    buffer_load_dwordx4 v[44:47], v10, s[12:15], 0 offen offset:896
    buffer_load_dwordx4 v[48:51], v10, s[12:15], 0 offen offset:1024
    buffer_load_dwordx4 v[52:55], v10, s[12:15], 0 offen offset:1152
    s_mov_b32 s16, s48
    s_mov_b32 s17, s49
    s_mov_b32 s18, 0x500
    s_mov_b32 s19, 0x20000
    s_mov_b32 s20, s56
    s_mov_b32 s21, s57
    s_mov_b32 s22, 0x500
    s_mov_b32 s23, 0x20000
    buffer_load_dwordx4 v[56:59], v11, s[16:19], 0 offen offset:0
    buffer_load_dwordx4 v[60:63], v11, s[16:19], 0 offen offset:128
    buffer_load_dwordx4 v[64:67], v11, s[16:19], 0 offen offset:256
    buffer_load_dwordx4 v[68:71], v11, s[16:19], 0 offen offset:384
    buffer_load_dwordx4 v[72:75], v11, s[16:19], 0 offen offset:512
    buffer_load_dwordx4 v[76:79], v11, s[16:19], 0 offen offset:640
    buffer_load_dwordx4 v[80:83], v11, s[16:19], 0 offen offset:768
    buffer_load_dwordx4 v[84:87], v11, s[16:19], 0 offen offset:896
    buffer_load_dwordx4 v[88:91], v11, s[16:19], 0 offen offset:1024
    buffer_load_dwordx4 v[92:95], v11, s[16:19], 0 offen offset:1152
    buffer_load_dwordx4 v[96:99], v11, s[20:23], 0 offen offset:0
    buffer_load_dwordx4 v[100:103], v11, s[20:23], 0 offen offset:128
    buffer_load_dwordx4 v[104:107], v11, s[20:23], 0 offen offset:256
    buffer_load_dwordx4 v[108:111], v11, s[20:23], 0 offen offset:384
    buffer_load_dwordx4 v[112:115], v11, s[20:23], 0 offen offset:512
    buffer_load_dwordx4 v[116:119], v11, s[20:23], 0 offen offset:640
    buffer_load_dwordx4 v[120:123], v11, s[20:23], 0 offen offset:768
    buffer_load_dwordx4 v[124:127], v11, s[20:23], 0 offen offset:896
    buffer_load_dwordx4 v[128:131], v11, s[20:23], 0 offen offset:1024
    buffer_load_dwordx4 v[132:135], v11, s[20:23], 0 offen offset:1152
    s_barrier
    v_mov_b32 v180, 0
    v_mov_b32 v181, 0
    v_mov_b32 v182, 0
    v_mov_b32 v183, 0
    v_and_b32 v10, 31, v9
    v_lshlrev_b32 v10, 2, v10
    v_add_u32 v10, 122880, v10
    v_sub_u32 v4, 0x87ff, v9
    s_setprio 2
    s_waitcnt vmcnt(10)
    v_dot2c_f32_bf16 v180, v16, v56
    v_dot2c_f32_bf16 v181, v17, v57
    v_dot2c_f32_bf16 v180, v18, v58
    v_dot2c_f32_bf16 v181, v19, v59
    v_dot2c_f32_bf16 v180, v20, v60
    v_dot2c_f32_bf16 v181, v21, v61
    v_dot2c_f32_bf16 v180, v22, v62
    v_dot2c_f32_bf16 v181, v23, v63
    v_dot2c_f32_bf16 v180, v24, v64
    v_dot2c_f32_bf16 v181, v25, v65
    v_dot2c_f32_bf16 v180, v26, v66
    v_dot2c_f32_bf16 v181, v27, v67
    v_dot2c_f32_bf16 v180, v28, v68
    v_dot2c_f32_bf16 v181, v29, v69
    v_dot2c_f32_bf16 v180, v30, v70
    v_dot2c_f32_bf16 v181, v31, v71
    v_dot2c_f32_bf16 v180, v32, v72
    v_dot2c_f32_bf16 v181, v33, v73
    v_dot2c_f32_bf16 v180, v34, v74
    v_dot2c_f32_bf16 v181, v35, v75
    v_dot2c_f32_bf16 v180, v36, v76
    v_dot2c_f32_bf16 v181, v37, v77
    v_dot2c_f32_bf16 v180, v38, v78
    v_dot2c_f32_bf16 v181, v39, v79
    v_dot2c_f32_bf16 v180, v40, v80
    v_dot2c_f32_bf16 v181, v41, v81
    v_dot2c_f32_bf16 v180, v42, v82
    v_dot2c_f32_bf16 v181, v43, v83
    v_dot2c_f32_bf16 v180, v44, v84
    v_dot2c_f32_bf16 v181, v45, v85
    v_dot2c_f32_bf16 v180, v46, v86
    v_dot2c_f32_bf16 v181, v47, v87
    v_dot2c_f32_bf16 v180, v48, v88
    v_dot2c_f32_bf16 v181, v49, v89
    v_dot2c_f32_bf16 v180, v50, v90
    v_dot2c_f32_bf16 v181, v51, v91
    v_dot2c_f32_bf16 v180, v52, v92
    v_dot2c_f32_bf16 v181, v53, v93
    v_dot2c_f32_bf16 v180, v54, v94
    v_dot2c_f32_bf16 v181, v55, v95
    s_waitcnt vmcnt(0)
    v_dot2c_f32_bf16 v182, v16, v96
    v_dot2c_f32_bf16 v183, v17, v97
    v_dot2c_f32_bf16 v182, v18, v98
    v_dot2c_f32_bf16 v183, v19, v99
    v_dot2c_f32_bf16 v182, v20, v100
    v_dot2c_f32_bf16 v183, v21, v101
    v_dot2c_f32_bf16 v182, v22, v102
    v_dot2c_f32_bf16 v183, v23, v103
    v_dot2c_f32_bf16 v182, v24, v104
    v_dot2c_f32_bf16 v183, v25, v105
    v_dot2c_f32_bf16 v182, v26, v106
    v_dot2c_f32_bf16 v183, v27, v107
    v_dot2c_f32_bf16 v182, v28, v108
    v_dot2c_f32_bf16 v183, v29, v109
    v_dot2c_f32_bf16 v182, v30, v110
    v_dot2c_f32_bf16 v183, v31, v111
    v_dot2c_f32_bf16 v182, v32, v112
    v_dot2c_f32_bf16 v183, v33, v113
    v_dot2c_f32_bf16 v182, v34, v114
    v_dot2c_f32_bf16 v183, v35, v115
    v_dot2c_f32_bf16 v182, v36, v116
    v_dot2c_f32_bf16 v183, v37, v117
    v_dot2c_f32_bf16 v182, v38, v118
    v_dot2c_f32_bf16 v183, v39, v119
    v_dot2c_f32_bf16 v182, v40, v120
    v_dot2c_f32_bf16 v183, v41, v121
    v_dot2c_f32_bf16 v182, v42, v122
    v_dot2c_f32_bf16 v183, v43, v123
    v_dot2c_f32_bf16 v182, v44, v124
    v_dot2c_f32_bf16 v183, v45, v125
    v_dot2c_f32_bf16 v182, v46, v126
    v_dot2c_f32_bf16 v183, v47, v127
    v_dot2c_f32_bf16 v182, v48, v128
    v_dot2c_f32_bf16 v183, v49, v129
    v_dot2c_f32_bf16 v182, v50, v130
    v_dot2c_f32_bf16 v183, v51, v131
    v_dot2c_f32_bf16 v182, v52, v132
    v_dot2c_f32_bf16 v183, v53, v133
    v_dot2c_f32_bf16 v182, v54, v134
    v_dot2c_f32_bf16 v183, v55, v135
    s_nop 2
    v_add_f32 v180, v180, v181
    v_add_f32 v182, v182, v183
    s_nop 0
    v_add_f32_dpp v180, v180, v180 quad_perm:[1,0,3,2] row_mask:0xf bank_mask:0xf
    v_add_f32_dpp v182, v182, v182 quad_perm:[1,0,3,2] row_mask:0xf bank_mask:0xf
    s_nop 0
    v_add_f32_dpp v180, v180, v180 quad_perm:[2,3,0,1] row_mask:0xf bank_mask:0xf
    v_add_f32_dpp v182, v182, v182 quad_perm:[2,3,0,1] row_mask:0xf bank_mask:0xf
    s_nop 0
    v_add_f32_dpp v180, v180, v180 row_half_mirror row_mask:0xf bank_mask:0xf
    v_add_f32_dpp v182, v182, v182 row_half_mirror row_mask:0xf bank_mask:0xf
    v_cvt_pk_bf16_f32 v2, v180, v180
    v_lshlrev_b32 v2, 16, v2
    v_ashrrev_i32 v3, 31, v2
    v_or_b32 v3, 0x80000000, v3
    v_xor_b32 v2, v2, v3
    v_and_b32 v2, 0xffff0000, v2
    v_or_b32 v2, v2, v4
    ds_write2_b32 v10, v2, v182 offset0:0 offset1:32
    s_mov_b64 exec, 1
    ds_add_u32 v12, v13 offset:36
    s_mov_b64 exec, -1
    s_setprio 0
    s_cmp_lg_u32 s30, 4
    s_cbranch_scc1 K_WARMA0
    s_call_b64 s[38:39], WP_p2g
    s_branch K_WARMAX
K_WARMA0:
    s_cmp_lg_u32 s30, 5
    s_cbranch_scc1 K_WARMA1
    s_call_b64 s[38:39], WP_gen
    s_branch K_WARMAX
K_WARMA1:
    s_cmp_lg_u32 s30, 6
    s_cbranch_scc1 K_WARMA2
    s_call_b64 s[38:39], WP_help
    s_call_b64 s[38:39], WP_flags
    s_branch K_WARMAX
K_WARMA2:
    s_call_b64 s[38:39], WP_spin
K_WARMAX:
    s_cmp_ge_u32 s30, 6
    s_cselect_b32 s44, 63, s44
    s_cmp_lg_u32 s44, 63
    s_cbranch_scc1 K_FFN_C
    s_mov_b32 s3, 1048576
K_FGH:
    ds_read_b32 v2, v12 offset:48
    s_sleep 8
    s_sub_u32 s3, s3, 1
    s_waitcnt lgkmcnt(0)
    v_readfirstlane_b32 s33, v2
    s_nop 3
    s_cselect_b32 s33, 1, s33
    s_cmp_lt_u32 s33, 1
    s_cbranch_scc1 K_FGH
    s_cmp_eq_u32 s30, 6
    s_cbranch_scc1 K_P2_HELP
    v_mov_b32 v7, 1
    s_branch K_P2_HELP
K_AUX_LO:
    s_waitcnt lgkmcnt(0)
    s_cmp_eq_u32 s30, 0
    s_cbranch_scc1 K_AUX_PUB
    s_cmp_eq_u32 s44, 63
    s_cbranch_scc1 K_AUX_NOF
    s_and_b32 s3, s44, 1
    s_cmp_eq_u32 s3, 0
    s_cselect_b64 s[60:61], s[50:51], s[52:53]
    s_cselect_b64 s[64:65], s[52:53], s[50:51]
    s_cselect_b32 s75, 0, 40960
    s_mov_b32 s62, 0x21c000
    s_mov_b32 s63, 0x20000
    s_mov_b32 s66, 0x21c000
    s_mov_b32 s67, 0x20000
    v_lshrrev_b32 v2, 2, v1
    v_mul_u32_u24 v184, 3456, v2
    v_and_b32 v2, 3, v1
    v_lshl_add_u32 v184, v2, 4, v184
    s_lshl_b32 s72, s44, 6
    v_add_u32 v184, s72, v184
    s_sub_u32 s74, s30, 1
K_FSA0:
    s_lshl_b32 s73, s74, 10
    s_mul_i32 s72, s74, 55296
    s_add_u32 m0, s73, s75
    s_waitcnt vmcnt(7)
    buffer_load_dwordx4 v184, s[60:63], s72 offen lds
    s_add_u32 s74, s74, 3
    s_cmp_lt_u32 s74, 24
    s_cbranch_scc1 K_FSA0
    s_barrier
    s_mov_b32 s3, 1048576
K_FGPB:
    ds_read_b32 v2, v12 offset:36
    s_sleep 1
    s_sub_u32 s3, s3, 1
    s_waitcnt lgkmcnt(0)
    v_readfirstlane_b32 s33, v2
    s_nop 3
    s_cselect_b32 s33, 5, s33
    s_cmp_lt_u32 s33, 5
    s_cbranch_scc1 K_FGPB
K_FSA:
    s_lshl_b32 s73, s74, 10
    s_mul_i32 s72, s74, 55296
    s_add_u32 m0, s73, s75
    s_waitcnt vmcnt(7)
    buffer_load_dwordx4 v184, s[60:63], s72 offen lds
    s_add_u32 s74, s74, 3
    s_cmp_lt_u32 s74, 40
    s_cbranch_scc1 K_FSA
    s_sub_u32 s74, s74, 40
    s_xor_b32 s75, s75, 40960
    s_mov_b32 s68, s54
    s_mov_b32 s69, s55
    s_mov_b32 s70, 0x21c000
    s_mov_b32 s71, 0x20000
    s_mul_i32 s3, s44, 40960
    v_lshrrev_b32 v2, 3, v1
    v_mul_u32_u24 v2, 1280, v2
    v_lshrrev_b32 v3, 4, v1
    v_lshlrev_b32 v3, 1, v3
    v_and_b32 v4, 7, v1
    v_xor_b32 v3, v3, v4
    v_lshl_add_u32 v2, v3, 4, v2
    v_add_u32 v185, s3, v2
K_FSB:
    s_lshl_b32 s73, s74, 10
    s_mul_i32 s72, s74, 55296
    s_add_u32 m0, s73, s75
    s_waitcnt vmcnt(7)
    buffer_load_dwordx4 v184, s[64:67], s72 offen lds
    s_add_u32 s74, s74, 3
    s_cmp_lt_u32 s74, 40
    s_cbranch_scc1 K_FSB
    s_sub_u32 s74, s74, 40
    s_mov_b32 s75, 81920
K_FSD0:
    s_lshl_b32 s73, s74, 10
    s_and_b32 s72, s74, 3
    s_mul_i32 s72, s72, 10208
    s_lshl_b32 s3, s74, 5
    s_add_u32 s72, s72, s3
    s_add_u32 m0, s73, s75
    s_waitcnt vmcnt(7)
    buffer_load_dwordx4 v185, s[68:71], s72 offen lds
    s_add_u32 s74, s74, 3
    s_cmp_lt_u32 s74, 24
    s_cbranch_scc1 K_FSD0
    s_waitcnt vmcnt(8)
    s_mov_b64 exec, 1
    ds_add_u32 v12, v13 offset:56
    s_mov_b64 exec, -1
K_FSD:
    s_lshl_b32 s73, s74, 10
    s_and_b32 s72, s74, 3
    s_mul_i32 s72, s72, 10208
    s_lshl_b32 s3, s74, 5
    s_add_u32 s72, s72, s3
    s_add_u32 m0, s73, s75
    s_waitcnt vmcnt(7)
    buffer_load_dwordx4 v185, s[68:71], s72 offen lds
    s_add_u32 s74, s74, 3
    s_cmp_lt_u32 s74, 40
    s_cbranch_scc1 K_FSD
    s_mul_i32 s3, s29, 96
    s_lshl_b32 s72, s30, 5
    s_add_u32 s3, s3, s72
    s_sub_u32 s3, s3, 128
    v_lshrrev_b32 v2, 1, v1
    v_add_u32 v2, s3, v2
    v_mul_u32_u24 v2, 1280, v2
    v_and_b32 v3, 1, v1
    v_lshl_add_u32 v2, v3, 7, v2
    buffer_load_dword v6, v2, s[24:27], 0 offen offset:1024
K_AUX_WR:
    s_mov_b32 s3, 1048576
K_FGR:
    ds_read_b32 v2, v12 offset:60
    s_sleep 2
    s_sub_u32 s3, s3, 1
    s_waitcnt lgkmcnt(0)
    v_readfirstlane_b32 s33, v2
    s_nop 3
    s_cselect_b32 s33, 2, s33
    s_cmp_lt_u32 s33, 2
    s_cbranch_scc1 K_FGR
    s_branch K_P2
K_AUX_NOF:
    s_cmp_lg_u32 s2, 63
    s_cbranch_scc1 K_AUX_NOZ
    s_cmp_lg_u32 s30, 1
    s_cbranch_scc1 K_AUX_NOZ
    s_add_u32 s60, s10, 0x80000
    s_addc_u32 s61, s11, 0
    s_mov_b32 s62, 0xc000
    s_mov_b32 s63, 0x20000
    v_mov_b32 v9, 786432
    global_load_dword v10, v9, s[10:11] sc1
    v_lshlrev_b32 v11, 4, v1
    v_add_u32 v11, 790528, v11
    global_load_dword v6, v11, s[10:11] sc1
    s_barrier
    s_mov_b32 s3, 1048576
K_FGZ:
    ds_read_b32 v2, v12 offset:36
    s_sleep 2
    s_sub_u32 s3, s3, 1
    s_waitcnt lgkmcnt(0)
    v_readfirstlane_b32 s33, v2
    s_nop 3
    s_cselect_b32 s33, 4, s33
    s_cmp_lt_u32 s33, 4
    s_cbranch_scc1 K_FGZ
    v_and_b32 v4, 7, v1
    v_lshlrev_b32 v4, 2, v4
    global_load_dword v7, v4, s[8:9] offset:192 sc1
    s_waitcnt vmcnt(1)
    v_add_u32 v10, 1, v10
    s_mov_b32 s3, 131072
    s_setprio 3
K_AG2_POLL:
    global_load_dwordx4 v[16:19], v11, s[10:11] sc1
    s_waitcnt vmcnt(0)
    v_xor_b32 v2, v10, v17
    v_xor_b32 v3, v10, v19
    v_or_b32 v2, v2, v3
    v_cmp_ne_u32 vcc, 0, v2
    s_cbranch_vccz K_AG2_GOT
    s_sleep 2
    s_sub_u32 s3, s3, 1
    s_cmp_lg_u32 s3, 0
    s_cbranch_scc1 K_AG2_POLL
K_AG2_GOT:
    s_nop 1
    v_max_u32_dpp v3, v16, v16 quad_perm:[1,0,3,2] row_mask:0xf bank_mask:0xf
    s_nop 1
    v_max_u32_dpp v3, v3, v3 quad_perm:[2,3,0,1] row_mask:0xf bank_mask:0xf
    s_nop 1
    v_max_u32_dpp v3, v3, v3 row_half_mirror row_mask:0xf bank_mask:0xf
    s_nop 1
    v_max_u32_dpp v3, v3, v3 row_mirror row_mask:0xf bank_mask:0xf
    s_nop 1
    v_readlane_b32 s74, v3, 0
    v_readlane_b32 s76, v3, 16
    v_readlane_b32 s77, v3, 32
    v_readlane_b32 s78, v3, 48
    s_nop 3
    s_max_u32 s74, s74, s76
    s_max_u32 s77, s77, s78
    s_max_u32 s74, s74, s77
    v_cmp_ne_u32 vcc, s74, v16
    s_nop 1
    v_cndmask_b32 v2, v18, v16, vcc
    s_nop 1
    v_max_u32_dpp v3, v2, v2 quad_perm:[1,0,3,2] row_mask:0xf bank_mask:0xf
    s_nop 1
    v_max_u32_dpp v3, v3, v3 quad_perm:[2,3,0,1] row_mask:0xf bank_mask:0xf
    s_nop 1
    v_max_u32_dpp v3, v3, v3 row_half_mirror row_mask:0xf bank_mask:0xf
    s_nop 1
    v_max_u32_dpp v3, v3, v3 row_mirror row_mask:0xf bank_mask:0xf
    s_nop 1
    v_readlane_b32 s75, v3, 0
    v_readlane_b32 s76, v3, 16
    v_readlane_b32 s77, v3, 32
    v_readlane_b32 s78, v3, 48
    s_nop 3
    s_max_u32 s75, s75, s76
    s_max_u32 s77, s77, s78
    s_max_u32 s75, s75, s77
    v_mov_b32 v176, s74
    v_mov_b32 v177, s75
    v_and_b32 v4, 7, v1
    v_lshlrev_b32 v4, 2, v4
    s_mov_b32 s3, 131072
K_ZPOLL4:
    v_cmp_eq_u32 vcc, 0, v7
    s_cbranch_vccz K_ZOK4
    s_sub_u32 s3, s3, 1
    s_cbranch_scc1 K_ZOK4
    global_load_dword v7, v4, s[8:9] offset:192 sc1
    s_waitcnt vmcnt(0)
    s_branch K_ZPOLL4
K_ZOK4:
    v_and_b32 v2, 7, v1
    v_mul_u32_u24 v2, 20, v2
    v_lshrrev_b32 v3, 3, v1
    v_add_lshl_u32 v2, v2, v3, 8
    buffer_store_dwordx2 v[176:177], v2, s[60:63], 0 offen offset:136 sc1
    s_mov_b64 exec, 1
    global_store_dword v9, v10, s[10:11] sc1
    s_mov_b64 exec, -1
    v_lshlrev_b32 v4, 2, v1
    s_mov_b32 s72, 43008
    s_mov_b32 s3, 131072
K_AGG_POLL:
    s_sleep 8
    buffer_load_dword v2, v4, s[60:63], s72 offen sc1
    s_waitcnt vmcnt(0)
    v_cmp_eq_u32 vcc, 0, v2
    s_cbranch_vccz K_AGG_GOT
    s_sub_u32 s3, s3, 1
    s_cmp_lg_u32 s3, 0
    s_cbranch_scc1 K_AGG_POLL
K_AGG_GOT:
    s_mov_b32 s62, 40960
    v_lshlrev_b32 v3, 8, v1
    s_mov_b32 s3, 0
    buffer_store_dwordx2 v[176:177], v3, s[60:63], s3 offen offset:128 sc1
    s_mov_b32 s3, 16384
    buffer_store_dwordx2 v[176:177], v3, s[60:63], s3 offen offset:128 sc1
    s_mov_b32 s3, 32768
    buffer_store_dwordx2 v[176:177], v3, s[60:63], s3 offen offset:128 sc1
    s_setprio 0
    s_branch K_AUX_NOK
K_AUX_NOZ:
    s_barrier
K_AUX_NOK:
    s_mov_b32 s3, 1048576
K_FGWD:
    ds_read_b32 v2, v12 offset:48
    s_sleep 4
    s_sub_u32 s3, s3, 1
    s_waitcnt lgkmcnt(0)
    v_readfirstlane_b32 s33, v2
    s_nop 3
    s_cselect_b32 s33, 1, s33
    s_cmp_lt_u32 s33, 1
    s_cbranch_scc1 K_FGWD
    s_branch K_P2
K_AUX_PUB:
    s_add_u32 s60, s10, 0x1000
    s_addc_u32 s61, s11, 0
    s_mov_b32 s62, 0x2000
    s_mov_b32 s63, 0x20000
    v_and_b32 v3, 31, v1
    v_lshlrev_b32 v10, 2, v3
    v_add_u32 v11, 122880, v10
    s_lshl_b32 s72, s74, 2
    v_mov_b32 v2, 786432
    global_load_dword v17, v2, s[10:11] sc1
    s_lshl_b32 s3, s2, 2
    s_add_u32 s3, s3, 567296
    v_mov_b32 v9, s3
    s_lshl_b32 s3, s2, 4
    s_add_u32 s3, s3, 790528
    v_lshl_add_u32 v20, v1, 4, s3
    v_and_b32 v5, 7, v1
    v_lshlrev_b32 v5, 2, v5
    s_barrier
    s_setprio 3
    s_waitcnt vmcnt(0)
    v_add_u32 v17, 1, v17
    v_mov_b32 v19, v17
    s_mov_b32 s3, 1048576
K_FGRT:
    ds_read_b32 v2, v12 offset:36
    s_sleep 0
    s_sub_u32 s3, s3, 1
    s_waitcnt lgkmcnt(0)
    v_readfirstlane_b32 s33, v2
    s_nop 3
    s_cselect_b32 s33, 4, s33
    s_cmp_lt_u32 s33, 4
    s_cbranch_scc1 K_FGRT
    ds_read2_b32 v[176:177], v11 offset0:0 offset1:32
    s_waitcnt lgkmcnt(0)
    s_nop 1
    v_max_u32_dpp v3, v176, v176 quad_perm:[1,0,3,2] row_mask:0xf bank_mask:0xf
    s_nop 1
    v_max_u32_dpp v3, v3, v3 quad_perm:[2,3,0,1] row_mask:0xf bank_mask:0xf
    s_nop 1
    v_max_u32_dpp v3, v3, v3 row_half_mirror row_mask:0xf bank_mask:0xf
    s_nop 1
    v_max_u32_dpp v3, v3, v3 row_mirror row_mask:0xf bank_mask:0xf
    s_nop 1
    v_readlane_b32 s74, v3, 0
    v_readlane_b32 s76, v3, 16
    v_readlane_b32 s77, v3, 32
    v_readlane_b32 s78, v3, 48
    s_nop 3
    s_max_u32 s74, s74, s76
    s_max_u32 s77, s77, s78
    s_max_u32 s74, s74, s77
    v_cmp_ne_u32 vcc, s74, v176
    s_nop 1
    v_cndmask_b32 v176, 0, v176, vcc
    s_nop 1
    v_max_u32_dpp v3, v176, v176 quad_perm:[1,0,3,2] row_mask:0xf bank_mask:0xf
    s_nop 1
    v_max_u32_dpp v3, v3, v3 quad_perm:[2,3,0,1] row_mask:0xf bank_mask:0xf
    s_nop 1
    v_max_u32_dpp v3, v3, v3 row_half_mirror row_mask:0xf bank_mask:0xf
    s_nop 1
    v_max_u32_dpp v3, v3, v3 row_mirror row_mask:0xf bank_mask:0xf
    s_nop 1
    v_readlane_b32 s75, v3, 0
    v_readlane_b32 s76, v3, 16
    v_readlane_b32 s77, v3, 32
    v_readlane_b32 s78, v3, 48
    s_nop 3
    s_max_u32 s75, s75, s76
    s_max_u32 s77, s77, s78
    s_max_u32 s75, s75, s77
    v_mov_b32 v16, s74
    v_mov_b32 v18, s75
    s_mov_b64 exec, 1
    global_store_dwordx4 v20, v[16:19], s[10:11] sc1
    s_mov_b64 exec, -1
    s_mov_b64 exec, 1
    ds_add_u32 v12, v13 offset:36
    s_mov_b64 exec, -1
    global_load_dword v7, v5, s[8:9] offset:192 sc1
    v_cvt_pk_bf16_f32 v177, v177, v177
    v_lshlrev_b32 v177, 16, v177
    v_mul_f32 v3, 0xbfb8aa3b, v177
    v_exp_f32 v3, v3
    s_nop 0
    v_add_f32 v3, 1.0, v3
    v_rcp_f32 v177, v3
    s_nop 0
    v_cvt_pk_bf16_f32 v177, v177, v177
    v_lshlrev_b32 v177, 16, v177
    s_mov_b32 exec_hi, 0
    buffer_store_dword v177, v10, s[60:63], s72 offen sc1
    s_mov_b64 exec, -1
    s_waitcnt vmcnt(0)
    v_and_b32 v4, 7, v1
    v_lshlrev_b32 v4, 2, v4
    s_mov_b32 s3, 131072
K_ZPOLL3:
    v_cmp_eq_u32 vcc, 0, v7
    s_cbranch_vccz K_ZOK3
    s_sub_u32 s3, s3, 1
    s_cbranch_scc1 K_ZOK3
    global_load_dword v7, v4, s[8:9] offset:192 sc1
    s_waitcnt vmcnt(0)
    s_branch K_ZPOLL3
K_ZOK3:
    s_mov_b64 exec, 1
    global_store_dword v9, v13, s[10:11] sc1
    s_mov_b64 exec, -1
    v_and_b32 v3, 1, v1
    v_lshl_add_u32 v3, v3, 2, s42
    v_lshlrev_b32 v10, 4, v1
    s_mov_b32 s3, 131072
K_AUX_POLL:
    s_sleep 6
    global_load_dword v2, v3, s[10:11] offset:136 sc1
    s_waitcnt vmcnt(0)
    v_cmp_eq_u32 vcc, 0, v2
    s_cbranch_vccz K_AUX_GOT
    s_sub_u32 s3, s3, 1
    s_cmp_lg_u32 s3, 0
    s_cbranch_scc1 K_AUX_POLL
K_AUX_GOT:
    v_readlane_b32 s74, v2, 0
    v_readlane_b32 s75, v2, 1
    s_nop 3
    s_and_b32 s74, s74, 0x7ff
    s_sub_u32 s74, 2047, s74
    s_mul_i32 s74, s74, 1280
    s_mov_b32 m0, 125184
    s_nop 0
    buffer_load_dwordx4 v10, s[12:15], s74 offen lds
    s_mov_b64 exec, 0xffff
    buffer_load_dwordx4 v10, s[12:15], s74 offen offset:1024 lds
    s_mov_b64 exec, -1
    s_and_b32 s75, s75, 0x7ff
    s_sub_u32 s75, 2047, s75
    s_mul_i32 s75, s75, 1280
    s_mov_b32 m0, 126528
    s_nop 0
    buffer_load_dwordx4 v10, s[12:15], s75 offen lds
    s_mov_b64 exec, 0xffff
    buffer_load_dwordx4 v10, s[12:15], s75 offen offset:1024 lds
    s_mov_b64 exec, -1
    s_waitcnt vmcnt(0)
    ds_write_b32 v12, v13 offset:48
    s_setprio 0
    s_branch K_P2
.p2align 12
K_FFN_C:
    s_add_u32 s64, s10, 0x10000
    s_addc_u32 s65, s11, 0
    s_mov_b32 s66, 0x43800
    s_mov_b32 s67, 0x20000
    s_and_b32 s73, s30, 1
    v_lshrrev_b32 v232, 4, v1
    v_bfe_u32 v4, v1, 2, 2
    v_lshl_add_u32 v2, v232, 3, v4
    v_and_b32 v3, 3, v1
    v_lshlrev_b32 v3, 3, v3
    v_lshl_add_u32 v233, v2, 6, v3
    s_lshl_b32 s72, s73, 5
    v_add_u32 v233, s72, v233
    v_lshl_add_u32 v2, v232, 2, v4
    v_bfe_u32 v4, v2, 1, 2
    v_lshl_add_u32 v3, v2, 7, v3
    v_lshl_add_u32 v3, v4, 5, v3
    s_mul_i32 s3, s73, 20480
    s_add_u32 s3, s3, 81920
    v_add_u32 v238, s3, v3
    v_xor_b32 v239, 32, v238
    v_xor_b32 v240, 64, v238
    v_xor_b32 v241, 96, v238
    v_and_b32 v2, 1, v1
    v_mul_u32_u24 v234, 1344, v2
    v_lshl_add_u32 v234, v232, 4, v234
    v_add_u32 v234, 125184, v234
    v_lshlrev_b32 v236, 4, v1
    v_add_u32 v236, 124160, v236
    s_lshl_b32 s3, s73, 3
    v_add_u32 v235, s3, v236
    v_mul_u32_u24 v2, 2560, v2
    v_lshl_add_u32 v237, v232, 4, v2
    s_mul_i32 s3, s44, 5120
    s_mul_i32 s72, s73, 1280
    s_add_u32 s72, s72, s3
    v_lshlrev_b32 v2, 4, v1
    buffer_store_dwordx4 v[16:19], v2, s[64:67], s72 offen offset:0 sc1
    buffer_store_dwordx4 v[16:19], v2, s[64:67], s72 offen offset:2560 sc1
    s_mov_b64 exec, 0xffff
    buffer_store_dwordx4 v[16:19], v2, s[64:67], s72 offen offset:1024 sc1
    buffer_store_dwordx4 v[16:19], v2, s[64:67], s72 offen offset:3584 sc1
    s_mov_b64 exec, -1
    v_add_u32 v5, 40960, v233
    s_mov_b32 s3, 1048576
K_FGD:
    ds_read_b32 v2, v12 offset:56
    s_sleep 2
    s_sub_u32 s3, s3, 1
    s_waitcnt lgkmcnt(0)
    v_readfirstlane_b32 s33, v2
    s_nop 3
    s_cselect_b32 s33, 3, s33
    s_cmp_lt_u32 s33, 3
    s_cbranch_scc1 K_FGD
    s_setprio 3
    ds_read_b64_tr_b16 v[16:17], v233 offset:0
    ds_read_b64_tr_b16 v[18:19], v233 offset:256
    ds_read_b64_tr_b16 v[20:21], v233 offset:2048
    ds_read_b64_tr_b16 v[22:23], v233 offset:2304
    ds_read_b64_tr_b16 v[24:25], v233 offset:4096
    ds_read_b64_tr_b16 v[26:27], v233 offset:4352
    ds_read_b64_tr_b16 v[28:29], v233 offset:6144
    ds_read_b64_tr_b16 v[30:31], v233 offset:6400
    ds_read_b64_tr_b16 v[32:33], v233 offset:8192
    ds_read_b64_tr_b16 v[34:35], v233 offset:8448
    ds_read_b64_tr_b16 v[36:37], v233 offset:10240
    ds_read_b64_tr_b16 v[38:39], v233 offset:10496
    ds_read_b64_tr_b16 v[40:41], v233 offset:12288
    ds_read_b64_tr_b16 v[42:43], v233 offset:12544
    ds_read_b64_tr_b16 v[44:45], v233 offset:14336
    ds_read_b64_tr_b16 v[46:47], v233 offset:14592
    ds_read_b64_tr_b16 v[48:49], v233 offset:16384
    ds_read_b64_tr_b16 v[50:51], v233 offset:16640
    ds_read_b64_tr_b16 v[52:53], v233 offset:18432
    ds_read_b64_tr_b16 v[54:55], v233 offset:18688
    ds_read_b64_tr_b16 v[56:57], v233 offset:20480
    ds_read_b64_tr_b16 v[58:59], v233 offset:20736
    ds_read_b64_tr_b16 v[60:61], v233 offset:22528
    ds_read_b64_tr_b16 v[62:63], v233 offset:22784
    ds_read_b64_tr_b16 v[64:65], v233 offset:24576
    ds_read_b64_tr_b16 v[66:67], v233 offset:24832
    ds_read_b64_tr_b16 v[68:69], v233 offset:26624
    ds_read_b64_tr_b16 v[70:71], v233 offset:26880
    ds_read_b64_tr_b16 v[72:73], v233 offset:28672
    ds_read_b64_tr_b16 v[74:75], v233 offset:28928
    ds_read_b64_tr_b16 v[76:77], v233 offset:30720
    ds_read_b64_tr_b16 v[78:79], v233 offset:30976
    ds_read_b64_tr_b16 v[80:81], v233 offset:32768
    ds_read_b64_tr_b16 v[82:83], v233 offset:33024
    ds_read_b64_tr_b16 v[84:85], v233 offset:34816
    ds_read_b64_tr_b16 v[86:87], v233 offset:35072
    ds_read_b64_tr_b16 v[88:89], v233 offset:36864
    ds_read_b64_tr_b16 v[90:91], v233 offset:37120
    ds_read_b64_tr_b16 v[92:93], v233 offset:38912
    ds_read_b64_tr_b16 v[94:95], v233 offset:39168
    ds_read_b64_tr_b16 v[96:97], v5 offset:0
    ds_read_b64_tr_b16 v[98:99], v5 offset:256
    ds_read_b64_tr_b16 v[100:101], v5 offset:2048
    ds_read_b64_tr_b16 v[102:103], v5 offset:2304
    ds_read_b64_tr_b16 v[104:105], v5 offset:4096
    ds_read_b64_tr_b16 v[106:107], v5 offset:4352
    ds_read_b64_tr_b16 v[108:109], v5 offset:6144
    ds_read_b64_tr_b16 v[110:111], v5 offset:6400
    ds_read_b64_tr_b16 v[112:113], v5 offset:8192
    ds_read_b64_tr_b16 v[114:115], v5 offset:8448
    ds_read_b64_tr_b16 v[116:117], v5 offset:10240
    ds_read_b64_tr_b16 v[118:119], v5 offset:10496
    ds_read_b64_tr_b16 v[120:121], v5 offset:12288
    ds_read_b64_tr_b16 v[122:123], v5 offset:12544
    ds_read_b64_tr_b16 v[124:125], v5 offset:14336
    ds_read_b64_tr_b16 v[126:127], v5 offset:14592
    ds_read_b64_tr_b16 v[128:129], v5 offset:16384
    ds_read_b64_tr_b16 v[130:131], v5 offset:16640
    ds_read_b64_tr_b16 v[132:133], v5 offset:18432
    ds_read_b64_tr_b16 v[134:135], v5 offset:18688
    ds_read_b64_tr_b16 v[136:137], v5 offset:20480
    ds_read_b64_tr_b16 v[138:139], v5 offset:20736
    ds_read_b64_tr_b16 v[140:141], v5 offset:22528
    ds_read_b64_tr_b16 v[142:143], v5 offset:22784
    ds_read_b64_tr_b16 v[144:145], v5 offset:24576
    ds_read_b64_tr_b16 v[146:147], v5 offset:24832
    ds_read_b64_tr_b16 v[148:149], v5 offset:26624
    ds_read_b64_tr_b16 v[150:151], v5 offset:26880
    ds_read_b64_tr_b16 v[152:153], v5 offset:28672
    ds_read_b64_tr_b16 v[154:155], v5 offset:28928
    ds_read_b64_tr_b16 v[156:157], v5 offset:30720
    ds_read_b64_tr_b16 v[158:159], v5 offset:30976
    ds_read_b64_tr_b16 v[160:161], v5 offset:32768
    ds_read_b64_tr_b16 v[162:163], v5 offset:33024
    ds_read_b64_tr_b16 v[164:165], v5 offset:34816
    ds_read_b64_tr_b16 v[166:167], v5 offset:35072
    ds_read_b64_tr_b16 v[168:169], v5 offset:36864
    ds_read_b64_tr_b16 v[170:171], v5 offset:37120
    ds_read_b64_tr_b16 v[172:173], v5 offset:38912
    ds_read_b64_tr_b16 v[174:175], v5 offset:39168
    s_waitcnt vmcnt(0) lgkmcnt(0)
    s_mov_b64 exec, 1
    ds_add_u32 v12, v13 offset:60
    s_mov_b64 exec, -1
    s_mov_b32 s3, 1048576
K_FGK:
    ds_read_b32 v2, v12 offset:48
    s_sleep 1
    s_sub_u32 s3, s3, 1
    s_waitcnt lgkmcnt(0)
    v_readfirstlane_b32 s33, v2
    s_nop 3
    s_cselect_b32 s33, 1, s33
    s_cmp_lt_u32 s33, 1
    s_cbranch_scc1 K_FGK
    ds_read_b128 v[188:191], v234 offset:0
    ds_read_b128 v[192:195], v234 offset:64
    ds_read_b128 v[196:199], v234 offset:128
    ds_read_b128 v[200:203], v234 offset:192
    ds_read_b128 v[204:207], v234 offset:256
    ds_read_b128 v[208:211], v234 offset:320
    ds_read_b128 v[212:215], v234 offset:384
    ds_read_b128 v[216:219], v234 offset:448
    s_waitcnt lgkmcnt(7)
    v_mfma_f32_16x16x32_bf16 v[220:223], v[16:19], v[188:191], 0
    v_mfma_f32_16x16x32_bf16 v[224:227], v[96:99], v[188:191], 0
    ds_read_b128 v[188:191], v234 offset:512
    s_waitcnt lgkmcnt(7)
    v_mfma_f32_16x16x32_bf16 v[220:223], v[20:23], v[192:195], v[220:223]
    v_mfma_f32_16x16x32_bf16 v[224:227], v[100:103], v[192:195], v[224:227]
    ds_read_b128 v[192:195], v234 offset:576
    s_waitcnt lgkmcnt(7)
    v_mfma_f32_16x16x32_bf16 v[220:223], v[24:27], v[196:199], v[220:223]
    v_mfma_f32_16x16x32_bf16 v[224:227], v[104:107], v[196:199], v[224:227]
    ds_read_b128 v[196:199], v234 offset:640
    s_waitcnt lgkmcnt(7)
    v_mfma_f32_16x16x32_bf16 v[220:223], v[28:31], v[200:203], v[220:223]
    v_mfma_f32_16x16x32_bf16 v[224:227], v[108:111], v[200:203], v[224:227]
    ds_read_b128 v[200:203], v234 offset:704
    s_waitcnt lgkmcnt(7)
    v_mfma_f32_16x16x32_bf16 v[220:223], v[32:35], v[204:207], v[220:223]
    v_mfma_f32_16x16x32_bf16 v[224:227], v[112:115], v[204:207], v[224:227]
    ds_read_b128 v[204:207], v234 offset:768
    s_waitcnt lgkmcnt(7)
    v_mfma_f32_16x16x32_bf16 v[220:223], v[36:39], v[208:211], v[220:223]
    v_mfma_f32_16x16x32_bf16 v[224:227], v[116:119], v[208:211], v[224:227]
    ds_read_b128 v[208:211], v234 offset:832
    s_waitcnt lgkmcnt(7)
    v_mfma_f32_16x16x32_bf16 v[220:223], v[40:43], v[212:215], v[220:223]
    v_mfma_f32_16x16x32_bf16 v[224:227], v[120:123], v[212:215], v[224:227]
    ds_read_b128 v[212:215], v234 offset:896
    s_waitcnt lgkmcnt(7)
    v_mfma_f32_16x16x32_bf16 v[220:223], v[44:47], v[216:219], v[220:223]
    v_mfma_f32_16x16x32_bf16 v[224:227], v[124:127], v[216:219], v[224:227]
    ds_read_b128 v[216:219], v234 offset:960
    s_waitcnt lgkmcnt(7)
    v_mfma_f32_16x16x32_bf16 v[220:223], v[48:51], v[188:191], v[220:223]
    v_mfma_f32_16x16x32_bf16 v[224:227], v[128:131], v[188:191], v[224:227]
    ds_read_b128 v[188:191], v234 offset:1024
    s_waitcnt lgkmcnt(7)
    v_mfma_f32_16x16x32_bf16 v[220:223], v[52:55], v[192:195], v[220:223]
    v_mfma_f32_16x16x32_bf16 v[224:227], v[132:135], v[192:195], v[224:227]
    ds_read_b128 v[192:195], v234 offset:1088
    s_waitcnt lgkmcnt(7)
    v_mfma_f32_16x16x32_bf16 v[220:223], v[56:59], v[196:199], v[220:223]
    v_mfma_f32_16x16x32_bf16 v[224:227], v[136:139], v[196:199], v[224:227]
    ds_read_b128 v[196:199], v234 offset:1152
    s_waitcnt lgkmcnt(7)
    v_mfma_f32_16x16x32_bf16 v[220:223], v[60:63], v[200:203], v[220:223]
    v_mfma_f32_16x16x32_bf16 v[224:227], v[140:143], v[200:203], v[224:227]
    ds_read_b128 v[200:203], v234 offset:1216
    s_waitcnt lgkmcnt(7)
    v_mfma_f32_16x16x32_bf16 v[220:223], v[64:67], v[204:207], v[220:223]
    v_mfma_f32_16x16x32_bf16 v[224:227], v[144:147], v[204:207], v[224:227]
    s_waitcnt lgkmcnt(6)
    v_mfma_f32_16x16x32_bf16 v[220:223], v[68:71], v[208:211], v[220:223]
    v_mfma_f32_16x16x32_bf16 v[224:227], v[148:151], v[208:211], v[224:227]
    s_waitcnt lgkmcnt(5)
    v_mfma_f32_16x16x32_bf16 v[220:223], v[72:75], v[212:215], v[220:223]
    v_mfma_f32_16x16x32_bf16 v[224:227], v[152:155], v[212:215], v[224:227]
    s_waitcnt lgkmcnt(4)
    v_mfma_f32_16x16x32_bf16 v[220:223], v[76:79], v[216:219], v[220:223]
    v_mfma_f32_16x16x32_bf16 v[224:227], v[156:159], v[216:219], v[224:227]
    s_waitcnt lgkmcnt(3)
    v_mfma_f32_16x16x32_bf16 v[220:223], v[80:83], v[188:191], v[220:223]
    v_mfma_f32_16x16x32_bf16 v[224:227], v[160:163], v[188:191], v[224:227]
    s_waitcnt lgkmcnt(2)
    v_mfma_f32_16x16x32_bf16 v[220:223], v[84:87], v[192:195], v[220:223]
    v_mfma_f32_16x16x32_bf16 v[224:227], v[164:167], v[192:195], v[224:227]
    s_waitcnt lgkmcnt(1)
    v_mfma_f32_16x16x32_bf16 v[220:223], v[88:91], v[196:199], v[220:223]
    v_mfma_f32_16x16x32_bf16 v[224:227], v[168:171], v[196:199], v[224:227]
    s_waitcnt lgkmcnt(0)
    v_mfma_f32_16x16x32_bf16 v[220:223], v[92:95], v[200:203], v[220:223]
    v_mfma_f32_16x16x32_bf16 v[224:227], v[172:175], v[200:203], v[224:227]
    s_mov_b32 s3, 1048576
K_FGDN:
    ds_read_b32 v2, v12 offset:52
    s_sleep 1
    s_sub_u32 s3, s3, 1
    s_waitcnt lgkmcnt(0)
    v_readfirstlane_b32 s33, v2
    s_nop 3
    s_cselect_b32 s33, 3, s33
    s_cmp_lt_u32 s33, 3
    s_cbranch_scc1 K_FGDN
    ds_read_b64_tr_b16 v[16:17], v238 offset:0
    ds_read_b64_tr_b16 v[18:19], v238 offset:2048
    ds_read_b64_tr_b16 v[20:21], v239 offset:0
    ds_read_b64_tr_b16 v[22:23], v239 offset:2048
    ds_read_b64_tr_b16 v[24:25], v240 offset:0
    ds_read_b64_tr_b16 v[26:27], v240 offset:2048
    ds_read_b64_tr_b16 v[28:29], v241 offset:0
    ds_read_b64_tr_b16 v[30:31], v241 offset:2048
    ds_read_b64_tr_b16 v[32:33], v238 offset:4096
    ds_read_b64_tr_b16 v[34:35], v238 offset:6144
    ds_read_b64_tr_b16 v[36:37], v239 offset:4096
    ds_read_b64_tr_b16 v[38:39], v239 offset:6144
    ds_read_b64_tr_b16 v[40:41], v240 offset:4096
    ds_read_b64_tr_b16 v[42:43], v240 offset:6144
    v_cvt_pk_bf16_f32 v221, v220, v221
    v_lshlrev_b32 v220, 16, v221
    v_and_b32 v221, 0xffff0000, v221
    v_cvt_pk_bf16_f32 v223, v222, v223
    v_lshlrev_b32 v222, 16, v223
    v_and_b32 v223, 0xffff0000, v223
    v_cvt_pk_bf16_f32 v225, v224, v225
    v_lshlrev_b32 v224, 16, v225
    v_and_b32 v225, 0xffff0000, v225
    v_cvt_pk_bf16_f32 v227, v226, v227
    v_lshlrev_b32 v226, 16, v227
    v_and_b32 v227, 0xffff0000, v227
    v_mul_f32 v188, 0xbfb8aa3b, v220
    v_mul_f32 v189, 0xbfb8aa3b, v221
    v_mul_f32 v190, 0xbfb8aa3b, v222
    v_mul_f32 v191, 0xbfb8aa3b, v223
    v_exp_f32 v188, v188
    v_exp_f32 v189, v189
    v_exp_f32 v190, v190
    v_exp_f32 v191, v191
    v_add_f32 v188, 1.0, v188
    v_add_f32 v189, 1.0, v189
    v_add_f32 v190, 1.0, v190
    v_add_f32 v191, 1.0, v191
    v_rcp_f32 v188, v188
    v_rcp_f32 v189, v189
    v_rcp_f32 v190, v190
    v_rcp_f32 v191, v191
    v_mul_f32 v220, v220, v188
    v_mul_f32 v221, v221, v189
    v_mul_f32 v222, v222, v190
    v_mul_f32 v223, v223, v191
    v_cvt_pk_bf16_f32 v221, v220, v221
    v_lshlrev_b32 v220, 16, v221
    v_and_b32 v221, 0xffff0000, v221
    v_cvt_pk_bf16_f32 v223, v222, v223
    v_lshlrev_b32 v222, 16, v223
    v_and_b32 v223, 0xffff0000, v223
    v_mul_f32 v220, v220, v224
    v_mul_f32 v221, v221, v225
    v_mul_f32 v222, v222, v226
    v_mul_f32 v223, v223, v227
    v_cvt_pk_bf16_f32 v228, v220, v221
    v_cvt_pk_bf16_f32 v229, v222, v223
    ds_write_b64 v235, v[228:229]
    s_mov_b64 exec, 1
    ds_add_u32 v12, v13 offset:52
    s_mov_b64 exec, -1
    ds_read_b64_tr_b16 v[44:45], v241 offset:4096
    ds_read_b64_tr_b16 v[46:47], v241 offset:6144
    ds_read_b64_tr_b16 v[48:49], v238 offset:8192
    ds_read_b64_tr_b16 v[50:51], v238 offset:10240
    ds_read_b64_tr_b16 v[52:53], v239 offset:8192
    ds_read_b64_tr_b16 v[54:55], v239 offset:10240
    ds_read_b64_tr_b16 v[56:57], v240 offset:8192
    ds_read_b64_tr_b16 v[58:59], v240 offset:10240
    ds_read_b64_tr_b16 v[60:61], v241 offset:8192
    ds_read_b64_tr_b16 v[62:63], v241 offset:10240
    ds_read_b64_tr_b16 v[64:65], v238 offset:12288
    ds_read_b64_tr_b16 v[66:67], v238 offset:14336
    ds_read_b64_tr_b16 v[68:69], v239 offset:12288
    ds_read_b64_tr_b16 v[70:71], v239 offset:14336
    ds_read_b64_tr_b16 v[72:73], v240 offset:12288
    ds_read_b64_tr_b16 v[74:75], v240 offset:14336
    ds_read_b64_tr_b16 v[76:77], v241 offset:12288
    ds_read_b64_tr_b16 v[78:79], v241 offset:14336
    ds_read_b64_tr_b16 v[80:81], v238 offset:16384
    ds_read_b64_tr_b16 v[82:83], v238 offset:18432
    ds_read_b64_tr_b16 v[84:85], v239 offset:16384
    ds_read_b64_tr_b16 v[86:87], v239 offset:18432
    ds_read_b64_tr_b16 v[88:89], v240 offset:16384
    ds_read_b64_tr_b16 v[90:91], v240 offset:18432
    ds_read_b64_tr_b16 v[92:93], v241 offset:16384
    ds_read_b64_tr_b16 v[94:95], v241 offset:18432
    s_mov_b32 s3, 1048576
K_FGP:
    ds_read_b32 v2, v12 offset:52
    s_sleep 0
    s_sub_u32 s3, s3, 1
    s_waitcnt lgkmcnt(0)
    v_readfirstlane_b32 s33, v2
    s_nop 3
    s_cselect_b32 s33, 5, s33
    s_cmp_lt_u32 s33, 5
    s_cbranch_scc1 K_FGP
    ds_read_b128 v[228:231], v236
    s_waitcnt lgkmcnt(0)
    v_mfma_f32_16x16x32_bf16 v[96:99], v[16:19], v[228:231], 0
    v_mfma_f32_16x16x32_bf16 v[100:103], v[20:23], v[228:231], 0
    v_mfma_f32_16x16x32_bf16 v[104:107], v[24:27], v[228:231], 0
    v_mfma_f32_16x16x32_bf16 v[108:111], v[28:31], v[228:231], 0
    v_mfma_f32_16x16x32_bf16 v[112:115], v[32:35], v[228:231], 0
    v_mfma_f32_16x16x32_bf16 v[116:119], v[36:39], v[228:231], 0
    v_mfma_f32_16x16x32_bf16 v[120:123], v[40:43], v[228:231], 0
    v_mfma_f32_16x16x32_bf16 v[124:127], v[44:47], v[228:231], 0
    v_mfma_f32_16x16x32_bf16 v[128:131], v[48:51], v[228:231], 0
    v_mfma_f32_16x16x32_bf16 v[132:135], v[52:55], v[228:231], 0
    v_mfma_f32_16x16x32_bf16 v[136:139], v[56:59], v[228:231], 0
    v_mfma_f32_16x16x32_bf16 v[140:143], v[60:63], v[228:231], 0
    v_mfma_f32_16x16x32_bf16 v[144:147], v[64:67], v[228:231], 0
    v_mfma_f32_16x16x32_bf16 v[148:151], v[68:71], v[228:231], 0
    v_mfma_f32_16x16x32_bf16 v[152:155], v[72:75], v[228:231], 0
    v_mfma_f32_16x16x32_bf16 v[156:159], v[76:79], v[228:231], 0
    v_mfma_f32_16x16x32_bf16 v[160:163], v[80:83], v[228:231], 0
    v_mfma_f32_16x16x32_bf16 v[164:167], v[84:87], v[228:231], 0
    v_mfma_f32_16x16x32_bf16 v[168:171], v[88:91], v[228:231], 0
    v_mfma_f32_16x16x32_bf16 v[172:175], v[92:95], v[228:231], 0
    s_mov_b32 exec_lo, 0x00030003
    s_mov_b32 exec_hi, 0x00030003
    buffer_store_dwordx4 v[96:99], v237, s[64:67], s72 offen offset:0 sc1
    buffer_store_dwordx4 v[100:103], v237, s[64:67], s72 offen offset:64 sc1
    buffer_store_dwordx4 v[104:107], v237, s[64:67], s72 offen offset:128 sc1
    buffer_store_dwordx4 v[108:111], v237, s[64:67], s72 offen offset:192 sc1
    buffer_store_dwordx4 v[112:115], v237, s[64:67], s72 offen offset:256 sc1
    buffer_store_dwordx4 v[116:119], v237, s[64:67], s72 offen offset:320 sc1
    buffer_store_dwordx4 v[120:123], v237, s[64:67], s72 offen offset:384 sc1
    buffer_store_dwordx4 v[124:127], v237, s[64:67], s72 offen offset:448 sc1
    buffer_store_dwordx4 v[128:131], v237, s[64:67], s72 offen offset:512 sc1
    buffer_store_dwordx4 v[132:135], v237, s[64:67], s72 offen offset:576 sc1
    buffer_store_dwordx4 v[136:139], v237, s[64:67], s72 offen offset:640 sc1
    buffer_store_dwordx4 v[140:143], v237, s[64:67], s72 offen offset:704 sc1
    buffer_store_dwordx4 v[144:147], v237, s[64:67], s72 offen offset:768 sc1
    buffer_store_dwordx4 v[148:151], v237, s[64:67], s72 offen offset:832 sc1
    buffer_store_dwordx4 v[152:155], v237, s[64:67], s72 offen offset:896 sc1
    buffer_store_dwordx4 v[156:159], v237, s[64:67], s72 offen offset:960 sc1
    buffer_store_dwordx4 v[160:163], v237, s[64:67], s72 offen offset:1024 sc1
    buffer_store_dwordx4 v[164:167], v237, s[64:67], s72 offen offset:1088 sc1
    buffer_store_dwordx4 v[168:171], v237, s[64:67], s72 offen offset:1152 sc1
    buffer_store_dwordx4 v[172:175], v237, s[64:67], s72 offen offset:1216 sc1
    s_mov_b64 exec, -1
    s_mul_i32 s3, s73, 2560
    s_lshl2_add_u32 s3, s44, s3
    s_add_u32 s3, s3, 568320
    v_lshl_add_u32 v2, v1, 8, s3
    s_mov_b64 exec, 0x3ff
    s_waitcnt vmcnt(0)
    global_store_dword v2, v13, s[10:11] sc1
    s_mov_b64 exec, -1
    s_branch K_P2_HELP
K_CODE_END:
.section .rodata,"a"
.p2align 6
.amdhsa_kernel gated_mix__sliding_local_dilated__moe_arch_mod__prompt_kernel
  .amdhsa_next_free_vgpr 248
  .amdhsa_next_free_sgpr 79
  .amdhsa_accum_offset 248
  .amdhsa_group_segment_fixed_size 0
  .amdhsa_kernarg_size 96
  .amdhsa_user_sgpr_count 2
  .amdhsa_user_sgpr_kernarg_segment_ptr 1
  .amdhsa_system_sgpr_workgroup_id_x 1
.end_amdhsa_kernel
```

```asm
; @launch grid=(256,1,1) block=(512,1,1) lds=163840
.amdgcn_target "amdgcn-amd-amdhsa--gfx950"
.text
.p2align 12
.p2align 8
.globl gated_mix__sliding_local_dilated__moe_arch_mod__prompt_kernel
.type gated_mix__sliding_local_dilated__moe_arch_mod__prompt_kernel,@function
gated_mix__sliding_local_dilated__moe_arch_mod__prompt_kernel:
    s_cmp_ge_u32 s2, 256
    s_cbranch_scc1 K_EXIT
    s_load_dwordx2 s[12:13], s[0:1], 0
    s_load_dwordx2 s[16:17], s[0:1], 8
    v_readfirstlane_b32 s30, v0
    s_load_dwordx4 s[8:11], s[0:1], 80
    s_load_dwordx2 s[24:25], s[0:1], 16
    s_load_dwordx2 s[6:7], s[0:1], 72
    s_and_b32 s28, s2, 7
    v_and_b32 v1, 63, v0
    s_mov_b32 s14, 0x280000
    s_mov_b32 s15, 0x20000
    s_lshr_b32 s30, s30, 6
    s_cmp_lt_u32 s2, 64
    s_cbranch_scc1 K_SLOW
    s_cmp_lt_u32 s30, 4
    s_cbranch_scc1 K_FAST
K_SLOW:
    s_getpc_b64 s[38:39]
K_PC:
    s_bfe_u32 s3, s2, 0x30003
    s_mul_i32 s3, s3, ((K_CODE_END-gated_mix__sliding_local_dilated__moe_arch_mod__prompt_kernel+1023)/1024)
    s_sub_u32 s38, s38, K_PC-gated_mix__sliding_local_dilated__moe_arch_mod__prompt_kernel
    s_subb_u32 s39, s39, 0
    v_subrev_u32 v3, 256, v0
    v_add_u32 v2, s3, v3
    v_lshlrev_b32 v2, 7, v2
    v_min_u32 v2, K_CODE_END-gated_mix__sliding_local_dilated__moe_arch_mod__prompt_kernel-4, v2
    v_cmp_gt_u32 vcc, ((K_CODE_END-gated_mix__sliding_local_dilated__moe_arch_mod__prompt_kernel+1023)/1024), v3
    s_and_saveexec_b64 s[4:5], vcc
    s_cbranch_execz K_NOPF
    global_load_dword v6, v2, s[38:39]
K_NOPF:
    s_mov_b64 exec, -1
    v_mov_b32 v2, 0
    v_mov_b32 v3, 158752
    ds_write2_b32 v3, v2, v2 offset0:0 offset1:1
    ds_write2_b32 v3, v2, v2 offset0:2 offset1:3
    ds_write2_b32 v3, v2, v2 offset0:4 offset1:5
    ds_write2_b32 v3, v2, v2 offset0:6 offset1:7
    ds_write2_b32 v3, v2, v2 offset0:8 offset1:9
    ds_write2_b32 v3, v2, v2 offset0:10 offset1:11
    s_mov_b32 s43, 1
    s_lshl_b32 s3, s30, 8
    s_add_u32 s3, s3, s2
    s_lshr_b32 s3, s3, 3
    s_cmp_lg_u32 s3, 160
    s_cbranch_scc1 K_COMMON
    s_mul_i32 s3, s2, 6144
    s_add_u32 s3, s3, 527360
    v_lshl_add_u32 v6, v1, 4, s3
    v_mov_b64 v[28:29], 0
    v_mov_b64 v[30:31], 0
    s_waitcnt lgkmcnt(0)
    global_store_dwordx4 v6, v[28:31], s[10:11] offset:-3072 sc1
    global_store_dwordx4 v6, v[28:31], s[10:11] offset:-2048 sc1
    global_store_dwordx4 v6, v[28:31], s[10:11] offset:-1024 sc1
    global_store_dwordx4 v6, v[28:31], s[10:11] offset:0 sc1
    global_store_dwordx4 v6, v[28:31], s[10:11] offset:1024 sc1
    global_store_dwordx4 v6, v[28:31], s[10:11] offset:2048 sc1
    s_lshl_b32 s3, s2, 2
    v_mov_b32 v2, s3
    v_mov_b32 v3, 1
    s_mov_b64 exec, 1
    s_waitcnt vmcnt(0)
    global_store_dword v2, v3, s[8:9] offset:192 sc1
    s_mov_b64 exec, -1
    s_branch K_COMMON
K_FAST:
    s_lshr_b32 s32, s2, 1
    s_and_b32 s32, s32, 28
    v_lshrrev_b32 v3, 4, v1
    s_lshr_b32 s3, s2, 6
    s_mov_b32 s59, 0x59608237
    s_cmp_eq_u32 s3, 2
    s_cselect_b32 s59, 0x26375904, s59
    v_and_b32 v4, 7, v1
    s_cmp_eq_u32 s3, 3
    s_cselect_b32 s59, 0x93042671, s59
    v_lshrrev_b32 v2, 3, v1
    s_lshr_b32 s59, s59, s32
    s_and_b32 s59, s59, 15
    v_xor_b32 v4, v4, v3
    s_lshl_b32 s33, s28, 2
    s_lshr_b32 s33, 0x76543210, s33
    s_and_b32 s33, s33, 15
    s_add_u32 s59, s59, s33
    s_cmp_ge_u32 s59, 10
    v_mul_u32_u24 v2, 1280, v2
    s_cselect_b32 s33, 10, 0
    s_sub_u32 s59, s59, s33
    s_lshr_b32 s53, s28, 1
    v_lshl_add_u32 v44, v4, 4, v2
    s_mul_i32 s53, s53, 655360
    s_lshl2_add_u32 s62, s3, s30
    s_cmp_eq_u32 s62, 15
    s_cselect_b32 s62, 0x800000, 0
    s_add_u32 s62, s62, 40960
    s_mul_i32 s3, s3, 225280
    v_xor_b32 v45, 64, v44
    s_add_u32 s53, s53, s3
    s_mul_i32 s54, s30, 61440
    s_add_u32 s53, s53, s54
    s_sub_u32 s53, s53, 245760
    s_mul_i32 s55, s30, 6144
    s_add_u32 s55, s55, 40960
    s_lshl_b32 s57, s59, 7
    s_add_u32 s57, s57, s53
    s_waitcnt lgkmcnt(0)
    s_add_u32 m0, s55, 0
    s_max_i32 s60, s57, 0
    buffer_load_dwordx4 v44, s[12:15], s60 offen lds
    s_add_u32 s60, s57, 10240
    s_add_u32 m0, s55, 1024
    s_max_i32 s60, s60, 0
    buffer_load_dwordx4 v45, s[12:15], s60 offen lds
    s_add_u32 m0, s55, 2048
    s_add_u32 s60, s57, 20480
    buffer_load_dwordx4 v44, s[12:15], s60 offen lds
    s_add_u32 m0, s55, 3072
    s_add_u32 s60, s57, 30720
    buffer_load_dwordx4 v45, s[12:15], s60 offen lds
    s_add_u32 m0, s55, 4096
    s_add_u32 s60, s57, s62
    buffer_load_dwordx4 v44, s[12:15], s60 offen lds
    s_add_u32 m0, s55, 5120
    s_add_u32 s60, s60, 10240
    buffer_load_dwordx4 v45, s[12:15], s60 offen lds
    v_lshlrev_b32 v2, 1, v3
    s_lshr_b32 s32, 0x64317520, s32
    v_sub_u32 v2, v1, v2
    s_and_b32 s32, s32, 7
    v_and_b32 v2, 15, v2
    s_and_b32 s3, s28, 1
    v_mul_u32_u24 v3, 3840, v3
    s_lshl3_add_u32 s32, s3, s32
    v_mul_u32_u24 v4, 13, v2
    s_mul_i32 s3, s32, 80
    v_lshrrev_b32 v4, 6, v4
    s_add_u32 s54, s54, s3
    v_mul_u32_u24 v4, 1200, v4
    s_lshl_b32 s56, s30, 12
    v_lshl_add_u32 v4, v2, 4, v4
    s_add_u32 s56, s56, 65536
    v_add_u32 v5, 1, v2
    s_mov_b32 s18, 0x258000
    v_and_b32 v5, 16, v5
    s_mov_b32 s19, 0x20000
    v_lshl_add_u32 v4, v5, 24, v4
    v_add_u32 v46, v3, v4
    s_mul_i32 s58, s59, 245760
    s_add_u32 s58, s58, s54
    s_add_u32 s59, s59, 1
    s_cmp_eq_u32 s59, 10
    s_cselect_b32 s59, 0, s59
    s_add_u32 m0, s56, 0
    s_add_u32 s60, s58, 0
    buffer_load_dwordx4 v46, s[16:19], s60 offen lds
    s_add_u32 m0, s56, 1024
    s_add_u32 s60, s58, 15360
    buffer_load_dwordx4 v46, s[16:19], s60 offen lds
    v_xor_b32 v2, 8, v2
    v_mul_u32_u24 v4, 13, v2
    v_lshrrev_b32 v4, 6, v4
    v_mul_u32_u24 v4, 1200, v4
    v_lshl_add_u32 v4, v2, 4, v4
    v_add_u32 v5, 1, v2
    v_and_b32 v5, 16, v5
    v_lshl_add_u32 v4, v5, 24, v4
    v_add_u32 v47, v3, v4
    s_add_u32 m0, s56, 2048
    s_add_u32 s60, s58, 30720
    buffer_load_dwordx4 v47, s[16:19], s60 offen lds
    s_add_u32 m0, s56, 3072
    s_add_u32 s60, s58, 46080
    buffer_load_dwordx4 v47, s[16:19], s60 offen lds
    s_mov_b32 s3, 40960
    s_cmp_ge_u32 s55, 81920
    s_cselect_b32 s60, -81920, s3
    s_add_u32 s55, s55, s60
    s_add_u32 s56, s56, s60
    s_lshl_b32 s57, s59, 7
    s_add_u32 s57, s57, s53
    s_mul_i32 s58, s59, 245760
    s_add_u32 s58, s58, s54
    s_add_u32 s59, s59, 1
    s_cmp_eq_u32 s59, 10
    s_cselect_b32 s59, 0, s59
    s_add_u32 m0, s56, 0
    s_add_u32 s60, s58, 0
    buffer_load_dwordx4 v46, s[16:19], s60 offen lds
    s_add_u32 m0, s55, 0
    s_max_i32 s60, s57, 0
    buffer_load_dwordx4 v44, s[12:15], s60 offen lds
    s_add_u32 m0, s56, 1024
    s_add_u32 s60, s58, 15360
    buffer_load_dwordx4 v46, s[16:19], s60 offen lds
    s_add_u32 s60, s57, 10240
    s_add_u32 m0, s55, 1024
    s_max_i32 s60, s60, 0
    buffer_load_dwordx4 v45, s[12:15], s60 offen lds
    s_add_u32 m0, s55, 2048
    s_add_u32 s60, s57, 20480
    buffer_load_dwordx4 v44, s[12:15], s60 offen lds
    s_mov_b32 s52, s30
    s_mov_b32 s43, 0
K_COMMON:
    v_mov_b32 v7, 0
    s_lshr_b32 s29, s2, 3
    s_xor_b32 s30, s30, 4
    s_mov_b32 s26, 0xc8000
    s_mov_b32 s27, 0x20000
    s_lshr_b32 s34, s29, 3
    s_lshl_b32 s34, s34, 2
    s_and_b32 s3, s29, 3
    s_add_u32 s34, s34, s3
    s_add_u32 s34, s34, 4
    s_bitcmp1_b32 s29, 2
    s_cselect_b32 s34, -1, s34
    s_cmp_lt_u32 s29, 8
    s_cselect_b32 s34, s29, s34
    s_lshl_b32 s40, s28, 1
    s_cmp_ge_u32 s34, 10
    s_addc_u32 s40, s40, 0
    s_sub_u32 s41, s34, 10
    s_cmp_ge_u32 s34, 10
    s_cselect_b32 s41, s41, s34
    s_mul_i32 s42, s28, 20
    s_add_u32 s42, s42, s34
    s_and_b32 s42, s42, 255
    s_lshl_b32 s42, s42, 8
    s_add_u32 s42, s42, 524288
    s_cmp_lt_u32 s29, 8
    s_cbranch_scc1 K_AUX
    s_lshr_b32 s31, s29, 3
    s_sub_u32 s31, s31, 1
    s_and_b32 s35, s29, 3
    s_and_b32 s3, s29, 4
    s_lshl_b32 s3, s3, 1
    s_add_u32 s35, s35, s3
    s_and_b32 s3, s28, 1
    s_lshl_b32 s3, s3, 2
    s_add_u32 s35, s35, s3
    v_and_b32 v9, 15, v1
    v_lshrrev_b32 v10, 4, v1
    v_bfe_u32 v11, v1, 2, 2
    v_and_b32 v12, 3, v1
    s_waitcnt lgkmcnt(0)
    s_add_u32 s20, s10, 0x100000
    s_addc_u32 s21, s11, 0
    s_mov_b32 s22, 0x280000
    s_mov_b32 s23, 0x20000
    s_and_b32 s3, s30, 3
    s_mul_i32 s3, s3, 3
    s_lshr_b32 s33, s30, 2
    s_lshl1_add_u32 s3, s33, s3
    s_mul_i32 s44, s31, 11
    s_add_u32 s44, s44, s3
    s_cmp_eq_u32 s44, 31
    s_cselect_b32 s51, 4, s30
    s_lshr_b32 s33, s28, 1
    s_lshl_b32 s33, s33, 5
    s_add_u32 s44, s44, s33
    s_mul_i32 s3, s3, 4352
    s_add_u32 s3, s3, 81920
    v_mul_u32_u24 v14, 272, v9
    v_lshl_add_u32 v13, v10, 3, v14
    v_add_u32 v13, s3, v13
    v_add3_u32 v14, v14, 32, s3
    v_cmp_eq_u32 vcc, 0, v10
    v_add_u32 v2, 208, v14
    v_add_u32 v3, 0, v14
    v_add_u32 v4, 40, v14
    v_cndmask_b32 v19, v2, v3, vcc
    v_cndmask_b32 v20, v2, v4, vcc
    v_lshl_add_u32 v15, v10, 2, v11
    v_mul_u32_u24 v15, 272, v15
    v_add_u32 v5, s3, v15
    v_lshl_add_u32 v15, v12, 3, v5
    v_add_u32 v2, 240, v5
    v_add_u32 v3, 192, v5
    v_add_u32 v4, 232, v5
    v_cmp_eq_u32 vcc, 0, v12
    s_nop 1
    v_cndmask_b32 v21, v2, v3, vcc
    v_cmp_eq_u32 vcc, 1, v12
    s_nop 1
    v_cndmask_b32 v22, v2, v4, vcc
    v_cmp_eq_u32 vcc, 2, v12
    s_nop 1
    v_cndmask_b32 v23, v2, v3, vcc
    v_cmp_eq_u32 vcc, 3, v12
    s_nop 1
    v_cndmask_b32 v24, v2, v4, vcc
    s_lshl_b32 s3, s35, 10
    v_lshl_add_u32 v16, v1, 4, s3
    s_lshl_b32 s3, s35, 8
    s_add_u32 s3, s3, 16384
    v_lshl_add_u32 v17, v9, 4, s3
    v_and_b32 v2, 1, v10
    v_lshl_add_u32 v17, v2, 3, v17
    s_cmp_lt_u32 s51, 4
    s_cselect_b32 s3, 0, 0x800000
    s_add_u32 s3, s3, 20480
    v_lshrrev_b32 v2, 1, v10
    v_mad_u32_u24 v17, v2, s3, v17
    s_mul_i32 s50, s44, 20480
    s_add_u32 s51, s50, s3
    v_mov_b32 v18, 0xf149f2ca
    v_lshlrev_b32 v2, 2, v10
    v_sub_u32 v2, v9, v2
    s_cmp_eq_u32 s44, 0
    s_cselect_b32 s3, 0xf149f2ca, 0
    v_subrev_u32 v3, 0, v2
    v_and_b32 v4, 0x80000001, v3
    v_cmp_eq_u32 vcc, 0, v4
    s_nop 1
    v_cndmask_b32 v32, v18, 0, vcc
    v_cmp_eq_u32 vcc, 0x80000000, v4
    s_nop 1
    v_cndmask_b32 v28, v18, 0, vcc
    v_add_f32 v36, s3, v28
    v_subrev_u32 v3, 1, v2
    v_and_b32 v4, 0x80000001, v3
    v_cmp_eq_u32 vcc, 0, v4
    s_nop 1
    v_cndmask_b32 v33, v18, 0, vcc
    v_cmp_eq_u32 vcc, 0x80000000, v4
    s_nop 1
    v_cndmask_b32 v29, v18, 0, vcc
    v_add_f32 v37, s3, v29
    v_subrev_u32 v3, 2, v2
    v_and_b32 v4, 0x80000001, v3
    v_cmp_eq_u32 vcc, 0, v4
    s_nop 1
    v_cndmask_b32 v34, v18, 0, vcc
    v_cmp_eq_u32 vcc, 0x80000000, v4
    s_nop 1
    v_cndmask_b32 v30, v18, 0, vcc
    v_add_f32 v38, s3, v30
    v_subrev_u32 v3, 3, v2
    v_and_b32 v4, 0x80000001, v3
    v_cmp_eq_u32 vcc, 0, v4
    s_nop 1
    v_cndmask_b32 v35, v18, 0, vcc
    v_cmp_eq_u32 vcc, 0x80000000, v4
    s_nop 1
    v_cndmask_b32 v31, v18, 0, vcc
    v_add_f32 v39, s3, v31
    v_mov_b32 v3, 0x0c0c0c0c
    v_mov_b32 v4, 0xc0c0100
    v_cmp_eq_u32 vcc, 0, v28
    v_mov_b32 v5, 0x1000c0c
    s_nop 0
    v_cndmask_b32 v3, v3, v4, vcc
    v_cmp_eq_u32 vcc, 0, v29
    s_nop 1
    v_cndmask_b32 v40, v3, v5, vcc
    v_mov_b32 v3, 0x0c0c0c0c
    v_mov_b32 v4, 0xc0c0302
    v_cmp_eq_u32 vcc, 0, v30
    v_mov_b32 v5, 0x3020c0c
    s_nop 0
    v_cndmask_b32 v3, v3, v4, vcc
    v_cmp_eq_u32 vcc, 0, v31
    s_nop 1
    v_cndmask_b32 v41, v3, v5, vcc
    v_mov_b32 v3, 0x0c0c0c0c
    v_mov_b32 v4, 0xc0c0100
    v_cmp_eq_u32 vcc, 0, v32
    v_mov_b32 v5, 0x1000c0c
    s_nop 0
    v_cndmask_b32 v3, v3, v4, vcc
    v_cmp_eq_u32 vcc, 0, v33
    s_nop 1
    v_cndmask_b32 v42, v3, v5, vcc
    v_mov_b32 v3, 0x0c0c0c0c
    v_mov_b32 v4, 0xc0c0302
    v_cmp_eq_u32 vcc, 0, v34
    v_mov_b32 v5, 0x3020c0c
    s_nop 0
    v_cndmask_b32 v3, v3, v4, vcc
    v_cmp_eq_u32 vcc, 0, v35
    s_nop 1
    v_cndmask_b32 v43, v3, v5, vcc
    s_mov_b32 s46, 0x3fb8aa3b
    s_mov_b32 s47, s46
    s_mov_b32 s48, 0x3e64f92e
    s_mov_b32 s49, s48
    s_mov_b32 s36, 0xfffff
    s_cmp_lg_u32 s31, 0
    s_cselect_b32 s33, 64, 0
    v_mov_b32 v2, s33
    v_cmp_gt_u32 vcc, 10, v1
    s_lshr_b32 s3, s28, 1
    s_lshl2_add_u32 s3, s3, s31
    v_cndmask_b32 v2, 0, v2, vcc
    v_lshl_add_u32 v2, v1, 8, v2
    s_mul_i32 s3, s3, 2560
    s_lshl2_add_u32 s3, s35, s3
    s_add_u32 s3, s3, 524288
    v_add_u32 v8, s3, v2
    s_cmp_eq_u32 s43, 1
    s_cbranch_scc1 K_CONS
    v_lshrrev_b32 v2, 3, v1
    v_mul_u32_u24 v2, 1280, v2
    v_lshrrev_b32 v3, 4, v1
    v_lshlrev_b32 v3, 1, v3
    v_and_b32 v4, 7, v1
    v_xor_b32 v3, v3, v4
    v_lshl_add_u32 v2, v3, 4, v2
    s_lshl_b32 s33, s41, 7
    v_add_u32 v18, s33, v2
    s_mov_b32 s61, 9
    s_mov_b32 s3, 40960
K_LOOP0:
    s_waitcnt vmcnt(5)
    s_barrier
    s_add_u32 m0, s56, 2048
    s_add_u32 s60, s58, 30720
    buffer_load_dwordx4 v47, s[16:19], s60 offen lds
    s_add_u32 m0, s55, 3072
    s_add_u32 s60, s57, 30720
    buffer_load_dwordx4 v45, s[12:15], s60 offen lds
    s_add_u32 m0, s56, 3072
    s_add_u32 s60, s58, 46080
    buffer_load_dwordx4 v47, s[16:19], s60 offen lds
    s_add_u32 m0, s55, 4096
    s_add_u32 s60, s57, s62
    buffer_load_dwordx4 v44, s[12:15], s60 offen lds
    s_add_u32 m0, s55, 5120
    s_add_u32 s60, s60, 10240
    buffer_load_dwordx4 v45, s[12:15], s60 offen lds
    s_sub_u32 s61, s61, 1
    s_cmp_eq_u32 s61, 0
    s_cbranch_scc1 K_LOOPX
    s_cmp_ge_u32 s55, 81920
    s_cselect_b32 s60, -81920, s3
    s_add_u32 s55, s55, s60
    s_add_u32 s56, s56, s60
    s_lshl_b32 s57, s59, 7
    s_add_u32 s57, s57, s53
    s_mul_i32 s58, s59, 245760
    s_add_u32 s58, s58, s54
    s_add_u32 s59, s59, 1
    s_cmp_eq_u32 s59, 10
    s_cselect_b32 s59, 0, s59
    s_add_u32 m0, s56, 0
    s_add_u32 s60, s58, 0
    buffer_load_dwordx4 v46, s[16:19], s60 offen lds
    s_add_u32 m0, s55, 0
    s_max_i32 s60, s57, 0
    buffer_load_dwordx4 v44, s[12:15], s60 offen lds
    s_add_u32 m0, s56, 1024
    s_add_u32 s60, s58, 15360
    buffer_load_dwordx4 v46, s[16:19], s60 offen lds
    s_add_u32 s60, s57, 10240
    s_add_u32 m0, s55, 1024
    s_max_i32 s60, s60, 0
    buffer_load_dwordx4 v45, s[12:15], s60 offen lds
    s_add_u32 m0, s55, 2048
    s_add_u32 s60, s57, 20480
    buffer_load_dwordx4 v44, s[12:15], s60 offen lds
    s_branch K_LOOP0
K_LOOPX:
    v_and_b32 v2, 7, v1
    v_lshlrev_b32 v2, 2, v2
    s_waitcnt vmcnt(0)
    s_barrier
    s_cmp_lt_u32 s30, 6
    s_cbranch_scc1 K_NOSMP
    global_load_dword v7, v2, s[8:9] offset:192 sc1
K_NOSMP:
    s_cmp_eq_u32 s34, -1
    s_cbranch_scc1 K_JOIN_S
    s_cmp_lt_u32 s52, 2
    s_cbranch_scc1 K_WOE
    s_cmp_lg_u32 s30, 7
    s_cbranch_scc1 K_JOIN_S
    s_mov_b32 s52, 2
    s_branch K_W7A
K_WOE:
    s_lshl_b32 s57, s52, 2
    s_lshr_b32 s57, 0x7520, s57
    s_and_b32 s57, s57, 7
    s_mul_i32 s57, s57, 51200
    s_mul_i32 s58, s52, 5120
    s_add_u32 s3, s57, 0
    s_add_u32 m0, s58, 0
    s_nop 0
    buffer_load_dwordx4 v18, s[24:27], s3 offen lds
    s_add_u32 s3, s57, 10240
    s_add_u32 m0, s58, 1024
    s_nop 0
    buffer_load_dwordx4 v18, s[24:27], s3 offen lds
    s_add_u32 s3, s57, 20480
    s_add_u32 m0, s58, 2048
    s_nop 0
    buffer_load_dwordx4 v18, s[24:27], s3 offen lds
    s_add_u32 s3, s57, 30720
    s_add_u32 m0, s58, 3072
    s_nop 0
    buffer_load_dwordx4 v18, s[24:27], s3 offen lds
    s_add_u32 s3, s57, 40960
    s_add_u32 m0, s58, 4096
    s_nop 0
    buffer_load_dwordx4 v18, s[24:27], s3 offen lds
    s_add_u32 s3, s57, 409600
    s_add_u32 m0, s58, 20480
    s_nop 0
    buffer_load_dwordx4 v18, s[24:27], s3 offen lds
    s_add_u32 s3, s57, 419840
    s_add_u32 m0, s58, 21504
    s_nop 0
    buffer_load_dwordx4 v18, s[24:27], s3 offen lds
    s_add_u32 s3, s57, 430080
    s_add_u32 m0, s58, 22528
    s_nop 0
    buffer_load_dwordx4 v18, s[24:27], s3 offen lds
    s_add_u32 s3, s57, 440320
    s_add_u32 m0, s58, 23552
    s_nop 0
    buffer_load_dwordx4 v18, s[24:27], s3 offen lds
    s_add_u32 s3, s57, 450560
    s_add_u32 m0, s58, 24576
    s_nop 0
    buffer_load_dwordx4 v18, s[24:27], s3 offen lds
    s_cmp_lg_u32 s30, 7
    s_cbranch_scc1 K_JOIN_S
    s_add_u32 s52, s52, 1
    s_cmp_lt_u32 s52, 4
    s_cbranch_scc1 K_WOE
    s_mov_b32 s52, 0
K_XD:
    s_lshl_b32 s57, s40, 3
    s_lshl1_add_u32 s57, s52, s57
    s_mul_i32 s57, s57, 20480
    s_lshl_b32 s33, s41, 7
    s_add_u32 s57, s57, s33
    s_lshl_b32 s33, s52, 12
    s_add_u32 m0, s33, 140288
    s_add_u32 s3, s57, 0
    buffer_load_dwordx4 v44, s[12:15], s3 offen lds
    s_add_u32 m0, s33, 141312
    s_add_u32 s3, s57, 10240
    buffer_load_dwordx4 v45, s[12:15], s3 offen lds
    s_add_u32 m0, s33, 142336
    s_add_u32 s3, s57, 20480
    buffer_load_dwordx4 v44, s[12:15], s3 offen lds
    s_add_u32 m0, s33, 143360
    s_add_u32 s3, s57, 30720
    buffer_load_dwordx4 v45, s[12:15], s3 offen lds
    s_add_u32 s52, s52, 1
    s_cmp_lt_u32 s52, 4
    s_cbranch_scc1 K_XD
    s_branch K_W7
.p2align 12
K_CONS:
    s_lshr_b32 s52, s30, 1
    s_and_b32 s53, s30, 1
    v_lshrrev_b32 v2, 1, v9
    v_xor_b32 v2, v2, v10
    v_lshlrev_b32 v2, 4, v2
    v_lshl_add_u32 v2, v9, 7, v2
    s_mul_i32 s3, s52, 12288
    v_add_u32 v44, s3, v2
    v_xor_b32 v45, 64, v44
    v_add_u32 v46, 81920, v44
    v_add_u32 v47, 81920, v45
    v_and_b32 v2, 1, v10
    v_lshl_or_b32 v2, v2, 2, v11
    v_lshl_add_u32 v3, v10, 3, v11
    v_lshlrev_b32 v3, 8, v3
    v_lshl_add_u32 v3, v12, 3, v3
    v_add_u32 v3, 24576, v3
    s_lshl_b32 s3, s53, 2
    v_add_u32 v2, s3, v2
    v_add_u32 v4, 0, v2
    v_and_b32 v4, 7, v4
    v_lshl_add_u32 v48, v4, 5, v3
    v_add_u32 v52, 81920, v48
    v_add_u32 v4, 1, v2
    v_and_b32 v4, 7, v4
    v_lshl_add_u32 v49, v4, 5, v3
    v_add_u32 v53, 81920, v49
    v_add_u32 v4, 2, v2
    v_and_b32 v4, 7, v4
    v_lshl_add_u32 v50, v4, 5, v3
    v_add_u32 v54, 81920, v50
    v_add_u32 v4, 3, v2
    v_and_b32 v4, 7, v4
    v_lshl_add_u32 v51, v4, 5, v3
    v_add_u32 v55, 81920, v51
    v_mul_u32_u24 v56, 272, v9
    v_lshl_add_u32 v56, v10, 3, v56
    s_mul_i32 s3, s52, 26112
    s_lshl_b32 s33, s53, 7
    s_add_u32 s3, s3, s33
    s_add_u32 s3, s3, 81920
    v_add_u32 v56, s3, v56
    v_mov_b64 v[60:61], 0
    v_mov_b64 v[62:63], 0
    v_mov_b64 v[64:65], 0
    v_mov_b64 v[66:67], 0
    v_mov_b64 v[68:69], 0
    v_mov_b64 v[70:71], 0
    v_mov_b64 v[72:73], 0
    v_mov_b64 v[74:75], 0
    v_mov_b64 v[76:77], 0
    v_mov_b64 v[78:79], 0
    v_mov_b64 v[80:81], 0
    v_mov_b64 v[82:83], 0
    v_mov_b64 v[84:85], 0
    v_mov_b64 v[86:87], 0
    v_mov_b64 v[88:89], 0
    v_mov_b64 v[90:91], 0
    v_mov_b64 v[92:93], 0
    v_mov_b64 v[94:95], 0
    v_mov_b64 v[96:97], 0
    v_mov_b64 v[98:99], 0
    v_mov_b64 v[100:101], 0
    v_mov_b64 v[102:103], 0
    v_mov_b64 v[104:105], 0
    v_mov_b64 v[106:107], 0
    v_mov_b64 v[108:109], 0
    v_mov_b64 v[110:111], 0
    v_mov_b64 v[112:113], 0
    v_mov_b64 v[114:115], 0
    v_mov_b64 v[116:117], 0
    v_mov_b64 v[118:119], 0
    v_mov_b64 v[120:121], 0
    v_mov_b64 v[122:123], 0
    v_mov_b64 v[124:125], 0
    v_mov_b64 v[126:127], 0
    v_mov_b64 v[128:129], 0
    v_mov_b64 v[130:131], 0
    v_mov_b64 v[132:133], 0
    v_mov_b64 v[134:135], 0
    v_mov_b64 v[136:137], 0
    v_mov_b64 v[138:139], 0
    v_mov_b64 v[140:141], 0
    v_mov_b64 v[142:143], 0
    v_mov_b64 v[144:145], 0
    v_mov_b64 v[146:147], 0
    v_mov_b64 v[148:149], 0
    v_mov_b64 v[150:151], 0
    v_mov_b64 v[152:153], 0
    v_mov_b64 v[154:155], 0
    s_mov_b32 s54, 3
    s_cmp_lg_u32 s30, 0
    s_cbranch_scc1 K_WARMM0
    s_call_b64 s[38:39], WP_attd
    s_call_b64 s[38:39], WP_p2g
    s_branch K_WARMMX
K_WARMM0:
    s_cmp_lg_u32 s30, 1
    s_cbranch_scc1 K_WARMM1
    s_call_b64 s[38:39], WP_atts
    s_call_b64 s[38:39], WP_early
    s_branch K_WARMMX
K_WARMM1:
    s_cmp_lg_u32 s30, 2
    s_cbranch_scc1 K_WARMM2
    s_call_b64 s[38:39], WP_help
    s_call_b64 s[38:39], WP_flags
    s_branch K_WARMMX
K_WARMM2:
    s_call_b64 s[38:39], WP_spin
K_WARMMX:
    s_barrier
    ds_read_b64_tr_b16 v[204:205], v48 offset:40960
    ds_read_b64_tr_b16 v[206:207], v48 offset:41984
    ds_read_b128 v[156:159], v44 offset:40960
    ds_read_b64_tr_b16 v[208:209], v49 offset:40960
    ds_read_b64_tr_b16 v[210:211], v49 offset:41984
    ds_read_b128 v[160:163], v44 offset:43008
    ds_read_b64_tr_b16 v[212:213], v50 offset:40960
    ds_read_b64_tr_b16 v[214:215], v50 offset:41984
    ds_read_b128 v[164:167], v44 offset:45056
    ds_read_b64_tr_b16 v[216:217], v51 offset:40960
    ds_read_b64_tr_b16 v[218:219], v51 offset:41984
    ds_read_b128 v[168:171], v44 offset:47104
    ds_read_b128 v[172:175], v44 offset:49152
    ds_read_b128 v[176:179], v44 offset:51200
K_CLOOP:
    s_waitcnt lgkmcnt(0)
    v_mfma_f32_16x16x32_bf16 v[60:63], v[204:207], v[156:159], v[60:63]
    ds_read_b64_tr_b16 v[220:221], v48 offset:49152
    v_mfma_f32_16x16x32_bf16 v[64:67], v[208:211], v[156:159], v[64:67]
    ds_read_b64_tr_b16 v[222:223], v48 offset:50176
    v_mfma_f32_16x16x32_bf16 v[68:71], v[212:215], v[156:159], v[68:71]
    ds_read_b128 v[180:183], v45 offset:40960
    v_mfma_f32_16x16x32_bf16 v[72:75], v[216:219], v[156:159], v[72:75]
    ds_read_b64_tr_b16 v[224:225], v49 offset:49152
    v_mfma_f32_16x16x32_bf16 v[88:91], v[216:219], v[160:163], v[88:91]
    ds_read_b64_tr_b16 v[226:227], v49 offset:50176
    v_mfma_f32_16x16x32_bf16 v[84:87], v[212:215], v[160:163], v[84:87]
    ds_read_b128 v[184:187], v45 offset:43008
    v_mfma_f32_16x16x32_bf16 v[80:83], v[208:211], v[160:163], v[80:83]
    ds_read_b64_tr_b16 v[228:229], v50 offset:49152
    v_mfma_f32_16x16x32_bf16 v[76:79], v[204:207], v[160:163], v[76:79]
    ds_read_b64_tr_b16 v[230:231], v50 offset:50176
    v_mfma_f32_16x16x32_bf16 v[92:95], v[204:207], v[164:167], v[92:95]
    ds_read_b128 v[188:191], v45 offset:45056
    v_mfma_f32_16x16x32_bf16 v[96:99], v[208:211], v[164:167], v[96:99]
    ds_read_b64_tr_b16 v[232:233], v51 offset:49152
    v_mfma_f32_16x16x32_bf16 v[100:103], v[212:215], v[164:167], v[100:103]
    ds_read_b64_tr_b16 v[234:235], v51 offset:50176
    v_mfma_f32_16x16x32_bf16 v[104:107], v[216:219], v[164:167], v[104:107]
    ds_read_b128 v[192:195], v45 offset:47104
    v_mfma_f32_16x16x32_bf16 v[120:123], v[216:219], v[168:171], v[120:123]
    ds_read_b128 v[196:199], v45 offset:49152
    v_mfma_f32_16x16x32_bf16 v[116:119], v[212:215], v[168:171], v[116:119]
    ds_read_b128 v[200:203], v45 offset:51200
    v_mfma_f32_16x16x32_bf16 v[112:115], v[208:211], v[168:171], v[112:115]
    v_mfma_f32_16x16x32_bf16 v[108:111], v[204:207], v[168:171], v[108:111]
    v_mfma_f32_16x16x32_bf16 v[124:127], v[204:207], v[172:175], v[124:127]
    v_mfma_f32_16x16x32_bf16 v[128:131], v[208:211], v[172:175], v[128:131]
    v_mfma_f32_16x16x32_bf16 v[132:135], v[212:215], v[172:175], v[132:135]
    v_mfma_f32_16x16x32_bf16 v[136:139], v[216:219], v[172:175], v[136:139]
    v_mfma_f32_16x16x32_bf16 v[152:155], v[216:219], v[176:179], v[152:155]
    v_mfma_f32_16x16x32_bf16 v[148:151], v[212:215], v[176:179], v[148:151]
    v_mfma_f32_16x16x32_bf16 v[144:147], v[208:211], v[176:179], v[144:147]
    v_mfma_f32_16x16x32_bf16 v[140:143], v[204:207], v[176:179], v[140:143]
    s_waitcnt lgkmcnt(0)
    s_barrier
    v_mfma_f32_16x16x32_bf16 v[60:63], v[220:223], v[180:183], v[60:63]
    ds_read_b64_tr_b16 v[204:205], v52 offset:0
    v_mfma_f32_16x16x32_bf16 v[64:67], v[224:227], v[180:183], v[64:67]
    ds_read_b64_tr_b16 v[206:207], v52 offset:1024
    v_mfma_f32_16x16x32_bf16 v[68:71], v[228:231], v[180:183], v[68:71]
    ds_read_b128 v[156:159], v46 offset:0
    v_mfma_f32_16x16x32_bf16 v[72:75], v[232:235], v[180:183], v[72:75]
    ds_read_b64_tr_b16 v[208:209], v53 offset:0
    v_mfma_f32_16x16x32_bf16 v[88:91], v[232:235], v[184:187], v[88:91]
    ds_read_b64_tr_b16 v[210:211], v53 offset:1024
    v_mfma_f32_16x16x32_bf16 v[84:87], v[228:231], v[184:187], v[84:87]
    ds_read_b128 v[160:163], v46 offset:2048
    v_mfma_f32_16x16x32_bf16 v[80:83], v[224:227], v[184:187], v[80:83]
    ds_read_b64_tr_b16 v[212:213], v54 offset:0
    v_mfma_f32_16x16x32_bf16 v[76:79], v[220:223], v[184:187], v[76:79]
    ds_read_b64_tr_b16 v[214:215], v54 offset:1024
    v_mfma_f32_16x16x32_bf16 v[92:95], v[220:223], v[188:191], v[92:95]
    ds_read_b128 v[164:167], v46 offset:4096
    v_mfma_f32_16x16x32_bf16 v[96:99], v[224:227], v[188:191], v[96:99]
    ds_read_b64_tr_b16 v[216:217], v55 offset:0
    v_mfma_f32_16x16x32_bf16 v[100:103], v[228:231], v[188:191], v[100:103]
    ds_read_b64_tr_b16 v[218:219], v55 offset:1024
    v_mfma_f32_16x16x32_bf16 v[104:107], v[232:235], v[188:191], v[104:107]
    ds_read_b128 v[168:171], v46 offset:6144
    v_mfma_f32_16x16x32_bf16 v[120:123], v[232:235], v[192:195], v[120:123]
    ds_read_b128 v[172:175], v46 offset:8192
    v_mfma_f32_16x16x32_bf16 v[116:119], v[228:231], v[192:195], v[116:119]
    ds_read_b128 v[176:179], v46 offset:10240
    v_mfma_f32_16x16x32_bf16 v[112:115], v[224:227], v[192:195], v[112:115]
    v_mfma_f32_16x16x32_bf16 v[108:111], v[220:223], v[192:195], v[108:111]
    v_mfma_f32_16x16x32_bf16 v[124:127], v[220:223], v[196:199], v[124:127]
    v_mfma_f32_16x16x32_bf16 v[128:131], v[224:227], v[196:199], v[128:131]
    v_mfma_f32_16x16x32_bf16 v[132:135], v[228:231], v[196:199], v[132:135]
    v_mfma_f32_16x16x32_bf16 v[136:139], v[232:235], v[196:199], v[136:139]
    v_mfma_f32_16x16x32_bf16 v[152:155], v[232:235], v[200:203], v[152:155]
    v_mfma_f32_16x16x32_bf16 v[148:151], v[228:231], v[200:203], v[148:151]
    v_mfma_f32_16x16x32_bf16 v[144:147], v[224:227], v[200:203], v[144:147]
    v_mfma_f32_16x16x32_bf16 v[140:143], v[220:223], v[200:203], v[140:143]
    s_waitcnt lgkmcnt(0)
    v_mfma_f32_16x16x32_bf16 v[60:63], v[204:207], v[156:159], v[60:63]
    ds_read_b64_tr_b16 v[220:221], v52 offset:8192
    v_mfma_f32_16x16x32_bf16 v[64:67], v[208:211], v[156:159], v[64:67]
    ds_read_b64_tr_b16 v[222:223], v52 offset:9216
    v_mfma_f32_16x16x32_bf16 v[68:71], v[212:215], v[156:159], v[68:71]
    ds_read_b128 v[180:183], v47 offset:0
    v_mfma_f32_16x16x32_bf16 v[72:75], v[216:219], v[156:159], v[72:75]
    ds_read_b64_tr_b16 v[224:225], v53 offset:8192
    v_mfma_f32_16x16x32_bf16 v[88:91], v[216:219], v[160:163], v[88:91]
    ds_read_b64_tr_b16 v[226:227], v53 offset:9216
    v_mfma_f32_16x16x32_bf16 v[84:87], v[212:215], v[160:163], v[84:87]
    ds_read_b128 v[184:187], v47 offset:2048
    v_mfma_f32_16x16x32_bf16 v[80:83], v[208:211], v[160:163], v[80:83]
    ds_read_b64_tr_b16 v[228:229], v54 offset:8192
    v_mfma_f32_16x16x32_bf16 v[76:79], v[204:207], v[160:163], v[76:79]
    ds_read_b64_tr_b16 v[230:231], v54 offset:9216
    v_mfma_f32_16x16x32_bf16 v[92:95], v[204:207], v[164:167], v[92:95]
    ds_read_b128 v[188:191], v47 offset:4096
    v_mfma_f32_16x16x32_bf16 v[96:99], v[208:211], v[164:167], v[96:99]
    ds_read_b64_tr_b16 v[232:233], v55 offset:8192
    v_mfma_f32_16x16x32_bf16 v[100:103], v[212:215], v[164:167], v[100:103]
    ds_read_b64_tr_b16 v[234:235], v55 offset:9216
    v_mfma_f32_16x16x32_bf16 v[104:107], v[216:219], v[164:167], v[104:107]
    ds_read_b128 v[192:195], v47 offset:6144
    v_mfma_f32_16x16x32_bf16 v[120:123], v[216:219], v[168:171], v[120:123]
    ds_read_b128 v[196:199], v47 offset:8192
    v_mfma_f32_16x16x32_bf16 v[116:119], v[212:215], v[168:171], v[116:119]
    ds_read_b128 v[200:203], v47 offset:10240
    v_mfma_f32_16x16x32_bf16 v[112:115], v[208:211], v[168:171], v[112:115]
    v_mfma_f32_16x16x32_bf16 v[108:111], v[204:207], v[168:171], v[108:111]
    v_mfma_f32_16x16x32_bf16 v[124:127], v[204:207], v[172:175], v[124:127]
    v_mfma_f32_16x16x32_bf16 v[128:131], v[208:211], v[172:175], v[128:131]
    v_mfma_f32_16x16x32_bf16 v[132:135], v[212:215], v[172:175], v[132:135]
    v_mfma_f32_16x16x32_bf16 v[136:139], v[216:219], v[172:175], v[136:139]
    v_mfma_f32_16x16x32_bf16 v[152:155], v[216:219], v[176:179], v[152:155]
    v_mfma_f32_16x16x32_bf16 v[148:151], v[212:215], v[176:179], v[148:151]
    v_mfma_f32_16x16x32_bf16 v[144:147], v[208:211], v[176:179], v[144:147]
    v_mfma_f32_16x16x32_bf16 v[140:143], v[204:207], v[176:179], v[140:143]
    s_waitcnt lgkmcnt(0)
    s_barrier
    v_mfma_f32_16x16x32_bf16 v[60:63], v[220:223], v[180:183], v[60:63]
    ds_read_b64_tr_b16 v[204:205], v48 offset:0
    v_mfma_f32_16x16x32_bf16 v[64:67], v[224:227], v[180:183], v[64:67]
    ds_read_b64_tr_b16 v[206:207], v48 offset:1024
    v_mfma_f32_16x16x32_bf16 v[68:71], v[228:231], v[180:183], v[68:71]
    ds_read_b128 v[156:159], v44 offset:0
    v_mfma_f32_16x16x32_bf16 v[72:75], v[232:235], v[180:183], v[72:75]
    ds_read_b64_tr_b16 v[208:209], v49 offset:0
    v_mfma_f32_16x16x32_bf16 v[88:91], v[232:235], v[184:187], v[88:91]
    ds_read_b64_tr_b16 v[210:211], v49 offset:1024
    v_mfma_f32_16x16x32_bf16 v[84:87], v[228:231], v[184:187], v[84:87]
    ds_read_b128 v[160:163], v44 offset:2048
    v_mfma_f32_16x16x32_bf16 v[80:83], v[224:227], v[184:187], v[80:83]
    ds_read_b64_tr_b16 v[212:213], v50 offset:0
    v_mfma_f32_16x16x32_bf16 v[76:79], v[220:223], v[184:187], v[76:79]
    ds_read_b64_tr_b16 v[214:215], v50 offset:1024
    v_mfma_f32_16x16x32_bf16 v[92:95], v[220:223], v[188:191], v[92:95]
    ds_read_b128 v[164:167], v44 offset:4096
    v_mfma_f32_16x16x32_bf16 v[96:99], v[224:227], v[188:191], v[96:99]
    ds_read_b64_tr_b16 v[216:217], v51 offset:0
    v_mfma_f32_16x16x32_bf16 v[100:103], v[228:231], v[188:191], v[100:103]
    ds_read_b64_tr_b16 v[218:219], v51 offset:1024
    v_mfma_f32_16x16x32_bf16 v[104:107], v[232:235], v[188:191], v[104:107]
    ds_read_b128 v[168:171], v44 offset:6144
    v_mfma_f32_16x16x32_bf16 v[120:123], v[232:235], v[192:195], v[120:123]
    ds_read_b128 v[172:175], v44 offset:8192
    v_mfma_f32_16x16x32_bf16 v[116:119], v[228:231], v[192:195], v[116:119]
    ds_read_b128 v[176:179], v44 offset:10240
    v_mfma_f32_16x16x32_bf16 v[112:115], v[224:227], v[192:195], v[112:115]
    v_mfma_f32_16x16x32_bf16 v[108:111], v[220:223], v[192:195], v[108:111]
    v_mfma_f32_16x16x32_bf16 v[124:127], v[220:223], v[196:199], v[124:127]
    v_mfma_f32_16x16x32_bf16 v[128:131], v[224:227], v[196:199], v[128:131]
    v_mfma_f32_16x16x32_bf16 v[132:135], v[228:231], v[196:199], v[132:135]
    v_mfma_f32_16x16x32_bf16 v[136:139], v[232:235], v[196:199], v[136:139]
    v_mfma_f32_16x16x32_bf16 v[152:155], v[232:235], v[200:203], v[152:155]
    v_mfma_f32_16x16x32_bf16 v[148:151], v[228:231], v[200:203], v[148:151]
    v_mfma_f32_16x16x32_bf16 v[144:147], v[224:227], v[200:203], v[144:147]
    v_mfma_f32_16x16x32_bf16 v[140:143], v[220:223], v[200:203], v[140:143]
    s_waitcnt lgkmcnt(0)
    v_mfma_f32_16x16x32_bf16 v[60:63], v[204:207], v[156:159], v[60:63]
    ds_read_b64_tr_b16 v[220:221], v48 offset:8192
    v_mfma_f32_16x16x32_bf16 v[64:67], v[208:211], v[156:159], v[64:67]
    ds_read_b64_tr_b16 v[222:223], v48 offset:9216
    v_mfma_f32_16x16x32_bf16 v[68:71], v[212:215], v[156:159], v[68:71]
    ds_read_b128 v[180:183], v45 offset:0
    v_mfma_f32_16x16x32_bf16 v[72:75], v[216:219], v[156:159], v[72:75]
    ds_read_b64_tr_b16 v[224:225], v49 offset:8192
    v_mfma_f32_16x16x32_bf16 v[88:91], v[216:219], v[160:163], v[88:91]
    ds_read_b64_tr_b16 v[226:227], v49 offset:9216
    v_mfma_f32_16x16x32_bf16 v[84:87], v[212:215], v[160:163], v[84:87]
    ds_read_b128 v[184:187], v45 offset:2048
    v_mfma_f32_16x16x32_bf16 v[80:83], v[208:211], v[160:163], v[80:83]
    ds_read_b64_tr_b16 v[228:229], v50 offset:8192
    v_mfma_f32_16x16x32_bf16 v[76:79], v[204:207], v[160:163], v[76:79]
    ds_read_b64_tr_b16 v[230:231], v50 offset:9216
    v_mfma_f32_16x16x32_bf16 v[92:95], v[204:207], v[164:167], v[92:95]
    ds_read_b128 v[188:191], v45 offset:4096
    v_mfma_f32_16x16x32_bf16 v[96:99], v[208:211], v[164:167], v[96:99]
    ds_read_b64_tr_b16 v[232:233], v51 offset:8192
    v_mfma_f32_16x16x32_bf16 v[100:103], v[212:215], v[164:167], v[100:103]
    ds_read_b64_tr_b16 v[234:235], v51 offset:9216
    v_mfma_f32_16x16x32_bf16 v[104:107], v[216:219], v[164:167], v[104:107]
    ds_read_b128 v[192:195], v45 offset:6144
    v_mfma_f32_16x16x32_bf16 v[120:123], v[216:219], v[168:171], v[120:123]
    ds_read_b128 v[196:199], v45 offset:8192
    v_mfma_f32_16x16x32_bf16 v[116:119], v[212:215], v[168:171], v[116:119]
    ds_read_b128 v[200:203], v45 offset:10240
    v_mfma_f32_16x16x32_bf16 v[112:115], v[208:211], v[168:171], v[112:115]
    v_mfma_f32_16x16x32_bf16 v[108:111], v[204:207], v[168:171], v[108:111]
    v_mfma_f32_16x16x32_bf16 v[124:127], v[204:207], v[172:175], v[124:127]
    v_mfma_f32_16x16x32_bf16 v[128:131], v[208:211], v[172:175], v[128:131]
    v_mfma_f32_16x16x32_bf16 v[132:135], v[212:215], v[172:175], v[132:135]
    v_mfma_f32_16x16x32_bf16 v[136:139], v[216:219], v[172:175], v[136:139]
    v_mfma_f32_16x16x32_bf16 v[152:155], v[216:219], v[176:179], v[152:155]
    v_mfma_f32_16x16x32_bf16 v[148:151], v[212:215], v[176:179], v[148:151]
    v_mfma_f32_16x16x32_bf16 v[144:147], v[208:211], v[176:179], v[144:147]
    v_mfma_f32_16x16x32_bf16 v[140:143], v[204:207], v[176:179], v[140:143]
    s_waitcnt lgkmcnt(0)
    s_barrier
    v_mfma_f32_16x16x32_bf16 v[60:63], v[220:223], v[180:183], v[60:63]
    ds_read_b64_tr_b16 v[204:205], v48 offset:40960
    v_mfma_f32_16x16x32_bf16 v[64:67], v[224:227], v[180:183], v[64:67]
    ds_read_b64_tr_b16 v[206:207], v48 offset:41984
    v_mfma_f32_16x16x32_bf16 v[68:71], v[228:231], v[180:183], v[68:71]
    ds_read_b128 v[156:159], v44 offset:40960
    v_mfma_f32_16x16x32_bf16 v[72:75], v[232:235], v[180:183], v[72:75]
    ds_read_b64_tr_b16 v[208:209], v49 offset:40960
    v_mfma_f32_16x16x32_bf16 v[88:91], v[232:235], v[184:187], v[88:91]
    ds_read_b64_tr_b16 v[210:211], v49 offset:41984
    v_mfma_f32_16x16x32_bf16 v[84:87], v[228:231], v[184:187], v[84:87]
    ds_read_b128 v[160:163], v44 offset:43008
    v_mfma_f32_16x16x32_bf16 v[80:83], v[224:227], v[184:187], v[80:83]
    ds_read_b64_tr_b16 v[212:213], v50 offset:40960
    v_mfma_f32_16x16x32_bf16 v[76:79], v[220:223], v[184:187], v[76:79]
    ds_read_b64_tr_b16 v[214:215], v50 offset:41984
    v_mfma_f32_16x16x32_bf16 v[92:95], v[220:223], v[188:191], v[92:95]
    ds_read_b128 v[164:167], v44 offset:45056
    v_mfma_f32_16x16x32_bf16 v[96:99], v[224:227], v[188:191], v[96:99]
    ds_read_b64_tr_b16 v[216:217], v51 offset:40960
    v_mfma_f32_16x16x32_bf16 v[100:103], v[228:231], v[188:191], v[100:103]
    ds_read_b64_tr_b16 v[218:219], v51 offset:41984
    v_mfma_f32_16x16x32_bf16 v[104:107], v[232:235], v[188:191], v[104:107]
    ds_read_b128 v[168:171], v44 offset:47104
    v_mfma_f32_16x16x32_bf16 v[120:123], v[232:235], v[192:195], v[120:123]
    ds_read_b128 v[172:175], v44 offset:49152
    v_mfma_f32_16x16x32_bf16 v[116:119], v[228:231], v[192:195], v[116:119]
    ds_read_b128 v[176:179], v44 offset:51200
    v_mfma_f32_16x16x32_bf16 v[112:115], v[224:227], v[192:195], v[112:115]
    s_sub_u32 s54, s54, 1
    v_mfma_f32_16x16x32_bf16 v[108:111], v[220:223], v[192:195], v[108:111]
    s_cmp_lg_u32 s54, 0
    v_mfma_f32_16x16x32_bf16 v[124:127], v[220:223], v[196:199], v[124:127]
    v_mfma_f32_16x16x32_bf16 v[128:131], v[224:227], v[196:199], v[128:131]
    v_mfma_f32_16x16x32_bf16 v[132:135], v[228:231], v[196:199], v[132:135]
    v_mfma_f32_16x16x32_bf16 v[136:139], v[232:235], v[196:199], v[136:139]
    v_mfma_f32_16x16x32_bf16 v[152:155], v[232:235], v[200:203], v[152:155]
    v_mfma_f32_16x16x32_bf16 v[148:151], v[228:231], v[200:203], v[148:151]
    v_mfma_f32_16x16x32_bf16 v[144:147], v[224:227], v[200:203], v[144:147]
    v_mfma_f32_16x16x32_bf16 v[140:143], v[220:223], v[200:203], v[140:143]
    s_cbranch_scc1 K_CLOOP
    s_waitcnt lgkmcnt(0)
    v_mfma_f32_16x16x32_bf16 v[60:63], v[204:207], v[156:159], v[60:63]
    ds_read_b128 v[180:183], v45 offset:40960
    ds_read_b64_tr_b16 v[220:221], v48 offset:49152
    v_mfma_f32_16x16x32_bf16 v[64:67], v[208:211], v[156:159], v[64:67]
    ds_read_b64_tr_b16 v[222:223], v48 offset:50176
    ds_read_b64_tr_b16 v[224:225], v49 offset:49152
    v_mfma_f32_16x16x32_bf16 v[68:71], v[212:215], v[156:159], v[68:71]
    ds_read_b64_tr_b16 v[226:227], v49 offset:50176
    ds_read_b64_tr_b16 v[228:229], v50 offset:49152
    v_mfma_f32_16x16x32_bf16 v[72:75], v[216:219], v[156:159], v[72:75]
    ds_read_b64_tr_b16 v[230:231], v50 offset:50176
    ds_read_b64_tr_b16 v[232:233], v51 offset:49152
    v_mfma_f32_16x16x32_bf16 v[76:79], v[204:207], v[160:163], v[76:79]
    ds_read_b64_tr_b16 v[234:235], v51 offset:50176
    ds_read_b128 v[184:187], v45 offset:43008
    v_mfma_f32_16x16x32_bf16 v[80:83], v[208:211], v[160:163], v[80:83]
    ds_read_b128 v[188:191], v45 offset:45056
    ds_read_b128 v[192:195], v45 offset:47104
    v_mfma_f32_16x16x32_bf16 v[84:87], v[212:215], v[160:163], v[84:87]
    ds_read_b128 v[196:199], v45 offset:49152
    ds_read_b128 v[200:203], v45 offset:51200
    v_mfma_f32_16x16x32_bf16 v[88:91], v[216:219], v[160:163], v[88:91]
    s_waitcnt lgkmcnt(11)
    v_mfma_f32_16x16x32_bf16 v[60:63], v[220:223], v[180:183], v[60:63]
    s_nop 1
    s_waitcnt lgkmcnt(9)
    v_mfma_f32_16x16x32_bf16 v[64:67], v[224:227], v[180:183], v[64:67]
    s_nop 1
    s_waitcnt lgkmcnt(7)
    v_mfma_f32_16x16x32_bf16 v[68:71], v[228:231], v[180:183], v[68:71]
    v_cvt_pk_bf16_f32 v60, v60, v61
    v_cvt_pk_bf16_f32 v61, v62, v63
    s_waitcnt lgkmcnt(5)
    v_mfma_f32_16x16x32_bf16 v[72:75], v[232:235], v[180:183], v[72:75]
    ds_write_b64 v56, v[60:61] offset:0
    s_waitcnt lgkmcnt(5)
    v_mfma_f32_16x16x32_bf16 v[76:79], v[220:223], v[184:187], v[76:79]
    v_cvt_pk_bf16_f32 v64, v64, v65
    v_cvt_pk_bf16_f32 v65, v66, v67
    v_mfma_f32_16x16x32_bf16 v[80:83], v[224:227], v[184:187], v[80:83]
    ds_write_b64 v56, v[64:65] offset:32
    v_mfma_f32_16x16x32_bf16 v[84:87], v[228:231], v[184:187], v[84:87]
    v_cvt_pk_bf16_f32 v68, v68, v69
    v_cvt_pk_bf16_f32 v69, v70, v71
    v_mfma_f32_16x16x32_bf16 v[88:91], v[232:235], v[184:187], v[88:91]
    ds_write_b64 v56, v[68:69] offset:64
    v_mfma_f32_16x16x32_bf16 v[92:95], v[204:207], v[164:167], v[92:95]
    v_cvt_pk_bf16_f32 v72, v72, v73
    v_cvt_pk_bf16_f32 v73, v74, v75
    v_mfma_f32_16x16x32_bf16 v[96:99], v[208:211], v[164:167], v[96:99]
    ds_write_b64 v56, v[72:73] offset:96
    v_mfma_f32_16x16x32_bf16 v[100:103], v[212:215], v[164:167], v[100:103]
    v_cvt_pk_bf16_f32 v76, v76, v77
    v_cvt_pk_bf16_f32 v77, v78, v79
    v_mfma_f32_16x16x32_bf16 v[104:107], v[216:219], v[164:167], v[104:107]
    ds_write_b64 v56, v[76:77] offset:4352
    s_waitcnt lgkmcnt(8)
    v_mfma_f32_16x16x32_bf16 v[92:95], v[220:223], v[188:191], v[92:95]
    v_cvt_pk_bf16_f32 v80, v80, v81
    v_cvt_pk_bf16_f32 v81, v82, v83
    v_mfma_f32_16x16x32_bf16 v[96:99], v[224:227], v[188:191], v[96:99]
    ds_write_b64 v56, v[80:81] offset:4384
    v_mfma_f32_16x16x32_bf16 v[100:103], v[228:231], v[188:191], v[100:103]
    v_cvt_pk_bf16_f32 v84, v84, v85
    v_cvt_pk_bf16_f32 v85, v86, v87
    v_mfma_f32_16x16x32_bf16 v[104:107], v[232:235], v[188:191], v[104:107]
    ds_write_b64 v56, v[84:85] offset:4416
    v_mfma_f32_16x16x32_bf16 v[108:111], v[204:207], v[168:171], v[108:111]
    v_cvt_pk_bf16_f32 v88, v88, v89
    v_cvt_pk_bf16_f32 v89, v90, v91
    v_mfma_f32_16x16x32_bf16 v[112:115], v[208:211], v[168:171], v[112:115]
    ds_write_b64 v56, v[88:89] offset:4448
    v_mfma_f32_16x16x32_bf16 v[116:119], v[212:215], v[168:171], v[116:119]
    v_cvt_pk_bf16_f32 v92, v92, v93
    v_cvt_pk_bf16_f32 v93, v94, v95
    v_mfma_f32_16x16x32_bf16 v[120:123], v[216:219], v[168:171], v[120:123]
    ds_write_b64 v56, v[92:93] offset:8704
    s_waitcnt lgkmcnt(11)
    v_mfma_f32_16x16x32_bf16 v[108:111], v[220:223], v[192:195], v[108:111]
    v_cvt_pk_bf16_f32 v96, v96, v97
    v_cvt_pk_bf16_f32 v97, v98, v99
    v_mfma_f32_16x16x32_bf16 v[112:115], v[224:227], v[192:195], v[112:115]
    ds_write_b64 v56, v[96:97] offset:8736
    v_mfma_f32_16x16x32_bf16 v[116:119], v[228:231], v[192:195], v[116:119]
    v_cvt_pk_bf16_f32 v100, v100, v101
    v_cvt_pk_bf16_f32 v101, v102, v103
    v_mfma_f32_16x16x32_bf16 v[120:123], v[232:235], v[192:195], v[120:123]
    ds_write_b64 v56, v[100:101] offset:8768
    v_mfma_f32_16x16x32_bf16 v[124:127], v[204:207], v[172:175], v[124:127]
    v_cvt_pk_bf16_f32 v104, v104, v105
    v_cvt_pk_bf16_f32 v105, v106, v107
    v_mfma_f32_16x16x32_bf16 v[128:131], v[208:211], v[172:175], v[128:131]
    ds_write_b64 v56, v[104:105] offset:8800
    v_mfma_f32_16x16x32_bf16 v[132:135], v[212:215], v[172:175], v[132:135]
    v_cvt_pk_bf16_f32 v108, v108, v109
    v_cvt_pk_bf16_f32 v109, v110, v111
    v_mfma_f32_16x16x32_bf16 v[136:139], v[216:219], v[172:175], v[136:139]
    ds_write_b64 v56, v[108:109] offset:13056
    s_waitcnt lgkmcnt(14)
    v_mfma_f32_16x16x32_bf16 v[124:127], v[220:223], v[196:199], v[124:127]
    v_cvt_pk_bf16_f32 v112, v112, v113
    v_cvt_pk_bf16_f32 v113, v114, v115
    v_mfma_f32_16x16x32_bf16 v[128:131], v[224:227], v[196:199], v[128:131]
    ds_write_b64 v56, v[112:113] offset:13088
    v_mfma_f32_16x16x32_bf16 v[132:135], v[228:231], v[196:199], v[132:135]
    v_cvt_pk_bf16_f32 v116, v116, v117
    v_cvt_pk_bf16_f32 v117, v118, v119
    v_mfma_f32_16x16x32_bf16 v[136:139], v[232:235], v[196:199], v[136:139]
    ds_write_b64 v56, v[116:117] offset:13120
    v_mfma_f32_16x16x32_bf16 v[140:143], v[204:207], v[176:179], v[140:143]
    v_cvt_pk_bf16_f32 v120, v120, v121
    v_cvt_pk_bf16_f32 v121, v122, v123
    v_mfma_f32_16x16x32_bf16 v[144:147], v[208:211], v[176:179], v[144:147]
    ds_write_b64 v56, v[120:121] offset:13152
    v_mfma_f32_16x16x32_bf16 v[148:151], v[212:215], v[176:179], v[148:151]
    v_cvt_pk_bf16_f32 v124, v124, v125
    v_cvt_pk_bf16_f32 v125, v126, v127
    v_mfma_f32_16x16x32_bf16 v[152:155], v[216:219], v[176:179], v[152:155]
    ds_write_b64 v56, v[124:125] offset:17408
    s_waitcnt lgkmcnt(15)
    v_mfma_f32_16x16x32_bf16 v[140:143], v[220:223], v[200:203], v[140:143]
    v_cvt_pk_bf16_f32 v128, v128, v129
    v_cvt_pk_bf16_f32 v129, v130, v131
    v_mfma_f32_16x16x32_bf16 v[144:147], v[224:227], v[200:203], v[144:147]
    ds_write_b64 v56, v[128:129] offset:17440
    v_mfma_f32_16x16x32_bf16 v[148:151], v[228:231], v[200:203], v[148:151]
    v_cvt_pk_bf16_f32 v132, v132, v133
    v_cvt_pk_bf16_f32 v133, v134, v135
    v_mfma_f32_16x16x32_bf16 v[152:155], v[232:235], v[200:203], v[152:155]
    ds_write_b64 v56, v[132:133] offset:17472
    v_cvt_pk_bf16_f32 v136, v136, v137
    v_cvt_pk_bf16_f32 v137, v138, v139
    v_cvt_pk_bf16_f32 v140, v140, v141
    v_cvt_pk_bf16_f32 v141, v142, v143
    v_cvt_pk_bf16_f32 v144, v144, v145
    v_cvt_pk_bf16_f32 v145, v146, v147
    v_cvt_pk_bf16_f32 v148, v148, v149
    v_cvt_pk_bf16_f32 v149, v150, v151
    v_cvt_pk_bf16_f32 v152, v152, v153
    v_cvt_pk_bf16_f32 v153, v154, v155
    ds_write_b64 v56, v[136:137] offset:17504
    ds_write_b64 v56, v[140:141] offset:21760
    ds_write_b64 v56, v[144:145] offset:21792
    ds_write_b64 v56, v[148:149] offset:21824
    ds_write_b64 v56, v[152:153] offset:21856
    s_setprio 0
    s_branch WS_attd
.p2align 12
WP_attd:
    s_setpc_b64 s[38:39]
WS_attd:
    s_waitcnt lgkmcnt(0)
    s_barrier
    ds_read_b64 v[60:61], v13 offset:80
    ds_read_b64 v[62:63], v14 offset:80
    ds_read_b64 v[44:45], v13 offset:4352
    ds_read_b64 v[46:47], v19 offset:4352
    ds_read_b64 v[64:65], v13 offset:4432
    ds_read_b64 v[66:67], v14 offset:4432
    ds_read_b64 v[72:73], v13 offset:120
    ds_read_b64 v[74:75], v14 offset:120
    ds_read_b64 v[48:49], v13 offset:4392
    ds_read_b64 v[50:51], v20 offset:4352
    ds_read_b64 v[76:77], v13 offset:4472
    ds_read_b64 v[78:79], v14 offset:4472
    ds_read_b64 v[52:53], v13 offset:8704
    ds_read_b64 v[54:55], v19 offset:8704
    ds_read_b64 v[68:69], v13 offset:8784
    ds_read_b64 v[70:71], v14 offset:8784
    s_waitcnt lgkmcnt(10)
    v_mfma_f32_16x16x32_bf16 v[116:119], v[60:63], v[44:47], v[36:39]
    v_mfma_f32_16x16x32_bf16 v[120:123], v[64:67], v[44:47], v[32:35]
    ds_read_b64 v[56:57], v13 offset:8744
    ds_read_b64 v[58:59], v20 offset:8704
    ds_read_b64 v[80:81], v13 offset:8824
    ds_read_b64 v[82:83], v14 offset:8824
    s_waitcnt lgkmcnt(8)
    v_mfma_f32_16x16x32_bf16 v[124:127], v[72:75], v[48:51], v[36:39]
    v_mfma_f32_16x16x32_bf16 v[128:131], v[76:79], v[48:51], v[32:35]
    s_waitcnt lgkmcnt(4)
    v_mfma_f32_16x16x32_bf16 v[132:135], v[64:67], v[52:55], v[28:31]
    v_mfma_f32_16x16x32_bf16 v[136:139], v[68:71], v[52:55], v[32:35]
    s_waitcnt lgkmcnt(0)
    v_mfma_f32_16x16x32_bf16 v[140:143], v[76:79], v[56:59], v[28:31]
    v_mfma_f32_16x16x32_bf16 v[144:147], v[80:83], v[56:59], v[32:35]
    ds_read_b64_tr_b16 v[84:85], v15 offset:160
    ds_read_b64_tr_b16 v[86:87], v15 offset:4512
    ds_read_b64_tr_b16 v[100:101], v21 offset:0
    ds_read_b64_tr_b16 v[102:103], v21 offset:4352
    v_max3_f32 v184, v116, v117, v120
    ds_read_b64_tr_b16 v[92:93], v15 offset:200
    v_max3_f32 v185, v118, v119, v122
    ds_read_b64_tr_b16 v[94:95], v15 offset:4552
    v_max_f32 v184, v184, v121
    ds_read_b64_tr_b16 v[104:105], v22 offset:0
    v_max_f32 v185, v185, v123
    ds_read_b64_tr_b16 v[106:107], v22 offset:4352
    v_max3_f32 v186, v124, v125, v128
    ds_read_b64_tr_b16 v[88:89], v15 offset:8864
    v_max3_f32 v187, v126, v127, v130
    ds_read_b64_tr_b16 v[108:109], v23 offset:4352
    v_max_f32 v186, v186, v129
    ds_read_b64_tr_b16 v[110:111], v23 offset:8704
    v_max_f32 v187, v187, v131
    ds_read_b64_tr_b16 v[96:97], v15 offset:8904
    v_max3_f32 v188, v132, v133, v136
    ds_read_b64_tr_b16 v[112:113], v24 offset:4352
    v_max3_f32 v189, v134, v135, v138
    ds_read_b64_tr_b16 v[114:115], v24 offset:8704
    v_max_f32 v188, v188, v137
    v_max_f32 v189, v189, v139
    v_max3_f32 v190, v140, v141, v144
    v_max3_f32 v191, v142, v143, v146
    v_max_f32 v190, v190, v145
    v_max_f32 v191, v191, v147
    v_cvt_pk_bf16_f32 v192, v184, v185
    v_cvt_pk_bf16_f32 v193, v186, v187
    v_cvt_pk_bf16_f32 v194, v188, v189
    v_cvt_pk_bf16_f32 v195, v190, v191
    v_lshlrev_b32 v184, 16, v192
    v_and_b32 v185, 0xffff0000, v192
    v_lshlrev_b32 v186, 16, v193
    v_and_b32 v187, 0xffff0000, v193
    v_lshlrev_b32 v188, 16, v194
    v_and_b32 v189, 0xffff0000, v194
    v_lshlrev_b32 v190, 16, v195
    v_and_b32 v191, 0xffff0000, v195
    v_pk_mul_f32 v[184:185], v[184:185], s[48:49]
    v_pk_mul_f32 v[186:187], v[186:187], s[48:49]
    v_pk_mul_f32 v[188:189], v[188:189], s[48:49]
    v_pk_mul_f32 v[190:191], v[190:191], s[48:49]
    v_cvt_pk_bf16_f32 v192, v184, v185
    v_cvt_pk_bf16_f32 v193, v186, v187
    v_cvt_pk_bf16_f32 v194, v188, v189
    v_cvt_pk_bf16_f32 v195, v190, v191
    v_permlane16_swap_b32 v192, v193
    s_nop 0
    v_permlane16_swap_b32 v194, v195
    s_nop 1
    v_permlane32_swap_b32 v192, v194
    v_permlane32_swap_b32 v193, v195
    v_lshlrev_b32 v184, 16, v192
    v_and_b32 v185, 0xffff0000, v192
    v_lshlrev_b32 v188, 16, v194
    v_and_b32 v189, 0xffff0000, v194
    v_lshlrev_b32 v186, 16, v193
    v_and_b32 v187, 0xffff0000, v193
    v_lshlrev_b32 v190, 16, v195
    v_and_b32 v191, 0xffff0000, v195
    v_max3_f32 v196, v184, v185, v188
    v_max3_f32 v197, v189, v186, v187
    v_max3_f32 v196, v196, v190, v191
    v_max_f32 v196, v196, v197
    v_mul_f32 v196, s46, v196
    v_pk_fma_f32 v[184:185], v[184:185], s[46:47], v[196:197] op_sel_hi:[1,1,0] neg_lo:[0,0,1] neg_hi:[0,0,1]
    v_pk_fma_f32 v[186:187], v[186:187], s[46:47], v[196:197] op_sel_hi:[1,1,0] neg_lo:[0,0,1] neg_hi:[0,0,1]
    v_pk_fma_f32 v[188:189], v[188:189], s[46:47], v[196:197] op_sel_hi:[1,1,0] neg_lo:[0,0,1] neg_hi:[0,0,1]
    v_pk_fma_f32 v[190:191], v[190:191], s[46:47], v[196:197] op_sel_hi:[1,1,0] neg_lo:[0,0,1] neg_hi:[0,0,1]
    v_exp_f32 v184, v184
    v_exp_f32 v185, v185
    v_exp_f32 v186, v186
    v_exp_f32 v187, v187
    v_exp_f32 v188, v188
    v_exp_f32 v189, v189
    v_exp_f32 v190, v190
    v_exp_f32 v191, v191
    v_pk_add_f32 v[200:201], v[184:185], v[186:187]
    v_pk_add_f32 v[202:203], v[188:189], v[190:191]
    v_pk_add_f32 v[200:201], v[200:201], v[202:203]
    v_add_f32 v200, v200, v201
    v_rcp_f32 v200, v200
    s_waitcnt lgkmcnt(0)
    v_pk_mul_f32 v[184:185], v[184:185], v[200:201] op_sel_hi:[1,0]
    v_pk_mul_f32 v[186:187], v[186:187], v[200:201] op_sel_hi:[1,0]
    v_pk_mul_f32 v[188:189], v[188:189], v[200:201] op_sel_hi:[1,0]
    v_pk_mul_f32 v[190:191], v[190:191], v[200:201] op_sel_hi:[1,0]
    v_cvt_pk_bf16_f32 v192, v184, v185
    v_cvt_pk_bf16_f32 v194, v188, v189
    v_cvt_pk_bf16_f32 v193, v186, v187
    v_cvt_pk_bf16_f32 v195, v190, v191
    v_permlane32_swap_b32 v192, v194
    s_nop 0
    v_permlane32_swap_b32 v193, v195
    s_nop 1
    v_permlane16_swap_b32 v192, v193
    v_permlane16_swap_b32 v194, v195
    v_perm_b32 v148, v192, v192, v40
    v_perm_b32 v149, v192, v192, v41
    v_perm_b32 v150, v192, v192, v42
    v_perm_b32 v151, v192, v192, v43
    v_perm_b32 v152, v193, v193, v40
    v_perm_b32 v153, v193, v193, v41
    v_perm_b32 v154, v193, v193, v42
    v_perm_b32 v155, v193, v193, v43
    v_mfma_f32_16x16x32_bf16 v[164:167], v[84:87], v[148:151], 0
    v_mfma_f32_16x16x32_bf16 v[180:183], v[100:103], v[148:151], 0
    v_perm_b32 v156, v194, v194, v40
    v_perm_b32 v157, v194, v194, v41
    v_perm_b32 v158, v194, v194, v42
    v_perm_b32 v159, v194, v194, v43
    v_mfma_f32_16x16x32_bf16 v[168:171], v[92:95], v[152:155], 0
    v_mfma_f32_16x16x32_bf16 v[180:183], v[104:107], v[152:155], v[180:183]
    v_perm_b32 v160, v195, v195, v40
    v_perm_b32 v161, v195, v195, v41
    v_perm_b32 v162, v195, v195, v42
    v_perm_b32 v163, v195, v195, v43
    v_mfma_f32_16x16x32_bf16 v[172:175], v[86:89], v[156:159], 0
    v_mfma_f32_16x16x32_bf16 v[180:183], v[108:111], v[156:159], v[180:183]
    v_mfma_f32_16x16x32_bf16 v[176:179], v[94:97], v[160:163], 0
    v_mfma_f32_16x16x32_bf16 v[180:183], v[112:115], v[160:163], v[180:183]
    v_cvt_pk_bf16_f32 v204, v164, v165
    v_cvt_pk_bf16_f32 v205, v166, v167
    v_cvt_pk_bf16_f32 v206, v168, v169
    v_cvt_pk_bf16_f32 v207, v170, v171
    buffer_store_dwordx4 v[204:207], v16, s[20:23], s50 offen sc1
    v_cvt_pk_bf16_f32 v208, v172, v173
    v_cvt_pk_bf16_f32 v209, v174, v175
    v_cvt_pk_bf16_f32 v210, v176, v177
    v_cvt_pk_bf16_f32 v211, v178, v179
    buffer_store_dwordx4 v[208:211], v16, s[20:23], s51 offen sc1
    v_cvt_pk_bf16_f32 v196, v180, v181
    v_cvt_pk_bf16_f32 v197, v182, v183
    buffer_store_dwordx2 v[196:197], v17, s[20:23], s50 offen sc1
    s_cmp_lg_u32 s34, -1
    s_cbranch_scc1 K_P2_EARLY
K_DRAIN:
    s_waitcnt vmcnt(0)
    s_barrier
    s_branch K_END
K_W7A:
    s_waitcnt vmcnt(0)
    v_and_b32 v4, 7, v1
    v_lshlrev_b32 v4, 2, v4
    s_mov_b32 s3, 131072
K_ZPOLL5:
    v_cmp_eq_u32 vcc, 0, v7
    s_cbranch_vccz K_ZOK5
    s_sub_u32 s3, s3, 1
    s_cbranch_scc1 K_ZOK5
    global_load_dword v7, v4, s[8:9] offset:192 sc1
    s_waitcnt vmcnt(0)
    s_branch K_ZPOLL5
K_ZOK5:
    v_mov_b32 v4, 158720
    v_mov_b32 v3, 1
    s_mov_b64 exec, 1
    s_nop 0
    ds_add_rtn_u32 v2, v4, v3 offset:48
    s_mov_b32 exec_lo, s36
    v_mov_b32 v3, 1
    s_waitcnt lgkmcnt(0)
    v_readfirstlane_b32 s33, v2
    s_nop 3
    s_and_b32 s33, s33, 0xff
    s_cmp_lg_u32 s33, 7
    s_cbranch_scc1 K_ARR7
    global_store_dword v8, v3, s[10:11] sc1
K_ARR7:
    s_mov_b64 exec, -1
    s_barrier
    s_branch K_WOE
K_W7:
    v_mov_b32 v3, 0x100
    s_mov_b64 exec, 1
    s_waitcnt vmcnt(0)
    ds_add_u32 v4, v3 offset:48
    s_mov_b64 exec, -1
    s_branch K_P2_HELP
K_FLAG:
    s_waitcnt vmcnt(0)
    v_and_b32 v4, 7, v1
    v_lshlrev_b32 v4, 2, v4
    s_mov_b32 s3, 131072
K_ZPOLL0:
    v_cmp_eq_u32 vcc, 0, v7
    s_cbranch_vccz K_ZOK0
    s_sub_u32 s3, s3, 1
    s_cbranch_scc1 K_ZOK0
    global_load_dword v7, v4, s[8:9] offset:192 sc1
    s_waitcnt vmcnt(0)
    s_branch K_ZPOLL0
K_ZOK0:
    v_mov_b32 v3, 1
    s_mov_b32 exec_lo, s36
    s_mov_b32 exec_hi, 0
    s_setprio 3
    s_barrier
    global_store_dword v8, v3, s[10:11] sc1
    s_mov_b64 exec, -1
    s_branch K_END
WP_atts:
    s_setpc_b64 s[38:39]
K_JOIN_S:
    s_setprio 0
    s_barrier
    s_cmp_eq_u32 s30, 7
    s_cbranch_scc1 K_FLAG
    ds_read_b64 v[52:53], v13 offset:80
    ds_read_b64 v[54:55], v14 offset:80
    ds_read_b64 v[44:45], v13 offset:4352
    ds_read_b64 v[46:47], v19 offset:4352
    ds_read_b64 v[56:57], v13 offset:4432
    ds_read_b64 v[58:59], v14 offset:4432
    ds_read_b64 v[60:61], v13 offset:120
    ds_read_b64 v[62:63], v14 offset:120
    ds_read_b64 v[48:49], v13 offset:4392
    ds_read_b64 v[50:51], v20 offset:4352
    ds_read_b64 v[64:65], v13 offset:4472
    ds_read_b64 v[66:67], v14 offset:4472
    s_waitcnt lgkmcnt(6)
    v_mfma_f32_16x16x32_bf16 v[84:87], v[52:55], v[44:47], v[36:39]
    v_mfma_f32_16x16x32_bf16 v[88:91], v[56:59], v[44:47], v[32:35]
    s_waitcnt lgkmcnt(0)
    v_mfma_f32_16x16x32_bf16 v[92:95], v[60:63], v[48:51], v[36:39]
    v_mfma_f32_16x16x32_bf16 v[96:99], v[64:67], v[48:51], v[32:35]
    ds_read_b64_tr_b16 v[68:69], v15 offset:160
    ds_read_b64_tr_b16 v[70:71], v15 offset:4512
    ds_read_b64_tr_b16 v[76:77], v21 offset:0
    ds_read_b64_tr_b16 v[78:79], v21 offset:4352
    ds_read_b64_tr_b16 v[72:73], v15 offset:200
    ds_read_b64_tr_b16 v[74:75], v15 offset:4552
    ds_read_b64_tr_b16 v[80:81], v22 offset:0
    ds_read_b64_tr_b16 v[82:83], v22 offset:4352
    v_max3_f32 v120, v84, v85, v88
    v_max3_f32 v121, v86, v87, v90
    v_max_f32 v120, v120, v89
    v_max_f32 v121, v121, v91
    v_max3_f32 v122, v92, v93, v96
    v_max3_f32 v123, v94, v95, v98
    v_max_f32 v122, v122, v97
    v_max_f32 v123, v123, v99
    v_cvt_pk_bf16_f32 v124, v120, v121
    v_cvt_pk_bf16_f32 v125, v122, v123
    v_lshlrev_b32 v120, 16, v124
    v_and_b32 v121, 0xffff0000, v124
    v_lshlrev_b32 v122, 16, v125
    v_and_b32 v123, 0xffff0000, v125
    v_pk_mul_f32 v[120:121], v[120:121], s[48:49]
    v_pk_mul_f32 v[122:123], v[122:123], s[48:49]
    v_cvt_pk_bf16_f32 v124, v120, v121
    v_cvt_pk_bf16_f32 v125, v122, v123
    s_nop 1
    v_permlane16_swap_b32 v124, v125
    v_lshlrev_b32 v120, 16, v124
    v_and_b32 v121, 0xffff0000, v124
    v_lshlrev_b32 v122, 16, v125
    v_and_b32 v123, 0xffff0000, v125
    v_max3_f32 v126, v120, v121, v122
    v_max_f32 v126, v126, v123
    v_mov_b32 v127, v126
    s_nop 1
    v_permlane32_swap_b32 v126, v127
    v_max_f32 v126, v126, v127
    v_mul_f32 v126, s46, v126
    v_pk_fma_f32 v[120:121], v[120:121], s[46:47], v[126:127] op_sel_hi:[1,1,0] neg_lo:[0,0,1] neg_hi:[0,0,1]
    v_pk_fma_f32 v[122:123], v[122:123], s[46:47], v[126:127] op_sel_hi:[1,1,0] neg_lo:[0,0,1] neg_hi:[0,0,1]
    v_exp_f32 v120, v120
    v_exp_f32 v121, v121
    v_exp_f32 v122, v122
    v_exp_f32 v123, v123
    s_nop 0
    v_pk_add_f32 v[128:129], v[120:121], v[122:123]
    v_add_f32 v128, v128, v129
    v_mov_b32 v129, v128
    s_nop 1
    v_permlane32_swap_b32 v128, v129
    v_add_f32 v128, v128, v129
    v_rcp_f32 v128, v128
    s_waitcnt lgkmcnt(0)
    v_pk_mul_f32 v[120:121], v[120:121], v[128:129] op_sel_hi:[1,0]
    v_pk_mul_f32 v[122:123], v[122:123], v[128:129] op_sel_hi:[1,0]
    v_cvt_pk_bf16_f32 v124, v120, v121
    v_cvt_pk_bf16_f32 v125, v122, v123
    s_nop 1
    v_permlane16_swap_b32 v124, v125
    v_perm_b32 v100, v124, v124, v40
    v_perm_b32 v101, v124, v124, v41
    v_perm_b32 v102, v124, v124, v42
    v_perm_b32 v103, v124, v124, v43
    v_perm_b32 v104, v125, v125, v40
    v_perm_b32 v105, v125, v125, v41
    v_perm_b32 v106, v125, v125, v42
    v_perm_b32 v107, v125, v125, v43
    v_mfma_f32_16x16x32_bf16 v[108:111], v[68:71], v[100:103], 0
    v_mfma_f32_16x16x32_bf16 v[116:119], v[76:79], v[100:103], 0
    v_mfma_f32_16x16x32_bf16 v[112:115], v[72:75], v[104:107], 0
    v_mfma_f32_16x16x32_bf16 v[116:119], v[80:83], v[104:107], v[116:119]
    s_nop 4
    v_cvt_pk_bf16_f32 v132, v108, v109
    v_cvt_pk_bf16_f32 v133, v110, v111
    v_cvt_pk_bf16_f32 v134, v112, v113
    v_cvt_pk_bf16_f32 v135, v114, v115
    buffer_store_dwordx4 v[132:135], v16, s[20:23], s50 offen sc1
    v_cvt_pk_bf16_f32 v126, v116, v117
    v_cvt_pk_bf16_f32 v127, v118, v119
    buffer_store_dwordx2 v[126:127], v17, s[20:23], s50 offen sc1
    s_cmp_eq_u32 s34, -1
    s_cbranch_scc1 K_DRAIN
    s_cmp_lg_u32 s30, 6
    s_cbranch_scc1 K_NOFL
    s_waitcnt vmcnt(2)
    v_and_b32 v4, 7, v1
    v_lshlrev_b32 v4, 2, v4
    s_mov_b32 s3, 131072
K_ZPOLL2:
    v_cmp_eq_u32 vcc, 0, v7
    s_cbranch_vccz K_ZOK2
    s_sub_u32 s3, s3, 1
    s_cbranch_scc1 K_ZOK2
    global_load_dword v7, v4, s[8:9] offset:192 sc1
    s_waitcnt vmcnt(0)
    s_branch K_ZPOLL2
K_ZOK2:
    v_and_b32 v2, 1, v1
    v_lshl_add_u32 v2, v2, 2, s42
    global_load_dword v7, v2, s[10:11] offset:128 sc1
K_NOFL:
    v_mov_b32 v4, 158720
    v_mov_b32 v3, 257
    s_mov_b64 exec, 1
    s_waitcnt vmcnt(0)
    ds_add_rtn_u32 v2, v4, v3 offset:48
    s_mov_b32 exec_lo, s36
    v_mov_b32 v3, 1
    s_waitcnt lgkmcnt(0)
    v_readfirstlane_b32 s33, v2
    s_nop 3
    s_and_b32 s33, s33, 0xff
    s_cmp_lg_u32 s33, 7
    s_cbranch_scc1 K_ARRS
    global_store_dword v8, v3, s[10:11] sc1
K_ARRS:
    s_mov_b64 exec, -1
    s_cmp_ge_u32 s30, 6
    s_cbranch_scc1 K_P2_HELP
    s_branch K_LATE
WP_early:
    s_setpc_b64 s[38:39]
K_P2_EARLY:
    s_lshl_b32 s54, s40, 7
    v_lshrrev_b32 v9, 4, v1
    v_mov_b32 v12, 158720
    s_add_u32 s20, s10, 0x100000
    s_addc_u32 s21, s11, 0
    s_mov_b32 s22, 0x280000
    s_mov_b32 s23, 0x20000
    s_add_u32 s16, s10, 0x1000
    s_addc_u32 s17, s11, 0
    s_mov_b32 s18, 0x2000
    s_mov_b32 s19, 0x20000
    s_mov_b32 s48, s6
    s_mov_b32 s49, s7
    s_mov_b32 s50, 0x280000
    s_mov_b32 s51, 0x20000
    s_lshl_b32 s53, s40, 3
    s_lshl1_add_u32 s53, s30, s53
    s_mov_b32 s55, 20480
    v_bfe_u32 v20, v1, 2, 2
    v_and_b32 v21, 3, v1
    s_mul_i32 s3, s53, 20480
    v_lshl_add_u32 v25, v1, 4, s3
    v_add_u32 v26, 20480, v25
    v_add_u32 v35, 16384, v25
    v_add_u32 v36, 16384, v26
    v_and_b32 v2, 15, v1
    s_lshl_b32 s3, s53, 6
    v_lshl_add_u32 v23, v2, 2, s3
    v_lshl_add_u32 v2, v9, 2, v20
    v_bfe_u32 v3, v2, 1, 2
    v_lshlrev_b32 v2, 7, v2
    v_lshl_add_u32 v2, v21, 3, v2
    v_lshl_add_u32 v24, v3, 5, v2
    v_lshrrev_b32 v3, 1, v20
    v_mul_u32_u24 v2, 40, v9
    v_add3_u32 v2, v2, 16, v20
    v_lshlrev_b32 v2, 7, v2
    v_lshl_add_u32 v2, v21, 3, v2
    v_xor_b32 v4, 0, v3
    v_lshl_add_u32 v60, v4, 5, v2
    v_xor_b32 v4, 1, v3
    v_lshl_add_u32 v61, v4, 5, v2
    v_xor_b32 v4, 2, v3
    v_lshl_add_u32 v62, v4, 5, v2
    v_xor_b32 v4, 3, v3
    v_lshl_add_u32 v63, v4, 5, v2
    v_lshrrev_b32 v3, 4, v1
    v_and_b32 v4, 7, v1
    v_lshrrev_b32 v2, 3, v1
    v_xor_b32 v4, v4, v3
    v_mul_u32_u24 v2, 1280, v2
    v_lshl_add_u32 v27, v4, 4, v2
    v_xor_b32 v28, 64, v27
    s_lshl_b32 s71, s40, 3
    s_lshl1_add_u32 s71, s30, s71
    s_mul_i32 s71, s71, 20480
    s_lshl_b32 s33, s41, 7
    s_add_u32 s71, s71, s33
    s_add_u32 s72, s71, 10240
    s_add_u32 s73, s71, 20480
    s_add_u32 s74, s71, 30720
    s_lshl_b32 s3, s30, 12
    s_add_u32 s3, s3, 140288
    v_lshl_add_u32 v33, v1, 4, s3
    v_and_b32 v2, 15, v1
    v_lshrrev_b32 v3, 1, v2
    v_lshrrev_b32 v4, 5, v1
    v_xor_b32 v3, v3, v4
    v_lshlrev_b32 v3, 4, v3
    v_lshl_add_u32 v3, v2, 7, v3
    v_and_b32 v4, 1, v9
    v_lshl_add_u32 v3, v4, 3, v3
    v_add_u32 v29, s3, v3
    v_xor_b32 v30, 32, v29
    v_xor_b32 v31, 64, v29
    v_xor_b32 v32, 96, v29
    s_and_b32 s33, s40, 3
    s_lshl_b32 s33, s33, 3
    s_lshr_b32 s33, 0x7f06037f, s33
    s_and_b32 s33, s33, 0xff
    s_lshl_b32 s3, s30, 1
    s_cmp_ge_u32 s3, s33
    s_cselect_b32 s64, 16, 0
    s_add_u32 s3, s3, 1
    s_cmp_ge_u32 s3, s33
    s_cselect_b32 s65, 16, 0
    s_mov_b32 s63, 0
    s_mov_b32 s66, 0
    s_mov_b32 s67, 16384
    v_mov_b32 v34, 0
    v_mov_b32 v4, 158720
    v_mov_b32 v3, 1
    s_mov_b64 exec, 1
    s_waitcnt vmcnt(0)
    ds_add_rtn_u32 v2, v4, v3 offset:48
    s_mov_b32 exec_lo, s36
    v_mov_b32 v3, 1
    s_waitcnt lgkmcnt(0)
    v_readfirstlane_b32 s33, v2
    s_nop 3
    s_and_b32 s33, s33, 0xff
    s_cmp_lg_u32 s33, 7
    s_cbranch_scc1 K_ARRD
    global_store_dword v8, v3, s[10:11] sc1
K_ARRD:
    s_mov_b64 exec, -1
    s_mov_b32 s3, 1048576
K_P2_GE:
    ds_read_b32 v2, v12 offset:48
    s_sub_u32 s3, s3, 1
    s_waitcnt lgkmcnt(0)
    v_readfirstlane_b32 s33, v2
    s_nop 3
    s_cselect_b32 s33, 1024, s33
    s_cmp_lt_u32 s33, 1024
    s_cbranch_scc1 K_P2_GE
K_P2_GEMM:
    s_setprio 0
    s_mov_b32 s3, 1048576
K_P2_GS:
    ds_read_b32 v2, v12 offset:40
    s_sub_u32 s3, s3, 1
    s_waitcnt lgkmcnt(0)
    v_readfirstlane_b32 s33, v2
    s_nop 3
    s_cselect_b32 s33, 1, s33
    s_cmp_lt_u32 s33, 1
    s_cbranch_scc1 K_P2_GS
    buffer_load_dword v64, v23, s[16:19], 0 offen offset:0 sc1
    buffer_load_dword v66, v23, s[16:19], 0 offen offset:64 sc1
    ds_read_b128 v[16:19], v12
    ds_read_b64 v[40:41], v29 offset:0
    ds_read_b64 v[42:43], v30 offset:0
    ds_read_b64 v[44:45], v31 offset:0
    ds_read_b64 v[46:47], v32 offset:0
    ds_read_b64 v[48:49], v29 offset:2048
    ds_read_b64 v[50:51], v30 offset:2048
    ds_read_b64 v[52:53], v31 offset:2048
    ds_read_b64 v[54:55], v32 offset:2048
    s_waitcnt lgkmcnt(4)
    v_lshlrev_b32 v72, 16, v40
    v_and_b32 v73, 0xffff0000, v40
    v_lshlrev_b32 v74, 16, v41
    v_and_b32 v75, 0xffff0000, v41
    v_lshlrev_b32 v76, 16, v42
    v_and_b32 v77, 0xffff0000, v42
    v_lshlrev_b32 v78, 16, v43
    v_and_b32 v79, 0xffff0000, v43
    v_lshlrev_b32 v80, 16, v44
    v_and_b32 v81, 0xffff0000, v44
    v_lshlrev_b32 v82, 16, v45
    v_and_b32 v83, 0xffff0000, v45
    v_lshlrev_b32 v84, 16, v46
    v_and_b32 v85, 0xffff0000, v46
    v_lshlrev_b32 v86, 16, v47
    v_and_b32 v87, 0xffff0000, v47
    s_waitcnt lgkmcnt(0)
    v_lshlrev_b32 v88, 16, v48
    v_and_b32 v89, 0xffff0000, v48
    v_lshlrev_b32 v90, 16, v49
    v_and_b32 v91, 0xffff0000, v49
    v_lshlrev_b32 v92, 16, v50
    v_and_b32 v93, 0xffff0000, v50
    v_lshlrev_b32 v94, 16, v51
    v_and_b32 v95, 0xffff0000, v51
    v_lshlrev_b32 v96, 16, v52
    v_and_b32 v97, 0xffff0000, v52
    v_lshlrev_b32 v98, 16, v53
    v_and_b32 v99, 0xffff0000, v53
    v_lshlrev_b32 v100, 16, v54
    v_and_b32 v101, 0xffff0000, v54
    v_lshlrev_b32 v102, 16, v55
    v_and_b32 v103, 0xffff0000, v55
    s_cmp_eq_u32 s63, 0
    s_cbranch_scc1 K_SP0
K_SPR0:
    s_ff1_i32_b32 s33, s63
    s_bitset0_b32 s63, s33
    s_lshl_b32 s75, s33, 10
    buffer_load_dwordx4 v[104:107], v25, s[20:23], s75 offen offset:0 sc1
    buffer_load_dwordx4 v[108:111], v26, s[20:23], s75 offen offset:0 sc1
    v_mad_u32_u24 v56, s75, 5, v24
    v_xor_b32 v58, 64, v56
    v_xor_b32 v57, 32, v56
    v_xor_b32 v59, 96, v56
    ds_read_b64_tr_b16 v[184:185], v56 offset:0
    ds_read_b64_tr_b16 v[186:187], v58 offset:2560
    ds_read_b64_tr_b16 v[188:189], v57 offset:0
    ds_read_b64_tr_b16 v[190:191], v59 offset:2560
    ds_read_b64_tr_b16 v[192:193], v58 offset:0
    ds_read_b64_tr_b16 v[194:195], v56 offset:2560
    ds_read_b64_tr_b16 v[196:197], v59 offset:0
    ds_read_b64_tr_b16 v[198:199], v57 offset:2560
    s_cmp_eq_u32 s63, 0
    s_cbranch_scc1 K_SP1
K_SPR1:
    s_ff1_i32_b32 s33, s63
    s_bitset0_b32 s63, s33
    s_lshl_b32 s76, s33, 10
    buffer_load_dwordx4 v[112:115], v25, s[20:23], s76 offen offset:0 sc1
    buffer_load_dwordx4 v[116:119], v26, s[20:23], s76 offen offset:0 sc1
    v_mad_u32_u24 v56, s76, 5, v24
    v_xor_b32 v58, 64, v56
    v_xor_b32 v57, 32, v56
    v_xor_b32 v59, 96, v56
    ds_read_b64_tr_b16 v[200:201], v56 offset:0
    ds_read_b64_tr_b16 v[202:203], v58 offset:2560
    ds_read_b64_tr_b16 v[204:205], v57 offset:0
    ds_read_b64_tr_b16 v[206:207], v59 offset:2560
    ds_read_b64_tr_b16 v[208:209], v58 offset:0
    ds_read_b64_tr_b16 v[210:211], v56 offset:2560
    ds_read_b64_tr_b16 v[212:213], v59 offset:0
    ds_read_b64_tr_b16 v[214:215], v57 offset:2560
    s_waitcnt vmcnt(4)
    s_mov_b64 exec, 1
    ds_add_u32 v12, v34 offset:44
    s_mov_b64 exec, -1
    v_sub_f32 v68, 1.0, v64
    v_cvt_pk_bf16_f32 v68, v68, v68
    v_lshlrev_b32 v68, 16, v68
    v_sub_f32 v70, 1.0, v66
    v_cvt_pk_bf16_f32 v70, v70, v70
    v_lshlrev_b32 v70, 16, v70
    v_pk_mul_f32 v[72:73], v[72:73], v[68:69] op_sel_hi:[1,0]
    v_pk_mul_f32 v[74:75], v[74:75], v[68:69] op_sel_hi:[1,0]
    v_pk_mul_f32 v[76:77], v[76:77], v[68:69] op_sel_hi:[1,0]
    v_pk_mul_f32 v[78:79], v[78:79], v[68:69] op_sel_hi:[1,0]
    v_pk_mul_f32 v[80:81], v[80:81], v[68:69] op_sel_hi:[1,0]
    v_pk_mul_f32 v[82:83], v[82:83], v[68:69] op_sel_hi:[1,0]
    v_pk_mul_f32 v[84:85], v[84:85], v[68:69] op_sel_hi:[1,0]
    v_pk_mul_f32 v[86:87], v[86:87], v[68:69] op_sel_hi:[1,0]
    v_pk_mul_f32 v[88:89], v[88:89], v[70:71] op_sel_hi:[1,0]
    v_pk_mul_f32 v[90:91], v[90:91], v[70:71] op_sel_hi:[1,0]
    v_pk_mul_f32 v[92:93], v[92:93], v[70:71] op_sel_hi:[1,0]
    v_pk_mul_f32 v[94:95], v[94:95], v[70:71] op_sel_hi:[1,0]
    v_pk_mul_f32 v[96:97], v[96:97], v[70:71] op_sel_hi:[1,0]
    v_pk_mul_f32 v[98:99], v[98:99], v[70:71] op_sel_hi:[1,0]
    v_pk_mul_f32 v[100:101], v[100:101], v[70:71] op_sel_hi:[1,0]
    v_pk_mul_f32 v[102:103], v[102:103], v[70:71] op_sel_hi:[1,0]
    s_cmp_eq_u32 s63, 0
    s_cbranch_scc1 K_SP2
K_SPR2:
    s_ff1_i32_b32 s33, s63
    s_bitset0_b32 s63, s33
    s_lshl_b32 s77, s33, 10
    buffer_load_dwordx4 v[120:123], v25, s[20:23], s77 offen offset:0 sc1
    buffer_load_dwordx4 v[124:127], v26, s[20:23], s77 offen offset:0 sc1
    s_cmp_eq_u32 s63, 0
    s_cbranch_scc1 K_SP3
K_SPR3:
    s_ff1_i32_b32 s33, s63
    s_bitset0_b32 s63, s33
    s_lshl_b32 s78, s33, 10
    buffer_load_dwordx4 v[128:131], v25, s[20:23], s78 offen offset:0 sc1
    buffer_load_dwordx4 v[132:135], v26, s[20:23], s78 offen offset:0 sc1
    s_cmp_eq_u32 s63, 0
    s_cbranch_scc1 K_SP4
K_SPR4:
    s_ff1_i32_b32 s33, s63
    s_bitset0_b32 s63, s33
    s_lshl_b32 s75, s33, 10
    buffer_load_dwordx4 v[136:139], v25, s[20:23], s75 offen offset:0 sc1
    buffer_load_dwordx4 v[140:143], v26, s[20:23], s75 offen offset:0 sc1
    s_branch WS_p2g
.p2align 12
WP_p2g:
    s_setpc_b64 s[38:39]
WS_p2g:
    s_waitcnt vmcnt(8) lgkmcnt(9)
    v_mfma_f32_16x16x32_bf16 v[152:155], v[184:187], v[104:107], 0
    v_mad_u32_u24 v56, s77, 5, v24
    v_xor_b32 v58, 64, v56
    v_xor_b32 v57, 32, v56
    v_mfma_f32_16x16x32_bf16 v[168:171], v[184:187], v[108:111], 0
    v_xor_b32 v59, 96, v56
    ds_read_b64_tr_b16 v[216:217], v56 offset:0
    ds_read_b64_tr_b16 v[218:219], v58 offset:2560
    v_mfma_f32_16x16x32_bf16 v[156:159], v[188:191], v[104:107], 0
    ds_read_b64_tr_b16 v[220:221], v57 offset:0
    ds_read_b64_tr_b16 v[222:223], v59 offset:2560
    ds_read_b64_tr_b16 v[224:225], v58 offset:0
    v_mfma_f32_16x16x32_bf16 v[172:175], v[188:191], v[108:111], 0
    ds_read_b64_tr_b16 v[226:227], v56 offset:2560
    ds_read_b64_tr_b16 v[228:229], v59 offset:0
    v_mfma_f32_16x16x32_bf16 v[160:163], v[192:195], v[104:107], 0
    ds_read_b64_tr_b16 v[230:231], v57 offset:2560
    s_cmp_eq_u32 s63, 0
    v_mfma_f32_16x16x32_bf16 v[176:179], v[192:195], v[108:111], 0
    s_cbranch_scc1 K_SP5
K_SPR5:
    s_ff1_i32_b32 s33, s63
    v_mfma_f32_16x16x32_bf16 v[164:167], v[196:199], v[104:107], 0
    s_bitset0_b32 s63, s33
    s_lshl_b32 s76, s33, 10
    v_mfma_f32_16x16x32_bf16 v[180:183], v[196:199], v[108:111], 0
    buffer_load_dwordx4 v[144:147], v25, s[20:23], s76 offen offset:0 sc1
    buffer_load_dwordx4 v[148:151], v26, s[20:23], s76 offen offset:0 sc1
    s_waitcnt vmcnt(8) lgkmcnt(9)
    v_mfma_f32_16x16x32_bf16 v[152:155], v[200:203], v[112:115], v[152:155]
    v_mad_u32_u24 v56, s78, 5, v24
    v_xor_b32 v58, 64, v56
    v_xor_b32 v57, 32, v56
    v_mfma_f32_16x16x32_bf16 v[168:171], v[200:203], v[116:119], v[168:171]
    v_xor_b32 v59, 96, v56
    ds_read_b64_tr_b16 v[184:185], v56 offset:0
    ds_read_b64_tr_b16 v[186:187], v58 offset:2560
    v_mfma_f32_16x16x32_bf16 v[156:159], v[204:207], v[112:115], v[156:159]
    ds_read_b64_tr_b16 v[188:189], v57 offset:0
    ds_read_b64_tr_b16 v[190:191], v59 offset:2560
    ds_read_b64_tr_b16 v[192:193], v58 offset:0
    v_mfma_f32_16x16x32_bf16 v[172:175], v[204:207], v[116:119], v[172:175]
    ds_read_b64_tr_b16 v[194:195], v56 offset:2560
    ds_read_b64_tr_b16 v[196:197], v59 offset:0
    v_mfma_f32_16x16x32_bf16 v[160:163], v[208:211], v[112:115], v[160:163]
    ds_read_b64_tr_b16 v[198:199], v57 offset:2560
    s_cmp_eq_u32 s63, 0
    v_mfma_f32_16x16x32_bf16 v[176:179], v[208:211], v[116:119], v[176:179]
    s_cbranch_scc1 K_SP6
K_SPR6:
    s_ff1_i32_b32 s33, s63
    v_mfma_f32_16x16x32_bf16 v[164:167], v[212:215], v[112:115], v[164:167]
    s_bitset0_b32 s63, s33
    s_lshl_b32 s77, s33, 10
    v_mfma_f32_16x16x32_bf16 v[180:183], v[212:215], v[116:119], v[180:183]
    buffer_load_dwordx4 v[104:107], v25, s[20:23], s77 offen offset:0 sc1
    buffer_load_dwordx4 v[108:111], v26, s[20:23], s77 offen offset:0 sc1
    s_waitcnt vmcnt(8) lgkmcnt(8)
    v_mfma_f32_16x16x32_bf16 v[152:155], v[216:219], v[120:123], v[152:155]
    v_mad_u32_u24 v56, s75, 5, v24
    v_xor_b32 v58, 64, v56
    v_xor_b32 v57, 32, v56
    v_mfma_f32_16x16x32_bf16 v[168:171], v[216:219], v[124:127], v[168:171]
    v_xor_b32 v59, 96, v56
    ds_read_b64_tr_b16 v[200:201], v56 offset:0
    ds_read_b64_tr_b16 v[202:203], v58 offset:2560
    v_mfma_f32_16x16x32_bf16 v[156:159], v[220:223], v[120:123], v[156:159]
    ds_read_b64_tr_b16 v[204:205], v57 offset:0
    ds_read_b64_tr_b16 v[206:207], v59 offset:2560
    ds_read_b64_tr_b16 v[208:209], v58 offset:0
    v_mfma_f32_16x16x32_bf16 v[172:175], v[220:223], v[124:127], v[172:175]
    ds_read_b64_tr_b16 v[210:211], v56 offset:2560
    ds_read_b64_tr_b16 v[212:213], v59 offset:0
    v_mfma_f32_16x16x32_bf16 v[160:163], v[224:227], v[120:123], v[160:163]
    ds_read_b64_tr_b16 v[214:215], v57 offset:2560
    s_andn2_b32 s33, s66, s63
    v_mfma_f32_16x16x32_bf16 v[176:179], v[224:227], v[124:127], v[176:179]
    s_bfe_u32 s33, s33, 0x40000
    s_cmp_eq_u32 s33, 15
    v_mfma_f32_16x16x32_bf16 v[164:167], v[228:231], v[120:123], v[164:167]
    s_cselect_b32 s78, 0, 1024
    s_xor_b32 s69, s78, 1024
    v_mfma_f32_16x16x32_bf16 v[180:183], v[228:231], v[124:127], v[180:183]
    buffer_load_dwordx4 v[112:115], v35, s[20:23], s78 offen offset:0 sc1
    buffer_load_dwordx4 v[116:119], v36, s[20:23], s78 offen offset:0 sc1
    s_waitcnt vmcnt(8) lgkmcnt(8)
    v_mfma_f32_16x16x32_bf16 v[152:155], v[184:187], v[128:131], v[152:155]
    v_mad_u32_u24 v56, s76, 5, v24
    v_xor_b32 v58, 64, v56
    v_xor_b32 v57, 32, v56
    v_mfma_f32_16x16x32_bf16 v[168:171], v[184:187], v[132:135], v[168:171]
    v_xor_b32 v59, 96, v56
    ds_read_b64_tr_b16 v[216:217], v56 offset:0
    ds_read_b64_tr_b16 v[218:219], v58 offset:2560
    v_mfma_f32_16x16x32_bf16 v[156:159], v[188:191], v[128:131], v[156:159]
    ds_read_b64_tr_b16 v[220:221], v57 offset:0
    ds_read_b64_tr_b16 v[222:223], v59 offset:2560
    ds_read_b64_tr_b16 v[224:225], v58 offset:0
    v_mfma_f32_16x16x32_bf16 v[172:175], v[188:191], v[132:135], v[172:175]
    ds_read_b64_tr_b16 v[226:227], v56 offset:2560
    ds_read_b64_tr_b16 v[228:229], v59 offset:0
    v_mfma_f32_16x16x32_bf16 v[160:163], v[192:195], v[128:131], v[160:163]
    ds_read_b64_tr_b16 v[230:231], v57 offset:2560
    s_cmp_eq_u32 s63, 0
    v_mfma_f32_16x16x32_bf16 v[176:179], v[192:195], v[132:135], v[176:179]
    s_cbranch_scc1 K_SP8
K_SPR8:
    s_ff1_i32_b32 s33, s63
    v_mfma_f32_16x16x32_bf16 v[164:167], v[196:199], v[128:131], v[164:167]
    s_bitset0_b32 s63, s33
    s_lshl_b32 s75, s33, 10
    v_mfma_f32_16x16x32_bf16 v[180:183], v[196:199], v[132:135], v[180:183]
    buffer_load_dwordx4 v[120:123], v25, s[20:23], s75 offen offset:0 sc1
    buffer_load_dwordx4 v[124:127], v26, s[20:23], s75 offen offset:0 sc1
    s_waitcnt vmcnt(8) lgkmcnt(8)
    v_mfma_f32_16x16x32_bf16 v[152:155], v[200:203], v[136:139], v[152:155]
    v_mad_u32_u24 v56, s77, 5, v24
    v_xor_b32 v58, 64, v56
    v_mfma_f32_16x16x32_bf16 v[168:171], v[200:203], v[140:143], v[168:171]
    v_xor_b32 v57, 32, v56
    v_xor_b32 v59, 96, v56
    v_mfma_f32_16x16x32_bf16 v[156:159], v[204:207], v[136:139], v[156:159]
    ds_read_b64_tr_b16 v[184:185], v56 offset:0
    ds_read_b64_tr_b16 v[186:187], v58 offset:2560
    v_mfma_f32_16x16x32_bf16 v[172:175], v[204:207], v[140:143], v[172:175]
    ds_read_b64_tr_b16 v[188:189], v57 offset:0
    ds_read_b64_tr_b16 v[190:191], v59 offset:2560
    v_mfma_f32_16x16x32_bf16 v[160:163], v[208:211], v[136:139], v[160:163]
    ds_read_b64_tr_b16 v[192:193], v58 offset:0
    ds_read_b64_tr_b16 v[194:195], v56 offset:2560
    v_mfma_f32_16x16x32_bf16 v[176:179], v[208:211], v[140:143], v[176:179]
    ds_read_b64_tr_b16 v[196:197], v59 offset:0
    ds_read_b64_tr_b16 v[198:199], v57 offset:2560
    v_mfma_f32_16x16x32_bf16 v[164:167], v[212:215], v[136:139], v[164:167]
    buffer_load_dwordx4 v[128:131], v35, s[20:23], s69 offen offset:0 sc1
    buffer_load_dwordx4 v[132:135], v36, s[20:23], s69 offen offset:0 sc1
    v_mfma_f32_16x16x32_bf16 v[180:183], v[212:215], v[140:143], v[180:183]
    s_waitcnt vmcnt(8) lgkmcnt(8)
    v_mfma_f32_16x16x32_bf16 v[152:155], v[216:219], v[144:147], v[152:155]
    v_mad_u32_u24 v56, s78, 20, v60
    v_xor_b32 v58, 64, v56
    v_xor_b32 v57, 32, v56
    v_mfma_f32_16x16x32_bf16 v[168:171], v[216:219], v[148:151], v[168:171]
    v_xor_b32 v59, 96, v56
    ds_read_b64_tr_b16 v[200:201], v56 offset:0
    ds_read_b64_tr_b16 v[202:203], v58 offset:2560
    v_mfma_f32_16x16x32_bf16 v[156:159], v[220:223], v[144:147], v[156:159]
    ds_read_b64_tr_b16 v[204:205], v57 offset:0
    ds_read_b64_tr_b16 v[206:207], v59 offset:2560
    ds_read_b64_tr_b16 v[208:209], v58 offset:0
    v_mfma_f32_16x16x32_bf16 v[172:175], v[220:223], v[148:151], v[172:175]
    ds_read_b64_tr_b16 v[210:211], v56 offset:2560
    ds_read_b64_tr_b16 v[212:213], v59 offset:0
    v_mfma_f32_16x16x32_bf16 v[160:163], v[224:227], v[144:147], v[160:163]
    ds_read_b64_tr_b16 v[214:215], v57 offset:2560
    s_cmp_eq_u32 s63, 0
    v_mfma_f32_16x16x32_bf16 v[176:179], v[224:227], v[148:151], v[176:179]
    s_cbranch_scc1 K_SP10
K_SPR10:
    s_ff1_i32_b32 s33, s63
    v_mfma_f32_16x16x32_bf16 v[164:167], v[228:231], v[144:147], v[164:167]
    s_bitset0_b32 s63, s33
    s_lshl_b32 s77, s33, 10
    v_mfma_f32_16x16x32_bf16 v[180:183], v[228:231], v[148:151], v[180:183]
    buffer_load_dwordx4 v[136:139], v25, s[20:23], s77 offen offset:0 sc1
    buffer_load_dwordx4 v[140:143], v26, s[20:23], s77 offen offset:0 sc1
    s_waitcnt vmcnt(8) lgkmcnt(8)
    v_mfma_f32_16x16x32_bf16 v[152:155], v[184:187], v[104:107], v[152:155]
    v_mad_u32_u24 v56, s75, 5, v24
    v_xor_b32 v58, 64, v56
    v_xor_b32 v57, 32, v56
    v_mfma_f32_16x16x32_bf16 v[168:171], v[184:187], v[108:111], v[168:171]
    v_xor_b32 v59, 96, v56
    ds_read_b64_tr_b16 v[216:217], v56 offset:0
    ds_read_b64_tr_b16 v[218:219], v58 offset:2560
    v_mfma_f32_16x16x32_bf16 v[156:159], v[188:191], v[104:107], v[156:159]
    ds_read_b64_tr_b16 v[220:221], v57 offset:0
    ds_read_b64_tr_b16 v[222:223], v59 offset:2560
    ds_read_b64_tr_b16 v[224:225], v58 offset:0
    v_mfma_f32_16x16x32_bf16 v[172:175], v[188:191], v[108:111], v[172:175]
    ds_read_b64_tr_b16 v[226:227], v56 offset:2560
    ds_read_b64_tr_b16 v[228:229], v59 offset:0
    v_mfma_f32_16x16x32_bf16 v[160:163], v[192:195], v[104:107], v[160:163]
    ds_read_b64_tr_b16 v[230:231], v57 offset:2560
    s_cmp_eq_u32 s63, 0
    v_mfma_f32_16x16x32_bf16 v[176:179], v[192:195], v[108:111], v[176:179]
    s_cbranch_scc1 K_SP11
K_SPR11:
    s_ff1_i32_b32 s33, s63
    v_mfma_f32_16x16x32_bf16 v[164:167], v[196:199], v[104:107], v[164:167]
    s_bitset0_b32 s63, s33
    s_lshl_b32 s78, s33, 10
    v_mfma_f32_16x16x32_bf16 v[180:183], v[196:199], v[108:111], v[180:183]
    buffer_load_dwordx4 v[144:147], v25, s[20:23], s78 offen offset:0 sc1
    buffer_load_dwordx4 v[148:151], v26, s[20:23], s78 offen offset:0 sc1
    s_waitcnt vmcnt(8) lgkmcnt(8)
    v_mfma_f32_16x16x32_bf16 v[152:155], v[200:203], v[112:115], v[152:155]
    v_mad_u32_u24 v56, s69, 20, v60
    v_xor_b32 v58, 64, v56
    v_xor_b32 v57, 32, v56
    v_mfma_f32_16x16x32_bf16 v[168:171], v[200:203], v[116:119], v[168:171]
    v_xor_b32 v59, 96, v56
    ds_read_b64_tr_b16 v[184:185], v56 offset:0
    ds_read_b64_tr_b16 v[186:187], v58 offset:2560
    v_mfma_f32_16x16x32_bf16 v[156:159], v[204:207], v[112:115], v[156:159]
    ds_read_b64_tr_b16 v[188:189], v57 offset:0
    ds_read_b64_tr_b16 v[190:191], v59 offset:2560
    ds_read_b64_tr_b16 v[192:193], v58 offset:0
    v_mfma_f32_16x16x32_bf16 v[172:175], v[204:207], v[116:119], v[172:175]
    ds_read_b64_tr_b16 v[194:195], v56 offset:2560
    ds_read_b64_tr_b16 v[196:197], v59 offset:0
    v_mfma_f32_16x16x32_bf16 v[160:163], v[208:211], v[112:115], v[160:163]
    ds_read_b64_tr_b16 v[198:199], v57 offset:2560
    s_cmp_eq_u32 s63, 0
    v_mfma_f32_16x16x32_bf16 v[176:179], v[208:211], v[116:119], v[176:179]
    s_cbranch_scc1 K_SP12
K_SPR12:
    s_ff1_i32_b32 s33, s63
    v_mfma_f32_16x16x32_bf16 v[164:167], v[212:215], v[112:115], v[164:167]
    s_bitset0_b32 s63, s33
    s_lshl_b32 s75, s33, 10
    v_mfma_f32_16x16x32_bf16 v[180:183], v[212:215], v[116:119], v[180:183]
    buffer_load_dwordx4 v[104:107], v25, s[20:23], s75 offen offset:0 sc1
    buffer_load_dwordx4 v[108:111], v26, s[20:23], s75 offen offset:0 sc1
    s_mov_b32 s3, 1048576
K_P2_GW:
    ds_read_b32 v2, v12 offset:44
    s_sub_u32 s3, s3, 1
    s_waitcnt lgkmcnt(0)
    v_readfirstlane_b32 s33, v2
    s_nop 3
    s_cselect_b32 s33, 4, s33
    s_cmp_lt_u32 s33, 4
    s_cbranch_scc1 K_P2_GW
    v_readfirstlane_b32 s56, v16
    v_readfirstlane_b32 s57, v17
    s_lshl_b32 s58, s53, 4
    s_waitcnt vmcnt(8)
    v_mfma_f32_16x16x32_bf16 v[152:155], v[216:219], v[120:123], v[152:155]
    v_mad_u32_u24 v56, s77, 5, v24
    v_xor_b32 v58, 64, v56
    v_xor_b32 v57, 32, v56
    v_mfma_f32_16x16x32_bf16 v[168:171], v[216:219], v[124:127], v[168:171]
    v_xor_b32 v59, 96, v56
    ds_read_b64_tr_b16 v[200:201], v56 offset:0
    ds_read_b64_tr_b16 v[202:203], v58 offset:2560
    v_mfma_f32_16x16x32_bf16 v[156:159], v[220:223], v[120:123], v[156:159]
    ds_read_b64_tr_b16 v[204:205], v57 offset:0
    ds_read_b64_tr_b16 v[206:207], v59 offset:2560
    ds_read_b64_tr_b16 v[208:209], v58 offset:0
    v_mfma_f32_16x16x32_bf16 v[172:175], v[220:223], v[124:127], v[172:175]
    ds_read_b64_tr_b16 v[210:211], v56 offset:2560
    ds_read_b64_tr_b16 v[212:213], v59 offset:0
    v_mfma_f32_16x16x32_bf16 v[160:163], v[224:227], v[120:123], v[160:163]
    ds_read_b64_tr_b16 v[214:215], v57 offset:2560
    s_cmp_eq_u32 s63, 0
    v_mfma_f32_16x16x32_bf16 v[176:179], v[224:227], v[124:127], v[176:179]
    s_cbranch_scc1 K_SP13
K_SPR13:
    s_ff1_i32_b32 s33, s63
    v_mfma_f32_16x16x32_bf16 v[164:167], v[228:231], v[120:123], v[164:167]
    s_bitset0_b32 s63, s33
    s_lshl_b32 s76, s33, 10
    v_mfma_f32_16x16x32_bf16 v[180:183], v[228:231], v[124:127], v[180:183]
    buffer_load_dwordx4 v[112:115], v25, s[20:23], s76 offen offset:0 sc1
    buffer_load_dwordx4 v[116:119], v26, s[20:23], s76 offen offset:0 sc1
    s_waitcnt vmcnt(8)
    v_mfma_f32_16x16x32_bf16 v[152:155], v[184:187], v[128:131], v[152:155]
    v_mad_u32_u24 v56, s78, 5, v24
    v_xor_b32 v58, 64, v56
    v_xor_b32 v57, 32, v56
    v_mfma_f32_16x16x32_bf16 v[168:171], v[184:187], v[132:135], v[168:171]
    v_xor_b32 v59, 96, v56
    ds_read_b64_tr_b16 v[216:217], v56 offset:0
    ds_read_b64_tr_b16 v[218:219], v58 offset:2560
    v_mfma_f32_16x16x32_bf16 v[156:159], v[188:191], v[128:131], v[156:159]
    ds_read_b64_tr_b16 v[220:221], v57 offset:0
    ds_read_b64_tr_b16 v[222:223], v59 offset:2560
    ds_read_b64_tr_b16 v[224:225], v58 offset:0
    v_mfma_f32_16x16x32_bf16 v[172:175], v[188:191], v[132:135], v[172:175]
    ds_read_b64_tr_b16 v[226:227], v56 offset:2560
    ds_read_b64_tr_b16 v[228:229], v59 offset:0
    v_mfma_f32_16x16x32_bf16 v[160:163], v[192:195], v[128:131], v[160:163]
    ds_read_b64_tr_b16 v[230:231], v57 offset:2560
    s_cmp_eq_u32 s63, 0
    v_mfma_f32_16x16x32_bf16 v[176:179], v[192:195], v[132:135], v[176:179]
    s_cbranch_scc1 K_SP14
K_SPR14:
    s_ff1_i32_b32 s33, s63
    v_mfma_f32_16x16x32_bf16 v[164:167], v[196:199], v[128:131], v[164:167]
    s_bitset0_b32 s63, s33
    s_lshl_b32 s77, s33, 10
    v_mfma_f32_16x16x32_bf16 v[180:183], v[196:199], v[132:135], v[180:183]
    buffer_load_dwordx4 v[120:123], v25, s[20:23], s77 offen offset:0 sc1
    buffer_load_dwordx4 v[124:127], v26, s[20:23], s77 offen offset:0 sc1
    s_waitcnt vmcnt(8) lgkmcnt(8)
    v_mfma_f32_16x16x32_bf16 v[152:155], v[200:203], v[136:139], v[152:155]
    v_mad_u32_u24 v56, s75, 5, v24
    v_xor_b32 v58, 64, v56
    v_xor_b32 v57, 32, v56
    v_mfma_f32_16x16x32_bf16 v[168:171], v[200:203], v[140:143], v[168:171]
    v_xor_b32 v59, 96, v56
    ds_read_b64_tr_b16 v[184:185], v56 offset:0
    ds_read_b64_tr_b16 v[186:187], v58 offset:2560
    v_mfma_f32_16x16x32_bf16 v[156:159], v[204:207], v[136:139], v[156:159]
    ds_read_b64_tr_b16 v[188:189], v57 offset:0
    ds_read_b64_tr_b16 v[190:191], v59 offset:2560
    ds_read_b64_tr_b16 v[192:193], v58 offset:0
    v_mfma_f32_16x16x32_bf16 v[172:175], v[204:207], v[140:143], v[172:175]
    ds_read_b64_tr_b16 v[194:195], v56 offset:2560
    ds_read_b64_tr_b16 v[196:197], v59 offset:0
    v_mfma_f32_16x16x32_bf16 v[160:163], v[208:211], v[136:139], v[160:163]
    ds_read_b64_tr_b16 v[198:199], v57 offset:2560
    s_cmp_eq_u32 s63, 0
    v_mfma_f32_16x16x32_bf16 v[176:179], v[208:211], v[140:143], v[176:179]
    s_cbranch_scc1 K_SP15
K_SPR15:
    s_ff1_i32_b32 s33, s63
    v_mfma_f32_16x16x32_bf16 v[164:167], v[212:215], v[136:139], v[164:167]
    s_bitset0_b32 s63, s33
    s_lshl_b32 s78, s33, 10
    v_mfma_f32_16x16x32_bf16 v[180:183], v[212:215], v[140:143], v[180:183]
    buffer_load_dwordx4 v[128:131], v25, s[20:23], s78 offen offset:0 sc1
    buffer_load_dwordx4 v[132:135], v26, s[20:23], s78 offen offset:0 sc1
    s_waitcnt vmcnt(8) lgkmcnt(8)
    v_mfma_f32_16x16x32_bf16 v[152:155], v[216:219], v[144:147], v[152:155]
    v_mad_u32_u24 v56, s76, 5, v24
    v_xor_b32 v58, 64, v56
    v_xor_b32 v57, 32, v56
    v_mfma_f32_16x16x32_bf16 v[168:171], v[216:219], v[148:151], v[168:171]
    v_xor_b32 v59, 96, v56
    ds_read_b64_tr_b16 v[200:201], v56 offset:0
    ds_read_b64_tr_b16 v[202:203], v58 offset:2560
    v_mfma_f32_16x16x32_bf16 v[156:159], v[220:223], v[144:147], v[156:159]
    ds_read_b64_tr_b16 v[204:205], v57 offset:0
    ds_read_b64_tr_b16 v[206:207], v59 offset:2560
    ds_read_b64_tr_b16 v[208:209], v58 offset:0
    v_mfma_f32_16x16x32_bf16 v[172:175], v[220:223], v[148:151], v[172:175]
    ds_read_b64_tr_b16 v[210:211], v56 offset:2560
    ds_read_b64_tr_b16 v[212:213], v59 offset:0
    v_mfma_f32_16x16x32_bf16 v[160:163], v[224:227], v[144:147], v[160:163]
    ds_read_b64_tr_b16 v[214:215], v57 offset:2560
    s_cmp_eq_u32 s63, 0
    v_mfma_f32_16x16x32_bf16 v[176:179], v[224:227], v[148:151], v[176:179]
    s_cbranch_scc1 K_SP16
K_SPR16:
    s_ff1_i32_b32 s33, s63
    v_mfma_f32_16x16x32_bf16 v[164:167], v[228:231], v[144:147], v[164:167]
    s_bitset0_b32 s63, s33
    s_lshl_b32 s75, s33, 10
    v_mfma_f32_16x16x32_bf16 v[180:183], v[228:231], v[148:151], v[180:183]
    buffer_load_dwordx4 v[136:139], v25, s[20:23], s75 offen offset:0 sc1
    buffer_load_dwordx4 v[140:143], v26, s[20:23], s75 offen offset:0 sc1
    s_waitcnt vmcnt(8) lgkmcnt(8)
    v_mfma_f32_16x16x32_bf16 v[152:155], v[184:187], v[104:107], v[152:155]
    v_mad_u32_u24 v56, s77, 5, v24
    v_xor_b32 v58, 64, v56
    v_xor_b32 v57, 32, v56
    v_mfma_f32_16x16x32_bf16 v[168:171], v[184:187], v[108:111], v[168:171]
    v_xor_b32 v59, 96, v56
    ds_read_b64_tr_b16 v[216:217], v56 offset:0
    ds_read_b64_tr_b16 v[218:219], v58 offset:2560
    v_mfma_f32_16x16x32_bf16 v[156:159], v[188:191], v[104:107], v[156:159]
    ds_read_b64_tr_b16 v[220:221], v57 offset:0
    ds_read_b64_tr_b16 v[222:223], v59 offset:2560
    ds_read_b64_tr_b16 v[224:225], v58 offset:0
    v_mfma_f32_16x16x32_bf16 v[172:175], v[188:191], v[108:111], v[172:175]
    ds_read_b64_tr_b16 v[226:227], v56 offset:2560
    ds_read_b64_tr_b16 v[228:229], v59 offset:0
    v_mfma_f32_16x16x32_bf16 v[160:163], v[192:195], v[104:107], v[160:163]
    ds_read_b64_tr_b16 v[230:231], v57 offset:2560
    s_andn2_b32 s33, s66, s63
    v_mfma_f32_16x16x32_bf16 v[176:179], v[192:195], v[108:111], v[176:179]
    s_bfe_u32 s33, s33, 0x40008
    s_cmp_eq_u32 s33, 15
    v_mfma_f32_16x16x32_bf16 v[164:167], v[196:199], v[104:107], v[164:167]
    s_cselect_b32 s76, 0, 1024
    s_xor_b32 s69, s76, 1024
    v_mfma_f32_16x16x32_bf16 v[180:183], v[196:199], v[108:111], v[180:183]
    buffer_load_dwordx4 v[144:147], v35, s[20:23], s76 offen offset:2048 sc1
    buffer_load_dwordx4 v[148:151], v36, s[20:23], s76 offen offset:2048 sc1
    s_waitcnt vmcnt(8) lgkmcnt(8)
    v_mfma_f32_16x16x32_bf16 v[152:155], v[200:203], v[112:115], v[152:155]
    v_mad_u32_u24 v56, s78, 5, v24
    v_xor_b32 v58, 64, v56
    v_xor_b32 v57, 32, v56
    v_mfma_f32_16x16x32_bf16 v[168:171], v[200:203], v[116:119], v[168:171]
    v_xor_b32 v59, 96, v56
    ds_read_b64_tr_b16 v[184:185], v56 offset:0
    ds_read_b64_tr_b16 v[186:187], v58 offset:2560
    v_mfma_f32_16x16x32_bf16 v[156:159], v[204:207], v[112:115], v[156:159]
    ds_read_b64_tr_b16 v[188:189], v57 offset:0
    ds_read_b64_tr_b16 v[190:191], v59 offset:2560
    ds_read_b64_tr_b16 v[192:193], v58 offset:0
    v_mfma_f32_16x16x32_bf16 v[172:175], v[204:207], v[116:119], v[172:175]
    ds_read_b64_tr_b16 v[194:195], v56 offset:2560
    ds_read_b64_tr_b16 v[196:197], v59 offset:0
    v_mfma_f32_16x16x32_bf16 v[160:163], v[208:211], v[112:115], v[160:163]
    ds_read_b64_tr_b16 v[198:199], v57 offset:2560
    s_cmp_eq_u32 s63, 0
    v_mfma_f32_16x16x32_bf16 v[176:179], v[208:211], v[116:119], v[176:179]
    s_cbranch_scc1 K_SP18
K_SPR18:
    s_ff1_i32_b32 s33, s63
    v_mfma_f32_16x16x32_bf16 v[164:167], v[212:215], v[112:115], v[164:167]
    s_bitset0_b32 s63, s33
    s_lshl_b32 s77, s33, 10
    v_mfma_f32_16x16x32_bf16 v[180:183], v[212:215], v[116:119], v[180:183]
    buffer_load_dwordx4 v[104:107], v25, s[20:23], s77 offen offset:0 sc1
    buffer_load_dwordx4 v[108:111], v26, s[20:23], s77 offen offset:0 sc1
    s_waitcnt vmcnt(8) lgkmcnt(8)
    v_mfma_f32_16x16x32_bf16 v[152:155], v[216:219], v[120:123], v[152:155]
    v_mad_u32_u24 v56, s75, 5, v24
    v_xor_b32 v58, 64, v56
    v_mfma_f32_16x16x32_bf16 v[168:171], v[216:219], v[124:127], v[168:171]
    v_xor_b32 v57, 32, v56
    v_xor_b32 v59, 96, v56
    v_mfma_f32_16x16x32_bf16 v[156:159], v[220:223], v[120:123], v[156:159]
    ds_read_b64_tr_b16 v[200:201], v56 offset:0
    ds_read_b64_tr_b16 v[202:203], v58 offset:2560
    v_mfma_f32_16x16x32_bf16 v[172:175], v[220:223], v[124:127], v[172:175]
    ds_read_b64_tr_b16 v[204:205], v57 offset:0
    ds_read_b64_tr_b16 v[206:207], v59 offset:2560
    v_mfma_f32_16x16x32_bf16 v[160:163], v[224:227], v[120:123], v[160:163]
    ds_read_b64_tr_b16 v[208:209], v58 offset:0
    ds_read_b64_tr_b16 v[210:211], v56 offset:2560
    v_mfma_f32_16x16x32_bf16 v[176:179], v[224:227], v[124:127], v[176:179]
    ds_read_b64_tr_b16 v[212:213], v59 offset:0
    ds_read_b64_tr_b16 v[214:215], v57 offset:2560
    v_mfma_f32_16x16x32_bf16 v[164:167], v[228:231], v[120:123], v[164:167]
    buffer_load_dwordx4 v[112:115], v35, s[20:23], s69 offen offset:2048 sc1
    buffer_load_dwordx4 v[116:119], v36, s[20:23], s69 offen offset:2048 sc1
    v_mfma_f32_16x16x32_bf16 v[180:183], v[228:231], v[124:127], v[180:183]
    s_waitcnt vmcnt(8) lgkmcnt(8)
    v_mfma_f32_16x16x32_bf16 v[152:155], v[184:187], v[128:131], v[152:155]
    v_mad_u32_u24 v56, s76, 20, v60
    v_xor_b32 v58, 64, v56
    v_mfma_f32_16x16x32_bf16 v[168:171], v[184:187], v[132:135], v[168:171]
    v_xor_b32 v57, 32, v56
    v_xor_b32 v59, 96, v56
    v_mfma_f32_16x16x32_bf16 v[156:159], v[188:191], v[128:131], v[156:159]
    ds_read_b64_tr_b16 v[216:217], v56 offset:40960
    ds_read_b64_tr_b16 v[218:219], v58 offset:43520
    v_mfma_f32_16x16x32_bf16 v[172:175], v[188:191], v[132:135], v[172:175]
    ds_read_b64_tr_b16 v[220:221], v57 offset:40960
    ds_read_b64_tr_b16 v[222:223], v59 offset:43520
    v_mfma_f32_16x16x32_bf16 v[160:163], v[192:195], v[128:131], v[160:163]
    ds_read_b64_tr_b16 v[224:225], v58 offset:40960
    ds_read_b64_tr_b16 v[226:227], v56 offset:43520
    v_mfma_f32_16x16x32_bf16 v[176:179], v[192:195], v[132:135], v[176:179]
    ds_read_b64_tr_b16 v[228:229], v59 offset:40960
    ds_read_b64_tr_b16 v[230:231], v57 offset:43520
    v_mfma_f32_16x16x32_bf16 v[164:167], v[196:199], v[128:131], v[164:167]
    v_mfma_f32_16x16x32_bf16 v[180:183], v[196:199], v[132:135], v[180:183]
    s_waitcnt vmcnt(6) lgkmcnt(8)
    v_mfma_f32_16x16x32_bf16 v[152:155], v[200:203], v[136:139], v[152:155]
    v_mad_u32_u24 v56, s77, 5, v24
    v_xor_b32 v58, 64, v56
    v_mfma_f32_16x16x32_bf16 v[168:171], v[200:203], v[140:143], v[168:171]
    v_xor_b32 v57, 32, v56
    v_xor_b32 v59, 96, v56
    v_mfma_f32_16x16x32_bf16 v[156:159], v[204:207], v[136:139], v[156:159]
    ds_read_b64_tr_b16 v[184:185], v56 offset:0
    ds_read_b64_tr_b16 v[186:187], v58 offset:2560
    v_mfma_f32_16x16x32_bf16 v[172:175], v[204:207], v[140:143], v[172:175]
    ds_read_b64_tr_b16 v[188:189], v57 offset:0
    ds_read_b64_tr_b16 v[190:191], v59 offset:2560
    v_mfma_f32_16x16x32_bf16 v[160:163], v[208:211], v[136:139], v[160:163]
    ds_read_b64_tr_b16 v[192:193], v58 offset:0
    ds_read_b64_tr_b16 v[194:195], v56 offset:2560
    v_mfma_f32_16x16x32_bf16 v[176:179], v[208:211], v[140:143], v[176:179]
    ds_read_b64_tr_b16 v[196:197], v59 offset:0
    ds_read_b64_tr_b16 v[198:199], v57 offset:2560
    v_mfma_f32_16x16x32_bf16 v[164:167], v[212:215], v[136:139], v[164:167]
    v_mfma_f32_16x16x32_bf16 v[180:183], v[212:215], v[140:143], v[180:183]
    s_waitcnt vmcnt(4) lgkmcnt(8)
    v_mfma_f32_16x16x32_bf16 v[152:155], v[216:219], v[144:147], v[152:155]
    v_mad_u32_u24 v56, s69, 20, v60
    v_xor_b32 v58, 64, v56
    v_mfma_f32_16x16x32_bf16 v[168:171], v[216:219], v[148:151], v[168:171]
    v_xor_b32 v57, 32, v56
    v_xor_b32 v59, 96, v56
    v_mfma_f32_16x16x32_bf16 v[156:159], v[220:223], v[144:147], v[156:159]
    ds_read_b64_tr_b16 v[200:201], v56 offset:40960
    ds_read_b64_tr_b16 v[202:203], v58 offset:43520
    v_mfma_f32_16x16x32_bf16 v[172:175], v[220:223], v[148:151], v[172:175]
    ds_read_b64_tr_b16 v[204:205], v57 offset:40960
    ds_read_b64_tr_b16 v[206:207], v59 offset:43520
    v_mfma_f32_16x16x32_bf16 v[160:163], v[224:227], v[144:147], v[160:163]
    ds_read_b64_tr_b16 v[208:209], v58 offset:40960
    ds_read_b64_tr_b16 v[210:211], v56 offset:43520
    v_mfma_f32_16x16x32_bf16 v[176:179], v[224:227], v[148:151], v[176:179]
    ds_read_b64_tr_b16 v[212:213], v59 offset:40960
    ds_read_b64_tr_b16 v[214:215], v57 offset:43520
    v_mfma_f32_16x16x32_bf16 v[164:167], v[228:231], v[144:147], v[164:167]
    v_mfma_f32_16x16x32_bf16 v[180:183], v[228:231], v[148:151], v[180:183]
    s_waitcnt vmcnt(2) lgkmcnt(8)
    v_mfma_f32_16x16x32_bf16 v[152:155], v[184:187], v[104:107], v[152:155]
    v_mfma_f32_16x16x32_bf16 v[156:159], v[188:191], v[104:107], v[156:159]
    v_mfma_f32_16x16x32_bf16 v[160:163], v[192:195], v[104:107], v[160:163]
    v_mfma_f32_16x16x32_bf16 v[164:167], v[196:199], v[104:107], v[164:167]
    s_sub_u32 s59, s56, s58
    s_cmp_lt_u32 s59, 32
    s_cbranch_scc1 K_YROW0
K_NOY0:
    s_sub_u32 s59, s57, s58
    s_cmp_lt_u32 s59, 32
    s_cbranch_scc1 K_YROW1
K_NOY1:
    s_waitcnt vmcnt(0) lgkmcnt(0)
    v_mfma_f32_16x16x32_bf16 v[152:155], v[200:203], v[112:115], v[152:155]
    v_mfma_f32_16x16x32_bf16 v[156:159], v[204:207], v[112:115], v[156:159]
    v_mfma_f32_16x16x32_bf16 v[160:163], v[208:211], v[112:115], v[160:163]
    v_mfma_f32_16x16x32_bf16 v[164:167], v[212:215], v[112:115], v[164:167]
    v_mfma_f32_16x16x32_bf16 v[168:171], v[184:187], v[108:111], v[168:171]
    v_mfma_f32_16x16x32_bf16 v[172:175], v[188:191], v[108:111], v[172:175]
    v_mfma_f32_16x16x32_bf16 v[176:179], v[192:195], v[108:111], v[176:179]
    s_nop 1
    v_fma_f32 v152, v152, v64, v72
    v_fma_f32 v153, v153, v64, v73
    v_fma_f32 v154, v154, v64, v74
    v_mfma_f32_16x16x32_bf16 v[180:183], v[196:199], v[108:111], v[180:183]
    v_fma_f32 v155, v155, v64, v75
    v_cvt_pk_bf16_f32 v40, v152, v153
    v_cvt_pk_bf16_f32 v41, v154, v155
    v_mfma_f32_16x16x32_bf16 v[168:171], v[200:203], v[116:119], v[168:171]
    v_fma_f32 v156, v156, v64, v76
    v_fma_f32 v157, v157, v64, v77
    ds_write_b64 v29, v[40:41] offset:0
    v_mfma_f32_16x16x32_bf16 v[172:175], v[204:207], v[116:119], v[172:175]
    v_fma_f32 v158, v158, v64, v78
    v_fma_f32 v159, v159, v64, v79
    v_cvt_pk_bf16_f32 v42, v156, v157
    v_mfma_f32_16x16x32_bf16 v[176:179], v[208:211], v[116:119], v[176:179]
    v_cvt_pk_bf16_f32 v43, v158, v159
    v_fma_f32 v160, v160, v64, v80
    v_fma_f32 v161, v161, v64, v81
    v_mfma_f32_16x16x32_bf16 v[180:183], v[212:215], v[116:119], v[180:183]
    ds_write_b64 v30, v[42:43] offset:0
    v_fma_f32 v162, v162, v64, v82
    v_fma_f32 v163, v163, v64, v83
    v_cvt_pk_bf16_f32 v44, v160, v161
    v_cvt_pk_bf16_f32 v45, v162, v163
    v_pk_fma_f32 v[164:165], v[164:165], v[64:65], v[84:85] op_sel_hi:[1,0,1]
    v_pk_fma_f32 v[166:167], v[166:167], v[64:65], v[86:87] op_sel_hi:[1,0,1]
    ds_write_b64 v31, v[44:45] offset:0
    v_cvt_pk_bf16_f32 v46, v164, v165
    v_cvt_pk_bf16_f32 v47, v166, v167
    ds_write_b64 v32, v[46:47] offset:0
    ds_read_b128 v[72:75], v33 offset:0
    ds_read_b128 v[76:79], v33 offset:1024
    v_pk_fma_f32 v[168:169], v[168:169], v[66:67], v[88:89] op_sel_hi:[1,0,1]
    v_pk_fma_f32 v[170:171], v[170:171], v[66:67], v[90:91] op_sel_hi:[1,0,1]
    v_cvt_pk_bf16_f32 v48, v168, v169
    v_cvt_pk_bf16_f32 v49, v170, v171
    v_pk_fma_f32 v[172:173], v[172:173], v[66:67], v[92:93] op_sel_hi:[1,0,1]
    v_pk_fma_f32 v[174:175], v[174:175], v[66:67], v[94:95] op_sel_hi:[1,0,1]
    v_cvt_pk_bf16_f32 v50, v172, v173
    v_cvt_pk_bf16_f32 v51, v174, v175
    v_pk_fma_f32 v[176:177], v[176:177], v[66:67], v[96:97] op_sel_hi:[1,0,1]
    v_pk_fma_f32 v[178:179], v[178:179], v[66:67], v[98:99] op_sel_hi:[1,0,1]
    v_cvt_pk_bf16_f32 v52, v176, v177
    v_cvt_pk_bf16_f32 v53, v178, v179
    v_pk_fma_f32 v[180:181], v[180:181], v[66:67], v[100:101] op_sel_hi:[1,0,1]
    v_pk_fma_f32 v[182:183], v[182:183], v[66:67], v[102:103] op_sel_hi:[1,0,1]
    v_cvt_pk_bf16_f32 v54, v180, v181
    v_cvt_pk_bf16_f32 v55, v182, v183
    s_waitcnt lgkmcnt(0)
    buffer_store_dwordx4 v[72:75], v27, s[48:51], s71 offen sc1
    buffer_store_dwordx4 v[76:79], v28, s[48:51], s72 offen sc1
    ds_write_b64 v29, v[48:49] offset:2048
    ds_write_b64 v30, v[50:51] offset:2048
    ds_write_b64 v31, v[52:53] offset:2048
    ds_write_b64 v32, v[54:55] offset:2048
    ds_read_b128 v[88:91], v33 offset:2048
    ds_read_b128 v[92:95], v33 offset:3072
    s_waitcnt lgkmcnt(1)
    buffer_store_dwordx4 v[88:91], v27, s[48:51], s73 offen sc1
    s_waitcnt lgkmcnt(0)
    buffer_store_dwordx4 v[92:95], v28, s[48:51], s74 offen sc1
K_END:
K_EXIT:
    s_endpgm
.p2align 12
WP_spin:
    s_setpc_b64 s[38:39]
K_SP0:
    ds_read_b32 v2, v12 offset:32
    s_waitcnt lgkmcnt(0)
    v_readfirstlane_b32 s33, v2
    s_nop 3
    s_lshr_b32 s63, s33, s64
    s_lshr_b32 s33, s33, s65
    s_and_b32 s63, s63, s33
    s_and_b32 s63, s63, 0xff
    s_andn2_b32 s63, s63, s66
    s_cbranch_scc0 K_SP0
    s_or_b32 s66, s66, s63
    s_branch K_SPR0
K_SP1:
    ds_read_b32 v2, v12 offset:32
    s_waitcnt lgkmcnt(0)
    v_readfirstlane_b32 s33, v2
    s_nop 3
    s_lshr_b32 s63, s33, s64
    s_lshr_b32 s33, s33, s65
    s_and_b32 s63, s63, s33
    s_and_b32 s63, s63, 0xff
    s_andn2_b32 s63, s63, s66
    s_cbranch_scc0 K_SP1
    s_or_b32 s66, s66, s63
    s_branch K_SPR1
K_SP2:
    ds_read_b32 v2, v12 offset:32
    s_waitcnt lgkmcnt(0)
    v_readfirstlane_b32 s33, v2
    s_nop 3
    s_lshr_b32 s63, s33, s64
    s_lshr_b32 s33, s33, s65
    s_and_b32 s63, s63, s33
    s_and_b32 s63, s63, 0xff
    s_andn2_b32 s63, s63, s66
    s_cbranch_scc0 K_SP2
    s_or_b32 s66, s66, s63
    s_branch K_SPR2
K_SP3:
    ds_read_b32 v2, v12 offset:32
    s_waitcnt lgkmcnt(0)
    v_readfirstlane_b32 s33, v2
    s_nop 3
    s_lshr_b32 s63, s33, s64
    s_lshr_b32 s33, s33, s65
    s_and_b32 s63, s63, s33
    s_and_b32 s63, s63, 0xff
    s_andn2_b32 s63, s63, s66
    s_cbranch_scc0 K_SP3
    s_or_b32 s66, s66, s63
    s_branch K_SPR3
K_SP4:
    ds_read_b32 v2, v12 offset:32
    s_waitcnt lgkmcnt(0)
    v_readfirstlane_b32 s33, v2
    s_nop 3
    s_lshr_b32 s63, s33, s64
    s_lshr_b32 s33, s33, s65
    s_and_b32 s63, s63, s33
    s_and_b32 s63, s63, 0xff
    s_andn2_b32 s63, s63, s66
    s_cbranch_scc0 K_SP4
    s_or_b32 s66, s66, s63
    s_branch K_SPR4
K_SP5:
    ds_read_b32 v2, v12 offset:32
    s_waitcnt lgkmcnt(0)
    v_readfirstlane_b32 s33, v2
    s_nop 3
    s_lshr_b32 s63, s33, s64
    s_lshr_b32 s33, s33, s65
    s_and_b32 s63, s63, s33
    s_and_b32 s63, s63, 0xff
    s_andn2_b32 s63, s63, s66
    s_cbranch_scc0 K_SP5
    s_or_b32 s66, s66, s63
    s_branch K_SPR5
K_SP6:
    ds_read_b32 v2, v12 offset:32
    s_waitcnt lgkmcnt(0)
    v_readfirstlane_b32 s33, v2
    s_nop 3
    s_lshr_b32 s63, s33, s64
    s_lshr_b32 s33, s33, s65
    s_and_b32 s63, s63, s33
    s_and_b32 s63, s63, 0xff
    s_andn2_b32 s63, s63, s66
    s_cbranch_scc0 K_SP6
    s_or_b32 s66, s66, s63
    s_branch K_SPR6
K_SP8:
    ds_read_b32 v2, v12 offset:32
    s_waitcnt lgkmcnt(0)
    v_readfirstlane_b32 s33, v2
    s_nop 3
    s_lshr_b32 s63, s33, s64
    s_lshr_b32 s33, s33, s65
    s_and_b32 s63, s63, s33
    s_and_b32 s63, s63, 0xff
    s_andn2_b32 s63, s63, s66
    s_cbranch_scc0 K_SP8
    s_or_b32 s66, s66, s63
    s_branch K_SPR8
K_SP10:
    ds_read_b32 v2, v12 offset:32
    s_waitcnt lgkmcnt(0)
    v_readfirstlane_b32 s33, v2
    s_nop 3
    s_lshr_b32 s63, s33, s64
    s_lshr_b32 s33, s33, s65
    s_and_b32 s63, s63, s33
    s_and_b32 s63, s63, 0xff00
    s_andn2_b32 s63, s63, s66
    s_cbranch_scc0 K_SP10
    s_or_b32 s66, s66, s63
    s_branch K_SPR10
K_SP11:
    ds_read_b32 v2, v12 offset:32
    s_waitcnt lgkmcnt(0)
    v_readfirstlane_b32 s33, v2
    s_nop 3
    s_lshr_b32 s63, s33, s64
    s_lshr_b32 s33, s33, s65
    s_and_b32 s63, s63, s33
    s_and_b32 s63, s63, 0xff00
    s_andn2_b32 s63, s63, s66
    s_cbranch_scc0 K_SP11
    s_or_b32 s66, s66, s63
    s_branch K_SPR11
K_SP12:
    ds_read_b32 v2, v12 offset:32
    s_waitcnt lgkmcnt(0)
    v_readfirstlane_b32 s33, v2
    s_nop 3
    s_lshr_b32 s63, s33, s64
    s_lshr_b32 s33, s33, s65
    s_and_b32 s63, s63, s33
    s_and_b32 s63, s63, 0xff00
    s_andn2_b32 s63, s63, s66
    s_cbranch_scc0 K_SP12
    s_or_b32 s66, s66, s63
    s_branch K_SPR12
K_SP13:
    ds_read_b32 v2, v12 offset:32
    s_waitcnt lgkmcnt(0)
    v_readfirstlane_b32 s33, v2
    s_nop 3
    s_lshr_b32 s63, s33, s64
    s_lshr_b32 s33, s33, s65
    s_and_b32 s63, s63, s33
    s_and_b32 s63, s63, 0xff00
    s_andn2_b32 s63, s63, s66
    s_cbranch_scc0 K_SP13
    s_or_b32 s66, s66, s63
    s_branch K_SPR13
K_SP14:
    ds_read_b32 v2, v12 offset:32
    s_waitcnt lgkmcnt(0)
    v_readfirstlane_b32 s33, v2
    s_nop 3
    s_lshr_b32 s63, s33, s64
    s_lshr_b32 s33, s33, s65
    s_and_b32 s63, s63, s33
    s_and_b32 s63, s63, 0xff00
    s_andn2_b32 s63, s63, s66
    s_cbranch_scc0 K_SP14
    s_or_b32 s66, s66, s63
    s_branch K_SPR14
K_SP15:
    ds_read_b32 v2, v12 offset:32
    s_waitcnt lgkmcnt(0)
    v_readfirstlane_b32 s33, v2
    s_nop 3
    s_lshr_b32 s63, s33, s64
    s_lshr_b32 s33, s33, s65
    s_and_b32 s63, s63, s33
    s_and_b32 s63, s63, 0xff00
    s_andn2_b32 s63, s63, s66
    s_cbranch_scc0 K_SP15
    s_or_b32 s66, s66, s63
    s_branch K_SPR15
K_SP16:
    ds_read_b32 v2, v12 offset:32
    s_waitcnt lgkmcnt(0)
    v_readfirstlane_b32 s33, v2
    s_nop 3
    s_lshr_b32 s63, s33, s64
    s_lshr_b32 s33, s33, s65
    s_and_b32 s63, s63, s33
    s_and_b32 s63, s63, 0xff00
    s_andn2_b32 s63, s63, s66
    s_cbranch_scc0 K_SP16
    s_or_b32 s66, s66, s63
    s_branch K_SPR16
K_SP18:
    ds_read_b32 v2, v12 offset:32
    s_waitcnt lgkmcnt(0)
    v_readfirstlane_b32 s33, v2
    s_nop 3
    s_lshr_b32 s63, s33, s64
    s_lshr_b32 s33, s33, s65
    s_and_b32 s63, s63, s33
    s_and_b32 s63, s63, 0xff00
    s_andn2_b32 s63, s63, s66
    s_cbranch_scc0 K_SP18
    s_or_b32 s66, s66, s63
    s_branch K_SPR18
WP_yr0:
    s_setpc_b64 s[38:39]
K_YROW0:
    v_lshlrev_b32 v5, 4, v9
    v_add_u32 v5, 158976, v5
    v_and_b32 v3, 15, v1
    s_and_b32 s33, s59, 15
    v_cmp_eq_u32 vcc, s33, v3
    s_mov_b32 s3, 1048576
K_P2_GY0:
    ds_read_b32 v2, v12 offset:64
    s_sub_u32 s3, s3, 1
    s_waitcnt lgkmcnt(0)
    v_readfirstlane_b32 s33, v2
    s_nop 3
    s_cselect_b32 s33, 1, s33
    s_cmp_lt_u32 s33, 1
    s_cbranch_scc1 K_P2_GY0
    s_mov_b64 exec, vcc
    s_cmp_ge_u32 s59, 16
    s_cbranch_scc1 K_YR1_0
    ds_read_b128 v[72:75], v5 offset:0
    ds_read_b128 v[76:79], v5 offset:64
    ds_read_b128 v[80:83], v5 offset:128
    ds_read_b128 v[84:87], v5 offset:192
    s_mov_b64 exec, -1
    s_branch K_NOY0
K_YR1_0:
    ds_read_b128 v[88:91], v5 offset:0
    ds_read_b128 v[92:95], v5 offset:64
    ds_read_b128 v[96:99], v5 offset:128
    ds_read_b128 v[100:103], v5 offset:192
    s_mov_b64 exec, -1
    s_branch K_NOY0
K_YROW1:
    v_lshlrev_b32 v5, 4, v9
    v_add_u32 v5, 159232, v5
    v_and_b32 v3, 15, v1
    s_and_b32 s33, s59, 15
    v_cmp_eq_u32 vcc, s33, v3
    s_mov_b32 s3, 1048576
K_P2_GY1:
    ds_read_b32 v2, v12 offset:68
    s_sub_u32 s3, s3, 1
    s_waitcnt lgkmcnt(0)
    v_readfirstlane_b32 s33, v2
    s_nop 3
    s_cselect_b32 s33, 1, s33
    s_cmp_lt_u32 s33, 1
    s_cbranch_scc1 K_P2_GY1
    s_mov_b64 exec, vcc
    s_cmp_ge_u32 s59, 16
    s_cbranch_scc1 K_YR1_1
    ds_read_b128 v[72:75], v5 offset:0
    ds_read_b128 v[76:79], v5 offset:64
    ds_read_b128 v[80:83], v5 offset:128
    ds_read_b128 v[84:87], v5 offset:192
    s_mov_b64 exec, -1
    s_branch K_NOY1
K_YR1_1:
    ds_read_b128 v[88:91], v5 offset:0
    ds_read_b128 v[92:95], v5 offset:64
    ds_read_b128 v[96:99], v5 offset:128
    ds_read_b128 v[100:103], v5 offset:192
    s_mov_b64 exec, -1
    s_branch K_NOY1
.p2align 12
WP_gen:
    s_setpc_b64 s[38:39]
K_P2:
    s_cmp_ge_u32 s30, 4
    s_cbranch_scc1 K_P2_HELP
    v_mov_b32 v12, 158720
    s_cmp_lg_u32 s30, 0
    s_cbranch_scc1 K_P2_W13
    v_lshrrev_b32 v3, 4, v1
    v_and_b32 v4, 7, v1
    v_lshrrev_b32 v2, 3, v1
    v_xor_b32 v4, v4, v3
    v_mul_u32_u24 v2, 1280, v2
    v_lshl_add_u32 v27, v4, 4, v2
    v_xor_b32 v28, 64, v27
    s_mov_b32 s58, 0
K_P2_XD:
    s_lshl_b32 s59, s40, 3
    s_lshl1_add_u32 s59, s58, s59
    s_mul_i32 s59, s59, 20480
    s_lshl_b32 s33, s41, 7
    s_add_u32 s59, s59, s33
    s_lshl_b32 s33, s58, 12
    s_add_u32 m0, s33, 140288
    s_add_u32 s3, s59, 0
    buffer_load_dwordx4 v27, s[12:15], s3 offen lds
    s_add_u32 m0, s33, 141312
    s_add_u32 s3, s59, 10240
    buffer_load_dwordx4 v28, s[12:15], s3 offen lds
    s_add_u32 m0, s33, 142336
    s_add_u32 s3, s59, 20480
    buffer_load_dwordx4 v27, s[12:15], s3 offen lds
    s_add_u32 m0, s33, 143360
    s_add_u32 s3, s59, 30720
    buffer_load_dwordx4 v28, s[12:15], s3 offen lds
    s_add_u32 s58, s58, 1
    s_cmp_lt_u32 s58, 4
    s_cbranch_scc1 K_P2_XD
    s_waitcnt vmcnt(0)
    s_branch K_P2_AUXW
K_P2_W13:
    v_lshrrev_b32 v2, 3, v1
    v_mul_u32_u24 v2, 1280, v2
    v_lshrrev_b32 v3, 4, v1
    v_lshlrev_b32 v3, 1, v3
    v_and_b32 v4, 7, v1
    v_xor_b32 v3, v3, v4
    v_lshl_add_u32 v2, v3, 4, v2
    s_lshl_b32 s33, s41, 7
    v_add_u32 v22, s33, v2
    s_mov_b32 s60, 0xfda87520
    s_mov_b32 s61, 0xecb96431
    s_sub_u32 s58, s30, 1
K_P2_WS:
    s_lshl_b32 s3, s58, 2
    s_lshr_b64 s[4:5], s[60:61], s3
    s_and_b32 s4, s4, 15
    s_mul_i32 s4, s4, 51200
    s_mul_i32 s59, s58, 5120
    s_add_u32 s52, s4, 0
    s_add_u32 m0, s59, 0
    s_waitcnt vmcnt(11)
    buffer_load_dwordx4 v22, s[24:27], s52 offen lds
    s_add_u32 s52, s4, 10240
    s_add_u32 m0, s59, 1024
    s_waitcnt vmcnt(11)
    buffer_load_dwordx4 v22, s[24:27], s52 offen lds
    s_add_u32 s52, s4, 20480
    s_add_u32 m0, s59, 2048
    s_waitcnt vmcnt(11)
    buffer_load_dwordx4 v22, s[24:27], s52 offen lds
    s_add_u32 s52, s4, 30720
    s_add_u32 m0, s59, 3072
    s_waitcnt vmcnt(11)
    buffer_load_dwordx4 v22, s[24:27], s52 offen lds
    s_add_u32 s52, s4, 40960
    s_add_u32 m0, s59, 4096
    s_waitcnt vmcnt(11)
    buffer_load_dwordx4 v22, s[24:27], s52 offen lds
    s_cmp_ge_u32 s58, 3
    s_cbranch_scc1 K_P2_WS1
    v_mov_b32 v3, 1
    s_waitcnt vmcnt(5)
    s_mov_b64 exec, 1
    ds_add_u32 v12, v3 offset:52
    s_mov_b64 exec, -1
K_P2_WS1:
    s_add_u32 s58, s58, 3
    s_cmp_lt_u32 s58, 16
    s_cbranch_scc1 K_P2_WS
K_P2_AUXW:
    v_mov_b32 v34, 1
    s_waitcnt vmcnt(10)
    s_mov_b64 exec, 1
    ds_add_u32 v12, v34 offset:72
    s_mov_b64 exec, -1
    s_lshl_b32 s54, s40, 7
    v_lshrrev_b32 v9, 4, v1
    v_mov_b32 v12, 158720
    s_add_u32 s20, s10, 0x100000
    s_addc_u32 s21, s11, 0
    s_mov_b32 s22, 0x280000
    s_mov_b32 s23, 0x20000
    s_add_u32 s16, s10, 0x1000
    s_addc_u32 s17, s11, 0
    s_mov_b32 s18, 0x2000
    s_mov_b32 s19, 0x20000
    s_mov_b32 s48, s6
    s_mov_b32 s49, s7
    s_mov_b32 s50, 0x280000
    s_mov_b32 s51, 0x20000
    s_lshl_b32 s53, s40, 3
    s_lshl1_add_u32 s53, s30, s53
    s_mov_b32 s55, 20480
    v_bfe_u32 v20, v1, 2, 2
    v_and_b32 v21, 3, v1
    s_mul_i32 s3, s53, 20480
    v_lshl_add_u32 v25, v1, 4, s3
    v_add_u32 v26, 20480, v25
    v_add_u32 v35, 16384, v25
    v_add_u32 v36, 16384, v26
    v_and_b32 v2, 15, v1
    s_lshl_b32 s3, s53, 6
    v_lshl_add_u32 v23, v2, 2, s3
    v_lshl_add_u32 v2, v9, 2, v20
    v_bfe_u32 v3, v2, 1, 2
    v_lshlrev_b32 v2, 7, v2
    v_lshl_add_u32 v2, v21, 3, v2
    v_lshl_add_u32 v24, v3, 5, v2
    v_lshrrev_b32 v3, 1, v20
    v_mul_u32_u24 v2, 40, v9
    v_add3_u32 v2, v2, 16, v20
    v_lshlrev_b32 v2, 7, v2
    v_lshl_add_u32 v2, v21, 3, v2
    v_xor_b32 v4, 0, v3
    v_lshl_add_u32 v60, v4, 5, v2
    v_xor_b32 v4, 1, v3
    v_lshl_add_u32 v61, v4, 5, v2
    v_xor_b32 v4, 2, v3
    v_lshl_add_u32 v62, v4, 5, v2
    v_xor_b32 v4, 3, v3
    v_lshl_add_u32 v63, v4, 5, v2
    v_lshrrev_b32 v3, 4, v1
    v_and_b32 v4, 7, v1
    v_lshrrev_b32 v2, 3, v1
    v_xor_b32 v4, v4, v3
    v_mul_u32_u24 v2, 1280, v2
    v_lshl_add_u32 v27, v4, 4, v2
    v_xor_b32 v28, 64, v27
    s_lshl_b32 s71, s40, 3
    s_lshl1_add_u32 s71, s30, s71
    s_mul_i32 s71, s71, 20480
    s_lshl_b32 s33, s41, 7
    s_add_u32 s71, s71, s33
    s_add_u32 s72, s71, 10240
    s_add_u32 s73, s71, 20480
    s_add_u32 s74, s71, 30720
    s_lshl_b32 s3, s30, 12
    s_add_u32 s3, s3, 140288
    v_lshl_add_u32 v33, v1, 4, s3
    v_and_b32 v2, 15, v1
    v_lshrrev_b32 v3, 1, v2
    v_lshrrev_b32 v4, 5, v1
    v_xor_b32 v3, v3, v4
    v_lshlrev_b32 v3, 4, v3
    v_lshl_add_u32 v3, v2, 7, v3
    v_and_b32 v4, 1, v9
    v_lshl_add_u32 v3, v4, 3, v3
    v_add_u32 v29, s3, v3
    v_xor_b32 v30, 32, v29
    v_xor_b32 v31, 64, v29
    v_xor_b32 v32, 96, v29
    s_and_b32 s33, s40, 3
    s_lshl_b32 s33, s33, 3
    s_lshr_b32 s33, 0x7f06037f, s33
    s_and_b32 s33, s33, 0xff
    s_lshl_b32 s3, s30, 1
    s_cmp_ge_u32 s3, s33
    s_cselect_b32 s64, 16, 0
    s_add_u32 s3, s3, 1
    s_cmp_ge_u32 s3, s33
    s_cselect_b32 s65, 16, 0
    s_mov_b32 s63, 0
    s_mov_b32 s66, 0
    s_mov_b32 s67, 16384
    s_mov_b32 s3, 1048576
K_P2_GWA:
    ds_read_b32 v2, v12 offset:72
    s_sub_u32 s3, s3, 1
    s_waitcnt lgkmcnt(0)
    v_readfirstlane_b32 s33, v2
    s_nop 3
    s_cselect_b32 s33, 4, s33
    s_cmp_lt_u32 s33, 4
    s_cbranch_scc1 K_P2_GWA
    s_branch K_P2_GEMM
WP_help:
    s_setpc_b64 s[38:39]
K_LATE:
    s_sub_u32 s44, s30, 4
K_WOL:
    s_lshl_b32 s50, s44, 2
    s_lshr_b32 s50, 0x6431, s50
    s_and_b32 s50, s50, 7
    s_mul_i32 s50, s50, 51200
    s_mul_i32 s51, s44, 5120
    s_add_u32 s3, s50, 0
    s_add_u32 m0, s51, 40960
    s_waitcnt vmcnt(13)
    buffer_load_dwordx4 v18, s[24:27], s3 offen lds
    s_add_u32 s3, s50, 10240
    s_add_u32 m0, s51, 41984
    s_waitcnt vmcnt(13)
    buffer_load_dwordx4 v18, s[24:27], s3 offen lds
    s_add_u32 s3, s50, 20480
    s_add_u32 m0, s51, 43008
    s_waitcnt vmcnt(13)
    buffer_load_dwordx4 v18, s[24:27], s3 offen lds
    s_add_u32 s3, s50, 30720
    s_add_u32 m0, s51, 44032
    s_waitcnt vmcnt(13)
    buffer_load_dwordx4 v18, s[24:27], s3 offen lds
    s_add_u32 s3, s50, 40960
    s_add_u32 m0, s51, 45056
    s_waitcnt vmcnt(13)
    buffer_load_dwordx4 v18, s[24:27], s3 offen lds
    s_add_u32 s3, s50, 409600
    s_add_u32 m0, s51, 61440
    s_waitcnt vmcnt(13)
    buffer_load_dwordx4 v18, s[24:27], s3 offen lds
    s_add_u32 s3, s50, 419840
    s_add_u32 m0, s51, 62464
    s_waitcnt vmcnt(13)
    buffer_load_dwordx4 v18, s[24:27], s3 offen lds
    s_add_u32 s3, s50, 430080
    s_add_u32 m0, s51, 63488
    s_waitcnt vmcnt(13)
    buffer_load_dwordx4 v18, s[24:27], s3 offen lds
    s_add_u32 s3, s50, 440320
    s_add_u32 m0, s51, 64512
    s_waitcnt vmcnt(13)
    buffer_load_dwordx4 v18, s[24:27], s3 offen lds
    s_add_u32 s3, s50, 450560
    s_add_u32 m0, s51, 65536
    s_waitcnt vmcnt(13)
    buffer_load_dwordx4 v18, s[24:27], s3 offen lds
    s_add_u32 s44, s44, 2
    s_cmp_lt_u32 s44, 4
    s_cbranch_scc1 K_WOL
    v_mov_b32 v2, 158720
    v_mov_b32 v3, 2
    s_waitcnt vmcnt(0)
    s_mov_b64 exec, 1
    ds_add_u32 v2, v3 offset:44
    s_mov_b64 exec, -1
K_P2_HELP:
    s_setprio 3
    s_add_u32 s59, s40, 1
    s_bitcmp1_b32 s59, 1
    s_cselect_b32 s59, 31, 15
    v_and_b32 v10, s59, v1
    v_lshl_add_u32 v10, v10, 2, s42
    s_cmp_lg_u32 s30, 7
    s_cbranch_scc1 K_P2_N7
    v_and_b32 v4, 7, v1
    v_lshlrev_b32 v4, 2, v4
    s_mov_b32 s3, 131072
K_ZPOLL1:
    v_cmp_eq_u32 vcc, 0, v7
    s_cbranch_vccz K_ZOK1
    s_sub_u32 s3, s3, 1
    s_cbranch_scc1 K_ZOK1
    global_load_dword v7, v4, s[8:9] offset:192 sc1
    s_waitcnt vmcnt(0)
    s_branch K_ZPOLL1
K_ZOK1:
    global_load_dword v7, v10, s[10:11] sc1
K_P2_N7:
    s_lshl_b32 s54, s40, 7
    v_lshrrev_b32 v9, 4, v1
    v_mov_b32 v12, 158720
    s_add_u32 s44, s10, 0x10000
    s_addc_u32 s45, s11, 0
    s_mov_b32 s46, 0x43800
    s_mov_b32 s47, 0x20000
    v_mov_b32 v80, 1
    s_cmp_eq_u32 s30, 7
    s_cbranch_scc1 K_P2_FLAGS
    s_cmp_lg_u32 s30, 6
    s_cbranch_scc1 K_END
    s_mov_b32 s3, 131072
K_P2_DPOLL:
    v_cmp_eq_u32 vcc, 0, v7
    s_cbranch_vccz K_P2_DOK
    s_cmp_eq_u32 s3, 131072
    s_cbranch_scc1 K_P2_DNS
    s_sleep 12
K_P2_DNS:
    v_and_b32 v11, 1, v1
    v_lshl_add_u32 v11, v11, 2, s42
    global_load_dword v7, v11, s[10:11] offset:128 sc1
    s_sub_u32 s3, s3, 1
    s_waitcnt vmcnt(0)
    s_cmp_lg_u32 s3, 0
    s_cbranch_scc1 K_P2_DPOLL
K_P2_DOK:
    v_readlane_b32 s58, v7, 0
    v_readlane_b32 s59, v7, 1
    s_nop 3
    s_and_b32 s3, s58, 0x7ff
    s_sub_u32 s3, 2047, s3
    v_mov_b32 v20, s3
    v_mov_b32 v4, s58
    v_and_b32 v4, 0xffff0000, v4
    v_ashrrev_i32 v5, 31, v4
    v_not_b32 v5, v5
    v_or_b32 v5, 0x80000000, v5
    v_xor_b32 v4, v4, v5
    v_and_b32 v4, 0xffff0000, v4
    v_mul_f32 v5, 0xbfb8aa3b, v4
    v_exp_f32 v5, v5
    s_nop 0
    v_add_f32 v5, 1.0, v5
    v_rcp_f32 v4, v5
    s_nop 0
    v_cvt_pk_bf16_f32 v22, v4, v4
    v_lshlrev_b32 v22, 16, v22
    s_and_b32 s3, s59, 0x7ff
    s_sub_u32 s3, 2047, s3
    v_mov_b32 v21, s3
    v_mov_b32 v4, s59
    v_and_b32 v4, 0xffff0000, v4
    v_ashrrev_i32 v5, 31, v4
    v_not_b32 v5, v5
    v_or_b32 v5, 0x80000000, v5
    v_xor_b32 v4, v4, v5
    v_and_b32 v4, 0xffff0000, v4
    v_mul_f32 v5, 0xbfb8aa3b, v4
    v_exp_f32 v5, v5
    s_nop 0
    v_add_f32 v5, 1.0, v5
    v_rcp_f32 v4, v5
    s_nop 0
    v_cvt_pk_bf16_f32 v23, v4, v4
    v_lshlrev_b32 v23, 16, v23
    ds_write_b128 v12, v[20:23]
    ds_write_b32 v12, v80 offset:40
    s_mov_b32 s53, 0
    v_mov_b32 v16, v20
    v_mov_b32 v17, v21
    v_mov_b32 v18, v22
    v_mov_b32 v19, v23
K_P2_HW:
    s_cmp_eq_u32 s53, 0
    s_cselect_b64 vcc, -1, 0
    s_nop 1
    v_cndmask_b32 v2, v17, v16, vcc
    v_cndmask_b32 v5, v19, v18, vcc
    s_nop 0
    v_readfirstlane_b32 s58, v2
    s_nop 3
    s_sub_u32 s3, s58, s54
    s_cmp_lt_u32 s3, 128
    s_cbranch_scc0 K_P2_YN
    s_call_b64 s[38:39], WP_yr0
    s_mul_i32 s3, s58, 1280
    s_lshl_b32 s33, s41, 7
    s_add_u32 s3, s3, s33
    v_and_b32 v2, 15, v1
    v_lshlrev_b32 v2, 3, v2
    buffer_load_dwordx2 v[84:85], v2, s[12:15], s3 offen
    s_lshl_b32 s3, s58, 2
    s_add_u32 s3, s3, 4096
    v_mov_b32 v2, s3
    global_load_dword v88, v2, s[10:11] sc1
    s_lshl1_add_u32 s3, s41, s53
    s_lshl_b32 s3, s3, 8
    s_add_u32 s3, s3, 568320
    v_min_u32 v3, 53, v1
    v_lshl_add_u32 v3, v3, 2, s3
    s_mov_b32 s3, 131072
K_P2_YPOLL:
    global_load_dword v2, v3, s[10:11] sc1
    s_sub_u32 s3, s3, 1
    s_waitcnt vmcnt(0)
    v_cmp_ne_u32 vcc, 1, v2
    s_cbranch_vccz K_P2_YGO
    s_sleep 16
    s_cmp_lg_u32 s3, 0
    s_cbranch_scc1 K_P2_YPOLL
K_P2_YGO:
    v_and_b32 v2, 15, v1
    v_lshlrev_b32 v2, 4, v2
    v_mul_u32_u24 v4, 5120, v9
    s_mov_b32 s59, s53
    s_mul_i32 s33, s59, 2560
    s_lshl_b32 s3, s41, 8
    s_add_u32 s3, s3, s33
    v_add3_u32 v3, v2, v4, s3
    s_mov_b32 s52, 0
    buffer_load_dwordx4 v[24:27], v3, s[44:47], s52 offen sc1
    s_mov_b32 s52, 20480
    buffer_load_dwordx4 v[28:31], v3, s[44:47], s52 offen sc1
    s_mov_b32 s52, 40960
    buffer_load_dwordx4 v[32:35], v3, s[44:47], s52 offen sc1
    s_mov_b32 s52, 61440
    buffer_load_dwordx4 v[36:39], v3, s[44:47], s52 offen sc1
    s_mov_b32 s52, 81920
    buffer_load_dwordx4 v[40:43], v3, s[44:47], s52 offen sc1
    s_mov_b32 s52, 102400
    buffer_load_dwordx4 v[44:47], v3, s[44:47], s52 offen sc1
    s_mov_b32 s52, 122880
    buffer_load_dwordx4 v[48:51], v3, s[44:47], s52 offen sc1
    s_mov_b32 s52, 143360
    buffer_load_dwordx4 v[52:55], v3, s[44:47], s52 offen sc1
    s_mov_b32 s52, 163840
    buffer_load_dwordx4 v[56:59], v3, s[44:47], s52 offen sc1
    s_mov_b32 s52, 184320
    buffer_load_dwordx4 v[60:63], v3, s[44:47], s52 offen sc1
    s_mov_b32 s52, 204800
    buffer_load_dwordx4 v[64:67], v3, s[44:47], s52 offen sc1
    s_mov_b32 s52, 225280
    buffer_load_dwordx4 v[68:71], v3, s[44:47], s52 offen sc1
    s_mov_b32 s52, 245760
    buffer_load_dwordx4 v[72:75], v3, s[44:47], s52 offen sc1
    s_mov_b32 s52, 266240
    buffer_load_dwordx4 v[76:79], v3, s[44:47], s52 offen sc1
    v_sub_f32 v88, 1.0, v88
    v_cvt_pk_bf16_f32 v88, v88, v88
    v_lshlrev_b32 v88, 16, v88
    v_lshlrev_b32 v86, 16, v85
    v_and_b32 v87, 0xffff0000, v85
    v_and_b32 v85, 0xffff0000, v84
    v_lshlrev_b32 v84, 16, v84
    s_waitcnt vmcnt(12)
    v_add_f32 v20, v24, v28
    v_add_f32 v21, v25, v29
    v_add_f32 v22, v26, v30
    v_add_f32 v23, v27, v31
    s_waitcnt vmcnt(11)
    v_add_f32 v20, v20, v32
    v_add_f32 v21, v21, v33
    v_add_f32 v22, v22, v34
    v_add_f32 v23, v23, v35
    s_waitcnt vmcnt(10)
    v_add_f32 v20, v20, v36
    v_add_f32 v21, v21, v37
    v_add_f32 v22, v22, v38
    v_add_f32 v23, v23, v39
    s_waitcnt vmcnt(9)
    v_add_f32 v20, v20, v40
    v_add_f32 v21, v21, v41
    v_add_f32 v22, v22, v42
    v_add_f32 v23, v23, v43
    s_waitcnt vmcnt(8)
    v_add_f32 v20, v20, v44
    v_add_f32 v21, v21, v45
    v_add_f32 v22, v22, v46
    v_add_f32 v23, v23, v47
    s_waitcnt vmcnt(7)
    v_add_f32 v20, v20, v48
    v_add_f32 v21, v21, v49
    v_add_f32 v22, v22, v50
    v_add_f32 v23, v23, v51
    s_waitcnt vmcnt(6)
    v_add_f32 v20, v20, v52
    v_add_f32 v21, v21, v53
    v_add_f32 v22, v22, v54
    v_add_f32 v23, v23, v55
    s_waitcnt vmcnt(5)
    v_add_f32 v20, v20, v56
    v_add_f32 v21, v21, v57
    v_add_f32 v22, v22, v58
    v_add_f32 v23, v23, v59
    s_waitcnt vmcnt(4)
    v_add_f32 v20, v20, v60
    v_add_f32 v21, v21, v61
    v_add_f32 v22, v22, v62
    v_add_f32 v23, v23, v63
    s_waitcnt vmcnt(3)
    v_add_f32 v20, v20, v64
    v_add_f32 v21, v21, v65
    v_add_f32 v22, v22, v66
    v_add_f32 v23, v23, v67
    s_waitcnt vmcnt(2)
    v_add_f32 v20, v20, v68
    v_add_f32 v21, v21, v69
    v_add_f32 v22, v22, v70
    v_add_f32 v23, v23, v71
    s_waitcnt vmcnt(1)
    v_add_f32 v20, v20, v72
    v_add_f32 v21, v21, v73
    v_add_f32 v22, v22, v74
    v_add_f32 v23, v23, v75
    s_waitcnt vmcnt(0)
    v_add_f32 v20, v20, v76
    v_add_f32 v21, v21, v77
    v_add_f32 v22, v22, v78
    v_add_f32 v23, v23, v79
    v_mov_b32 v24, v20
    v_mov_b32 v25, v21
    v_mov_b32 v26, v22
    v_mov_b32 v27, v23
    s_nop 0
    v_permlane16_swap_b32 v20, v24
    v_permlane16_swap_b32 v21, v25
    v_permlane16_swap_b32 v22, v26
    v_permlane16_swap_b32 v23, v27
    v_add_f32 v20, v20, v24
    v_add_f32 v21, v21, v25
    v_add_f32 v22, v22, v26
    v_add_f32 v23, v23, v27
    v_mov_b32 v24, v20
    v_mov_b32 v25, v21
    v_mov_b32 v26, v22
    v_mov_b32 v27, v23
    s_nop 0
    v_permlane32_swap_b32 v20, v24
    v_permlane32_swap_b32 v21, v25
    v_permlane32_swap_b32 v22, v26
    v_permlane32_swap_b32 v23, v27
    v_add_f32 v20, v20, v24
    v_add_f32 v21, v21, v25
    v_add_f32 v22, v22, v26
    v_add_f32 v23, v23, v27
    v_cvt_pk_bf16_f32 v20, v20, v20
    v_lshlrev_b32 v20, 16, v20
    v_mul_f32 v20, v5, v20
    v_cvt_pk_bf16_f32 v20, v20, v20
    v_lshlrev_b32 v20, 16, v20
    v_add_f32 v20, v20, v84
    v_cvt_pk_bf16_f32 v20, v20, v20
    v_lshlrev_b32 v20, 16, v20
    v_mul_f32 v20, v20, v88
    v_cvt_pk_bf16_f32 v21, v21, v21
    v_lshlrev_b32 v21, 16, v21
    v_mul_f32 v21, v5, v21
    v_cvt_pk_bf16_f32 v21, v21, v21
    v_lshlrev_b32 v21, 16, v21
    v_add_f32 v21, v21, v85
    v_cvt_pk_bf16_f32 v21, v21, v21
    v_lshlrev_b32 v21, 16, v21
    v_mul_f32 v21, v21, v88
    v_cvt_pk_bf16_f32 v22, v22, v22
    v_lshlrev_b32 v22, 16, v22
    v_mul_f32 v22, v5, v22
    v_cvt_pk_bf16_f32 v22, v22, v22
    v_lshlrev_b32 v22, 16, v22
    v_add_f32 v22, v22, v86
    v_cvt_pk_bf16_f32 v22, v22, v22
    v_lshlrev_b32 v22, 16, v22
    v_mul_f32 v22, v22, v88
    v_cvt_pk_bf16_f32 v23, v23, v23
    v_lshlrev_b32 v23, 16, v23
    v_mul_f32 v23, v5, v23
    v_cvt_pk_bf16_f32 v23, v23, v23
    v_lshlrev_b32 v23, 16, v23
    v_add_f32 v23, v23, v87
    v_cvt_pk_bf16_f32 v23, v23, v23
    v_lshlrev_b32 v23, 16, v23
    v_mul_f32 v23, v23, v88
    s_lshl_b32 s3, s59, 8
    s_add_u32 s3, s3, 158976
    v_add_u32 v2, s3, v2
    ds_write_b128 v2, v[20:23]
    s_lshl_b32 s3, s59, 2
    v_add_u32 v2, s3, v12
    ds_write_b32 v2, v80 offset:64
K_P2_YN:
    s_add_u32 s53, s53, 1
    s_cmp_lt_u32 s53, 2
    s_cbranch_scc1 K_P2_HW
    s_branch K_END
WP_flags:
    s_setpc_b64 s[38:39]
K_P2_FLAGS:
    s_mov_b32 exec_hi, 0
    s_waitcnt vmcnt(0)
    s_mov_b32 s3, 131072
K_P2_FCHK:
    v_cmp_eq_u32 vcc, 1, v7
    s_nop 1
    v_mov_b32 v2, vcc_lo
    ds_write_b32 v12, v2 offset:32
    s_cmp_eq_u32 vcc_lo, -1
    s_cbranch_scc1 K_P2_FGO
    s_cmp_lg_u32 vcc_lo, 0
    s_cbranch_scc1 K_P2_FS
    s_sleep 4
K_P2_FS:
    s_sleep 6
    global_load_dword v7, v10, s[10:11] sc1
    s_sub_u32 s3, s3, 1
    s_waitcnt vmcnt(0)
    s_cbranch_scc0 K_P2_FCHK
    v_mov_b32 v2, -1
    ds_write_b32 v12, v2 offset:32
K_P2_FGO:
    s_mov_b64 exec, -1
    s_branch K_END
.p2align 12
K_AUX:
    s_load_dwordx8 s[48:55], s[0:1], 32
    s_load_dwordx2 s[56:57], s[0:1], 64
    s_mul_i32 s44, s28, 7
    s_add_u32 s44, s44, s29
    s_sub_u32 s44, s44, 1
    s_cmp_lt_u32 s44, 54
    s_cselect_b32 s44, s44, 63
    s_cmp_eq_u32 s29, 0
    s_cselect_b32 s44, 63, s44
    s_lshl_b32 s74, s28, 8
    s_lshl_b32 s3, s29, 5
    s_add_u32 s74, s74, s3
    v_mov_b32 v12, 158720
    v_mov_b32 v13, 1
    s_cmp_lt_u32 s30, 4
    s_cbranch_scc1 K_AUX_LO
    s_lshl_b32 s3, s30, 3
    s_add_u32 s3, s3, s74
    s_sub_u32 s3, s3, 32
    v_lshrrev_b32 v9, 3, v1
    v_add_u32 v9, s3, v9
    v_and_b32 v11, 7, v1
    v_lshlrev_b32 v11, 4, v11
    v_mul_u32_u24 v10, 1280, v9
    v_add_u32 v10, v10, v11
    s_waitcnt lgkmcnt(0)
    buffer_load_dwordx4 v[16:19], v10, s[12:15], 0 offen offset:0
    buffer_load_dwordx4 v[20:23], v10, s[12:15], 0 offen offset:128
    buffer_load_dwordx4 v[24:27], v10, s[12:15], 0 offen offset:256
    buffer_load_dwordx4 v[28:31], v10, s[12:15], 0 offen offset:384
    buffer_load_dwordx4 v[32:35], v10, s[12:15], 0 offen offset:512
    buffer_load_dwordx4 v[36:39], v10, s[12:15], 0 offen offset:640
    buffer_load_dwordx4 v[40:43], v10, s[12:15], 0 offen offset:768
    buffer_load_dwordx4 v[44:47], v10, s[12:15], 0 offen offset:896
    buffer_load_dwordx4 v[48:51], v10, s[12:15], 0 offen offset:1024
    buffer_load_dwordx4 v[52:55], v10, s[12:15], 0 offen offset:1152
    s_mov_b32 s16, s48
    s_mov_b32 s17, s49
    s_mov_b32 s18, 0x500
    s_mov_b32 s19, 0x20000
    s_mov_b32 s20, s56
    s_mov_b32 s21, s57
    s_mov_b32 s22, 0x500
    s_mov_b32 s23, 0x20000
    buffer_load_dwordx4 v[56:59], v11, s[16:19], 0 offen offset:0
    buffer_load_dwordx4 v[60:63], v11, s[16:19], 0 offen offset:128
    buffer_load_dwordx4 v[64:67], v11, s[16:19], 0 offen offset:256
    buffer_load_dwordx4 v[68:71], v11, s[16:19], 0 offen offset:384
    buffer_load_dwordx4 v[72:75], v11, s[16:19], 0 offen offset:512
    buffer_load_dwordx4 v[76:79], v11, s[16:19], 0 offen offset:640
    buffer_load_dwordx4 v[80:83], v11, s[16:19], 0 offen offset:768
    buffer_load_dwordx4 v[84:87], v11, s[16:19], 0 offen offset:896
    buffer_load_dwordx4 v[88:91], v11, s[16:19], 0 offen offset:1024
    buffer_load_dwordx4 v[92:95], v11, s[16:19], 0 offen offset:1152
    buffer_load_dwordx4 v[96:99], v11, s[20:23], 0 offen offset:0
    buffer_load_dwordx4 v[100:103], v11, s[20:23], 0 offen offset:128
    buffer_load_dwordx4 v[104:107], v11, s[20:23], 0 offen offset:256
    buffer_load_dwordx4 v[108:111], v11, s[20:23], 0 offen offset:384
    buffer_load_dwordx4 v[112:115], v11, s[20:23], 0 offen offset:512
    buffer_load_dwordx4 v[116:119], v11, s[20:23], 0 offen offset:640
    buffer_load_dwordx4 v[120:123], v11, s[20:23], 0 offen offset:768
    buffer_load_dwordx4 v[124:127], v11, s[20:23], 0 offen offset:896
    buffer_load_dwordx4 v[128:131], v11, s[20:23], 0 offen offset:1024
    buffer_load_dwordx4 v[132:135], v11, s[20:23], 0 offen offset:1152
    s_barrier
    v_mov_b32 v180, 0
    v_mov_b32 v181, 0
    v_mov_b32 v182, 0
    v_mov_b32 v183, 0
    v_and_b32 v10, 31, v9
    v_lshlrev_b32 v10, 2, v10
    v_add_u32 v10, 122880, v10
    v_sub_u32 v4, 0x87ff, v9
    s_setprio 2
    s_waitcnt vmcnt(10)
    v_dot2c_f32_bf16 v180, v16, v56
    v_dot2c_f32_bf16 v181, v17, v57
    v_dot2c_f32_bf16 v180, v18, v58
    v_dot2c_f32_bf16 v181, v19, v59
    v_dot2c_f32_bf16 v180, v20, v60
    v_dot2c_f32_bf16 v181, v21, v61
    v_dot2c_f32_bf16 v180, v22, v62
    v_dot2c_f32_bf16 v181, v23, v63
    v_dot2c_f32_bf16 v180, v24, v64
    v_dot2c_f32_bf16 v181, v25, v65
    v_dot2c_f32_bf16 v180, v26, v66
    v_dot2c_f32_bf16 v181, v27, v67
    v_dot2c_f32_bf16 v180, v28, v68
    v_dot2c_f32_bf16 v181, v29, v69
    v_dot2c_f32_bf16 v180, v30, v70
    v_dot2c_f32_bf16 v181, v31, v71
    v_dot2c_f32_bf16 v180, v32, v72
    v_dot2c_f32_bf16 v181, v33, v73
    v_dot2c_f32_bf16 v180, v34, v74
    v_dot2c_f32_bf16 v181, v35, v75
    v_dot2c_f32_bf16 v180, v36, v76
    v_dot2c_f32_bf16 v181, v37, v77
    v_dot2c_f32_bf16 v180, v38, v78
    v_dot2c_f32_bf16 v181, v39, v79
    v_dot2c_f32_bf16 v180, v40, v80
    v_dot2c_f32_bf16 v181, v41, v81
    v_dot2c_f32_bf16 v180, v42, v82
    v_dot2c_f32_bf16 v181, v43, v83
    v_dot2c_f32_bf16 v180, v44, v84
    v_dot2c_f32_bf16 v181, v45, v85
    v_dot2c_f32_bf16 v180, v46, v86
    v_dot2c_f32_bf16 v181, v47, v87
    v_dot2c_f32_bf16 v180, v48, v88
    v_dot2c_f32_bf16 v181, v49, v89
    v_dot2c_f32_bf16 v180, v50, v90
    v_dot2c_f32_bf16 v181, v51, v91
    v_dot2c_f32_bf16 v180, v52, v92
    v_dot2c_f32_bf16 v181, v53, v93
    v_dot2c_f32_bf16 v180, v54, v94
    v_dot2c_f32_bf16 v181, v55, v95
    s_waitcnt vmcnt(0)
    v_dot2c_f32_bf16 v182, v16, v96
    v_dot2c_f32_bf16 v183, v17, v97
    v_dot2c_f32_bf16 v182, v18, v98
    v_dot2c_f32_bf16 v183, v19, v99
    v_dot2c_f32_bf16 v182, v20, v100
    v_dot2c_f32_bf16 v183, v21, v101
    v_dot2c_f32_bf16 v182, v22, v102
    v_dot2c_f32_bf16 v183, v23, v103
    v_dot2c_f32_bf16 v182, v24, v104
    v_dot2c_f32_bf16 v183, v25, v105
    v_dot2c_f32_bf16 v182, v26, v106
    v_dot2c_f32_bf16 v183, v27, v107
    v_dot2c_f32_bf16 v182, v28, v108
    v_dot2c_f32_bf16 v183, v29, v109
    v_dot2c_f32_bf16 v182, v30, v110
    v_dot2c_f32_bf16 v183, v31, v111
    v_dot2c_f32_bf16 v182, v32, v112
    v_dot2c_f32_bf16 v183, v33, v113
    v_dot2c_f32_bf16 v182, v34, v114
    v_dot2c_f32_bf16 v183, v35, v115
    v_dot2c_f32_bf16 v182, v36, v116
    v_dot2c_f32_bf16 v183, v37, v117
    v_dot2c_f32_bf16 v182, v38, v118
    v_dot2c_f32_bf16 v183, v39, v119
    v_dot2c_f32_bf16 v182, v40, v120
    v_dot2c_f32_bf16 v183, v41, v121
    v_dot2c_f32_bf16 v182, v42, v122
    v_dot2c_f32_bf16 v183, v43, v123
    v_dot2c_f32_bf16 v182, v44, v124
    v_dot2c_f32_bf16 v183, v45, v125
    v_dot2c_f32_bf16 v182, v46, v126
    v_dot2c_f32_bf16 v183, v47, v127
    v_dot2c_f32_bf16 v182, v48, v128
    v_dot2c_f32_bf16 v183, v49, v129
    v_dot2c_f32_bf16 v182, v50, v130
    v_dot2c_f32_bf16 v183, v51, v131
    v_dot2c_f32_bf16 v182, v52, v132
    v_dot2c_f32_bf16 v183, v53, v133
    v_dot2c_f32_bf16 v182, v54, v134
    v_dot2c_f32_bf16 v183, v55, v135
    s_nop 2
    v_add_f32 v180, v180, v181
    v_add_f32 v182, v182, v183
    s_nop 0
    v_add_f32_dpp v180, v180, v180 quad_perm:[1,0,3,2] row_mask:0xf bank_mask:0xf
    v_add_f32_dpp v182, v182, v182 quad_perm:[1,0,3,2] row_mask:0xf bank_mask:0xf
    s_nop 0
    v_add_f32_dpp v180, v180, v180 quad_perm:[2,3,0,1] row_mask:0xf bank_mask:0xf
    v_add_f32_dpp v182, v182, v182 quad_perm:[2,3,0,1] row_mask:0xf bank_mask:0xf
    s_nop 0
    v_add_f32_dpp v180, v180, v180 row_half_mirror row_mask:0xf bank_mask:0xf
    v_add_f32_dpp v182, v182, v182 row_half_mirror row_mask:0xf bank_mask:0xf
    v_cvt_pk_bf16_f32 v2, v180, v180
    v_lshlrev_b32 v2, 16, v2
    v_ashrrev_i32 v3, 31, v2
    v_or_b32 v3, 0x80000000, v3
    v_xor_b32 v2, v2, v3
    v_and_b32 v2, 0xffff0000, v2
    v_or_b32 v2, v2, v4
    ds_write2_b32 v10, v2, v182 offset0:0 offset1:32
    s_mov_b64 exec, 1
    ds_add_u32 v12, v13 offset:36
    s_mov_b64 exec, -1
    s_setprio 0
    s_cmp_lg_u32 s30, 4
    s_cbranch_scc1 K_WARMA0
    s_call_b64 s[38:39], WP_p2g
    s_branch K_WARMAX
K_WARMA0:
    s_cmp_lg_u32 s30, 5
    s_cbranch_scc1 K_WARMA1
    s_call_b64 s[38:39], WP_gen
    s_branch K_WARMAX
K_WARMA1:
    s_cmp_lg_u32 s30, 6
    s_cbranch_scc1 K_WARMA2
    s_call_b64 s[38:39], WP_help
    s_call_b64 s[38:39], WP_flags
    s_branch K_WARMAX
K_WARMA2:
    s_call_b64 s[38:39], WP_spin
K_WARMAX:
    s_cmp_ge_u32 s30, 6
    s_cselect_b32 s44, 63, s44
    s_cmp_lg_u32 s44, 63
    s_cbranch_scc1 K_FFN_C
    s_mov_b32 s3, 1048576
K_FGH:
    ds_read_b32 v2, v12 offset:48
    s_sleep 8
    s_sub_u32 s3, s3, 1
    s_waitcnt lgkmcnt(0)
    v_readfirstlane_b32 s33, v2
    s_nop 3
    s_cselect_b32 s33, 1, s33
    s_cmp_lt_u32 s33, 1
    s_cbranch_scc1 K_FGH
    s_cmp_eq_u32 s30, 6
    s_cbranch_scc1 K_P2_HELP
    v_mov_b32 v7, 1
    s_branch K_P2_HELP
K_AUX_LO:
    s_waitcnt lgkmcnt(0)
    s_cmp_eq_u32 s30, 0
    s_cbranch_scc1 K_AUX_PUB
    s_cmp_eq_u32 s44, 63
    s_cbranch_scc1 K_AUX_NOF
    s_and_b32 s3, s44, 1
    s_cmp_eq_u32 s3, 0
    s_cselect_b64 s[60:61], s[50:51], s[52:53]
    s_cselect_b64 s[64:65], s[52:53], s[50:51]
    s_cselect_b32 s75, 0, 40960
    s_mov_b32 s62, 0x21c000
    s_mov_b32 s63, 0x20000
    s_mov_b32 s66, 0x21c000
    s_mov_b32 s67, 0x20000
    v_lshrrev_b32 v2, 2, v1
    v_mul_u32_u24 v184, 3456, v2
    v_and_b32 v2, 3, v1
    v_lshl_add_u32 v184, v2, 4, v184
    s_lshl_b32 s72, s44, 6
    v_add_u32 v184, s72, v184
    s_sub_u32 s74, s30, 1
K_FSA0:
    s_lshl_b32 s73, s74, 10
    s_mul_i32 s72, s74, 55296
    s_add_u32 m0, s73, s75
    s_waitcnt vmcnt(7)
    buffer_load_dwordx4 v184, s[60:63], s72 offen lds
    s_add_u32 s74, s74, 3
    s_cmp_lt_u32 s74, 24
    s_cbranch_scc1 K_FSA0
    s_barrier
    s_mov_b32 s3, 1048576
K_FGPB:
    ds_read_b32 v2, v12 offset:36
    s_sleep 1
    s_sub_u32 s3, s3, 1
    s_waitcnt lgkmcnt(0)
    v_readfirstlane_b32 s33, v2
    s_nop 3
    s_cselect_b32 s33, 5, s33
    s_cmp_lt_u32 s33, 5
    s_cbranch_scc1 K_FGPB
K_FSA:
    s_lshl_b32 s73, s74, 10
    s_mul_i32 s72, s74, 55296
    s_add_u32 m0, s73, s75
    s_waitcnt vmcnt(7)
    buffer_load_dwordx4 v184, s[60:63], s72 offen lds
    s_add_u32 s74, s74, 3
    s_cmp_lt_u32 s74, 40
    s_cbranch_scc1 K_FSA
    s_sub_u32 s74, s74, 40
    s_xor_b32 s75, s75, 40960
    s_mov_b32 s68, s54
    s_mov_b32 s69, s55
    s_mov_b32 s70, 0x21c000
    s_mov_b32 s71, 0x20000
    s_mul_i32 s3, s44, 40960
    v_lshrrev_b32 v2, 3, v1
    v_mul_u32_u24 v2, 1280, v2
    v_lshrrev_b32 v3, 4, v1
    v_lshlrev_b32 v3, 1, v3
    v_and_b32 v4, 7, v1
    v_xor_b32 v3, v3, v4
    v_lshl_add_u32 v2, v3, 4, v2
    v_add_u32 v185, s3, v2
K_FSB:
    s_lshl_b32 s73, s74, 10
    s_mul_i32 s72, s74, 55296
    s_add_u32 m0, s73, s75
    s_waitcnt vmcnt(7)
    buffer_load_dwordx4 v184, s[64:67], s72 offen lds
    s_add_u32 s74, s74, 3
    s_cmp_lt_u32 s74, 40
    s_cbranch_scc1 K_FSB
    s_sub_u32 s74, s74, 40
    s_mov_b32 s75, 81920
K_FSD0:
    s_lshl_b32 s73, s74, 10
    s_and_b32 s72, s74, 3
    s_mul_i32 s72, s72, 10208
    s_lshl_b32 s3, s74, 5
    s_add_u32 s72, s72, s3
    s_add_u32 m0, s73, s75
    s_waitcnt vmcnt(7)
    buffer_load_dwordx4 v185, s[68:71], s72 offen lds
    s_add_u32 s74, s74, 3
    s_cmp_lt_u32 s74, 24
    s_cbranch_scc1 K_FSD0
    s_waitcnt vmcnt(8)
    s_mov_b64 exec, 1
    ds_add_u32 v12, v13 offset:56
    s_mov_b64 exec, -1
K_FSD:
    s_lshl_b32 s73, s74, 10
    s_and_b32 s72, s74, 3
    s_mul_i32 s72, s72, 10208
    s_lshl_b32 s3, s74, 5
    s_add_u32 s72, s72, s3
    s_add_u32 m0, s73, s75
    s_waitcnt vmcnt(7)
    buffer_load_dwordx4 v185, s[68:71], s72 offen lds
    s_add_u32 s74, s74, 3
    s_cmp_lt_u32 s74, 40
    s_cbranch_scc1 K_FSD
    s_mul_i32 s3, s29, 96
    s_lshl_b32 s72, s30, 5
    s_add_u32 s3, s3, s72
    s_sub_u32 s3, s3, 128
    v_lshrrev_b32 v2, 1, v1
    v_add_u32 v2, s3, v2
    v_mul_u32_u24 v2, 1280, v2
    v_and_b32 v3, 1, v1
    v_lshl_add_u32 v2, v3, 7, v2
    buffer_load_dword v6, v2, s[24:27], 0 offen offset:1024
K_AUX_WR:
    s_mov_b32 s3, 1048576
K_FGR:
    ds_read_b32 v2, v12 offset:60
    s_sleep 2
    s_sub_u32 s3, s3, 1
    s_waitcnt lgkmcnt(0)
    v_readfirstlane_b32 s33, v2
    s_nop 3
    s_cselect_b32 s33, 2, s33
    s_cmp_lt_u32 s33, 2
    s_cbranch_scc1 K_FGR
    s_branch K_P2
K_AUX_NOF:
    s_cmp_lg_u32 s2, 63
    s_cbranch_scc1 K_AUX_NOZ
    s_cmp_lg_u32 s30, 1
    s_cbranch_scc1 K_AUX_NOZ
    s_add_u32 s60, s10, 0x80000
    s_addc_u32 s61, s11, 0
    s_mov_b32 s62, 0xc000
    s_mov_b32 s63, 0x20000
    v_mov_b32 v9, 786432
    global_load_dword v10, v9, s[10:11] sc1
    v_lshlrev_b32 v11, 4, v1
    v_add_u32 v11, 790528, v11
    global_load_dword v6, v11, s[10:11] sc1
    s_barrier
    s_mov_b32 s3, 1048576
K_FGZ:
    ds_read_b32 v2, v12 offset:36
    s_sleep 2
    s_sub_u32 s3, s3, 1
    s_waitcnt lgkmcnt(0)
    v_readfirstlane_b32 s33, v2
    s_nop 3
    s_cselect_b32 s33, 4, s33
    s_cmp_lt_u32 s33, 4
    s_cbranch_scc1 K_FGZ
    v_and_b32 v4, 7, v1
    v_lshlrev_b32 v4, 2, v4
    global_load_dword v7, v4, s[8:9] offset:192 sc1
    s_waitcnt vmcnt(1)
    v_add_u32 v10, 1, v10
    s_mov_b32 s3, 131072
    s_setprio 3
K_AG2_POLL:
    global_load_dwordx4 v[16:19], v11, s[10:11] sc1
    s_waitcnt vmcnt(0)
    v_xor_b32 v2, v10, v17
    v_xor_b32 v3, v10, v19
    v_or_b32 v2, v2, v3
    v_cmp_ne_u32 vcc, 0, v2
    s_cbranch_vccz K_AG2_GOT
    s_sleep 2
    s_sub_u32 s3, s3, 1
    s_cmp_lg_u32 s3, 0
    s_cbranch_scc1 K_AG2_POLL
K_AG2_GOT:
    s_nop 1
    v_max_u32_dpp v3, v16, v16 quad_perm:[1,0,3,2] row_mask:0xf bank_mask:0xf
    s_nop 1
    v_max_u32_dpp v3, v3, v3 quad_perm:[2,3,0,1] row_mask:0xf bank_mask:0xf
    s_nop 1
    v_max_u32_dpp v3, v3, v3 row_half_mirror row_mask:0xf bank_mask:0xf
    s_nop 1
    v_max_u32_dpp v3, v3, v3 row_mirror row_mask:0xf bank_mask:0xf
    s_nop 1
    v_readlane_b32 s74, v3, 0
    v_readlane_b32 s76, v3, 16
    v_readlane_b32 s77, v3, 32
    v_readlane_b32 s78, v3, 48
    s_nop 3
    s_max_u32 s74, s74, s76
    s_max_u32 s77, s77, s78
    s_max_u32 s74, s74, s77
    v_cmp_ne_u32 vcc, s74, v16
    s_nop 1
    v_cndmask_b32 v2, v18, v16, vcc
    s_nop 1
    v_max_u32_dpp v3, v2, v2 quad_perm:[1,0,3,2] row_mask:0xf bank_mask:0xf
    s_nop 1
    v_max_u32_dpp v3, v3, v3 quad_perm:[2,3,0,1] row_mask:0xf bank_mask:0xf
    s_nop 1
    v_max_u32_dpp v3, v3, v3 row_half_mirror row_mask:0xf bank_mask:0xf
    s_nop 1
    v_max_u32_dpp v3, v3, v3 row_mirror row_mask:0xf bank_mask:0xf
    s_nop 1
    v_readlane_b32 s75, v3, 0
    v_readlane_b32 s76, v3, 16
    v_readlane_b32 s77, v3, 32
    v_readlane_b32 s78, v3, 48
    s_nop 3
    s_max_u32 s75, s75, s76
    s_max_u32 s77, s77, s78
    s_max_u32 s75, s75, s77
    v_mov_b32 v176, s74
    v_mov_b32 v177, s75
    v_and_b32 v4, 7, v1
    v_lshlrev_b32 v4, 2, v4
    s_mov_b32 s3, 131072
K_ZPOLL4:
    v_cmp_eq_u32 vcc, 0, v7
    s_cbranch_vccz K_ZOK4
    s_sub_u32 s3, s3, 1
    s_cbranch_scc1 K_ZOK4
    global_load_dword v7, v4, s[8:9] offset:192 sc1
    s_waitcnt vmcnt(0)
    s_branch K_ZPOLL4
K_ZOK4:
    v_and_b32 v2, 7, v1
    v_mul_u32_u24 v2, 20, v2
    v_lshrrev_b32 v3, 3, v1
    v_add_lshl_u32 v2, v2, v3, 8
    buffer_store_dwordx2 v[176:177], v2, s[60:63], 0 offen offset:136 sc1
    s_mov_b64 exec, 1
    global_store_dword v9, v10, s[10:11] sc1
    s_mov_b64 exec, -1
    v_lshlrev_b32 v4, 2, v1
    s_mov_b32 s72, 43008
    s_mov_b32 s3, 131072
K_AGG_POLL:
    s_sleep 8
    buffer_load_dword v2, v4, s[60:63], s72 offen sc1
    s_waitcnt vmcnt(0)
    v_cmp_eq_u32 vcc, 0, v2
    s_cbranch_vccz K_AGG_GOT
    s_sub_u32 s3, s3, 1
    s_cmp_lg_u32 s3, 0
    s_cbranch_scc1 K_AGG_POLL
K_AGG_GOT:
    s_mov_b32 s62, 40960
    v_lshlrev_b32 v3, 8, v1
    s_mov_b32 s3, 0
    buffer_store_dwordx2 v[176:177], v3, s[60:63], s3 offen offset:128 sc1
    s_mov_b32 s3, 16384
    buffer_store_dwordx2 v[176:177], v3, s[60:63], s3 offen offset:128 sc1
    s_mov_b32 s3, 32768
    buffer_store_dwordx2 v[176:177], v3, s[60:63], s3 offen offset:128 sc1
    s_setprio 0
    s_branch K_AUX_NOK
K_AUX_NOZ:
    s_barrier
K_AUX_NOK:
    s_mov_b32 s3, 1048576
K_FGWD:
    ds_read_b32 v2, v12 offset:48
    s_sleep 4
    s_sub_u32 s3, s3, 1
    s_waitcnt lgkmcnt(0)
    v_readfirstlane_b32 s33, v2
    s_nop 3
    s_cselect_b32 s33, 1, s33
    s_cmp_lt_u32 s33, 1
    s_cbranch_scc1 K_FGWD
    s_branch K_P2
K_AUX_PUB:
    s_add_u32 s60, s10, 0x1000
    s_addc_u32 s61, s11, 0
    s_mov_b32 s62, 0x2000
    s_mov_b32 s63, 0x20000
    v_and_b32 v3, 31, v1
    v_lshlrev_b32 v10, 2, v3
    v_add_u32 v11, 122880, v10
    s_lshl_b32 s72, s74, 2
    v_mov_b32 v2, 786432
    global_load_dword v17, v2, s[10:11] sc1
    s_lshl_b32 s3, s2, 2
    s_add_u32 s3, s3, 567296
    v_mov_b32 v9, s3
    s_lshl_b32 s3, s2, 4
    s_add_u32 s3, s3, 790528
    v_lshl_add_u32 v20, v1, 4, s3
    v_and_b32 v5, 7, v1
    v_lshlrev_b32 v5, 2, v5
    s_barrier
    s_setprio 3
    s_waitcnt vmcnt(0)
    v_add_u32 v17, 1, v17
    v_mov_b32 v19, v17
    s_mov_b32 s3, 1048576
K_FGRT:
    ds_read_b32 v2, v12 offset:36
    s_sleep 0
    s_sub_u32 s3, s3, 1
    s_waitcnt lgkmcnt(0)
    v_readfirstlane_b32 s33, v2
    s_nop 3
    s_cselect_b32 s33, 4, s33
    s_cmp_lt_u32 s33, 4
    s_cbranch_scc1 K_FGRT
    ds_read2_b32 v[176:177], v11 offset0:0 offset1:32
    s_waitcnt lgkmcnt(0)
    s_nop 1
    v_max_u32_dpp v3, v176, v176 quad_perm:[1,0,3,2] row_mask:0xf bank_mask:0xf
    s_nop 1
    v_max_u32_dpp v3, v3, v3 quad_perm:[2,3,0,1] row_mask:0xf bank_mask:0xf
    s_nop 1
    v_max_u32_dpp v3, v3, v3 row_half_mirror row_mask:0xf bank_mask:0xf
    s_nop 1
    v_max_u32_dpp v3, v3, v3 row_mirror row_mask:0xf bank_mask:0xf
    s_nop 1
    v_readlane_b32 s74, v3, 0
    v_readlane_b32 s76, v3, 16
    v_readlane_b32 s77, v3, 32
    v_readlane_b32 s78, v3, 48
    s_nop 3
    s_max_u32 s74, s74, s76
    s_max_u32 s77, s77, s78
    s_max_u32 s74, s74, s77
    v_cmp_ne_u32 vcc, s74, v176
    s_nop 1
    v_cndmask_b32 v176, 0, v176, vcc
    s_nop 1
    v_max_u32_dpp v3, v176, v176 quad_perm:[1,0,3,2] row_mask:0xf bank_mask:0xf
    s_nop 1
    v_max_u32_dpp v3, v3, v3 quad_perm:[2,3,0,1] row_mask:0xf bank_mask:0xf
    s_nop 1
    v_max_u32_dpp v3, v3, v3 row_half_mirror row_mask:0xf bank_mask:0xf
    s_nop 1
    v_max_u32_dpp v3, v3, v3 row_mirror row_mask:0xf bank_mask:0xf
    s_nop 1
    v_readlane_b32 s75, v3, 0
    v_readlane_b32 s76, v3, 16
    v_readlane_b32 s77, v3, 32
    v_readlane_b32 s78, v3, 48
    s_nop 3
    s_max_u32 s75, s75, s76
    s_max_u32 s77, s77, s78
    s_max_u32 s75, s75, s77
    v_mov_b32 v16, s74
    v_mov_b32 v18, s75
    s_mov_b64 exec, 1
    global_store_dwordx4 v20, v[16:19], s[10:11] sc1
    s_mov_b64 exec, -1
    s_mov_b64 exec, 1
    ds_add_u32 v12, v13 offset:36
    s_mov_b64 exec, -1
    global_load_dword v7, v5, s[8:9] offset:192 sc1
    v_cvt_pk_bf16_f32 v177, v177, v177
    v_lshlrev_b32 v177, 16, v177
    v_mul_f32 v3, 0xbfb8aa3b, v177
    v_exp_f32 v3, v3
    s_nop 0
    v_add_f32 v3, 1.0, v3
    v_rcp_f32 v177, v3
    s_nop 0
    v_cvt_pk_bf16_f32 v177, v177, v177
    v_lshlrev_b32 v177, 16, v177
    s_mov_b32 exec_hi, 0
    buffer_store_dword v177, v10, s[60:63], s72 offen sc1
    s_mov_b64 exec, -1
    s_waitcnt vmcnt(0)
    v_and_b32 v4, 7, v1
    v_lshlrev_b32 v4, 2, v4
    s_mov_b32 s3, 131072
K_ZPOLL3:
    v_cmp_eq_u32 vcc, 0, v7
    s_cbranch_vccz K_ZOK3
    s_sub_u32 s3, s3, 1
    s_cbranch_scc1 K_ZOK3
    global_load_dword v7, v4, s[8:9] offset:192 sc1
    s_waitcnt vmcnt(0)
    s_branch K_ZPOLL3
K_ZOK3:
    s_mov_b64 exec, 1
    global_store_dword v9, v13, s[10:11] sc1
    s_mov_b64 exec, -1
    v_and_b32 v3, 1, v1
    v_lshl_add_u32 v3, v3, 2, s42
    v_lshlrev_b32 v10, 4, v1
    s_mov_b32 s3, 131072
K_AUX_POLL:
    s_sleep 6
    global_load_dword v2, v3, s[10:11] offset:136 sc1
    s_waitcnt vmcnt(0)
    v_cmp_eq_u32 vcc, 0, v2
    s_cbranch_vccz K_AUX_GOT
    s_sub_u32 s3, s3, 1
    s_cmp_lg_u32 s3, 0
    s_cbranch_scc1 K_AUX_POLL
K_AUX_GOT:
    v_readlane_b32 s74, v2, 0
    v_readlane_b32 s75, v2, 1
    s_nop 3
    s_and_b32 s74, s74, 0x7ff
    s_sub_u32 s74, 2047, s74
    s_mul_i32 s74, s74, 1280
    s_mov_b32 m0, 125184
    s_nop 0
    buffer_load_dwordx4 v10, s[12:15], s74 offen lds
    s_mov_b64 exec, 0xffff
    buffer_load_dwordx4 v10, s[12:15], s74 offen offset:1024 lds
    s_mov_b64 exec, -1
    s_and_b32 s75, s75, 0x7ff
    s_sub_u32 s75, 2047, s75
    s_mul_i32 s75, s75, 1280
    s_mov_b32 m0, 126528
    s_nop 0
    buffer_load_dwordx4 v10, s[12:15], s75 offen lds
    s_mov_b64 exec, 0xffff
    buffer_load_dwordx4 v10, s[12:15], s75 offen offset:1024 lds
    s_mov_b64 exec, -1
    s_waitcnt vmcnt(0)
    ds_write_b32 v12, v13 offset:48
    s_setprio 0
    s_branch K_P2
.p2align 12
K_FFN_C:
    s_add_u32 s64, s10, 0x10000
    s_addc_u32 s65, s11, 0
    s_mov_b32 s66, 0x43800
    s_mov_b32 s67, 0x20000
    s_and_b32 s73, s30, 1
    v_lshrrev_b32 v232, 4, v1
    v_bfe_u32 v4, v1, 2, 2
    v_lshl_add_u32 v2, v232, 3, v4
    v_and_b32 v3, 3, v1
    v_lshlrev_b32 v3, 3, v3
    v_lshl_add_u32 v233, v2, 6, v3
    s_lshl_b32 s72, s73, 5
    v_add_u32 v233, s72, v233
    v_lshl_add_u32 v2, v232, 2, v4
    v_bfe_u32 v4, v2, 1, 2
    v_lshl_add_u32 v3, v2, 7, v3
    v_lshl_add_u32 v3, v4, 5, v3
    s_mul_i32 s3, s73, 20480
    s_add_u32 s3, s3, 81920
    v_add_u32 v238, s3, v3
    v_xor_b32 v239, 32, v238
    v_xor_b32 v240, 64, v238
    v_xor_b32 v241, 96, v238
    v_and_b32 v2, 1, v1
    v_mul_u32_u24 v234, 1344, v2
    v_lshl_add_u32 v234, v232, 4, v234
    v_add_u32 v234, 125184, v234
    v_lshlrev_b32 v236, 4, v1
    v_add_u32 v236, 124160, v236
    s_lshl_b32 s3, s73, 3
    v_add_u32 v235, s3, v236
    v_mul_u32_u24 v2, 2560, v2
    v_lshl_add_u32 v237, v232, 4, v2
    s_mul_i32 s3, s44, 5120
    s_mul_i32 s72, s73, 1280
    s_add_u32 s72, s72, s3
    v_lshlrev_b32 v2, 4, v1
    buffer_store_dwordx4 v[16:19], v2, s[64:67], s72 offen offset:0 sc1
    buffer_store_dwordx4 v[16:19], v2, s[64:67], s72 offen offset:2560 sc1
    s_mov_b64 exec, 0xffff
    buffer_store_dwordx4 v[16:19], v2, s[64:67], s72 offen offset:1024 sc1
    buffer_store_dwordx4 v[16:19], v2, s[64:67], s72 offen offset:3584 sc1
    s_mov_b64 exec, -1
    v_add_u32 v5, 40960, v233
    s_mov_b32 s3, 1048576
K_FGD:
    ds_read_b32 v2, v12 offset:56
    s_sleep 2
    s_sub_u32 s3, s3, 1
    s_waitcnt lgkmcnt(0)
    v_readfirstlane_b32 s33, v2
    s_nop 3
    s_cselect_b32 s33, 3, s33
    s_cmp_lt_u32 s33, 3
    s_cbranch_scc1 K_FGD
    s_setprio 3
    ds_read_b64_tr_b16 v[16:17], v233 offset:0
    ds_read_b64_tr_b16 v[18:19], v233 offset:256
    ds_read_b64_tr_b16 v[20:21], v233 offset:2048
    ds_read_b64_tr_b16 v[22:23], v233 offset:2304
    ds_read_b64_tr_b16 v[24:25], v233 offset:4096
    ds_read_b64_tr_b16 v[26:27], v233 offset:4352
    ds_read_b64_tr_b16 v[28:29], v233 offset:6144
    ds_read_b64_tr_b16 v[30:31], v233 offset:6400
    ds_read_b64_tr_b16 v[32:33], v233 offset:8192
    ds_read_b64_tr_b16 v[34:35], v233 offset:8448
    ds_read_b64_tr_b16 v[36:37], v233 offset:10240
    ds_read_b64_tr_b16 v[38:39], v233 offset:10496
    ds_read_b64_tr_b16 v[40:41], v233 offset:12288
    ds_read_b64_tr_b16 v[42:43], v233 offset:12544
    ds_read_b64_tr_b16 v[44:45], v233 offset:14336
    ds_read_b64_tr_b16 v[46:47], v233 offset:14592
    ds_read_b64_tr_b16 v[48:49], v233 offset:16384
    ds_read_b64_tr_b16 v[50:51], v233 offset:16640
    ds_read_b64_tr_b16 v[52:53], v233 offset:18432
    ds_read_b64_tr_b16 v[54:55], v233 offset:18688
    ds_read_b64_tr_b16 v[56:57], v233 offset:20480
    ds_read_b64_tr_b16 v[58:59], v233 offset:20736
    ds_read_b64_tr_b16 v[60:61], v233 offset:22528
    ds_read_b64_tr_b16 v[62:63], v233 offset:22784
    ds_read_b64_tr_b16 v[64:65], v233 offset:24576
    ds_read_b64_tr_b16 v[66:67], v233 offset:24832
    ds_read_b64_tr_b16 v[68:69], v233 offset:26624
    ds_read_b64_tr_b16 v[70:71], v233 offset:26880
    ds_read_b64_tr_b16 v[72:73], v233 offset:28672
    ds_read_b64_tr_b16 v[74:75], v233 offset:28928
    ds_read_b64_tr_b16 v[76:77], v233 offset:30720
    ds_read_b64_tr_b16 v[78:79], v233 offset:30976
    ds_read_b64_tr_b16 v[80:81], v233 offset:32768
    ds_read_b64_tr_b16 v[82:83], v233 offset:33024
    ds_read_b64_tr_b16 v[84:85], v233 offset:34816
    ds_read_b64_tr_b16 v[86:87], v233 offset:35072
    ds_read_b64_tr_b16 v[88:89], v233 offset:36864
    ds_read_b64_tr_b16 v[90:91], v233 offset:37120
    ds_read_b64_tr_b16 v[92:93], v233 offset:38912
    ds_read_b64_tr_b16 v[94:95], v233 offset:39168
    ds_read_b64_tr_b16 v[96:97], v5 offset:0
    ds_read_b64_tr_b16 v[98:99], v5 offset:256
    ds_read_b64_tr_b16 v[100:101], v5 offset:2048
    ds_read_b64_tr_b16 v[102:103], v5 offset:2304
    ds_read_b64_tr_b16 v[104:105], v5 offset:4096
    ds_read_b64_tr_b16 v[106:107], v5 offset:4352
    ds_read_b64_tr_b16 v[108:109], v5 offset:6144
    ds_read_b64_tr_b16 v[110:111], v5 offset:6400
    ds_read_b64_tr_b16 v[112:113], v5 offset:8192
    ds_read_b64_tr_b16 v[114:115], v5 offset:8448
    ds_read_b64_tr_b16 v[116:117], v5 offset:10240
    ds_read_b64_tr_b16 v[118:119], v5 offset:10496
    ds_read_b64_tr_b16 v[120:121], v5 offset:12288
    ds_read_b64_tr_b16 v[122:123], v5 offset:12544
    ds_read_b64_tr_b16 v[124:125], v5 offset:14336
    ds_read_b64_tr_b16 v[126:127], v5 offset:14592
    ds_read_b64_tr_b16 v[128:129], v5 offset:16384
    ds_read_b64_tr_b16 v[130:131], v5 offset:16640
    ds_read_b64_tr_b16 v[132:133], v5 offset:18432
    ds_read_b64_tr_b16 v[134:135], v5 offset:18688
    ds_read_b64_tr_b16 v[136:137], v5 offset:20480
    ds_read_b64_tr_b16 v[138:139], v5 offset:20736
    ds_read_b64_tr_b16 v[140:141], v5 offset:22528
    ds_read_b64_tr_b16 v[142:143], v5 offset:22784
    ds_read_b64_tr_b16 v[144:145], v5 offset:24576
    ds_read_b64_tr_b16 v[146:147], v5 offset:24832
    ds_read_b64_tr_b16 v[148:149], v5 offset:26624
    ds_read_b64_tr_b16 v[150:151], v5 offset:26880
    ds_read_b64_tr_b16 v[152:153], v5 offset:28672
    ds_read_b64_tr_b16 v[154:155], v5 offset:28928
    ds_read_b64_tr_b16 v[156:157], v5 offset:30720
    ds_read_b64_tr_b16 v[158:159], v5 offset:30976
    ds_read_b64_tr_b16 v[160:161], v5 offset:32768
    ds_read_b64_tr_b16 v[162:163], v5 offset:33024
    ds_read_b64_tr_b16 v[164:165], v5 offset:34816
    ds_read_b64_tr_b16 v[166:167], v5 offset:35072
    ds_read_b64_tr_b16 v[168:169], v5 offset:36864
    ds_read_b64_tr_b16 v[170:171], v5 offset:37120
    ds_read_b64_tr_b16 v[172:173], v5 offset:38912
    ds_read_b64_tr_b16 v[174:175], v5 offset:39168
    s_waitcnt vmcnt(0) lgkmcnt(0)
    s_mov_b64 exec, 1
    ds_add_u32 v12, v13 offset:60
    s_mov_b64 exec, -1
    s_mov_b32 s3, 1048576
K_FGK:
    ds_read_b32 v2, v12 offset:48
    s_sleep 1
    s_sub_u32 s3, s3, 1
    s_waitcnt lgkmcnt(0)
    v_readfirstlane_b32 s33, v2
    s_nop 3
    s_cselect_b32 s33, 1, s33
    s_cmp_lt_u32 s33, 1
    s_cbranch_scc1 K_FGK
    ds_read_b128 v[188:191], v234 offset:0
    ds_read_b128 v[192:195], v234 offset:64
    ds_read_b128 v[196:199], v234 offset:128
    ds_read_b128 v[200:203], v234 offset:192
    ds_read_b128 v[204:207], v234 offset:256
    ds_read_b128 v[208:211], v234 offset:320
    ds_read_b128 v[212:215], v234 offset:384
    ds_read_b128 v[216:219], v234 offset:448
    s_waitcnt lgkmcnt(7)
    v_mfma_f32_16x16x32_bf16 v[220:223], v[16:19], v[188:191], 0
    v_mfma_f32_16x16x32_bf16 v[224:227], v[96:99], v[188:191], 0
    ds_read_b128 v[188:191], v234 offset:512
    s_waitcnt lgkmcnt(7)
    v_mfma_f32_16x16x32_bf16 v[220:223], v[20:23], v[192:195], v[220:223]
    v_mfma_f32_16x16x32_bf16 v[224:227], v[100:103], v[192:195], v[224:227]
    ds_read_b128 v[192:195], v234 offset:576
    s_waitcnt lgkmcnt(7)
    v_mfma_f32_16x16x32_bf16 v[220:223], v[24:27], v[196:199], v[220:223]
    v_mfma_f32_16x16x32_bf16 v[224:227], v[104:107], v[196:199], v[224:227]
    ds_read_b128 v[196:199], v234 offset:640
    s_waitcnt lgkmcnt(7)
    v_mfma_f32_16x16x32_bf16 v[220:223], v[28:31], v[200:203], v[220:223]
    v_mfma_f32_16x16x32_bf16 v[224:227], v[108:111], v[200:203], v[224:227]
    ds_read_b128 v[200:203], v234 offset:704
    s_waitcnt lgkmcnt(7)
    v_mfma_f32_16x16x32_bf16 v[220:223], v[32:35], v[204:207], v[220:223]
    v_mfma_f32_16x16x32_bf16 v[224:227], v[112:115], v[204:207], v[224:227]
    ds_read_b128 v[204:207], v234 offset:768
    s_waitcnt lgkmcnt(7)
    v_mfma_f32_16x16x32_bf16 v[220:223], v[36:39], v[208:211], v[220:223]
    v_mfma_f32_16x16x32_bf16 v[224:227], v[116:119], v[208:211], v[224:227]
    ds_read_b128 v[208:211], v234 offset:832
    s_waitcnt lgkmcnt(7)
    v_mfma_f32_16x16x32_bf16 v[220:223], v[40:43], v[212:215], v[220:223]
    v_mfma_f32_16x16x32_bf16 v[224:227], v[120:123], v[212:215], v[224:227]
    ds_read_b128 v[212:215], v234 offset:896
    s_waitcnt lgkmcnt(7)
    v_mfma_f32_16x16x32_bf16 v[220:223], v[44:47], v[216:219], v[220:223]
    v_mfma_f32_16x16x32_bf16 v[224:227], v[124:127], v[216:219], v[224:227]
    ds_read_b128 v[216:219], v234 offset:960
    s_waitcnt lgkmcnt(7)
    v_mfma_f32_16x16x32_bf16 v[220:223], v[48:51], v[188:191], v[220:223]
    v_mfma_f32_16x16x32_bf16 v[224:227], v[128:131], v[188:191], v[224:227]
    ds_read_b128 v[188:191], v234 offset:1024
    s_waitcnt lgkmcnt(7)
    v_mfma_f32_16x16x32_bf16 v[220:223], v[52:55], v[192:195], v[220:223]
    v_mfma_f32_16x16x32_bf16 v[224:227], v[132:135], v[192:195], v[224:227]
    ds_read_b128 v[192:195], v234 offset:1088
    s_waitcnt lgkmcnt(7)
    v_mfma_f32_16x16x32_bf16 v[220:223], v[56:59], v[196:199], v[220:223]
    v_mfma_f32_16x16x32_bf16 v[224:227], v[136:139], v[196:199], v[224:227]
    ds_read_b128 v[196:199], v234 offset:1152
    s_waitcnt lgkmcnt(7)
    v_mfma_f32_16x16x32_bf16 v[220:223], v[60:63], v[200:203], v[220:223]
    v_mfma_f32_16x16x32_bf16 v[224:227], v[140:143], v[200:203], v[224:227]
    ds_read_b128 v[200:203], v234 offset:1216
    s_waitcnt lgkmcnt(7)
    v_mfma_f32_16x16x32_bf16 v[220:223], v[64:67], v[204:207], v[220:223]
    v_mfma_f32_16x16x32_bf16 v[224:227], v[144:147], v[204:207], v[224:227]
    s_waitcnt lgkmcnt(6)
    v_mfma_f32_16x16x32_bf16 v[220:223], v[68:71], v[208:211], v[220:223]
    v_mfma_f32_16x16x32_bf16 v[224:227], v[148:151], v[208:211], v[224:227]
    s_waitcnt lgkmcnt(5)
    v_mfma_f32_16x16x32_bf16 v[220:223], v[72:75], v[212:215], v[220:223]
    v_mfma_f32_16x16x32_bf16 v[224:227], v[152:155], v[212:215], v[224:227]
    s_waitcnt lgkmcnt(4)
    v_mfma_f32_16x16x32_bf16 v[220:223], v[76:79], v[216:219], v[220:223]
    v_mfma_f32_16x16x32_bf16 v[224:227], v[156:159], v[216:219], v[224:227]
    s_waitcnt lgkmcnt(3)
    v_mfma_f32_16x16x32_bf16 v[220:223], v[80:83], v[188:191], v[220:223]
    v_mfma_f32_16x16x32_bf16 v[224:227], v[160:163], v[188:191], v[224:227]
    s_waitcnt lgkmcnt(2)
    v_mfma_f32_16x16x32_bf16 v[220:223], v[84:87], v[192:195], v[220:223]
    v_mfma_f32_16x16x32_bf16 v[224:227], v[164:167], v[192:195], v[224:227]
    s_waitcnt lgkmcnt(1)
    v_mfma_f32_16x16x32_bf16 v[220:223], v[88:91], v[196:199], v[220:223]
    v_mfma_f32_16x16x32_bf16 v[224:227], v[168:171], v[196:199], v[224:227]
    s_waitcnt lgkmcnt(0)
    v_mfma_f32_16x16x32_bf16 v[220:223], v[92:95], v[200:203], v[220:223]
    v_mfma_f32_16x16x32_bf16 v[224:227], v[172:175], v[200:203], v[224:227]
    s_mov_b32 s3, 1048576
K_FGDN:
    ds_read_b32 v2, v12 offset:52
    s_sleep 1
    s_sub_u32 s3, s3, 1
    s_waitcnt lgkmcnt(0)
    v_readfirstlane_b32 s33, v2
    s_nop 3
    s_cselect_b32 s33, 3, s33
    s_cmp_lt_u32 s33, 3
    s_cbranch_scc1 K_FGDN
    ds_read_b64_tr_b16 v[16:17], v238 offset:0
    ds_read_b64_tr_b16 v[18:19], v238 offset:2048
    ds_read_b64_tr_b16 v[20:21], v239 offset:0
    ds_read_b64_tr_b16 v[22:23], v239 offset:2048
    ds_read_b64_tr_b16 v[24:25], v240 offset:0
    ds_read_b64_tr_b16 v[26:27], v240 offset:2048
    ds_read_b64_tr_b16 v[28:29], v241 offset:0
    ds_read_b64_tr_b16 v[30:31], v241 offset:2048
    ds_read_b64_tr_b16 v[32:33], v238 offset:4096
    ds_read_b64_tr_b16 v[34:35], v238 offset:6144
    ds_read_b64_tr_b16 v[36:37], v239 offset:4096
    ds_read_b64_tr_b16 v[38:39], v239 offset:6144
    ds_read_b64_tr_b16 v[40:41], v240 offset:4096
    ds_read_b64_tr_b16 v[42:43], v240 offset:6144
    v_cvt_pk_bf16_f32 v221, v220, v221
    v_lshlrev_b32 v220, 16, v221
    v_and_b32 v221, 0xffff0000, v221
    v_cvt_pk_bf16_f32 v223, v222, v223
    v_lshlrev_b32 v222, 16, v223
    v_and_b32 v223, 0xffff0000, v223
    v_cvt_pk_bf16_f32 v225, v224, v225
    v_lshlrev_b32 v224, 16, v225
    v_and_b32 v225, 0xffff0000, v225
    v_cvt_pk_bf16_f32 v227, v226, v227
    v_lshlrev_b32 v226, 16, v227
    v_and_b32 v227, 0xffff0000, v227
    v_mul_f32 v188, 0xbfb8aa3b, v220
    v_mul_f32 v189, 0xbfb8aa3b, v221
    v_mul_f32 v190, 0xbfb8aa3b, v222
    v_mul_f32 v191, 0xbfb8aa3b, v223
    v_exp_f32 v188, v188
    v_exp_f32 v189, v189
    v_exp_f32 v190, v190
    v_exp_f32 v191, v191
    v_add_f32 v188, 1.0, v188
    v_add_f32 v189, 1.0, v189
    v_add_f32 v190, 1.0, v190
    v_add_f32 v191, 1.0, v191
    v_rcp_f32 v188, v188
    v_rcp_f32 v189, v189
    v_rcp_f32 v190, v190
    v_rcp_f32 v191, v191
    v_mul_f32 v220, v220, v188
    v_mul_f32 v221, v221, v189
    v_mul_f32 v222, v222, v190
    v_mul_f32 v223, v223, v191
    v_cvt_pk_bf16_f32 v221, v220, v221
    v_lshlrev_b32 v220, 16, v221
    v_and_b32 v221, 0xffff0000, v221
    v_cvt_pk_bf16_f32 v223, v222, v223
    v_lshlrev_b32 v222, 16, v223
    v_and_b32 v223, 0xffff0000, v223
    v_mul_f32 v220, v220, v224
    v_mul_f32 v221, v221, v225
    v_mul_f32 v222, v222, v226
    v_mul_f32 v223, v223, v227
    v_cvt_pk_bf16_f32 v228, v220, v221
    v_cvt_pk_bf16_f32 v229, v222, v223
    ds_write_b64 v235, v[228:229]
    s_mov_b64 exec, 1
    ds_add_u32 v12, v13 offset:52
    s_mov_b64 exec, -1
    ds_read_b64_tr_b16 v[44:45], v241 offset:4096
    ds_read_b64_tr_b16 v[46:47], v241 offset:6144
    ds_read_b64_tr_b16 v[48:49], v238 offset:8192
    ds_read_b64_tr_b16 v[50:51], v238 offset:10240
    ds_read_b64_tr_b16 v[52:53], v239 offset:8192
    ds_read_b64_tr_b16 v[54:55], v239 offset:10240
    ds_read_b64_tr_b16 v[56:57], v240 offset:8192
    ds_read_b64_tr_b16 v[58:59], v240 offset:10240
    ds_read_b64_tr_b16 v[60:61], v241 offset:8192
    ds_read_b64_tr_b16 v[62:63], v241 offset:10240
    ds_read_b64_tr_b16 v[64:65], v238 offset:12288
    ds_read_b64_tr_b16 v[66:67], v238 offset:14336
    ds_read_b64_tr_b16 v[68:69], v239 offset:12288
    ds_read_b64_tr_b16 v[70:71], v239 offset:14336
    ds_read_b64_tr_b16 v[72:73], v240 offset:12288
    ds_read_b64_tr_b16 v[74:75], v240 offset:14336
    ds_read_b64_tr_b16 v[76:77], v241 offset:12288
    ds_read_b64_tr_b16 v[78:79], v241 offset:14336
    ds_read_b64_tr_b16 v[80:81], v238 offset:16384
    ds_read_b64_tr_b16 v[82:83], v238 offset:18432
    ds_read_b64_tr_b16 v[84:85], v239 offset:16384
    ds_read_b64_tr_b16 v[86:87], v239 offset:18432
    ds_read_b64_tr_b16 v[88:89], v240 offset:16384
    ds_read_b64_tr_b16 v[90:91], v240 offset:18432
    ds_read_b64_tr_b16 v[92:93], v241 offset:16384
    ds_read_b64_tr_b16 v[94:95], v241 offset:18432
    s_mov_b32 s3, 1048576
K_FGP:
    ds_read_b32 v2, v12 offset:52
    s_sleep 0
    s_sub_u32 s3, s3, 1
    s_waitcnt lgkmcnt(0)
    v_readfirstlane_b32 s33, v2
    s_nop 3
    s_cselect_b32 s33, 5, s33
    s_cmp_lt_u32 s33, 5
    s_cbranch_scc1 K_FGP
    ds_read_b128 v[228:231], v236
    s_waitcnt lgkmcnt(0)
    v_mfma_f32_16x16x32_bf16 v[96:99], v[16:19], v[228:231], 0
    v_mfma_f32_16x16x32_bf16 v[100:103], v[20:23], v[228:231], 0
    v_mfma_f32_16x16x32_bf16 v[104:107], v[24:27], v[228:231], 0
    v_mfma_f32_16x16x32_bf16 v[108:111], v[28:31], v[228:231], 0
    v_mfma_f32_16x16x32_bf16 v[112:115], v[32:35], v[228:231], 0
    v_mfma_f32_16x16x32_bf16 v[116:119], v[36:39], v[228:231], 0
    v_mfma_f32_16x16x32_bf16 v[120:123], v[40:43], v[228:231], 0
    v_mfma_f32_16x16x32_bf16 v[124:127], v[44:47], v[228:231], 0
    v_mfma_f32_16x16x32_bf16 v[128:131], v[48:51], v[228:231], 0
    v_mfma_f32_16x16x32_bf16 v[132:135], v[52:55], v[228:231], 0
    v_mfma_f32_16x16x32_bf16 v[136:139], v[56:59], v[228:231], 0
    v_mfma_f32_16x16x32_bf16 v[140:143], v[60:63], v[228:231], 0
    v_mfma_f32_16x16x32_bf16 v[144:147], v[64:67], v[228:231], 0
    v_mfma_f32_16x16x32_bf16 v[148:151], v[68:71], v[228:231], 0
    v_mfma_f32_16x16x32_bf16 v[152:155], v[72:75], v[228:231], 0
    v_mfma_f32_16x16x32_bf16 v[156:159], v[76:79], v[228:231], 0
    v_mfma_f32_16x16x32_bf16 v[160:163], v[80:83], v[228:231], 0
    v_mfma_f32_16x16x32_bf16 v[164:167], v[84:87], v[228:231], 0
    v_mfma_f32_16x16x32_bf16 v[168:171], v[88:91], v[228:231], 0
    v_mfma_f32_16x16x32_bf16 v[172:175], v[92:95], v[228:231], 0
    s_mov_b32 exec_lo, 0x00030003
    s_mov_b32 exec_hi, 0x00030003
    buffer_store_dwordx4 v[96:99], v237, s[64:67], s72 offen offset:0 sc1
    buffer_store_dwordx4 v[100:103], v237, s[64:67], s72 offen offset:64 sc1
    buffer_store_dwordx4 v[104:107], v237, s[64:67], s72 offen offset:128 sc1
    buffer_store_dwordx4 v[108:111], v237, s[64:67], s72 offen offset:192 sc1
    buffer_store_dwordx4 v[112:115], v237, s[64:67], s72 offen offset:256 sc1
    buffer_store_dwordx4 v[116:119], v237, s[64:67], s72 offen offset:320 sc1
    buffer_store_dwordx4 v[120:123], v237, s[64:67], s72 offen offset:384 sc1
    buffer_store_dwordx4 v[124:127], v237, s[64:67], s72 offen offset:448 sc1
    buffer_store_dwordx4 v[128:131], v237, s[64:67], s72 offen offset:512 sc1
    buffer_store_dwordx4 v[132:135], v237, s[64:67], s72 offen offset:576 sc1
    buffer_store_dwordx4 v[136:139], v237, s[64:67], s72 offen offset:640 sc1
    buffer_store_dwordx4 v[140:143], v237, s[64:67], s72 offen offset:704 sc1
    buffer_store_dwordx4 v[144:147], v237, s[64:67], s72 offen offset:768 sc1
    buffer_store_dwordx4 v[148:151], v237, s[64:67], s72 offen offset:832 sc1
    buffer_store_dwordx4 v[152:155], v237, s[64:67], s72 offen offset:896 sc1
    buffer_store_dwordx4 v[156:159], v237, s[64:67], s72 offen offset:960 sc1
    buffer_store_dwordx4 v[160:163], v237, s[64:67], s72 offen offset:1024 sc1
    buffer_store_dwordx4 v[164:167], v237, s[64:67], s72 offen offset:1088 sc1
    buffer_store_dwordx4 v[168:171], v237, s[64:67], s72 offen offset:1152 sc1
    buffer_store_dwordx4 v[172:175], v237, s[64:67], s72 offen offset:1216 sc1
    s_mov_b64 exec, -1
    s_mul_i32 s3, s73, 2560
    s_lshl2_add_u32 s3, s44, s3
    s_add_u32 s3, s3, 568320
    v_lshl_add_u32 v2, v1, 8, s3
    s_mov_b64 exec, 0x3ff
    s_waitcnt vmcnt(0)
    global_store_dword v2, v13, s[10:11] sc1
    s_mov_b64 exec, -1
    s_branch K_P2_HELP
K_CODE_END:
.section .rodata,"a"
.p2align 6
.amdhsa_kernel gated_mix__sliding_local_dilated__moe_arch_mod__prompt_kernel
  .amdhsa_next_free_vgpr 248
  .amdhsa_next_free_sgpr 79
  .amdhsa_accum_offset 248
  .amdhsa_group_segment_fixed_size 0
  .amdhsa_kernarg_size 96
  .amdhsa_user_sgpr_count 2
  .amdhsa_user_sgpr_kernarg_segment_ptr 1
  .amdhsa_system_sgpr_workgroup_id_x 1
.end_amdhsa_kernel
```

```asm
; @launch grid=(256,1,1) block=(512,1,1) lds=163840
.amdgcn_target "amdgcn-amd-amdhsa--gfx950"
.text
.p2align 12
.p2align 8
.globl gated_mix__sliding_local_dilated__moe_arch_mod__prompt_kernel
.type gated_mix__sliding_local_dilated__moe_arch_mod__prompt_kernel,@function
gated_mix__sliding_local_dilated__moe_arch_mod__prompt_kernel:
    s_cmp_ge_u32 s2, 256
    s_cbranch_scc1 K_EXIT
    s_load_dwordx2 s[12:13], s[0:1], 0
    s_load_dwordx2 s[16:17], s[0:1], 8
    v_readfirstlane_b32 s30, v0
    s_load_dwordx4 s[8:11], s[0:1], 80
    s_load_dwordx2 s[24:25], s[0:1], 16
    s_load_dwordx2 s[6:7], s[0:1], 72
    s_and_b32 s28, s2, 7
    v_and_b32 v1, 63, v0
    s_mov_b32 s14, 0x280000
    s_mov_b32 s15, 0x20000
    s_lshr_b32 s30, s30, 6
    s_cmp_lt_u32 s2, 64
    s_cbranch_scc1 K_SLOW
    s_cmp_lt_u32 s30, 4
    s_cbranch_scc1 K_FAST
K_SLOW:
    s_getpc_b64 s[38:39]
K_PC:
    s_bfe_u32 s3, s2, 0x30003
    s_mul_i32 s3, s3, ((K_CODE_END-gated_mix__sliding_local_dilated__moe_arch_mod__prompt_kernel+1023)/1024)
    s_sub_u32 s38, s38, K_PC-gated_mix__sliding_local_dilated__moe_arch_mod__prompt_kernel
    s_subb_u32 s39, s39, 0
    v_subrev_u32 v3, 256, v0
    v_add_u32 v2, s3, v3
    v_lshlrev_b32 v2, 7, v2
    v_min_u32 v2, K_CODE_END-gated_mix__sliding_local_dilated__moe_arch_mod__prompt_kernel-4, v2
    v_cmp_gt_u32 vcc, ((K_CODE_END-gated_mix__sliding_local_dilated__moe_arch_mod__prompt_kernel+1023)/1024), v3
    s_and_saveexec_b64 s[4:5], vcc
    s_cbranch_execz K_NOPF
    global_load_dword v6, v2, s[38:39]
K_NOPF:
    s_mov_b64 exec, -1
    v_mov_b32 v2, 0
    v_mov_b32 v3, 158752
    ds_write2_b32 v3, v2, v2 offset0:0 offset1:1
    ds_write2_b32 v3, v2, v2 offset0:2 offset1:3
    ds_write2_b32 v3, v2, v2 offset0:4 offset1:5
    ds_write2_b32 v3, v2, v2 offset0:6 offset1:7
    ds_write2_b32 v3, v2, v2 offset0:8 offset1:9
    ds_write2_b32 v3, v2, v2 offset0:10 offset1:11
    s_mov_b32 s43, 1
    s_lshl_b32 s3, s30, 8
    s_add_u32 s3, s3, s2
    s_lshr_b32 s3, s3, 3
    s_cmp_lg_u32 s3, 160
    s_cbranch_scc1 K_COMMON
    s_mul_i32 s3, s2, 6144
    s_add_u32 s3, s3, 527360
    v_lshl_add_u32 v6, v1, 4, s3
    v_mov_b64 v[28:29], 0
    v_mov_b64 v[30:31], 0
    s_waitcnt lgkmcnt(0)
    global_store_dwordx4 v6, v[28:31], s[10:11] offset:-3072 sc1
    global_store_dwordx4 v6, v[28:31], s[10:11] offset:-2048 sc1
    global_store_dwordx4 v6, v[28:31], s[10:11] offset:-1024 sc1
    global_store_dwordx4 v6, v[28:31], s[10:11] offset:0 sc1
    global_store_dwordx4 v6, v[28:31], s[10:11] offset:1024 sc1
    global_store_dwordx4 v6, v[28:31], s[10:11] offset:2048 sc1
    s_lshl_b32 s3, s2, 2
    v_mov_b32 v2, s3
    v_mov_b32 v3, 1
    s_mov_b64 exec, 1
    s_waitcnt vmcnt(0)
    global_store_dword v2, v3, s[8:9] offset:192 sc1
    s_mov_b64 exec, -1
    s_branch K_COMMON
K_FAST:
    s_lshr_b32 s32, s2, 1
    s_and_b32 s32, s32, 28
    v_lshrrev_b32 v3, 4, v1
    s_lshr_b32 s3, s2, 6
    s_mov_b32 s59, 0x59608237
    s_cmp_eq_u32 s3, 2
    s_cselect_b32 s59, 0x26375904, s59
    v_and_b32 v4, 7, v1
    s_cmp_eq_u32 s3, 3
    s_cselect_b32 s59, 0x93042671, s59
    v_lshrrev_b32 v2, 3, v1
    s_lshr_b32 s59, s59, s32
    s_and_b32 s59, s59, 15
    v_xor_b32 v4, v4, v3
    s_lshl_b32 s33, s28, 2
    s_lshr_b32 s33, 0x76543210, s33
    s_and_b32 s33, s33, 15
    s_add_u32 s59, s59, s33
    s_cmp_ge_u32 s59, 10
    v_mul_u32_u24 v2, 1280, v2
    s_cselect_b32 s33, 10, 0
    s_sub_u32 s59, s59, s33
    s_lshr_b32 s53, s28, 1
    v_lshl_add_u32 v44, v4, 4, v2
    s_mul_i32 s53, s53, 655360
    s_lshl2_add_u32 s62, s3, s30
    s_cmp_eq_u32 s62, 15
    s_cselect_b32 s62, 0x800000, 0
    s_add_u32 s62, s62, 40960
    s_mul_i32 s3, s3, 225280
    v_xor_b32 v45, 64, v44
    s_add_u32 s53, s53, s3
    s_mul_i32 s54, s30, 61440
    s_add_u32 s53, s53, s54
    s_sub_u32 s53, s53, 245760
    s_mul_i32 s55, s30, 6144
    s_add_u32 s55, s55, 40960
    s_lshl_b32 s57, s59, 7
    s_add_u32 s57, s57, s53
    s_waitcnt lgkmcnt(0)
    s_add_u32 m0, s55, 0
    s_max_i32 s60, s57, 0
    buffer_load_dwordx4 v44, s[12:15], s60 offen lds
    s_add_u32 s60, s57, 10240
    s_add_u32 m0, s55, 1024
    s_max_i32 s60, s60, 0
    buffer_load_dwordx4 v45, s[12:15], s60 offen lds
    s_add_u32 m0, s55, 2048
    s_add_u32 s60, s57, 20480
    buffer_load_dwordx4 v44, s[12:15], s60 offen lds
    s_add_u32 m0, s55, 3072
    s_add_u32 s60, s57, 30720
    buffer_load_dwordx4 v45, s[12:15], s60 offen lds
    s_add_u32 m0, s55, 4096
    s_add_u32 s60, s57, s62
    buffer_load_dwordx4 v44, s[12:15], s60 offen lds
    s_add_u32 m0, s55, 5120
    s_add_u32 s60, s60, 10240
    buffer_load_dwordx4 v45, s[12:15], s60 offen lds
    v_lshlrev_b32 v2, 1, v3
    s_lshr_b32 s32, 0x64317520, s32
    v_sub_u32 v2, v1, v2
    s_and_b32 s32, s32, 7
    v_and_b32 v2, 15, v2
    s_and_b32 s3, s28, 1
    v_mul_u32_u24 v3, 3840, v3
    s_lshl3_add_u32 s32, s3, s32
    v_mul_u32_u24 v4, 13, v2
    s_mul_i32 s3, s32, 80
    v_lshrrev_b32 v4, 6, v4
    s_add_u32 s54, s54, s3
    v_mul_u32_u24 v4, 1200, v4
    s_lshl_b32 s56, s30, 12
    v_lshl_add_u32 v4, v2, 4, v4
    s_add_u32 s56, s56, 65536
    v_add_u32 v5, 1, v2
    s_mov_b32 s18, 0x258000
    v_and_b32 v5, 16, v5
    s_mov_b32 s19, 0x20000
    v_lshl_add_u32 v4, v5, 24, v4
    v_add_u32 v46, v3, v4
    s_mul_i32 s58, s59, 245760
    s_add_u32 s58, s58, s54
    s_add_u32 s59, s59, 1
    s_cmp_eq_u32 s59, 10
    s_cselect_b32 s59, 0, s59
    s_add_u32 m0, s56, 0
    s_add_u32 s60, s58, 0
    buffer_load_dwordx4 v46, s[16:19], s60 offen lds
    s_add_u32 m0, s56, 1024
    s_add_u32 s60, s58, 15360
    buffer_load_dwordx4 v46, s[16:19], s60 offen lds
    v_xor_b32 v2, 8, v2
    v_mul_u32_u24 v4, 13, v2
    v_lshrrev_b32 v4, 6, v4
    v_mul_u32_u24 v4, 1200, v4
    v_lshl_add_u32 v4, v2, 4, v4
    v_add_u32 v5, 1, v2
    v_and_b32 v5, 16, v5
    v_lshl_add_u32 v4, v5, 24, v4
    v_add_u32 v47, v3, v4
    s_add_u32 m0, s56, 2048
    s_add_u32 s60, s58, 30720
    buffer_load_dwordx4 v47, s[16:19], s60 offen lds
    s_add_u32 m0, s56, 3072
    s_add_u32 s60, s58, 46080
    buffer_load_dwordx4 v47, s[16:19], s60 offen lds
    s_mov_b32 s52, s30
    s_mov_b32 s43, 0
K_COMMON:
    v_mov_b32 v7, 0
    s_lshr_b32 s29, s2, 3
    s_xor_b32 s30, s30, 4
    s_mov_b32 s26, 0xc8000
    s_mov_b32 s27, 0x20000
    s_lshr_b32 s34, s29, 3
    s_lshl_b32 s34, s34, 2
    s_and_b32 s3, s29, 3
    s_add_u32 s34, s34, s3
    s_add_u32 s34, s34, 4
    s_bitcmp1_b32 s29, 2
    s_cselect_b32 s34, -1, s34
    s_cmp_lt_u32 s29, 8
    s_cselect_b32 s34, s29, s34
    s_lshl_b32 s40, s28, 1
    s_cmp_ge_u32 s34, 10
    s_addc_u32 s40, s40, 0
    s_sub_u32 s41, s34, 10
    s_cmp_ge_u32 s34, 10
    s_cselect_b32 s41, s41, s34
    s_mul_i32 s42, s28, 20
    s_add_u32 s42, s42, s34
    s_and_b32 s42, s42, 255
    s_lshl_b32 s42, s42, 8
    s_add_u32 s42, s42, 524288
    s_cmp_lt_u32 s29, 8
    s_cbranch_scc1 K_AUX
    s_lshr_b32 s31, s29, 3
    s_sub_u32 s31, s31, 1
    s_and_b32 s35, s29, 3
    s_and_b32 s3, s29, 4
    s_lshl_b32 s3, s3, 1
    s_add_u32 s35, s35, s3
    s_and_b32 s3, s28, 1
    s_lshl_b32 s3, s3, 2
    s_add_u32 s35, s35, s3
    v_and_b32 v9, 15, v1
    v_lshrrev_b32 v10, 4, v1
    v_bfe_u32 v11, v1, 2, 2
    v_and_b32 v12, 3, v1
    s_waitcnt lgkmcnt(0)
    s_add_u32 s20, s10, 0x100000
    s_addc_u32 s21, s11, 0
    s_mov_b32 s22, 0x280000
    s_mov_b32 s23, 0x20000
    s_and_b32 s3, s30, 3
    s_mul_i32 s3, s3, 3
    s_lshr_b32 s33, s30, 2
    s_lshl1_add_u32 s3, s33, s3
    s_mul_i32 s44, s31, 11
    s_add_u32 s44, s44, s3
    s_cmp_eq_u32 s44, 31
    s_cselect_b32 s51, 4, s30
    s_lshr_b32 s33, s28, 1
    s_lshl_b32 s33, s33, 5
    s_add_u32 s44, s44, s33
    s_mul_i32 s3, s3, 4352
    s_add_u32 s3, s3, 81920
    v_mul_u32_u24 v14, 272, v9
    v_lshl_add_u32 v13, v10, 3, v14
    v_add_u32 v13, s3, v13
    v_add3_u32 v14, v14, 32, s3
    v_cmp_eq_u32 vcc, 0, v10
    v_add_u32 v2, 208, v14
    v_add_u32 v3, 0, v14
    v_add_u32 v4, 40, v14
    v_cndmask_b32 v19, v2, v3, vcc
    v_cndmask_b32 v20, v2, v4, vcc
    v_lshl_add_u32 v15, v10, 2, v11
    v_mul_u32_u24 v15, 272, v15
    v_add_u32 v5, s3, v15
    v_lshl_add_u32 v15, v12, 3, v5
    v_add_u32 v2, 240, v5
    v_add_u32 v3, 192, v5
    v_add_u32 v4, 232, v5
    v_cmp_eq_u32 vcc, 0, v12
    s_nop 1
    v_cndmask_b32 v21, v2, v3, vcc
    v_cmp_eq_u32 vcc, 1, v12
    s_nop 1
    v_cndmask_b32 v22, v2, v4, vcc
    v_cmp_eq_u32 vcc, 2, v12
    s_nop 1
    v_cndmask_b32 v23, v2, v3, vcc
    v_cmp_eq_u32 vcc, 3, v12
    s_nop 1
    v_cndmask_b32 v24, v2, v4, vcc
    s_lshl_b32 s3, s35, 10
    v_lshl_add_u32 v16, v1, 4, s3
    s_lshl_b32 s3, s35, 8
    s_add_u32 s3, s3, 16384
    v_lshl_add_u32 v17, v9, 4, s3
    v_and_b32 v2, 1, v10
    v_lshl_add_u32 v17, v2, 3, v17
    s_cmp_lt_u32 s51, 4
    s_cselect_b32 s3, 0, 0x800000
    s_add_u32 s3, s3, 20480
    v_lshrrev_b32 v2, 1, v10
    v_mad_u32_u24 v17, v2, s3, v17
    s_mul_i32 s50, s44, 20480
    s_add_u32 s51, s50, s3
    v_mov_b32 v18, 0xf149f2ca
    v_lshlrev_b32 v2, 2, v10
    v_sub_u32 v2, v9, v2
    s_cmp_eq_u32 s44, 0
    s_cselect_b32 s3, 0xf149f2ca, 0
    v_subrev_u32 v3, 0, v2
    v_and_b32 v4, 0x80000001, v3
    v_cmp_eq_u32 vcc, 0, v4
    s_nop 1
    v_cndmask_b32 v32, v18, 0, vcc
    v_cmp_eq_u32 vcc, 0x80000000, v4
    s_nop 1
    v_cndmask_b32 v28, v18, 0, vcc
    v_add_f32 v36, s3, v28
    v_subrev_u32 v3, 1, v2
    v_and_b32 v4, 0x80000001, v3
    v_cmp_eq_u32 vcc, 0, v4
    s_nop 1
    v_cndmask_b32 v33, v18, 0, vcc
    v_cmp_eq_u32 vcc, 0x80000000, v4
    s_nop 1
    v_cndmask_b32 v29, v18, 0, vcc
    v_add_f32 v37, s3, v29
    v_subrev_u32 v3, 2, v2
    v_and_b32 v4, 0x80000001, v3
    v_cmp_eq_u32 vcc, 0, v4
    s_nop 1
    v_cndmask_b32 v34, v18, 0, vcc
    v_cmp_eq_u32 vcc, 0x80000000, v4
    s_nop 1
    v_cndmask_b32 v30, v18, 0, vcc
    v_add_f32 v38, s3, v30
    v_subrev_u32 v3, 3, v2
    v_and_b32 v4, 0x80000001, v3
    v_cmp_eq_u32 vcc, 0, v4
    s_nop 1
    v_cndmask_b32 v35, v18, 0, vcc
    v_cmp_eq_u32 vcc, 0x80000000, v4
    s_nop 1
    v_cndmask_b32 v31, v18, 0, vcc
    v_add_f32 v39, s3, v31
    v_mov_b32 v3, 0x0c0c0c0c
    v_mov_b32 v4, 0xc0c0100
    v_cmp_eq_u32 vcc, 0, v28
    v_mov_b32 v5, 0x1000c0c
    s_nop 0
    v_cndmask_b32 v3, v3, v4, vcc
    v_cmp_eq_u32 vcc, 0, v29
    s_nop 1
    v_cndmask_b32 v40, v3, v5, vcc
    v_mov_b32 v3, 0x0c0c0c0c
    v_mov_b32 v4, 0xc0c0302
    v_cmp_eq_u32 vcc, 0, v30
    v_mov_b32 v5, 0x3020c0c
    s_nop 0
    v_cndmask_b32 v3, v3, v4, vcc
    v_cmp_eq_u32 vcc, 0, v31
    s_nop 1
    v_cndmask_b32 v41, v3, v5, vcc
    v_mov_b32 v3, 0x0c0c0c0c
    v_mov_b32 v4, 0xc0c0100
    v_cmp_eq_u32 vcc, 0, v32
    v_mov_b32 v5, 0x1000c0c
    s_nop 0
    v_cndmask_b32 v3, v3, v4, vcc
    v_cmp_eq_u32 vcc, 0, v33
    s_nop 1
    v_cndmask_b32 v42, v3, v5, vcc
    v_mov_b32 v3, 0x0c0c0c0c
    v_mov_b32 v4, 0xc0c0302
    v_cmp_eq_u32 vcc, 0, v34
    v_mov_b32 v5, 0x3020c0c
    s_nop 0
    v_cndmask_b32 v3, v3, v4, vcc
    v_cmp_eq_u32 vcc, 0, v35
    s_nop 1
    v_cndmask_b32 v43, v3, v5, vcc
    s_mov_b32 s46, 0x3fb8aa3b
    s_mov_b32 s47, s46
    s_mov_b32 s48, 0x3e64f92e
    s_mov_b32 s49, s48
    s_mov_b32 s36, 0xfffff
    s_cmp_lg_u32 s31, 0
    s_cselect_b32 s33, 64, 0
    v_mov_b32 v2, s33
    v_cmp_gt_u32 vcc, 10, v1
    s_lshr_b32 s3, s28, 1
    s_lshl2_add_u32 s3, s3, s31
    v_cndmask_b32 v2, 0, v2, vcc
    v_lshl_add_u32 v2, v1, 8, v2
    s_mul_i32 s3, s3, 2560
    s_lshl2_add_u32 s3, s35, s3
    s_add_u32 s3, s3, 524288
    v_add_u32 v8, s3, v2
    s_cmp_eq_u32 s43, 1
    s_cbranch_scc1 K_CONS
    v_lshrrev_b32 v2, 3, v1
    v_mul_u32_u24 v2, 1280, v2
    v_lshrrev_b32 v3, 4, v1
    v_lshlrev_b32 v3, 1, v3
    v_and_b32 v4, 7, v1
    v_xor_b32 v3, v3, v4
    v_lshl_add_u32 v2, v3, 4, v2
    s_lshl_b32 s33, s41, 7
    v_add_u32 v18, s33, v2
    s_mov_b32 s61, 9
    s_mov_b32 s3, 40960
    s_branch K_LOOPE
K_LOOP:
    s_waitcnt vmcnt(5)
    s_barrier
    s_add_u32 m0, s56, 2048
    s_add_u32 s60, s58, 30720
    buffer_load_dwordx4 v47, s[16:19], s60 offen lds
    s_add_u32 m0, s55, 3072
    s_add_u32 s60, s57, 30720
    buffer_load_dwordx4 v45, s[12:15], s60 offen lds
    s_add_u32 m0, s56, 3072
    s_add_u32 s60, s58, 46080
    buffer_load_dwordx4 v47, s[16:19], s60 offen lds
    s_add_u32 m0, s55, 4096
    s_add_u32 s60, s57, s62
    buffer_load_dwordx4 v44, s[12:15], s60 offen lds
    s_add_u32 m0, s55, 5120
    s_add_u32 s60, s60, 10240
    buffer_load_dwordx4 v45, s[12:15], s60 offen lds
    s_sub_u32 s61, s61, 1
    s_cmp_eq_u32 s61, 0
    s_cbranch_scc1 K_LOOPX
K_LOOPE:
    s_cmp_ge_u32 s55, 81920
    s_cselect_b32 s60, -81920, s3
    s_add_u32 s55, s55, s60
    s_add_u32 s56, s56, s60
    s_lshl_b32 s57, s59, 7
    s_add_u32 s57, s57, s53
    s_mul_i32 s58, s59, 245760
    s_add_u32 s58, s58, s54
    s_add_u32 s59, s59, 1
    s_cmp_eq_u32 s59, 10
    s_cselect_b32 s59, 0, s59
    s_add_u32 m0, s56, 0
    s_add_u32 s60, s58, 0
    buffer_load_dwordx4 v46, s[16:19], s60 offen lds
    s_add_u32 m0, s55, 0
    s_max_i32 s60, s57, 0
    buffer_load_dwordx4 v44, s[12:15], s60 offen lds
    s_add_u32 m0, s56, 1024
    s_add_u32 s60, s58, 15360
    buffer_load_dwordx4 v46, s[16:19], s60 offen lds
    s_add_u32 s60, s57, 10240
    s_add_u32 m0, s55, 1024
    s_max_i32 s60, s60, 0
    buffer_load_dwordx4 v45, s[12:15], s60 offen lds
    s_add_u32 m0, s55, 2048
    s_add_u32 s60, s57, 20480
    buffer_load_dwordx4 v44, s[12:15], s60 offen lds
    s_branch K_LOOP
K_LOOPX:
    v_and_b32 v2, 7, v1
    v_lshlrev_b32 v2, 2, v2
    s_waitcnt vmcnt(0)
    s_barrier
    s_cmp_lt_u32 s30, 6
    s_cbranch_scc1 K_NOSMP
    global_load_dword v7, v2, s[8:9] offset:192 sc1
K_NOSMP:
    s_cmp_eq_u32 s34, -1
    s_cbranch_scc1 K_JOIN_S
    s_cmp_lt_u32 s52, 2
    s_cbranch_scc1 K_WOE
    s_cmp_lg_u32 s30, 7
    s_cbranch_scc1 K_JOIN_S
    s_mov_b32 s52, 2
    s_branch K_W7A
K_WOE:
    s_lshl_b32 s57, s52, 2
    s_lshr_b32 s57, 0x7520, s57
    s_and_b32 s57, s57, 7
    s_mul_i32 s57, s57, 51200
    s_mul_i32 s58, s52, 5120
    s_add_u32 s3, s57, 0
    s_add_u32 m0, s58, 0
    s_nop 0
    buffer_load_dwordx4 v18, s[24:27], s3 offen lds
    s_add_u32 s3, s57, 10240
    s_add_u32 m0, s58, 1024
    s_nop 0
    buffer_load_dwordx4 v18, s[24:27], s3 offen lds
    s_add_u32 s3, s57, 20480
    s_add_u32 m0, s58, 2048
    s_nop 0
    buffer_load_dwordx4 v18, s[24:27], s3 offen lds
    s_add_u32 s3, s57, 30720
    s_add_u32 m0, s58, 3072
    s_nop 0
    buffer_load_dwordx4 v18, s[24:27], s3 offen lds
    s_add_u32 s3, s57, 40960
    s_add_u32 m0, s58, 4096
    s_nop 0
    buffer_load_dwordx4 v18, s[24:27], s3 offen lds
    s_add_u32 s3, s57, 409600
    s_add_u32 m0, s58, 20480
    s_nop 0
    buffer_load_dwordx4 v18, s[24:27], s3 offen lds
    s_add_u32 s3, s57, 419840
    s_add_u32 m0, s58, 21504
    s_nop 0
    buffer_load_dwordx4 v18, s[24:27], s3 offen lds
    s_add_u32 s3, s57, 430080
    s_add_u32 m0, s58, 22528
    s_nop 0
    buffer_load_dwordx4 v18, s[24:27], s3 offen lds
    s_add_u32 s3, s57, 440320
    s_add_u32 m0, s58, 23552
    s_nop 0
    buffer_load_dwordx4 v18, s[24:27], s3 offen lds
    s_add_u32 s3, s57, 450560
    s_add_u32 m0, s58, 24576
    s_nop 0
    buffer_load_dwordx4 v18, s[24:27], s3 offen lds
    s_cmp_lg_u32 s30, 7
    s_cbranch_scc1 K_JOIN_S
    s_add_u32 s52, s52, 1
    s_cmp_lt_u32 s52, 4
    s_cbranch_scc1 K_WOE
    s_mov_b32 s52, 0
K_XD:
    s_lshl_b32 s57, s40, 3
    s_lshl1_add_u32 s57, s52, s57
    s_mul_i32 s57, s57, 20480
    s_lshl_b32 s33, s41, 7
    s_add_u32 s57, s57, s33
    s_lshl_b32 s33, s52, 12
    s_add_u32 m0, s33, 140288
    s_add_u32 s3, s57, 0
    buffer_load_dwordx4 v44, s[12:15], s3 offen lds
    s_add_u32 m0, s33, 141312
    s_add_u32 s3, s57, 10240
    buffer_load_dwordx4 v45, s[12:15], s3 offen lds
    s_add_u32 m0, s33, 142336
    s_add_u32 s3, s57, 20480
    buffer_load_dwordx4 v44, s[12:15], s3 offen lds
    s_add_u32 m0, s33, 143360
    s_add_u32 s3, s57, 30720
    buffer_load_dwordx4 v45, s[12:15], s3 offen lds
    s_add_u32 s52, s52, 1
    s_cmp_lt_u32 s52, 4
    s_cbranch_scc1 K_XD
    s_branch K_W7
.p2align 12
K_CONS:
    s_lshr_b32 s52, s30, 1
    s_and_b32 s53, s30, 1
    v_lshrrev_b32 v2, 1, v9
    v_xor_b32 v2, v2, v10
    v_lshlrev_b32 v2, 4, v2
    v_lshl_add_u32 v2, v9, 7, v2
    s_mul_i32 s3, s52, 12288
    v_add_u32 v44, s3, v2
    v_xor_b32 v45, 64, v44
    v_add_u32 v46, 81920, v44
    v_add_u32 v47, 81920, v45
    v_and_b32 v2, 1, v10
    v_lshl_or_b32 v2, v2, 2, v11
    v_lshl_add_u32 v3, v10, 3, v11
    v_lshlrev_b32 v3, 8, v3
    v_lshl_add_u32 v3, v12, 3, v3
    v_add_u32 v3, 24576, v3
    s_lshl_b32 s3, s53, 2
    v_add_u32 v2, s3, v2
    v_add_u32 v4, 0, v2
    v_and_b32 v4, 7, v4
    v_lshl_add_u32 v48, v4, 5, v3
    v_add_u32 v52, 81920, v48
    v_add_u32 v4, 1, v2
    v_and_b32 v4, 7, v4
    v_lshl_add_u32 v49, v4, 5, v3
    v_add_u32 v53, 81920, v49
    v_add_u32 v4, 2, v2
    v_and_b32 v4, 7, v4
    v_lshl_add_u32 v50, v4, 5, v3
    v_add_u32 v54, 81920, v50
    v_add_u32 v4, 3, v2
    v_and_b32 v4, 7, v4
    v_lshl_add_u32 v51, v4, 5, v3
    v_add_u32 v55, 81920, v51
    v_mul_u32_u24 v56, 272, v9
    v_lshl_add_u32 v56, v10, 3, v56
    s_mul_i32 s3, s52, 26112
    s_lshl_b32 s33, s53, 7
    s_add_u32 s3, s3, s33
    s_add_u32 s3, s3, 81920
    v_add_u32 v56, s3, v56
    v_mov_b64 v[60:61], 0
    v_mov_b64 v[62:63], 0
    v_mov_b64 v[64:65], 0
    v_mov_b64 v[66:67], 0
    v_mov_b64 v[68:69], 0
    v_mov_b64 v[70:71], 0
    v_mov_b64 v[72:73], 0
    v_mov_b64 v[74:75], 0
    v_mov_b64 v[76:77], 0
    v_mov_b64 v[78:79], 0
    v_mov_b64 v[80:81], 0
    v_mov_b64 v[82:83], 0
    v_mov_b64 v[84:85], 0
    v_mov_b64 v[86:87], 0
    v_mov_b64 v[88:89], 0
    v_mov_b64 v[90:91], 0
    v_mov_b64 v[92:93], 0
    v_mov_b64 v[94:95], 0
    v_mov_b64 v[96:97], 0
    v_mov_b64 v[98:99], 0
    v_mov_b64 v[100:101], 0
    v_mov_b64 v[102:103], 0
    v_mov_b64 v[104:105], 0
    v_mov_b64 v[106:107], 0
    v_mov_b64 v[108:109], 0
    v_mov_b64 v[110:111], 0
    v_mov_b64 v[112:113], 0
    v_mov_b64 v[114:115], 0
    v_mov_b64 v[116:117], 0
    v_mov_b64 v[118:119], 0
    v_mov_b64 v[120:121], 0
    v_mov_b64 v[122:123], 0
    v_mov_b64 v[124:125], 0
    v_mov_b64 v[126:127], 0
    v_mov_b64 v[128:129], 0
    v_mov_b64 v[130:131], 0
    v_mov_b64 v[132:133], 0
    v_mov_b64 v[134:135], 0
    v_mov_b64 v[136:137], 0
    v_mov_b64 v[138:139], 0
    v_mov_b64 v[140:141], 0
    v_mov_b64 v[142:143], 0
    v_mov_b64 v[144:145], 0
    v_mov_b64 v[146:147], 0
    v_mov_b64 v[148:149], 0
    v_mov_b64 v[150:151], 0
    v_mov_b64 v[152:153], 0
    v_mov_b64 v[154:155], 0
    s_mov_b32 s54, 3
    s_cmp_lg_u32 s30, 0
    s_cbranch_scc1 K_WARMM0
    s_call_b64 s[38:39], WP_attd
    s_call_b64 s[38:39], WP_p2g
    s_branch K_WARMMX
K_WARMM0:
    s_cmp_lg_u32 s30, 1
    s_cbranch_scc1 K_WARMM1
    s_call_b64 s[38:39], WP_atts
    s_call_b64 s[38:39], WP_early
    s_branch K_WARMMX
K_WARMM1:
    s_cmp_lg_u32 s30, 2
    s_cbranch_scc1 K_WARMM2
    s_call_b64 s[38:39], WP_help
    s_call_b64 s[38:39], WP_flags
    s_branch K_WARMMX
K_WARMM2:
    s_call_b64 s[38:39], WP_spin
K_WARMMX:
    s_barrier
    ds_read_b64_tr_b16 v[204:205], v48 offset:40960
    ds_read_b64_tr_b16 v[206:207], v48 offset:41984
    ds_read_b128 v[156:159], v44 offset:40960
    ds_read_b64_tr_b16 v[208:209], v49 offset:40960
    ds_read_b64_tr_b16 v[210:211], v49 offset:41984
    ds_read_b128 v[160:163], v44 offset:43008
    ds_read_b64_tr_b16 v[212:213], v50 offset:40960
    ds_read_b64_tr_b16 v[214:215], v50 offset:41984
    ds_read_b128 v[164:167], v44 offset:45056
    ds_read_b64_tr_b16 v[216:217], v51 offset:40960
    ds_read_b64_tr_b16 v[218:219], v51 offset:41984
    ds_read_b128 v[168:171], v44 offset:47104
    ds_read_b128 v[172:175], v44 offset:49152
    ds_read_b128 v[176:179], v44 offset:51200
K_CLOOP:
    s_waitcnt lgkmcnt(0)
    v_mfma_f32_16x16x32_bf16 v[60:63], v[204:207], v[156:159], v[60:63]
    ds_read_b64_tr_b16 v[220:221], v48 offset:49152
    v_mfma_f32_16x16x32_bf16 v[64:67], v[208:211], v[156:159], v[64:67]
    ds_read_b64_tr_b16 v[222:223], v48 offset:50176
    v_mfma_f32_16x16x32_bf16 v[68:71], v[212:215], v[156:159], v[68:71]
    ds_read_b128 v[180:183], v45 offset:40960
    v_mfma_f32_16x16x32_bf16 v[72:75], v[216:219], v[156:159], v[72:75]
    ds_read_b64_tr_b16 v[224:225], v49 offset:49152
    v_mfma_f32_16x16x32_bf16 v[88:91], v[216:219], v[160:163], v[88:91]
    ds_read_b64_tr_b16 v[226:227], v49 offset:50176
    v_mfma_f32_16x16x32_bf16 v[84:87], v[212:215], v[160:163], v[84:87]
    ds_read_b128 v[184:187], v45 offset:43008
    v_mfma_f32_16x16x32_bf16 v[80:83], v[208:211], v[160:163], v[80:83]
    ds_read_b64_tr_b16 v[228:229], v50 offset:49152
    v_mfma_f32_16x16x32_bf16 v[76:79], v[204:207], v[160:163], v[76:79]
    ds_read_b64_tr_b16 v[230:231], v50 offset:50176
    v_mfma_f32_16x16x32_bf16 v[92:95], v[204:207], v[164:167], v[92:95]
    ds_read_b128 v[188:191], v45 offset:45056
    v_mfma_f32_16x16x32_bf16 v[96:99], v[208:211], v[164:167], v[96:99]
    ds_read_b64_tr_b16 v[232:233], v51 offset:49152
    v_mfma_f32_16x16x32_bf16 v[100:103], v[212:215], v[164:167], v[100:103]
    ds_read_b64_tr_b16 v[234:235], v51 offset:50176
    v_mfma_f32_16x16x32_bf16 v[104:107], v[216:219], v[164:167], v[104:107]
    ds_read_b128 v[192:195], v45 offset:47104
    v_mfma_f32_16x16x32_bf16 v[120:123], v[216:219], v[168:171], v[120:123]
    ds_read_b128 v[196:199], v45 offset:49152
    v_mfma_f32_16x16x32_bf16 v[116:119], v[212:215], v[168:171], v[116:119]
    ds_read_b128 v[200:203], v45 offset:51200
    v_mfma_f32_16x16x32_bf16 v[112:115], v[208:211], v[168:171], v[112:115]
    v_mfma_f32_16x16x32_bf16 v[108:111], v[204:207], v[168:171], v[108:111]
    v_mfma_f32_16x16x32_bf16 v[124:127], v[204:207], v[172:175], v[124:127]
    v_mfma_f32_16x16x32_bf16 v[128:131], v[208:211], v[172:175], v[128:131]
    v_mfma_f32_16x16x32_bf16 v[132:135], v[212:215], v[172:175], v[132:135]
    v_mfma_f32_16x16x32_bf16 v[136:139], v[216:219], v[172:175], v[136:139]
    v_mfma_f32_16x16x32_bf16 v[152:155], v[216:219], v[176:179], v[152:155]
    v_mfma_f32_16x16x32_bf16 v[148:151], v[212:215], v[176:179], v[148:151]
    v_mfma_f32_16x16x32_bf16 v[144:147], v[208:211], v[176:179], v[144:147]
    v_mfma_f32_16x16x32_bf16 v[140:143], v[204:207], v[176:179], v[140:143]
    s_waitcnt lgkmcnt(0)
    s_barrier
    v_mfma_f32_16x16x32_bf16 v[60:63], v[220:223], v[180:183], v[60:63]
    ds_read_b64_tr_b16 v[204:205], v52 offset:0
    v_mfma_f32_16x16x32_bf16 v[64:67], v[224:227], v[180:183], v[64:67]
    ds_read_b64_tr_b16 v[206:207], v52 offset:1024
    v_mfma_f32_16x16x32_bf16 v[68:71], v[228:231], v[180:183], v[68:71]
    ds_read_b128 v[156:159], v46 offset:0
    v_mfma_f32_16x16x32_bf16 v[72:75], v[232:235], v[180:183], v[72:75]
    ds_read_b64_tr_b16 v[208:209], v53 offset:0
    v_mfma_f32_16x16x32_bf16 v[88:91], v[232:235], v[184:187], v[88:91]
    ds_read_b64_tr_b16 v[210:211], v53 offset:1024
    v_mfma_f32_16x16x32_bf16 v[84:87], v[228:231], v[184:187], v[84:87]
    ds_read_b128 v[160:163], v46 offset:2048
    v_mfma_f32_16x16x32_bf16 v[80:83], v[224:227], v[184:187], v[80:83]
    ds_read_b64_tr_b16 v[212:213], v54 offset:0
    v_mfma_f32_16x16x32_bf16 v[76:79], v[220:223], v[184:187], v[76:79]
    ds_read_b64_tr_b16 v[214:215], v54 offset:1024
    v_mfma_f32_16x16x32_bf16 v[92:95], v[220:223], v[188:191], v[92:95]
    ds_read_b128 v[164:167], v46 offset:4096
    v_mfma_f32_16x16x32_bf16 v[96:99], v[224:227], v[188:191], v[96:99]
    ds_read_b64_tr_b16 v[216:217], v55 offset:0
    v_mfma_f32_16x16x32_bf16 v[100:103], v[228:231], v[188:191], v[100:103]
    ds_read_b64_tr_b16 v[218:219], v55 offset:1024
    v_mfma_f32_16x16x32_bf16 v[104:107], v[232:235], v[188:191], v[104:107]
    ds_read_b128 v[168:171], v46 offset:6144
    v_mfma_f32_16x16x32_bf16 v[120:123], v[232:235], v[192:195], v[120:123]
    ds_read_b128 v[172:175], v46 offset:8192
    v_mfma_f32_16x16x32_bf16 v[116:119], v[228:231], v[192:195], v[116:119]
    ds_read_b128 v[176:179], v46 offset:10240
    v_mfma_f32_16x16x32_bf16 v[112:115], v[224:227], v[192:195], v[112:115]
    v_mfma_f32_16x16x32_bf16 v[108:111], v[220:223], v[192:195], v[108:111]
    v_mfma_f32_16x16x32_bf16 v[124:127], v[220:223], v[196:199], v[124:127]
    v_mfma_f32_16x16x32_bf16 v[128:131], v[224:227], v[196:199], v[128:131]
    v_mfma_f32_16x16x32_bf16 v[132:135], v[228:231], v[196:199], v[132:135]
    v_mfma_f32_16x16x32_bf16 v[136:139], v[232:235], v[196:199], v[136:139]
    v_mfma_f32_16x16x32_bf16 v[152:155], v[232:235], v[200:203], v[152:155]
    v_mfma_f32_16x16x32_bf16 v[148:151], v[228:231], v[200:203], v[148:151]
    v_mfma_f32_16x16x32_bf16 v[144:147], v[224:227], v[200:203], v[144:147]
    v_mfma_f32_16x16x32_bf16 v[140:143], v[220:223], v[200:203], v[140:143]
    s_waitcnt lgkmcnt(0)
    v_mfma_f32_16x16x32_bf16 v[60:63], v[204:207], v[156:159], v[60:63]
    ds_read_b64_tr_b16 v[220:221], v52 offset:8192
    v_mfma_f32_16x16x32_bf16 v[64:67], v[208:211], v[156:159], v[64:67]
    ds_read_b64_tr_b16 v[222:223], v52 offset:9216
    v_mfma_f32_16x16x32_bf16 v[68:71], v[212:215], v[156:159], v[68:71]
    ds_read_b128 v[180:183], v47 offset:0
    v_mfma_f32_16x16x32_bf16 v[72:75], v[216:219], v[156:159], v[72:75]
    ds_read_b64_tr_b16 v[224:225], v53 offset:8192
    v_mfma_f32_16x16x32_bf16 v[88:91], v[216:219], v[160:163], v[88:91]
    ds_read_b64_tr_b16 v[226:227], v53 offset:9216
    v_mfma_f32_16x16x32_bf16 v[84:87], v[212:215], v[160:163], v[84:87]
    ds_read_b128 v[184:187], v47 offset:2048
    v_mfma_f32_16x16x32_bf16 v[80:83], v[208:211], v[160:163], v[80:83]
    ds_read_b64_tr_b16 v[228:229], v54 offset:8192
    v_mfma_f32_16x16x32_bf16 v[76:79], v[204:207], v[160:163], v[76:79]
    ds_read_b64_tr_b16 v[230:231], v54 offset:9216
    v_mfma_f32_16x16x32_bf16 v[92:95], v[204:207], v[164:167], v[92:95]
    ds_read_b128 v[188:191], v47 offset:4096
    v_mfma_f32_16x16x32_bf16 v[96:99], v[208:211], v[164:167], v[96:99]
    ds_read_b64_tr_b16 v[232:233], v55 offset:8192
    v_mfma_f32_16x16x32_bf16 v[100:103], v[212:215], v[164:167], v[100:103]
    ds_read_b64_tr_b16 v[234:235], v55 offset:9216
    v_mfma_f32_16x16x32_bf16 v[104:107], v[216:219], v[164:167], v[104:107]
    ds_read_b128 v[192:195], v47 offset:6144
    v_mfma_f32_16x16x32_bf16 v[120:123], v[216:219], v[168:171], v[120:123]
    ds_read_b128 v[196:199], v47 offset:8192
    v_mfma_f32_16x16x32_bf16 v[116:119], v[212:215], v[168:171], v[116:119]
    ds_read_b128 v[200:203], v47 offset:10240
    v_mfma_f32_16x16x32_bf16 v[112:115], v[208:211], v[168:171], v[112:115]
    v_mfma_f32_16x16x32_bf16 v[108:111], v[204:207], v[168:171], v[108:111]
    v_mfma_f32_16x16x32_bf16 v[124:127], v[204:207], v[172:175], v[124:127]
    v_mfma_f32_16x16x32_bf16 v[128:131], v[208:211], v[172:175], v[128:131]
    v_mfma_f32_16x16x32_bf16 v[132:135], v[212:215], v[172:175], v[132:135]
    v_mfma_f32_16x16x32_bf16 v[136:139], v[216:219], v[172:175], v[136:139]
    v_mfma_f32_16x16x32_bf16 v[152:155], v[216:219], v[176:179], v[152:155]
    v_mfma_f32_16x16x32_bf16 v[148:151], v[212:215], v[176:179], v[148:151]
    v_mfma_f32_16x16x32_bf16 v[144:147], v[208:211], v[176:179], v[144:147]
    v_mfma_f32_16x16x32_bf16 v[140:143], v[204:207], v[176:179], v[140:143]
    s_waitcnt lgkmcnt(0)
    s_barrier
    v_mfma_f32_16x16x32_bf16 v[60:63], v[220:223], v[180:183], v[60:63]
    ds_read_b64_tr_b16 v[204:205], v48 offset:0
    v_mfma_f32_16x16x32_bf16 v[64:67], v[224:227], v[180:183], v[64:67]
    ds_read_b64_tr_b16 v[206:207], v48 offset:1024
    v_mfma_f32_16x16x32_bf16 v[68:71], v[228:231], v[180:183], v[68:71]
    ds_read_b128 v[156:159], v44 offset:0
    v_mfma_f32_16x16x32_bf16 v[72:75], v[232:235], v[180:183], v[72:75]
    ds_read_b64_tr_b16 v[208:209], v49 offset:0
    v_mfma_f32_16x16x32_bf16 v[88:91], v[232:235], v[184:187], v[88:91]
    ds_read_b64_tr_b16 v[210:211], v49 offset:1024
    v_mfma_f32_16x16x32_bf16 v[84:87], v[228:231], v[184:187], v[84:87]
    ds_read_b128 v[160:163], v44 offset:2048
    v_mfma_f32_16x16x32_bf16 v[80:83], v[224:227], v[184:187], v[80:83]
    ds_read_b64_tr_b16 v[212:213], v50 offset:0
    v_mfma_f32_16x16x32_bf16 v[76:79], v[220:223], v[184:187], v[76:79]
    ds_read_b64_tr_b16 v[214:215], v50 offset:1024
    v_mfma_f32_16x16x32_bf16 v[92:95], v[220:223], v[188:191], v[92:95]
    ds_read_b128 v[164:167], v44 offset:4096
    v_mfma_f32_16x16x32_bf16 v[96:99], v[224:227], v[188:191], v[96:99]
    ds_read_b64_tr_b16 v[216:217], v51 offset:0
    v_mfma_f32_16x16x32_bf16 v[100:103], v[228:231], v[188:191], v[100:103]
    ds_read_b64_tr_b16 v[218:219], v51 offset:1024
    v_mfma_f32_16x16x32_bf16 v[104:107], v[232:235], v[188:191], v[104:107]
    ds_read_b128 v[168:171], v44 offset:6144
    v_mfma_f32_16x16x32_bf16 v[120:123], v[232:235], v[192:195], v[120:123]
    ds_read_b128 v[172:175], v44 offset:8192
    v_mfma_f32_16x16x32_bf16 v[116:119], v[228:231], v[192:195], v[116:119]
    ds_read_b128 v[176:179], v44 offset:10240
    v_mfma_f32_16x16x32_bf16 v[112:115], v[224:227], v[192:195], v[112:115]
    v_mfma_f32_16x16x32_bf16 v[108:111], v[220:223], v[192:195], v[108:111]
    v_mfma_f32_16x16x32_bf16 v[124:127], v[220:223], v[196:199], v[124:127]
    v_mfma_f32_16x16x32_bf16 v[128:131], v[224:227], v[196:199], v[128:131]
    v_mfma_f32_16x16x32_bf16 v[132:135], v[228:231], v[196:199], v[132:135]
    v_mfma_f32_16x16x32_bf16 v[136:139], v[232:235], v[196:199], v[136:139]
    v_mfma_f32_16x16x32_bf16 v[152:155], v[232:235], v[200:203], v[152:155]
    v_mfma_f32_16x16x32_bf16 v[148:151], v[228:231], v[200:203], v[148:151]
    v_mfma_f32_16x16x32_bf16 v[144:147], v[224:227], v[200:203], v[144:147]
    v_mfma_f32_16x16x32_bf16 v[140:143], v[220:223], v[200:203], v[140:143]
    s_waitcnt lgkmcnt(0)
    v_mfma_f32_16x16x32_bf16 v[60:63], v[204:207], v[156:159], v[60:63]
    ds_read_b64_tr_b16 v[220:221], v48 offset:8192
    v_mfma_f32_16x16x32_bf16 v[64:67], v[208:211], v[156:159], v[64:67]
    ds_read_b64_tr_b16 v[222:223], v48 offset:9216
    v_mfma_f32_16x16x32_bf16 v[68:71], v[212:215], v[156:159], v[68:71]
    ds_read_b128 v[180:183], v45 offset:0
    v_mfma_f32_16x16x32_bf16 v[72:75], v[216:219], v[156:159], v[72:75]
    ds_read_b64_tr_b16 v[224:225], v49 offset:8192
    v_mfma_f32_16x16x32_bf16 v[88:91], v[216:219], v[160:163], v[88:91]
    ds_read_b64_tr_b16 v[226:227], v49 offset:9216
    v_mfma_f32_16x16x32_bf16 v[84:87], v[212:215], v[160:163], v[84:87]
    ds_read_b128 v[184:187], v45 offset:2048
    v_mfma_f32_16x16x32_bf16 v[80:83], v[208:211], v[160:163], v[80:83]
    ds_read_b64_tr_b16 v[228:229], v50 offset:8192
    v_mfma_f32_16x16x32_bf16 v[76:79], v[204:207], v[160:163], v[76:79]
    ds_read_b64_tr_b16 v[230:231], v50 offset:9216
    v_mfma_f32_16x16x32_bf16 v[92:95], v[204:207], v[164:167], v[92:95]
    ds_read_b128 v[188:191], v45 offset:4096
    v_mfma_f32_16x16x32_bf16 v[96:99], v[208:211], v[164:167], v[96:99]
    ds_read_b64_tr_b16 v[232:233], v51 offset:8192
    v_mfma_f32_16x16x32_bf16 v[100:103], v[212:215], v[164:167], v[100:103]
    ds_read_b64_tr_b16 v[234:235], v51 offset:9216
    v_mfma_f32_16x16x32_bf16 v[104:107], v[216:219], v[164:167], v[104:107]
    ds_read_b128 v[192:195], v45 offset:6144
    v_mfma_f32_16x16x32_bf16 v[120:123], v[216:219], v[168:171], v[120:123]
    ds_read_b128 v[196:199], v45 offset:8192
    v_mfma_f32_16x16x32_bf16 v[116:119], v[212:215], v[168:171], v[116:119]
    ds_read_b128 v[200:203], v45 offset:10240
    v_mfma_f32_16x16x32_bf16 v[112:115], v[208:211], v[168:171], v[112:115]
    v_mfma_f32_16x16x32_bf16 v[108:111], v[204:207], v[168:171], v[108:111]
    v_mfma_f32_16x16x32_bf16 v[124:127], v[204:207], v[172:175], v[124:127]
    v_mfma_f32_16x16x32_bf16 v[128:131], v[208:211], v[172:175], v[128:131]
    v_mfma_f32_16x16x32_bf16 v[132:135], v[212:215], v[172:175], v[132:135]
    v_mfma_f32_16x16x32_bf16 v[136:139], v[216:219], v[172:175], v[136:139]
    v_mfma_f32_16x16x32_bf16 v[152:155], v[216:219], v[176:179], v[152:155]
    v_mfma_f32_16x16x32_bf16 v[148:151], v[212:215], v[176:179], v[148:151]
    v_mfma_f32_16x16x32_bf16 v[144:147], v[208:211], v[176:179], v[144:147]
    v_mfma_f32_16x16x32_bf16 v[140:143], v[204:207], v[176:179], v[140:143]
    s_waitcnt lgkmcnt(0)
    s_barrier
    v_mfma_f32_16x16x32_bf16 v[60:63], v[220:223], v[180:183], v[60:63]
    ds_read_b64_tr_b16 v[204:205], v48 offset:40960
    v_mfma_f32_16x16x32_bf16 v[64:67], v[224:227], v[180:183], v[64:67]
    ds_read_b64_tr_b16 v[206:207], v48 offset:41984
    v_mfma_f32_16x16x32_bf16 v[68:71], v[228:231], v[180:183], v[68:71]
    ds_read_b128 v[156:159], v44 offset:40960
    v_mfma_f32_16x16x32_bf16 v[72:75], v[232:235], v[180:183], v[72:75]
    ds_read_b64_tr_b16 v[208:209], v49 offset:40960
    v_mfma_f32_16x16x32_bf16 v[88:91], v[232:235], v[184:187], v[88:91]
    ds_read_b64_tr_b16 v[210:211], v49 offset:41984
    v_mfma_f32_16x16x32_bf16 v[84:87], v[228:231], v[184:187], v[84:87]
    ds_read_b128 v[160:163], v44 offset:43008
    v_mfma_f32_16x16x32_bf16 v[80:83], v[224:227], v[184:187], v[80:83]
    ds_read_b64_tr_b16 v[212:213], v50 offset:40960
    v_mfma_f32_16x16x32_bf16 v[76:79], v[220:223], v[184:187], v[76:79]
    ds_read_b64_tr_b16 v[214:215], v50 offset:41984
    v_mfma_f32_16x16x32_bf16 v[92:95], v[220:223], v[188:191], v[92:95]
    ds_read_b128 v[164:167], v44 offset:45056
    v_mfma_f32_16x16x32_bf16 v[96:99], v[224:227], v[188:191], v[96:99]
    ds_read_b64_tr_b16 v[216:217], v51 offset:40960
    v_mfma_f32_16x16x32_bf16 v[100:103], v[228:231], v[188:191], v[100:103]
    ds_read_b64_tr_b16 v[218:219], v51 offset:41984
    v_mfma_f32_16x16x32_bf16 v[104:107], v[232:235], v[188:191], v[104:107]
    ds_read_b128 v[168:171], v44 offset:47104
    v_mfma_f32_16x16x32_bf16 v[120:123], v[232:235], v[192:195], v[120:123]
    ds_read_b128 v[172:175], v44 offset:49152
    v_mfma_f32_16x16x32_bf16 v[116:119], v[228:231], v[192:195], v[116:119]
    ds_read_b128 v[176:179], v44 offset:51200
    v_mfma_f32_16x16x32_bf16 v[112:115], v[224:227], v[192:195], v[112:115]
    s_sub_u32 s54, s54, 1
    v_mfma_f32_16x16x32_bf16 v[108:111], v[220:223], v[192:195], v[108:111]
    s_cmp_lg_u32 s54, 0
    v_mfma_f32_16x16x32_bf16 v[124:127], v[220:223], v[196:199], v[124:127]
    v_mfma_f32_16x16x32_bf16 v[128:131], v[224:227], v[196:199], v[128:131]
    v_mfma_f32_16x16x32_bf16 v[132:135], v[228:231], v[196:199], v[132:135]
    v_mfma_f32_16x16x32_bf16 v[136:139], v[232:235], v[196:199], v[136:139]
    v_mfma_f32_16x16x32_bf16 v[152:155], v[232:235], v[200:203], v[152:155]
    v_mfma_f32_16x16x32_bf16 v[148:151], v[228:231], v[200:203], v[148:151]
    v_mfma_f32_16x16x32_bf16 v[144:147], v[224:227], v[200:203], v[144:147]
    v_mfma_f32_16x16x32_bf16 v[140:143], v[220:223], v[200:203], v[140:143]
    s_cbranch_scc1 K_CLOOP
    s_waitcnt lgkmcnt(0)
    v_mfma_f32_16x16x32_bf16 v[60:63], v[204:207], v[156:159], v[60:63]
    ds_read_b128 v[180:183], v45 offset:40960
    ds_read_b64_tr_b16 v[220:221], v48 offset:49152
    v_mfma_f32_16x16x32_bf16 v[64:67], v[208:211], v[156:159], v[64:67]
    ds_read_b64_tr_b16 v[222:223], v48 offset:50176
    ds_read_b64_tr_b16 v[224:225], v49 offset:49152
    v_mfma_f32_16x16x32_bf16 v[68:71], v[212:215], v[156:159], v[68:71]
    ds_read_b64_tr_b16 v[226:227], v49 offset:50176
    ds_read_b64_tr_b16 v[228:229], v50 offset:49152
    v_mfma_f32_16x16x32_bf16 v[72:75], v[216:219], v[156:159], v[72:75]
    ds_read_b64_tr_b16 v[230:231], v50 offset:50176
    ds_read_b64_tr_b16 v[232:233], v51 offset:49152
    v_mfma_f32_16x16x32_bf16 v[76:79], v[204:207], v[160:163], v[76:79]
    ds_read_b64_tr_b16 v[234:235], v51 offset:50176
    ds_read_b128 v[184:187], v45 offset:43008
    v_mfma_f32_16x16x32_bf16 v[80:83], v[208:211], v[160:163], v[80:83]
    ds_read_b128 v[188:191], v45 offset:45056
    ds_read_b128 v[192:195], v45 offset:47104
    v_mfma_f32_16x16x32_bf16 v[84:87], v[212:215], v[160:163], v[84:87]
    ds_read_b128 v[196:199], v45 offset:49152
    ds_read_b128 v[200:203], v45 offset:51200
    v_mfma_f32_16x16x32_bf16 v[88:91], v[216:219], v[160:163], v[88:91]
    s_waitcnt lgkmcnt(11)
    v_mfma_f32_16x16x32_bf16 v[60:63], v[220:223], v[180:183], v[60:63]
    s_nop 1
    s_waitcnt lgkmcnt(9)
    v_mfma_f32_16x16x32_bf16 v[64:67], v[224:227], v[180:183], v[64:67]
    s_nop 1
    s_waitcnt lgkmcnt(7)
    v_mfma_f32_16x16x32_bf16 v[68:71], v[228:231], v[180:183], v[68:71]
    v_cvt_pk_bf16_f32 v60, v60, v61
    v_cvt_pk_bf16_f32 v61, v62, v63
    s_waitcnt lgkmcnt(5)
    v_mfma_f32_16x16x32_bf16 v[72:75], v[232:235], v[180:183], v[72:75]
    ds_write_b64 v56, v[60:61] offset:0
    s_waitcnt lgkmcnt(5)
    v_mfma_f32_16x16x32_bf16 v[76:79], v[220:223], v[184:187], v[76:79]
    v_cvt_pk_bf16_f32 v64, v64, v65
    v_cvt_pk_bf16_f32 v65, v66, v67
    v_mfma_f32_16x16x32_bf16 v[80:83], v[224:227], v[184:187], v[80:83]
    ds_write_b64 v56, v[64:65] offset:32
    v_mfma_f32_16x16x32_bf16 v[84:87], v[228:231], v[184:187], v[84:87]
    v_cvt_pk_bf16_f32 v68, v68, v69
    v_cvt_pk_bf16_f32 v69, v70, v71
    v_mfma_f32_16x16x32_bf16 v[88:91], v[232:235], v[184:187], v[88:91]
    ds_write_b64 v56, v[68:69] offset:64
    v_mfma_f32_16x16x32_bf16 v[92:95], v[204:207], v[164:167], v[92:95]
    v_cvt_pk_bf16_f32 v72, v72, v73
    v_cvt_pk_bf16_f32 v73, v74, v75
    v_mfma_f32_16x16x32_bf16 v[96:99], v[208:211], v[164:167], v[96:99]
    ds_write_b64 v56, v[72:73] offset:96
    v_mfma_f32_16x16x32_bf16 v[100:103], v[212:215], v[164:167], v[100:103]
    v_cvt_pk_bf16_f32 v76, v76, v77
    v_cvt_pk_bf16_f32 v77, v78, v79
    v_mfma_f32_16x16x32_bf16 v[104:107], v[216:219], v[164:167], v[104:107]
    ds_write_b64 v56, v[76:77] offset:4352
    s_waitcnt lgkmcnt(8)
    v_mfma_f32_16x16x32_bf16 v[92:95], v[220:223], v[188:191], v[92:95]
    v_cvt_pk_bf16_f32 v80, v80, v81
    v_cvt_pk_bf16_f32 v81, v82, v83
    v_mfma_f32_16x16x32_bf16 v[96:99], v[224:227], v[188:191], v[96:99]
    ds_write_b64 v56, v[80:81] offset:4384
    v_mfma_f32_16x16x32_bf16 v[100:103], v[228:231], v[188:191], v[100:103]
    v_cvt_pk_bf16_f32 v84, v84, v85
    v_cvt_pk_bf16_f32 v85, v86, v87
    v_mfma_f32_16x16x32_bf16 v[104:107], v[232:235], v[188:191], v[104:107]
    ds_write_b64 v56, v[84:85] offset:4416
    v_mfma_f32_16x16x32_bf16 v[108:111], v[204:207], v[168:171], v[108:111]
    v_cvt_pk_bf16_f32 v88, v88, v89
    v_cvt_pk_bf16_f32 v89, v90, v91
    v_mfma_f32_16x16x32_bf16 v[112:115], v[208:211], v[168:171], v[112:115]
    ds_write_b64 v56, v[88:89] offset:4448
    v_mfma_f32_16x16x32_bf16 v[116:119], v[212:215], v[168:171], v[116:119]
    v_cvt_pk_bf16_f32 v92, v92, v93
    v_cvt_pk_bf16_f32 v93, v94, v95
    v_mfma_f32_16x16x32_bf16 v[120:123], v[216:219], v[168:171], v[120:123]
    ds_write_b64 v56, v[92:93] offset:8704
    s_waitcnt lgkmcnt(11)
    v_mfma_f32_16x16x32_bf16 v[108:111], v[220:223], v[192:195], v[108:111]
    v_cvt_pk_bf16_f32 v96, v96, v97
    v_cvt_pk_bf16_f32 v97, v98, v99
    v_mfma_f32_16x16x32_bf16 v[112:115], v[224:227], v[192:195], v[112:115]
    ds_write_b64 v56, v[96:97] offset:8736
    v_mfma_f32_16x16x32_bf16 v[116:119], v[228:231], v[192:195], v[116:119]
    v_cvt_pk_bf16_f32 v100, v100, v101
    v_cvt_pk_bf16_f32 v101, v102, v103
    v_mfma_f32_16x16x32_bf16 v[120:123], v[232:235], v[192:195], v[120:123]
    ds_write_b64 v56, v[100:101] offset:8768
    v_mfma_f32_16x16x32_bf16 v[124:127], v[204:207], v[172:175], v[124:127]
    v_cvt_pk_bf16_f32 v104, v104, v105
    v_cvt_pk_bf16_f32 v105, v106, v107
    v_mfma_f32_16x16x32_bf16 v[128:131], v[208:211], v[172:175], v[128:131]
    ds_write_b64 v56, v[104:105] offset:8800
    v_mfma_f32_16x16x32_bf16 v[132:135], v[212:215], v[172:175], v[132:135]
    v_cvt_pk_bf16_f32 v108, v108, v109
    v_cvt_pk_bf16_f32 v109, v110, v111
    v_mfma_f32_16x16x32_bf16 v[136:139], v[216:219], v[172:175], v[136:139]
    ds_write_b64 v56, v[108:109] offset:13056
    s_waitcnt lgkmcnt(14)
    v_mfma_f32_16x16x32_bf16 v[124:127], v[220:223], v[196:199], v[124:127]
    v_cvt_pk_bf16_f32 v112, v112, v113
    v_cvt_pk_bf16_f32 v113, v114, v115
    v_mfma_f32_16x16x32_bf16 v[128:131], v[224:227], v[196:199], v[128:131]
    ds_write_b64 v56, v[112:113] offset:13088
    v_mfma_f32_16x16x32_bf16 v[132:135], v[228:231], v[196:199], v[132:135]
    v_cvt_pk_bf16_f32 v116, v116, v117
    v_cvt_pk_bf16_f32 v117, v118, v119
    v_mfma_f32_16x16x32_bf16 v[136:139], v[232:235], v[196:199], v[136:139]
    ds_write_b64 v56, v[116:117] offset:13120
    v_mfma_f32_16x16x32_bf16 v[140:143], v[204:207], v[176:179], v[140:143]
    v_cvt_pk_bf16_f32 v120, v120, v121
    v_cvt_pk_bf16_f32 v121, v122, v123
    v_mfma_f32_16x16x32_bf16 v[144:147], v[208:211], v[176:179], v[144:147]
    ds_write_b64 v56, v[120:121] offset:13152
    v_mfma_f32_16x16x32_bf16 v[148:151], v[212:215], v[176:179], v[148:151]
    v_cvt_pk_bf16_f32 v124, v124, v125
    v_cvt_pk_bf16_f32 v125, v126, v127
    v_mfma_f32_16x16x32_bf16 v[152:155], v[216:219], v[176:179], v[152:155]
    ds_write_b64 v56, v[124:125] offset:17408
    s_waitcnt lgkmcnt(15)
    v_mfma_f32_16x16x32_bf16 v[140:143], v[220:223], v[200:203], v[140:143]
    v_cvt_pk_bf16_f32 v128, v128, v129
    v_cvt_pk_bf16_f32 v129, v130, v131
    v_mfma_f32_16x16x32_bf16 v[144:147], v[224:227], v[200:203], v[144:147]
    ds_write_b64 v56, v[128:129] offset:17440
    v_mfma_f32_16x16x32_bf16 v[148:151], v[228:231], v[200:203], v[148:151]
    v_cvt_pk_bf16_f32 v132, v132, v133
    v_cvt_pk_bf16_f32 v133, v134, v135
    v_mfma_f32_16x16x32_bf16 v[152:155], v[232:235], v[200:203], v[152:155]
    ds_write_b64 v56, v[132:133] offset:17472
    v_cvt_pk_bf16_f32 v136, v136, v137
    v_cvt_pk_bf16_f32 v137, v138, v139
    v_cvt_pk_bf16_f32 v140, v140, v141
    v_cvt_pk_bf16_f32 v141, v142, v143
    v_cvt_pk_bf16_f32 v144, v144, v145
    v_cvt_pk_bf16_f32 v145, v146, v147
    v_cvt_pk_bf16_f32 v148, v148, v149
    v_cvt_pk_bf16_f32 v149, v150, v151
    v_cvt_pk_bf16_f32 v152, v152, v153
    v_cvt_pk_bf16_f32 v153, v154, v155
    ds_write_b64 v56, v[136:137] offset:17504
    ds_write_b64 v56, v[140:141] offset:21760
    ds_write_b64 v56, v[144:145] offset:21792
    ds_write_b64 v56, v[148:149] offset:21824
    ds_write_b64 v56, v[152:153] offset:21856
    s_setprio 0
    s_branch WS_attd
.p2align 12
WP_attd:
    s_setpc_b64 s[38:39]
WS_attd:
    s_waitcnt lgkmcnt(0)
    s_barrier
    ds_read_b64 v[60:61], v13 offset:80
    ds_read_b64 v[62:63], v14 offset:80
    ds_read_b64 v[44:45], v13 offset:4352
    ds_read_b64 v[46:47], v19 offset:4352
    ds_read_b64 v[64:65], v13 offset:4432
    ds_read_b64 v[66:67], v14 offset:4432
    ds_read_b64 v[72:73], v13 offset:120
    ds_read_b64 v[74:75], v14 offset:120
    ds_read_b64 v[48:49], v13 offset:4392
    ds_read_b64 v[50:51], v20 offset:4352
    ds_read_b64 v[76:77], v13 offset:4472
    ds_read_b64 v[78:79], v14 offset:4472
    ds_read_b64 v[52:53], v13 offset:8704
    ds_read_b64 v[54:55], v19 offset:8704
    ds_read_b64 v[68:69], v13 offset:8784
    ds_read_b64 v[70:71], v14 offset:8784
    s_waitcnt lgkmcnt(10)
    v_mfma_f32_16x16x32_bf16 v[116:119], v[60:63], v[44:47], v[36:39]
    v_mfma_f32_16x16x32_bf16 v[120:123], v[64:67], v[44:47], v[32:35]
    ds_read_b64 v[56:57], v13 offset:8744
    ds_read_b64 v[58:59], v20 offset:8704
    ds_read_b64 v[80:81], v13 offset:8824
    ds_read_b64 v[82:83], v14 offset:8824
    s_waitcnt lgkmcnt(8)
    v_mfma_f32_16x16x32_bf16 v[124:127], v[72:75], v[48:51], v[36:39]
    v_mfma_f32_16x16x32_bf16 v[128:131], v[76:79], v[48:51], v[32:35]
    s_waitcnt lgkmcnt(4)
    v_mfma_f32_16x16x32_bf16 v[132:135], v[64:67], v[52:55], v[28:31]
    v_mfma_f32_16x16x32_bf16 v[136:139], v[68:71], v[52:55], v[32:35]
    s_waitcnt lgkmcnt(0)
    v_mfma_f32_16x16x32_bf16 v[140:143], v[76:79], v[56:59], v[28:31]
    v_mfma_f32_16x16x32_bf16 v[144:147], v[80:83], v[56:59], v[32:35]
    ds_read_b64_tr_b16 v[84:85], v15 offset:160
    ds_read_b64_tr_b16 v[86:87], v15 offset:4512
    ds_read_b64_tr_b16 v[100:101], v21 offset:0
    ds_read_b64_tr_b16 v[102:103], v21 offset:4352
    v_max3_f32 v184, v116, v117, v120
    ds_read_b64_tr_b16 v[92:93], v15 offset:200
    v_max3_f32 v185, v118, v119, v122
    ds_read_b64_tr_b16 v[94:95], v15 offset:4552
    v_max_f32 v184, v184, v121
    ds_read_b64_tr_b16 v[104:105], v22 offset:0
    v_max_f32 v185, v185, v123
    ds_read_b64_tr_b16 v[106:107], v22 offset:4352
    v_max3_f32 v186, v124, v125, v128
    ds_read_b64_tr_b16 v[88:89], v15 offset:8864
    v_max3_f32 v187, v126, v127, v130
    ds_read_b64_tr_b16 v[108:109], v23 offset:4352
    v_max_f32 v186, v186, v129
    ds_read_b64_tr_b16 v[110:111], v23 offset:8704
    v_max_f32 v187, v187, v131
    ds_read_b64_tr_b16 v[96:97], v15 offset:8904
    v_max3_f32 v188, v132, v133, v136
    ds_read_b64_tr_b16 v[112:113], v24 offset:4352
    v_max3_f32 v189, v134, v135, v138
    ds_read_b64_tr_b16 v[114:115], v24 offset:8704
    v_max_f32 v188, v188, v137
    v_max_f32 v189, v189, v139
    v_max3_f32 v190, v140, v141, v144
    v_max3_f32 v191, v142, v143, v146
    v_max_f32 v190, v190, v145
    v_max_f32 v191, v191, v147
    v_cvt_pk_bf16_f32 v192, v184, v185
    v_cvt_pk_bf16_f32 v193, v186, v187
    v_cvt_pk_bf16_f32 v194, v188, v189
    v_cvt_pk_bf16_f32 v195, v190, v191
    v_lshlrev_b32 v184, 16, v192
    v_and_b32 v185, 0xffff0000, v192
    v_lshlrev_b32 v186, 16, v193
    v_and_b32 v187, 0xffff0000, v193
    v_lshlrev_b32 v188, 16, v194
    v_and_b32 v189, 0xffff0000, v194
    v_lshlrev_b32 v190, 16, v195
    v_and_b32 v191, 0xffff0000, v195
    v_pk_mul_f32 v[184:185], v[184:185], s[48:49]
    v_pk_mul_f32 v[186:187], v[186:187], s[48:49]
    v_pk_mul_f32 v[188:189], v[188:189], s[48:49]
    v_pk_mul_f32 v[190:191], v[190:191], s[48:49]
    v_cvt_pk_bf16_f32 v192, v184, v185
    v_cvt_pk_bf16_f32 v193, v186, v187
    v_cvt_pk_bf16_f32 v194, v188, v189
    v_cvt_pk_bf16_f32 v195, v190, v191
    v_permlane16_swap_b32 v192, v193
    s_nop 0
    v_permlane16_swap_b32 v194, v195
    s_nop 1
    v_permlane32_swap_b32 v192, v194
    v_permlane32_swap_b32 v193, v195
    v_lshlrev_b32 v184, 16, v192
    v_and_b32 v185, 0xffff0000, v192
    v_lshlrev_b32 v188, 16, v194
    v_and_b32 v189, 0xffff0000, v194
    v_lshlrev_b32 v186, 16, v193
    v_and_b32 v187, 0xffff0000, v193
    v_lshlrev_b32 v190, 16, v195
    v_and_b32 v191, 0xffff0000, v195
    v_max3_f32 v196, v184, v185, v188
    v_max3_f32 v197, v189, v186, v187
    v_max3_f32 v196, v196, v190, v191
    v_max_f32 v196, v196, v197
    v_mul_f32 v196, s46, v196
    v_pk_fma_f32 v[184:185], v[184:185], s[46:47], v[196:197] op_sel_hi:[1,1,0] neg_lo:[0,0,1] neg_hi:[0,0,1]
    v_pk_fma_f32 v[186:187], v[186:187], s[46:47], v[196:197] op_sel_hi:[1,1,0] neg_lo:[0,0,1] neg_hi:[0,0,1]
    v_pk_fma_f32 v[188:189], v[188:189], s[46:47], v[196:197] op_sel_hi:[1,1,0] neg_lo:[0,0,1] neg_hi:[0,0,1]
    v_pk_fma_f32 v[190:191], v[190:191], s[46:47], v[196:197] op_sel_hi:[1,1,0] neg_lo:[0,0,1] neg_hi:[0,0,1]
    v_exp_f32 v184, v184
    v_exp_f32 v185, v185
    v_exp_f32 v186, v186
    v_exp_f32 v187, v187
    v_exp_f32 v188, v188
    v_exp_f32 v189, v189
    v_exp_f32 v190, v190
    v_exp_f32 v191, v191
    v_pk_add_f32 v[200:201], v[184:185], v[186:187]
    v_pk_add_f32 v[202:203], v[188:189], v[190:191]
    v_pk_add_f32 v[200:201], v[200:201], v[202:203]
    v_add_f32 v200, v200, v201
    v_rcp_f32 v200, v200
    s_waitcnt lgkmcnt(0)
    v_pk_mul_f32 v[184:185], v[184:185], v[200:201] op_sel_hi:[1,0]
    v_pk_mul_f32 v[186:187], v[186:187], v[200:201] op_sel_hi:[1,0]
    v_pk_mul_f32 v[188:189], v[188:189], v[200:201] op_sel_hi:[1,0]
    v_pk_mul_f32 v[190:191], v[190:191], v[200:201] op_sel_hi:[1,0]
    v_cvt_pk_bf16_f32 v192, v184, v185
    v_cvt_pk_bf16_f32 v194, v188, v189
    v_cvt_pk_bf16_f32 v193, v186, v187
    v_cvt_pk_bf16_f32 v195, v190, v191
    v_permlane32_swap_b32 v192, v194
    s_nop 0
    v_permlane32_swap_b32 v193, v195
    s_nop 1
    v_permlane16_swap_b32 v192, v193
    v_permlane16_swap_b32 v194, v195
    v_perm_b32 v148, v192, v192, v40
    v_perm_b32 v149, v192, v192, v41
    v_perm_b32 v150, v192, v192, v42
    v_perm_b32 v151, v192, v192, v43
    v_perm_b32 v152, v193, v193, v40
    v_perm_b32 v153, v193, v193, v41
    v_perm_b32 v154, v193, v193, v42
    v_perm_b32 v155, v193, v193, v43
    v_mfma_f32_16x16x32_bf16 v[164:167], v[84:87], v[148:151], 0
    v_mfma_f32_16x16x32_bf16 v[180:183], v[100:103], v[148:151], 0
    v_perm_b32 v156, v194, v194, v40
    v_perm_b32 v157, v194, v194, v41
    v_perm_b32 v158, v194, v194, v42
    v_perm_b32 v159, v194, v194, v43
    v_mfma_f32_16x16x32_bf16 v[168:171], v[92:95], v[152:155], 0
    v_mfma_f32_16x16x32_bf16 v[180:183], v[104:107], v[152:155], v[180:183]
    v_perm_b32 v160, v195, v195, v40
    v_perm_b32 v161, v195, v195, v41
    v_perm_b32 v162, v195, v195, v42
    v_perm_b32 v163, v195, v195, v43
    v_mfma_f32_16x16x32_bf16 v[172:175], v[86:89], v[156:159], 0
    v_mfma_f32_16x16x32_bf16 v[180:183], v[108:111], v[156:159], v[180:183]
    v_mfma_f32_16x16x32_bf16 v[176:179], v[94:97], v[160:163], 0
    v_mfma_f32_16x16x32_bf16 v[180:183], v[112:115], v[160:163], v[180:183]
    v_cvt_pk_bf16_f32 v204, v164, v165
    v_cvt_pk_bf16_f32 v205, v166, v167
    v_cvt_pk_bf16_f32 v206, v168, v169
    v_cvt_pk_bf16_f32 v207, v170, v171
    buffer_store_dwordx4 v[204:207], v16, s[20:23], s50 offen sc1
    v_cvt_pk_bf16_f32 v208, v172, v173
    v_cvt_pk_bf16_f32 v209, v174, v175
    v_cvt_pk_bf16_f32 v210, v176, v177
    v_cvt_pk_bf16_f32 v211, v178, v179
    buffer_store_dwordx4 v[208:211], v16, s[20:23], s51 offen sc1
    v_cvt_pk_bf16_f32 v196, v180, v181
    v_cvt_pk_bf16_f32 v197, v182, v183
    buffer_store_dwordx2 v[196:197], v17, s[20:23], s50 offen sc1
    s_cmp_lg_u32 s34, -1
    s_cbranch_scc1 K_P2_EARLY
K_DRAIN:
    s_waitcnt vmcnt(0)
    s_barrier
    s_branch K_END
K_W7A:
    s_waitcnt vmcnt(0)
    v_and_b32 v4, 7, v1
    v_lshlrev_b32 v4, 2, v4
    s_mov_b32 s3, 131072
K_ZPOLL5:
    v_cmp_eq_u32 vcc, 0, v7
    s_cbranch_vccz K_ZOK5
    s_sub_u32 s3, s3, 1
    s_cbranch_scc1 K_ZOK5
    global_load_dword v7, v4, s[8:9] offset:192 sc1
    s_waitcnt vmcnt(0)
    s_branch K_ZPOLL5
K_ZOK5:
    v_mov_b32 v4, 158720
    v_mov_b32 v3, 1
    s_mov_b64 exec, 1
    s_nop 0
    ds_add_rtn_u32 v2, v4, v3 offset:48
    s_mov_b32 exec_lo, s36
    v_mov_b32 v3, 1
    s_waitcnt lgkmcnt(0)
    v_readfirstlane_b32 s33, v2
    s_nop 3
    s_and_b32 s33, s33, 0xff
    s_cmp_lg_u32 s33, 7
    s_cbranch_scc1 K_ARR7
    global_store_dword v8, v3, s[10:11] sc1
K_ARR7:
    s_mov_b64 exec, -1
    s_barrier
    s_branch K_WOE
K_W7:
    v_mov_b32 v3, 0x100
    s_mov_b64 exec, 1
    s_waitcnt vmcnt(0)
    ds_add_u32 v4, v3 offset:48
    s_mov_b64 exec, -1
    s_branch K_P2_HELP
K_FLAG:
    s_waitcnt vmcnt(0)
    v_and_b32 v4, 7, v1
    v_lshlrev_b32 v4, 2, v4
    s_mov_b32 s3, 131072
K_ZPOLL0:
    v_cmp_eq_u32 vcc, 0, v7
    s_cbranch_vccz K_ZOK0
    s_sub_u32 s3, s3, 1
    s_cbranch_scc1 K_ZOK0
    global_load_dword v7, v4, s[8:9] offset:192 sc1
    s_waitcnt vmcnt(0)
    s_branch K_ZPOLL0
K_ZOK0:
    v_mov_b32 v3, 1
    s_mov_b32 exec_lo, s36
    s_mov_b32 exec_hi, 0
    s_setprio 3
    s_barrier
    global_store_dword v8, v3, s[10:11] sc1
    s_mov_b64 exec, -1
    s_branch K_END
WP_atts:
    s_setpc_b64 s[38:39]
K_JOIN_S:
    s_setprio 0
    s_barrier
    s_cmp_eq_u32 s30, 7
    s_cbranch_scc1 K_FLAG
    ds_read_b64 v[52:53], v13 offset:80
    ds_read_b64 v[54:55], v14 offset:80
    ds_read_b64 v[44:45], v13 offset:4352
    ds_read_b64 v[46:47], v19 offset:4352
    ds_read_b64 v[56:57], v13 offset:4432
    ds_read_b64 v[58:59], v14 offset:4432
    ds_read_b64 v[60:61], v13 offset:120
    ds_read_b64 v[62:63], v14 offset:120
    ds_read_b64 v[48:49], v13 offset:4392
    ds_read_b64 v[50:51], v20 offset:4352
    ds_read_b64 v[64:65], v13 offset:4472
    ds_read_b64 v[66:67], v14 offset:4472
    s_waitcnt lgkmcnt(6)
    v_mfma_f32_16x16x32_bf16 v[84:87], v[52:55], v[44:47], v[36:39]
    v_mfma_f32_16x16x32_bf16 v[88:91], v[56:59], v[44:47], v[32:35]
    s_waitcnt lgkmcnt(0)
    v_mfma_f32_16x16x32_bf16 v[92:95], v[60:63], v[48:51], v[36:39]
    v_mfma_f32_16x16x32_bf16 v[96:99], v[64:67], v[48:51], v[32:35]
    ds_read_b64_tr_b16 v[68:69], v15 offset:160
    ds_read_b64_tr_b16 v[70:71], v15 offset:4512
    ds_read_b64_tr_b16 v[76:77], v21 offset:0
    ds_read_b64_tr_b16 v[78:79], v21 offset:4352
    ds_read_b64_tr_b16 v[72:73], v15 offset:200
    ds_read_b64_tr_b16 v[74:75], v15 offset:4552
    ds_read_b64_tr_b16 v[80:81], v22 offset:0
    ds_read_b64_tr_b16 v[82:83], v22 offset:4352
    v_max3_f32 v120, v84, v85, v88
    v_max3_f32 v121, v86, v87, v90
    v_max_f32 v120, v120, v89
    v_max_f32 v121, v121, v91
    v_max3_f32 v122, v92, v93, v96
    v_max3_f32 v123, v94, v95, v98
    v_max_f32 v122, v122, v97
    v_max_f32 v123, v123, v99
    v_cvt_pk_bf16_f32 v124, v120, v121
    v_cvt_pk_bf16_f32 v125, v122, v123
    v_lshlrev_b32 v120, 16, v124
    v_and_b32 v121, 0xffff0000, v124
    v_lshlrev_b32 v122, 16, v125
    v_and_b32 v123, 0xffff0000, v125
    v_pk_mul_f32 v[120:121], v[120:121], s[48:49]
    v_pk_mul_f32 v[122:123], v[122:123], s[48:49]
    v_cvt_pk_bf16_f32 v124, v120, v121
    v_cvt_pk_bf16_f32 v125, v122, v123
    s_nop 1
    v_permlane16_swap_b32 v124, v125
    v_lshlrev_b32 v120, 16, v124
    v_and_b32 v121, 0xffff0000, v124
    v_lshlrev_b32 v122, 16, v125
    v_and_b32 v123, 0xffff0000, v125
    v_max3_f32 v126, v120, v121, v122
    v_max_f32 v126, v126, v123
    v_mov_b32 v127, v126
    s_nop 1
    v_permlane32_swap_b32 v126, v127
    v_max_f32 v126, v126, v127
    v_mul_f32 v126, s46, v126
    v_pk_fma_f32 v[120:121], v[120:121], s[46:47], v[126:127] op_sel_hi:[1,1,0] neg_lo:[0,0,1] neg_hi:[0,0,1]
    v_pk_fma_f32 v[122:123], v[122:123], s[46:47], v[126:127] op_sel_hi:[1,1,0] neg_lo:[0,0,1] neg_hi:[0,0,1]
    v_exp_f32 v120, v120
    v_exp_f32 v121, v121
    v_exp_f32 v122, v122
    v_exp_f32 v123, v123
    s_nop 0
    v_pk_add_f32 v[128:129], v[120:121], v[122:123]
    v_add_f32 v128, v128, v129
    v_mov_b32 v129, v128
    s_nop 1
    v_permlane32_swap_b32 v128, v129
    v_add_f32 v128, v128, v129
    v_rcp_f32 v128, v128
    s_waitcnt lgkmcnt(0)
    v_pk_mul_f32 v[120:121], v[120:121], v[128:129] op_sel_hi:[1,0]
    v_pk_mul_f32 v[122:123], v[122:123], v[128:129] op_sel_hi:[1,0]
    v_cvt_pk_bf16_f32 v124, v120, v121
    v_cvt_pk_bf16_f32 v125, v122, v123
    s_nop 1
    v_permlane16_swap_b32 v124, v125
    v_perm_b32 v100, v124, v124, v40
    v_perm_b32 v101, v124, v124, v41
    v_perm_b32 v102, v124, v124, v42
    v_perm_b32 v103, v124, v124, v43
    v_perm_b32 v104, v125, v125, v40
    v_perm_b32 v105, v125, v125, v41
    v_perm_b32 v106, v125, v125, v42
    v_perm_b32 v107, v125, v125, v43
    v_mfma_f32_16x16x32_bf16 v[108:111], v[68:71], v[100:103], 0
    v_mfma_f32_16x16x32_bf16 v[116:119], v[76:79], v[100:103], 0
    v_mfma_f32_16x16x32_bf16 v[112:115], v[72:75], v[104:107], 0
    v_mfma_f32_16x16x32_bf16 v[116:119], v[80:83], v[104:107], v[116:119]
    s_nop 4
    v_cvt_pk_bf16_f32 v132, v108, v109
    v_cvt_pk_bf16_f32 v133, v110, v111
    v_cvt_pk_bf16_f32 v134, v112, v113
    v_cvt_pk_bf16_f32 v135, v114, v115
    buffer_store_dwordx4 v[132:135], v16, s[20:23], s50 offen sc1
    v_cvt_pk_bf16_f32 v126, v116, v117
    v_cvt_pk_bf16_f32 v127, v118, v119
    buffer_store_dwordx2 v[126:127], v17, s[20:23], s50 offen sc1
    s_cmp_eq_u32 s34, -1
    s_cbranch_scc1 K_DRAIN
    s_cmp_lg_u32 s30, 6
    s_cbranch_scc1 K_NOFL
    s_waitcnt vmcnt(2)
    v_and_b32 v4, 7, v1
    v_lshlrev_b32 v4, 2, v4
    s_mov_b32 s3, 131072
K_ZPOLL2:
    v_cmp_eq_u32 vcc, 0, v7
    s_cbranch_vccz K_ZOK2
    s_sub_u32 s3, s3, 1
    s_cbranch_scc1 K_ZOK2
    global_load_dword v7, v4, s[8:9] offset:192 sc1
    s_waitcnt vmcnt(0)
    s_branch K_ZPOLL2
K_ZOK2:
    v_and_b32 v2, 1, v1
    v_lshl_add_u32 v2, v2, 2, s42
    global_load_dword v7, v2, s[10:11] offset:128 sc1
K_NOFL:
    v_mov_b32 v4, 158720
    v_mov_b32 v3, 257
    s_mov_b64 exec, 1
    s_waitcnt vmcnt(0)
    ds_add_rtn_u32 v2, v4, v3 offset:48
    s_mov_b32 exec_lo, s36
    v_mov_b32 v3, 1
    s_waitcnt lgkmcnt(0)
    v_readfirstlane_b32 s33, v2
    s_nop 3
    s_and_b32 s33, s33, 0xff
    s_cmp_lg_u32 s33, 7
    s_cbranch_scc1 K_ARRS
    global_store_dword v8, v3, s[10:11] sc1
K_ARRS:
    s_mov_b64 exec, -1
    s_cmp_ge_u32 s30, 6
    s_cbranch_scc1 K_P2_HELP
    s_branch K_LATE
WP_early:
    s_setpc_b64 s[38:39]
K_P2_EARLY:
    s_lshl_b32 s54, s40, 7
    v_lshrrev_b32 v9, 4, v1
    v_mov_b32 v12, 158720
    s_add_u32 s20, s10, 0x100000
    s_addc_u32 s21, s11, 0
    s_mov_b32 s22, 0x280000
    s_mov_b32 s23, 0x20000
    s_add_u32 s16, s10, 0x1000
    s_addc_u32 s17, s11, 0
    s_mov_b32 s18, 0x2000
    s_mov_b32 s19, 0x20000
    s_mov_b32 s48, s6
    s_mov_b32 s49, s7
    s_mov_b32 s50, 0x280000
    s_mov_b32 s51, 0x20000
    s_lshl_b32 s53, s40, 3
    s_lshl1_add_u32 s53, s30, s53
    s_mov_b32 s55, 20480
    v_bfe_u32 v20, v1, 2, 2
    v_and_b32 v21, 3, v1
    s_mul_i32 s3, s53, 20480
    v_lshl_add_u32 v25, v1, 4, s3
    v_add_u32 v26, 20480, v25
    v_add_u32 v35, 16384, v25
    v_add_u32 v36, 16384, v26
    v_and_b32 v2, 15, v1
    s_lshl_b32 s3, s53, 6
    v_lshl_add_u32 v23, v2, 2, s3
    v_lshl_add_u32 v2, v9, 2, v20
    v_bfe_u32 v3, v2, 1, 2
    v_lshlrev_b32 v2, 7, v2
    v_lshl_add_u32 v2, v21, 3, v2
    v_lshl_add_u32 v24, v3, 5, v2
    v_lshrrev_b32 v3, 1, v20
    v_mul_u32_u24 v2, 40, v9
    v_add3_u32 v2, v2, 16, v20
    v_lshlrev_b32 v2, 7, v2
    v_lshl_add_u32 v2, v21, 3, v2
    v_xor_b32 v4, 0, v3
    v_lshl_add_u32 v60, v4, 5, v2
    v_xor_b32 v4, 1, v3
    v_lshl_add_u32 v61, v4, 5, v2
    v_xor_b32 v4, 2, v3
    v_lshl_add_u32 v62, v4, 5, v2
    v_xor_b32 v4, 3, v3
    v_lshl_add_u32 v63, v4, 5, v2
    v_lshrrev_b32 v3, 4, v1
    v_and_b32 v4, 7, v1
    v_lshrrev_b32 v2, 3, v1
    v_xor_b32 v4, v4, v3
    v_mul_u32_u24 v2, 1280, v2
    v_lshl_add_u32 v27, v4, 4, v2
    v_xor_b32 v28, 64, v27
    s_lshl_b32 s71, s40, 3
    s_lshl1_add_u32 s71, s30, s71
    s_mul_i32 s71, s71, 20480
    s_lshl_b32 s33, s41, 7
    s_add_u32 s71, s71, s33
    s_add_u32 s72, s71, 10240
    s_add_u32 s73, s71, 20480
    s_add_u32 s74, s71, 30720
    s_lshl_b32 s3, s30, 12
    s_add_u32 s3, s3, 140288
    v_lshl_add_u32 v33, v1, 4, s3
    v_and_b32 v2, 15, v1
    v_lshrrev_b32 v3, 1, v2
    v_lshrrev_b32 v4, 5, v1
    v_xor_b32 v3, v3, v4
    v_lshlrev_b32 v3, 4, v3
    v_lshl_add_u32 v3, v2, 7, v3
    v_and_b32 v4, 1, v9
    v_lshl_add_u32 v3, v4, 3, v3
    v_add_u32 v29, s3, v3
    v_xor_b32 v30, 32, v29
    v_xor_b32 v31, 64, v29
    v_xor_b32 v32, 96, v29
    s_and_b32 s33, s40, 3
    s_lshl_b32 s33, s33, 3
    s_lshr_b32 s33, 0x7f06037f, s33
    s_and_b32 s33, s33, 0xff
    s_lshl_b32 s3, s30, 1
    s_cmp_ge_u32 s3, s33
    s_cselect_b32 s64, 16, 0
    s_add_u32 s3, s3, 1
    s_cmp_ge_u32 s3, s33
    s_cselect_b32 s65, 16, 0
    s_mov_b32 s63, 0
    s_mov_b32 s66, 0
    s_mov_b32 s67, 16384
    v_mov_b32 v34, 0
    v_mov_b32 v4, 158720
    v_mov_b32 v3, 1
    s_mov_b64 exec, 1
    s_waitcnt vmcnt(0)
    ds_add_rtn_u32 v2, v4, v3 offset:48
    s_mov_b32 exec_lo, s36
    v_mov_b32 v3, 1
    s_waitcnt lgkmcnt(0)
    v_readfirstlane_b32 s33, v2
    s_nop 3
    s_and_b32 s33, s33, 0xff
    s_cmp_lg_u32 s33, 7
    s_cbranch_scc1 K_ARRD
    global_store_dword v8, v3, s[10:11] sc1
K_ARRD:
    s_mov_b64 exec, -1
    s_mov_b32 s3, 1048576
K_P2_GE:
    ds_read_b32 v2, v12 offset:48
    s_sub_u32 s3, s3, 1
    s_waitcnt lgkmcnt(0)
    v_readfirstlane_b32 s33, v2
    s_nop 3
    s_cselect_b32 s33, 1024, s33
    s_cmp_lt_u32 s33, 1024
    s_cbranch_scc1 K_P2_GE
K_P2_GEMM:
    s_setprio 0
    s_mov_b32 s3, 1048576
K_P2_GS:
    ds_read_b32 v2, v12 offset:40
    s_sub_u32 s3, s3, 1
    s_waitcnt lgkmcnt(0)
    v_readfirstlane_b32 s33, v2
    s_nop 3
    s_cselect_b32 s33, 1, s33
    s_cmp_lt_u32 s33, 1
    s_cbranch_scc1 K_P2_GS
    buffer_load_dword v64, v23, s[16:19], 0 offen offset:0 sc1
    buffer_load_dword v66, v23, s[16:19], 0 offen offset:64 sc1
    ds_read_b128 v[16:19], v12
    ds_read_b64 v[40:41], v29 offset:0
    ds_read_b64 v[42:43], v30 offset:0
    ds_read_b64 v[44:45], v31 offset:0
    ds_read_b64 v[46:47], v32 offset:0
    ds_read_b64 v[48:49], v29 offset:2048
    ds_read_b64 v[50:51], v30 offset:2048
    ds_read_b64 v[52:53], v31 offset:2048
    ds_read_b64 v[54:55], v32 offset:2048
    s_waitcnt lgkmcnt(4)
    v_lshlrev_b32 v72, 16, v40
    v_and_b32 v73, 0xffff0000, v40
    v_lshlrev_b32 v74, 16, v41
    v_and_b32 v75, 0xffff0000, v41
    v_lshlrev_b32 v76, 16, v42
    v_and_b32 v77, 0xffff0000, v42
    v_lshlrev_b32 v78, 16, v43
    v_and_b32 v79, 0xffff0000, v43
    v_lshlrev_b32 v80, 16, v44
    v_and_b32 v81, 0xffff0000, v44
    v_lshlrev_b32 v82, 16, v45
    v_and_b32 v83, 0xffff0000, v45
    v_lshlrev_b32 v84, 16, v46
    v_and_b32 v85, 0xffff0000, v46
    v_lshlrev_b32 v86, 16, v47
    v_and_b32 v87, 0xffff0000, v47
    s_waitcnt lgkmcnt(0)
    v_lshlrev_b32 v88, 16, v48
    v_and_b32 v89, 0xffff0000, v48
    v_lshlrev_b32 v90, 16, v49
    v_and_b32 v91, 0xffff0000, v49
    v_lshlrev_b32 v92, 16, v50
    v_and_b32 v93, 0xffff0000, v50
    v_lshlrev_b32 v94, 16, v51
    v_and_b32 v95, 0xffff0000, v51
    v_lshlrev_b32 v96, 16, v52
    v_and_b32 v97, 0xffff0000, v52
    v_lshlrev_b32 v98, 16, v53
    v_and_b32 v99, 0xffff0000, v53
    v_lshlrev_b32 v100, 16, v54
    v_and_b32 v101, 0xffff0000, v54
    v_lshlrev_b32 v102, 16, v55
    v_and_b32 v103, 0xffff0000, v55
    s_cmp_eq_u32 s63, 0
    s_cbranch_scc1 K_SP0
K_SPR0:
    s_ff1_i32_b32 s33, s63
    s_bitset0_b32 s63, s33
    s_lshl_b32 s75, s33, 10
    buffer_load_dwordx4 v[104:107], v25, s[20:23], s75 offen offset:0 sc1
    buffer_load_dwordx4 v[108:111], v26, s[20:23], s75 offen offset:0 sc1
    v_mad_u32_u24 v56, s75, 5, v24
    v_xor_b32 v58, 64, v56
    v_xor_b32 v57, 32, v56
    v_xor_b32 v59, 96, v56
    ds_read_b64_tr_b16 v[184:185], v56 offset:0
    ds_read_b64_tr_b16 v[186:187], v58 offset:2560
    ds_read_b64_tr_b16 v[188:189], v57 offset:0
    ds_read_b64_tr_b16 v[190:191], v59 offset:2560
    ds_read_b64_tr_b16 v[192:193], v58 offset:0
    ds_read_b64_tr_b16 v[194:195], v56 offset:2560
    ds_read_b64_tr_b16 v[196:197], v59 offset:0
    ds_read_b64_tr_b16 v[198:199], v57 offset:2560
    s_cmp_eq_u32 s63, 0
    s_cbranch_scc1 K_SP1
K_SPR1:
    s_ff1_i32_b32 s33, s63
    s_bitset0_b32 s63, s33
    s_lshl_b32 s76, s33, 10
    buffer_load_dwordx4 v[112:115], v25, s[20:23], s76 offen offset:0 sc1
    buffer_load_dwordx4 v[116:119], v26, s[20:23], s76 offen offset:0 sc1
    v_mad_u32_u24 v56, s76, 5, v24
    v_xor_b32 v58, 64, v56
    v_xor_b32 v57, 32, v56
    v_xor_b32 v59, 96, v56
    ds_read_b64_tr_b16 v[200:201], v56 offset:0
    ds_read_b64_tr_b16 v[202:203], v58 offset:2560
    ds_read_b64_tr_b16 v[204:205], v57 offset:0
    ds_read_b64_tr_b16 v[206:207], v59 offset:2560
    ds_read_b64_tr_b16 v[208:209], v58 offset:0
    ds_read_b64_tr_b16 v[210:211], v56 offset:2560
    ds_read_b64_tr_b16 v[212:213], v59 offset:0
    ds_read_b64_tr_b16 v[214:215], v57 offset:2560
    s_waitcnt vmcnt(4)
    s_mov_b64 exec, 1
    ds_add_u32 v12, v34 offset:44
    s_mov_b64 exec, -1
    v_sub_f32 v68, 1.0, v64
    v_cvt_pk_bf16_f32 v68, v68, v68
    v_lshlrev_b32 v68, 16, v68
    v_sub_f32 v70, 1.0, v66
    v_cvt_pk_bf16_f32 v70, v70, v70
    v_lshlrev_b32 v70, 16, v70
    v_pk_mul_f32 v[72:73], v[72:73], v[68:69] op_sel_hi:[1,0]
    v_pk_mul_f32 v[74:75], v[74:75], v[68:69] op_sel_hi:[1,0]
    v_pk_mul_f32 v[76:77], v[76:77], v[68:69] op_sel_hi:[1,0]
    v_pk_mul_f32 v[78:79], v[78:79], v[68:69] op_sel_hi:[1,0]
    v_pk_mul_f32 v[80:81], v[80:81], v[68:69] op_sel_hi:[1,0]
    v_pk_mul_f32 v[82:83], v[82:83], v[68:69] op_sel_hi:[1,0]
    v_pk_mul_f32 v[84:85], v[84:85], v[68:69] op_sel_hi:[1,0]
    v_pk_mul_f32 v[86:87], v[86:87], v[68:69] op_sel_hi:[1,0]
    v_pk_mul_f32 v[88:89], v[88:89], v[70:71] op_sel_hi:[1,0]
    v_pk_mul_f32 v[90:91], v[90:91], v[70:71] op_sel_hi:[1,0]
    v_pk_mul_f32 v[92:93], v[92:93], v[70:71] op_sel_hi:[1,0]
    v_pk_mul_f32 v[94:95], v[94:95], v[70:71] op_sel_hi:[1,0]
    v_pk_mul_f32 v[96:97], v[96:97], v[70:71] op_sel_hi:[1,0]
    v_pk_mul_f32 v[98:99], v[98:99], v[70:71] op_sel_hi:[1,0]
    v_pk_mul_f32 v[100:101], v[100:101], v[70:71] op_sel_hi:[1,0]
    v_pk_mul_f32 v[102:103], v[102:103], v[70:71] op_sel_hi:[1,0]
    s_cmp_eq_u32 s63, 0
    s_cbranch_scc1 K_SP2
K_SPR2:
    s_ff1_i32_b32 s33, s63
    s_bitset0_b32 s63, s33
    s_lshl_b32 s77, s33, 10
    buffer_load_dwordx4 v[120:123], v25, s[20:23], s77 offen offset:0 sc1
    buffer_load_dwordx4 v[124:127], v26, s[20:23], s77 offen offset:0 sc1
    s_cmp_eq_u32 s63, 0
    s_cbranch_scc1 K_SP3
K_SPR3:
    s_ff1_i32_b32 s33, s63
    s_bitset0_b32 s63, s33
    s_lshl_b32 s78, s33, 10
    buffer_load_dwordx4 v[128:131], v25, s[20:23], s78 offen offset:0 sc1
    buffer_load_dwordx4 v[132:135], v26, s[20:23], s78 offen offset:0 sc1
    s_cmp_eq_u32 s63, 0
    s_cbranch_scc1 K_SP4
K_SPR4:
    s_ff1_i32_b32 s33, s63
    s_bitset0_b32 s63, s33
    s_lshl_b32 s75, s33, 10
    buffer_load_dwordx4 v[136:139], v25, s[20:23], s75 offen offset:0 sc1
    buffer_load_dwordx4 v[140:143], v26, s[20:23], s75 offen offset:0 sc1
    s_branch WS_p2g
.p2align 12
WP_p2g:
    s_setpc_b64 s[38:39]
WS_p2g:
    s_waitcnt vmcnt(8) lgkmcnt(9)
    v_mfma_f32_16x16x32_bf16 v[152:155], v[184:187], v[104:107], 0
    v_mad_u32_u24 v56, s77, 5, v24
    v_xor_b32 v58, 64, v56
    v_xor_b32 v57, 32, v56
    v_mfma_f32_16x16x32_bf16 v[168:171], v[184:187], v[108:111], 0
    v_xor_b32 v59, 96, v56
    ds_read_b64_tr_b16 v[216:217], v56 offset:0
    ds_read_b64_tr_b16 v[218:219], v58 offset:2560
    v_mfma_f32_16x16x32_bf16 v[156:159], v[188:191], v[104:107], 0
    ds_read_b64_tr_b16 v[220:221], v57 offset:0
    ds_read_b64_tr_b16 v[222:223], v59 offset:2560
    ds_read_b64_tr_b16 v[224:225], v58 offset:0
    v_mfma_f32_16x16x32_bf16 v[172:175], v[188:191], v[108:111], 0
    ds_read_b64_tr_b16 v[226:227], v56 offset:2560
    ds_read_b64_tr_b16 v[228:229], v59 offset:0
    v_mfma_f32_16x16x32_bf16 v[160:163], v[192:195], v[104:107], 0
    ds_read_b64_tr_b16 v[230:231], v57 offset:2560
    s_cmp_eq_u32 s63, 0
    v_mfma_f32_16x16x32_bf16 v[176:179], v[192:195], v[108:111], 0
    s_cbranch_scc1 K_SP5
K_SPR5:
    s_ff1_i32_b32 s33, s63
    v_mfma_f32_16x16x32_bf16 v[164:167], v[196:199], v[104:107], 0
    s_bitset0_b32 s63, s33
    s_lshl_b32 s76, s33, 10
    v_mfma_f32_16x16x32_bf16 v[180:183], v[196:199], v[108:111], 0
    buffer_load_dwordx4 v[144:147], v25, s[20:23], s76 offen offset:0 sc1
    buffer_load_dwordx4 v[148:151], v26, s[20:23], s76 offen offset:0 sc1
    s_waitcnt vmcnt(8) lgkmcnt(9)
    v_mfma_f32_16x16x32_bf16 v[152:155], v[200:203], v[112:115], v[152:155]
    v_mad_u32_u24 v56, s78, 5, v24
    v_xor_b32 v58, 64, v56
    v_xor_b32 v57, 32, v56
    v_mfma_f32_16x16x32_bf16 v[168:171], v[200:203], v[116:119], v[168:171]
    v_xor_b32 v59, 96, v56
    ds_read_b64_tr_b16 v[184:185], v56 offset:0
    ds_read_b64_tr_b16 v[186:187], v58 offset:2560
    v_mfma_f32_16x16x32_bf16 v[156:159], v[204:207], v[112:115], v[156:159]
    ds_read_b64_tr_b16 v[188:189], v57 offset:0
    ds_read_b64_tr_b16 v[190:191], v59 offset:2560
    ds_read_b64_tr_b16 v[192:193], v58 offset:0
    v_mfma_f32_16x16x32_bf16 v[172:175], v[204:207], v[116:119], v[172:175]
    ds_read_b64_tr_b16 v[194:195], v56 offset:2560
    ds_read_b64_tr_b16 v[196:197], v59 offset:0
    v_mfma_f32_16x16x32_bf16 v[160:163], v[208:211], v[112:115], v[160:163]
    ds_read_b64_tr_b16 v[198:199], v57 offset:2560
    s_cmp_eq_u32 s63, 0
    v_mfma_f32_16x16x32_bf16 v[176:179], v[208:211], v[116:119], v[176:179]
    s_cbranch_scc1 K_SP6
K_SPR6:
    s_ff1_i32_b32 s33, s63
    v_mfma_f32_16x16x32_bf16 v[164:167], v[212:215], v[112:115], v[164:167]
    s_bitset0_b32 s63, s33
    s_lshl_b32 s77, s33, 10
    v_mfma_f32_16x16x32_bf16 v[180:183], v[212:215], v[116:119], v[180:183]
    buffer_load_dwordx4 v[104:107], v25, s[20:23], s77 offen offset:0 sc1
    buffer_load_dwordx4 v[108:111], v26, s[20:23], s77 offen offset:0 sc1
    s_waitcnt vmcnt(8) lgkmcnt(8)
    v_mfma_f32_16x16x32_bf16 v[152:155], v[216:219], v[120:123], v[152:155]
    v_mad_u32_u24 v56, s75, 5, v24
    v_xor_b32 v58, 64, v56
    v_xor_b32 v57, 32, v56
    v_mfma_f32_16x16x32_bf16 v[168:171], v[216:219], v[124:127], v[168:171]
    v_xor_b32 v59, 96, v56
    ds_read_b64_tr_b16 v[200:201], v56 offset:0
    ds_read_b64_tr_b16 v[202:203], v58 offset:2560
    v_mfma_f32_16x16x32_bf16 v[156:159], v[220:223], v[120:123], v[156:159]
    ds_read_b64_tr_b16 v[204:205], v57 offset:0
    ds_read_b64_tr_b16 v[206:207], v59 offset:2560
    ds_read_b64_tr_b16 v[208:209], v58 offset:0
    v_mfma_f32_16x16x32_bf16 v[172:175], v[220:223], v[124:127], v[172:175]
    ds_read_b64_tr_b16 v[210:211], v56 offset:2560
    ds_read_b64_tr_b16 v[212:213], v59 offset:0
    v_mfma_f32_16x16x32_bf16 v[160:163], v[224:227], v[120:123], v[160:163]
    ds_read_b64_tr_b16 v[214:215], v57 offset:2560
    s_andn2_b32 s33, s66, s63
    v_mfma_f32_16x16x32_bf16 v[176:179], v[224:227], v[124:127], v[176:179]
    s_bfe_u32 s33, s33, 0x40000
    s_cmp_eq_u32 s33, 15
    v_mfma_f32_16x16x32_bf16 v[164:167], v[228:231], v[120:123], v[164:167]
    s_cselect_b32 s78, 0, 1024
    s_xor_b32 s69, s78, 1024
    v_mfma_f32_16x16x32_bf16 v[180:183], v[228:231], v[124:127], v[180:183]
    buffer_load_dwordx4 v[112:115], v35, s[20:23], s78 offen offset:0 sc1
    buffer_load_dwordx4 v[116:119], v36, s[20:23], s78 offen offset:0 sc1
    s_waitcnt vmcnt(8) lgkmcnt(8)
    v_mfma_f32_16x16x32_bf16 v[152:155], v[184:187], v[128:131], v[152:155]
    v_mad_u32_u24 v56, s76, 5, v24
    v_xor_b32 v58, 64, v56
    v_xor_b32 v57, 32, v56
    v_mfma_f32_16x16x32_bf16 v[168:171], v[184:187], v[132:135], v[168:171]
    v_xor_b32 v59, 96, v56
    ds_read_b64_tr_b16 v[216:217], v56 offset:0
    ds_read_b64_tr_b16 v[218:219], v58 offset:2560
    v_mfma_f32_16x16x32_bf16 v[156:159], v[188:191], v[128:131], v[156:159]
    ds_read_b64_tr_b16 v[220:221], v57 offset:0
    ds_read_b64_tr_b16 v[222:223], v59 offset:2560
    ds_read_b64_tr_b16 v[224:225], v58 offset:0
    v_mfma_f32_16x16x32_bf16 v[172:175], v[188:191], v[132:135], v[172:175]
    ds_read_b64_tr_b16 v[226:227], v56 offset:2560
    ds_read_b64_tr_b16 v[228:229], v59 offset:0
    v_mfma_f32_16x16x32_bf16 v[160:163], v[192:195], v[128:131], v[160:163]
    ds_read_b64_tr_b16 v[230:231], v57 offset:2560
    s_cmp_eq_u32 s63, 0
    v_mfma_f32_16x16x32_bf16 v[176:179], v[192:195], v[132:135], v[176:179]
    s_cbranch_scc1 K_SP8
K_SPR8:
    s_ff1_i32_b32 s33, s63
    v_mfma_f32_16x16x32_bf16 v[164:167], v[196:199], v[128:131], v[164:167]
    s_bitset0_b32 s63, s33
    s_lshl_b32 s75, s33, 10
    v_mfma_f32_16x16x32_bf16 v[180:183], v[196:199], v[132:135], v[180:183]
    buffer_load_dwordx4 v[120:123], v25, s[20:23], s75 offen offset:0 sc1
    buffer_load_dwordx4 v[124:127], v26, s[20:23], s75 offen offset:0 sc1
    s_waitcnt vmcnt(8) lgkmcnt(8)
    v_mfma_f32_16x16x32_bf16 v[152:155], v[200:203], v[136:139], v[152:155]
    v_mad_u32_u24 v56, s77, 5, v24
    v_xor_b32 v58, 64, v56
    v_mfma_f32_16x16x32_bf16 v[168:171], v[200:203], v[140:143], v[168:171]
    v_xor_b32 v57, 32, v56
    v_xor_b32 v59, 96, v56
    v_mfma_f32_16x16x32_bf16 v[156:159], v[204:207], v[136:139], v[156:159]
    ds_read_b64_tr_b16 v[184:185], v56 offset:0
    ds_read_b64_tr_b16 v[186:187], v58 offset:2560
    v_mfma_f32_16x16x32_bf16 v[172:175], v[204:207], v[140:143], v[172:175]
    ds_read_b64_tr_b16 v[188:189], v57 offset:0
    ds_read_b64_tr_b16 v[190:191], v59 offset:2560
    v_mfma_f32_16x16x32_bf16 v[160:163], v[208:211], v[136:139], v[160:163]
    ds_read_b64_tr_b16 v[192:193], v58 offset:0
    ds_read_b64_tr_b16 v[194:195], v56 offset:2560
    v_mfma_f32_16x16x32_bf16 v[176:179], v[208:211], v[140:143], v[176:179]
    ds_read_b64_tr_b16 v[196:197], v59 offset:0
    ds_read_b64_tr_b16 v[198:199], v57 offset:2560
    v_mfma_f32_16x16x32_bf16 v[164:167], v[212:215], v[136:139], v[164:167]
    buffer_load_dwordx4 v[128:131], v35, s[20:23], s69 offen offset:0 sc1
    buffer_load_dwordx4 v[132:135], v36, s[20:23], s69 offen offset:0 sc1
    v_mfma_f32_16x16x32_bf16 v[180:183], v[212:215], v[140:143], v[180:183]
    s_waitcnt vmcnt(8) lgkmcnt(8)
    v_mfma_f32_16x16x32_bf16 v[152:155], v[216:219], v[144:147], v[152:155]
    v_mad_u32_u24 v56, s78, 20, v60
    v_xor_b32 v58, 64, v56
    v_xor_b32 v57, 32, v56
    v_mfma_f32_16x16x32_bf16 v[168:171], v[216:219], v[148:151], v[168:171]
    v_xor_b32 v59, 96, v56
    ds_read_b64_tr_b16 v[200:201], v56 offset:0
    ds_read_b64_tr_b16 v[202:203], v58 offset:2560
    v_mfma_f32_16x16x32_bf16 v[156:159], v[220:223], v[144:147], v[156:159]
    ds_read_b64_tr_b16 v[204:205], v57 offset:0
    ds_read_b64_tr_b16 v[206:207], v59 offset:2560
    ds_read_b64_tr_b16 v[208:209], v58 offset:0
    v_mfma_f32_16x16x32_bf16 v[172:175], v[220:223], v[148:151], v[172:175]
    ds_read_b64_tr_b16 v[210:211], v56 offset:2560
    ds_read_b64_tr_b16 v[212:213], v59 offset:0
    v_mfma_f32_16x16x32_bf16 v[160:163], v[224:227], v[144:147], v[160:163]
    ds_read_b64_tr_b16 v[214:215], v57 offset:2560
    s_cmp_eq_u32 s63, 0
    v_mfma_f32_16x16x32_bf16 v[176:179], v[224:227], v[148:151], v[176:179]
    s_cbranch_scc1 K_SP10
K_SPR10:
    s_ff1_i32_b32 s33, s63
    v_mfma_f32_16x16x32_bf16 v[164:167], v[228:231], v[144:147], v[164:167]
    s_bitset0_b32 s63, s33
    s_lshl_b32 s77, s33, 10
    v_mfma_f32_16x16x32_bf16 v[180:183], v[228:231], v[148:151], v[180:183]
    buffer_load_dwordx4 v[136:139], v25, s[20:23], s77 offen offset:0 sc1
    buffer_load_dwordx4 v[140:143], v26, s[20:23], s77 offen offset:0 sc1
    s_waitcnt vmcnt(8) lgkmcnt(8)
    v_mfma_f32_16x16x32_bf16 v[152:155], v[184:187], v[104:107], v[152:155]
    v_mad_u32_u24 v56, s75, 5, v24
    v_xor_b32 v58, 64, v56
    v_xor_b32 v57, 32, v56
    v_mfma_f32_16x16x32_bf16 v[168:171], v[184:187], v[108:111], v[168:171]
    v_xor_b32 v59, 96, v56
    ds_read_b64_tr_b16 v[216:217], v56 offset:0
    ds_read_b64_tr_b16 v[218:219], v58 offset:2560
    v_mfma_f32_16x16x32_bf16 v[156:159], v[188:191], v[104:107], v[156:159]
    ds_read_b64_tr_b16 v[220:221], v57 offset:0
    ds_read_b64_tr_b16 v[222:223], v59 offset:2560
    ds_read_b64_tr_b16 v[224:225], v58 offset:0
    v_mfma_f32_16x16x32_bf16 v[172:175], v[188:191], v[108:111], v[172:175]
    ds_read_b64_tr_b16 v[226:227], v56 offset:2560
    ds_read_b64_tr_b16 v[228:229], v59 offset:0
    v_mfma_f32_16x16x32_bf16 v[160:163], v[192:195], v[104:107], v[160:163]
    ds_read_b64_tr_b16 v[230:231], v57 offset:2560
    s_cmp_eq_u32 s63, 0
    v_mfma_f32_16x16x32_bf16 v[176:179], v[192:195], v[108:111], v[176:179]
    s_cbranch_scc1 K_SP11
K_SPR11:
    s_ff1_i32_b32 s33, s63
    v_mfma_f32_16x16x32_bf16 v[164:167], v[196:199], v[104:107], v[164:167]
    s_bitset0_b32 s63, s33
    s_lshl_b32 s78, s33, 10
    v_mfma_f32_16x16x32_bf16 v[180:183], v[196:199], v[108:111], v[180:183]
    buffer_load_dwordx4 v[144:147], v25, s[20:23], s78 offen offset:0 sc1
    buffer_load_dwordx4 v[148:151], v26, s[20:23], s78 offen offset:0 sc1
    s_waitcnt vmcnt(8) lgkmcnt(8)
    v_mfma_f32_16x16x32_bf16 v[152:155], v[200:203], v[112:115], v[152:155]
    v_mad_u32_u24 v56, s69, 20, v60
    v_xor_b32 v58, 64, v56
    v_xor_b32 v57, 32, v56
    v_mfma_f32_16x16x32_bf16 v[168:171], v[200:203], v[116:119], v[168:171]
    v_xor_b32 v59, 96, v56
    ds_read_b64_tr_b16 v[184:185], v56 offset:0
    ds_read_b64_tr_b16 v[186:187], v58 offset:2560
    v_mfma_f32_16x16x32_bf16 v[156:159], v[204:207], v[112:115], v[156:159]
    ds_read_b64_tr_b16 v[188:189], v57 offset:0
    ds_read_b64_tr_b16 v[190:191], v59 offset:2560
    ds_read_b64_tr_b16 v[192:193], v58 offset:0
    v_mfma_f32_16x16x32_bf16 v[172:175], v[204:207], v[116:119], v[172:175]
    ds_read_b64_tr_b16 v[194:195], v56 offset:2560
    ds_read_b64_tr_b16 v[196:197], v59 offset:0
    v_mfma_f32_16x16x32_bf16 v[160:163], v[208:211], v[112:115], v[160:163]
    ds_read_b64_tr_b16 v[198:199], v57 offset:2560
    s_cmp_eq_u32 s63, 0
    v_mfma_f32_16x16x32_bf16 v[176:179], v[208:211], v[116:119], v[176:179]
    s_cbranch_scc1 K_SP12
K_SPR12:
    s_ff1_i32_b32 s33, s63
    v_mfma_f32_16x16x32_bf16 v[164:167], v[212:215], v[112:115], v[164:167]
    s_bitset0_b32 s63, s33
    s_lshl_b32 s75, s33, 10
    v_mfma_f32_16x16x32_bf16 v[180:183], v[212:215], v[116:119], v[180:183]
    buffer_load_dwordx4 v[104:107], v25, s[20:23], s75 offen offset:0 sc1
    buffer_load_dwordx4 v[108:111], v26, s[20:23], s75 offen offset:0 sc1
    s_mov_b32 s3, 1048576
K_P2_GW:
    ds_read_b32 v2, v12 offset:44
    s_sub_u32 s3, s3, 1
    s_waitcnt lgkmcnt(0)
    v_readfirstlane_b32 s33, v2
    s_nop 3
    s_cselect_b32 s33, 4, s33
    s_cmp_lt_u32 s33, 4
    s_cbranch_scc1 K_P2_GW
    v_readfirstlane_b32 s56, v16
    v_readfirstlane_b32 s57, v17
    s_lshl_b32 s58, s53, 4
    s_waitcnt vmcnt(8)
    v_mfma_f32_16x16x32_bf16 v[152:155], v[216:219], v[120:123], v[152:155]
    v_mad_u32_u24 v56, s77, 5, v24
    v_xor_b32 v58, 64, v56
    v_xor_b32 v57, 32, v56
    v_mfma_f32_16x16x32_bf16 v[168:171], v[216:219], v[124:127], v[168:171]
    v_xor_b32 v59, 96, v56
    ds_read_b64_tr_b16 v[200:201], v56 offset:0
    ds_read_b64_tr_b16 v[202:203], v58 offset:2560
    v_mfma_f32_16x16x32_bf16 v[156:159], v[220:223], v[120:123], v[156:159]
    ds_read_b64_tr_b16 v[204:205], v57 offset:0
    ds_read_b64_tr_b16 v[206:207], v59 offset:2560
    ds_read_b64_tr_b16 v[208:209], v58 offset:0
    v_mfma_f32_16x16x32_bf16 v[172:175], v[220:223], v[124:127], v[172:175]
    ds_read_b64_tr_b16 v[210:211], v56 offset:2560
    ds_read_b64_tr_b16 v[212:213], v59 offset:0
    v_mfma_f32_16x16x32_bf16 v[160:163], v[224:227], v[120:123], v[160:163]
    ds_read_b64_tr_b16 v[214:215], v57 offset:2560
    s_cmp_eq_u32 s63, 0
    v_mfma_f32_16x16x32_bf16 v[176:179], v[224:227], v[124:127], v[176:179]
    s_cbranch_scc1 K_SP13
K_SPR13:
    s_ff1_i32_b32 s33, s63
    v_mfma_f32_16x16x32_bf16 v[164:167], v[228:231], v[120:123], v[164:167]
    s_bitset0_b32 s63, s33
    s_lshl_b32 s76, s33, 10
    v_mfma_f32_16x16x32_bf16 v[180:183], v[228:231], v[124:127], v[180:183]
    buffer_load_dwordx4 v[112:115], v25, s[20:23], s76 offen offset:0 sc1
    buffer_load_dwordx4 v[116:119], v26, s[20:23], s76 offen offset:0 sc1
    s_waitcnt vmcnt(8)
    v_mfma_f32_16x16x32_bf16 v[152:155], v[184:187], v[128:131], v[152:155]
    v_mad_u32_u24 v56, s78, 5, v24
    v_xor_b32 v58, 64, v56
    v_xor_b32 v57, 32, v56
    v_mfma_f32_16x16x32_bf16 v[168:171], v[184:187], v[132:135], v[168:171]
    v_xor_b32 v59, 96, v56
    ds_read_b64_tr_b16 v[216:217], v56 offset:0
    ds_read_b64_tr_b16 v[218:219], v58 offset:2560
    v_mfma_f32_16x16x32_bf16 v[156:159], v[188:191], v[128:131], v[156:159]
    ds_read_b64_tr_b16 v[220:221], v57 offset:0
    ds_read_b64_tr_b16 v[222:223], v59 offset:2560
    ds_read_b64_tr_b16 v[224:225], v58 offset:0
    v_mfma_f32_16x16x32_bf16 v[172:175], v[188:191], v[132:135], v[172:175]
    ds_read_b64_tr_b16 v[226:227], v56 offset:2560
    ds_read_b64_tr_b16 v[228:229], v59 offset:0
    v_mfma_f32_16x16x32_bf16 v[160:163], v[192:195], v[128:131], v[160:163]
    ds_read_b64_tr_b16 v[230:231], v57 offset:2560
    s_cmp_eq_u32 s63, 0
    v_mfma_f32_16x16x32_bf16 v[176:179], v[192:195], v[132:135], v[176:179]
    s_cbranch_scc1 K_SP14
K_SPR14:
    s_ff1_i32_b32 s33, s63
    v_mfma_f32_16x16x32_bf16 v[164:167], v[196:199], v[128:131], v[164:167]
    s_bitset0_b32 s63, s33
    s_lshl_b32 s77, s33, 10
    v_mfma_f32_16x16x32_bf16 v[180:183], v[196:199], v[132:135], v[180:183]
    buffer_load_dwordx4 v[120:123], v25, s[20:23], s77 offen offset:0 sc1
    buffer_load_dwordx4 v[124:127], v26, s[20:23], s77 offen offset:0 sc1
    s_waitcnt vmcnt(8) lgkmcnt(8)
    v_mfma_f32_16x16x32_bf16 v[152:155], v[200:203], v[136:139], v[152:155]
    v_mad_u32_u24 v56, s75, 5, v24
    v_xor_b32 v58, 64, v56
    v_xor_b32 v57, 32, v56
    v_mfma_f32_16x16x32_bf16 v[168:171], v[200:203], v[140:143], v[168:171]
    v_xor_b32 v59, 96, v56
    ds_read_b64_tr_b16 v[184:185], v56 offset:0
    ds_read_b64_tr_b16 v[186:187], v58 offset:2560
    v_mfma_f32_16x16x32_bf16 v[156:159], v[204:207], v[136:139], v[156:159]
    ds_read_b64_tr_b16 v[188:189], v57 offset:0
    ds_read_b64_tr_b16 v[190:191], v59 offset:2560
    ds_read_b64_tr_b16 v[192:193], v58 offset:0
    v_mfma_f32_16x16x32_bf16 v[172:175], v[204:207], v[140:143], v[172:175]
    ds_read_b64_tr_b16 v[194:195], v56 offset:2560
    ds_read_b64_tr_b16 v[196:197], v59 offset:0
    v_mfma_f32_16x16x32_bf16 v[160:163], v[208:211], v[136:139], v[160:163]
    ds_read_b64_tr_b16 v[198:199], v57 offset:2560
    s_cmp_eq_u32 s63, 0
    v_mfma_f32_16x16x32_bf16 v[176:179], v[208:211], v[140:143], v[176:179]
    s_cbranch_scc1 K_SP15
K_SPR15:
    s_ff1_i32_b32 s33, s63
    v_mfma_f32_16x16x32_bf16 v[164:167], v[212:215], v[136:139], v[164:167]
    s_bitset0_b32 s63, s33
    s_lshl_b32 s78, s33, 10
    v_mfma_f32_16x16x32_bf16 v[180:183], v[212:215], v[140:143], v[180:183]
    buffer_load_dwordx4 v[128:131], v25, s[20:23], s78 offen offset:0 sc1
    buffer_load_dwordx4 v[132:135], v26, s[20:23], s78 offen offset:0 sc1
    s_waitcnt vmcnt(8) lgkmcnt(8)
    v_mfma_f32_16x16x32_bf16 v[152:155], v[216:219], v[144:147], v[152:155]
    v_mad_u32_u24 v56, s76, 5, v24
    v_xor_b32 v58, 64, v56
    v_xor_b32 v57, 32, v56
    v_mfma_f32_16x16x32_bf16 v[168:171], v[216:219], v[148:151], v[168:171]
    v_xor_b32 v59, 96, v56
    ds_read_b64_tr_b16 v[200:201], v56 offset:0
    ds_read_b64_tr_b16 v[202:203], v58 offset:2560
    v_mfma_f32_16x16x32_bf16 v[156:159], v[220:223], v[144:147], v[156:159]
    ds_read_b64_tr_b16 v[204:205], v57 offset:0
    ds_read_b64_tr_b16 v[206:207], v59 offset:2560
    ds_read_b64_tr_b16 v[208:209], v58 offset:0
    v_mfma_f32_16x16x32_bf16 v[172:175], v[220:223], v[148:151], v[172:175]
    ds_read_b64_tr_b16 v[210:211], v56 offset:2560
    ds_read_b64_tr_b16 v[212:213], v59 offset:0
    v_mfma_f32_16x16x32_bf16 v[160:163], v[224:227], v[144:147], v[160:163]
    ds_read_b64_tr_b16 v[214:215], v57 offset:2560
    s_cmp_eq_u32 s63, 0
    v_mfma_f32_16x16x32_bf16 v[176:179], v[224:227], v[148:151], v[176:179]
    s_cbranch_scc1 K_SP16
K_SPR16:
    s_ff1_i32_b32 s33, s63
    v_mfma_f32_16x16x32_bf16 v[164:167], v[228:231], v[144:147], v[164:167]
    s_bitset0_b32 s63, s33
    s_lshl_b32 s75, s33, 10
    v_mfma_f32_16x16x32_bf16 v[180:183], v[228:231], v[148:151], v[180:183]
    buffer_load_dwordx4 v[136:139], v25, s[20:23], s75 offen offset:0 sc1
    buffer_load_dwordx4 v[140:143], v26, s[20:23], s75 offen offset:0 sc1
    s_waitcnt vmcnt(8) lgkmcnt(8)
    v_mfma_f32_16x16x32_bf16 v[152:155], v[184:187], v[104:107], v[152:155]
    v_mad_u32_u24 v56, s77, 5, v24
    v_xor_b32 v58, 64, v56
    v_xor_b32 v57, 32, v56
    v_mfma_f32_16x16x32_bf16 v[168:171], v[184:187], v[108:111], v[168:171]
    v_xor_b32 v59, 96, v56
    ds_read_b64_tr_b16 v[216:217], v56 offset:0
    ds_read_b64_tr_b16 v[218:219], v58 offset:2560
    v_mfma_f32_16x16x32_bf16 v[156:159], v[188:191], v[104:107], v[156:159]
    ds_read_b64_tr_b16 v[220:221], v57 offset:0
    ds_read_b64_tr_b16 v[222:223], v59 offset:2560
    ds_read_b64_tr_b16 v[224:225], v58 offset:0
    v_mfma_f32_16x16x32_bf16 v[172:175], v[188:191], v[108:111], v[172:175]
    ds_read_b64_tr_b16 v[226:227], v56 offset:2560
    ds_read_b64_tr_b16 v[228:229], v59 offset:0
    v_mfma_f32_16x16x32_bf16 v[160:163], v[192:195], v[104:107], v[160:163]
    ds_read_b64_tr_b16 v[230:231], v57 offset:2560
    s_andn2_b32 s33, s66, s63
    v_mfma_f32_16x16x32_bf16 v[176:179], v[192:195], v[108:111], v[176:179]
    s_bfe_u32 s33, s33, 0x40008
    s_cmp_eq_u32 s33, 15
    v_mfma_f32_16x16x32_bf16 v[164:167], v[196:199], v[104:107], v[164:167]
    s_cselect_b32 s76, 0, 1024
    s_xor_b32 s69, s76, 1024
    v_mfma_f32_16x16x32_bf16 v[180:183], v[196:199], v[108:111], v[180:183]
    buffer_load_dwordx4 v[144:147], v35, s[20:23], s76 offen offset:2048 sc1
    buffer_load_dwordx4 v[148:151], v36, s[20:23], s76 offen offset:2048 sc1
    s_waitcnt vmcnt(8) lgkmcnt(8)
    v_mfma_f32_16x16x32_bf16 v[152:155], v[200:203], v[112:115], v[152:155]
    v_mad_u32_u24 v56, s78, 5, v24
    v_xor_b32 v58, 64, v56
    v_xor_b32 v57, 32, v56
    v_mfma_f32_16x16x32_bf16 v[168:171], v[200:203], v[116:119], v[168:171]
    v_xor_b32 v59, 96, v56
    ds_read_b64_tr_b16 v[184:185], v56 offset:0
    ds_read_b64_tr_b16 v[186:187], v58 offset:2560
    v_mfma_f32_16x16x32_bf16 v[156:159], v[204:207], v[112:115], v[156:159]
    ds_read_b64_tr_b16 v[188:189], v57 offset:0
    ds_read_b64_tr_b16 v[190:191], v59 offset:2560
    ds_read_b64_tr_b16 v[192:193], v58 offset:0
    v_mfma_f32_16x16x32_bf16 v[172:175], v[204:207], v[116:119], v[172:175]
    ds_read_b64_tr_b16 v[194:195], v56 offset:2560
    ds_read_b64_tr_b16 v[196:197], v59 offset:0
    v_mfma_f32_16x16x32_bf16 v[160:163], v[208:211], v[112:115], v[160:163]
    ds_read_b64_tr_b16 v[198:199], v57 offset:2560
    s_cmp_eq_u32 s63, 0
    v_mfma_f32_16x16x32_bf16 v[176:179], v[208:211], v[116:119], v[176:179]
    s_cbranch_scc1 K_SP18
K_SPR18:
    s_ff1_i32_b32 s33, s63
    v_mfma_f32_16x16x32_bf16 v[164:167], v[212:215], v[112:115], v[164:167]
    s_bitset0_b32 s63, s33
    s_lshl_b32 s77, s33, 10
    v_mfma_f32_16x16x32_bf16 v[180:183], v[212:215], v[116:119], v[180:183]
    buffer_load_dwordx4 v[104:107], v25, s[20:23], s77 offen offset:0 sc1
    buffer_load_dwordx4 v[108:111], v26, s[20:23], s77 offen offset:0 sc1
    s_waitcnt vmcnt(8) lgkmcnt(8)
    v_mfma_f32_16x16x32_bf16 v[152:155], v[216:219], v[120:123], v[152:155]
    v_mad_u32_u24 v56, s75, 5, v24
    v_xor_b32 v58, 64, v56
    v_mfma_f32_16x16x32_bf16 v[168:171], v[216:219], v[124:127], v[168:171]
    v_xor_b32 v57, 32, v56
    v_xor_b32 v59, 96, v56
    v_mfma_f32_16x16x32_bf16 v[156:159], v[220:223], v[120:123], v[156:159]
    ds_read_b64_tr_b16 v[200:201], v56 offset:0
    ds_read_b64_tr_b16 v[202:203], v58 offset:2560
    v_mfma_f32_16x16x32_bf16 v[172:175], v[220:223], v[124:127], v[172:175]
    ds_read_b64_tr_b16 v[204:205], v57 offset:0
    ds_read_b64_tr_b16 v[206:207], v59 offset:2560
    v_mfma_f32_16x16x32_bf16 v[160:163], v[224:227], v[120:123], v[160:163]
    ds_read_b64_tr_b16 v[208:209], v58 offset:0
    ds_read_b64_tr_b16 v[210:211], v56 offset:2560
    v_mfma_f32_16x16x32_bf16 v[176:179], v[224:227], v[124:127], v[176:179]
    ds_read_b64_tr_b16 v[212:213], v59 offset:0
    ds_read_b64_tr_b16 v[214:215], v57 offset:2560
    v_mfma_f32_16x16x32_bf16 v[164:167], v[228:231], v[120:123], v[164:167]
    buffer_load_dwordx4 v[112:115], v35, s[20:23], s69 offen offset:2048 sc1
    buffer_load_dwordx4 v[116:119], v36, s[20:23], s69 offen offset:2048 sc1
    v_mfma_f32_16x16x32_bf16 v[180:183], v[228:231], v[124:127], v[180:183]
    s_waitcnt vmcnt(8) lgkmcnt(8)
    v_mfma_f32_16x16x32_bf16 v[152:155], v[184:187], v[128:131], v[152:155]
    v_mad_u32_u24 v56, s76, 20, v60
    v_xor_b32 v58, 64, v56
    v_mfma_f32_16x16x32_bf16 v[168:171], v[184:187], v[132:135], v[168:171]
    v_xor_b32 v57, 32, v56
    v_xor_b32 v59, 96, v56
    v_mfma_f32_16x16x32_bf16 v[156:159], v[188:191], v[128:131], v[156:159]
    ds_read_b64_tr_b16 v[216:217], v56 offset:40960
    ds_read_b64_tr_b16 v[218:219], v58 offset:43520
    v_mfma_f32_16x16x32_bf16 v[172:175], v[188:191], v[132:135], v[172:175]
    ds_read_b64_tr_b16 v[220:221], v57 offset:40960
    ds_read_b64_tr_b16 v[222:223], v59 offset:43520
    v_mfma_f32_16x16x32_bf16 v[160:163], v[192:195], v[128:131], v[160:163]
    ds_read_b64_tr_b16 v[224:225], v58 offset:40960
    ds_read_b64_tr_b16 v[226:227], v56 offset:43520
    v_mfma_f32_16x16x32_bf16 v[176:179], v[192:195], v[132:135], v[176:179]
    ds_read_b64_tr_b16 v[228:229], v59 offset:40960
    ds_read_b64_tr_b16 v[230:231], v57 offset:43520
    v_mfma_f32_16x16x32_bf16 v[164:167], v[196:199], v[128:131], v[164:167]
    v_mfma_f32_16x16x32_bf16 v[180:183], v[196:199], v[132:135], v[180:183]
    s_waitcnt vmcnt(6) lgkmcnt(8)
    v_mfma_f32_16x16x32_bf16 v[152:155], v[200:203], v[136:139], v[152:155]
    v_mad_u32_u24 v56, s77, 5, v24
    v_xor_b32 v58, 64, v56
    v_mfma_f32_16x16x32_bf16 v[168:171], v[200:203], v[140:143], v[168:171]
    v_xor_b32 v57, 32, v56
    v_xor_b32 v59, 96, v56
    v_mfma_f32_16x16x32_bf16 v[156:159], v[204:207], v[136:139], v[156:159]
    ds_read_b64_tr_b16 v[184:185], v56 offset:0
    ds_read_b64_tr_b16 v[186:187], v58 offset:2560
    v_mfma_f32_16x16x32_bf16 v[172:175], v[204:207], v[140:143], v[172:175]
    ds_read_b64_tr_b16 v[188:189], v57 offset:0
    ds_read_b64_tr_b16 v[190:191], v59 offset:2560
    v_mfma_f32_16x16x32_bf16 v[160:163], v[208:211], v[136:139], v[160:163]
    ds_read_b64_tr_b16 v[192:193], v58 offset:0
    ds_read_b64_tr_b16 v[194:195], v56 offset:2560
    v_mfma_f32_16x16x32_bf16 v[176:179], v[208:211], v[140:143], v[176:179]
    ds_read_b64_tr_b16 v[196:197], v59 offset:0
    ds_read_b64_tr_b16 v[198:199], v57 offset:2560
    v_mfma_f32_16x16x32_bf16 v[164:167], v[212:215], v[136:139], v[164:167]
    v_mfma_f32_16x16x32_bf16 v[180:183], v[212:215], v[140:143], v[180:183]
    s_waitcnt vmcnt(4) lgkmcnt(8)
    v_mfma_f32_16x16x32_bf16 v[152:155], v[216:219], v[144:147], v[152:155]
    v_mad_u32_u24 v56, s69, 20, v60
    v_xor_b32 v58, 64, v56
    v_mfma_f32_16x16x32_bf16 v[168:171], v[216:219], v[148:151], v[168:171]
    v_xor_b32 v57, 32, v56
    v_xor_b32 v59, 96, v56
    v_mfma_f32_16x16x32_bf16 v[156:159], v[220:223], v[144:147], v[156:159]
    ds_read_b64_tr_b16 v[200:201], v56 offset:40960
    ds_read_b64_tr_b16 v[202:203], v58 offset:43520
    v_mfma_f32_16x16x32_bf16 v[172:175], v[220:223], v[148:151], v[172:175]
    ds_read_b64_tr_b16 v[204:205], v57 offset:40960
    ds_read_b64_tr_b16 v[206:207], v59 offset:43520
    v_mfma_f32_16x16x32_bf16 v[160:163], v[224:227], v[144:147], v[160:163]
    ds_read_b64_tr_b16 v[208:209], v58 offset:40960
    ds_read_b64_tr_b16 v[210:211], v56 offset:43520
    v_mfma_f32_16x16x32_bf16 v[176:179], v[224:227], v[148:151], v[176:179]
    ds_read_b64_tr_b16 v[212:213], v59 offset:40960
    ds_read_b64_tr_b16 v[214:215], v57 offset:43520
    v_mfma_f32_16x16x32_bf16 v[164:167], v[228:231], v[144:147], v[164:167]
    v_mfma_f32_16x16x32_bf16 v[180:183], v[228:231], v[148:151], v[180:183]
    s_waitcnt vmcnt(2) lgkmcnt(8)
    v_mfma_f32_16x16x32_bf16 v[152:155], v[184:187], v[104:107], v[152:155]
    v_mfma_f32_16x16x32_bf16 v[156:159], v[188:191], v[104:107], v[156:159]
    v_mfma_f32_16x16x32_bf16 v[160:163], v[192:195], v[104:107], v[160:163]
    v_mfma_f32_16x16x32_bf16 v[164:167], v[196:199], v[104:107], v[164:167]
    s_sub_u32 s59, s56, s58
    s_cmp_lt_u32 s59, 32
    s_cbranch_scc1 K_YROW0
K_NOY0:
    s_sub_u32 s59, s57, s58
    s_cmp_lt_u32 s59, 32
    s_cbranch_scc1 K_YROW1
K_NOY1:
    s_waitcnt vmcnt(0) lgkmcnt(0)
    v_mfma_f32_16x16x32_bf16 v[152:155], v[200:203], v[112:115], v[152:155]
    v_mfma_f32_16x16x32_bf16 v[156:159], v[204:207], v[112:115], v[156:159]
    v_mfma_f32_16x16x32_bf16 v[160:163], v[208:211], v[112:115], v[160:163]
    v_mfma_f32_16x16x32_bf16 v[164:167], v[212:215], v[112:115], v[164:167]
    v_mfma_f32_16x16x32_bf16 v[168:171], v[184:187], v[108:111], v[168:171]
    v_mfma_f32_16x16x32_bf16 v[172:175], v[188:191], v[108:111], v[172:175]
    v_mfma_f32_16x16x32_bf16 v[176:179], v[192:195], v[108:111], v[176:179]
    s_nop 1
    v_fma_f32 v152, v152, v64, v72
    v_fma_f32 v153, v153, v64, v73
    v_fma_f32 v154, v154, v64, v74
    v_mfma_f32_16x16x32_bf16 v[180:183], v[196:199], v[108:111], v[180:183]
    v_fma_f32 v155, v155, v64, v75
    v_cvt_pk_bf16_f32 v40, v152, v153
    v_cvt_pk_bf16_f32 v41, v154, v155
    v_mfma_f32_16x16x32_bf16 v[168:171], v[200:203], v[116:119], v[168:171]
    v_fma_f32 v156, v156, v64, v76
    v_fma_f32 v157, v157, v64, v77
    ds_write_b64 v29, v[40:41] offset:0
    v_mfma_f32_16x16x32_bf16 v[172:175], v[204:207], v[116:119], v[172:175]
    v_fma_f32 v158, v158, v64, v78
    v_fma_f32 v159, v159, v64, v79
    v_cvt_pk_bf16_f32 v42, v156, v157
    v_mfma_f32_16x16x32_bf16 v[176:179], v[208:211], v[116:119], v[176:179]
    v_cvt_pk_bf16_f32 v43, v158, v159
    v_fma_f32 v160, v160, v64, v80
    v_fma_f32 v161, v161, v64, v81
    v_mfma_f32_16x16x32_bf16 v[180:183], v[212:215], v[116:119], v[180:183]
    ds_write_b64 v30, v[42:43] offset:0
    v_fma_f32 v162, v162, v64, v82
    v_fma_f32 v163, v163, v64, v83
    v_cvt_pk_bf16_f32 v44, v160, v161
    v_cvt_pk_bf16_f32 v45, v162, v163
    v_pk_fma_f32 v[164:165], v[164:165], v[64:65], v[84:85] op_sel_hi:[1,0,1]
    v_pk_fma_f32 v[166:167], v[166:167], v[64:65], v[86:87] op_sel_hi:[1,0,1]
    ds_write_b64 v31, v[44:45] offset:0
    v_cvt_pk_bf16_f32 v46, v164, v165
    v_cvt_pk_bf16_f32 v47, v166, v167
    ds_write_b64 v32, v[46:47] offset:0
    ds_read_b128 v[72:75], v33 offset:0
    ds_read_b128 v[76:79], v33 offset:1024
    v_pk_fma_f32 v[168:169], v[168:169], v[66:67], v[88:89] op_sel_hi:[1,0,1]
    v_pk_fma_f32 v[170:171], v[170:171], v[66:67], v[90:91] op_sel_hi:[1,0,1]
    v_cvt_pk_bf16_f32 v48, v168, v169
    v_cvt_pk_bf16_f32 v49, v170, v171
    v_pk_fma_f32 v[172:173], v[172:173], v[66:67], v[92:93] op_sel_hi:[1,0,1]
    v_pk_fma_f32 v[174:175], v[174:175], v[66:67], v[94:95] op_sel_hi:[1,0,1]
    v_cvt_pk_bf16_f32 v50, v172, v173
    v_cvt_pk_bf16_f32 v51, v174, v175
    v_pk_fma_f32 v[176:177], v[176:177], v[66:67], v[96:97] op_sel_hi:[1,0,1]
    v_pk_fma_f32 v[178:179], v[178:179], v[66:67], v[98:99] op_sel_hi:[1,0,1]
    v_cvt_pk_bf16_f32 v52, v176, v177
    v_cvt_pk_bf16_f32 v53, v178, v179
    v_pk_fma_f32 v[180:181], v[180:181], v[66:67], v[100:101] op_sel_hi:[1,0,1]
    v_pk_fma_f32 v[182:183], v[182:183], v[66:67], v[102:103] op_sel_hi:[1,0,1]
    v_cvt_pk_bf16_f32 v54, v180, v181
    v_cvt_pk_bf16_f32 v55, v182, v183
    s_waitcnt lgkmcnt(0)
    buffer_store_dwordx4 v[72:75], v27, s[48:51], s71 offen sc1
    buffer_store_dwordx4 v[76:79], v28, s[48:51], s72 offen sc1
    ds_write_b64 v29, v[48:49] offset:2048
    ds_write_b64 v30, v[50:51] offset:2048
    ds_write_b64 v31, v[52:53] offset:2048
    ds_write_b64 v32, v[54:55] offset:2048
    ds_read_b128 v[88:91], v33 offset:2048
    ds_read_b128 v[92:95], v33 offset:3072
    s_waitcnt lgkmcnt(1)
    buffer_store_dwordx4 v[88:91], v27, s[48:51], s73 offen sc1
    s_waitcnt lgkmcnt(0)
    buffer_store_dwordx4 v[92:95], v28, s[48:51], s74 offen sc1
K_END:
K_EXIT:
    s_endpgm
.p2align 12
WP_spin:
    s_setpc_b64 s[38:39]
K_SP0:
    ds_read_b32 v2, v12 offset:32
    s_waitcnt lgkmcnt(0)
    v_readfirstlane_b32 s33, v2
    s_nop 3
    s_lshr_b32 s63, s33, s64
    s_lshr_b32 s33, s33, s65
    s_and_b32 s63, s63, s33
    s_and_b32 s63, s63, 0xff
    s_andn2_b32 s63, s63, s66
    s_cbranch_scc0 K_SP0
    s_or_b32 s66, s66, s63
    s_branch K_SPR0
K_SP1:
    ds_read_b32 v2, v12 offset:32
    s_waitcnt lgkmcnt(0)
    v_readfirstlane_b32 s33, v2
    s_nop 3
    s_lshr_b32 s63, s33, s64
    s_lshr_b32 s33, s33, s65
    s_and_b32 s63, s63, s33
    s_and_b32 s63, s63, 0xff
    s_andn2_b32 s63, s63, s66
    s_cbranch_scc0 K_SP1
    s_or_b32 s66, s66, s63
    s_branch K_SPR1
K_SP2:
    ds_read_b32 v2, v12 offset:32
    s_waitcnt lgkmcnt(0)
    v_readfirstlane_b32 s33, v2
    s_nop 3
    s_lshr_b32 s63, s33, s64
    s_lshr_b32 s33, s33, s65
    s_and_b32 s63, s63, s33
    s_and_b32 s63, s63, 0xff
    s_andn2_b32 s63, s63, s66
    s_cbranch_scc0 K_SP2
    s_or_b32 s66, s66, s63
    s_branch K_SPR2
K_SP3:
    ds_read_b32 v2, v12 offset:32
    s_waitcnt lgkmcnt(0)
    v_readfirstlane_b32 s33, v2
    s_nop 3
    s_lshr_b32 s63, s33, s64
    s_lshr_b32 s33, s33, s65
    s_and_b32 s63, s63, s33
    s_and_b32 s63, s63, 0xff
    s_andn2_b32 s63, s63, s66
    s_cbranch_scc0 K_SP3
    s_or_b32 s66, s66, s63
    s_branch K_SPR3
K_SP4:
    ds_read_b32 v2, v12 offset:32
    s_waitcnt lgkmcnt(0)
    v_readfirstlane_b32 s33, v2
    s_nop 3
    s_lshr_b32 s63, s33, s64
    s_lshr_b32 s33, s33, s65
    s_and_b32 s63, s63, s33
    s_and_b32 s63, s63, 0xff
    s_andn2_b32 s63, s63, s66
    s_cbranch_scc0 K_SP4
    s_or_b32 s66, s66, s63
    s_branch K_SPR4
K_SP5:
    ds_read_b32 v2, v12 offset:32
    s_waitcnt lgkmcnt(0)
    v_readfirstlane_b32 s33, v2
    s_nop 3
    s_lshr_b32 s63, s33, s64
    s_lshr_b32 s33, s33, s65
    s_and_b32 s63, s63, s33
    s_and_b32 s63, s63, 0xff
    s_andn2_b32 s63, s63, s66
    s_cbranch_scc0 K_SP5
    s_or_b32 s66, s66, s63
    s_branch K_SPR5
K_SP6:
    ds_read_b32 v2, v12 offset:32
    s_waitcnt lgkmcnt(0)
    v_readfirstlane_b32 s33, v2
    s_nop 3
    s_lshr_b32 s63, s33, s64
    s_lshr_b32 s33, s33, s65
    s_and_b32 s63, s63, s33
    s_and_b32 s63, s63, 0xff
    s_andn2_b32 s63, s63, s66
    s_cbranch_scc0 K_SP6
    s_or_b32 s66, s66, s63
    s_branch K_SPR6
K_SP8:
    ds_read_b32 v2, v12 offset:32
    s_waitcnt lgkmcnt(0)
    v_readfirstlane_b32 s33, v2
    s_nop 3
    s_lshr_b32 s63, s33, s64
    s_lshr_b32 s33, s33, s65
    s_and_b32 s63, s63, s33
    s_and_b32 s63, s63, 0xff
    s_andn2_b32 s63, s63, s66
    s_cbranch_scc0 K_SP8
    s_or_b32 s66, s66, s63
    s_branch K_SPR8
K_SP10:
    ds_read_b32 v2, v12 offset:32
    s_waitcnt lgkmcnt(0)
    v_readfirstlane_b32 s33, v2
    s_nop 3
    s_lshr_b32 s63, s33, s64
    s_lshr_b32 s33, s33, s65
    s_and_b32 s63, s63, s33
    s_and_b32 s63, s63, 0xff00
    s_andn2_b32 s63, s63, s66
    s_cbranch_scc0 K_SP10
    s_or_b32 s66, s66, s63
    s_branch K_SPR10
K_SP11:
    ds_read_b32 v2, v12 offset:32
    s_waitcnt lgkmcnt(0)
    v_readfirstlane_b32 s33, v2
    s_nop 3
    s_lshr_b32 s63, s33, s64
    s_lshr_b32 s33, s33, s65
    s_and_b32 s63, s63, s33
    s_and_b32 s63, s63, 0xff00
    s_andn2_b32 s63, s63, s66
    s_cbranch_scc0 K_SP11
    s_or_b32 s66, s66, s63
    s_branch K_SPR11
K_SP12:
    ds_read_b32 v2, v12 offset:32
    s_waitcnt lgkmcnt(0)
    v_readfirstlane_b32 s33, v2
    s_nop 3
    s_lshr_b32 s63, s33, s64
    s_lshr_b32 s33, s33, s65
    s_and_b32 s63, s63, s33
    s_and_b32 s63, s63, 0xff00
    s_andn2_b32 s63, s63, s66
    s_cbranch_scc0 K_SP12
    s_or_b32 s66, s66, s63
    s_branch K_SPR12
K_SP13:
    ds_read_b32 v2, v12 offset:32
    s_waitcnt lgkmcnt(0)
    v_readfirstlane_b32 s33, v2
    s_nop 3
    s_lshr_b32 s63, s33, s64
    s_lshr_b32 s33, s33, s65
    s_and_b32 s63, s63, s33
    s_and_b32 s63, s63, 0xff00
    s_andn2_b32 s63, s63, s66
    s_cbranch_scc0 K_SP13
    s_or_b32 s66, s66, s63
    s_branch K_SPR13
K_SP14:
    ds_read_b32 v2, v12 offset:32
    s_waitcnt lgkmcnt(0)
    v_readfirstlane_b32 s33, v2
    s_nop 3
    s_lshr_b32 s63, s33, s64
    s_lshr_b32 s33, s33, s65
    s_and_b32 s63, s63, s33
    s_and_b32 s63, s63, 0xff00
    s_andn2_b32 s63, s63, s66
    s_cbranch_scc0 K_SP14
    s_or_b32 s66, s66, s63
    s_branch K_SPR14
K_SP15:
    ds_read_b32 v2, v12 offset:32
    s_waitcnt lgkmcnt(0)
    v_readfirstlane_b32 s33, v2
    s_nop 3
    s_lshr_b32 s63, s33, s64
    s_lshr_b32 s33, s33, s65
    s_and_b32 s63, s63, s33
    s_and_b32 s63, s63, 0xff00
    s_andn2_b32 s63, s63, s66
    s_cbranch_scc0 K_SP15
    s_or_b32 s66, s66, s63
    s_branch K_SPR15
K_SP16:
    ds_read_b32 v2, v12 offset:32
    s_waitcnt lgkmcnt(0)
    v_readfirstlane_b32 s33, v2
    s_nop 3
    s_lshr_b32 s63, s33, s64
    s_lshr_b32 s33, s33, s65
    s_and_b32 s63, s63, s33
    s_and_b32 s63, s63, 0xff00
    s_andn2_b32 s63, s63, s66
    s_cbranch_scc0 K_SP16
    s_or_b32 s66, s66, s63
    s_branch K_SPR16
K_SP18:
    ds_read_b32 v2, v12 offset:32
    s_waitcnt lgkmcnt(0)
    v_readfirstlane_b32 s33, v2
    s_nop 3
    s_lshr_b32 s63, s33, s64
    s_lshr_b32 s33, s33, s65
    s_and_b32 s63, s63, s33
    s_and_b32 s63, s63, 0xff00
    s_andn2_b32 s63, s63, s66
    s_cbranch_scc0 K_SP18
    s_or_b32 s66, s66, s63
    s_branch K_SPR18
WP_yr0:
    s_setpc_b64 s[38:39]
K_YROW0:
    v_lshlrev_b32 v5, 4, v9
    v_add_u32 v5, 158976, v5
    v_and_b32 v3, 15, v1
    s_and_b32 s33, s59, 15
    v_cmp_eq_u32 vcc, s33, v3
    s_mov_b32 s3, 1048576
K_P2_GY0:
    ds_read_b32 v2, v12 offset:64
    s_sub_u32 s3, s3, 1
    s_waitcnt lgkmcnt(0)
    v_readfirstlane_b32 s33, v2
    s_nop 3
    s_cselect_b32 s33, 1, s33
    s_cmp_lt_u32 s33, 1
    s_cbranch_scc1 K_P2_GY0
    s_mov_b64 exec, vcc
    s_cmp_ge_u32 s59, 16
    s_cbranch_scc1 K_YR1_0
    ds_read_b128 v[72:75], v5 offset:0
    ds_read_b128 v[76:79], v5 offset:64
    ds_read_b128 v[80:83], v5 offset:128
    ds_read_b128 v[84:87], v5 offset:192
    s_mov_b64 exec, -1
    s_branch K_NOY0
K_YR1_0:
    ds_read_b128 v[88:91], v5 offset:0
    ds_read_b128 v[92:95], v5 offset:64
    ds_read_b128 v[96:99], v5 offset:128
    ds_read_b128 v[100:103], v5 offset:192
    s_mov_b64 exec, -1
    s_branch K_NOY0
K_YROW1:
    v_lshlrev_b32 v5, 4, v9
    v_add_u32 v5, 159232, v5
    v_and_b32 v3, 15, v1
    s_and_b32 s33, s59, 15
    v_cmp_eq_u32 vcc, s33, v3
    s_mov_b32 s3, 1048576
K_P2_GY1:
    ds_read_b32 v2, v12 offset:68
    s_sub_u32 s3, s3, 1
    s_waitcnt lgkmcnt(0)
    v_readfirstlane_b32 s33, v2
    s_nop 3
    s_cselect_b32 s33, 1, s33
    s_cmp_lt_u32 s33, 1
    s_cbranch_scc1 K_P2_GY1
    s_mov_b64 exec, vcc
    s_cmp_ge_u32 s59, 16
    s_cbranch_scc1 K_YR1_1
    ds_read_b128 v[72:75], v5 offset:0
    ds_read_b128 v[76:79], v5 offset:64
    ds_read_b128 v[80:83], v5 offset:128
    ds_read_b128 v[84:87], v5 offset:192
    s_mov_b64 exec, -1
    s_branch K_NOY1
K_YR1_1:
    ds_read_b128 v[88:91], v5 offset:0
    ds_read_b128 v[92:95], v5 offset:64
    ds_read_b128 v[96:99], v5 offset:128
    ds_read_b128 v[100:103], v5 offset:192
    s_mov_b64 exec, -1
    s_branch K_NOY1
.p2align 12
WP_gen:
    s_setpc_b64 s[38:39]
K_P2:
    s_cmp_ge_u32 s30, 4
    s_cbranch_scc1 K_P2_HELP
    v_mov_b32 v12, 158720
    s_cmp_lg_u32 s30, 0
    s_cbranch_scc1 K_P2_W13
    v_lshrrev_b32 v3, 4, v1
    v_and_b32 v4, 7, v1
    v_lshrrev_b32 v2, 3, v1
    v_xor_b32 v4, v4, v3
    v_mul_u32_u24 v2, 1280, v2
    v_lshl_add_u32 v27, v4, 4, v2
    v_xor_b32 v28, 64, v27
    s_mov_b32 s58, 0
K_P2_XD:
    s_lshl_b32 s59, s40, 3
    s_lshl1_add_u32 s59, s58, s59
    s_mul_i32 s59, s59, 20480
    s_lshl_b32 s33, s41, 7
    s_add_u32 s59, s59, s33
    s_lshl_b32 s33, s58, 12
    s_add_u32 m0, s33, 140288
    s_add_u32 s3, s59, 0
    buffer_load_dwordx4 v27, s[12:15], s3 offen lds
    s_add_u32 m0, s33, 141312
    s_add_u32 s3, s59, 10240
    buffer_load_dwordx4 v28, s[12:15], s3 offen lds
    s_add_u32 m0, s33, 142336
    s_add_u32 s3, s59, 20480
    buffer_load_dwordx4 v27, s[12:15], s3 offen lds
    s_add_u32 m0, s33, 143360
    s_add_u32 s3, s59, 30720
    buffer_load_dwordx4 v28, s[12:15], s3 offen lds
    s_add_u32 s58, s58, 1
    s_cmp_lt_u32 s58, 4
    s_cbranch_scc1 K_P2_XD
    s_waitcnt vmcnt(0)
    s_branch K_P2_AUXW
K_P2_W13:
    v_lshrrev_b32 v2, 3, v1
    v_mul_u32_u24 v2, 1280, v2
    v_lshrrev_b32 v3, 4, v1
    v_lshlrev_b32 v3, 1, v3
    v_and_b32 v4, 7, v1
    v_xor_b32 v3, v3, v4
    v_lshl_add_u32 v2, v3, 4, v2
    s_lshl_b32 s33, s41, 7
    v_add_u32 v22, s33, v2
    s_mov_b32 s60, 0xfda87520
    s_mov_b32 s61, 0xecb96431
    s_sub_u32 s58, s30, 1
K_P2_WS:
    s_lshl_b32 s3, s58, 2
    s_lshr_b64 s[4:5], s[60:61], s3
    s_and_b32 s4, s4, 15
    s_mul_i32 s4, s4, 51200
    s_mul_i32 s59, s58, 5120
    s_add_u32 s52, s4, 0
    s_add_u32 m0, s59, 0
    s_waitcnt vmcnt(11)
    buffer_load_dwordx4 v22, s[24:27], s52 offen lds
    s_add_u32 s52, s4, 10240
    s_add_u32 m0, s59, 1024
    s_waitcnt vmcnt(11)
    buffer_load_dwordx4 v22, s[24:27], s52 offen lds
    s_add_u32 s52, s4, 20480
    s_add_u32 m0, s59, 2048
    s_waitcnt vmcnt(11)
    buffer_load_dwordx4 v22, s[24:27], s52 offen lds
    s_add_u32 s52, s4, 30720
    s_add_u32 m0, s59, 3072
    s_waitcnt vmcnt(11)
    buffer_load_dwordx4 v22, s[24:27], s52 offen lds
    s_add_u32 s52, s4, 40960
    s_add_u32 m0, s59, 4096
    s_waitcnt vmcnt(11)
    buffer_load_dwordx4 v22, s[24:27], s52 offen lds
    s_cmp_ge_u32 s58, 3
    s_cbranch_scc1 K_P2_WS1
    v_mov_b32 v3, 1
    s_waitcnt vmcnt(5)
    s_mov_b64 exec, 1
    ds_add_u32 v12, v3 offset:52
    s_mov_b64 exec, -1
K_P2_WS1:
    s_add_u32 s58, s58, 3
    s_cmp_lt_u32 s58, 16
    s_cbranch_scc1 K_P2_WS
K_P2_AUXW:
    v_mov_b32 v34, 1
    s_waitcnt vmcnt(10)
    s_mov_b64 exec, 1
    ds_add_u32 v12, v34 offset:72
    s_mov_b64 exec, -1
    s_lshl_b32 s54, s40, 7
    v_lshrrev_b32 v9, 4, v1
    v_mov_b32 v12, 158720
    s_add_u32 s20, s10, 0x100000
    s_addc_u32 s21, s11, 0
    s_mov_b32 s22, 0x280000
    s_mov_b32 s23, 0x20000
    s_add_u32 s16, s10, 0x1000
    s_addc_u32 s17, s11, 0
    s_mov_b32 s18, 0x2000
    s_mov_b32 s19, 0x20000
    s_mov_b32 s48, s6
    s_mov_b32 s49, s7
    s_mov_b32 s50, 0x280000
    s_mov_b32 s51, 0x20000
    s_lshl_b32 s53, s40, 3
    s_lshl1_add_u32 s53, s30, s53
    s_mov_b32 s55, 20480
    v_bfe_u32 v20, v1, 2, 2
    v_and_b32 v21, 3, v1
    s_mul_i32 s3, s53, 20480
    v_lshl_add_u32 v25, v1, 4, s3
    v_add_u32 v26, 20480, v25
    v_add_u32 v35, 16384, v25
    v_add_u32 v36, 16384, v26
    v_and_b32 v2, 15, v1
    s_lshl_b32 s3, s53, 6
    v_lshl_add_u32 v23, v2, 2, s3
    v_lshl_add_u32 v2, v9, 2, v20
    v_bfe_u32 v3, v2, 1, 2
    v_lshlrev_b32 v2, 7, v2
    v_lshl_add_u32 v2, v21, 3, v2
    v_lshl_add_u32 v24, v3, 5, v2
    v_lshrrev_b32 v3, 1, v20
    v_mul_u32_u24 v2, 40, v9
    v_add3_u32 v2, v2, 16, v20
    v_lshlrev_b32 v2, 7, v2
    v_lshl_add_u32 v2, v21, 3, v2
    v_xor_b32 v4, 0, v3
    v_lshl_add_u32 v60, v4, 5, v2
    v_xor_b32 v4, 1, v3
    v_lshl_add_u32 v61, v4, 5, v2
    v_xor_b32 v4, 2, v3
    v_lshl_add_u32 v62, v4, 5, v2
    v_xor_b32 v4, 3, v3
    v_lshl_add_u32 v63, v4, 5, v2
    v_lshrrev_b32 v3, 4, v1
    v_and_b32 v4, 7, v1
    v_lshrrev_b32 v2, 3, v1
    v_xor_b32 v4, v4, v3
    v_mul_u32_u24 v2, 1280, v2
    v_lshl_add_u32 v27, v4, 4, v2
    v_xor_b32 v28, 64, v27
    s_lshl_b32 s71, s40, 3
    s_lshl1_add_u32 s71, s30, s71
    s_mul_i32 s71, s71, 20480
    s_lshl_b32 s33, s41, 7
    s_add_u32 s71, s71, s33
    s_add_u32 s72, s71, 10240
    s_add_u32 s73, s71, 20480
    s_add_u32 s74, s71, 30720
    s_lshl_b32 s3, s30, 12
    s_add_u32 s3, s3, 140288
    v_lshl_add_u32 v33, v1, 4, s3
    v_and_b32 v2, 15, v1
    v_lshrrev_b32 v3, 1, v2
    v_lshrrev_b32 v4, 5, v1
    v_xor_b32 v3, v3, v4
    v_lshlrev_b32 v3, 4, v3
    v_lshl_add_u32 v3, v2, 7, v3
    v_and_b32 v4, 1, v9
    v_lshl_add_u32 v3, v4, 3, v3
    v_add_u32 v29, s3, v3
    v_xor_b32 v30, 32, v29
    v_xor_b32 v31, 64, v29
    v_xor_b32 v32, 96, v29
    s_and_b32 s33, s40, 3
    s_lshl_b32 s33, s33, 3
    s_lshr_b32 s33, 0x7f06037f, s33
    s_and_b32 s33, s33, 0xff
    s_lshl_b32 s3, s30, 1
    s_cmp_ge_u32 s3, s33
    s_cselect_b32 s64, 16, 0
    s_add_u32 s3, s3, 1
    s_cmp_ge_u32 s3, s33
    s_cselect_b32 s65, 16, 0
    s_mov_b32 s63, 0
    s_mov_b32 s66, 0
    s_mov_b32 s67, 16384
    s_mov_b32 s3, 1048576
K_P2_GWA:
    ds_read_b32 v2, v12 offset:72
    s_sub_u32 s3, s3, 1
    s_waitcnt lgkmcnt(0)
    v_readfirstlane_b32 s33, v2
    s_nop 3
    s_cselect_b32 s33, 4, s33
    s_cmp_lt_u32 s33, 4
    s_cbranch_scc1 K_P2_GWA
    s_branch K_P2_GEMM
WP_help:
    s_setpc_b64 s[38:39]
K_LATE:
    s_sub_u32 s44, s30, 4
K_WOL:
    s_lshl_b32 s50, s44, 2
    s_lshr_b32 s50, 0x6431, s50
    s_and_b32 s50, s50, 7
    s_mul_i32 s50, s50, 51200
    s_mul_i32 s51, s44, 5120
    s_add_u32 s3, s50, 0
    s_add_u32 m0, s51, 40960
    s_waitcnt vmcnt(13)
    buffer_load_dwordx4 v18, s[24:27], s3 offen lds
    s_add_u32 s3, s50, 10240
    s_add_u32 m0, s51, 41984
    s_waitcnt vmcnt(13)
    buffer_load_dwordx4 v18, s[24:27], s3 offen lds
    s_add_u32 s3, s50, 20480
    s_add_u32 m0, s51, 43008
    s_waitcnt vmcnt(13)
    buffer_load_dwordx4 v18, s[24:27], s3 offen lds
    s_add_u32 s3, s50, 30720
    s_add_u32 m0, s51, 44032
    s_waitcnt vmcnt(13)
    buffer_load_dwordx4 v18, s[24:27], s3 offen lds
    s_add_u32 s3, s50, 40960
    s_add_u32 m0, s51, 45056
    s_waitcnt vmcnt(13)
    buffer_load_dwordx4 v18, s[24:27], s3 offen lds
    s_add_u32 s3, s50, 409600
    s_add_u32 m0, s51, 61440
    s_waitcnt vmcnt(13)
    buffer_load_dwordx4 v18, s[24:27], s3 offen lds
    s_add_u32 s3, s50, 419840
    s_add_u32 m0, s51, 62464
    s_waitcnt vmcnt(13)
    buffer_load_dwordx4 v18, s[24:27], s3 offen lds
    s_add_u32 s3, s50, 430080
    s_add_u32 m0, s51, 63488
    s_waitcnt vmcnt(13)
    buffer_load_dwordx4 v18, s[24:27], s3 offen lds
    s_add_u32 s3, s50, 440320
    s_add_u32 m0, s51, 64512
    s_waitcnt vmcnt(13)
    buffer_load_dwordx4 v18, s[24:27], s3 offen lds
    s_add_u32 s3, s50, 450560
    s_add_u32 m0, s51, 65536
    s_waitcnt vmcnt(13)
    buffer_load_dwordx4 v18, s[24:27], s3 offen lds
    s_add_u32 s44, s44, 2
    s_cmp_lt_u32 s44, 4
    s_cbranch_scc1 K_WOL
    v_mov_b32 v2, 158720
    v_mov_b32 v3, 2
    s_waitcnt vmcnt(0)
    s_mov_b64 exec, 1
    ds_add_u32 v2, v3 offset:44
    s_mov_b64 exec, -1
K_P2_HELP:
    s_setprio 3
    s_add_u32 s59, s40, 1
    s_bitcmp1_b32 s59, 1
    s_cselect_b32 s59, 31, 15
    v_and_b32 v10, s59, v1
    v_lshl_add_u32 v10, v10, 2, s42
    s_cmp_lg_u32 s30, 7
    s_cbranch_scc1 K_P2_N7
    v_and_b32 v4, 7, v1
    v_lshlrev_b32 v4, 2, v4
    s_mov_b32 s3, 131072
K_ZPOLL1:
    v_cmp_eq_u32 vcc, 0, v7
    s_cbranch_vccz K_ZOK1
    s_sub_u32 s3, s3, 1
    s_cbranch_scc1 K_ZOK1
    global_load_dword v7, v4, s[8:9] offset:192 sc1
    s_waitcnt vmcnt(0)
    s_branch K_ZPOLL1
K_ZOK1:
    global_load_dword v7, v10, s[10:11] sc1
K_P2_N7:
    s_lshl_b32 s54, s40, 7
    v_lshrrev_b32 v9, 4, v1
    v_mov_b32 v12, 158720
    s_add_u32 s44, s10, 0x10000
    s_addc_u32 s45, s11, 0
    s_mov_b32 s46, 0x43800
    s_mov_b32 s47, 0x20000
    v_mov_b32 v80, 1
    s_cmp_eq_u32 s30, 7
    s_cbranch_scc1 K_P2_FLAGS
    s_cmp_lg_u32 s30, 6
    s_cbranch_scc1 K_END
    s_mov_b32 s3, 131072
K_P2_DPOLL:
    v_cmp_eq_u32 vcc, 0, v7
    s_cbranch_vccz K_P2_DOK
    s_cmp_eq_u32 s3, 131072
    s_cbranch_scc1 K_P2_DNS
    s_sleep 12
K_P2_DNS:
    v_and_b32 v11, 1, v1
    v_lshl_add_u32 v11, v11, 2, s42
    global_load_dword v7, v11, s[10:11] offset:128 sc1
    s_sub_u32 s3, s3, 1
    s_waitcnt vmcnt(0)
    s_cmp_lg_u32 s3, 0
    s_cbranch_scc1 K_P2_DPOLL
K_P2_DOK:
    v_readlane_b32 s58, v7, 0
    v_readlane_b32 s59, v7, 1
    s_nop 3
    s_and_b32 s3, s58, 0x7ff
    s_sub_u32 s3, 2047, s3
    v_mov_b32 v20, s3
    v_mov_b32 v4, s58
    v_and_b32 v4, 0xffff0000, v4
    v_ashrrev_i32 v5, 31, v4
    v_not_b32 v5, v5
    v_or_b32 v5, 0x80000000, v5
    v_xor_b32 v4, v4, v5
    v_and_b32 v4, 0xffff0000, v4
    v_mul_f32 v5, 0xbfb8aa3b, v4
    v_exp_f32 v5, v5
    s_nop 0
    v_add_f32 v5, 1.0, v5
    v_rcp_f32 v4, v5
    s_nop 0
    v_cvt_pk_bf16_f32 v22, v4, v4
    v_lshlrev_b32 v22, 16, v22
    s_and_b32 s3, s59, 0x7ff
    s_sub_u32 s3, 2047, s3
    v_mov_b32 v21, s3
    v_mov_b32 v4, s59
    v_and_b32 v4, 0xffff0000, v4
    v_ashrrev_i32 v5, 31, v4
    v_not_b32 v5, v5
    v_or_b32 v5, 0x80000000, v5
    v_xor_b32 v4, v4, v5
    v_and_b32 v4, 0xffff0000, v4
    v_mul_f32 v5, 0xbfb8aa3b, v4
    v_exp_f32 v5, v5
    s_nop 0
    v_add_f32 v5, 1.0, v5
    v_rcp_f32 v4, v5
    s_nop 0
    v_cvt_pk_bf16_f32 v23, v4, v4
    v_lshlrev_b32 v23, 16, v23
    ds_write_b128 v12, v[20:23]
    ds_write_b32 v12, v80 offset:40
    s_mov_b32 s53, 0
    v_mov_b32 v16, v20
    v_mov_b32 v17, v21
    v_mov_b32 v18, v22
    v_mov_b32 v19, v23
K_P2_HW:
    s_cmp_eq_u32 s53, 0
    s_cselect_b64 vcc, -1, 0
    s_nop 1
    v_cndmask_b32 v2, v17, v16, vcc
    v_cndmask_b32 v5, v19, v18, vcc
    s_nop 0
    v_readfirstlane_b32 s58, v2
    s_nop 3
    s_sub_u32 s3, s58, s54
    s_cmp_lt_u32 s3, 128
    s_cbranch_scc0 K_P2_YN
    s_call_b64 s[38:39], WP_yr0
    s_mul_i32 s3, s58, 1280
    s_lshl_b32 s33, s41, 7
    s_add_u32 s3, s3, s33
    v_and_b32 v2, 15, v1
    v_lshlrev_b32 v2, 3, v2
    buffer_load_dwordx2 v[84:85], v2, s[12:15], s3 offen
    s_lshl_b32 s3, s58, 2
    s_add_u32 s3, s3, 4096
    v_mov_b32 v2, s3
    global_load_dword v88, v2, s[10:11] sc1
    s_lshl1_add_u32 s3, s41, s53
    s_lshl_b32 s3, s3, 8
    s_add_u32 s3, s3, 568320
    v_min_u32 v3, 53, v1
    v_lshl_add_u32 v3, v3, 2, s3
    s_mov_b32 s3, 131072
K_P2_YPOLL:
    global_load_dword v2, v3, s[10:11] sc1
    s_sub_u32 s3, s3, 1
    s_waitcnt vmcnt(0)
    v_cmp_ne_u32 vcc, 1, v2
    s_cbranch_vccz K_P2_YGO
    s_sleep 16
    s_cmp_lg_u32 s3, 0
    s_cbranch_scc1 K_P2_YPOLL
K_P2_YGO:
    v_and_b32 v2, 15, v1
    v_lshlrev_b32 v2, 4, v2
    v_mul_u32_u24 v4, 5120, v9
    s_mov_b32 s59, s53
    s_mul_i32 s33, s59, 2560
    s_lshl_b32 s3, s41, 8
    s_add_u32 s3, s3, s33
    v_add3_u32 v3, v2, v4, s3
    s_mov_b32 s52, 0
    buffer_load_dwordx4 v[24:27], v3, s[44:47], s52 offen sc1
    s_mov_b32 s52, 20480
    buffer_load_dwordx4 v[28:31], v3, s[44:47], s52 offen sc1
    s_mov_b32 s52, 40960
    buffer_load_dwordx4 v[32:35], v3, s[44:47], s52 offen sc1
    s_mov_b32 s52, 61440
    buffer_load_dwordx4 v[36:39], v3, s[44:47], s52 offen sc1
    s_mov_b32 s52, 81920
    buffer_load_dwordx4 v[40:43], v3, s[44:47], s52 offen sc1
    s_mov_b32 s52, 102400
    buffer_load_dwordx4 v[44:47], v3, s[44:47], s52 offen sc1
    s_mov_b32 s52, 122880
    buffer_load_dwordx4 v[48:51], v3, s[44:47], s52 offen sc1
    s_mov_b32 s52, 143360
    buffer_load_dwordx4 v[52:55], v3, s[44:47], s52 offen sc1
    s_mov_b32 s52, 163840
    buffer_load_dwordx4 v[56:59], v3, s[44:47], s52 offen sc1
    s_mov_b32 s52, 184320
    buffer_load_dwordx4 v[60:63], v3, s[44:47], s52 offen sc1
    s_mov_b32 s52, 204800
    buffer_load_dwordx4 v[64:67], v3, s[44:47], s52 offen sc1
    s_mov_b32 s52, 225280
    buffer_load_dwordx4 v[68:71], v3, s[44:47], s52 offen sc1
    s_mov_b32 s52, 245760
    buffer_load_dwordx4 v[72:75], v3, s[44:47], s52 offen sc1
    s_mov_b32 s52, 266240
    buffer_load_dwordx4 v[76:79], v3, s[44:47], s52 offen sc1
    v_sub_f32 v88, 1.0, v88
    v_cvt_pk_bf16_f32 v88, v88, v88
    v_lshlrev_b32 v88, 16, v88
    v_lshlrev_b32 v86, 16, v85
    v_and_b32 v87, 0xffff0000, v85
    v_and_b32 v85, 0xffff0000, v84
    v_lshlrev_b32 v84, 16, v84
    s_waitcnt vmcnt(12)
    v_add_f32 v20, v24, v28
    v_add_f32 v21, v25, v29
    v_add_f32 v22, v26, v30
    v_add_f32 v23, v27, v31
    s_waitcnt vmcnt(11)
    v_add_f32 v20, v20, v32
    v_add_f32 v21, v21, v33
    v_add_f32 v22, v22, v34
    v_add_f32 v23, v23, v35
    s_waitcnt vmcnt(10)
    v_add_f32 v20, v20, v36
    v_add_f32 v21, v21, v37
    v_add_f32 v22, v22, v38
    v_add_f32 v23, v23, v39
    s_waitcnt vmcnt(9)
    v_add_f32 v20, v20, v40
    v_add_f32 v21, v21, v41
    v_add_f32 v22, v22, v42
    v_add_f32 v23, v23, v43
    s_waitcnt vmcnt(8)
    v_add_f32 v20, v20, v44
    v_add_f32 v21, v21, v45
    v_add_f32 v22, v22, v46
    v_add_f32 v23, v23, v47
    s_waitcnt vmcnt(7)
    v_add_f32 v20, v20, v48
    v_add_f32 v21, v21, v49
    v_add_f32 v22, v22, v50
    v_add_f32 v23, v23, v51
    s_waitcnt vmcnt(6)
    v_add_f32 v20, v20, v52
    v_add_f32 v21, v21, v53
    v_add_f32 v22, v22, v54
    v_add_f32 v23, v23, v55
    s_waitcnt vmcnt(5)
    v_add_f32 v20, v20, v56
    v_add_f32 v21, v21, v57
    v_add_f32 v22, v22, v58
    v_add_f32 v23, v23, v59
    s_waitcnt vmcnt(4)
    v_add_f32 v20, v20, v60
    v_add_f32 v21, v21, v61
    v_add_f32 v22, v22, v62
    v_add_f32 v23, v23, v63
    s_waitcnt vmcnt(3)
    v_add_f32 v20, v20, v64
    v_add_f32 v21, v21, v65
    v_add_f32 v22, v22, v66
    v_add_f32 v23, v23, v67
    s_waitcnt vmcnt(2)
    v_add_f32 v20, v20, v68
    v_add_f32 v21, v21, v69
    v_add_f32 v22, v22, v70
    v_add_f32 v23, v23, v71
    s_waitcnt vmcnt(1)
    v_add_f32 v20, v20, v72
    v_add_f32 v21, v21, v73
    v_add_f32 v22, v22, v74
    v_add_f32 v23, v23, v75
    s_waitcnt vmcnt(0)
    v_add_f32 v20, v20, v76
    v_add_f32 v21, v21, v77
    v_add_f32 v22, v22, v78
    v_add_f32 v23, v23, v79
    v_mov_b32 v24, v20
    v_mov_b32 v25, v21
    v_mov_b32 v26, v22
    v_mov_b32 v27, v23
    s_nop 0
    v_permlane16_swap_b32 v20, v24
    v_permlane16_swap_b32 v21, v25
    v_permlane16_swap_b32 v22, v26
    v_permlane16_swap_b32 v23, v27
    v_add_f32 v20, v20, v24
    v_add_f32 v21, v21, v25
    v_add_f32 v22, v22, v26
    v_add_f32 v23, v23, v27
    v_mov_b32 v24, v20
    v_mov_b32 v25, v21
    v_mov_b32 v26, v22
    v_mov_b32 v27, v23
    s_nop 0
    v_permlane32_swap_b32 v20, v24
    v_permlane32_swap_b32 v21, v25
    v_permlane32_swap_b32 v22, v26
    v_permlane32_swap_b32 v23, v27
    v_add_f32 v20, v20, v24
    v_add_f32 v21, v21, v25
    v_add_f32 v22, v22, v26
    v_add_f32 v23, v23, v27
    v_cvt_pk_bf16_f32 v20, v20, v20
    v_lshlrev_b32 v20, 16, v20
    v_mul_f32 v20, v5, v20
    v_cvt_pk_bf16_f32 v20, v20, v20
    v_lshlrev_b32 v20, 16, v20
    v_add_f32 v20, v20, v84
    v_cvt_pk_bf16_f32 v20, v20, v20
    v_lshlrev_b32 v20, 16, v20
    v_mul_f32 v20, v20, v88
    v_cvt_pk_bf16_f32 v21, v21, v21
    v_lshlrev_b32 v21, 16, v21
    v_mul_f32 v21, v5, v21
    v_cvt_pk_bf16_f32 v21, v21, v21
    v_lshlrev_b32 v21, 16, v21
    v_add_f32 v21, v21, v85
    v_cvt_pk_bf16_f32 v21, v21, v21
    v_lshlrev_b32 v21, 16, v21
    v_mul_f32 v21, v21, v88
    v_cvt_pk_bf16_f32 v22, v22, v22
    v_lshlrev_b32 v22, 16, v22
    v_mul_f32 v22, v5, v22
    v_cvt_pk_bf16_f32 v22, v22, v22
    v_lshlrev_b32 v22, 16, v22
    v_add_f32 v22, v22, v86
    v_cvt_pk_bf16_f32 v22, v22, v22
    v_lshlrev_b32 v22, 16, v22
    v_mul_f32 v22, v22, v88
    v_cvt_pk_bf16_f32 v23, v23, v23
    v_lshlrev_b32 v23, 16, v23
    v_mul_f32 v23, v5, v23
    v_cvt_pk_bf16_f32 v23, v23, v23
    v_lshlrev_b32 v23, 16, v23
    v_add_f32 v23, v23, v87
    v_cvt_pk_bf16_f32 v23, v23, v23
    v_lshlrev_b32 v23, 16, v23
    v_mul_f32 v23, v23, v88
    s_lshl_b32 s3, s59, 8
    s_add_u32 s3, s3, 158976
    v_add_u32 v2, s3, v2
    ds_write_b128 v2, v[20:23]
    s_lshl_b32 s3, s59, 2
    v_add_u32 v2, s3, v12
    ds_write_b32 v2, v80 offset:64
K_P2_YN:
    s_add_u32 s53, s53, 1
    s_cmp_lt_u32 s53, 2
    s_cbranch_scc1 K_P2_HW
    s_branch K_END
WP_flags:
    s_setpc_b64 s[38:39]
K_P2_FLAGS:
    s_mov_b32 exec_hi, 0
    s_waitcnt vmcnt(0)
    s_mov_b32 s3, 131072
K_P2_FCHK:
    v_cmp_eq_u32 vcc, 1, v7
    s_nop 1
    v_mov_b32 v2, vcc_lo
    ds_write_b32 v12, v2 offset:32
    s_cmp_eq_u32 vcc_lo, -1
    s_cbranch_scc1 K_P2_FGO
    s_cmp_lg_u32 vcc_lo, 0
    s_cbranch_scc1 K_P2_FS
    s_sleep 4
K_P2_FS:
    s_sleep 6
    global_load_dword v7, v10, s[10:11] sc1
    s_sub_u32 s3, s3, 1
    s_waitcnt vmcnt(0)
    s_cbranch_scc0 K_P2_FCHK
    v_mov_b32 v2, -1
    ds_write_b32 v12, v2 offset:32
K_P2_FGO:
    s_mov_b64 exec, -1
    s_branch K_END
.p2align 12
K_AUX:
    s_load_dwordx8 s[48:55], s[0:1], 32
    s_load_dwordx2 s[56:57], s[0:1], 64
    s_mul_i32 s44, s28, 7
    s_add_u32 s44, s44, s29
    s_sub_u32 s44, s44, 1
    s_cmp_lt_u32 s44, 54
    s_cselect_b32 s44, s44, 63
    s_cmp_eq_u32 s29, 0
    s_cselect_b32 s44, 63, s44
    s_lshl_b32 s74, s28, 8
    s_lshl_b32 s3, s29, 5
    s_add_u32 s74, s74, s3
    v_mov_b32 v12, 158720
    v_mov_b32 v13, 1
    s_cmp_lt_u32 s30, 4
    s_cbranch_scc1 K_AUX_LO
    s_lshl_b32 s3, s30, 3
    s_add_u32 s3, s3, s74
    s_sub_u32 s3, s3, 32
    v_lshrrev_b32 v9, 3, v1
    v_add_u32 v9, s3, v9
    v_and_b32 v11, 7, v1
    v_lshlrev_b32 v11, 4, v11
    v_mul_u32_u24 v10, 1280, v9
    v_add_u32 v10, v10, v11
    s_waitcnt lgkmcnt(0)
    buffer_load_dwordx4 v[16:19], v10, s[12:15], 0 offen offset:0
    buffer_load_dwordx4 v[20:23], v10, s[12:15], 0 offen offset:128
    buffer_load_dwordx4 v[24:27], v10, s[12:15], 0 offen offset:256
    buffer_load_dwordx4 v[28:31], v10, s[12:15], 0 offen offset:384
    buffer_load_dwordx4 v[32:35], v10, s[12:15], 0 offen offset:512
    buffer_load_dwordx4 v[36:39], v10, s[12:15], 0 offen offset:640
    buffer_load_dwordx4 v[40:43], v10, s[12:15], 0 offen offset:768
    buffer_load_dwordx4 v[44:47], v10, s[12:15], 0 offen offset:896
    buffer_load_dwordx4 v[48:51], v10, s[12:15], 0 offen offset:1024
    buffer_load_dwordx4 v[52:55], v10, s[12:15], 0 offen offset:1152
    s_mov_b32 s16, s48
    s_mov_b32 s17, s49
    s_mov_b32 s18, 0x500
    s_mov_b32 s19, 0x20000
    s_mov_b32 s20, s56
    s_mov_b32 s21, s57
    s_mov_b32 s22, 0x500
    s_mov_b32 s23, 0x20000
    buffer_load_dwordx4 v[56:59], v11, s[16:19], 0 offen offset:0
    buffer_load_dwordx4 v[60:63], v11, s[16:19], 0 offen offset:128
    buffer_load_dwordx4 v[64:67], v11, s[16:19], 0 offen offset:256
    buffer_load_dwordx4 v[68:71], v11, s[16:19], 0 offen offset:384
    buffer_load_dwordx4 v[72:75], v11, s[16:19], 0 offen offset:512
    buffer_load_dwordx4 v[76:79], v11, s[16:19], 0 offen offset:640
    buffer_load_dwordx4 v[80:83], v11, s[16:19], 0 offen offset:768
    buffer_load_dwordx4 v[84:87], v11, s[16:19], 0 offen offset:896
    buffer_load_dwordx4 v[88:91], v11, s[16:19], 0 offen offset:1024
    buffer_load_dwordx4 v[92:95], v11, s[16:19], 0 offen offset:1152
    buffer_load_dwordx4 v[96:99], v11, s[20:23], 0 offen offset:0
    buffer_load_dwordx4 v[100:103], v11, s[20:23], 0 offen offset:128
    buffer_load_dwordx4 v[104:107], v11, s[20:23], 0 offen offset:256
    buffer_load_dwordx4 v[108:111], v11, s[20:23], 0 offen offset:384
    buffer_load_dwordx4 v[112:115], v11, s[20:23], 0 offen offset:512
    buffer_load_dwordx4 v[116:119], v11, s[20:23], 0 offen offset:640
    buffer_load_dwordx4 v[120:123], v11, s[20:23], 0 offen offset:768
    buffer_load_dwordx4 v[124:127], v11, s[20:23], 0 offen offset:896
    buffer_load_dwordx4 v[128:131], v11, s[20:23], 0 offen offset:1024
    buffer_load_dwordx4 v[132:135], v11, s[20:23], 0 offen offset:1152
    s_barrier
    v_mov_b32 v180, 0
    v_mov_b32 v181, 0
    v_mov_b32 v182, 0
    v_mov_b32 v183, 0
    v_and_b32 v10, 31, v9
    v_lshlrev_b32 v10, 2, v10
    v_add_u32 v10, 122880, v10
    v_sub_u32 v4, 0x87ff, v9
    s_setprio 2
    s_waitcnt vmcnt(10)
    v_dot2c_f32_bf16 v180, v16, v56
    v_dot2c_f32_bf16 v181, v17, v57
    v_dot2c_f32_bf16 v180, v18, v58
    v_dot2c_f32_bf16 v181, v19, v59
    v_dot2c_f32_bf16 v180, v20, v60
    v_dot2c_f32_bf16 v181, v21, v61
    v_dot2c_f32_bf16 v180, v22, v62
    v_dot2c_f32_bf16 v181, v23, v63
    v_dot2c_f32_bf16 v180, v24, v64
    v_dot2c_f32_bf16 v181, v25, v65
    v_dot2c_f32_bf16 v180, v26, v66
    v_dot2c_f32_bf16 v181, v27, v67
    v_dot2c_f32_bf16 v180, v28, v68
    v_dot2c_f32_bf16 v181, v29, v69
    v_dot2c_f32_bf16 v180, v30, v70
    v_dot2c_f32_bf16 v181, v31, v71
    v_dot2c_f32_bf16 v180, v32, v72
    v_dot2c_f32_bf16 v181, v33, v73
    v_dot2c_f32_bf16 v180, v34, v74
    v_dot2c_f32_bf16 v181, v35, v75
    v_dot2c_f32_bf16 v180, v36, v76
    v_dot2c_f32_bf16 v181, v37, v77
    v_dot2c_f32_bf16 v180, v38, v78
    v_dot2c_f32_bf16 v181, v39, v79
    v_dot2c_f32_bf16 v180, v40, v80
    v_dot2c_f32_bf16 v181, v41, v81
    v_dot2c_f32_bf16 v180, v42, v82
    v_dot2c_f32_bf16 v181, v43, v83
    v_dot2c_f32_bf16 v180, v44, v84
    v_dot2c_f32_bf16 v181, v45, v85
    v_dot2c_f32_bf16 v180, v46, v86
    v_dot2c_f32_bf16 v181, v47, v87
    v_dot2c_f32_bf16 v180, v48, v88
    v_dot2c_f32_bf16 v181, v49, v89
    v_dot2c_f32_bf16 v180, v50, v90
    v_dot2c_f32_bf16 v181, v51, v91
    v_dot2c_f32_bf16 v180, v52, v92
    v_dot2c_f32_bf16 v181, v53, v93
    v_dot2c_f32_bf16 v180, v54, v94
    v_dot2c_f32_bf16 v181, v55, v95
    s_waitcnt vmcnt(0)
    v_dot2c_f32_bf16 v182, v16, v96
    v_dot2c_f32_bf16 v183, v17, v97
    v_dot2c_f32_bf16 v182, v18, v98
    v_dot2c_f32_bf16 v183, v19, v99
    v_dot2c_f32_bf16 v182, v20, v100
    v_dot2c_f32_bf16 v183, v21, v101
    v_dot2c_f32_bf16 v182, v22, v102
    v_dot2c_f32_bf16 v183, v23, v103
    v_dot2c_f32_bf16 v182, v24, v104
    v_dot2c_f32_bf16 v183, v25, v105
    v_dot2c_f32_bf16 v182, v26, v106
    v_dot2c_f32_bf16 v183, v27, v107
    v_dot2c_f32_bf16 v182, v28, v108
    v_dot2c_f32_bf16 v183, v29, v109
    v_dot2c_f32_bf16 v182, v30, v110
    v_dot2c_f32_bf16 v183, v31, v111
    v_dot2c_f32_bf16 v182, v32, v112
    v_dot2c_f32_bf16 v183, v33, v113
    v_dot2c_f32_bf16 v182, v34, v114
    v_dot2c_f32_bf16 v183, v35, v115
    v_dot2c_f32_bf16 v182, v36, v116
    v_dot2c_f32_bf16 v183, v37, v117
    v_dot2c_f32_bf16 v182, v38, v118
    v_dot2c_f32_bf16 v183, v39, v119
    v_dot2c_f32_bf16 v182, v40, v120
    v_dot2c_f32_bf16 v183, v41, v121
    v_dot2c_f32_bf16 v182, v42, v122
    v_dot2c_f32_bf16 v183, v43, v123
    v_dot2c_f32_bf16 v182, v44, v124
    v_dot2c_f32_bf16 v183, v45, v125
    v_dot2c_f32_bf16 v182, v46, v126
    v_dot2c_f32_bf16 v183, v47, v127
    v_dot2c_f32_bf16 v182, v48, v128
    v_dot2c_f32_bf16 v183, v49, v129
    v_dot2c_f32_bf16 v182, v50, v130
    v_dot2c_f32_bf16 v183, v51, v131
    v_dot2c_f32_bf16 v182, v52, v132
    v_dot2c_f32_bf16 v183, v53, v133
    v_dot2c_f32_bf16 v182, v54, v134
    v_dot2c_f32_bf16 v183, v55, v135
    s_nop 2
    v_add_f32 v180, v180, v181
    v_add_f32 v182, v182, v183
    s_nop 0
    v_add_f32_dpp v180, v180, v180 quad_perm:[1,0,3,2] row_mask:0xf bank_mask:0xf
    v_add_f32_dpp v182, v182, v182 quad_perm:[1,0,3,2] row_mask:0xf bank_mask:0xf
    s_nop 0
    v_add_f32_dpp v180, v180, v180 quad_perm:[2,3,0,1] row_mask:0xf bank_mask:0xf
    v_add_f32_dpp v182, v182, v182 quad_perm:[2,3,0,1] row_mask:0xf bank_mask:0xf
    s_nop 0
    v_add_f32_dpp v180, v180, v180 row_half_mirror row_mask:0xf bank_mask:0xf
    v_add_f32_dpp v182, v182, v182 row_half_mirror row_mask:0xf bank_mask:0xf
    v_cvt_pk_bf16_f32 v2, v180, v180
    v_lshlrev_b32 v2, 16, v2
    v_ashrrev_i32 v3, 31, v2
    v_or_b32 v3, 0x80000000, v3
    v_xor_b32 v2, v2, v3
    v_and_b32 v2, 0xffff0000, v2
    v_or_b32 v2, v2, v4
    ds_write2_b32 v10, v2, v182 offset0:0 offset1:32
    s_mov_b64 exec, 1
    ds_add_u32 v12, v13 offset:36
    s_mov_b64 exec, -1
    s_setprio 0
    s_cmp_lg_u32 s30, 4
    s_cbranch_scc1 K_WARMA0
    s_call_b64 s[38:39], WP_p2g
    s_branch K_WARMAX
K_WARMA0:
    s_cmp_lg_u32 s30, 5
    s_cbranch_scc1 K_WARMA1
    s_call_b64 s[38:39], WP_gen
    s_branch K_WARMAX
K_WARMA1:
    s_cmp_lg_u32 s30, 6
    s_cbranch_scc1 K_WARMA2
    s_call_b64 s[38:39], WP_help
    s_call_b64 s[38:39], WP_flags
    s_branch K_WARMAX
K_WARMA2:
    s_call_b64 s[38:39], WP_spin
K_WARMAX:
    s_cmp_ge_u32 s30, 6
    s_cselect_b32 s44, 63, s44
    s_cmp_lg_u32 s44, 63
    s_cbranch_scc1 K_FFN_C
    s_mov_b32 s3, 1048576
K_FGH:
    ds_read_b32 v2, v12 offset:48
    s_sleep 8
    s_sub_u32 s3, s3, 1
    s_waitcnt lgkmcnt(0)
    v_readfirstlane_b32 s33, v2
    s_nop 3
    s_cselect_b32 s33, 1, s33
    s_cmp_lt_u32 s33, 1
    s_cbranch_scc1 K_FGH
    s_cmp_eq_u32 s30, 6
    s_cbranch_scc1 K_P2_HELP
    v_mov_b32 v7, 1
    s_branch K_P2_HELP
K_AUX_LO:
    s_waitcnt lgkmcnt(0)
    s_cmp_eq_u32 s30, 0
    s_cbranch_scc1 K_AUX_PUB
    s_cmp_eq_u32 s44, 63
    s_cbranch_scc1 K_AUX_NOF
    s_and_b32 s3, s44, 1
    s_cmp_eq_u32 s3, 0
    s_cselect_b64 s[60:61], s[50:51], s[52:53]
    s_cselect_b64 s[64:65], s[52:53], s[50:51]
    s_cselect_b32 s75, 0, 40960
    s_mov_b32 s62, 0x21c000
    s_mov_b32 s63, 0x20000
    s_mov_b32 s66, 0x21c000
    s_mov_b32 s67, 0x20000
    v_lshrrev_b32 v2, 2, v1
    v_mul_u32_u24 v184, 3456, v2
    v_and_b32 v2, 3, v1
    v_lshl_add_u32 v184, v2, 4, v184
    s_lshl_b32 s72, s44, 6
    v_add_u32 v184, s72, v184
    s_sub_u32 s74, s30, 1
K_FSA0:
    s_lshl_b32 s73, s74, 10
    s_mul_i32 s72, s74, 55296
    s_add_u32 m0, s73, s75
    s_waitcnt vmcnt(7)
    buffer_load_dwordx4 v184, s[60:63], s72 offen lds
    s_add_u32 s74, s74, 3
    s_cmp_lt_u32 s74, 24
    s_cbranch_scc1 K_FSA0
    s_barrier
    s_mov_b32 s3, 1048576
K_FGPB:
    ds_read_b32 v2, v12 offset:36
    s_sleep 1
    s_sub_u32 s3, s3, 1
    s_waitcnt lgkmcnt(0)
    v_readfirstlane_b32 s33, v2
    s_nop 3
    s_cselect_b32 s33, 5, s33
    s_cmp_lt_u32 s33, 5
    s_cbranch_scc1 K_FGPB
K_FSA:
    s_lshl_b32 s73, s74, 10
    s_mul_i32 s72, s74, 55296
    s_add_u32 m0, s73, s75
    s_waitcnt vmcnt(7)
    buffer_load_dwordx4 v184, s[60:63], s72 offen lds
    s_add_u32 s74, s74, 3
    s_cmp_lt_u32 s74, 40
    s_cbranch_scc1 K_FSA
    s_sub_u32 s74, s74, 40
    s_xor_b32 s75, s75, 40960
    s_mov_b32 s68, s54
    s_mov_b32 s69, s55
    s_mov_b32 s70, 0x21c000
    s_mov_b32 s71, 0x20000
    s_mul_i32 s3, s44, 40960
    v_lshrrev_b32 v2, 3, v1
    v_mul_u32_u24 v2, 1280, v2
    v_lshrrev_b32 v3, 4, v1
    v_lshlrev_b32 v3, 1, v3
    v_and_b32 v4, 7, v1
    v_xor_b32 v3, v3, v4
    v_lshl_add_u32 v2, v3, 4, v2
    v_add_u32 v185, s3, v2
K_FSB:
    s_lshl_b32 s73, s74, 10
    s_mul_i32 s72, s74, 55296
    s_add_u32 m0, s73, s75
    s_waitcnt vmcnt(7)
    buffer_load_dwordx4 v184, s[64:67], s72 offen lds
    s_add_u32 s74, s74, 3
    s_cmp_lt_u32 s74, 40
    s_cbranch_scc1 K_FSB
    s_sub_u32 s74, s74, 40
    s_mov_b32 s75, 81920
K_FSD0:
    s_lshl_b32 s73, s74, 10
    s_and_b32 s72, s74, 3
    s_mul_i32 s72, s72, 10208
    s_lshl_b32 s3, s74, 5
    s_add_u32 s72, s72, s3
    s_add_u32 m0, s73, s75
    s_waitcnt vmcnt(7)
    buffer_load_dwordx4 v185, s[68:71], s72 offen lds
    s_add_u32 s74, s74, 3
    s_cmp_lt_u32 s74, 24
    s_cbranch_scc1 K_FSD0
    s_waitcnt vmcnt(8)
    s_mov_b64 exec, 1
    ds_add_u32 v12, v13 offset:56
    s_mov_b64 exec, -1
K_FSD:
    s_lshl_b32 s73, s74, 10
    s_and_b32 s72, s74, 3
    s_mul_i32 s72, s72, 10208
    s_lshl_b32 s3, s74, 5
    s_add_u32 s72, s72, s3
    s_add_u32 m0, s73, s75
    s_waitcnt vmcnt(7)
    buffer_load_dwordx4 v185, s[68:71], s72 offen lds
    s_add_u32 s74, s74, 3
    s_cmp_lt_u32 s74, 40
    s_cbranch_scc1 K_FSD
    s_mul_i32 s3, s29, 96
    s_lshl_b32 s72, s30, 5
    s_add_u32 s3, s3, s72
    s_sub_u32 s3, s3, 128
    v_lshrrev_b32 v2, 1, v1
    v_add_u32 v2, s3, v2
    v_mul_u32_u24 v2, 1280, v2
    v_and_b32 v3, 1, v1
    v_lshl_add_u32 v2, v3, 7, v2
    buffer_load_dword v6, v2, s[24:27], 0 offen offset:1024
K_AUX_WR:
    s_mov_b32 s3, 1048576
K_FGR:
    ds_read_b32 v2, v12 offset:60
    s_sleep 2
    s_sub_u32 s3, s3, 1
    s_waitcnt lgkmcnt(0)
    v_readfirstlane_b32 s33, v2
    s_nop 3
    s_cselect_b32 s33, 2, s33
    s_cmp_lt_u32 s33, 2
    s_cbranch_scc1 K_FGR
    s_branch K_P2
K_AUX_NOF:
    s_cmp_lg_u32 s2, 63
    s_cbranch_scc1 K_AUX_NOZ
    s_cmp_lg_u32 s30, 1
    s_cbranch_scc1 K_AUX_NOZ
    s_add_u32 s60, s10, 0x80000
    s_addc_u32 s61, s11, 0
    s_mov_b32 s62, 0xc000
    s_mov_b32 s63, 0x20000
    v_mov_b32 v9, 786432
    global_load_dword v10, v9, s[10:11] sc1
    v_lshlrev_b32 v11, 4, v1
    v_add_u32 v11, 790528, v11
    global_load_dword v6, v11, s[10:11] sc1
    s_barrier
    s_mov_b32 s3, 1048576
K_FGZ:
    ds_read_b32 v2, v12 offset:36
    s_sleep 2
    s_sub_u32 s3, s3, 1
    s_waitcnt lgkmcnt(0)
    v_readfirstlane_b32 s33, v2
    s_nop 3
    s_cselect_b32 s33, 4, s33
    s_cmp_lt_u32 s33, 4
    s_cbranch_scc1 K_FGZ
    v_and_b32 v4, 7, v1
    v_lshlrev_b32 v4, 2, v4
    global_load_dword v7, v4, s[8:9] offset:192 sc1
    s_waitcnt vmcnt(1)
    v_add_u32 v10, 1, v10
    s_mov_b32 s3, 131072
    s_setprio 3
K_AG2_POLL:
    global_load_dwordx4 v[16:19], v11, s[10:11] sc1
    s_waitcnt vmcnt(0)
    v_xor_b32 v2, v10, v17
    v_xor_b32 v3, v10, v19
    v_or_b32 v2, v2, v3
    v_cmp_ne_u32 vcc, 0, v2
    s_cbranch_vccz K_AG2_GOT
    s_sleep 2
    s_sub_u32 s3, s3, 1
    s_cmp_lg_u32 s3, 0
    s_cbranch_scc1 K_AG2_POLL
K_AG2_GOT:
    s_nop 1
    v_max_u32_dpp v3, v16, v16 quad_perm:[1,0,3,2] row_mask:0xf bank_mask:0xf
    s_nop 1
    v_max_u32_dpp v3, v3, v3 quad_perm:[2,3,0,1] row_mask:0xf bank_mask:0xf
    s_nop 1
    v_max_u32_dpp v3, v3, v3 row_half_mirror row_mask:0xf bank_mask:0xf
    s_nop 1
    v_max_u32_dpp v3, v3, v3 row_mirror row_mask:0xf bank_mask:0xf
    s_nop 1
    v_readlane_b32 s74, v3, 0
    v_readlane_b32 s76, v3, 16
    v_readlane_b32 s77, v3, 32
    v_readlane_b32 s78, v3, 48
    s_nop 3
    s_max_u32 s74, s74, s76
    s_max_u32 s77, s77, s78
    s_max_u32 s74, s74, s77
    v_cmp_ne_u32 vcc, s74, v16
    s_nop 1
    v_cndmask_b32 v2, v18, v16, vcc
    s_nop 1
    v_max_u32_dpp v3, v2, v2 quad_perm:[1,0,3,2] row_mask:0xf bank_mask:0xf
    s_nop 1
    v_max_u32_dpp v3, v3, v3 quad_perm:[2,3,0,1] row_mask:0xf bank_mask:0xf
    s_nop 1
    v_max_u32_dpp v3, v3, v3 row_half_mirror row_mask:0xf bank_mask:0xf
    s_nop 1
    v_max_u32_dpp v3, v3, v3 row_mirror row_mask:0xf bank_mask:0xf
    s_nop 1
    v_readlane_b32 s75, v3, 0
    v_readlane_b32 s76, v3, 16
    v_readlane_b32 s77, v3, 32
    v_readlane_b32 s78, v3, 48
    s_nop 3
    s_max_u32 s75, s75, s76
    s_max_u32 s77, s77, s78
    s_max_u32 s75, s75, s77
    v_mov_b32 v176, s74
    v_mov_b32 v177, s75
    v_and_b32 v4, 7, v1
    v_lshlrev_b32 v4, 2, v4
    s_mov_b32 s3, 131072
K_ZPOLL4:
    v_cmp_eq_u32 vcc, 0, v7
    s_cbranch_vccz K_ZOK4
    s_sub_u32 s3, s3, 1
    s_cbranch_scc1 K_ZOK4
    global_load_dword v7, v4, s[8:9] offset:192 sc1
    s_waitcnt vmcnt(0)
    s_branch K_ZPOLL4
K_ZOK4:
    v_and_b32 v2, 7, v1
    v_mul_u32_u24 v2, 20, v2
    v_lshrrev_b32 v3, 3, v1
    v_add_lshl_u32 v2, v2, v3, 8
    buffer_store_dwordx2 v[176:177], v2, s[60:63], 0 offen offset:136 sc1
    s_mov_b64 exec, 1
    global_store_dword v9, v10, s[10:11] sc1
    s_mov_b64 exec, -1
    v_lshlrev_b32 v4, 2, v1
    s_mov_b32 s72, 43008
    s_mov_b32 s3, 131072
K_AGG_POLL:
    s_sleep 8
    buffer_load_dword v2, v4, s[60:63], s72 offen sc1
    s_waitcnt vmcnt(0)
    v_cmp_eq_u32 vcc, 0, v2
    s_cbranch_vccz K_AGG_GOT
    s_sub_u32 s3, s3, 1
    s_cmp_lg_u32 s3, 0
    s_cbranch_scc1 K_AGG_POLL
K_AGG_GOT:
    s_mov_b32 s62, 40960
    v_lshlrev_b32 v3, 8, v1
    s_mov_b32 s3, 0
    buffer_store_dwordx2 v[176:177], v3, s[60:63], s3 offen offset:128 sc1
    s_mov_b32 s3, 16384
    buffer_store_dwordx2 v[176:177], v3, s[60:63], s3 offen offset:128 sc1
    s_mov_b32 s3, 32768
    buffer_store_dwordx2 v[176:177], v3, s[60:63], s3 offen offset:128 sc1
    s_setprio 0
    s_branch K_AUX_NOK
K_AUX_NOZ:
    s_barrier
K_AUX_NOK:
    s_mov_b32 s3, 1048576
K_FGWD:
    ds_read_b32 v2, v12 offset:48
    s_sleep 4
    s_sub_u32 s3, s3, 1
    s_waitcnt lgkmcnt(0)
    v_readfirstlane_b32 s33, v2
    s_nop 3
    s_cselect_b32 s33, 1, s33
    s_cmp_lt_u32 s33, 1
    s_cbranch_scc1 K_FGWD
    s_branch K_P2
K_AUX_PUB:
    s_add_u32 s60, s10, 0x1000
    s_addc_u32 s61, s11, 0
    s_mov_b32 s62, 0x2000
    s_mov_b32 s63, 0x20000
    v_and_b32 v3, 31, v1
    v_lshlrev_b32 v10, 2, v3
    v_add_u32 v11, 122880, v10
    s_lshl_b32 s72, s74, 2
    v_mov_b32 v2, 786432
    global_load_dword v17, v2, s[10:11] sc1
    s_lshl_b32 s3, s2, 2
    s_add_u32 s3, s3, 567296
    v_mov_b32 v9, s3
    s_lshl_b32 s3, s2, 4
    s_add_u32 s3, s3, 790528
    v_lshl_add_u32 v20, v1, 4, s3
    v_and_b32 v5, 7, v1
    v_lshlrev_b32 v5, 2, v5
    s_barrier
    s_setprio 3
    s_waitcnt vmcnt(0)
    v_add_u32 v17, 1, v17
    v_mov_b32 v19, v17
    s_mov_b32 s3, 1048576
K_FGRT:
    ds_read_b32 v2, v12 offset:36
    s_sleep 0
    s_sub_u32 s3, s3, 1
    s_waitcnt lgkmcnt(0)
    v_readfirstlane_b32 s33, v2
    s_nop 3
    s_cselect_b32 s33, 4, s33
    s_cmp_lt_u32 s33, 4
    s_cbranch_scc1 K_FGRT
    ds_read2_b32 v[176:177], v11 offset0:0 offset1:32
    s_waitcnt lgkmcnt(0)
    s_nop 1
    v_max_u32_dpp v3, v176, v176 quad_perm:[1,0,3,2] row_mask:0xf bank_mask:0xf
    s_nop 1
    v_max_u32_dpp v3, v3, v3 quad_perm:[2,3,0,1] row_mask:0xf bank_mask:0xf
    s_nop 1
    v_max_u32_dpp v3, v3, v3 row_half_mirror row_mask:0xf bank_mask:0xf
    s_nop 1
    v_max_u32_dpp v3, v3, v3 row_mirror row_mask:0xf bank_mask:0xf
    s_nop 1
    v_readlane_b32 s74, v3, 0
    v_readlane_b32 s76, v3, 16
    v_readlane_b32 s77, v3, 32
    v_readlane_b32 s78, v3, 48
    s_nop 3
    s_max_u32 s74, s74, s76
    s_max_u32 s77, s77, s78
    s_max_u32 s74, s74, s77
    v_cmp_ne_u32 vcc, s74, v176
    s_nop 1
    v_cndmask_b32 v176, 0, v176, vcc
    s_nop 1
    v_max_u32_dpp v3, v176, v176 quad_perm:[1,0,3,2] row_mask:0xf bank_mask:0xf
    s_nop 1
    v_max_u32_dpp v3, v3, v3 quad_perm:[2,3,0,1] row_mask:0xf bank_mask:0xf
    s_nop 1
    v_max_u32_dpp v3, v3, v3 row_half_mirror row_mask:0xf bank_mask:0xf
    s_nop 1
    v_max_u32_dpp v3, v3, v3 row_mirror row_mask:0xf bank_mask:0xf
    s_nop 1
    v_readlane_b32 s75, v3, 0
    v_readlane_b32 s76, v3, 16
    v_readlane_b32 s77, v3, 32
    v_readlane_b32 s78, v3, 48
    s_nop 3
    s_max_u32 s75, s75, s76
    s_max_u32 s77, s77, s78
    s_max_u32 s75, s75, s77
    v_mov_b32 v16, s74
    v_mov_b32 v18, s75
    s_mov_b64 exec, 1
    global_store_dwordx4 v20, v[16:19], s[10:11] sc1
    s_mov_b64 exec, -1
    s_mov_b64 exec, 1
    ds_add_u32 v12, v13 offset:36
    s_mov_b64 exec, -1
    global_load_dword v7, v5, s[8:9] offset:192 sc1
    v_cvt_pk_bf16_f32 v177, v177, v177
    v_lshlrev_b32 v177, 16, v177
    v_mul_f32 v3, 0xbfb8aa3b, v177
    v_exp_f32 v3, v3
    s_nop 0
    v_add_f32 v3, 1.0, v3
    v_rcp_f32 v177, v3
    s_nop 0
    v_cvt_pk_bf16_f32 v177, v177, v177
    v_lshlrev_b32 v177, 16, v177
    s_mov_b32 exec_hi, 0
    buffer_store_dword v177, v10, s[60:63], s72 offen sc1
    s_mov_b64 exec, -1
    s_waitcnt vmcnt(0)
    v_and_b32 v4, 7, v1
    v_lshlrev_b32 v4, 2, v4
    s_mov_b32 s3, 131072
K_ZPOLL3:
    v_cmp_eq_u32 vcc, 0, v7
    s_cbranch_vccz K_ZOK3
    s_sub_u32 s3, s3, 1
    s_cbranch_scc1 K_ZOK3
    global_load_dword v7, v4, s[8:9] offset:192 sc1
    s_waitcnt vmcnt(0)
    s_branch K_ZPOLL3
K_ZOK3:
    s_mov_b64 exec, 1
    global_store_dword v9, v13, s[10:11] sc1
    s_mov_b64 exec, -1
    v_and_b32 v3, 1, v1
    v_lshl_add_u32 v3, v3, 2, s42
    v_lshlrev_b32 v10, 4, v1
    s_mov_b32 s3, 131072
K_AUX_POLL:
    s_sleep 6
    global_load_dword v2, v3, s[10:11] offset:136 sc1
    s_waitcnt vmcnt(0)
    v_cmp_eq_u32 vcc, 0, v2
    s_cbranch_vccz K_AUX_GOT
    s_sub_u32 s3, s3, 1
    s_cmp_lg_u32 s3, 0
    s_cbranch_scc1 K_AUX_POLL
K_AUX_GOT:
    v_readlane_b32 s74, v2, 0
    v_readlane_b32 s75, v2, 1
    s_nop 3
    s_and_b32 s74, s74, 0x7ff
    s_sub_u32 s74, 2047, s74
    s_mul_i32 s74, s74, 1280
    s_mov_b32 m0, 125184
    s_nop 0
    buffer_load_dwordx4 v10, s[12:15], s74 offen lds
    s_mov_b64 exec, 0xffff
    buffer_load_dwordx4 v10, s[12:15], s74 offen offset:1024 lds
    s_mov_b64 exec, -1
    s_and_b32 s75, s75, 0x7ff
    s_sub_u32 s75, 2047, s75
    s_mul_i32 s75, s75, 1280
    s_mov_b32 m0, 126528
    s_nop 0
    buffer_load_dwordx4 v10, s[12:15], s75 offen lds
    s_mov_b64 exec, 0xffff
    buffer_load_dwordx4 v10, s[12:15], s75 offen offset:1024 lds
    s_mov_b64 exec, -1
    s_waitcnt vmcnt(0)
    ds_write_b32 v12, v13 offset:48
    s_setprio 0
    s_branch K_P2
.p2align 12
K_FFN_C:
    s_add_u32 s64, s10, 0x10000
    s_addc_u32 s65, s11, 0
    s_mov_b32 s66, 0x43800
    s_mov_b32 s67, 0x20000
    s_and_b32 s73, s30, 1
    v_lshrrev_b32 v232, 4, v1
    v_bfe_u32 v4, v1, 2, 2
    v_lshl_add_u32 v2, v232, 3, v4
    v_and_b32 v3, 3, v1
    v_lshlrev_b32 v3, 3, v3
    v_lshl_add_u32 v233, v2, 6, v3
    s_lshl_b32 s72, s73, 5
    v_add_u32 v233, s72, v233
    v_lshl_add_u32 v2, v232, 2, v4
    v_bfe_u32 v4, v2, 1, 2
    v_lshl_add_u32 v3, v2, 7, v3
    v_lshl_add_u32 v3, v4, 5, v3
    s_mul_i32 s3, s73, 20480
    s_add_u32 s3, s3, 81920
    v_add_u32 v238, s3, v3
    v_xor_b32 v239, 32, v238
    v_xor_b32 v240, 64, v238
    v_xor_b32 v241, 96, v238
    v_and_b32 v2, 1, v1
    v_mul_u32_u24 v234, 1344, v2
    v_lshl_add_u32 v234, v232, 4, v234
    v_add_u32 v234, 125184, v234
    v_lshlrev_b32 v236, 4, v1
    v_add_u32 v236, 124160, v236
    s_lshl_b32 s3, s73, 3
    v_add_u32 v235, s3, v236
    v_mul_u32_u24 v2, 2560, v2
    v_lshl_add_u32 v237, v232, 4, v2
    s_mul_i32 s3, s44, 5120
    s_mul_i32 s72, s73, 1280
    s_add_u32 s72, s72, s3
    v_lshlrev_b32 v2, 4, v1
    buffer_store_dwordx4 v[16:19], v2, s[64:67], s72 offen offset:0 sc1
    buffer_store_dwordx4 v[16:19], v2, s[64:67], s72 offen offset:2560 sc1
    s_mov_b64 exec, 0xffff
    buffer_store_dwordx4 v[16:19], v2, s[64:67], s72 offen offset:1024 sc1
    buffer_store_dwordx4 v[16:19], v2, s[64:67], s72 offen offset:3584 sc1
    s_mov_b64 exec, -1
    v_add_u32 v5, 40960, v233
    s_mov_b32 s3, 1048576
K_FGD:
    ds_read_b32 v2, v12 offset:56
    s_sleep 2
    s_sub_u32 s3, s3, 1
    s_waitcnt lgkmcnt(0)
    v_readfirstlane_b32 s33, v2
    s_nop 3
    s_cselect_b32 s33, 3, s33
    s_cmp_lt_u32 s33, 3
    s_cbranch_scc1 K_FGD
    s_setprio 3
    ds_read_b64_tr_b16 v[16:17], v233 offset:0
    ds_read_b64_tr_b16 v[18:19], v233 offset:256
    ds_read_b64_tr_b16 v[20:21], v233 offset:2048
    ds_read_b64_tr_b16 v[22:23], v233 offset:2304
    ds_read_b64_tr_b16 v[24:25], v233 offset:4096
    ds_read_b64_tr_b16 v[26:27], v233 offset:4352
    ds_read_b64_tr_b16 v[28:29], v233 offset:6144
    ds_read_b64_tr_b16 v[30:31], v233 offset:6400
    ds_read_b64_tr_b16 v[32:33], v233 offset:8192
    ds_read_b64_tr_b16 v[34:35], v233 offset:8448
    ds_read_b64_tr_b16 v[36:37], v233 offset:10240
    ds_read_b64_tr_b16 v[38:39], v233 offset:10496
    ds_read_b64_tr_b16 v[40:41], v233 offset:12288
    ds_read_b64_tr_b16 v[42:43], v233 offset:12544
    ds_read_b64_tr_b16 v[44:45], v233 offset:14336
    ds_read_b64_tr_b16 v[46:47], v233 offset:14592
    ds_read_b64_tr_b16 v[48:49], v233 offset:16384
    ds_read_b64_tr_b16 v[50:51], v233 offset:16640
    ds_read_b64_tr_b16 v[52:53], v233 offset:18432
    ds_read_b64_tr_b16 v[54:55], v233 offset:18688
    ds_read_b64_tr_b16 v[56:57], v233 offset:20480
    ds_read_b64_tr_b16 v[58:59], v233 offset:20736
    ds_read_b64_tr_b16 v[60:61], v233 offset:22528
    ds_read_b64_tr_b16 v[62:63], v233 offset:22784
    ds_read_b64_tr_b16 v[64:65], v233 offset:24576
    ds_read_b64_tr_b16 v[66:67], v233 offset:24832
    ds_read_b64_tr_b16 v[68:69], v233 offset:26624
    ds_read_b64_tr_b16 v[70:71], v233 offset:26880
    ds_read_b64_tr_b16 v[72:73], v233 offset:28672
    ds_read_b64_tr_b16 v[74:75], v233 offset:28928
    ds_read_b64_tr_b16 v[76:77], v233 offset:30720
    ds_read_b64_tr_b16 v[78:79], v233 offset:30976
    ds_read_b64_tr_b16 v[80:81], v233 offset:32768
    ds_read_b64_tr_b16 v[82:83], v233 offset:33024
    ds_read_b64_tr_b16 v[84:85], v233 offset:34816
    ds_read_b64_tr_b16 v[86:87], v233 offset:35072
    ds_read_b64_tr_b16 v[88:89], v233 offset:36864
    ds_read_b64_tr_b16 v[90:91], v233 offset:37120
    ds_read_b64_tr_b16 v[92:93], v233 offset:38912
    ds_read_b64_tr_b16 v[94:95], v233 offset:39168
    ds_read_b64_tr_b16 v[96:97], v5 offset:0
    ds_read_b64_tr_b16 v[98:99], v5 offset:256
    ds_read_b64_tr_b16 v[100:101], v5 offset:2048
    ds_read_b64_tr_b16 v[102:103], v5 offset:2304
    ds_read_b64_tr_b16 v[104:105], v5 offset:4096
    ds_read_b64_tr_b16 v[106:107], v5 offset:4352
    ds_read_b64_tr_b16 v[108:109], v5 offset:6144
    ds_read_b64_tr_b16 v[110:111], v5 offset:6400
    ds_read_b64_tr_b16 v[112:113], v5 offset:8192
    ds_read_b64_tr_b16 v[114:115], v5 offset:8448
    ds_read_b64_tr_b16 v[116:117], v5 offset:10240
    ds_read_b64_tr_b16 v[118:119], v5 offset:10496
    ds_read_b64_tr_b16 v[120:121], v5 offset:12288
    ds_read_b64_tr_b16 v[122:123], v5 offset:12544
    ds_read_b64_tr_b16 v[124:125], v5 offset:14336
    ds_read_b64_tr_b16 v[126:127], v5 offset:14592
    ds_read_b64_tr_b16 v[128:129], v5 offset:16384
    ds_read_b64_tr_b16 v[130:131], v5 offset:16640
    ds_read_b64_tr_b16 v[132:133], v5 offset:18432
    ds_read_b64_tr_b16 v[134:135], v5 offset:18688
    ds_read_b64_tr_b16 v[136:137], v5 offset:20480
    ds_read_b64_tr_b16 v[138:139], v5 offset:20736
    ds_read_b64_tr_b16 v[140:141], v5 offset:22528
    ds_read_b64_tr_b16 v[142:143], v5 offset:22784
    ds_read_b64_tr_b16 v[144:145], v5 offset:24576
    ds_read_b64_tr_b16 v[146:147], v5 offset:24832
    ds_read_b64_tr_b16 v[148:149], v5 offset:26624
    ds_read_b64_tr_b16 v[150:151], v5 offset:26880
    ds_read_b64_tr_b16 v[152:153], v5 offset:28672
    ds_read_b64_tr_b16 v[154:155], v5 offset:28928
    ds_read_b64_tr_b16 v[156:157], v5 offset:30720
    ds_read_b64_tr_b16 v[158:159], v5 offset:30976
    ds_read_b64_tr_b16 v[160:161], v5 offset:32768
    ds_read_b64_tr_b16 v[162:163], v5 offset:33024
    ds_read_b64_tr_b16 v[164:165], v5 offset:34816
    ds_read_b64_tr_b16 v[166:167], v5 offset:35072
    ds_read_b64_tr_b16 v[168:169], v5 offset:36864
    ds_read_b64_tr_b16 v[170:171], v5 offset:37120
    ds_read_b64_tr_b16 v[172:173], v5 offset:38912
    ds_read_b64_tr_b16 v[174:175], v5 offset:39168
    s_waitcnt vmcnt(0) lgkmcnt(0)
    s_mov_b64 exec, 1
    ds_add_u32 v12, v13 offset:60
    s_mov_b64 exec, -1
    s_mov_b32 s3, 1048576
K_FGK:
    ds_read_b32 v2, v12 offset:48
    s_sleep 1
    s_sub_u32 s3, s3, 1
    s_waitcnt lgkmcnt(0)
    v_readfirstlane_b32 s33, v2
    s_nop 3
    s_cselect_b32 s33, 1, s33
    s_cmp_lt_u32 s33, 1
    s_cbranch_scc1 K_FGK
    ds_read_b128 v[188:191], v234 offset:0
    ds_read_b128 v[192:195], v234 offset:64
    ds_read_b128 v[196:199], v234 offset:128
    ds_read_b128 v[200:203], v234 offset:192
    ds_read_b128 v[204:207], v234 offset:256
    ds_read_b128 v[208:211], v234 offset:320
    ds_read_b128 v[212:215], v234 offset:384
    ds_read_b128 v[216:219], v234 offset:448
    s_waitcnt lgkmcnt(7)
    v_mfma_f32_16x16x32_bf16 v[220:223], v[16:19], v[188:191], 0
    v_mfma_f32_16x16x32_bf16 v[224:227], v[96:99], v[188:191], 0
    ds_read_b128 v[188:191], v234 offset:512
    s_waitcnt lgkmcnt(7)
    v_mfma_f32_16x16x32_bf16 v[220:223], v[20:23], v[192:195], v[220:223]
    v_mfma_f32_16x16x32_bf16 v[224:227], v[100:103], v[192:195], v[224:227]
    ds_read_b128 v[192:195], v234 offset:576
    s_waitcnt lgkmcnt(7)
    v_mfma_f32_16x16x32_bf16 v[220:223], v[24:27], v[196:199], v[220:223]
    v_mfma_f32_16x16x32_bf16 v[224:227], v[104:107], v[196:199], v[224:227]
    ds_read_b128 v[196:199], v234 offset:640
    s_waitcnt lgkmcnt(7)
    v_mfma_f32_16x16x32_bf16 v[220:223], v[28:31], v[200:203], v[220:223]
    v_mfma_f32_16x16x32_bf16 v[224:227], v[108:111], v[200:203], v[224:227]
    ds_read_b128 v[200:203], v234 offset:704
    s_waitcnt lgkmcnt(7)
    v_mfma_f32_16x16x32_bf16 v[220:223], v[32:35], v[204:207], v[220:223]
    v_mfma_f32_16x16x32_bf16 v[224:227], v[112:115], v[204:207], v[224:227]
    ds_read_b128 v[204:207], v234 offset:768
    s_waitcnt lgkmcnt(7)
    v_mfma_f32_16x16x32_bf16 v[220:223], v[36:39], v[208:211], v[220:223]
    v_mfma_f32_16x16x32_bf16 v[224:227], v[116:119], v[208:211], v[224:227]
    ds_read_b128 v[208:211], v234 offset:832
    s_waitcnt lgkmcnt(7)
    v_mfma_f32_16x16x32_bf16 v[220:223], v[40:43], v[212:215], v[220:223]
    v_mfma_f32_16x16x32_bf16 v[224:227], v[120:123], v[212:215], v[224:227]
    ds_read_b128 v[212:215], v234 offset:896
    s_waitcnt lgkmcnt(7)
    v_mfma_f32_16x16x32_bf16 v[220:223], v[44:47], v[216:219], v[220:223]
    v_mfma_f32_16x16x32_bf16 v[224:227], v[124:127], v[216:219], v[224:227]
    ds_read_b128 v[216:219], v234 offset:960
    s_waitcnt lgkmcnt(7)
    v_mfma_f32_16x16x32_bf16 v[220:223], v[48:51], v[188:191], v[220:223]
    v_mfma_f32_16x16x32_bf16 v[224:227], v[128:131], v[188:191], v[224:227]
    ds_read_b128 v[188:191], v234 offset:1024
    s_waitcnt lgkmcnt(7)
    v_mfma_f32_16x16x32_bf16 v[220:223], v[52:55], v[192:195], v[220:223]
    v_mfma_f32_16x16x32_bf16 v[224:227], v[132:135], v[192:195], v[224:227]
    ds_read_b128 v[192:195], v234 offset:1088
    s_waitcnt lgkmcnt(7)
    v_mfma_f32_16x16x32_bf16 v[220:223], v[56:59], v[196:199], v[220:223]
    v_mfma_f32_16x16x32_bf16 v[224:227], v[136:139], v[196:199], v[224:227]
    ds_read_b128 v[196:199], v234 offset:1152
    s_waitcnt lgkmcnt(7)
    v_mfma_f32_16x16x32_bf16 v[220:223], v[60:63], v[200:203], v[220:223]
    v_mfma_f32_16x16x32_bf16 v[224:227], v[140:143], v[200:203], v[224:227]
    ds_read_b128 v[200:203], v234 offset:1216
    s_waitcnt lgkmcnt(7)
    v_mfma_f32_16x16x32_bf16 v[220:223], v[64:67], v[204:207], v[220:223]
    v_mfma_f32_16x16x32_bf16 v[224:227], v[144:147], v[204:207], v[224:227]
    s_waitcnt lgkmcnt(6)
    v_mfma_f32_16x16x32_bf16 v[220:223], v[68:71], v[208:211], v[220:223]
    v_mfma_f32_16x16x32_bf16 v[224:227], v[148:151], v[208:211], v[224:227]
    s_waitcnt lgkmcnt(5)
    v_mfma_f32_16x16x32_bf16 v[220:223], v[72:75], v[212:215], v[220:223]
    v_mfma_f32_16x16x32_bf16 v[224:227], v[152:155], v[212:215], v[224:227]
    s_waitcnt lgkmcnt(4)
    v_mfma_f32_16x16x32_bf16 v[220:223], v[76:79], v[216:219], v[220:223]
    v_mfma_f32_16x16x32_bf16 v[224:227], v[156:159], v[216:219], v[224:227]
    s_waitcnt lgkmcnt(3)
    v_mfma_f32_16x16x32_bf16 v[220:223], v[80:83], v[188:191], v[220:223]
    v_mfma_f32_16x16x32_bf16 v[224:227], v[160:163], v[188:191], v[224:227]
    s_waitcnt lgkmcnt(2)
    v_mfma_f32_16x16x32_bf16 v[220:223], v[84:87], v[192:195], v[220:223]
    v_mfma_f32_16x16x32_bf16 v[224:227], v[164:167], v[192:195], v[224:227]
    s_waitcnt lgkmcnt(1)
    v_mfma_f32_16x16x32_bf16 v[220:223], v[88:91], v[196:199], v[220:223]
    v_mfma_f32_16x16x32_bf16 v[224:227], v[168:171], v[196:199], v[224:227]
    s_waitcnt lgkmcnt(0)
    v_mfma_f32_16x16x32_bf16 v[220:223], v[92:95], v[200:203], v[220:223]
    v_mfma_f32_16x16x32_bf16 v[224:227], v[172:175], v[200:203], v[224:227]
    s_mov_b32 s3, 1048576
K_FGDN:
    ds_read_b32 v2, v12 offset:52
    s_sleep 1
    s_sub_u32 s3, s3, 1
    s_waitcnt lgkmcnt(0)
    v_readfirstlane_b32 s33, v2
    s_nop 3
    s_cselect_b32 s33, 3, s33
    s_cmp_lt_u32 s33, 3
    s_cbranch_scc1 K_FGDN
    ds_read_b64_tr_b16 v[16:17], v238 offset:0
    ds_read_b64_tr_b16 v[18:19], v238 offset:2048
    ds_read_b64_tr_b16 v[20:21], v239 offset:0
    ds_read_b64_tr_b16 v[22:23], v239 offset:2048
    ds_read_b64_tr_b16 v[24:25], v240 offset:0
    ds_read_b64_tr_b16 v[26:27], v240 offset:2048
    ds_read_b64_tr_b16 v[28:29], v241 offset:0
    ds_read_b64_tr_b16 v[30:31], v241 offset:2048
    ds_read_b64_tr_b16 v[32:33], v238 offset:4096
    ds_read_b64_tr_b16 v[34:35], v238 offset:6144
    ds_read_b64_tr_b16 v[36:37], v239 offset:4096
    ds_read_b64_tr_b16 v[38:39], v239 offset:6144
    ds_read_b64_tr_b16 v[40:41], v240 offset:4096
    ds_read_b64_tr_b16 v[42:43], v240 offset:6144
    v_cvt_pk_bf16_f32 v221, v220, v221
    v_lshlrev_b32 v220, 16, v221
    v_and_b32 v221, 0xffff0000, v221
    v_cvt_pk_bf16_f32 v223, v222, v223
    v_lshlrev_b32 v222, 16, v223
    v_and_b32 v223, 0xffff0000, v223
    v_cvt_pk_bf16_f32 v225, v224, v225
    v_lshlrev_b32 v224, 16, v225
    v_and_b32 v225, 0xffff0000, v225
    v_cvt_pk_bf16_f32 v227, v226, v227
    v_lshlrev_b32 v226, 16, v227
    v_and_b32 v227, 0xffff0000, v227
    v_mul_f32 v188, 0xbfb8aa3b, v220
    v_mul_f32 v189, 0xbfb8aa3b, v221
    v_mul_f32 v190, 0xbfb8aa3b, v222
    v_mul_f32 v191, 0xbfb8aa3b, v223
    v_exp_f32 v188, v188
    v_exp_f32 v189, v189
    v_exp_f32 v190, v190
    v_exp_f32 v191, v191
    v_add_f32 v188, 1.0, v188
    v_add_f32 v189, 1.0, v189
    v_add_f32 v190, 1.0, v190
    v_add_f32 v191, 1.0, v191
    v_rcp_f32 v188, v188
    v_rcp_f32 v189, v189
    v_rcp_f32 v190, v190
    v_rcp_f32 v191, v191
    v_mul_f32 v220, v220, v188
    v_mul_f32 v221, v221, v189
    v_mul_f32 v222, v222, v190
    v_mul_f32 v223, v223, v191
    v_cvt_pk_bf16_f32 v221, v220, v221
    v_lshlrev_b32 v220, 16, v221
    v_and_b32 v221, 0xffff0000, v221
    v_cvt_pk_bf16_f32 v223, v222, v223
    v_lshlrev_b32 v222, 16, v223
    v_and_b32 v223, 0xffff0000, v223
    v_mul_f32 v220, v220, v224
    v_mul_f32 v221, v221, v225
    v_mul_f32 v222, v222, v226
    v_mul_f32 v223, v223, v227
    v_cvt_pk_bf16_f32 v228, v220, v221
    v_cvt_pk_bf16_f32 v229, v222, v223
    ds_write_b64 v235, v[228:229]
    s_mov_b64 exec, 1
    ds_add_u32 v12, v13 offset:52
    s_mov_b64 exec, -1
    ds_read_b64_tr_b16 v[44:45], v241 offset:4096
    ds_read_b64_tr_b16 v[46:47], v241 offset:6144
    ds_read_b64_tr_b16 v[48:49], v238 offset:8192
    ds_read_b64_tr_b16 v[50:51], v238 offset:10240
    ds_read_b64_tr_b16 v[52:53], v239 offset:8192
    ds_read_b64_tr_b16 v[54:55], v239 offset:10240
    ds_read_b64_tr_b16 v[56:57], v240 offset:8192
    ds_read_b64_tr_b16 v[58:59], v240 offset:10240
    ds_read_b64_tr_b16 v[60:61], v241 offset:8192
    ds_read_b64_tr_b16 v[62:63], v241 offset:10240
    ds_read_b64_tr_b16 v[64:65], v238 offset:12288
    ds_read_b64_tr_b16 v[66:67], v238 offset:14336
    ds_read_b64_tr_b16 v[68:69], v239 offset:12288
    ds_read_b64_tr_b16 v[70:71], v239 offset:14336
    ds_read_b64_tr_b16 v[72:73], v240 offset:12288
    ds_read_b64_tr_b16 v[74:75], v240 offset:14336
    ds_read_b64_tr_b16 v[76:77], v241 offset:12288
    ds_read_b64_tr_b16 v[78:79], v241 offset:14336
    ds_read_b64_tr_b16 v[80:81], v238 offset:16384
    ds_read_b64_tr_b16 v[82:83], v238 offset:18432
    ds_read_b64_tr_b16 v[84:85], v239 offset:16384
    ds_read_b64_tr_b16 v[86:87], v239 offset:18432
    ds_read_b64_tr_b16 v[88:89], v240 offset:16384
    ds_read_b64_tr_b16 v[90:91], v240 offset:18432
    ds_read_b64_tr_b16 v[92:93], v241 offset:16384
    ds_read_b64_tr_b16 v[94:95], v241 offset:18432
    s_mov_b32 s3, 1048576
K_FGP:
    ds_read_b32 v2, v12 offset:52
    s_sleep 0
    s_sub_u32 s3, s3, 1
    s_waitcnt lgkmcnt(0)
    v_readfirstlane_b32 s33, v2
    s_nop 3
    s_cselect_b32 s33, 5, s33
    s_cmp_lt_u32 s33, 5
    s_cbranch_scc1 K_FGP
    ds_read_b128 v[228:231], v236
    s_waitcnt lgkmcnt(0)
    v_mfma_f32_16x16x32_bf16 v[96:99], v[16:19], v[228:231], 0
    v_mfma_f32_16x16x32_bf16 v[100:103], v[20:23], v[228:231], 0
    v_mfma_f32_16x16x32_bf16 v[104:107], v[24:27], v[228:231], 0
    v_mfma_f32_16x16x32_bf16 v[108:111], v[28:31], v[228:231], 0
    v_mfma_f32_16x16x32_bf16 v[112:115], v[32:35], v[228:231], 0
    v_mfma_f32_16x16x32_bf16 v[116:119], v[36:39], v[228:231], 0
    v_mfma_f32_16x16x32_bf16 v[120:123], v[40:43], v[228:231], 0
    v_mfma_f32_16x16x32_bf16 v[124:127], v[44:47], v[228:231], 0
    v_mfma_f32_16x16x32_bf16 v[128:131], v[48:51], v[228:231], 0
    v_mfma_f32_16x16x32_bf16 v[132:135], v[52:55], v[228:231], 0
    v_mfma_f32_16x16x32_bf16 v[136:139], v[56:59], v[228:231], 0
    v_mfma_f32_16x16x32_bf16 v[140:143], v[60:63], v[228:231], 0
    v_mfma_f32_16x16x32_bf16 v[144:147], v[64:67], v[228:231], 0
    v_mfma_f32_16x16x32_bf16 v[148:151], v[68:71], v[228:231], 0
    v_mfma_f32_16x16x32_bf16 v[152:155], v[72:75], v[228:231], 0
    v_mfma_f32_16x16x32_bf16 v[156:159], v[76:79], v[228:231], 0
    v_mfma_f32_16x16x32_bf16 v[160:163], v[80:83], v[228:231], 0
    v_mfma_f32_16x16x32_bf16 v[164:167], v[84:87], v[228:231], 0
    v_mfma_f32_16x16x32_bf16 v[168:171], v[88:91], v[228:231], 0
    v_mfma_f32_16x16x32_bf16 v[172:175], v[92:95], v[228:231], 0
    s_mov_b32 exec_lo, 0x00030003
    s_mov_b32 exec_hi, 0x00030003
    buffer_store_dwordx4 v[96:99], v237, s[64:67], s72 offen offset:0 sc1
    buffer_store_dwordx4 v[100:103], v237, s[64:67], s72 offen offset:64 sc1
    buffer_store_dwordx4 v[104:107], v237, s[64:67], s72 offen offset:128 sc1
    buffer_store_dwordx4 v[108:111], v237, s[64:67], s72 offen offset:192 sc1
    buffer_store_dwordx4 v[112:115], v237, s[64:67], s72 offen offset:256 sc1
    buffer_store_dwordx4 v[116:119], v237, s[64:67], s72 offen offset:320 sc1
    buffer_store_dwordx4 v[120:123], v237, s[64:67], s72 offen offset:384 sc1
    buffer_store_dwordx4 v[124:127], v237, s[64:67], s72 offen offset:448 sc1
    buffer_store_dwordx4 v[128:131], v237, s[64:67], s72 offen offset:512 sc1
    buffer_store_dwordx4 v[132:135], v237, s[64:67], s72 offen offset:576 sc1
    buffer_store_dwordx4 v[136:139], v237, s[64:67], s72 offen offset:640 sc1
    buffer_store_dwordx4 v[140:143], v237, s[64:67], s72 offen offset:704 sc1
    buffer_store_dwordx4 v[144:147], v237, s[64:67], s72 offen offset:768 sc1
    buffer_store_dwordx4 v[148:151], v237, s[64:67], s72 offen offset:832 sc1
    buffer_store_dwordx4 v[152:155], v237, s[64:67], s72 offen offset:896 sc1
    buffer_store_dwordx4 v[156:159], v237, s[64:67], s72 offen offset:960 sc1
    buffer_store_dwordx4 v[160:163], v237, s[64:67], s72 offen offset:1024 sc1
    buffer_store_dwordx4 v[164:167], v237, s[64:67], s72 offen offset:1088 sc1
    buffer_store_dwordx4 v[168:171], v237, s[64:67], s72 offen offset:1152 sc1
    buffer_store_dwordx4 v[172:175], v237, s[64:67], s72 offen offset:1216 sc1
    s_mov_b64 exec, -1
    s_mul_i32 s3, s73, 2560
    s_lshl2_add_u32 s3, s44, s3
    s_add_u32 s3, s3, 568320
    v_lshl_add_u32 v2, v1, 8, s3
    s_mov_b64 exec, 0x3ff
    s_waitcnt vmcnt(0)
    global_store_dword v2, v13, s[10:11] sc1
    s_mov_b64 exec, -1
    s_branch K_P2_HELP
K_CODE_END:
.section .rodata,"a"
.p2align 6
.amdhsa_kernel gated_mix__sliding_local_dilated__moe_arch_mod__prompt_kernel
  .amdhsa_next_free_vgpr 248
  .amdhsa_next_free_sgpr 79
  .amdhsa_accum_offset 248
  .amdhsa_group_segment_fixed_size 0
  .amdhsa_kernarg_size 96
  .amdhsa_user_sgpr_count 2
  .amdhsa_user_sgpr_kernarg_segment_ptr 1
  .amdhsa_system_sgpr_workgroup_id_x 1
.end_amdhsa_kernel
```

```asm
; @launch grid=(256,1,1) block=(512,1,1) lds=163840
.amdgcn_target "amdgcn-amd-amdhsa--gfx950"
.text
.p2align 12
.p2align 8
.globl gated_mix__sliding_local_dilated__moe_arch_mod__prompt_kernel
.type gated_mix__sliding_local_dilated__moe_arch_mod__prompt_kernel,@function
gated_mix__sliding_local_dilated__moe_arch_mod__prompt_kernel:
    s_cmp_ge_u32 s2, 256
    s_cbranch_scc1 K_EXIT
    s_load_dwordx2 s[12:13], s[0:1], 0
    s_load_dwordx2 s[16:17], s[0:1], 8
    v_readfirstlane_b32 s30, v0
    s_load_dwordx4 s[8:11], s[0:1], 80
    s_load_dwordx2 s[24:25], s[0:1], 16
    s_load_dwordx2 s[6:7], s[0:1], 72
    s_and_b32 s28, s2, 7
    v_and_b32 v1, 63, v0
    s_mov_b32 s14, 0x280000
    s_mov_b32 s15, 0x20000
    s_lshr_b32 s30, s30, 6
    s_cmp_lt_u32 s2, 64
    s_cbranch_scc1 K_SLOW
    s_cmp_lt_u32 s30, 4
    s_cbranch_scc1 K_FAST
K_SLOW:
    s_getpc_b64 s[38:39]
K_PC:
    s_bfe_u32 s3, s2, 0x30003
    s_mul_i32 s3, s3, ((K_CODE_END-gated_mix__sliding_local_dilated__moe_arch_mod__prompt_kernel+1023)/1024)
    s_sub_u32 s38, s38, K_PC-gated_mix__sliding_local_dilated__moe_arch_mod__prompt_kernel
    s_subb_u32 s39, s39, 0
    v_subrev_u32 v3, 256, v0
    v_add_u32 v2, s3, v3
    v_lshlrev_b32 v2, 7, v2
    v_min_u32 v2, K_CODE_END-gated_mix__sliding_local_dilated__moe_arch_mod__prompt_kernel-4, v2
    v_cmp_gt_u32 vcc, ((K_CODE_END-gated_mix__sliding_local_dilated__moe_arch_mod__prompt_kernel+1023)/1024), v3
    s_and_saveexec_b64 s[4:5], vcc
    s_cbranch_execz K_NOPF
    global_load_dword v6, v2, s[38:39]
K_NOPF:
    s_mov_b64 exec, -1
    v_mov_b32 v2, 0
    v_mov_b32 v3, 158752
    ds_write2_b32 v3, v2, v2 offset0:0 offset1:1
    ds_write2_b32 v3, v2, v2 offset0:2 offset1:3
    ds_write2_b32 v3, v2, v2 offset0:4 offset1:5
    ds_write2_b32 v3, v2, v2 offset0:6 offset1:7
    ds_write2_b32 v3, v2, v2 offset0:8 offset1:9
    ds_write2_b32 v3, v2, v2 offset0:10 offset1:11
    s_mov_b32 s43, 1
    s_lshl_b32 s3, s30, 8
    s_add_u32 s3, s3, s2
    s_lshr_b32 s3, s3, 3
    s_cmp_lg_u32 s3, 160
    s_cbranch_scc1 K_COMMON
    s_mul_i32 s3, s2, 6144
    s_add_u32 s3, s3, 527360
    v_lshl_add_u32 v6, v1, 4, s3
    v_mov_b64 v[28:29], 0
    v_mov_b64 v[30:31], 0
    s_waitcnt lgkmcnt(0)
    global_store_dwordx4 v6, v[28:31], s[10:11] offset:-3072 sc1
    global_store_dwordx4 v6, v[28:31], s[10:11] offset:-2048 sc1
    global_store_dwordx4 v6, v[28:31], s[10:11] offset:-1024 sc1
    global_store_dwordx4 v6, v[28:31], s[10:11] offset:0 sc1
    global_store_dwordx4 v6, v[28:31], s[10:11] offset:1024 sc1
    global_store_dwordx4 v6, v[28:31], s[10:11] offset:2048 sc1
    s_lshl_b32 s3, s2, 2
    v_mov_b32 v2, s3
    v_mov_b32 v3, 1
    s_mov_b64 exec, 1
    s_waitcnt vmcnt(0)
    global_store_dword v2, v3, s[8:9] offset:192 sc1
    s_mov_b64 exec, -1
    s_branch K_COMMON
K_FAST:
    s_lshr_b32 s32, s2, 1
    s_and_b32 s32, s32, 28
    v_lshrrev_b32 v3, 4, v1
    s_lshr_b32 s3, s2, 6
    s_mov_b32 s59, 0x59608237
    s_cmp_eq_u32 s3, 2
    s_cselect_b32 s59, 0x26375904, s59
    v_and_b32 v4, 7, v1
    s_cmp_eq_u32 s3, 3
    s_cselect_b32 s59, 0x93042671, s59
    v_lshrrev_b32 v2, 3, v1
    s_lshr_b32 s59, s59, s32
    s_and_b32 s59, s59, 15
    v_xor_b32 v4, v4, v3
    s_lshl_b32 s33, s28, 2
    s_lshr_b32 s33, 0x76543210, s33
    s_and_b32 s33, s33, 15
    s_add_u32 s59, s59, s33
    s_cmp_ge_u32 s59, 10
    v_mul_u32_u24 v2, 1280, v2
    s_cselect_b32 s33, 10, 0
    s_sub_u32 s59, s59, s33
    s_lshr_b32 s53, s28, 1
    v_lshl_add_u32 v44, v4, 4, v2
    s_mul_i32 s53, s53, 655360
    s_lshl2_add_u32 s62, s3, s30
    s_cmp_eq_u32 s62, 15
    s_cselect_b32 s62, 0x800000, 0
    s_add_u32 s62, s62, 40960
    s_mul_i32 s3, s3, 225280
    v_xor_b32 v45, 64, v44
    s_add_u32 s53, s53, s3
    s_mul_i32 s54, s30, 61440
    s_add_u32 s53, s53, s54
    s_sub_u32 s53, s53, 245760
    s_mul_i32 s55, s30, 6144
    s_add_u32 s55, s55, 40960
    s_lshl_b32 s57, s59, 7
    s_add_u32 s57, s57, s53
    s_waitcnt lgkmcnt(0)
    s_add_u32 m0, s55, 0
    s_max_i32 s60, s57, 0
    buffer_load_dwordx4 v44, s[12:15], s60 offen lds
    s_add_u32 s60, s57, 10240
    s_add_u32 m0, s55, 1024
    s_max_i32 s60, s60, 0
    buffer_load_dwordx4 v45, s[12:15], s60 offen lds
    s_add_u32 m0, s55, 2048
    s_add_u32 s60, s57, 20480
    buffer_load_dwordx4 v44, s[12:15], s60 offen lds
    s_add_u32 m0, s55, 3072
    s_add_u32 s60, s57, 30720
    buffer_load_dwordx4 v45, s[12:15], s60 offen lds
    s_add_u32 m0, s55, 4096
    s_add_u32 s60, s57, s62
    buffer_load_dwordx4 v44, s[12:15], s60 offen lds
    s_add_u32 m0, s55, 5120
    s_add_u32 s60, s60, 10240
    buffer_load_dwordx4 v45, s[12:15], s60 offen lds
    v_lshlrev_b32 v2, 1, v3
    s_lshr_b32 s32, 0x64317520, s32
    v_sub_u32 v2, v1, v2
    s_and_b32 s32, s32, 7
    v_and_b32 v2, 15, v2
    s_and_b32 s3, s28, 1
    v_mul_u32_u24 v3, 3840, v3
    s_lshl3_add_u32 s32, s3, s32
    v_mul_u32_u24 v4, 13, v2
    s_mul_i32 s3, s32, 80
    v_lshrrev_b32 v4, 6, v4
    s_add_u32 s54, s54, s3
    v_mul_u32_u24 v4, 1200, v4
    s_lshl_b32 s56, s30, 12
    v_lshl_add_u32 v4, v2, 4, v4
    s_add_u32 s56, s56, 65536
    v_add_u32 v5, 1, v2
    s_mov_b32 s18, 0x258000
    v_and_b32 v5, 16, v5
    s_mov_b32 s19, 0x20000
    v_lshl_add_u32 v4, v5, 24, v4
    v_add_u32 v46, v3, v4
    s_mul_i32 s58, s59, 245760
    s_add_u32 s58, s58, s54
    s_add_u32 s59, s59, 1
    s_cmp_eq_u32 s59, 10
    s_cselect_b32 s59, 0, s59
    s_add_u32 m0, s56, 0
    s_add_u32 s60, s58, 0
    buffer_load_dwordx4 v46, s[16:19], s60 offen lds
    s_add_u32 m0, s56, 1024
    s_add_u32 s60, s58, 15360
    buffer_load_dwordx4 v46, s[16:19], s60 offen lds
    v_xor_b32 v2, 8, v2
    v_mul_u32_u24 v4, 13, v2
    v_lshrrev_b32 v4, 6, v4
    v_mul_u32_u24 v4, 1200, v4
    v_lshl_add_u32 v4, v2, 4, v4
    v_add_u32 v5, 1, v2
    v_and_b32 v5, 16, v5
    v_lshl_add_u32 v4, v5, 24, v4
    v_add_u32 v47, v3, v4
    s_add_u32 m0, s56, 2048
    s_add_u32 s60, s58, 30720
    buffer_load_dwordx4 v47, s[16:19], s60 offen lds
    s_add_u32 m0, s56, 3072
    s_add_u32 s60, s58, 46080
    buffer_load_dwordx4 v47, s[16:19], s60 offen lds
    s_mov_b32 s52, s30
    s_mov_b32 s43, 0
K_COMMON:
    v_mov_b32 v7, 0
    s_lshr_b32 s29, s2, 3
    s_xor_b32 s30, s30, 4
    s_mov_b32 s26, 0xc8000
    s_mov_b32 s27, 0x20000
    s_lshr_b32 s34, s29, 3
    s_lshl_b32 s34, s34, 2
    s_and_b32 s3, s29, 3
    s_add_u32 s34, s34, s3
    s_add_u32 s34, s34, 4
    s_bitcmp1_b32 s29, 2
    s_cselect_b32 s34, -1, s34
    s_cmp_lt_u32 s29, 8
    s_cselect_b32 s34, s29, s34
    s_lshl_b32 s40, s28, 1
    s_cmp_ge_u32 s34, 10
    s_addc_u32 s40, s40, 0
    s_sub_u32 s41, s34, 10
    s_cmp_ge_u32 s34, 10
    s_cselect_b32 s41, s41, s34
    s_mul_i32 s42, s28, 20
    s_add_u32 s42, s42, s34
    s_and_b32 s42, s42, 255
    s_lshl_b32 s42, s42, 8
    s_add_u32 s42, s42, 524288
    s_cmp_lt_u32 s29, 8
    s_cbranch_scc1 K_AUX
    s_lshr_b32 s31, s29, 3
    s_sub_u32 s31, s31, 1
    s_and_b32 s35, s29, 3
    s_and_b32 s3, s29, 4
    s_lshl_b32 s3, s3, 1
    s_add_u32 s35, s35, s3
    s_and_b32 s3, s28, 1
    s_lshl_b32 s3, s3, 2
    s_add_u32 s35, s35, s3
    v_and_b32 v9, 15, v1
    v_lshrrev_b32 v10, 4, v1
    v_bfe_u32 v11, v1, 2, 2
    v_and_b32 v12, 3, v1
    s_waitcnt lgkmcnt(0)
    s_add_u32 s20, s10, 0x100000
    s_addc_u32 s21, s11, 0
    s_mov_b32 s22, 0x280000
    s_mov_b32 s23, 0x20000
    s_and_b32 s3, s30, 3
    s_mul_i32 s3, s3, 3
    s_lshr_b32 s33, s30, 2
    s_lshl1_add_u32 s3, s33, s3
    s_mul_i32 s44, s31, 11
    s_add_u32 s44, s44, s3
    s_cmp_eq_u32 s44, 31
    s_cselect_b32 s51, 4, s30
    s_lshr_b32 s33, s28, 1
    s_lshl_b32 s33, s33, 5
    s_add_u32 s44, s44, s33
    s_mul_i32 s3, s3, 4352
    s_add_u32 s3, s3, 81920
    v_mul_u32_u24 v14, 272, v9
    v_lshl_add_u32 v13, v10, 3, v14
    v_add_u32 v13, s3, v13
    v_add3_u32 v14, v14, 32, s3
    v_cmp_eq_u32 vcc, 0, v10
    v_add_u32 v2, 208, v14
    v_add_u32 v3, 0, v14
    v_add_u32 v4, 40, v14
    v_cndmask_b32 v19, v2, v3, vcc
    v_cndmask_b32 v20, v2, v4, vcc
    v_lshl_add_u32 v15, v10, 2, v11
    v_mul_u32_u24 v15, 272, v15
    v_add_u32 v5, s3, v15
    v_lshl_add_u32 v15, v12, 3, v5
    v_add_u32 v2, 240, v5
    v_add_u32 v3, 192, v5
    v_add_u32 v4, 232, v5
    v_cmp_eq_u32 vcc, 0, v12
    s_nop 1
    v_cndmask_b32 v21, v2, v3, vcc
    v_cmp_eq_u32 vcc, 1, v12
    s_nop 1
    v_cndmask_b32 v22, v2, v4, vcc
    v_cmp_eq_u32 vcc, 2, v12
    s_nop 1
    v_cndmask_b32 v23, v2, v3, vcc
    v_cmp_eq_u32 vcc, 3, v12
    s_nop 1
    v_cndmask_b32 v24, v2, v4, vcc
    s_lshl_b32 s3, s35, 10
    v_lshl_add_u32 v16, v1, 4, s3
    s_lshl_b32 s3, s35, 8
    s_add_u32 s3, s3, 16384
    v_lshl_add_u32 v17, v9, 4, s3
    v_and_b32 v2, 1, v10
    v_lshl_add_u32 v17, v2, 23, v17
    s_cmp_lt_u32 s51, 4
    s_cselect_b32 s3, 0, 0x800000
    s_add_u32 s3, s3, 20480
    v_lshrrev_b32 v2, 1, v10
    v_mad_u32_u24 v17, v2, s3, v17
    s_mul_i32 s50, s44, 20480
    s_add_u32 s51, s50, s3
    v_mov_b32 v18, 0xf149f2ca
    v_lshlrev_b32 v2, 2, v10
    v_sub_u32 v2, v9, v2
    s_cmp_eq_u32 s44, 0
    s_cselect_b32 s3, 0xf149f2ca, 0
    v_subrev_u32 v3, 0, v2
    v_and_b32 v4, 0x80000001, v3
    v_cmp_eq_u32 vcc, 0, v4
    s_nop 1
    v_cndmask_b32 v32, v18, 0, vcc
    v_cmp_eq_u32 vcc, 0x80000000, v4
    s_nop 1
    v_cndmask_b32 v28, v18, 0, vcc
    v_add_f32 v36, s3, v28
    v_subrev_u32 v3, 1, v2
    v_and_b32 v4, 0x80000001, v3
    v_cmp_eq_u32 vcc, 0, v4
    s_nop 1
    v_cndmask_b32 v33, v18, 0, vcc
    v_cmp_eq_u32 vcc, 0x80000000, v4
    s_nop 1
    v_cndmask_b32 v29, v18, 0, vcc
    v_add_f32 v37, s3, v29
    v_subrev_u32 v3, 2, v2
    v_and_b32 v4, 0x80000001, v3
    v_cmp_eq_u32 vcc, 0, v4
    s_nop 1
    v_cndmask_b32 v34, v18, 0, vcc
    v_cmp_eq_u32 vcc, 0x80000000, v4
    s_nop 1
    v_cndmask_b32 v30, v18, 0, vcc
    v_add_f32 v38, s3, v30
    v_subrev_u32 v3, 3, v2
    v_and_b32 v4, 0x80000001, v3
    v_cmp_eq_u32 vcc, 0, v4
    s_nop 1
    v_cndmask_b32 v35, v18, 0, vcc
    v_cmp_eq_u32 vcc, 0x80000000, v4
    s_nop 1
    v_cndmask_b32 v31, v18, 0, vcc
    v_add_f32 v39, s3, v31
    v_mov_b32 v3, 0x0c0c0c0c
    v_mov_b32 v4, 0xc0c0100
    v_cmp_eq_u32 vcc, 0, v28
    v_mov_b32 v5, 0x1000c0c
    s_nop 0
    v_cndmask_b32 v3, v3, v4, vcc
    v_cmp_eq_u32 vcc, 0, v29
    s_nop 1
    v_cndmask_b32 v40, v3, v5, vcc
    v_mov_b32 v3, 0x0c0c0c0c
    v_mov_b32 v4, 0xc0c0302
    v_cmp_eq_u32 vcc, 0, v30
    v_mov_b32 v5, 0x3020c0c
    s_nop 0
    v_cndmask_b32 v3, v3, v4, vcc
    v_cmp_eq_u32 vcc, 0, v31
    s_nop 1
    v_cndmask_b32 v41, v3, v5, vcc
    v_mov_b32 v3, 0x0c0c0c0c
    v_mov_b32 v4, 0xc0c0100
    v_cmp_eq_u32 vcc, 0, v32
    v_mov_b32 v5, 0x1000c0c
    s_nop 0
    v_cndmask_b32 v3, v3, v4, vcc
    v_cmp_eq_u32 vcc, 0, v33
    s_nop 1
    v_cndmask_b32 v42, v3, v5, vcc
    v_mov_b32 v3, 0x0c0c0c0c
    v_mov_b32 v4, 0xc0c0302
    v_cmp_eq_u32 vcc, 0, v34
    v_mov_b32 v5, 0x3020c0c
    s_nop 0
    v_cndmask_b32 v3, v3, v4, vcc
    v_cmp_eq_u32 vcc, 0, v35
    s_nop 1
    v_cndmask_b32 v43, v3, v5, vcc
    s_mov_b32 s46, 0x3fb8aa3b
    s_mov_b32 s47, s46
    s_mov_b32 s48, 0x3e64f92e
    s_mov_b32 s49, s48
    s_mov_b32 s36, 0xfffff
    s_cmp_lg_u32 s31, 0
    s_cselect_b32 s33, 64, 0
    v_mov_b32 v2, s33
    v_cmp_gt_u32 vcc, 10, v1
    s_lshr_b32 s3, s28, 1
    s_lshl2_add_u32 s3, s3, s31
    v_cndmask_b32 v2, 0, v2, vcc
    v_lshl_add_u32 v2, v1, 8, v2
    s_mul_i32 s3, s3, 2560
    s_lshl2_add_u32 s3, s35, s3
    s_add_u32 s3, s3, 524288
    v_add_u32 v8, s3, v2
    s_cmp_eq_u32 s43, 1
    s_cbranch_scc1 K_CONS
    v_lshrrev_b32 v2, 3, v1
    v_mul_u32_u24 v2, 1280, v2
    v_lshrrev_b32 v3, 4, v1
    v_lshlrev_b32 v3, 1, v3
    v_and_b32 v4, 7, v1
    v_xor_b32 v3, v3, v4
    v_lshl_add_u32 v2, v3, 4, v2
    s_lshl_b32 s33, s41, 7
    v_add_u32 v18, s33, v2
    s_mov_b32 s61, 9
    s_mov_b32 s3, 40960
    s_branch K_LOOPE
K_LOOP:
    s_waitcnt vmcnt(5)
    s_barrier
    s_add_u32 m0, s56, 2048
    s_add_u32 s60, s58, 30720
    buffer_load_dwordx4 v47, s[16:19], s60 offen lds
    s_add_u32 m0, s55, 3072
    s_add_u32 s60, s57, 30720
    buffer_load_dwordx4 v45, s[12:15], s60 offen lds
    s_add_u32 m0, s56, 3072
    s_add_u32 s60, s58, 46080
    buffer_load_dwordx4 v47, s[16:19], s60 offen lds
    s_add_u32 m0, s55, 4096
    s_add_u32 s60, s57, s62
    buffer_load_dwordx4 v44, s[12:15], s60 offen lds
    s_add_u32 m0, s55, 5120
    s_add_u32 s60, s60, 10240
    buffer_load_dwordx4 v45, s[12:15], s60 offen lds
    s_sub_u32 s61, s61, 1
    s_cmp_eq_u32 s61, 0
    s_cbranch_scc1 K_LOOPX
K_LOOPE:
    s_cmp_ge_u32 s55, 81920
    s_cselect_b32 s60, -81920, s3
    s_add_u32 s55, s55, s60
    s_add_u32 s56, s56, s60
    s_lshl_b32 s57, s59, 7
    s_add_u32 s57, s57, s53
    s_mul_i32 s58, s59, 245760
    s_add_u32 s58, s58, s54
    s_add_u32 s59, s59, 1
    s_cmp_eq_u32 s59, 10
    s_cselect_b32 s59, 0, s59
    s_add_u32 m0, s56, 0
    s_add_u32 s60, s58, 0
    buffer_load_dwordx4 v46, s[16:19], s60 offen lds
    s_add_u32 m0, s55, 0
    s_max_i32 s60, s57, 0
    buffer_load_dwordx4 v44, s[12:15], s60 offen lds
    s_add_u32 m0, s56, 1024
    s_add_u32 s60, s58, 15360
    buffer_load_dwordx4 v46, s[16:19], s60 offen lds
    s_add_u32 s60, s57, 10240
    s_add_u32 m0, s55, 1024
    s_max_i32 s60, s60, 0
    buffer_load_dwordx4 v45, s[12:15], s60 offen lds
    s_add_u32 m0, s55, 2048
    s_add_u32 s60, s57, 20480
    buffer_load_dwordx4 v44, s[12:15], s60 offen lds
    s_branch K_LOOP
K_LOOPX:
    v_and_b32 v2, 7, v1
    v_lshlrev_b32 v2, 2, v2
    s_waitcnt vmcnt(0)
    s_barrier
    s_cmp_lt_u32 s30, 6
    s_cbranch_scc1 K_NOSMP
    global_load_dword v7, v2, s[8:9] offset:192 sc1
K_NOSMP:
    s_cmp_eq_u32 s34, -1
    s_cbranch_scc1 K_JOIN_S
    s_cmp_lt_u32 s52, 2
    s_cbranch_scc1 K_WOE
    s_cmp_lg_u32 s30, 7
    s_cbranch_scc1 K_JOIN_S
    s_mov_b32 s52, 2
    s_branch K_W7A
K_WOE:
    s_lshl_b32 s57, s52, 2
    s_lshr_b32 s57, 0x7520, s57
    s_and_b32 s57, s57, 7
    s_mul_i32 s57, s57, 51200
    s_mul_i32 s58, s52, 5120
    s_add_u32 s3, s57, 0
    s_add_u32 m0, s58, 0
    s_nop 0
    buffer_load_dwordx4 v18, s[24:27], s3 offen lds
    s_add_u32 s3, s57, 10240
    s_add_u32 m0, s58, 1024
    s_nop 0
    buffer_load_dwordx4 v18, s[24:27], s3 offen lds
    s_add_u32 s3, s57, 20480
    s_add_u32 m0, s58, 2048
    s_nop 0
    buffer_load_dwordx4 v18, s[24:27], s3 offen lds
    s_add_u32 s3, s57, 30720
    s_add_u32 m0, s58, 3072
    s_nop 0
    buffer_load_dwordx4 v18, s[24:27], s3 offen lds
    s_add_u32 s3, s57, 40960
    s_add_u32 m0, s58, 4096
    s_nop 0
    buffer_load_dwordx4 v18, s[24:27], s3 offen lds
    s_add_u32 s3, s57, 409600
    s_add_u32 m0, s58, 20480
    s_nop 0
    buffer_load_dwordx4 v18, s[24:27], s3 offen lds
    s_add_u32 s3, s57, 419840
    s_add_u32 m0, s58, 21504
    s_nop 0
    buffer_load_dwordx4 v18, s[24:27], s3 offen lds
    s_add_u32 s3, s57, 430080
    s_add_u32 m0, s58, 22528
    s_nop 0
    buffer_load_dwordx4 v18, s[24:27], s3 offen lds
    s_add_u32 s3, s57, 440320
    s_add_u32 m0, s58, 23552
    s_nop 0
    buffer_load_dwordx4 v18, s[24:27], s3 offen lds
    s_add_u32 s3, s57, 450560
    s_add_u32 m0, s58, 24576
    s_nop 0
    buffer_load_dwordx4 v18, s[24:27], s3 offen lds
    s_cmp_lg_u32 s30, 7
    s_cbranch_scc1 K_JOIN_S
    s_add_u32 s52, s52, 1
    s_cmp_lt_u32 s52, 4
    s_cbranch_scc1 K_WOE
    s_mov_b32 s52, 0
K_XD:
    s_lshl_b32 s57, s40, 3
    s_lshl1_add_u32 s57, s52, s57
    s_mul_i32 s57, s57, 20480
    s_lshl_b32 s33, s41, 7
    s_add_u32 s57, s57, s33
    s_lshl_b32 s33, s52, 12
    s_add_u32 m0, s33, 140288
    s_add_u32 s3, s57, 0
    buffer_load_dwordx4 v44, s[12:15], s3 offen lds
    s_add_u32 m0, s33, 141312
    s_add_u32 s3, s57, 10240
    buffer_load_dwordx4 v45, s[12:15], s3 offen lds
    s_add_u32 m0, s33, 142336
    s_add_u32 s3, s57, 20480
    buffer_load_dwordx4 v44, s[12:15], s3 offen lds
    s_add_u32 m0, s33, 143360
    s_add_u32 s3, s57, 30720
    buffer_load_dwordx4 v45, s[12:15], s3 offen lds
    s_add_u32 s52, s52, 1
    s_cmp_lt_u32 s52, 4
    s_cbranch_scc1 K_XD
    s_branch K_W7
.p2align 12
K_CONS:
    s_lshr_b32 s52, s30, 1
    s_and_b32 s53, s30, 1
    v_lshrrev_b32 v2, 1, v9
    v_xor_b32 v2, v2, v10
    v_lshlrev_b32 v2, 4, v2
    v_lshl_add_u32 v2, v9, 7, v2
    s_mul_i32 s3, s52, 12288
    v_add_u32 v44, s3, v2
    v_xor_b32 v45, 64, v44
    v_add_u32 v46, 81920, v44
    v_add_u32 v47, 81920, v45
    v_and_b32 v2, 1, v10
    v_lshl_or_b32 v2, v2, 2, v11
    v_lshl_add_u32 v3, v10, 3, v11
    v_lshlrev_b32 v3, 8, v3
    v_lshl_add_u32 v3, v12, 3, v3
    v_add_u32 v3, 24576, v3
    s_lshl_b32 s3, s53, 2
    v_add_u32 v2, s3, v2
    v_add_u32 v4, 0, v2
    v_and_b32 v4, 7, v4
    v_lshl_add_u32 v48, v4, 5, v3
    v_add_u32 v52, 81920, v48
    v_add_u32 v4, 1, v2
    v_and_b32 v4, 7, v4
    v_lshl_add_u32 v49, v4, 5, v3
    v_add_u32 v53, 81920, v49
    v_add_u32 v4, 2, v2
    v_and_b32 v4, 7, v4
    v_lshl_add_u32 v50, v4, 5, v3
    v_add_u32 v54, 81920, v50
    v_add_u32 v4, 3, v2
    v_and_b32 v4, 7, v4
    v_lshl_add_u32 v51, v4, 5, v3
    v_add_u32 v55, 81920, v51
    v_mul_u32_u24 v56, 272, v9
    v_lshl_add_u32 v56, v10, 3, v56
    s_mul_i32 s3, s52, 26112
    s_lshl_b32 s33, s53, 7
    s_add_u32 s3, s3, s33
    s_add_u32 s3, s3, 81920
    v_add_u32 v56, s3, v56
    v_mov_b64 v[60:61], 0
    v_mov_b64 v[62:63], 0
    v_mov_b64 v[64:65], 0
    v_mov_b64 v[66:67], 0
    v_mov_b64 v[68:69], 0
    v_mov_b64 v[70:71], 0
    v_mov_b64 v[72:73], 0
    v_mov_b64 v[74:75], 0
    v_mov_b64 v[76:77], 0
    v_mov_b64 v[78:79], 0
    v_mov_b64 v[80:81], 0
    v_mov_b64 v[82:83], 0
    v_mov_b64 v[84:85], 0
    v_mov_b64 v[86:87], 0
    v_mov_b64 v[88:89], 0
    v_mov_b64 v[90:91], 0
    v_mov_b64 v[92:93], 0
    v_mov_b64 v[94:95], 0
    v_mov_b64 v[96:97], 0
    v_mov_b64 v[98:99], 0
    v_mov_b64 v[100:101], 0
    v_mov_b64 v[102:103], 0
    v_mov_b64 v[104:105], 0
    v_mov_b64 v[106:107], 0
    v_mov_b64 v[108:109], 0
    v_mov_b64 v[110:111], 0
    v_mov_b64 v[112:113], 0
    v_mov_b64 v[114:115], 0
    v_mov_b64 v[116:117], 0
    v_mov_b64 v[118:119], 0
    v_mov_b64 v[120:121], 0
    v_mov_b64 v[122:123], 0
    v_mov_b64 v[124:125], 0
    v_mov_b64 v[126:127], 0
    v_mov_b64 v[128:129], 0
    v_mov_b64 v[130:131], 0
    v_mov_b64 v[132:133], 0
    v_mov_b64 v[134:135], 0
    v_mov_b64 v[136:137], 0
    v_mov_b64 v[138:139], 0
    v_mov_b64 v[140:141], 0
    v_mov_b64 v[142:143], 0
    v_mov_b64 v[144:145], 0
    v_mov_b64 v[146:147], 0
    v_mov_b64 v[148:149], 0
    v_mov_b64 v[150:151], 0
    v_mov_b64 v[152:153], 0
    v_mov_b64 v[154:155], 0
    s_mov_b32 s54, 3
    s_cmp_lg_u32 s30, 0
    s_cbranch_scc1 K_WARMM0
    s_call_b64 s[38:39], WP_attd
    s_call_b64 s[38:39], WP_p2g
    s_branch K_WARMMX
K_WARMM0:
    s_cmp_lg_u32 s30, 1
    s_cbranch_scc1 K_WARMM1
    s_call_b64 s[38:39], WP_atts
    s_call_b64 s[38:39], WP_early
    s_branch K_WARMMX
K_WARMM1:
    s_cmp_lg_u32 s30, 2
    s_cbranch_scc1 K_WARMM2
    s_call_b64 s[38:39], WP_help
    s_call_b64 s[38:39], WP_flags
    s_branch K_WARMMX
K_WARMM2:
    s_call_b64 s[38:39], WP_spin
K_WARMMX:
    s_barrier
    ds_read_b64_tr_b16 v[204:205], v48 offset:40960
    ds_read_b64_tr_b16 v[206:207], v48 offset:41984
    ds_read_b128 v[156:159], v44 offset:40960
    ds_read_b64_tr_b16 v[208:209], v49 offset:40960
    ds_read_b64_tr_b16 v[210:211], v49 offset:41984
    ds_read_b128 v[160:163], v44 offset:43008
    ds_read_b64_tr_b16 v[212:213], v50 offset:40960
    ds_read_b64_tr_b16 v[214:215], v50 offset:41984
    ds_read_b128 v[164:167], v44 offset:45056
    ds_read_b64_tr_b16 v[216:217], v51 offset:40960
    ds_read_b64_tr_b16 v[218:219], v51 offset:41984
    ds_read_b128 v[168:171], v44 offset:47104
    ds_read_b128 v[172:175], v44 offset:49152
    ds_read_b128 v[176:179], v44 offset:51200
K_CLOOP:
    s_waitcnt lgkmcnt(0)
    v_mfma_f32_16x16x32_bf16 v[60:63], v[204:207], v[156:159], v[60:63]
    ds_read_b64_tr_b16 v[220:221], v48 offset:49152
    v_mfma_f32_16x16x32_bf16 v[64:67], v[208:211], v[156:159], v[64:67]
    ds_read_b64_tr_b16 v[222:223], v48 offset:50176
    v_mfma_f32_16x16x32_bf16 v[68:71], v[212:215], v[156:159], v[68:71]
    ds_read_b128 v[180:183], v45 offset:40960
    v_mfma_f32_16x16x32_bf16 v[72:75], v[216:219], v[156:159], v[72:75]
    ds_read_b64_tr_b16 v[224:225], v49 offset:49152
    v_mfma_f32_16x16x32_bf16 v[88:91], v[216:219], v[160:163], v[88:91]
    ds_read_b64_tr_b16 v[226:227], v49 offset:50176
    v_mfma_f32_16x16x32_bf16 v[84:87], v[212:215], v[160:163], v[84:87]
    ds_read_b128 v[184:187], v45 offset:43008
    v_mfma_f32_16x16x32_bf16 v[80:83], v[208:211], v[160:163], v[80:83]
    ds_read_b64_tr_b16 v[228:229], v50 offset:49152
    v_mfma_f32_16x16x32_bf16 v[76:79], v[204:207], v[160:163], v[76:79]
    ds_read_b64_tr_b16 v[230:231], v50 offset:50176
    v_mfma_f32_16x16x32_bf16 v[92:95], v[204:207], v[164:167], v[92:95]
    ds_read_b128 v[188:191], v45 offset:45056
    v_mfma_f32_16x16x32_bf16 v[96:99], v[208:211], v[164:167], v[96:99]
    ds_read_b64_tr_b16 v[232:233], v51 offset:49152
    v_mfma_f32_16x16x32_bf16 v[100:103], v[212:215], v[164:167], v[100:103]
    ds_read_b64_tr_b16 v[234:235], v51 offset:50176
    v_mfma_f32_16x16x32_bf16 v[104:107], v[216:219], v[164:167], v[104:107]
    ds_read_b128 v[192:195], v45 offset:47104
    v_mfma_f32_16x16x32_bf16 v[120:123], v[216:219], v[168:171], v[120:123]
    ds_read_b128 v[196:199], v45 offset:49152
    v_mfma_f32_16x16x32_bf16 v[116:119], v[212:215], v[168:171], v[116:119]
    ds_read_b128 v[200:203], v45 offset:51200
    v_mfma_f32_16x16x32_bf16 v[112:115], v[208:211], v[168:171], v[112:115]
    v_mfma_f32_16x16x32_bf16 v[108:111], v[204:207], v[168:171], v[108:111]
    v_mfma_f32_16x16x32_bf16 v[124:127], v[204:207], v[172:175], v[124:127]
    v_mfma_f32_16x16x32_bf16 v[128:131], v[208:211], v[172:175], v[128:131]
    v_mfma_f32_16x16x32_bf16 v[132:135], v[212:215], v[172:175], v[132:135]
    v_mfma_f32_16x16x32_bf16 v[136:139], v[216:219], v[172:175], v[136:139]
    v_mfma_f32_16x16x32_bf16 v[152:155], v[216:219], v[176:179], v[152:155]
    v_mfma_f32_16x16x32_bf16 v[148:151], v[212:215], v[176:179], v[148:151]
    v_mfma_f32_16x16x32_bf16 v[144:147], v[208:211], v[176:179], v[144:147]
    v_mfma_f32_16x16x32_bf16 v[140:143], v[204:207], v[176:179], v[140:143]
    s_waitcnt lgkmcnt(0)
    s_barrier
    v_mfma_f32_16x16x32_bf16 v[60:63], v[220:223], v[180:183], v[60:63]
    ds_read_b64_tr_b16 v[204:205], v52 offset:0
    v_mfma_f32_16x16x32_bf16 v[64:67], v[224:227], v[180:183], v[64:67]
    ds_read_b64_tr_b16 v[206:207], v52 offset:1024
    v_mfma_f32_16x16x32_bf16 v[68:71], v[228:231], v[180:183], v[68:71]
    ds_read_b128 v[156:159], v46 offset:0
    v_mfma_f32_16x16x32_bf16 v[72:75], v[232:235], v[180:183], v[72:75]
    ds_read_b64_tr_b16 v[208:209], v53 offset:0
    v_mfma_f32_16x16x32_bf16 v[88:91], v[232:235], v[184:187], v[88:91]
    ds_read_b64_tr_b16 v[210:211], v53 offset:1024
    v_mfma_f32_16x16x32_bf16 v[84:87], v[228:231], v[184:187], v[84:87]
    ds_read_b128 v[160:163], v46 offset:2048
    v_mfma_f32_16x16x32_bf16 v[80:83], v[224:227], v[184:187], v[80:83]
    ds_read_b64_tr_b16 v[212:213], v54 offset:0
    v_mfma_f32_16x16x32_bf16 v[76:79], v[220:223], v[184:187], v[76:79]
    ds_read_b64_tr_b16 v[214:215], v54 offset:1024
    v_mfma_f32_16x16x32_bf16 v[92:95], v[220:223], v[188:191], v[92:95]
    ds_read_b128 v[164:167], v46 offset:4096
    v_mfma_f32_16x16x32_bf16 v[96:99], v[224:227], v[188:191], v[96:99]
    ds_read_b64_tr_b16 v[216:217], v55 offset:0
    v_mfma_f32_16x16x32_bf16 v[100:103], v[228:231], v[188:191], v[100:103]
    ds_read_b64_tr_b16 v[218:219], v55 offset:1024
    v_mfma_f32_16x16x32_bf16 v[104:107], v[232:235], v[188:191], v[104:107]
    ds_read_b128 v[168:171], v46 offset:6144
    v_mfma_f32_16x16x32_bf16 v[120:123], v[232:235], v[192:195], v[120:123]
    ds_read_b128 v[172:175], v46 offset:8192
    v_mfma_f32_16x16x32_bf16 v[116:119], v[228:231], v[192:195], v[116:119]
    ds_read_b128 v[176:179], v46 offset:10240
    v_mfma_f32_16x16x32_bf16 v[112:115], v[224:227], v[192:195], v[112:115]
    v_mfma_f32_16x16x32_bf16 v[108:111], v[220:223], v[192:195], v[108:111]
    v_mfma_f32_16x16x32_bf16 v[124:127], v[220:223], v[196:199], v[124:127]
    v_mfma_f32_16x16x32_bf16 v[128:131], v[224:227], v[196:199], v[128:131]
    v_mfma_f32_16x16x32_bf16 v[132:135], v[228:231], v[196:199], v[132:135]
    v_mfma_f32_16x16x32_bf16 v[136:139], v[232:235], v[196:199], v[136:139]
    v_mfma_f32_16x16x32_bf16 v[152:155], v[232:235], v[200:203], v[152:155]
    v_mfma_f32_16x16x32_bf16 v[148:151], v[228:231], v[200:203], v[148:151]
    v_mfma_f32_16x16x32_bf16 v[144:147], v[224:227], v[200:203], v[144:147]
    v_mfma_f32_16x16x32_bf16 v[140:143], v[220:223], v[200:203], v[140:143]
    s_waitcnt lgkmcnt(0)
    v_mfma_f32_16x16x32_bf16 v[60:63], v[204:207], v[156:159], v[60:63]
    ds_read_b64_tr_b16 v[220:221], v52 offset:8192
    v_mfma_f32_16x16x32_bf16 v[64:67], v[208:211], v[156:159], v[64:67]
    ds_read_b64_tr_b16 v[222:223], v52 offset:9216
    v_mfma_f32_16x16x32_bf16 v[68:71], v[212:215], v[156:159], v[68:71]
    ds_read_b128 v[180:183], v47 offset:0
    v_mfma_f32_16x16x32_bf16 v[72:75], v[216:219], v[156:159], v[72:75]
    ds_read_b64_tr_b16 v[224:225], v53 offset:8192
    v_mfma_f32_16x16x32_bf16 v[88:91], v[216:219], v[160:163], v[88:91]
    ds_read_b64_tr_b16 v[226:227], v53 offset:9216
    v_mfma_f32_16x16x32_bf16 v[84:87], v[212:215], v[160:163], v[84:87]
    ds_read_b128 v[184:187], v47 offset:2048
    v_mfma_f32_16x16x32_bf16 v[80:83], v[208:211], v[160:163], v[80:83]
    ds_read_b64_tr_b16 v[228:229], v54 offset:8192
    v_mfma_f32_16x16x32_bf16 v[76:79], v[204:207], v[160:163], v[76:79]
    ds_read_b64_tr_b16 v[230:231], v54 offset:9216
    v_mfma_f32_16x16x32_bf16 v[92:95], v[204:207], v[164:167], v[92:95]
    ds_read_b128 v[188:191], v47 offset:4096
    v_mfma_f32_16x16x32_bf16 v[96:99], v[208:211], v[164:167], v[96:99]
    ds_read_b64_tr_b16 v[232:233], v55 offset:8192
    v_mfma_f32_16x16x32_bf16 v[100:103], v[212:215], v[164:167], v[100:103]
    ds_read_b64_tr_b16 v[234:235], v55 offset:9216
    v_mfma_f32_16x16x32_bf16 v[104:107], v[216:219], v[164:167], v[104:107]
    ds_read_b128 v[192:195], v47 offset:6144
    v_mfma_f32_16x16x32_bf16 v[120:123], v[216:219], v[168:171], v[120:123]
    ds_read_b128 v[196:199], v47 offset:8192
    v_mfma_f32_16x16x32_bf16 v[116:119], v[212:215], v[168:171], v[116:119]
    ds_read_b128 v[200:203], v47 offset:10240
    v_mfma_f32_16x16x32_bf16 v[112:115], v[208:211], v[168:171], v[112:115]
    v_mfma_f32_16x16x32_bf16 v[108:111], v[204:207], v[168:171], v[108:111]
    v_mfma_f32_16x16x32_bf16 v[124:127], v[204:207], v[172:175], v[124:127]
    v_mfma_f32_16x16x32_bf16 v[128:131], v[208:211], v[172:175], v[128:131]
    v_mfma_f32_16x16x32_bf16 v[132:135], v[212:215], v[172:175], v[132:135]
    v_mfma_f32_16x16x32_bf16 v[136:139], v[216:219], v[172:175], v[136:139]
    v_mfma_f32_16x16x32_bf16 v[152:155], v[216:219], v[176:179], v[152:155]
    v_mfma_f32_16x16x32_bf16 v[148:151], v[212:215], v[176:179], v[148:151]
    v_mfma_f32_16x16x32_bf16 v[144:147], v[208:211], v[176:179], v[144:147]
    v_mfma_f32_16x16x32_bf16 v[140:143], v[204:207], v[176:179], v[140:143]
    s_waitcnt lgkmcnt(0)
    s_barrier
    v_mfma_f32_16x16x32_bf16 v[60:63], v[220:223], v[180:183], v[60:63]
    ds_read_b64_tr_b16 v[204:205], v48 offset:0
    v_mfma_f32_16x16x32_bf16 v[64:67], v[224:227], v[180:183], v[64:67]
    ds_read_b64_tr_b16 v[206:207], v48 offset:1024
    v_mfma_f32_16x16x32_bf16 v[68:71], v[228:231], v[180:183], v[68:71]
    ds_read_b128 v[156:159], v44 offset:0
    v_mfma_f32_16x16x32_bf16 v[72:75], v[232:235], v[180:183], v[72:75]
    ds_read_b64_tr_b16 v[208:209], v49 offset:0
    v_mfma_f32_16x16x32_bf16 v[88:91], v[232:235], v[184:187], v[88:91]
    ds_read_b64_tr_b16 v[210:211], v49 offset:1024
    v_mfma_f32_16x16x32_bf16 v[84:87], v[228:231], v[184:187], v[84:87]
    ds_read_b128 v[160:163], v44 offset:2048
    v_mfma_f32_16x16x32_bf16 v[80:83], v[224:227], v[184:187], v[80:83]
    ds_read_b64_tr_b16 v[212:213], v50 offset:0
    v_mfma_f32_16x16x32_bf16 v[76:79], v[220:223], v[184:187], v[76:79]
    ds_read_b64_tr_b16 v[214:215], v50 offset:1024
    v_mfma_f32_16x16x32_bf16 v[92:95], v[220:223], v[188:191], v[92:95]
    ds_read_b128 v[164:167], v44 offset:4096
    v_mfma_f32_16x16x32_bf16 v[96:99], v[224:227], v[188:191], v[96:99]
    ds_read_b64_tr_b16 v[216:217], v51 offset:0
    v_mfma_f32_16x16x32_bf16 v[100:103], v[228:231], v[188:191], v[100:103]
    ds_read_b64_tr_b16 v[218:219], v51 offset:1024
    v_mfma_f32_16x16x32_bf16 v[104:107], v[232:235], v[188:191], v[104:107]
    ds_read_b128 v[168:171], v44 offset:6144
    v_mfma_f32_16x16x32_bf16 v[120:123], v[232:235], v[192:195], v[120:123]
    ds_read_b128 v[172:175], v44 offset:8192
    v_mfma_f32_16x16x32_bf16 v[116:119], v[228:231], v[192:195], v[116:119]
    ds_read_b128 v[176:179], v44 offset:10240
    v_mfma_f32_16x16x32_bf16 v[112:115], v[224:227], v[192:195], v[112:115]
    v_mfma_f32_16x16x32_bf16 v[108:111], v[220:223], v[192:195], v[108:111]
    v_mfma_f32_16x16x32_bf16 v[124:127], v[220:223], v[196:199], v[124:127]
    v_mfma_f32_16x16x32_bf16 v[128:131], v[224:227], v[196:199], v[128:131]
    v_mfma_f32_16x16x32_bf16 v[132:135], v[228:231], v[196:199], v[132:135]
    v_mfma_f32_16x16x32_bf16 v[136:139], v[232:235], v[196:199], v[136:139]
    v_mfma_f32_16x16x32_bf16 v[152:155], v[232:235], v[200:203], v[152:155]
    v_mfma_f32_16x16x32_bf16 v[148:151], v[228:231], v[200:203], v[148:151]
    v_mfma_f32_16x16x32_bf16 v[144:147], v[224:227], v[200:203], v[144:147]
    v_mfma_f32_16x16x32_bf16 v[140:143], v[220:223], v[200:203], v[140:143]
    s_waitcnt lgkmcnt(0)
    v_mfma_f32_16x16x32_bf16 v[60:63], v[204:207], v[156:159], v[60:63]
    ds_read_b64_tr_b16 v[220:221], v48 offset:8192
    v_mfma_f32_16x16x32_bf16 v[64:67], v[208:211], v[156:159], v[64:67]
    ds_read_b64_tr_b16 v[222:223], v48 offset:9216
    v_mfma_f32_16x16x32_bf16 v[68:71], v[212:215], v[156:159], v[68:71]
    ds_read_b128 v[180:183], v45 offset:0
    v_mfma_f32_16x16x32_bf16 v[72:75], v[216:219], v[156:159], v[72:75]
    ds_read_b64_tr_b16 v[224:225], v49 offset:8192
    v_mfma_f32_16x16x32_bf16 v[88:91], v[216:219], v[160:163], v[88:91]
    ds_read_b64_tr_b16 v[226:227], v49 offset:9216
    v_mfma_f32_16x16x32_bf16 v[84:87], v[212:215], v[160:163], v[84:87]
    ds_read_b128 v[184:187], v45 offset:2048
    v_mfma_f32_16x16x32_bf16 v[80:83], v[208:211], v[160:163], v[80:83]
    ds_read_b64_tr_b16 v[228:229], v50 offset:8192
    v_mfma_f32_16x16x32_bf16 v[76:79], v[204:207], v[160:163], v[76:79]
    ds_read_b64_tr_b16 v[230:231], v50 offset:9216
    v_mfma_f32_16x16x32_bf16 v[92:95], v[204:207], v[164:167], v[92:95]
    ds_read_b128 v[188:191], v45 offset:4096
    v_mfma_f32_16x16x32_bf16 v[96:99], v[208:211], v[164:167], v[96:99]
    ds_read_b64_tr_b16 v[232:233], v51 offset:8192
    v_mfma_f32_16x16x32_bf16 v[100:103], v[212:215], v[164:167], v[100:103]
    ds_read_b64_tr_b16 v[234:235], v51 offset:9216
    v_mfma_f32_16x16x32_bf16 v[104:107], v[216:219], v[164:167], v[104:107]
    ds_read_b128 v[192:195], v45 offset:6144
    v_mfma_f32_16x16x32_bf16 v[120:123], v[216:219], v[168:171], v[120:123]
    ds_read_b128 v[196:199], v45 offset:8192
    v_mfma_f32_16x16x32_bf16 v[116:119], v[212:215], v[168:171], v[116:119]
    ds_read_b128 v[200:203], v45 offset:10240
    v_mfma_f32_16x16x32_bf16 v[112:115], v[208:211], v[168:171], v[112:115]
    v_mfma_f32_16x16x32_bf16 v[108:111], v[204:207], v[168:171], v[108:111]
    v_mfma_f32_16x16x32_bf16 v[124:127], v[204:207], v[172:175], v[124:127]
    v_mfma_f32_16x16x32_bf16 v[128:131], v[208:211], v[172:175], v[128:131]
    v_mfma_f32_16x16x32_bf16 v[132:135], v[212:215], v[172:175], v[132:135]
    v_mfma_f32_16x16x32_bf16 v[136:139], v[216:219], v[172:175], v[136:139]
    v_mfma_f32_16x16x32_bf16 v[152:155], v[216:219], v[176:179], v[152:155]
    v_mfma_f32_16x16x32_bf16 v[148:151], v[212:215], v[176:179], v[148:151]
    v_mfma_f32_16x16x32_bf16 v[144:147], v[208:211], v[176:179], v[144:147]
    v_mfma_f32_16x16x32_bf16 v[140:143], v[204:207], v[176:179], v[140:143]
    s_waitcnt lgkmcnt(0)
    s_barrier
    v_mfma_f32_16x16x32_bf16 v[60:63], v[220:223], v[180:183], v[60:63]
    ds_read_b64_tr_b16 v[204:205], v48 offset:40960
    v_mfma_f32_16x16x32_bf16 v[64:67], v[224:227], v[180:183], v[64:67]
    ds_read_b64_tr_b16 v[206:207], v48 offset:41984
    v_mfma_f32_16x16x32_bf16 v[68:71], v[228:231], v[180:183], v[68:71]
    ds_read_b128 v[156:159], v44 offset:40960
    v_mfma_f32_16x16x32_bf16 v[72:75], v[232:235], v[180:183], v[72:75]
    ds_read_b64_tr_b16 v[208:209], v49 offset:40960
    v_mfma_f32_16x16x32_bf16 v[88:91], v[232:235], v[184:187], v[88:91]
    ds_read_b64_tr_b16 v[210:211], v49 offset:41984
    v_mfma_f32_16x16x32_bf16 v[84:87], v[228:231], v[184:187], v[84:87]
    ds_read_b128 v[160:163], v44 offset:43008
    v_mfma_f32_16x16x32_bf16 v[80:83], v[224:227], v[184:187], v[80:83]
    ds_read_b64_tr_b16 v[212:213], v50 offset:40960
    v_mfma_f32_16x16x32_bf16 v[76:79], v[220:223], v[184:187], v[76:79]
    ds_read_b64_tr_b16 v[214:215], v50 offset:41984
    v_mfma_f32_16x16x32_bf16 v[92:95], v[220:223], v[188:191], v[92:95]
    ds_read_b128 v[164:167], v44 offset:45056
    v_mfma_f32_16x16x32_bf16 v[96:99], v[224:227], v[188:191], v[96:99]
    ds_read_b64_tr_b16 v[216:217], v51 offset:40960
    v_mfma_f32_16x16x32_bf16 v[100:103], v[228:231], v[188:191], v[100:103]
    ds_read_b64_tr_b16 v[218:219], v51 offset:41984
    v_mfma_f32_16x16x32_bf16 v[104:107], v[232:235], v[188:191], v[104:107]
    ds_read_b128 v[168:171], v44 offset:47104
    v_mfma_f32_16x16x32_bf16 v[120:123], v[232:235], v[192:195], v[120:123]
    ds_read_b128 v[172:175], v44 offset:49152
    v_mfma_f32_16x16x32_bf16 v[116:119], v[228:231], v[192:195], v[116:119]
    ds_read_b128 v[176:179], v44 offset:51200
    v_mfma_f32_16x16x32_bf16 v[112:115], v[224:227], v[192:195], v[112:115]
    s_sub_u32 s54, s54, 1
    v_mfma_f32_16x16x32_bf16 v[108:111], v[220:223], v[192:195], v[108:111]
    s_cmp_lg_u32 s54, 0
    v_mfma_f32_16x16x32_bf16 v[124:127], v[220:223], v[196:199], v[124:127]
    v_mfma_f32_16x16x32_bf16 v[128:131], v[224:227], v[196:199], v[128:131]
    v_mfma_f32_16x16x32_bf16 v[132:135], v[228:231], v[196:199], v[132:135]
    v_mfma_f32_16x16x32_bf16 v[136:139], v[232:235], v[196:199], v[136:139]
    v_mfma_f32_16x16x32_bf16 v[152:155], v[232:235], v[200:203], v[152:155]
    v_mfma_f32_16x16x32_bf16 v[148:151], v[228:231], v[200:203], v[148:151]
    v_mfma_f32_16x16x32_bf16 v[144:147], v[224:227], v[200:203], v[144:147]
    v_mfma_f32_16x16x32_bf16 v[140:143], v[220:223], v[200:203], v[140:143]
    s_cbranch_scc1 K_CLOOP
    s_waitcnt lgkmcnt(0)
    v_mfma_f32_16x16x32_bf16 v[60:63], v[204:207], v[156:159], v[60:63]
    ds_read_b128 v[180:183], v45 offset:40960
    ds_read_b64_tr_b16 v[220:221], v48 offset:49152
    v_mfma_f32_16x16x32_bf16 v[64:67], v[208:211], v[156:159], v[64:67]
    ds_read_b64_tr_b16 v[222:223], v48 offset:50176
    ds_read_b64_tr_b16 v[224:225], v49 offset:49152
    v_mfma_f32_16x16x32_bf16 v[68:71], v[212:215], v[156:159], v[68:71]
    ds_read_b64_tr_b16 v[226:227], v49 offset:50176
    ds_read_b64_tr_b16 v[228:229], v50 offset:49152
    v_mfma_f32_16x16x32_bf16 v[72:75], v[216:219], v[156:159], v[72:75]
    ds_read_b64_tr_b16 v[230:231], v50 offset:50176
    ds_read_b64_tr_b16 v[232:233], v51 offset:49152
    v_mfma_f32_16x16x32_bf16 v[76:79], v[204:207], v[160:163], v[76:79]
    ds_read_b64_tr_b16 v[234:235], v51 offset:50176
    ds_read_b128 v[184:187], v45 offset:43008
    v_mfma_f32_16x16x32_bf16 v[80:83], v[208:211], v[160:163], v[80:83]
    ds_read_b128 v[188:191], v45 offset:45056
    ds_read_b128 v[192:195], v45 offset:47104
    v_mfma_f32_16x16x32_bf16 v[84:87], v[212:215], v[160:163], v[84:87]
    ds_read_b128 v[196:199], v45 offset:49152
    ds_read_b128 v[200:203], v45 offset:51200
    v_mfma_f32_16x16x32_bf16 v[88:91], v[216:219], v[160:163], v[88:91]
    s_waitcnt lgkmcnt(11)
    v_mfma_f32_16x16x32_bf16 v[60:63], v[220:223], v[180:183], v[60:63]
    s_nop 1
    s_waitcnt lgkmcnt(9)
    v_mfma_f32_16x16x32_bf16 v[64:67], v[224:227], v[180:183], v[64:67]
    s_nop 1
    s_waitcnt lgkmcnt(7)
    v_mfma_f32_16x16x32_bf16 v[68:71], v[228:231], v[180:183], v[68:71]
    v_cvt_pk_bf16_f32 v60, v60, v61
    v_cvt_pk_bf16_f32 v61, v62, v63
    s_waitcnt lgkmcnt(5)
    v_mfma_f32_16x16x32_bf16 v[72:75], v[232:235], v[180:183], v[72:75]
    ds_write_b64 v56, v[60:61] offset:0
    s_waitcnt lgkmcnt(5)
    v_mfma_f32_16x16x32_bf16 v[76:79], v[220:223], v[184:187], v[76:79]
    v_cvt_pk_bf16_f32 v64, v64, v65
    v_cvt_pk_bf16_f32 v65, v66, v67
    v_mfma_f32_16x16x32_bf16 v[80:83], v[224:227], v[184:187], v[80:83]
    ds_write_b64 v56, v[64:65] offset:32
    v_mfma_f32_16x16x32_bf16 v[84:87], v[228:231], v[184:187], v[84:87]
    v_cvt_pk_bf16_f32 v68, v68, v69
    v_cvt_pk_bf16_f32 v69, v70, v71
    v_mfma_f32_16x16x32_bf16 v[88:91], v[232:235], v[184:187], v[88:91]
    ds_write_b64 v56, v[68:69] offset:64
    v_mfma_f32_16x16x32_bf16 v[92:95], v[204:207], v[164:167], v[92:95]
    v_cvt_pk_bf16_f32 v72, v72, v73
    v_cvt_pk_bf16_f32 v73, v74, v75
    v_mfma_f32_16x16x32_bf16 v[96:99], v[208:211], v[164:167], v[96:99]
    ds_write_b64 v56, v[72:73] offset:96
    v_mfma_f32_16x16x32_bf16 v[100:103], v[212:215], v[164:167], v[100:103]
    v_cvt_pk_bf16_f32 v76, v76, v77
    v_cvt_pk_bf16_f32 v77, v78, v79
    v_mfma_f32_16x16x32_bf16 v[104:107], v[216:219], v[164:167], v[104:107]
    ds_write_b64 v56, v[76:77] offset:4352
    s_waitcnt lgkmcnt(8)
    v_mfma_f32_16x16x32_bf16 v[92:95], v[220:223], v[188:191], v[92:95]
    v_cvt_pk_bf16_f32 v80, v80, v81
    v_cvt_pk_bf16_f32 v81, v82, v83
    v_mfma_f32_16x16x32_bf16 v[96:99], v[224:227], v[188:191], v[96:99]
    ds_write_b64 v56, v[80:81] offset:4384
    v_mfma_f32_16x16x32_bf16 v[100:103], v[228:231], v[188:191], v[100:103]
    v_cvt_pk_bf16_f32 v84, v84, v85
    v_cvt_pk_bf16_f32 v85, v86, v87
    v_mfma_f32_16x16x32_bf16 v[104:107], v[232:235], v[188:191], v[104:107]
    ds_write_b64 v56, v[84:85] offset:4416
    v_mfma_f32_16x16x32_bf16 v[108:111], v[204:207], v[168:171], v[108:111]
    v_cvt_pk_bf16_f32 v88, v88, v89
    v_cvt_pk_bf16_f32 v89, v90, v91
    v_mfma_f32_16x16x32_bf16 v[112:115], v[208:211], v[168:171], v[112:115]
    ds_write_b64 v56, v[88:89] offset:4448
    v_mfma_f32_16x16x32_bf16 v[116:119], v[212:215], v[168:171], v[116:119]
    v_cvt_pk_bf16_f32 v92, v92, v93
    v_cvt_pk_bf16_f32 v93, v94, v95
    v_mfma_f32_16x16x32_bf16 v[120:123], v[216:219], v[168:171], v[120:123]
    ds_write_b64 v56, v[92:93] offset:8704
    s_waitcnt lgkmcnt(11)
    v_mfma_f32_16x16x32_bf16 v[108:111], v[220:223], v[192:195], v[108:111]
    v_cvt_pk_bf16_f32 v96, v96, v97
    v_cvt_pk_bf16_f32 v97, v98, v99
    v_mfma_f32_16x16x32_bf16 v[112:115], v[224:227], v[192:195], v[112:115]
    ds_write_b64 v56, v[96:97] offset:8736
    v_mfma_f32_16x16x32_bf16 v[116:119], v[228:231], v[192:195], v[116:119]
    v_cvt_pk_bf16_f32 v100, v100, v101
    v_cvt_pk_bf16_f32 v101, v102, v103
    v_mfma_f32_16x16x32_bf16 v[120:123], v[232:235], v[192:195], v[120:123]
    ds_write_b64 v56, v[100:101] offset:8768
    v_mfma_f32_16x16x32_bf16 v[124:127], v[204:207], v[172:175], v[124:127]
    v_cvt_pk_bf16_f32 v104, v104, v105
    v_cvt_pk_bf16_f32 v105, v106, v107
    v_mfma_f32_16x16x32_bf16 v[128:131], v[208:211], v[172:175], v[128:131]
    ds_write_b64 v56, v[104:105] offset:8800
    v_mfma_f32_16x16x32_bf16 v[132:135], v[212:215], v[172:175], v[132:135]
    v_cvt_pk_bf16_f32 v108, v108, v109
    v_cvt_pk_bf16_f32 v109, v110, v111
    v_mfma_f32_16x16x32_bf16 v[136:139], v[216:219], v[172:175], v[136:139]
    ds_write_b64 v56, v[108:109] offset:13056
    s_waitcnt lgkmcnt(14)
    v_mfma_f32_16x16x32_bf16 v[124:127], v[220:223], v[196:199], v[124:127]
    v_cvt_pk_bf16_f32 v112, v112, v113
    v_cvt_pk_bf16_f32 v113, v114, v115
    v_mfma_f32_16x16x32_bf16 v[128:131], v[224:227], v[196:199], v[128:131]
    ds_write_b64 v56, v[112:113] offset:13088
    v_mfma_f32_16x16x32_bf16 v[132:135], v[228:231], v[196:199], v[132:135]
    v_cvt_pk_bf16_f32 v116, v116, v117
    v_cvt_pk_bf16_f32 v117, v118, v119
    v_mfma_f32_16x16x32_bf16 v[136:139], v[232:235], v[196:199], v[136:139]
    ds_write_b64 v56, v[116:117] offset:13120
    v_mfma_f32_16x16x32_bf16 v[140:143], v[204:207], v[176:179], v[140:143]
    v_cvt_pk_bf16_f32 v120, v120, v121
    v_cvt_pk_bf16_f32 v121, v122, v123
    v_mfma_f32_16x16x32_bf16 v[144:147], v[208:211], v[176:179], v[144:147]
    ds_write_b64 v56, v[120:121] offset:13152
    v_mfma_f32_16x16x32_bf16 v[148:151], v[212:215], v[176:179], v[148:151]
    v_cvt_pk_bf16_f32 v124, v124, v125
    v_cvt_pk_bf16_f32 v125, v126, v127
    v_mfma_f32_16x16x32_bf16 v[152:155], v[216:219], v[176:179], v[152:155]
    ds_write_b64 v56, v[124:125] offset:17408
    s_waitcnt lgkmcnt(15)
    v_mfma_f32_16x16x32_bf16 v[140:143], v[220:223], v[200:203], v[140:143]
    v_cvt_pk_bf16_f32 v128, v128, v129
    v_cvt_pk_bf16_f32 v129, v130, v131
    v_mfma_f32_16x16x32_bf16 v[144:147], v[224:227], v[200:203], v[144:147]
    ds_write_b64 v56, v[128:129] offset:17440
    v_mfma_f32_16x16x32_bf16 v[148:151], v[228:231], v[200:203], v[148:151]
    v_cvt_pk_bf16_f32 v132, v132, v133
    v_cvt_pk_bf16_f32 v133, v134, v135
    v_mfma_f32_16x16x32_bf16 v[152:155], v[232:235], v[200:203], v[152:155]
    ds_write_b64 v56, v[132:133] offset:17472
    v_cvt_pk_bf16_f32 v136, v136, v137
    v_cvt_pk_bf16_f32 v137, v138, v139
    v_cvt_pk_bf16_f32 v140, v140, v141
    v_cvt_pk_bf16_f32 v141, v142, v143
    v_cvt_pk_bf16_f32 v144, v144, v145
    v_cvt_pk_bf16_f32 v145, v146, v147
    v_cvt_pk_bf16_f32 v148, v148, v149
    v_cvt_pk_bf16_f32 v149, v150, v151
    v_cvt_pk_bf16_f32 v152, v152, v153
    v_cvt_pk_bf16_f32 v153, v154, v155
    ds_write_b64 v56, v[136:137] offset:17504
    ds_write_b64 v56, v[140:141] offset:21760
    ds_write_b64 v56, v[144:145] offset:21792
    ds_write_b64 v56, v[148:149] offset:21824
    ds_write_b64 v56, v[152:153] offset:21856
    s_setprio 0
    s_branch WS_attd
.p2align 12
WP_attd:
    s_setpc_b64 s[38:39]
WS_attd:
    s_waitcnt lgkmcnt(0)
    s_barrier
    ds_read_b64 v[60:61], v13 offset:80
    ds_read_b64 v[62:63], v14 offset:80
    ds_read_b64 v[44:45], v13 offset:4352
    ds_read_b64 v[46:47], v19 offset:4352
    ds_read_b64 v[64:65], v13 offset:4432
    ds_read_b64 v[66:67], v14 offset:4432
    ds_read_b64 v[72:73], v13 offset:120
    ds_read_b64 v[74:75], v14 offset:120
    ds_read_b64 v[48:49], v13 offset:4392
    ds_read_b64 v[50:51], v20 offset:4352
    ds_read_b64 v[76:77], v13 offset:4472
    ds_read_b64 v[78:79], v14 offset:4472
    ds_read_b64 v[52:53], v13 offset:8704
    ds_read_b64 v[54:55], v19 offset:8704
    ds_read_b64 v[68:69], v13 offset:8784
    ds_read_b64 v[70:71], v14 offset:8784
    s_waitcnt lgkmcnt(10)
    v_mfma_f32_16x16x32_bf16 v[116:119], v[60:63], v[44:47], v[36:39]
    v_mfma_f32_16x16x32_bf16 v[120:123], v[64:67], v[44:47], v[32:35]
    ds_read_b64 v[56:57], v13 offset:8744
    ds_read_b64 v[58:59], v20 offset:8704
    ds_read_b64 v[80:81], v13 offset:8824
    ds_read_b64 v[82:83], v14 offset:8824
    s_waitcnt lgkmcnt(8)
    v_mfma_f32_16x16x32_bf16 v[124:127], v[72:75], v[48:51], v[36:39]
    v_mfma_f32_16x16x32_bf16 v[128:131], v[76:79], v[48:51], v[32:35]
    s_waitcnt lgkmcnt(4)
    v_mfma_f32_16x16x32_bf16 v[132:135], v[64:67], v[52:55], v[28:31]
    v_mfma_f32_16x16x32_bf16 v[136:139], v[68:71], v[52:55], v[32:35]
    s_waitcnt lgkmcnt(0)
    v_mfma_f32_16x16x32_bf16 v[140:143], v[76:79], v[56:59], v[28:31]
    v_mfma_f32_16x16x32_bf16 v[144:147], v[80:83], v[56:59], v[32:35]
    ds_read_b64_tr_b16 v[84:85], v15 offset:160
    ds_read_b64_tr_b16 v[86:87], v15 offset:4512
    ds_read_b64_tr_b16 v[100:101], v21 offset:0
    ds_read_b64_tr_b16 v[102:103], v21 offset:4352
    v_max3_f32 v184, v116, v117, v120
    ds_read_b64_tr_b16 v[92:93], v15 offset:200
    v_max3_f32 v185, v118, v119, v122
    ds_read_b64_tr_b16 v[94:95], v15 offset:4552
    v_max_f32 v184, v184, v121
    ds_read_b64_tr_b16 v[104:105], v22 offset:0
    v_max_f32 v185, v185, v123
    ds_read_b64_tr_b16 v[106:107], v22 offset:4352
    v_max3_f32 v186, v124, v125, v128
    ds_read_b64_tr_b16 v[88:89], v15 offset:8864
    v_max3_f32 v187, v126, v127, v130
    ds_read_b64_tr_b16 v[108:109], v23 offset:4352
    v_max_f32 v186, v186, v129
    ds_read_b64_tr_b16 v[110:111], v23 offset:8704
    v_max_f32 v187, v187, v131
    ds_read_b64_tr_b16 v[96:97], v15 offset:8904
    v_max3_f32 v188, v132, v133, v136
    ds_read_b64_tr_b16 v[112:113], v24 offset:4352
    v_max3_f32 v189, v134, v135, v138
    ds_read_b64_tr_b16 v[114:115], v24 offset:8704
    v_max_f32 v188, v188, v137
    v_max_f32 v189, v189, v139
    v_max3_f32 v190, v140, v141, v144
    v_max3_f32 v191, v142, v143, v146
    v_max_f32 v190, v190, v145
    v_max_f32 v191, v191, v147
    v_cvt_pk_bf16_f32 v192, v184, v185
    v_cvt_pk_bf16_f32 v193, v186, v187
    v_cvt_pk_bf16_f32 v194, v188, v189
    v_cvt_pk_bf16_f32 v195, v190, v191
    v_lshlrev_b32 v184, 16, v192
    v_and_b32 v185, 0xffff0000, v192
    v_lshlrev_b32 v186, 16, v193
    v_and_b32 v187, 0xffff0000, v193
    v_lshlrev_b32 v188, 16, v194
    v_and_b32 v189, 0xffff0000, v194
    v_lshlrev_b32 v190, 16, v195
    v_and_b32 v191, 0xffff0000, v195
    v_pk_mul_f32 v[184:185], v[184:185], s[48:49]
    v_pk_mul_f32 v[186:187], v[186:187], s[48:49]
    v_pk_mul_f32 v[188:189], v[188:189], s[48:49]
    v_pk_mul_f32 v[190:191], v[190:191], s[48:49]
    v_cvt_pk_bf16_f32 v192, v184, v185
    v_cvt_pk_bf16_f32 v193, v186, v187
    v_cvt_pk_bf16_f32 v194, v188, v189
    v_cvt_pk_bf16_f32 v195, v190, v191
    v_permlane16_swap_b32 v192, v193
    s_nop 0
    v_permlane16_swap_b32 v194, v195
    s_nop 1
    v_permlane32_swap_b32 v192, v194
    v_permlane32_swap_b32 v193, v195
    v_lshlrev_b32 v184, 16, v192
    v_and_b32 v185, 0xffff0000, v192
    v_lshlrev_b32 v188, 16, v194
    v_and_b32 v189, 0xffff0000, v194
    v_lshlrev_b32 v186, 16, v193
    v_and_b32 v187, 0xffff0000, v193
    v_lshlrev_b32 v190, 16, v195
    v_and_b32 v191, 0xffff0000, v195
    v_max3_f32 v196, v184, v185, v188
    v_max3_f32 v197, v189, v186, v187
    v_max3_f32 v196, v196, v190, v191
    v_max_f32 v196, v196, v197
    v_mul_f32 v196, s46, v196
    v_pk_fma_f32 v[184:185], v[184:185], s[46:47], v[196:197] op_sel_hi:[1,1,0] neg_lo:[0,0,1] neg_hi:[0,0,1]
    v_pk_fma_f32 v[186:187], v[186:187], s[46:47], v[196:197] op_sel_hi:[1,1,0] neg_lo:[0,0,1] neg_hi:[0,0,1]
    v_pk_fma_f32 v[188:189], v[188:189], s[46:47], v[196:197] op_sel_hi:[1,1,0] neg_lo:[0,0,1] neg_hi:[0,0,1]
    v_pk_fma_f32 v[190:191], v[190:191], s[46:47], v[196:197] op_sel_hi:[1,1,0] neg_lo:[0,0,1] neg_hi:[0,0,1]
    v_exp_f32 v184, v184
    v_exp_f32 v185, v185
    v_exp_f32 v186, v186
    v_exp_f32 v187, v187
    v_exp_f32 v188, v188
    v_exp_f32 v189, v189
    v_exp_f32 v190, v190
    v_exp_f32 v191, v191
    v_pk_add_f32 v[200:201], v[184:185], v[186:187]
    v_pk_add_f32 v[202:203], v[188:189], v[190:191]
    v_pk_add_f32 v[200:201], v[200:201], v[202:203]
    v_add_f32 v200, v200, v201
    v_rcp_f32 v200, v200
    s_waitcnt lgkmcnt(0)
    v_pk_mul_f32 v[184:185], v[184:185], v[200:201] op_sel_hi:[1,0]
    v_pk_mul_f32 v[186:187], v[186:187], v[200:201] op_sel_hi:[1,0]
    v_pk_mul_f32 v[188:189], v[188:189], v[200:201] op_sel_hi:[1,0]
    v_pk_mul_f32 v[190:191], v[190:191], v[200:201] op_sel_hi:[1,0]
    v_cvt_pk_bf16_f32 v192, v184, v185
    v_cvt_pk_bf16_f32 v194, v188, v189
    v_cvt_pk_bf16_f32 v193, v186, v187
    v_cvt_pk_bf16_f32 v195, v190, v191
    v_permlane32_swap_b32 v192, v194
    s_nop 0
    v_permlane32_swap_b32 v193, v195
    s_nop 1
    v_permlane16_swap_b32 v192, v193
    v_permlane16_swap_b32 v194, v195
    v_perm_b32 v148, v192, v192, v40
    v_perm_b32 v149, v192, v192, v41
    v_perm_b32 v150, v192, v192, v42
    v_perm_b32 v151, v192, v192, v43
    v_perm_b32 v152, v193, v193, v40
    v_perm_b32 v153, v193, v193, v41
    v_perm_b32 v154, v193, v193, v42
    v_perm_b32 v155, v193, v193, v43
    v_mfma_f32_16x16x32_bf16 v[164:167], v[84:87], v[148:151], 0
    v_mfma_f32_16x16x32_bf16 v[180:183], v[100:103], v[148:151], 0
    v_perm_b32 v156, v194, v194, v40
    v_perm_b32 v157, v194, v194, v41
    v_perm_b32 v158, v194, v194, v42
    v_perm_b32 v159, v194, v194, v43
    v_mfma_f32_16x16x32_bf16 v[168:171], v[92:95], v[152:155], 0
    v_mfma_f32_16x16x32_bf16 v[180:183], v[104:107], v[152:155], v[180:183]
    v_perm_b32 v160, v195, v195, v40
    v_perm_b32 v161, v195, v195, v41
    v_perm_b32 v162, v195, v195, v42
    v_perm_b32 v163, v195, v195, v43
    v_mfma_f32_16x16x32_bf16 v[172:175], v[86:89], v[156:159], 0
    v_mfma_f32_16x16x32_bf16 v[180:183], v[108:111], v[156:159], v[180:183]
    v_mfma_f32_16x16x32_bf16 v[176:179], v[94:97], v[160:163], 0
    v_mfma_f32_16x16x32_bf16 v[180:183], v[112:115], v[160:163], v[180:183]
    v_cvt_pk_bf16_f32 v204, v164, v165
    v_cvt_pk_bf16_f32 v205, v166, v167
    v_cvt_pk_bf16_f32 v206, v168, v169
    v_cvt_pk_bf16_f32 v207, v170, v171
    buffer_store_dwordx4 v[204:207], v16, s[20:23], s50 offen sc1
    v_cvt_pk_bf16_f32 v208, v172, v173
    v_cvt_pk_bf16_f32 v209, v174, v175
    v_cvt_pk_bf16_f32 v210, v176, v177
    v_cvt_pk_bf16_f32 v211, v178, v179
    v_cvt_pk_bf16_f32 v200, v180, v181
    v_cvt_pk_bf16_f32 v201, v182, v183
    v_cvt_pk_bf16_f32 v202, v180, v181
    v_cvt_pk_bf16_f32 v203, v182, v183
    buffer_store_dwordx4 v[208:211], v16, s[20:23], s51 offen sc1
    v_permlane16_swap_b32 v200, v202
    v_permlane16_swap_b32 v201, v203
    buffer_store_dwordx4 v[200:203], v17, s[20:23], s50 offen sc1
    s_cmp_lg_u32 s34, -1
    s_cbranch_scc1 K_P2_EARLY
K_DRAIN:
    s_waitcnt vmcnt(0)
    s_barrier
    s_branch K_END
K_W7A:
    s_waitcnt vmcnt(0)
    v_and_b32 v4, 7, v1
    v_lshlrev_b32 v4, 2, v4
    s_mov_b32 s3, 131072
K_ZPOLL5:
    v_cmp_eq_u32 vcc, 0, v7
    s_cbranch_vccz K_ZOK5
    s_sub_u32 s3, s3, 1
    s_cbranch_scc1 K_ZOK5
    global_load_dword v7, v4, s[8:9] offset:192 sc1
    s_waitcnt vmcnt(0)
    s_branch K_ZPOLL5
K_ZOK5:
    v_mov_b32 v4, 158720
    v_mov_b32 v3, 1
    s_mov_b64 exec, 1
    s_nop 0
    ds_add_rtn_u32 v2, v4, v3 offset:48
    s_mov_b32 exec_lo, s36
    v_mov_b32 v3, 1
    s_waitcnt lgkmcnt(0)
    v_readfirstlane_b32 s33, v2
    s_nop 3
    s_and_b32 s33, s33, 0xff
    s_cmp_lg_u32 s33, 7
    s_cbranch_scc1 K_ARR7
    global_store_dword v8, v3, s[10:11] sc1
K_ARR7:
    s_mov_b64 exec, -1
    s_barrier
    s_branch K_WOE
K_W7:
    v_mov_b32 v3, 0x100
    s_mov_b64 exec, 1
    s_waitcnt vmcnt(0)
    ds_add_u32 v4, v3 offset:48
    s_mov_b64 exec, -1
    s_branch K_P2_HELP
K_FLAG:
    s_waitcnt vmcnt(0)
    v_and_b32 v4, 7, v1
    v_lshlrev_b32 v4, 2, v4
    s_mov_b32 s3, 131072
K_ZPOLL0:
    v_cmp_eq_u32 vcc, 0, v7
    s_cbranch_vccz K_ZOK0
    s_sub_u32 s3, s3, 1
    s_cbranch_scc1 K_ZOK0
    global_load_dword v7, v4, s[8:9] offset:192 sc1
    s_waitcnt vmcnt(0)
    s_branch K_ZPOLL0
K_ZOK0:
    v_mov_b32 v3, 1
    s_mov_b32 exec_lo, s36
    s_mov_b32 exec_hi, 0
    s_setprio 3
    s_barrier
    global_store_dword v8, v3, s[10:11] sc1
    s_mov_b64 exec, -1
    s_branch K_END
WP_atts:
    s_setpc_b64 s[38:39]
K_JOIN_S:
    s_setprio 0
    s_barrier
    s_cmp_eq_u32 s30, 7
    s_cbranch_scc1 K_FLAG
    ds_read_b64 v[52:53], v13 offset:80
    ds_read_b64 v[54:55], v14 offset:80
    ds_read_b64 v[44:45], v13 offset:4352
    ds_read_b64 v[46:47], v19 offset:4352
    ds_read_b64 v[56:57], v13 offset:4432
    ds_read_b64 v[58:59], v14 offset:4432
    ds_read_b64 v[60:61], v13 offset:120
    ds_read_b64 v[62:63], v14 offset:120
    ds_read_b64 v[48:49], v13 offset:4392
    ds_read_b64 v[50:51], v20 offset:4352
    ds_read_b64 v[64:65], v13 offset:4472
    ds_read_b64 v[66:67], v14 offset:4472
    s_waitcnt lgkmcnt(6)
    v_mfma_f32_16x16x32_bf16 v[84:87], v[52:55], v[44:47], v[36:39]
    v_mfma_f32_16x16x32_bf16 v[88:91], v[56:59], v[44:47], v[32:35]
    s_waitcnt lgkmcnt(0)
    v_mfma_f32_16x16x32_bf16 v[92:95], v[60:63], v[48:51], v[36:39]
    v_mfma_f32_16x16x32_bf16 v[96:99], v[64:67], v[48:51], v[32:35]
    ds_read_b64_tr_b16 v[68:69], v15 offset:160
    ds_read_b64_tr_b16 v[70:71], v15 offset:4512
    ds_read_b64_tr_b16 v[76:77], v21 offset:0
    ds_read_b64_tr_b16 v[78:79], v21 offset:4352
    ds_read_b64_tr_b16 v[72:73], v15 offset:200
    ds_read_b64_tr_b16 v[74:75], v15 offset:4552
    ds_read_b64_tr_b16 v[80:81], v22 offset:0
    ds_read_b64_tr_b16 v[82:83], v22 offset:4352
    v_max3_f32 v120, v84, v85, v88
    v_max3_f32 v121, v86, v87, v90
    v_max_f32 v120, v120, v89
    v_max_f32 v121, v121, v91
    v_max3_f32 v122, v92, v93, v96
    v_max3_f32 v123, v94, v95, v98
    v_max_f32 v122, v122, v97
    v_max_f32 v123, v123, v99
    v_cvt_pk_bf16_f32 v124, v120, v121
    v_cvt_pk_bf16_f32 v125, v122, v123
    v_lshlrev_b32 v120, 16, v124
    v_and_b32 v121, 0xffff0000, v124
    v_lshlrev_b32 v122, 16, v125
    v_and_b32 v123, 0xffff0000, v125
    v_pk_mul_f32 v[120:121], v[120:121], s[48:49]
    v_pk_mul_f32 v[122:123], v[122:123], s[48:49]
    v_cvt_pk_bf16_f32 v124, v120, v121
    v_cvt_pk_bf16_f32 v125, v122, v123
    s_nop 1
    v_permlane16_swap_b32 v124, v125
    v_lshlrev_b32 v120, 16, v124
    v_and_b32 v121, 0xffff0000, v124
    v_lshlrev_b32 v122, 16, v125
    v_and_b32 v123, 0xffff0000, v125
    v_max3_f32 v126, v120, v121, v122
    v_max_f32 v126, v126, v123
    v_mov_b32 v127, v126
    s_nop 1
    v_permlane32_swap_b32 v126, v127
    v_max_f32 v126, v126, v127
    v_mul_f32 v126, s46, v126
    v_pk_fma_f32 v[120:121], v[120:121], s[46:47], v[126:127] op_sel_hi:[1,1,0] neg_lo:[0,0,1] neg_hi:[0,0,1]
    v_pk_fma_f32 v[122:123], v[122:123], s[46:47], v[126:127] op_sel_hi:[1,1,0] neg_lo:[0,0,1] neg_hi:[0,0,1]
    v_exp_f32 v120, v120
    v_exp_f32 v121, v121
    v_exp_f32 v122, v122
    v_exp_f32 v123, v123
    s_nop 0
    v_pk_add_f32 v[128:129], v[120:121], v[122:123]
    v_add_f32 v128, v128, v129
    v_mov_b32 v129, v128
    s_nop 1
    v_permlane32_swap_b32 v128, v129
    v_add_f32 v128, v128, v129
    v_rcp_f32 v128, v128
    s_waitcnt lgkmcnt(0)
    v_pk_mul_f32 v[120:121], v[120:121], v[128:129] op_sel_hi:[1,0]
    v_pk_mul_f32 v[122:123], v[122:123], v[128:129] op_sel_hi:[1,0]
    v_cvt_pk_bf16_f32 v124, v120, v121
    v_cvt_pk_bf16_f32 v125, v122, v123
    s_nop 1
    v_permlane16_swap_b32 v124, v125
    v_perm_b32 v100, v124, v124, v40
    v_perm_b32 v101, v124, v124, v41
    v_perm_b32 v102, v124, v124, v42
    v_perm_b32 v103, v124, v124, v43
    v_perm_b32 v104, v125, v125, v40
    v_perm_b32 v105, v125, v125, v41
    v_perm_b32 v106, v125, v125, v42
    v_perm_b32 v107, v125, v125, v43
    v_mfma_f32_16x16x32_bf16 v[108:111], v[68:71], v[100:103], 0
    v_mfma_f32_16x16x32_bf16 v[116:119], v[76:79], v[100:103], 0
    v_mfma_f32_16x16x32_bf16 v[112:115], v[72:75], v[104:107], 0
    v_mfma_f32_16x16x32_bf16 v[116:119], v[80:83], v[104:107], v[116:119]
    s_nop 4
    v_cvt_pk_bf16_f32 v132, v108, v109
    v_cvt_pk_bf16_f32 v133, v110, v111
    v_cvt_pk_bf16_f32 v134, v112, v113
    v_cvt_pk_bf16_f32 v135, v114, v115
    v_cvt_pk_bf16_f32 v128, v116, v117
    v_cvt_pk_bf16_f32 v129, v118, v119
    v_cvt_pk_bf16_f32 v130, v116, v117
    v_cvt_pk_bf16_f32 v131, v118, v119
    buffer_store_dwordx4 v[132:135], v16, s[20:23], s50 offen sc1
    v_permlane16_swap_b32 v128, v130
    v_permlane16_swap_b32 v129, v131
    buffer_store_dwordx4 v[128:131], v17, s[20:23], s50 offen sc1
    s_cmp_eq_u32 s34, -1
    s_cbranch_scc1 K_DRAIN
    s_cmp_lg_u32 s30, 6
    s_cbranch_scc1 K_NOFL
    s_waitcnt vmcnt(2)
    v_and_b32 v4, 7, v1
    v_lshlrev_b32 v4, 2, v4
    s_mov_b32 s3, 131072
K_ZPOLL2:
    v_cmp_eq_u32 vcc, 0, v7
    s_cbranch_vccz K_ZOK2
    s_sub_u32 s3, s3, 1
    s_cbranch_scc1 K_ZOK2
    global_load_dword v7, v4, s[8:9] offset:192 sc1
    s_waitcnt vmcnt(0)
    s_branch K_ZPOLL2
K_ZOK2:
    v_and_b32 v2, 1, v1
    v_lshl_add_u32 v2, v2, 2, s42
    global_load_dword v7, v2, s[10:11] offset:128 sc1
K_NOFL:
    v_mov_b32 v4, 158720
    v_mov_b32 v3, 257
    s_mov_b64 exec, 1
    s_waitcnt vmcnt(0)
    ds_add_rtn_u32 v2, v4, v3 offset:48
    s_mov_b32 exec_lo, s36
    v_mov_b32 v3, 1
    s_waitcnt lgkmcnt(0)
    v_readfirstlane_b32 s33, v2
    s_nop 3
    s_and_b32 s33, s33, 0xff
    s_cmp_lg_u32 s33, 7
    s_cbranch_scc1 K_ARRS
    global_store_dword v8, v3, s[10:11] sc1
K_ARRS:
    s_mov_b64 exec, -1
    s_cmp_ge_u32 s30, 6
    s_cbranch_scc1 K_P2_HELP
    s_branch K_LATE
WP_early:
    s_setpc_b64 s[38:39]
K_P2_EARLY:
    s_lshl_b32 s54, s40, 7
    v_lshrrev_b32 v9, 4, v1
    v_mov_b32 v12, 158720
    s_add_u32 s20, s10, 0x100000
    s_addc_u32 s21, s11, 0
    s_mov_b32 s22, 0x280000
    s_mov_b32 s23, 0x20000
    s_add_u32 s16, s10, 0x1000
    s_addc_u32 s17, s11, 0
    s_mov_b32 s18, 0x2000
    s_mov_b32 s19, 0x20000
    s_mov_b32 s48, s6
    s_mov_b32 s49, s7
    s_mov_b32 s50, 0x280000
    s_mov_b32 s51, 0x20000
    s_lshl_b32 s53, s40, 3
    s_lshl1_add_u32 s53, s30, s53
    s_mov_b32 s55, 20480
    v_bfe_u32 v20, v1, 2, 2
    v_and_b32 v21, 3, v1
    s_mul_i32 s3, s53, 20480
    v_lshl_add_u32 v25, v1, 4, s3
    v_add_u32 v26, 20480, v25
    v_add_u32 v35, 16384, v25
    v_add_u32 v36, 16384, v26
    v_and_b32 v2, 15, v1
    s_lshl_b32 s3, s53, 6
    v_lshl_add_u32 v23, v2, 2, s3
    v_lshl_add_u32 v2, v9, 2, v20
    v_bfe_u32 v3, v2, 1, 2
    v_lshlrev_b32 v2, 7, v2
    v_lshl_add_u32 v2, v21, 3, v2
    v_lshl_add_u32 v24, v3, 5, v2
    v_lshrrev_b32 v3, 1, v20
    v_mul_u32_u24 v2, 40, v9
    v_add3_u32 v2, v2, 16, v20
    v_lshlrev_b32 v2, 7, v2
    v_lshl_add_u32 v2, v21, 3, v2
    v_xor_b32 v4, 0, v3
    v_lshl_add_u32 v60, v4, 5, v2
    v_xor_b32 v4, 1, v3
    v_lshl_add_u32 v61, v4, 5, v2
    v_xor_b32 v4, 2, v3
    v_lshl_add_u32 v62, v4, 5, v2
    v_xor_b32 v4, 3, v3
    v_lshl_add_u32 v63, v4, 5, v2
    v_lshrrev_b32 v3, 4, v1
    v_and_b32 v4, 7, v1
    v_lshrrev_b32 v2, 3, v1
    v_xor_b32 v4, v4, v3
    v_mul_u32_u24 v2, 1280, v2
    v_lshl_add_u32 v27, v4, 4, v2
    v_xor_b32 v28, 64, v27
    s_lshl_b32 s71, s40, 3
    s_lshl1_add_u32 s71, s30, s71
    s_mul_i32 s71, s71, 20480
    s_lshl_b32 s33, s41, 7
    s_add_u32 s71, s71, s33
    s_add_u32 s72, s71, 10240
    s_add_u32 s73, s71, 20480
    s_add_u32 s74, s71, 30720
    s_lshl_b32 s3, s30, 12
    s_add_u32 s3, s3, 140288
    v_lshl_add_u32 v33, v1, 4, s3
    v_and_b32 v2, 15, v1
    v_lshrrev_b32 v3, 1, v2
    v_lshrrev_b32 v4, 5, v1
    v_xor_b32 v3, v3, v4
    v_lshlrev_b32 v3, 4, v3
    v_lshl_add_u32 v3, v2, 7, v3
    v_and_b32 v4, 1, v9
    v_lshl_add_u32 v3, v4, 3, v3
    v_add_u32 v29, s3, v3
    v_xor_b32 v30, 32, v29
    v_xor_b32 v31, 64, v29
    v_xor_b32 v32, 96, v29
    s_and_b32 s33, s40, 3
    s_lshl_b32 s33, s33, 3
    s_lshr_b32 s33, 0x7f06037f, s33
    s_and_b32 s33, s33, 0xff
    s_lshl_b32 s3, s30, 1
    s_cmp_ge_u32 s3, s33
    s_cselect_b32 s64, 16, 0
    s_add_u32 s3, s3, 1
    s_cmp_ge_u32 s3, s33
    s_cselect_b32 s65, 16, 0
    s_mov_b32 s63, 0
    s_mov_b32 s66, 0
    s_mov_b32 s67, 16384
    v_mov_b32 v34, 0
    v_mov_b32 v4, 158720
    v_mov_b32 v3, 1
    s_mov_b64 exec, 1
    s_waitcnt vmcnt(0)
    ds_add_rtn_u32 v2, v4, v3 offset:48
    s_mov_b32 exec_lo, s36
    v_mov_b32 v3, 1
    s_waitcnt lgkmcnt(0)
    v_readfirstlane_b32 s33, v2
    s_nop 3
    s_and_b32 s33, s33, 0xff
    s_cmp_lg_u32 s33, 7
    s_cbranch_scc1 K_ARRD
    global_store_dword v8, v3, s[10:11] sc1
K_ARRD:
    s_mov_b64 exec, -1
    s_mov_b32 s3, 1048576
K_P2_GE:
    ds_read_b32 v2, v12 offset:48
    s_sub_u32 s3, s3, 1
    s_waitcnt lgkmcnt(0)
    v_readfirstlane_b32 s33, v2
    s_nop 3
    s_cselect_b32 s33, 1024, s33
    s_cmp_lt_u32 s33, 1024
    s_cbranch_scc1 K_P2_GE
K_P2_GEMM:
    s_setprio 0
    s_mov_b32 s3, 1048576
K_P2_GS:
    ds_read_b32 v2, v12 offset:40
    s_sub_u32 s3, s3, 1
    s_waitcnt lgkmcnt(0)
    v_readfirstlane_b32 s33, v2
    s_nop 3
    s_cselect_b32 s33, 1, s33
    s_cmp_lt_u32 s33, 1
    s_cbranch_scc1 K_P2_GS
    buffer_load_dword v64, v23, s[16:19], 0 offen offset:0 sc1
    buffer_load_dword v66, v23, s[16:19], 0 offen offset:64 sc1
    ds_read_b128 v[16:19], v12
    ds_read_b64 v[40:41], v29 offset:0
    ds_read_b64 v[42:43], v30 offset:0
    ds_read_b64 v[44:45], v31 offset:0
    ds_read_b64 v[46:47], v32 offset:0
    ds_read_b64 v[48:49], v29 offset:2048
    ds_read_b64 v[50:51], v30 offset:2048
    ds_read_b64 v[52:53], v31 offset:2048
    ds_read_b64 v[54:55], v32 offset:2048
    s_waitcnt lgkmcnt(4)
    v_lshlrev_b32 v72, 16, v40
    v_and_b32 v73, 0xffff0000, v40
    v_lshlrev_b32 v74, 16, v41
    v_and_b32 v75, 0xffff0000, v41
    v_lshlrev_b32 v76, 16, v42
    v_and_b32 v77, 0xffff0000, v42
    v_lshlrev_b32 v78, 16, v43
    v_and_b32 v79, 0xffff0000, v43
    v_lshlrev_b32 v80, 16, v44
    v_and_b32 v81, 0xffff0000, v44
    v_lshlrev_b32 v82, 16, v45
    v_and_b32 v83, 0xffff0000, v45
    v_lshlrev_b32 v84, 16, v46
    v_and_b32 v85, 0xffff0000, v46
    v_lshlrev_b32 v86, 16, v47
    v_and_b32 v87, 0xffff0000, v47
    s_waitcnt lgkmcnt(0)
    v_lshlrev_b32 v88, 16, v48
    v_and_b32 v89, 0xffff0000, v48
    v_lshlrev_b32 v90, 16, v49
    v_and_b32 v91, 0xffff0000, v49
    v_lshlrev_b32 v92, 16, v50
    v_and_b32 v93, 0xffff0000, v50
    v_lshlrev_b32 v94, 16, v51
    v_and_b32 v95, 0xffff0000, v51
    v_lshlrev_b32 v96, 16, v52
    v_and_b32 v97, 0xffff0000, v52
    v_lshlrev_b32 v98, 16, v53
    v_and_b32 v99, 0xffff0000, v53
    v_lshlrev_b32 v100, 16, v54
    v_and_b32 v101, 0xffff0000, v54
    v_lshlrev_b32 v102, 16, v55
    v_and_b32 v103, 0xffff0000, v55
    s_cmp_eq_u32 s63, 0
    s_cbranch_scc1 K_SP0
K_SPR0:
    s_ff1_i32_b32 s33, s63
    s_bitset0_b32 s63, s33
    s_lshl_b32 s75, s33, 10
    buffer_load_dwordx4 v[104:107], v25, s[20:23], s75 offen offset:0 sc1
    buffer_load_dwordx4 v[108:111], v26, s[20:23], s75 offen offset:0 sc1
    v_mad_u32_u24 v56, s75, 5, v24
    v_xor_b32 v58, 64, v56
    v_xor_b32 v57, 32, v56
    v_xor_b32 v59, 96, v56
    ds_read_b64_tr_b16 v[184:185], v56 offset:0
    ds_read_b64_tr_b16 v[186:187], v58 offset:2560
    ds_read_b64_tr_b16 v[188:189], v57 offset:0
    ds_read_b64_tr_b16 v[190:191], v59 offset:2560
    ds_read_b64_tr_b16 v[192:193], v58 offset:0
    ds_read_b64_tr_b16 v[194:195], v56 offset:2560
    ds_read_b64_tr_b16 v[196:197], v59 offset:0
    ds_read_b64_tr_b16 v[198:199], v57 offset:2560
    s_cmp_eq_u32 s63, 0
    s_cbranch_scc1 K_SP1
K_SPR1:
    s_ff1_i32_b32 s33, s63
    s_bitset0_b32 s63, s33
    s_lshl_b32 s76, s33, 10
    buffer_load_dwordx4 v[112:115], v25, s[20:23], s76 offen offset:0 sc1
    buffer_load_dwordx4 v[116:119], v26, s[20:23], s76 offen offset:0 sc1
    v_mad_u32_u24 v56, s76, 5, v24
    v_xor_b32 v58, 64, v56
    v_xor_b32 v57, 32, v56
    v_xor_b32 v59, 96, v56
    ds_read_b64_tr_b16 v[200:201], v56 offset:0
    ds_read_b64_tr_b16 v[202:203], v58 offset:2560
    ds_read_b64_tr_b16 v[204:205], v57 offset:0
    ds_read_b64_tr_b16 v[206:207], v59 offset:2560
    ds_read_b64_tr_b16 v[208:209], v58 offset:0
    ds_read_b64_tr_b16 v[210:211], v56 offset:2560
    ds_read_b64_tr_b16 v[212:213], v59 offset:0
    ds_read_b64_tr_b16 v[214:215], v57 offset:2560
    s_waitcnt vmcnt(4)
    s_mov_b64 exec, 1
    ds_add_u32 v12, v34 offset:44
    s_mov_b64 exec, -1
    v_sub_f32 v68, 1.0, v64
    v_cvt_pk_bf16_f32 v68, v68, v68
    v_lshlrev_b32 v68, 16, v68
    v_sub_f32 v70, 1.0, v66
    v_cvt_pk_bf16_f32 v70, v70, v70
    v_lshlrev_b32 v70, 16, v70
    v_pk_mul_f32 v[72:73], v[72:73], v[68:69] op_sel_hi:[1,0]
    v_pk_mul_f32 v[74:75], v[74:75], v[68:69] op_sel_hi:[1,0]
    v_pk_mul_f32 v[76:77], v[76:77], v[68:69] op_sel_hi:[1,0]
    v_pk_mul_f32 v[78:79], v[78:79], v[68:69] op_sel_hi:[1,0]
    v_pk_mul_f32 v[80:81], v[80:81], v[68:69] op_sel_hi:[1,0]
    v_pk_mul_f32 v[82:83], v[82:83], v[68:69] op_sel_hi:[1,0]
    v_pk_mul_f32 v[84:85], v[84:85], v[68:69] op_sel_hi:[1,0]
    v_pk_mul_f32 v[86:87], v[86:87], v[68:69] op_sel_hi:[1,0]
    v_pk_mul_f32 v[88:89], v[88:89], v[70:71] op_sel_hi:[1,0]
    v_pk_mul_f32 v[90:91], v[90:91], v[70:71] op_sel_hi:[1,0]
    v_pk_mul_f32 v[92:93], v[92:93], v[70:71] op_sel_hi:[1,0]
    v_pk_mul_f32 v[94:95], v[94:95], v[70:71] op_sel_hi:[1,0]
    v_pk_mul_f32 v[96:97], v[96:97], v[70:71] op_sel_hi:[1,0]
    v_pk_mul_f32 v[98:99], v[98:99], v[70:71] op_sel_hi:[1,0]
    v_pk_mul_f32 v[100:101], v[100:101], v[70:71] op_sel_hi:[1,0]
    v_pk_mul_f32 v[102:103], v[102:103], v[70:71] op_sel_hi:[1,0]
    s_cmp_eq_u32 s63, 0
    s_cbranch_scc1 K_SP2
K_SPR2:
    s_ff1_i32_b32 s33, s63
    s_bitset0_b32 s63, s33
    s_lshl_b32 s77, s33, 10
    buffer_load_dwordx4 v[120:123], v25, s[20:23], s77 offen offset:0 sc1
    buffer_load_dwordx4 v[124:127], v26, s[20:23], s77 offen offset:0 sc1
    s_cmp_eq_u32 s63, 0
    s_cbranch_scc1 K_SP3
K_SPR3:
    s_ff1_i32_b32 s33, s63
    s_bitset0_b32 s63, s33
    s_lshl_b32 s78, s33, 10
    buffer_load_dwordx4 v[128:131], v25, s[20:23], s78 offen offset:0 sc1
    buffer_load_dwordx4 v[132:135], v26, s[20:23], s78 offen offset:0 sc1
    s_cmp_eq_u32 s63, 0
    s_cbranch_scc1 K_SP4
K_SPR4:
    s_ff1_i32_b32 s33, s63
    s_bitset0_b32 s63, s33
    s_lshl_b32 s75, s33, 10
    buffer_load_dwordx4 v[136:139], v25, s[20:23], s75 offen offset:0 sc1
    buffer_load_dwordx4 v[140:143], v26, s[20:23], s75 offen offset:0 sc1
    s_branch WS_p2g
.p2align 12
WP_p2g:
    s_setpc_b64 s[38:39]
WS_p2g:
    s_waitcnt vmcnt(8) lgkmcnt(9)
    v_mfma_f32_16x16x32_bf16 v[152:155], v[184:187], v[104:107], 0
    v_mad_u32_u24 v56, s77, 5, v24
    v_xor_b32 v58, 64, v56
    v_xor_b32 v57, 32, v56
    v_mfma_f32_16x16x32_bf16 v[168:171], v[184:187], v[108:111], 0
    v_xor_b32 v59, 96, v56
    ds_read_b64_tr_b16 v[216:217], v56 offset:0
    ds_read_b64_tr_b16 v[218:219], v58 offset:2560
    v_mfma_f32_16x16x32_bf16 v[156:159], v[188:191], v[104:107], 0
    ds_read_b64_tr_b16 v[220:221], v57 offset:0
    ds_read_b64_tr_b16 v[222:223], v59 offset:2560
    ds_read_b64_tr_b16 v[224:225], v58 offset:0
    v_mfma_f32_16x16x32_bf16 v[172:175], v[188:191], v[108:111], 0
    ds_read_b64_tr_b16 v[226:227], v56 offset:2560
    ds_read_b64_tr_b16 v[228:229], v59 offset:0
    v_mfma_f32_16x16x32_bf16 v[160:163], v[192:195], v[104:107], 0
    ds_read_b64_tr_b16 v[230:231], v57 offset:2560
    s_cmp_eq_u32 s63, 0
    v_mfma_f32_16x16x32_bf16 v[176:179], v[192:195], v[108:111], 0
    s_cbranch_scc1 K_SP5
K_SPR5:
    s_ff1_i32_b32 s33, s63
    v_mfma_f32_16x16x32_bf16 v[164:167], v[196:199], v[104:107], 0
    s_bitset0_b32 s63, s33
    s_lshl_b32 s76, s33, 10
    v_mfma_f32_16x16x32_bf16 v[180:183], v[196:199], v[108:111], 0
    buffer_load_dwordx4 v[144:147], v25, s[20:23], s76 offen offset:0 sc1
    buffer_load_dwordx4 v[148:151], v26, s[20:23], s76 offen offset:0 sc1
    s_waitcnt vmcnt(8) lgkmcnt(9)
    v_mfma_f32_16x16x32_bf16 v[152:155], v[200:203], v[112:115], v[152:155]
    v_mad_u32_u24 v56, s78, 5, v24
    v_xor_b32 v58, 64, v56
    v_xor_b32 v57, 32, v56
    v_mfma_f32_16x16x32_bf16 v[168:171], v[200:203], v[116:119], v[168:171]
    v_xor_b32 v59, 96, v56
    ds_read_b64_tr_b16 v[184:185], v56 offset:0
    ds_read_b64_tr_b16 v[186:187], v58 offset:2560
    v_mfma_f32_16x16x32_bf16 v[156:159], v[204:207], v[112:115], v[156:159]
    ds_read_b64_tr_b16 v[188:189], v57 offset:0
    ds_read_b64_tr_b16 v[190:191], v59 offset:2560
    ds_read_b64_tr_b16 v[192:193], v58 offset:0
    v_mfma_f32_16x16x32_bf16 v[172:175], v[204:207], v[116:119], v[172:175]
    ds_read_b64_tr_b16 v[194:195], v56 offset:2560
    ds_read_b64_tr_b16 v[196:197], v59 offset:0
    v_mfma_f32_16x16x32_bf16 v[160:163], v[208:211], v[112:115], v[160:163]
    ds_read_b64_tr_b16 v[198:199], v57 offset:2560
    s_cmp_eq_u32 s63, 0
    v_mfma_f32_16x16x32_bf16 v[176:179], v[208:211], v[116:119], v[176:179]
    s_cbranch_scc1 K_SP6
K_SPR6:
    s_ff1_i32_b32 s33, s63
    v_mfma_f32_16x16x32_bf16 v[164:167], v[212:215], v[112:115], v[164:167]
    s_bitset0_b32 s63, s33
    s_lshl_b32 s77, s33, 10
    v_mfma_f32_16x16x32_bf16 v[180:183], v[212:215], v[116:119], v[180:183]
    buffer_load_dwordx4 v[104:107], v25, s[20:23], s77 offen offset:0 sc1
    buffer_load_dwordx4 v[108:111], v26, s[20:23], s77 offen offset:0 sc1
    s_waitcnt vmcnt(8) lgkmcnt(8)
    v_mfma_f32_16x16x32_bf16 v[152:155], v[216:219], v[120:123], v[152:155]
    v_mad_u32_u24 v56, s75, 5, v24
    v_xor_b32 v58, 64, v56
    v_xor_b32 v57, 32, v56
    v_mfma_f32_16x16x32_bf16 v[168:171], v[216:219], v[124:127], v[168:171]
    v_xor_b32 v59, 96, v56
    ds_read_b64_tr_b16 v[200:201], v56 offset:0
    ds_read_b64_tr_b16 v[202:203], v58 offset:2560
    v_mfma_f32_16x16x32_bf16 v[156:159], v[220:223], v[120:123], v[156:159]
    ds_read_b64_tr_b16 v[204:205], v57 offset:0
    ds_read_b64_tr_b16 v[206:207], v59 offset:2560
    ds_read_b64_tr_b16 v[208:209], v58 offset:0
    v_mfma_f32_16x16x32_bf16 v[172:175], v[220:223], v[124:127], v[172:175]
    ds_read_b64_tr_b16 v[210:211], v56 offset:2560
    ds_read_b64_tr_b16 v[212:213], v59 offset:0
    v_mfma_f32_16x16x32_bf16 v[160:163], v[224:227], v[120:123], v[160:163]
    ds_read_b64_tr_b16 v[214:215], v57 offset:2560
    s_andn2_b32 s33, s66, s63
    v_mfma_f32_16x16x32_bf16 v[176:179], v[224:227], v[124:127], v[176:179]
    s_bfe_u32 s33, s33, 0x40000
    s_cmp_eq_u32 s33, 15
    v_mfma_f32_16x16x32_bf16 v[164:167], v[228:231], v[120:123], v[164:167]
    s_cselect_b32 s78, 0, 1024
    s_xor_b32 s69, s78, 1024
    v_mfma_f32_16x16x32_bf16 v[180:183], v[228:231], v[124:127], v[180:183]
    buffer_load_dwordx4 v[112:115], v35, s[20:23], s78 offen offset:0 sc1
    buffer_load_dwordx4 v[116:119], v36, s[20:23], s78 offen offset:0 sc1
    s_waitcnt vmcnt(8) lgkmcnt(8)
    v_mfma_f32_16x16x32_bf16 v[152:155], v[184:187], v[128:131], v[152:155]
    v_mad_u32_u24 v56, s76, 5, v24
    v_xor_b32 v58, 64, v56
    v_xor_b32 v57, 32, v56
    v_mfma_f32_16x16x32_bf16 v[168:171], v[184:187], v[132:135], v[168:171]
    v_xor_b32 v59, 96, v56
    ds_read_b64_tr_b16 v[216:217], v56 offset:0
    ds_read_b64_tr_b16 v[218:219], v58 offset:2560
    v_mfma_f32_16x16x32_bf16 v[156:159], v[188:191], v[128:131], v[156:159]
    ds_read_b64_tr_b16 v[220:221], v57 offset:0
    ds_read_b64_tr_b16 v[222:223], v59 offset:2560
    ds_read_b64_tr_b16 v[224:225], v58 offset:0
    v_mfma_f32_16x16x32_bf16 v[172:175], v[188:191], v[132:135], v[172:175]
    ds_read_b64_tr_b16 v[226:227], v56 offset:2560
    ds_read_b64_tr_b16 v[228:229], v59 offset:0
    v_mfma_f32_16x16x32_bf16 v[160:163], v[192:195], v[128:131], v[160:163]
    ds_read_b64_tr_b16 v[230:231], v57 offset:2560
    s_cmp_eq_u32 s63, 0
    v_mfma_f32_16x16x32_bf16 v[176:179], v[192:195], v[132:135], v[176:179]
    s_cbranch_scc1 K_SP8
K_SPR8:
    s_ff1_i32_b32 s33, s63
    v_mfma_f32_16x16x32_bf16 v[164:167], v[196:199], v[128:131], v[164:167]
    s_bitset0_b32 s63, s33
    s_lshl_b32 s75, s33, 10
    v_mfma_f32_16x16x32_bf16 v[180:183], v[196:199], v[132:135], v[180:183]
    buffer_load_dwordx4 v[120:123], v25, s[20:23], s75 offen offset:0 sc1
    buffer_load_dwordx4 v[124:127], v26, s[20:23], s75 offen offset:0 sc1
    s_waitcnt vmcnt(8) lgkmcnt(8)
    v_mfma_f32_16x16x32_bf16 v[152:155], v[200:203], v[136:139], v[152:155]
    v_mad_u32_u24 v56, s77, 5, v24
    v_xor_b32 v58, 64, v56
    v_mfma_f32_16x16x32_bf16 v[168:171], v[200:203], v[140:143], v[168:171]
    v_xor_b32 v57, 32, v56
    v_xor_b32 v59, 96, v56
    v_mfma_f32_16x16x32_bf16 v[156:159], v[204:207], v[136:139], v[156:159]
    ds_read_b64_tr_b16 v[184:185], v56 offset:0
    ds_read_b64_tr_b16 v[186:187], v58 offset:2560
    v_mfma_f32_16x16x32_bf16 v[172:175], v[204:207], v[140:143], v[172:175]
    ds_read_b64_tr_b16 v[188:189], v57 offset:0
    ds_read_b64_tr_b16 v[190:191], v59 offset:2560
    v_mfma_f32_16x16x32_bf16 v[160:163], v[208:211], v[136:139], v[160:163]
    ds_read_b64_tr_b16 v[192:193], v58 offset:0
    ds_read_b64_tr_b16 v[194:195], v56 offset:2560
    v_mfma_f32_16x16x32_bf16 v[176:179], v[208:211], v[140:143], v[176:179]
    ds_read_b64_tr_b16 v[196:197], v59 offset:0
    ds_read_b64_tr_b16 v[198:199], v57 offset:2560
    v_mfma_f32_16x16x32_bf16 v[164:167], v[212:215], v[136:139], v[164:167]
    buffer_load_dwordx4 v[128:131], v35, s[20:23], s69 offen offset:0 sc1
    buffer_load_dwordx4 v[132:135], v36, s[20:23], s69 offen offset:0 sc1
    v_mfma_f32_16x16x32_bf16 v[180:183], v[212:215], v[140:143], v[180:183]
    s_waitcnt vmcnt(8) lgkmcnt(8)
    v_mfma_f32_16x16x32_bf16 v[152:155], v[216:219], v[144:147], v[152:155]
    v_mad_u32_u24 v56, s78, 20, v60
    v_xor_b32 v58, 64, v56
    v_xor_b32 v57, 32, v56
    v_mfma_f32_16x16x32_bf16 v[168:171], v[216:219], v[148:151], v[168:171]
    v_xor_b32 v59, 96, v56
    ds_read_b64_tr_b16 v[200:201], v56 offset:0
    ds_read_b64_tr_b16 v[202:203], v58 offset:2560
    v_mfma_f32_16x16x32_bf16 v[156:159], v[220:223], v[144:147], v[156:159]
    ds_read_b64_tr_b16 v[204:205], v57 offset:0
    ds_read_b64_tr_b16 v[206:207], v59 offset:2560
    ds_read_b64_tr_b16 v[208:209], v58 offset:0
    v_mfma_f32_16x16x32_bf16 v[172:175], v[220:223], v[148:151], v[172:175]
    ds_read_b64_tr_b16 v[210:211], v56 offset:2560
    ds_read_b64_tr_b16 v[212:213], v59 offset:0
    v_mfma_f32_16x16x32_bf16 v[160:163], v[224:227], v[144:147], v[160:163]
    ds_read_b64_tr_b16 v[214:215], v57 offset:2560
    s_cmp_eq_u32 s63, 0
    v_mfma_f32_16x16x32_bf16 v[176:179], v[224:227], v[148:151], v[176:179]
    s_cbranch_scc1 K_SP10
K_SPR10:
    s_ff1_i32_b32 s33, s63
    v_mfma_f32_16x16x32_bf16 v[164:167], v[228:231], v[144:147], v[164:167]
    s_bitset0_b32 s63, s33
    s_lshl_b32 s77, s33, 10
    v_mfma_f32_16x16x32_bf16 v[180:183], v[228:231], v[148:151], v[180:183]
    buffer_load_dwordx4 v[136:139], v25, s[20:23], s77 offen offset:0 sc1
    buffer_load_dwordx4 v[140:143], v26, s[20:23], s77 offen offset:0 sc1
    s_waitcnt vmcnt(8) lgkmcnt(8)
    v_mfma_f32_16x16x32_bf16 v[152:155], v[184:187], v[104:107], v[152:155]
    v_mad_u32_u24 v56, s75, 5, v24
    v_xor_b32 v58, 64, v56
    v_xor_b32 v57, 32, v56
    v_mfma_f32_16x16x32_bf16 v[168:171], v[184:187], v[108:111], v[168:171]
    v_xor_b32 v59, 96, v56
    ds_read_b64_tr_b16 v[216:217], v56 offset:0
    ds_read_b64_tr_b16 v[218:219], v58 offset:2560
    v_mfma_f32_16x16x32_bf16 v[156:159], v[188:191], v[104:107], v[156:159]
    ds_read_b64_tr_b16 v[220:221], v57 offset:0
    ds_read_b64_tr_b16 v[222:223], v59 offset:2560
    ds_read_b64_tr_b16 v[224:225], v58 offset:0
    v_mfma_f32_16x16x32_bf16 v[172:175], v[188:191], v[108:111], v[172:175]
    ds_read_b64_tr_b16 v[226:227], v56 offset:2560
    ds_read_b64_tr_b16 v[228:229], v59 offset:0
    v_mfma_f32_16x16x32_bf16 v[160:163], v[192:195], v[104:107], v[160:163]
    ds_read_b64_tr_b16 v[230:231], v57 offset:2560
    s_cmp_eq_u32 s63, 0
    v_mfma_f32_16x16x32_bf16 v[176:179], v[192:195], v[108:111], v[176:179]
    s_cbranch_scc1 K_SP11
K_SPR11:
    s_ff1_i32_b32 s33, s63
    v_mfma_f32_16x16x32_bf16 v[164:167], v[196:199], v[104:107], v[164:167]
    s_bitset0_b32 s63, s33
    s_lshl_b32 s78, s33, 10
    v_mfma_f32_16x16x32_bf16 v[180:183], v[196:199], v[108:111], v[180:183]
    buffer_load_dwordx4 v[144:147], v25, s[20:23], s78 offen offset:0 sc1
    buffer_load_dwordx4 v[148:151], v26, s[20:23], s78 offen offset:0 sc1
    s_waitcnt vmcnt(8) lgkmcnt(8)
    v_mfma_f32_16x16x32_bf16 v[152:155], v[200:203], v[112:115], v[152:155]
    v_mad_u32_u24 v56, s69, 20, v60
    v_xor_b32 v58, 64, v56
    v_xor_b32 v57, 32, v56
    v_mfma_f32_16x16x32_bf16 v[168:171], v[200:203], v[116:119], v[168:171]
    v_xor_b32 v59, 96, v56
    ds_read_b64_tr_b16 v[184:185], v56 offset:0
    ds_read_b64_tr_b16 v[186:187], v58 offset:2560
    v_mfma_f32_16x16x32_bf16 v[156:159], v[204:207], v[112:115], v[156:159]
    ds_read_b64_tr_b16 v[188:189], v57 offset:0
    ds_read_b64_tr_b16 v[190:191], v59 offset:2560
    ds_read_b64_tr_b16 v[192:193], v58 offset:0
    v_mfma_f32_16x16x32_bf16 v[172:175], v[204:207], v[116:119], v[172:175]
    ds_read_b64_tr_b16 v[194:195], v56 offset:2560
    ds_read_b64_tr_b16 v[196:197], v59 offset:0
    v_mfma_f32_16x16x32_bf16 v[160:163], v[208:211], v[112:115], v[160:163]
    ds_read_b64_tr_b16 v[198:199], v57 offset:2560
    s_cmp_eq_u32 s63, 0
    v_mfma_f32_16x16x32_bf16 v[176:179], v[208:211], v[116:119], v[176:179]
    s_cbranch_scc1 K_SP12
K_SPR12:
    s_ff1_i32_b32 s33, s63
    v_mfma_f32_16x16x32_bf16 v[164:167], v[212:215], v[112:115], v[164:167]
    s_bitset0_b32 s63, s33
    s_lshl_b32 s75, s33, 10
    v_mfma_f32_16x16x32_bf16 v[180:183], v[212:215], v[116:119], v[180:183]
    buffer_load_dwordx4 v[104:107], v25, s[20:23], s75 offen offset:0 sc1
    buffer_load_dwordx4 v[108:111], v26, s[20:23], s75 offen offset:0 sc1
    s_mov_b32 s3, 1048576
K_P2_GW:
    ds_read_b32 v2, v12 offset:44
    s_sub_u32 s3, s3, 1
    s_waitcnt lgkmcnt(0)
    v_readfirstlane_b32 s33, v2
    s_nop 3
    s_cselect_b32 s33, 4, s33
    s_cmp_lt_u32 s33, 4
    s_cbranch_scc1 K_P2_GW
    v_readfirstlane_b32 s56, v16
    v_readfirstlane_b32 s57, v17
    s_lshl_b32 s58, s53, 4
    s_waitcnt vmcnt(8)
    v_mfma_f32_16x16x32_bf16 v[152:155], v[216:219], v[120:123], v[152:155]
    v_mad_u32_u24 v56, s77, 5, v24
    v_xor_b32 v58, 64, v56
    v_xor_b32 v57, 32, v56
    v_mfma_f32_16x16x32_bf16 v[168:171], v[216:219], v[124:127], v[168:171]
    v_xor_b32 v59, 96, v56
    ds_read_b64_tr_b16 v[200:201], v56 offset:0
    ds_read_b64_tr_b16 v[202:203], v58 offset:2560
    v_mfma_f32_16x16x32_bf16 v[156:159], v[220:223], v[120:123], v[156:159]
    ds_read_b64_tr_b16 v[204:205], v57 offset:0
    ds_read_b64_tr_b16 v[206:207], v59 offset:2560
    ds_read_b64_tr_b16 v[208:209], v58 offset:0
    v_mfma_f32_16x16x32_bf16 v[172:175], v[220:223], v[124:127], v[172:175]
    ds_read_b64_tr_b16 v[210:211], v56 offset:2560
    ds_read_b64_tr_b16 v[212:213], v59 offset:0
    v_mfma_f32_16x16x32_bf16 v[160:163], v[224:227], v[120:123], v[160:163]
    ds_read_b64_tr_b16 v[214:215], v57 offset:2560
    s_cmp_eq_u32 s63, 0
    v_mfma_f32_16x16x32_bf16 v[176:179], v[224:227], v[124:127], v[176:179]
    s_cbranch_scc1 K_SP13
K_SPR13:
    s_ff1_i32_b32 s33, s63
    v_mfma_f32_16x16x32_bf16 v[164:167], v[228:231], v[120:123], v[164:167]
    s_bitset0_b32 s63, s33
    s_lshl_b32 s76, s33, 10
    v_mfma_f32_16x16x32_bf16 v[180:183], v[228:231], v[124:127], v[180:183]
    buffer_load_dwordx4 v[112:115], v25, s[20:23], s76 offen offset:0 sc1
    buffer_load_dwordx4 v[116:119], v26, s[20:23], s76 offen offset:0 sc1
    s_waitcnt vmcnt(8)
    v_mfma_f32_16x16x32_bf16 v[152:155], v[184:187], v[128:131], v[152:155]
    v_mad_u32_u24 v56, s78, 5, v24
    v_xor_b32 v58, 64, v56
    v_xor_b32 v57, 32, v56
    v_mfma_f32_16x16x32_bf16 v[168:171], v[184:187], v[132:135], v[168:171]
    v_xor_b32 v59, 96, v56
    ds_read_b64_tr_b16 v[216:217], v56 offset:0
    ds_read_b64_tr_b16 v[218:219], v58 offset:2560
    v_mfma_f32_16x16x32_bf16 v[156:159], v[188:191], v[128:131], v[156:159]
    ds_read_b64_tr_b16 v[220:221], v57 offset:0
    ds_read_b64_tr_b16 v[222:223], v59 offset:2560
    ds_read_b64_tr_b16 v[224:225], v58 offset:0
    v_mfma_f32_16x16x32_bf16 v[172:175], v[188:191], v[132:135], v[172:175]
    ds_read_b64_tr_b16 v[226:227], v56 offset:2560
    ds_read_b64_tr_b16 v[228:229], v59 offset:0
    v_mfma_f32_16x16x32_bf16 v[160:163], v[192:195], v[128:131], v[160:163]
    ds_read_b64_tr_b16 v[230:231], v57 offset:2560
    s_cmp_eq_u32 s63, 0
    v_mfma_f32_16x16x32_bf16 v[176:179], v[192:195], v[132:135], v[176:179]
    s_cbranch_scc1 K_SP14
K_SPR14:
    s_ff1_i32_b32 s33, s63
    v_mfma_f32_16x16x32_bf16 v[164:167], v[196:199], v[128:131], v[164:167]
    s_bitset0_b32 s63, s33
    s_lshl_b32 s77, s33, 10
    v_mfma_f32_16x16x32_bf16 v[180:183], v[196:199], v[132:135], v[180:183]
    buffer_load_dwordx4 v[120:123], v25, s[20:23], s77 offen offset:0 sc1
    buffer_load_dwordx4 v[124:127], v26, s[20:23], s77 offen offset:0 sc1
    s_waitcnt vmcnt(8) lgkmcnt(8)
    v_mfma_f32_16x16x32_bf16 v[152:155], v[200:203], v[136:139], v[152:155]
    v_mad_u32_u24 v56, s75, 5, v24
    v_xor_b32 v58, 64, v56
    v_xor_b32 v57, 32, v56
    v_mfma_f32_16x16x32_bf16 v[168:171], v[200:203], v[140:143], v[168:171]
    v_xor_b32 v59, 96, v56
    ds_read_b64_tr_b16 v[184:185], v56 offset:0
    ds_read_b64_tr_b16 v[186:187], v58 offset:2560
    v_mfma_f32_16x16x32_bf16 v[156:159], v[204:207], v[136:139], v[156:159]
    ds_read_b64_tr_b16 v[188:189], v57 offset:0
    ds_read_b64_tr_b16 v[190:191], v59 offset:2560
    ds_read_b64_tr_b16 v[192:193], v58 offset:0
    v_mfma_f32_16x16x32_bf16 v[172:175], v[204:207], v[140:143], v[172:175]
    ds_read_b64_tr_b16 v[194:195], v56 offset:2560
    ds_read_b64_tr_b16 v[196:197], v59 offset:0
    v_mfma_f32_16x16x32_bf16 v[160:163], v[208:211], v[136:139], v[160:163]
    ds_read_b64_tr_b16 v[198:199], v57 offset:2560
    s_cmp_eq_u32 s63, 0
    v_mfma_f32_16x16x32_bf16 v[176:179], v[208:211], v[140:143], v[176:179]
    s_cbranch_scc1 K_SP15
K_SPR15:
    s_ff1_i32_b32 s33, s63
    v_mfma_f32_16x16x32_bf16 v[164:167], v[212:215], v[136:139], v[164:167]
    s_bitset0_b32 s63, s33
    s_lshl_b32 s78, s33, 10
    v_mfma_f32_16x16x32_bf16 v[180:183], v[212:215], v[140:143], v[180:183]
    buffer_load_dwordx4 v[128:131], v25, s[20:23], s78 offen offset:0 sc1
    buffer_load_dwordx4 v[132:135], v26, s[20:23], s78 offen offset:0 sc1
    s_waitcnt vmcnt(8) lgkmcnt(8)
    v_mfma_f32_16x16x32_bf16 v[152:155], v[216:219], v[144:147], v[152:155]
    v_mad_u32_u24 v56, s76, 5, v24
    v_xor_b32 v58, 64, v56
    v_xor_b32 v57, 32, v56
    v_mfma_f32_16x16x32_bf16 v[168:171], v[216:219], v[148:151], v[168:171]
    v_xor_b32 v59, 96, v56
    ds_read_b64_tr_b16 v[200:201], v56 offset:0
    ds_read_b64_tr_b16 v[202:203], v58 offset:2560
    v_mfma_f32_16x16x32_bf16 v[156:159], v[220:223], v[144:147], v[156:159]
    ds_read_b64_tr_b16 v[204:205], v57 offset:0
    ds_read_b64_tr_b16 v[206:207], v59 offset:2560
    ds_read_b64_tr_b16 v[208:209], v58 offset:0
    v_mfma_f32_16x16x32_bf16 v[172:175], v[220:223], v[148:151], v[172:175]
    ds_read_b64_tr_b16 v[210:211], v56 offset:2560
    ds_read_b64_tr_b16 v[212:213], v59 offset:0
    v_mfma_f32_16x16x32_bf16 v[160:163], v[224:227], v[144:147], v[160:163]
    ds_read_b64_tr_b16 v[214:215], v57 offset:2560
    s_cmp_eq_u32 s63, 0
    v_mfma_f32_16x16x32_bf16 v[176:179], v[224:227], v[148:151], v[176:179]
    s_cbranch_scc1 K_SP16
K_SPR16:
    s_ff1_i32_b32 s33, s63
    v_mfma_f32_16x16x32_bf16 v[164:167], v[228:231], v[144:147], v[164:167]
    s_bitset0_b32 s63, s33
    s_lshl_b32 s75, s33, 10
    v_mfma_f32_16x16x32_bf16 v[180:183], v[228:231], v[148:151], v[180:183]
    buffer_load_dwordx4 v[136:139], v25, s[20:23], s75 offen offset:0 sc1
    buffer_load_dwordx4 v[140:143], v26, s[20:23], s75 offen offset:0 sc1
    s_waitcnt vmcnt(8) lgkmcnt(8)
    v_mfma_f32_16x16x32_bf16 v[152:155], v[184:187], v[104:107], v[152:155]
    v_mad_u32_u24 v56, s77, 5, v24
    v_xor_b32 v58, 64, v56
    v_xor_b32 v57, 32, v56
    v_mfma_f32_16x16x32_bf16 v[168:171], v[184:187], v[108:111], v[168:171]
    v_xor_b32 v59, 96, v56
    ds_read_b64_tr_b16 v[216:217], v56 offset:0
    ds_read_b64_tr_b16 v[218:219], v58 offset:2560
    v_mfma_f32_16x16x32_bf16 v[156:159], v[188:191], v[104:107], v[156:159]
    ds_read_b64_tr_b16 v[220:221], v57 offset:0
    ds_read_b64_tr_b16 v[222:223], v59 offset:2560
    ds_read_b64_tr_b16 v[224:225], v58 offset:0
    v_mfma_f32_16x16x32_bf16 v[172:175], v[188:191], v[108:111], v[172:175]
    ds_read_b64_tr_b16 v[226:227], v56 offset:2560
    ds_read_b64_tr_b16 v[228:229], v59 offset:0
    v_mfma_f32_16x16x32_bf16 v[160:163], v[192:195], v[104:107], v[160:163]
    ds_read_b64_tr_b16 v[230:231], v57 offset:2560
    s_andn2_b32 s33, s66, s63
    v_mfma_f32_16x16x32_bf16 v[176:179], v[192:195], v[108:111], v[176:179]
    s_bfe_u32 s33, s33, 0x40008
    s_cmp_eq_u32 s33, 15
    v_mfma_f32_16x16x32_bf16 v[164:167], v[196:199], v[104:107], v[164:167]
    s_cselect_b32 s76, 0, 1024
    s_xor_b32 s69, s76, 1024
    v_mfma_f32_16x16x32_bf16 v[180:183], v[196:199], v[108:111], v[180:183]
    buffer_load_dwordx4 v[144:147], v35, s[20:23], s76 offen offset:2048 sc1
    buffer_load_dwordx4 v[148:151], v36, s[20:23], s76 offen offset:2048 sc1
    s_waitcnt vmcnt(8) lgkmcnt(8)
    v_mfma_f32_16x16x32_bf16 v[152:155], v[200:203], v[112:115], v[152:155]
    v_mad_u32_u24 v56, s78, 5, v24
    v_xor_b32 v58, 64, v56
    v_xor_b32 v57, 32, v56
    v_mfma_f32_16x16x32_bf16 v[168:171], v[200:203], v[116:119], v[168:171]
    v_xor_b32 v59, 96, v56
    ds_read_b64_tr_b16 v[184:185], v56 offset:0
    ds_read_b64_tr_b16 v[186:187], v58 offset:2560
    v_mfma_f32_16x16x32_bf16 v[156:159], v[204:207], v[112:115], v[156:159]
    ds_read_b64_tr_b16 v[188:189], v57 offset:0
    ds_read_b64_tr_b16 v[190:191], v59 offset:2560
    ds_read_b64_tr_b16 v[192:193], v58 offset:0
    v_mfma_f32_16x16x32_bf16 v[172:175], v[204:207], v[116:119], v[172:175]
    ds_read_b64_tr_b16 v[194:195], v56 offset:2560
    ds_read_b64_tr_b16 v[196:197], v59 offset:0
    v_mfma_f32_16x16x32_bf16 v[160:163], v[208:211], v[112:115], v[160:163]
    ds_read_b64_tr_b16 v[198:199], v57 offset:2560
    s_cmp_eq_u32 s63, 0
    v_mfma_f32_16x16x32_bf16 v[176:179], v[208:211], v[116:119], v[176:179]
    s_cbranch_scc1 K_SP18
K_SPR18:
    s_ff1_i32_b32 s33, s63
    v_mfma_f32_16x16x32_bf16 v[164:167], v[212:215], v[112:115], v[164:167]
    s_bitset0_b32 s63, s33
    s_lshl_b32 s77, s33, 10
    v_mfma_f32_16x16x32_bf16 v[180:183], v[212:215], v[116:119], v[180:183]
    buffer_load_dwordx4 v[104:107], v25, s[20:23], s77 offen offset:0 sc1
    buffer_load_dwordx4 v[108:111], v26, s[20:23], s77 offen offset:0 sc1
    s_waitcnt vmcnt(8) lgkmcnt(8)
    v_mfma_f32_16x16x32_bf16 v[152:155], v[216:219], v[120:123], v[152:155]
    v_mad_u32_u24 v56, s75, 5, v24
    v_xor_b32 v58, 64, v56
    v_mfma_f32_16x16x32_bf16 v[168:171], v[216:219], v[124:127], v[168:171]
    v_xor_b32 v57, 32, v56
    v_xor_b32 v59, 96, v56
    v_mfma_f32_16x16x32_bf16 v[156:159], v[220:223], v[120:123], v[156:159]
    ds_read_b64_tr_b16 v[200:201], v56 offset:0
    ds_read_b64_tr_b16 v[202:203], v58 offset:2560
    v_mfma_f32_16x16x32_bf16 v[172:175], v[220:223], v[124:127], v[172:175]
    ds_read_b64_tr_b16 v[204:205], v57 offset:0
    ds_read_b64_tr_b16 v[206:207], v59 offset:2560
    v_mfma_f32_16x16x32_bf16 v[160:163], v[224:227], v[120:123], v[160:163]
    ds_read_b64_tr_b16 v[208:209], v58 offset:0
    ds_read_b64_tr_b16 v[210:211], v56 offset:2560
    v_mfma_f32_16x16x32_bf16 v[176:179], v[224:227], v[124:127], v[176:179]
    ds_read_b64_tr_b16 v[212:213], v59 offset:0
    ds_read_b64_tr_b16 v[214:215], v57 offset:2560
    v_mfma_f32_16x16x32_bf16 v[164:167], v[228:231], v[120:123], v[164:167]
    buffer_load_dwordx4 v[112:115], v35, s[20:23], s69 offen offset:2048 sc1
    buffer_load_dwordx4 v[116:119], v36, s[20:23], s69 offen offset:2048 sc1
    v_mfma_f32_16x16x32_bf16 v[180:183], v[228:231], v[124:127], v[180:183]
    s_waitcnt vmcnt(8) lgkmcnt(8)
    v_mfma_f32_16x16x32_bf16 v[152:155], v[184:187], v[128:131], v[152:155]
    v_mad_u32_u24 v56, s76, 20, v60
    v_xor_b32 v58, 64, v56
    v_mfma_f32_16x16x32_bf16 v[168:171], v[184:187], v[132:135], v[168:171]
    v_xor_b32 v57, 32, v56
    v_xor_b32 v59, 96, v56
    v_mfma_f32_16x16x32_bf16 v[156:159], v[188:191], v[128:131], v[156:159]
    ds_read_b64_tr_b16 v[216:217], v56 offset:40960
    ds_read_b64_tr_b16 v[218:219], v58 offset:43520
    v_mfma_f32_16x16x32_bf16 v[172:175], v[188:191], v[132:135], v[172:175]
    ds_read_b64_tr_b16 v[220:221], v57 offset:40960
    ds_read_b64_tr_b16 v[222:223], v59 offset:43520
    v_mfma_f32_16x16x32_bf16 v[160:163], v[192:195], v[128:131], v[160:163]
    ds_read_b64_tr_b16 v[224:225], v58 offset:40960
    ds_read_b64_tr_b16 v[226:227], v56 offset:43520
    v_mfma_f32_16x16x32_bf16 v[176:179], v[192:195], v[132:135], v[176:179]
    ds_read_b64_tr_b16 v[228:229], v59 offset:40960
    ds_read_b64_tr_b16 v[230:231], v57 offset:43520
    v_mfma_f32_16x16x32_bf16 v[164:167], v[196:199], v[128:131], v[164:167]
    v_mfma_f32_16x16x32_bf16 v[180:183], v[196:199], v[132:135], v[180:183]
    s_waitcnt vmcnt(6) lgkmcnt(8)
    v_mfma_f32_16x16x32_bf16 v[152:155], v[200:203], v[136:139], v[152:155]
    v_mad_u32_u24 v56, s77, 5, v24
    v_xor_b32 v58, 64, v56
    v_mfma_f32_16x16x32_bf16 v[168:171], v[200:203], v[140:143], v[168:171]
    v_xor_b32 v57, 32, v56
    v_xor_b32 v59, 96, v56
    v_mfma_f32_16x16x32_bf16 v[156:159], v[204:207], v[136:139], v[156:159]
    ds_read_b64_tr_b16 v[184:185], v56 offset:0
    ds_read_b64_tr_b16 v[186:187], v58 offset:2560
    v_mfma_f32_16x16x32_bf16 v[172:175], v[204:207], v[140:143], v[172:175]
    ds_read_b64_tr_b16 v[188:189], v57 offset:0
    ds_read_b64_tr_b16 v[190:191], v59 offset:2560
    v_mfma_f32_16x16x32_bf16 v[160:163], v[208:211], v[136:139], v[160:163]
    ds_read_b64_tr_b16 v[192:193], v58 offset:0
    ds_read_b64_tr_b16 v[194:195], v56 offset:2560
    v_mfma_f32_16x16x32_bf16 v[176:179], v[208:211], v[140:143], v[176:179]
    ds_read_b64_tr_b16 v[196:197], v59 offset:0
    ds_read_b64_tr_b16 v[198:199], v57 offset:2560
    v_mfma_f32_16x16x32_bf16 v[164:167], v[212:215], v[136:139], v[164:167]
    v_mfma_f32_16x16x32_bf16 v[180:183], v[212:215], v[140:143], v[180:183]
    s_waitcnt vmcnt(4) lgkmcnt(8)
    v_mfma_f32_16x16x32_bf16 v[152:155], v[216:219], v[144:147], v[152:155]
    v_mad_u32_u24 v56, s69, 20, v60
    v_xor_b32 v58, 64, v56
    v_mfma_f32_16x16x32_bf16 v[168:171], v[216:219], v[148:151], v[168:171]
    v_xor_b32 v57, 32, v56
    v_xor_b32 v59, 96, v56
    v_mfma_f32_16x16x32_bf16 v[156:159], v[220:223], v[144:147], v[156:159]
    ds_read_b64_tr_b16 v[200:201], v56 offset:40960
    ds_read_b64_tr_b16 v[202:203], v58 offset:43520
    v_mfma_f32_16x16x32_bf16 v[172:175], v[220:223], v[148:151], v[172:175]
    ds_read_b64_tr_b16 v[204:205], v57 offset:40960
    ds_read_b64_tr_b16 v[206:207], v59 offset:43520
    v_mfma_f32_16x16x32_bf16 v[160:163], v[224:227], v[144:147], v[160:163]
    ds_read_b64_tr_b16 v[208:209], v58 offset:40960
    ds_read_b64_tr_b16 v[210:211], v56 offset:43520
    v_mfma_f32_16x16x32_bf16 v[176:179], v[224:227], v[148:151], v[176:179]
    ds_read_b64_tr_b16 v[212:213], v59 offset:40960
    ds_read_b64_tr_b16 v[214:215], v57 offset:43520
    v_mfma_f32_16x16x32_bf16 v[164:167], v[228:231], v[144:147], v[164:167]
    v_mfma_f32_16x16x32_bf16 v[180:183], v[228:231], v[148:151], v[180:183]
    s_waitcnt vmcnt(2) lgkmcnt(8)
    v_mfma_f32_16x16x32_bf16 v[152:155], v[184:187], v[104:107], v[152:155]
    v_mfma_f32_16x16x32_bf16 v[156:159], v[188:191], v[104:107], v[156:159]
    v_mfma_f32_16x16x32_bf16 v[160:163], v[192:195], v[104:107], v[160:163]
    v_mfma_f32_16x16x32_bf16 v[164:167], v[196:199], v[104:107], v[164:167]
    s_sub_u32 s59, s56, s58
    s_cmp_lt_u32 s59, 32
    s_cbranch_scc1 K_YROW0
K_NOY0:
    s_sub_u32 s59, s57, s58
    s_cmp_lt_u32 s59, 32
    s_cbranch_scc1 K_YROW1
K_NOY1:
    s_waitcnt vmcnt(0) lgkmcnt(0)
    v_mfma_f32_16x16x32_bf16 v[152:155], v[200:203], v[112:115], v[152:155]
    v_mfma_f32_16x16x32_bf16 v[156:159], v[204:207], v[112:115], v[156:159]
    v_mfma_f32_16x16x32_bf16 v[160:163], v[208:211], v[112:115], v[160:163]
    v_mfma_f32_16x16x32_bf16 v[164:167], v[212:215], v[112:115], v[164:167]
    v_mfma_f32_16x16x32_bf16 v[168:171], v[184:187], v[108:111], v[168:171]
    v_mfma_f32_16x16x32_bf16 v[172:175], v[188:191], v[108:111], v[172:175]
    v_mfma_f32_16x16x32_bf16 v[176:179], v[192:195], v[108:111], v[176:179]
    s_nop 1
    v_fma_f32 v152, v152, v64, v72
    v_fma_f32 v153, v153, v64, v73
    v_fma_f32 v154, v154, v64, v74
    v_mfma_f32_16x16x32_bf16 v[180:183], v[196:199], v[108:111], v[180:183]
    v_fma_f32 v155, v155, v64, v75
    v_cvt_pk_bf16_f32 v40, v152, v153
    v_cvt_pk_bf16_f32 v41, v154, v155
    v_mfma_f32_16x16x32_bf16 v[168:171], v[200:203], v[116:119], v[168:171]
    v_fma_f32 v156, v156, v64, v76
    v_fma_f32 v157, v157, v64, v77
    ds_write_b64 v29, v[40:41] offset:0
    v_mfma_f32_16x16x32_bf16 v[172:175], v[204:207], v[116:119], v[172:175]
    v_fma_f32 v158, v158, v64, v78
    v_fma_f32 v159, v159, v64, v79
    v_cvt_pk_bf16_f32 v42, v156, v157
    v_mfma_f32_16x16x32_bf16 v[176:179], v[208:211], v[116:119], v[176:179]
    v_cvt_pk_bf16_f32 v43, v158, v159
    v_fma_f32 v160, v160, v64, v80
    v_fma_f32 v161, v161, v64, v81
    v_mfma_f32_16x16x32_bf16 v[180:183], v[212:215], v[116:119], v[180:183]
    ds_write_b64 v30, v[42:43] offset:0
    v_fma_f32 v162, v162, v64, v82
    v_fma_f32 v163, v163, v64, v83
    v_cvt_pk_bf16_f32 v44, v160, v161
    v_cvt_pk_bf16_f32 v45, v162, v163
    v_pk_fma_f32 v[164:165], v[164:165], v[64:65], v[84:85] op_sel_hi:[1,0,1]
    v_pk_fma_f32 v[166:167], v[166:167], v[64:65], v[86:87] op_sel_hi:[1,0,1]
    ds_write_b64 v31, v[44:45] offset:0
    v_cvt_pk_bf16_f32 v46, v164, v165
    v_cvt_pk_bf16_f32 v47, v166, v167
    ds_write_b64 v32, v[46:47] offset:0
    ds_read_b128 v[72:75], v33 offset:0
    ds_read_b128 v[76:79], v33 offset:1024
    v_pk_fma_f32 v[168:169], v[168:169], v[66:67], v[88:89] op_sel_hi:[1,0,1]
    v_pk_fma_f32 v[170:171], v[170:171], v[66:67], v[90:91] op_sel_hi:[1,0,1]
    v_cvt_pk_bf16_f32 v48, v168, v169
    v_cvt_pk_bf16_f32 v49, v170, v171
    v_pk_fma_f32 v[172:173], v[172:173], v[66:67], v[92:93] op_sel_hi:[1,0,1]
    v_pk_fma_f32 v[174:175], v[174:175], v[66:67], v[94:95] op_sel_hi:[1,0,1]
    v_cvt_pk_bf16_f32 v50, v172, v173
    v_cvt_pk_bf16_f32 v51, v174, v175
    v_pk_fma_f32 v[176:177], v[176:177], v[66:67], v[96:97] op_sel_hi:[1,0,1]
    v_pk_fma_f32 v[178:179], v[178:179], v[66:67], v[98:99] op_sel_hi:[1,0,1]
    v_cvt_pk_bf16_f32 v52, v176, v177
    v_cvt_pk_bf16_f32 v53, v178, v179
    v_pk_fma_f32 v[180:181], v[180:181], v[66:67], v[100:101] op_sel_hi:[1,0,1]
    v_pk_fma_f32 v[182:183], v[182:183], v[66:67], v[102:103] op_sel_hi:[1,0,1]
    v_cvt_pk_bf16_f32 v54, v180, v181
    v_cvt_pk_bf16_f32 v55, v182, v183
    s_waitcnt lgkmcnt(0)
    buffer_store_dwordx4 v[72:75], v27, s[48:51], s71 offen sc1
    buffer_store_dwordx4 v[76:79], v28, s[48:51], s72 offen sc1
    ds_write_b64 v29, v[48:49] offset:2048
    ds_write_b64 v30, v[50:51] offset:2048
    ds_write_b64 v31, v[52:53] offset:2048
    ds_write_b64 v32, v[54:55] offset:2048
    ds_read_b128 v[88:91], v33 offset:2048
    ds_read_b128 v[92:95], v33 offset:3072
    s_waitcnt lgkmcnt(1)
    buffer_store_dwordx4 v[88:91], v27, s[48:51], s73 offen sc1
    s_waitcnt lgkmcnt(0)
    buffer_store_dwordx4 v[92:95], v28, s[48:51], s74 offen sc1
K_END:
K_EXIT:
    s_endpgm
.p2align 12
WP_spin:
    s_setpc_b64 s[38:39]
K_SP0:
    ds_read_b32 v2, v12 offset:32
    s_waitcnt lgkmcnt(0)
    v_readfirstlane_b32 s33, v2
    s_nop 3
    s_lshr_b32 s63, s33, s64
    s_lshr_b32 s33, s33, s65
    s_and_b32 s63, s63, s33
    s_and_b32 s63, s63, 0xff
    s_andn2_b32 s63, s63, s66
    s_cbranch_scc0 K_SP0
    s_or_b32 s66, s66, s63
    s_branch K_SPR0
K_SP1:
    ds_read_b32 v2, v12 offset:32
    s_waitcnt lgkmcnt(0)
    v_readfirstlane_b32 s33, v2
    s_nop 3
    s_lshr_b32 s63, s33, s64
    s_lshr_b32 s33, s33, s65
    s_and_b32 s63, s63, s33
    s_and_b32 s63, s63, 0xff
    s_andn2_b32 s63, s63, s66
    s_cbranch_scc0 K_SP1
    s_or_b32 s66, s66, s63
    s_branch K_SPR1
K_SP2:
    ds_read_b32 v2, v12 offset:32
    s_waitcnt lgkmcnt(0)
    v_readfirstlane_b32 s33, v2
    s_nop 3
    s_lshr_b32 s63, s33, s64
    s_lshr_b32 s33, s33, s65
    s_and_b32 s63, s63, s33
    s_and_b32 s63, s63, 0xff
    s_andn2_b32 s63, s63, s66
    s_cbranch_scc0 K_SP2
    s_or_b32 s66, s66, s63
    s_branch K_SPR2
K_SP3:
    ds_read_b32 v2, v12 offset:32
    s_waitcnt lgkmcnt(0)
    v_readfirstlane_b32 s33, v2
    s_nop 3
    s_lshr_b32 s63, s33, s64
    s_lshr_b32 s33, s33, s65
    s_and_b32 s63, s63, s33
    s_and_b32 s63, s63, 0xff
    s_andn2_b32 s63, s63, s66
    s_cbranch_scc0 K_SP3
    s_or_b32 s66, s66, s63
    s_branch K_SPR3
K_SP4:
    ds_read_b32 v2, v12 offset:32
    s_waitcnt lgkmcnt(0)
    v_readfirstlane_b32 s33, v2
    s_nop 3
    s_lshr_b32 s63, s33, s64
    s_lshr_b32 s33, s33, s65
    s_and_b32 s63, s63, s33
    s_and_b32 s63, s63, 0xff
    s_andn2_b32 s63, s63, s66
    s_cbranch_scc0 K_SP4
    s_or_b32 s66, s66, s63
    s_branch K_SPR4
K_SP5:
    ds_read_b32 v2, v12 offset:32
    s_waitcnt lgkmcnt(0)
    v_readfirstlane_b32 s33, v2
    s_nop 3
    s_lshr_b32 s63, s33, s64
    s_lshr_b32 s33, s33, s65
    s_and_b32 s63, s63, s33
    s_and_b32 s63, s63, 0xff
    s_andn2_b32 s63, s63, s66
    s_cbranch_scc0 K_SP5
    s_or_b32 s66, s66, s63
    s_branch K_SPR5
K_SP6:
    ds_read_b32 v2, v12 offset:32
    s_waitcnt lgkmcnt(0)
    v_readfirstlane_b32 s33, v2
    s_nop 3
    s_lshr_b32 s63, s33, s64
    s_lshr_b32 s33, s33, s65
    s_and_b32 s63, s63, s33
    s_and_b32 s63, s63, 0xff
    s_andn2_b32 s63, s63, s66
    s_cbranch_scc0 K_SP6
    s_or_b32 s66, s66, s63
    s_branch K_SPR6
K_SP8:
    ds_read_b32 v2, v12 offset:32
    s_waitcnt lgkmcnt(0)
    v_readfirstlane_b32 s33, v2
    s_nop 3
    s_lshr_b32 s63, s33, s64
    s_lshr_b32 s33, s33, s65
    s_and_b32 s63, s63, s33
    s_and_b32 s63, s63, 0xff
    s_andn2_b32 s63, s63, s66
    s_cbranch_scc0 K_SP8
    s_or_b32 s66, s66, s63
    s_branch K_SPR8
K_SP10:
    ds_read_b32 v2, v12 offset:32
    s_waitcnt lgkmcnt(0)
    v_readfirstlane_b32 s33, v2
    s_nop 3
    s_lshr_b32 s63, s33, s64
    s_lshr_b32 s33, s33, s65
    s_and_b32 s63, s63, s33
    s_and_b32 s63, s63, 0xff00
    s_andn2_b32 s63, s63, s66
    s_cbranch_scc0 K_SP10
    s_or_b32 s66, s66, s63
    s_branch K_SPR10
K_SP11:
    ds_read_b32 v2, v12 offset:32
    s_waitcnt lgkmcnt(0)
    v_readfirstlane_b32 s33, v2
    s_nop 3
    s_lshr_b32 s63, s33, s64
    s_lshr_b32 s33, s33, s65
    s_and_b32 s63, s63, s33
    s_and_b32 s63, s63, 0xff00
    s_andn2_b32 s63, s63, s66
    s_cbranch_scc0 K_SP11
    s_or_b32 s66, s66, s63
    s_branch K_SPR11
K_SP12:
    ds_read_b32 v2, v12 offset:32
    s_waitcnt lgkmcnt(0)
    v_readfirstlane_b32 s33, v2
    s_nop 3
    s_lshr_b32 s63, s33, s64
    s_lshr_b32 s33, s33, s65
    s_and_b32 s63, s63, s33
    s_and_b32 s63, s63, 0xff00
    s_andn2_b32 s63, s63, s66
    s_cbranch_scc0 K_SP12
    s_or_b32 s66, s66, s63
    s_branch K_SPR12
K_SP13:
    ds_read_b32 v2, v12 offset:32
    s_waitcnt lgkmcnt(0)
    v_readfirstlane_b32 s33, v2
    s_nop 3
    s_lshr_b32 s63, s33, s64
    s_lshr_b32 s33, s33, s65
    s_and_b32 s63, s63, s33
    s_and_b32 s63, s63, 0xff00
    s_andn2_b32 s63, s63, s66
    s_cbranch_scc0 K_SP13
    s_or_b32 s66, s66, s63
    s_branch K_SPR13
K_SP14:
    ds_read_b32 v2, v12 offset:32
    s_waitcnt lgkmcnt(0)
    v_readfirstlane_b32 s33, v2
    s_nop 3
    s_lshr_b32 s63, s33, s64
    s_lshr_b32 s33, s33, s65
    s_and_b32 s63, s63, s33
    s_and_b32 s63, s63, 0xff00
    s_andn2_b32 s63, s63, s66
    s_cbranch_scc0 K_SP14
    s_or_b32 s66, s66, s63
    s_branch K_SPR14
K_SP15:
    ds_read_b32 v2, v12 offset:32
    s_waitcnt lgkmcnt(0)
    v_readfirstlane_b32 s33, v2
    s_nop 3
    s_lshr_b32 s63, s33, s64
    s_lshr_b32 s33, s33, s65
    s_and_b32 s63, s63, s33
    s_and_b32 s63, s63, 0xff00
    s_andn2_b32 s63, s63, s66
    s_cbranch_scc0 K_SP15
    s_or_b32 s66, s66, s63
    s_branch K_SPR15
K_SP16:
    ds_read_b32 v2, v12 offset:32
    s_waitcnt lgkmcnt(0)
    v_readfirstlane_b32 s33, v2
    s_nop 3
    s_lshr_b32 s63, s33, s64
    s_lshr_b32 s33, s33, s65
    s_and_b32 s63, s63, s33
    s_and_b32 s63, s63, 0xff00
    s_andn2_b32 s63, s63, s66
    s_cbranch_scc0 K_SP16
    s_or_b32 s66, s66, s63
    s_branch K_SPR16
K_SP18:
    ds_read_b32 v2, v12 offset:32
    s_waitcnt lgkmcnt(0)
    v_readfirstlane_b32 s33, v2
    s_nop 3
    s_lshr_b32 s63, s33, s64
    s_lshr_b32 s33, s33, s65
    s_and_b32 s63, s63, s33
    s_and_b32 s63, s63, 0xff00
    s_andn2_b32 s63, s63, s66
    s_cbranch_scc0 K_SP18
    s_or_b32 s66, s66, s63
    s_branch K_SPR18
WP_yr0:
    s_setpc_b64 s[38:39]
K_YROW0:
    v_lshlrev_b32 v5, 4, v9
    v_add_u32 v5, 158976, v5
    v_and_b32 v3, 15, v1
    s_and_b32 s33, s59, 15
    v_cmp_eq_u32 vcc, s33, v3
    s_mov_b32 s3, 1048576
K_P2_GY0:
    ds_read_b32 v2, v12 offset:64
    s_sub_u32 s3, s3, 1
    s_waitcnt lgkmcnt(0)
    v_readfirstlane_b32 s33, v2
    s_nop 3
    s_cselect_b32 s33, 1, s33
    s_cmp_lt_u32 s33, 1
    s_cbranch_scc1 K_P2_GY0
    s_mov_b64 exec, vcc
    s_cmp_ge_u32 s59, 16
    s_cbranch_scc1 K_YR1_0
    ds_read_b128 v[72:75], v5 offset:0
    ds_read_b128 v[76:79], v5 offset:64
    ds_read_b128 v[80:83], v5 offset:128
    ds_read_b128 v[84:87], v5 offset:192
    s_mov_b64 exec, -1
    s_branch K_NOY0
K_YR1_0:
    ds_read_b128 v[88:91], v5 offset:0
    ds_read_b128 v[92:95], v5 offset:64
    ds_read_b128 v[96:99], v5 offset:128
    ds_read_b128 v[100:103], v5 offset:192
    s_mov_b64 exec, -1
    s_branch K_NOY0
K_YROW1:
    v_lshlrev_b32 v5, 4, v9
    v_add_u32 v5, 159232, v5
    v_and_b32 v3, 15, v1
    s_and_b32 s33, s59, 15
    v_cmp_eq_u32 vcc, s33, v3
    s_mov_b32 s3, 1048576
K_P2_GY1:
    ds_read_b32 v2, v12 offset:68
    s_sub_u32 s3, s3, 1
    s_waitcnt lgkmcnt(0)
    v_readfirstlane_b32 s33, v2
    s_nop 3
    s_cselect_b32 s33, 1, s33
    s_cmp_lt_u32 s33, 1
    s_cbranch_scc1 K_P2_GY1
    s_mov_b64 exec, vcc
    s_cmp_ge_u32 s59, 16
    s_cbranch_scc1 K_YR1_1
    ds_read_b128 v[72:75], v5 offset:0
    ds_read_b128 v[76:79], v5 offset:64
    ds_read_b128 v[80:83], v5 offset:128
    ds_read_b128 v[84:87], v5 offset:192
    s_mov_b64 exec, -1
    s_branch K_NOY1
K_YR1_1:
    ds_read_b128 v[88:91], v5 offset:0
    ds_read_b128 v[92:95], v5 offset:64
    ds_read_b128 v[96:99], v5 offset:128
    ds_read_b128 v[100:103], v5 offset:192
    s_mov_b64 exec, -1
    s_branch K_NOY1
.p2align 12
WP_gen:
    s_setpc_b64 s[38:39]
K_P2:
    s_cmp_ge_u32 s30, 4
    s_cbranch_scc1 K_P2_HELP
    v_mov_b32 v12, 158720
    s_cmp_lg_u32 s30, 0
    s_cbranch_scc1 K_P2_W13
    v_lshrrev_b32 v3, 4, v1
    v_and_b32 v4, 7, v1
    v_lshrrev_b32 v2, 3, v1
    v_xor_b32 v4, v4, v3
    v_mul_u32_u24 v2, 1280, v2
    v_lshl_add_u32 v27, v4, 4, v2
    v_xor_b32 v28, 64, v27
    s_mov_b32 s58, 0
K_P2_XD:
    s_lshl_b32 s59, s40, 3
    s_lshl1_add_u32 s59, s58, s59
    s_mul_i32 s59, s59, 20480
    s_lshl_b32 s33, s41, 7
    s_add_u32 s59, s59, s33
    s_lshl_b32 s33, s58, 12
    s_add_u32 m0, s33, 140288
    s_add_u32 s3, s59, 0
    buffer_load_dwordx4 v27, s[12:15], s3 offen lds
    s_add_u32 m0, s33, 141312
    s_add_u32 s3, s59, 10240
    buffer_load_dwordx4 v28, s[12:15], s3 offen lds
    s_add_u32 m0, s33, 142336
    s_add_u32 s3, s59, 20480
    buffer_load_dwordx4 v27, s[12:15], s3 offen lds
    s_add_u32 m0, s33, 143360
    s_add_u32 s3, s59, 30720
    buffer_load_dwordx4 v28, s[12:15], s3 offen lds
    s_add_u32 s58, s58, 1
    s_cmp_lt_u32 s58, 4
    s_cbranch_scc1 K_P2_XD
    s_waitcnt vmcnt(0)
    s_branch K_P2_AUXW
K_P2_W13:
    v_lshrrev_b32 v2, 3, v1
    v_mul_u32_u24 v2, 1280, v2
    v_lshrrev_b32 v3, 4, v1
    v_lshlrev_b32 v3, 1, v3
    v_and_b32 v4, 7, v1
    v_xor_b32 v3, v3, v4
    v_lshl_add_u32 v2, v3, 4, v2
    s_lshl_b32 s33, s41, 7
    v_add_u32 v22, s33, v2
    s_mov_b32 s60, 0xfda87520
    s_mov_b32 s61, 0xecb96431
    s_sub_u32 s58, s30, 1
K_P2_WS:
    s_lshl_b32 s3, s58, 2
    s_lshr_b64 s[4:5], s[60:61], s3
    s_and_b32 s4, s4, 15
    s_mul_i32 s4, s4, 51200
    s_mul_i32 s59, s58, 5120
    s_add_u32 s52, s4, 0
    s_add_u32 m0, s59, 0
    s_waitcnt vmcnt(11)
    buffer_load_dwordx4 v22, s[24:27], s52 offen lds
    s_add_u32 s52, s4, 10240
    s_add_u32 m0, s59, 1024
    s_waitcnt vmcnt(11)
    buffer_load_dwordx4 v22, s[24:27], s52 offen lds
    s_add_u32 s52, s4, 20480
    s_add_u32 m0, s59, 2048
    s_waitcnt vmcnt(11)
    buffer_load_dwordx4 v22, s[24:27], s52 offen lds
    s_add_u32 s52, s4, 30720
    s_add_u32 m0, s59, 3072
    s_waitcnt vmcnt(11)
    buffer_load_dwordx4 v22, s[24:27], s52 offen lds
    s_add_u32 s52, s4, 40960
    s_add_u32 m0, s59, 4096
    s_waitcnt vmcnt(11)
    buffer_load_dwordx4 v22, s[24:27], s52 offen lds
    s_cmp_ge_u32 s58, 3
    s_cbranch_scc1 K_P2_WS1
    v_mov_b32 v3, 1
    s_waitcnt vmcnt(5)
    s_mov_b64 exec, 1
    ds_add_u32 v12, v3 offset:52
    s_mov_b64 exec, -1
K_P2_WS1:
    s_add_u32 s58, s58, 3
    s_cmp_lt_u32 s58, 16
    s_cbranch_scc1 K_P2_WS
K_P2_AUXW:
    v_mov_b32 v34, 1
    s_waitcnt vmcnt(10)
    s_mov_b64 exec, 1
    ds_add_u32 v12, v34 offset:72
    s_mov_b64 exec, -1
    s_lshl_b32 s54, s40, 7
    v_lshrrev_b32 v9, 4, v1
    v_mov_b32 v12, 158720
    s_add_u32 s20, s10, 0x100000
    s_addc_u32 s21, s11, 0
    s_mov_b32 s22, 0x280000
    s_mov_b32 s23, 0x20000
    s_add_u32 s16, s10, 0x1000
    s_addc_u32 s17, s11, 0
    s_mov_b32 s18, 0x2000
    s_mov_b32 s19, 0x20000
    s_mov_b32 s48, s6
    s_mov_b32 s49, s7
    s_mov_b32 s50, 0x280000
    s_mov_b32 s51, 0x20000
    s_lshl_b32 s53, s40, 3
    s_lshl1_add_u32 s53, s30, s53
    s_mov_b32 s55, 20480
    v_bfe_u32 v20, v1, 2, 2
    v_and_b32 v21, 3, v1
    s_mul_i32 s3, s53, 20480
    v_lshl_add_u32 v25, v1, 4, s3
    v_add_u32 v26, 20480, v25
    v_add_u32 v35, 16384, v25
    v_add_u32 v36, 16384, v26
    v_and_b32 v2, 15, v1
    s_lshl_b32 s3, s53, 6
    v_lshl_add_u32 v23, v2, 2, s3
    v_lshl_add_u32 v2, v9, 2, v20
    v_bfe_u32 v3, v2, 1, 2
    v_lshlrev_b32 v2, 7, v2
    v_lshl_add_u32 v2, v21, 3, v2
    v_lshl_add_u32 v24, v3, 5, v2
    v_lshrrev_b32 v3, 1, v20
    v_mul_u32_u24 v2, 40, v9
    v_add3_u32 v2, v2, 16, v20
    v_lshlrev_b32 v2, 7, v2
    v_lshl_add_u32 v2, v21, 3, v2
    v_xor_b32 v4, 0, v3
    v_lshl_add_u32 v60, v4, 5, v2
    v_xor_b32 v4, 1, v3
    v_lshl_add_u32 v61, v4, 5, v2
    v_xor_b32 v4, 2, v3
    v_lshl_add_u32 v62, v4, 5, v2
    v_xor_b32 v4, 3, v3
    v_lshl_add_u32 v63, v4, 5, v2
    v_lshrrev_b32 v3, 4, v1
    v_and_b32 v4, 7, v1
    v_lshrrev_b32 v2, 3, v1
    v_xor_b32 v4, v4, v3
    v_mul_u32_u24 v2, 1280, v2
    v_lshl_add_u32 v27, v4, 4, v2
    v_xor_b32 v28, 64, v27
    s_lshl_b32 s71, s40, 3
    s_lshl1_add_u32 s71, s30, s71
    s_mul_i32 s71, s71, 20480
    s_lshl_b32 s33, s41, 7
    s_add_u32 s71, s71, s33
    s_add_u32 s72, s71, 10240
    s_add_u32 s73, s71, 20480
    s_add_u32 s74, s71, 30720
    s_lshl_b32 s3, s30, 12
    s_add_u32 s3, s3, 140288
    v_lshl_add_u32 v33, v1, 4, s3
    v_and_b32 v2, 15, v1
    v_lshrrev_b32 v3, 1, v2
    v_lshrrev_b32 v4, 5, v1
    v_xor_b32 v3, v3, v4
    v_lshlrev_b32 v3, 4, v3
    v_lshl_add_u32 v3, v2, 7, v3
    v_and_b32 v4, 1, v9
    v_lshl_add_u32 v3, v4, 3, v3
    v_add_u32 v29, s3, v3
    v_xor_b32 v30, 32, v29
    v_xor_b32 v31, 64, v29
    v_xor_b32 v32, 96, v29
    s_and_b32 s33, s40, 3
    s_lshl_b32 s33, s33, 3
    s_lshr_b32 s33, 0x7f06037f, s33
    s_and_b32 s33, s33, 0xff
    s_lshl_b32 s3, s30, 1
    s_cmp_ge_u32 s3, s33
    s_cselect_b32 s64, 16, 0
    s_add_u32 s3, s3, 1
    s_cmp_ge_u32 s3, s33
    s_cselect_b32 s65, 16, 0
    s_mov_b32 s63, 0
    s_mov_b32 s66, 0
    s_mov_b32 s67, 16384
    s_mov_b32 s3, 1048576
K_P2_GWA:
    ds_read_b32 v2, v12 offset:72
    s_sub_u32 s3, s3, 1
    s_waitcnt lgkmcnt(0)
    v_readfirstlane_b32 s33, v2
    s_nop 3
    s_cselect_b32 s33, 4, s33
    s_cmp_lt_u32 s33, 4
    s_cbranch_scc1 K_P2_GWA
    s_branch K_P2_GEMM
WP_help:
    s_setpc_b64 s[38:39]
K_LATE:
    s_sub_u32 s44, s30, 4
K_WOL:
    s_lshl_b32 s50, s44, 2
    s_lshr_b32 s50, 0x6431, s50
    s_and_b32 s50, s50, 7
    s_mul_i32 s50, s50, 51200
    s_mul_i32 s51, s44, 5120
    s_add_u32 s3, s50, 0
    s_add_u32 m0, s51, 40960
    s_waitcnt vmcnt(13)
    buffer_load_dwordx4 v18, s[24:27], s3 offen lds
    s_add_u32 s3, s50, 10240
    s_add_u32 m0, s51, 41984
    s_waitcnt vmcnt(13)
    buffer_load_dwordx4 v18, s[24:27], s3 offen lds
    s_add_u32 s3, s50, 20480
    s_add_u32 m0, s51, 43008
    s_waitcnt vmcnt(13)
    buffer_load_dwordx4 v18, s[24:27], s3 offen lds
    s_add_u32 s3, s50, 30720
    s_add_u32 m0, s51, 44032
    s_waitcnt vmcnt(13)
    buffer_load_dwordx4 v18, s[24:27], s3 offen lds
    s_add_u32 s3, s50, 40960
    s_add_u32 m0, s51, 45056
    s_waitcnt vmcnt(13)
    buffer_load_dwordx4 v18, s[24:27], s3 offen lds
    s_add_u32 s3, s50, 409600
    s_add_u32 m0, s51, 61440
    s_waitcnt vmcnt(13)
    buffer_load_dwordx4 v18, s[24:27], s3 offen lds
    s_add_u32 s3, s50, 419840
    s_add_u32 m0, s51, 62464
    s_waitcnt vmcnt(13)
    buffer_load_dwordx4 v18, s[24:27], s3 offen lds
    s_add_u32 s3, s50, 430080
    s_add_u32 m0, s51, 63488
    s_waitcnt vmcnt(13)
    buffer_load_dwordx4 v18, s[24:27], s3 offen lds
    s_add_u32 s3, s50, 440320
    s_add_u32 m0, s51, 64512
    s_waitcnt vmcnt(13)
    buffer_load_dwordx4 v18, s[24:27], s3 offen lds
    s_add_u32 s3, s50, 450560
    s_add_u32 m0, s51, 65536
    s_waitcnt vmcnt(13)
    buffer_load_dwordx4 v18, s[24:27], s3 offen lds
    s_add_u32 s44, s44, 2
    s_cmp_lt_u32 s44, 4
    s_cbranch_scc1 K_WOL
    v_mov_b32 v2, 158720
    v_mov_b32 v3, 2
    s_waitcnt vmcnt(0)
    s_mov_b64 exec, 1
    ds_add_u32 v2, v3 offset:44
    s_mov_b64 exec, -1
K_P2_HELP:
    s_setprio 3
    s_add_u32 s59, s40, 1
    s_bitcmp1_b32 s59, 1
    s_cselect_b32 s59, 31, 15
    v_and_b32 v10, s59, v1
    v_lshl_add_u32 v10, v10, 2, s42
    s_cmp_lg_u32 s30, 7
    s_cbranch_scc1 K_P2_N7
    v_and_b32 v4, 7, v1
    v_lshlrev_b32 v4, 2, v4
    s_mov_b32 s3, 131072
K_ZPOLL1:
    v_cmp_eq_u32 vcc, 0, v7
    s_cbranch_vccz K_ZOK1
    s_sub_u32 s3, s3, 1
    s_cbranch_scc1 K_ZOK1
    global_load_dword v7, v4, s[8:9] offset:192 sc1
    s_waitcnt vmcnt(0)
    s_branch K_ZPOLL1
K_ZOK1:
    global_load_dword v7, v10, s[10:11] sc1
K_P2_N7:
    s_lshl_b32 s54, s40, 7
    v_lshrrev_b32 v9, 4, v1
    v_mov_b32 v12, 158720
    s_add_u32 s44, s10, 0x10000
    s_addc_u32 s45, s11, 0
    s_mov_b32 s46, 0x43800
    s_mov_b32 s47, 0x20000
    v_mov_b32 v80, 1
    s_cmp_eq_u32 s30, 7
    s_cbranch_scc1 K_P2_FLAGS
    s_cmp_lg_u32 s30, 6
    s_cbranch_scc1 K_END
    s_mov_b32 s3, 131072
K_P2_DPOLL:
    v_cmp_eq_u32 vcc, 0, v7
    s_cbranch_vccz K_P2_DOK
    s_cmp_eq_u32 s3, 131072
    s_cbranch_scc1 K_P2_DNS
    s_sleep 12
K_P2_DNS:
    v_and_b32 v11, 1, v1
    v_lshl_add_u32 v11, v11, 2, s42
    global_load_dword v7, v11, s[10:11] offset:128 sc1
    s_sub_u32 s3, s3, 1
    s_waitcnt vmcnt(0)
    s_cmp_lg_u32 s3, 0
    s_cbranch_scc1 K_P2_DPOLL
K_P2_DOK:
    v_readlane_b32 s58, v7, 0
    v_readlane_b32 s59, v7, 1
    s_nop 3
    s_and_b32 s3, s58, 0x7ff
    s_sub_u32 s3, 2047, s3
    v_mov_b32 v20, s3
    v_mov_b32 v4, s58
    v_and_b32 v4, 0xffff0000, v4
    v_ashrrev_i32 v5, 31, v4
    v_not_b32 v5, v5
    v_or_b32 v5, 0x80000000, v5
    v_xor_b32 v4, v4, v5
    v_and_b32 v4, 0xffff0000, v4
    v_mul_f32 v5, 0xbfb8aa3b, v4
    v_exp_f32 v5, v5
    s_nop 0
    v_add_f32 v5, 1.0, v5
    v_rcp_f32 v4, v5
    s_nop 0
    v_cvt_pk_bf16_f32 v22, v4, v4
    v_lshlrev_b32 v22, 16, v22
    s_and_b32 s3, s59, 0x7ff
    s_sub_u32 s3, 2047, s3
    v_mov_b32 v21, s3
    v_mov_b32 v4, s59
    v_and_b32 v4, 0xffff0000, v4
    v_ashrrev_i32 v5, 31, v4
    v_not_b32 v5, v5
    v_or_b32 v5, 0x80000000, v5
    v_xor_b32 v4, v4, v5
    v_and_b32 v4, 0xffff0000, v4
    v_mul_f32 v5, 0xbfb8aa3b, v4
    v_exp_f32 v5, v5
    s_nop 0
    v_add_f32 v5, 1.0, v5
    v_rcp_f32 v4, v5
    s_nop 0
    v_cvt_pk_bf16_f32 v23, v4, v4
    v_lshlrev_b32 v23, 16, v23
    ds_write_b128 v12, v[20:23]
    ds_write_b32 v12, v80 offset:40
    s_mov_b32 s53, 0
    v_mov_b32 v16, v20
    v_mov_b32 v17, v21
    v_mov_b32 v18, v22
    v_mov_b32 v19, v23
K_P2_HW:
    s_cmp_eq_u32 s53, 0
    s_cselect_b64 vcc, -1, 0
    s_nop 1
    v_cndmask_b32 v2, v17, v16, vcc
    v_cndmask_b32 v5, v19, v18, vcc
    s_nop 0
    v_readfirstlane_b32 s58, v2
    s_nop 3
    s_sub_u32 s3, s58, s54
    s_cmp_lt_u32 s3, 128
    s_cbranch_scc0 K_P2_YN
    s_call_b64 s[38:39], WP_yr0
    s_mul_i32 s3, s58, 1280
    s_lshl_b32 s33, s41, 7
    s_add_u32 s3, s3, s33
    v_and_b32 v2, 15, v1
    v_lshlrev_b32 v2, 3, v2
    buffer_load_dwordx2 v[84:85], v2, s[12:15], s3 offen
    s_lshl_b32 s3, s58, 2
    s_add_u32 s3, s3, 4096
    v_mov_b32 v2, s3
    global_load_dword v88, v2, s[10:11] sc1
    s_lshl1_add_u32 s3, s41, s53
    s_lshl_b32 s3, s3, 8
    s_add_u32 s3, s3, 568320
    v_min_u32 v3, 53, v1
    v_lshl_add_u32 v3, v3, 2, s3
    s_mov_b32 s3, 131072
K_P2_YPOLL:
    global_load_dword v2, v3, s[10:11] sc1
    s_sub_u32 s3, s3, 1
    s_waitcnt vmcnt(0)
    v_cmp_ne_u32 vcc, 1, v2
    s_cbranch_vccz K_P2_YGO
    s_sleep 16
    s_cmp_lg_u32 s3, 0
    s_cbranch_scc1 K_P2_YPOLL
K_P2_YGO:
    v_and_b32 v2, 15, v1
    v_lshlrev_b32 v2, 4, v2
    v_mul_u32_u24 v4, 5120, v9
    s_mov_b32 s59, s53
    s_mul_i32 s33, s59, 2560
    s_lshl_b32 s3, s41, 8
    s_add_u32 s3, s3, s33
    v_add3_u32 v3, v2, v4, s3
    s_mov_b32 s52, 0
    buffer_load_dwordx4 v[24:27], v3, s[44:47], s52 offen sc1
    s_mov_b32 s52, 20480
    buffer_load_dwordx4 v[28:31], v3, s[44:47], s52 offen sc1
    s_mov_b32 s52, 40960
    buffer_load_dwordx4 v[32:35], v3, s[44:47], s52 offen sc1
    s_mov_b32 s52, 61440
    buffer_load_dwordx4 v[36:39], v3, s[44:47], s52 offen sc1
    s_mov_b32 s52, 81920
    buffer_load_dwordx4 v[40:43], v3, s[44:47], s52 offen sc1
    s_mov_b32 s52, 102400
    buffer_load_dwordx4 v[44:47], v3, s[44:47], s52 offen sc1
    s_mov_b32 s52, 122880
    buffer_load_dwordx4 v[48:51], v3, s[44:47], s52 offen sc1
    s_mov_b32 s52, 143360
    buffer_load_dwordx4 v[52:55], v3, s[44:47], s52 offen sc1
    s_mov_b32 s52, 163840
    buffer_load_dwordx4 v[56:59], v3, s[44:47], s52 offen sc1
    s_mov_b32 s52, 184320
    buffer_load_dwordx4 v[60:63], v3, s[44:47], s52 offen sc1
    s_mov_b32 s52, 204800
    buffer_load_dwordx4 v[64:67], v3, s[44:47], s52 offen sc1
    s_mov_b32 s52, 225280
    buffer_load_dwordx4 v[68:71], v3, s[44:47], s52 offen sc1
    s_mov_b32 s52, 245760
    buffer_load_dwordx4 v[72:75], v3, s[44:47], s52 offen sc1
    s_mov_b32 s52, 266240
    buffer_load_dwordx4 v[76:79], v3, s[44:47], s52 offen sc1
    v_sub_f32 v88, 1.0, v88
    v_cvt_pk_bf16_f32 v88, v88, v88
    v_lshlrev_b32 v88, 16, v88
    v_lshlrev_b32 v86, 16, v85
    v_and_b32 v87, 0xffff0000, v85
    v_and_b32 v85, 0xffff0000, v84
    v_lshlrev_b32 v84, 16, v84
    s_waitcnt vmcnt(12)
    v_add_f32 v20, v24, v28
    v_add_f32 v21, v25, v29
    v_add_f32 v22, v26, v30
    v_add_f32 v23, v27, v31
    s_waitcnt vmcnt(11)
    v_add_f32 v20, v20, v32
    v_add_f32 v21, v21, v33
    v_add_f32 v22, v22, v34
    v_add_f32 v23, v23, v35
    s_waitcnt vmcnt(10)
    v_add_f32 v20, v20, v36
    v_add_f32 v21, v21, v37
    v_add_f32 v22, v22, v38
    v_add_f32 v23, v23, v39
    s_waitcnt vmcnt(9)
    v_add_f32 v20, v20, v40
    v_add_f32 v21, v21, v41
    v_add_f32 v22, v22, v42
    v_add_f32 v23, v23, v43
    s_waitcnt vmcnt(8)
    v_add_f32 v20, v20, v44
    v_add_f32 v21, v21, v45
    v_add_f32 v22, v22, v46
    v_add_f32 v23, v23, v47
    s_waitcnt vmcnt(7)
    v_add_f32 v20, v20, v48
    v_add_f32 v21, v21, v49
    v_add_f32 v22, v22, v50
    v_add_f32 v23, v23, v51
    s_waitcnt vmcnt(6)
    v_add_f32 v20, v20, v52
    v_add_f32 v21, v21, v53
    v_add_f32 v22, v22, v54
    v_add_f32 v23, v23, v55
    s_waitcnt vmcnt(5)
    v_add_f32 v20, v20, v56
    v_add_f32 v21, v21, v57
    v_add_f32 v22, v22, v58
    v_add_f32 v23, v23, v59
    s_waitcnt vmcnt(4)
    v_add_f32 v20, v20, v60
    v_add_f32 v21, v21, v61
    v_add_f32 v22, v22, v62
    v_add_f32 v23, v23, v63
    s_waitcnt vmcnt(3)
    v_add_f32 v20, v20, v64
    v_add_f32 v21, v21, v65
    v_add_f32 v22, v22, v66
    v_add_f32 v23, v23, v67
    s_waitcnt vmcnt(2)
    v_add_f32 v20, v20, v68
    v_add_f32 v21, v21, v69
    v_add_f32 v22, v22, v70
    v_add_f32 v23, v23, v71
    s_waitcnt vmcnt(1)
    v_add_f32 v20, v20, v72
    v_add_f32 v21, v21, v73
    v_add_f32 v22, v22, v74
    v_add_f32 v23, v23, v75
    s_waitcnt vmcnt(0)
    v_add_f32 v20, v20, v76
    v_add_f32 v21, v21, v77
    v_add_f32 v22, v22, v78
    v_add_f32 v23, v23, v79
    v_mov_b32 v24, v20
    v_mov_b32 v25, v21
    v_mov_b32 v26, v22
    v_mov_b32 v27, v23
    s_nop 0
    v_permlane16_swap_b32 v20, v24
    v_permlane16_swap_b32 v21, v25
    v_permlane16_swap_b32 v22, v26
    v_permlane16_swap_b32 v23, v27
    v_add_f32 v20, v20, v24
    v_add_f32 v21, v21, v25
    v_add_f32 v22, v22, v26
    v_add_f32 v23, v23, v27
    v_mov_b32 v24, v20
    v_mov_b32 v25, v21
    v_mov_b32 v26, v22
    v_mov_b32 v27, v23
    s_nop 0
    v_permlane32_swap_b32 v20, v24
    v_permlane32_swap_b32 v21, v25
    v_permlane32_swap_b32 v22, v26
    v_permlane32_swap_b32 v23, v27
    v_add_f32 v20, v20, v24
    v_add_f32 v21, v21, v25
    v_add_f32 v22, v22, v26
    v_add_f32 v23, v23, v27
    v_cvt_pk_bf16_f32 v20, v20, v20
    v_lshlrev_b32 v20, 16, v20
    v_mul_f32 v20, v5, v20
    v_cvt_pk_bf16_f32 v20, v20, v20
    v_lshlrev_b32 v20, 16, v20
    v_add_f32 v20, v20, v84
    v_cvt_pk_bf16_f32 v20, v20, v20
    v_lshlrev_b32 v20, 16, v20
    v_mul_f32 v20, v20, v88
    v_cvt_pk_bf16_f32 v21, v21, v21
    v_lshlrev_b32 v21, 16, v21
    v_mul_f32 v21, v5, v21
    v_cvt_pk_bf16_f32 v21, v21, v21
    v_lshlrev_b32 v21, 16, v21
    v_add_f32 v21, v21, v85
    v_cvt_pk_bf16_f32 v21, v21, v21
    v_lshlrev_b32 v21, 16, v21
    v_mul_f32 v21, v21, v88
    v_cvt_pk_bf16_f32 v22, v22, v22
    v_lshlrev_b32 v22, 16, v22
    v_mul_f32 v22, v5, v22
    v_cvt_pk_bf16_f32 v22, v22, v22
    v_lshlrev_b32 v22, 16, v22
    v_add_f32 v22, v22, v86
    v_cvt_pk_bf16_f32 v22, v22, v22
    v_lshlrev_b32 v22, 16, v22
    v_mul_f32 v22, v22, v88
    v_cvt_pk_bf16_f32 v23, v23, v23
    v_lshlrev_b32 v23, 16, v23
    v_mul_f32 v23, v5, v23
    v_cvt_pk_bf16_f32 v23, v23, v23
    v_lshlrev_b32 v23, 16, v23
    v_add_f32 v23, v23, v87
    v_cvt_pk_bf16_f32 v23, v23, v23
    v_lshlrev_b32 v23, 16, v23
    v_mul_f32 v23, v23, v88
    s_lshl_b32 s3, s59, 8
    s_add_u32 s3, s3, 158976
    v_add_u32 v2, s3, v2
    ds_write_b128 v2, v[20:23]
    s_lshl_b32 s3, s59, 2
    v_add_u32 v2, s3, v12
    ds_write_b32 v2, v80 offset:64
K_P2_YN:
    s_add_u32 s53, s53, 1
    s_cmp_lt_u32 s53, 2
    s_cbranch_scc1 K_P2_HW
    s_branch K_END
WP_flags:
    s_setpc_b64 s[38:39]
K_P2_FLAGS:
    s_mov_b32 exec_hi, 0
    s_waitcnt vmcnt(0)
    s_mov_b32 s3, 131072
K_P2_FCHK:
    v_cmp_eq_u32 vcc, 1, v7
    s_nop 1
    v_mov_b32 v2, vcc_lo
    ds_write_b32 v12, v2 offset:32
    s_cmp_eq_u32 vcc_lo, -1
    s_cbranch_scc1 K_P2_FGO
    s_cmp_lg_u32 vcc_lo, 0
    s_cbranch_scc1 K_P2_FS
    s_sleep 4
K_P2_FS:
    s_sleep 6
    global_load_dword v7, v10, s[10:11] sc1
    s_sub_u32 s3, s3, 1
    s_waitcnt vmcnt(0)
    s_cbranch_scc0 K_P2_FCHK
    v_mov_b32 v2, -1
    ds_write_b32 v12, v2 offset:32
K_P2_FGO:
    s_mov_b64 exec, -1
    s_branch K_END
.p2align 12
K_AUX:
    s_load_dwordx8 s[48:55], s[0:1], 32
    s_load_dwordx2 s[56:57], s[0:1], 64
    s_mul_i32 s44, s28, 7
    s_add_u32 s44, s44, s29
    s_sub_u32 s44, s44, 1
    s_cmp_lt_u32 s44, 54
    s_cselect_b32 s44, s44, 63
    s_cmp_eq_u32 s29, 0
    s_cselect_b32 s44, 63, s44
    s_lshl_b32 s74, s28, 8
    s_lshl_b32 s3, s29, 5
    s_add_u32 s74, s74, s3
    v_mov_b32 v12, 158720
    v_mov_b32 v13, 1
    s_cmp_lt_u32 s30, 4
    s_cbranch_scc1 K_AUX_LO
    s_lshl_b32 s3, s30, 3
    s_add_u32 s3, s3, s74
    s_sub_u32 s3, s3, 32
    v_lshrrev_b32 v9, 3, v1
    v_add_u32 v9, s3, v9
    v_and_b32 v11, 7, v1
    v_lshlrev_b32 v11, 4, v11
    v_mul_u32_u24 v10, 1280, v9
    v_add_u32 v10, v10, v11
    s_waitcnt lgkmcnt(0)
    buffer_load_dwordx4 v[16:19], v10, s[12:15], 0 offen offset:0
    buffer_load_dwordx4 v[20:23], v10, s[12:15], 0 offen offset:128
    buffer_load_dwordx4 v[24:27], v10, s[12:15], 0 offen offset:256
    buffer_load_dwordx4 v[28:31], v10, s[12:15], 0 offen offset:384
    buffer_load_dwordx4 v[32:35], v10, s[12:15], 0 offen offset:512
    buffer_load_dwordx4 v[36:39], v10, s[12:15], 0 offen offset:640
    buffer_load_dwordx4 v[40:43], v10, s[12:15], 0 offen offset:768
    buffer_load_dwordx4 v[44:47], v10, s[12:15], 0 offen offset:896
    buffer_load_dwordx4 v[48:51], v10, s[12:15], 0 offen offset:1024
    buffer_load_dwordx4 v[52:55], v10, s[12:15], 0 offen offset:1152
    s_mov_b32 s16, s48
    s_mov_b32 s17, s49
    s_mov_b32 s18, 0x500
    s_mov_b32 s19, 0x20000
    s_mov_b32 s20, s56
    s_mov_b32 s21, s57
    s_mov_b32 s22, 0x500
    s_mov_b32 s23, 0x20000
    buffer_load_dwordx4 v[56:59], v11, s[16:19], 0 offen offset:0
    buffer_load_dwordx4 v[60:63], v11, s[16:19], 0 offen offset:128
    buffer_load_dwordx4 v[64:67], v11, s[16:19], 0 offen offset:256
    buffer_load_dwordx4 v[68:71], v11, s[16:19], 0 offen offset:384
    buffer_load_dwordx4 v[72:75], v11, s[16:19], 0 offen offset:512
    buffer_load_dwordx4 v[76:79], v11, s[16:19], 0 offen offset:640
    buffer_load_dwordx4 v[80:83], v11, s[16:19], 0 offen offset:768
    buffer_load_dwordx4 v[84:87], v11, s[16:19], 0 offen offset:896
    buffer_load_dwordx4 v[88:91], v11, s[16:19], 0 offen offset:1024
    buffer_load_dwordx4 v[92:95], v11, s[16:19], 0 offen offset:1152
    buffer_load_dwordx4 v[96:99], v11, s[20:23], 0 offen offset:0
    buffer_load_dwordx4 v[100:103], v11, s[20:23], 0 offen offset:128
    buffer_load_dwordx4 v[104:107], v11, s[20:23], 0 offen offset:256
    buffer_load_dwordx4 v[108:111], v11, s[20:23], 0 offen offset:384
    buffer_load_dwordx4 v[112:115], v11, s[20:23], 0 offen offset:512
    buffer_load_dwordx4 v[116:119], v11, s[20:23], 0 offen offset:640
    buffer_load_dwordx4 v[120:123], v11, s[20:23], 0 offen offset:768
    buffer_load_dwordx4 v[124:127], v11, s[20:23], 0 offen offset:896
    buffer_load_dwordx4 v[128:131], v11, s[20:23], 0 offen offset:1024
    buffer_load_dwordx4 v[132:135], v11, s[20:23], 0 offen offset:1152
    s_barrier
    v_mov_b32 v180, 0
    v_mov_b32 v181, 0
    v_mov_b32 v182, 0
    v_mov_b32 v183, 0
    v_and_b32 v10, 31, v9
    v_lshlrev_b32 v10, 2, v10
    v_add_u32 v10, 122880, v10
    v_sub_u32 v4, 0x87ff, v9
    s_setprio 2
    s_waitcnt vmcnt(10)
    v_dot2c_f32_bf16 v180, v16, v56
    v_dot2c_f32_bf16 v181, v17, v57
    v_dot2c_f32_bf16 v180, v18, v58
    v_dot2c_f32_bf16 v181, v19, v59
    v_dot2c_f32_bf16 v180, v20, v60
    v_dot2c_f32_bf16 v181, v21, v61
    v_dot2c_f32_bf16 v180, v22, v62
    v_dot2c_f32_bf16 v181, v23, v63
    v_dot2c_f32_bf16 v180, v24, v64
    v_dot2c_f32_bf16 v181, v25, v65
    v_dot2c_f32_bf16 v180, v26, v66
    v_dot2c_f32_bf16 v181, v27, v67
    v_dot2c_f32_bf16 v180, v28, v68
    v_dot2c_f32_bf16 v181, v29, v69
    v_dot2c_f32_bf16 v180, v30, v70
    v_dot2c_f32_bf16 v181, v31, v71
    v_dot2c_f32_bf16 v180, v32, v72
    v_dot2c_f32_bf16 v181, v33, v73
    v_dot2c_f32_bf16 v180, v34, v74
    v_dot2c_f32_bf16 v181, v35, v75
    v_dot2c_f32_bf16 v180, v36, v76
    v_dot2c_f32_bf16 v181, v37, v77
    v_dot2c_f32_bf16 v180, v38, v78
    v_dot2c_f32_bf16 v181, v39, v79
    v_dot2c_f32_bf16 v180, v40, v80
    v_dot2c_f32_bf16 v181, v41, v81
    v_dot2c_f32_bf16 v180, v42, v82
    v_dot2c_f32_bf16 v181, v43, v83
    v_dot2c_f32_bf16 v180, v44, v84
    v_dot2c_f32_bf16 v181, v45, v85
    v_dot2c_f32_bf16 v180, v46, v86
    v_dot2c_f32_bf16 v181, v47, v87
    v_dot2c_f32_bf16 v180, v48, v88
    v_dot2c_f32_bf16 v181, v49, v89
    v_dot2c_f32_bf16 v180, v50, v90
    v_dot2c_f32_bf16 v181, v51, v91
    v_dot2c_f32_bf16 v180, v52, v92
    v_dot2c_f32_bf16 v181, v53, v93
    v_dot2c_f32_bf16 v180, v54, v94
    v_dot2c_f32_bf16 v181, v55, v95
    s_waitcnt vmcnt(0)
    v_dot2c_f32_bf16 v182, v16, v96
    v_dot2c_f32_bf16 v183, v17, v97
    v_dot2c_f32_bf16 v182, v18, v98
    v_dot2c_f32_bf16 v183, v19, v99
    v_dot2c_f32_bf16 v182, v20, v100
    v_dot2c_f32_bf16 v183, v21, v101
    v_dot2c_f32_bf16 v182, v22, v102
    v_dot2c_f32_bf16 v183, v23, v103
    v_dot2c_f32_bf16 v182, v24, v104
    v_dot2c_f32_bf16 v183, v25, v105
    v_dot2c_f32_bf16 v182, v26, v106
    v_dot2c_f32_bf16 v183, v27, v107
    v_dot2c_f32_bf16 v182, v28, v108
    v_dot2c_f32_bf16 v183, v29, v109
    v_dot2c_f32_bf16 v182, v30, v110
    v_dot2c_f32_bf16 v183, v31, v111
    v_dot2c_f32_bf16 v182, v32, v112
    v_dot2c_f32_bf16 v183, v33, v113
    v_dot2c_f32_bf16 v182, v34, v114
    v_dot2c_f32_bf16 v183, v35, v115
    v_dot2c_f32_bf16 v182, v36, v116
    v_dot2c_f32_bf16 v183, v37, v117
    v_dot2c_f32_bf16 v182, v38, v118
    v_dot2c_f32_bf16 v183, v39, v119
    v_dot2c_f32_bf16 v182, v40, v120
    v_dot2c_f32_bf16 v183, v41, v121
    v_dot2c_f32_bf16 v182, v42, v122
    v_dot2c_f32_bf16 v183, v43, v123
    v_dot2c_f32_bf16 v182, v44, v124
    v_dot2c_f32_bf16 v183, v45, v125
    v_dot2c_f32_bf16 v182, v46, v126
    v_dot2c_f32_bf16 v183, v47, v127
    v_dot2c_f32_bf16 v182, v48, v128
    v_dot2c_f32_bf16 v183, v49, v129
    v_dot2c_f32_bf16 v182, v50, v130
    v_dot2c_f32_bf16 v183, v51, v131
    v_dot2c_f32_bf16 v182, v52, v132
    v_dot2c_f32_bf16 v183, v53, v133
    v_dot2c_f32_bf16 v182, v54, v134
    v_dot2c_f32_bf16 v183, v55, v135
    s_nop 2
    v_add_f32 v180, v180, v181
    v_add_f32 v182, v182, v183
    s_nop 0
    v_add_f32_dpp v180, v180, v180 quad_perm:[1,0,3,2] row_mask:0xf bank_mask:0xf
    v_add_f32_dpp v182, v182, v182 quad_perm:[1,0,3,2] row_mask:0xf bank_mask:0xf
    s_nop 0
    v_add_f32_dpp v180, v180, v180 quad_perm:[2,3,0,1] row_mask:0xf bank_mask:0xf
    v_add_f32_dpp v182, v182, v182 quad_perm:[2,3,0,1] row_mask:0xf bank_mask:0xf
    s_nop 0
    v_add_f32_dpp v180, v180, v180 row_half_mirror row_mask:0xf bank_mask:0xf
    v_add_f32_dpp v182, v182, v182 row_half_mirror row_mask:0xf bank_mask:0xf
    v_cvt_pk_bf16_f32 v2, v180, v180
    v_lshlrev_b32 v2, 16, v2
    v_ashrrev_i32 v3, 31, v2
    v_or_b32 v3, 0x80000000, v3
    v_xor_b32 v2, v2, v3
    v_and_b32 v2, 0xffff0000, v2
    v_or_b32 v2, v2, v4
    ds_write2_b32 v10, v2, v182 offset0:0 offset1:32
    s_mov_b64 exec, 1
    ds_add_u32 v12, v13 offset:36
    s_mov_b64 exec, -1
    s_setprio 0
    s_cmp_lg_u32 s30, 4
    s_cbranch_scc1 K_WARMA0
    s_call_b64 s[38:39], WP_p2g
    s_branch K_WARMAX
K_WARMA0:
    s_cmp_lg_u32 s30, 5
    s_cbranch_scc1 K_WARMA1
    s_call_b64 s[38:39], WP_gen
    s_branch K_WARMAX
K_WARMA1:
    s_cmp_lg_u32 s30, 6
    s_cbranch_scc1 K_WARMA2
    s_call_b64 s[38:39], WP_help
    s_call_b64 s[38:39], WP_flags
    s_branch K_WARMAX
K_WARMA2:
    s_call_b64 s[38:39], WP_spin
K_WARMAX:
    s_cmp_ge_u32 s30, 6
    s_cselect_b32 s44, 63, s44
    s_cmp_lg_u32 s44, 63
    s_cbranch_scc1 K_FFN_C
    s_mov_b32 s3, 1048576
K_FGH:
    ds_read_b32 v2, v12 offset:48
    s_sleep 8
    s_sub_u32 s3, s3, 1
    s_waitcnt lgkmcnt(0)
    v_readfirstlane_b32 s33, v2
    s_nop 3
    s_cselect_b32 s33, 1, s33
    s_cmp_lt_u32 s33, 1
    s_cbranch_scc1 K_FGH
    s_cmp_eq_u32 s30, 6
    s_cbranch_scc1 K_P2_HELP
    v_mov_b32 v7, 1
    s_branch K_P2_HELP
K_AUX_LO:
    s_waitcnt lgkmcnt(0)
    s_cmp_eq_u32 s30, 0
    s_cbranch_scc1 K_AUX_PUB
    s_cmp_eq_u32 s44, 63
    s_cbranch_scc1 K_AUX_NOF
    s_and_b32 s3, s44, 1
    s_cmp_eq_u32 s3, 0
    s_cselect_b64 s[60:61], s[50:51], s[52:53]
    s_cselect_b64 s[64:65], s[52:53], s[50:51]
    s_cselect_b32 s75, 0, 40960
    s_mov_b32 s62, 0x21c000
    s_mov_b32 s63, 0x20000
    s_mov_b32 s66, 0x21c000
    s_mov_b32 s67, 0x20000
    v_lshrrev_b32 v2, 2, v1
    v_mul_u32_u24 v184, 3456, v2
    v_and_b32 v2, 3, v1
    v_lshl_add_u32 v184, v2, 4, v184
    s_lshl_b32 s72, s44, 6
    v_add_u32 v184, s72, v184
    s_sub_u32 s74, s30, 1
K_FSA0:
    s_lshl_b32 s73, s74, 10
    s_mul_i32 s72, s74, 55296
    s_add_u32 m0, s73, s75
    s_waitcnt vmcnt(7)
    buffer_load_dwordx4 v184, s[60:63], s72 offen lds
    s_add_u32 s74, s74, 3
    s_cmp_lt_u32 s74, 24
    s_cbranch_scc1 K_FSA0
    s_barrier
    s_mov_b32 s3, 1048576
K_FGPB:
    ds_read_b32 v2, v12 offset:36
    s_sleep 1
    s_sub_u32 s3, s3, 1
    s_waitcnt lgkmcnt(0)
    v_readfirstlane_b32 s33, v2
    s_nop 3
    s_cselect_b32 s33, 5, s33
    s_cmp_lt_u32 s33, 5
    s_cbranch_scc1 K_FGPB
K_FSA:
    s_lshl_b32 s73, s74, 10
    s_mul_i32 s72, s74, 55296
    s_add_u32 m0, s73, s75
    s_waitcnt vmcnt(7)
    buffer_load_dwordx4 v184, s[60:63], s72 offen lds
    s_add_u32 s74, s74, 3
    s_cmp_lt_u32 s74, 40
    s_cbranch_scc1 K_FSA
    s_sub_u32 s74, s74, 40
    s_xor_b32 s75, s75, 40960
    s_mov_b32 s68, s54
    s_mov_b32 s69, s55
    s_mov_b32 s70, 0x21c000
    s_mov_b32 s71, 0x20000
    s_mul_i32 s3, s44, 40960
    v_lshrrev_b32 v2, 3, v1
    v_mul_u32_u24 v2, 1280, v2
    v_lshrrev_b32 v3, 4, v1
    v_lshlrev_b32 v3, 1, v3
    v_and_b32 v4, 7, v1
    v_xor_b32 v3, v3, v4
    v_lshl_add_u32 v2, v3, 4, v2
    v_add_u32 v185, s3, v2
K_FSB:
    s_lshl_b32 s73, s74, 10
    s_mul_i32 s72, s74, 55296
    s_add_u32 m0, s73, s75
    s_waitcnt vmcnt(7)
    buffer_load_dwordx4 v184, s[64:67], s72 offen lds
    s_add_u32 s74, s74, 3
    s_cmp_lt_u32 s74, 40
    s_cbranch_scc1 K_FSB
    s_sub_u32 s74, s74, 40
    s_mov_b32 s75, 81920
K_FSD0:
    s_lshl_b32 s73, s74, 10
    s_and_b32 s72, s74, 3
    s_mul_i32 s72, s72, 10208
    s_lshl_b32 s3, s74, 5
    s_add_u32 s72, s72, s3
    s_add_u32 m0, s73, s75
    s_waitcnt vmcnt(7)
    buffer_load_dwordx4 v185, s[68:71], s72 offen lds
    s_add_u32 s74, s74, 3
    s_cmp_lt_u32 s74, 24
    s_cbranch_scc1 K_FSD0
    s_waitcnt vmcnt(8)
    s_mov_b64 exec, 1
    ds_add_u32 v12, v13 offset:56
    s_mov_b64 exec, -1
K_FSD:
    s_lshl_b32 s73, s74, 10
    s_and_b32 s72, s74, 3
    s_mul_i32 s72, s72, 10208
    s_lshl_b32 s3, s74, 5
    s_add_u32 s72, s72, s3
    s_add_u32 m0, s73, s75
    s_waitcnt vmcnt(7)
    buffer_load_dwordx4 v185, s[68:71], s72 offen lds
    s_add_u32 s74, s74, 3
    s_cmp_lt_u32 s74, 40
    s_cbranch_scc1 K_FSD
    s_mul_i32 s3, s29, 96
    s_lshl_b32 s72, s30, 5
    s_add_u32 s3, s3, s72
    s_sub_u32 s3, s3, 128
    v_lshrrev_b32 v2, 1, v1
    v_add_u32 v2, s3, v2
    v_mul_u32_u24 v2, 1280, v2
    v_and_b32 v3, 1, v1
    v_lshl_add_u32 v2, v3, 7, v2
    buffer_load_dword v6, v2, s[24:27], 0 offen offset:1024
K_AUX_WR:
    s_mov_b32 s3, 1048576
K_FGR:
    ds_read_b32 v2, v12 offset:60
    s_sleep 2
    s_sub_u32 s3, s3, 1
    s_waitcnt lgkmcnt(0)
    v_readfirstlane_b32 s33, v2
    s_nop 3
    s_cselect_b32 s33, 2, s33
    s_cmp_lt_u32 s33, 2
    s_cbranch_scc1 K_FGR
    s_branch K_P2
K_AUX_NOF:
    s_cmp_lg_u32 s2, 63
    s_cbranch_scc1 K_AUX_NOZ
    s_cmp_lg_u32 s30, 1
    s_cbranch_scc1 K_AUX_NOZ
    s_add_u32 s60, s10, 0x80000
    s_addc_u32 s61, s11, 0
    s_mov_b32 s62, 0xc000
    s_mov_b32 s63, 0x20000
    v_mov_b32 v9, 786432
    global_load_dword v10, v9, s[10:11] sc1
    v_lshlrev_b32 v11, 4, v1
    v_add_u32 v11, 790528, v11
    global_load_dword v6, v11, s[10:11] sc1
    s_barrier
    s_mov_b32 s3, 1048576
K_FGZ:
    ds_read_b32 v2, v12 offset:36
    s_sleep 2
    s_sub_u32 s3, s3, 1
    s_waitcnt lgkmcnt(0)
    v_readfirstlane_b32 s33, v2
    s_nop 3
    s_cselect_b32 s33, 4, s33
    s_cmp_lt_u32 s33, 4
    s_cbranch_scc1 K_FGZ
    v_and_b32 v4, 7, v1
    v_lshlrev_b32 v4, 2, v4
    global_load_dword v7, v4, s[8:9] offset:192 sc1
    s_waitcnt vmcnt(1)
    v_add_u32 v10, 1, v10
    s_mov_b32 s3, 131072
    s_setprio 3
K_AG2_POLL:
    global_load_dwordx4 v[16:19], v11, s[10:11] sc1
    s_waitcnt vmcnt(0)
    v_xor_b32 v2, v10, v17
    v_xor_b32 v3, v10, v19
    v_or_b32 v2, v2, v3
    v_cmp_ne_u32 vcc, 0, v2
    s_cbranch_vccz K_AG2_GOT
    s_sleep 2
    s_sub_u32 s3, s3, 1
    s_cmp_lg_u32 s3, 0
    s_cbranch_scc1 K_AG2_POLL
K_AG2_GOT:
    s_nop 1
    v_max_u32_dpp v3, v16, v16 quad_perm:[1,0,3,2] row_mask:0xf bank_mask:0xf
    s_nop 1
    v_max_u32_dpp v3, v3, v3 quad_perm:[2,3,0,1] row_mask:0xf bank_mask:0xf
    s_nop 1
    v_max_u32_dpp v3, v3, v3 row_half_mirror row_mask:0xf bank_mask:0xf
    s_nop 1
    v_max_u32_dpp v3, v3, v3 row_mirror row_mask:0xf bank_mask:0xf
    s_nop 1
    v_readlane_b32 s74, v3, 0
    v_readlane_b32 s76, v3, 16
    v_readlane_b32 s77, v3, 32
    v_readlane_b32 s78, v3, 48
    s_nop 3
    s_max_u32 s74, s74, s76
    s_max_u32 s77, s77, s78
    s_max_u32 s74, s74, s77
    v_cmp_ne_u32 vcc, s74, v16
    s_nop 1
    v_cndmask_b32 v2, v18, v16, vcc
    s_nop 1
    v_max_u32_dpp v3, v2, v2 quad_perm:[1,0,3,2] row_mask:0xf bank_mask:0xf
    s_nop 1
    v_max_u32_dpp v3, v3, v3 quad_perm:[2,3,0,1] row_mask:0xf bank_mask:0xf
    s_nop 1
    v_max_u32_dpp v3, v3, v3 row_half_mirror row_mask:0xf bank_mask:0xf
    s_nop 1
    v_max_u32_dpp v3, v3, v3 row_mirror row_mask:0xf bank_mask:0xf
    s_nop 1
    v_readlane_b32 s75, v3, 0
    v_readlane_b32 s76, v3, 16
    v_readlane_b32 s77, v3, 32
    v_readlane_b32 s78, v3, 48
    s_nop 3
    s_max_u32 s75, s75, s76
    s_max_u32 s77, s77, s78
    s_max_u32 s75, s75, s77
    v_mov_b32 v176, s74
    v_mov_b32 v177, s75
    v_and_b32 v4, 7, v1
    v_lshlrev_b32 v4, 2, v4
    s_mov_b32 s3, 131072
K_ZPOLL4:
    v_cmp_eq_u32 vcc, 0, v7
    s_cbranch_vccz K_ZOK4
    s_sub_u32 s3, s3, 1
    s_cbranch_scc1 K_ZOK4
    global_load_dword v7, v4, s[8:9] offset:192 sc1
    s_waitcnt vmcnt(0)
    s_branch K_ZPOLL4
K_ZOK4:
    v_and_b32 v2, 7, v1
    v_mul_u32_u24 v2, 20, v2
    v_lshrrev_b32 v3, 3, v1
    v_add_lshl_u32 v2, v2, v3, 8
    buffer_store_dwordx2 v[176:177], v2, s[60:63], 0 offen offset:136 sc1
    s_mov_b64 exec, 1
    global_store_dword v9, v10, s[10:11] sc1
    s_mov_b64 exec, -1
    v_lshlrev_b32 v4, 2, v1
    s_mov_b32 s72, 43008
    s_mov_b32 s3, 131072
K_AGG_POLL:
    s_sleep 8
    buffer_load_dword v2, v4, s[60:63], s72 offen sc1
    s_waitcnt vmcnt(0)
    v_cmp_eq_u32 vcc, 0, v2
    s_cbranch_vccz K_AGG_GOT
    s_sub_u32 s3, s3, 1
    s_cmp_lg_u32 s3, 0
    s_cbranch_scc1 K_AGG_POLL
K_AGG_GOT:
    s_mov_b32 s62, 40960
    v_lshlrev_b32 v3, 8, v1
    s_mov_b32 s3, 0
    buffer_store_dwordx2 v[176:177], v3, s[60:63], s3 offen offset:128 sc1
    s_mov_b32 s3, 16384
    buffer_store_dwordx2 v[176:177], v3, s[60:63], s3 offen offset:128 sc1
    s_mov_b32 s3, 32768
    buffer_store_dwordx2 v[176:177], v3, s[60:63], s3 offen offset:128 sc1
    s_setprio 0
    s_branch K_AUX_NOK
K_AUX_NOZ:
    s_barrier
K_AUX_NOK:
    s_mov_b32 s3, 1048576
K_FGWD:
    ds_read_b32 v2, v12 offset:48
    s_sleep 4
    s_sub_u32 s3, s3, 1
    s_waitcnt lgkmcnt(0)
    v_readfirstlane_b32 s33, v2
    s_nop 3
    s_cselect_b32 s33, 1, s33
    s_cmp_lt_u32 s33, 1
    s_cbranch_scc1 K_FGWD
    s_branch K_P2
K_AUX_PUB:
    s_add_u32 s60, s10, 0x1000
    s_addc_u32 s61, s11, 0
    s_mov_b32 s62, 0x2000
    s_mov_b32 s63, 0x20000
    v_and_b32 v3, 31, v1
    v_lshlrev_b32 v10, 2, v3
    v_add_u32 v11, 122880, v10
    s_lshl_b32 s72, s74, 2
    v_mov_b32 v2, 786432
    global_load_dword v17, v2, s[10:11] sc1
    s_lshl_b32 s3, s2, 2
    s_add_u32 s3, s3, 567296
    v_mov_b32 v9, s3
    s_lshl_b32 s3, s2, 4
    s_add_u32 s3, s3, 790528
    v_lshl_add_u32 v20, v1, 4, s3
    v_and_b32 v5, 7, v1
    v_lshlrev_b32 v5, 2, v5
    s_barrier
    s_setprio 3
    s_waitcnt vmcnt(0)
    v_add_u32 v17, 1, v17
    v_mov_b32 v19, v17
    s_mov_b32 s3, 1048576
K_FGRT:
    ds_read_b32 v2, v12 offset:36
    s_sleep 0
    s_sub_u32 s3, s3, 1
    s_waitcnt lgkmcnt(0)
    v_readfirstlane_b32 s33, v2
    s_nop 3
    s_cselect_b32 s33, 4, s33
    s_cmp_lt_u32 s33, 4
    s_cbranch_scc1 K_FGRT
    ds_read2_b32 v[176:177], v11 offset0:0 offset1:32
    s_waitcnt lgkmcnt(0)
    s_nop 1
    v_max_u32_dpp v3, v176, v176 quad_perm:[1,0,3,2] row_mask:0xf bank_mask:0xf
    s_nop 1
    v_max_u32_dpp v3, v3, v3 quad_perm:[2,3,0,1] row_mask:0xf bank_mask:0xf
    s_nop 1
    v_max_u32_dpp v3, v3, v3 row_half_mirror row_mask:0xf bank_mask:0xf
    s_nop 1
    v_max_u32_dpp v3, v3, v3 row_mirror row_mask:0xf bank_mask:0xf
    s_nop 1
    v_readlane_b32 s74, v3, 0
    v_readlane_b32 s76, v3, 16
    v_readlane_b32 s77, v3, 32
    v_readlane_b32 s78, v3, 48
    s_nop 3
    s_max_u32 s74, s74, s76
    s_max_u32 s77, s77, s78
    s_max_u32 s74, s74, s77
    v_cmp_ne_u32 vcc, s74, v176
    s_nop 1
    v_cndmask_b32 v176, 0, v176, vcc
    s_nop 1
    v_max_u32_dpp v3, v176, v176 quad_perm:[1,0,3,2] row_mask:0xf bank_mask:0xf
    s_nop 1
    v_max_u32_dpp v3, v3, v3 quad_perm:[2,3,0,1] row_mask:0xf bank_mask:0xf
    s_nop 1
    v_max_u32_dpp v3, v3, v3 row_half_mirror row_mask:0xf bank_mask:0xf
    s_nop 1
    v_max_u32_dpp v3, v3, v3 row_mirror row_mask:0xf bank_mask:0xf
    s_nop 1
    v_readlane_b32 s75, v3, 0
    v_readlane_b32 s76, v3, 16
    v_readlane_b32 s77, v3, 32
    v_readlane_b32 s78, v3, 48
    s_nop 3
    s_max_u32 s75, s75, s76
    s_max_u32 s77, s77, s78
    s_max_u32 s75, s75, s77
    v_mov_b32 v16, s74
    v_mov_b32 v18, s75
    s_mov_b64 exec, 1
    global_store_dwordx4 v20, v[16:19], s[10:11] sc1
    s_mov_b64 exec, -1
    s_mov_b64 exec, 1
    ds_add_u32 v12, v13 offset:36
    s_mov_b64 exec, -1
    global_load_dword v7, v5, s[8:9] offset:192 sc1
    v_cvt_pk_bf16_f32 v177, v177, v177
    v_lshlrev_b32 v177, 16, v177
    v_mul_f32 v3, 0xbfb8aa3b, v177
    v_exp_f32 v3, v3
    s_nop 0
    v_add_f32 v3, 1.0, v3
    v_rcp_f32 v177, v3
    s_nop 0
    v_cvt_pk_bf16_f32 v177, v177, v177
    v_lshlrev_b32 v177, 16, v177
    s_mov_b32 exec_hi, 0
    buffer_store_dword v177, v10, s[60:63], s72 offen sc1
    s_mov_b64 exec, -1
    s_waitcnt vmcnt(0)
    v_and_b32 v4, 7, v1
    v_lshlrev_b32 v4, 2, v4
    s_mov_b32 s3, 131072
K_ZPOLL3:
    v_cmp_eq_u32 vcc, 0, v7
    s_cbranch_vccz K_ZOK3
    s_sub_u32 s3, s3, 1
    s_cbranch_scc1 K_ZOK3
    global_load_dword v7, v4, s[8:9] offset:192 sc1
    s_waitcnt vmcnt(0)
    s_branch K_ZPOLL3
K_ZOK3:
    s_mov_b64 exec, 1
    global_store_dword v9, v13, s[10:11] sc1
    s_mov_b64 exec, -1
    v_and_b32 v3, 1, v1
    v_lshl_add_u32 v3, v3, 2, s42
    v_lshlrev_b32 v10, 4, v1
    s_mov_b32 s3, 131072
K_AUX_POLL:
    s_sleep 6
    global_load_dword v2, v3, s[10:11] offset:136 sc1
    s_waitcnt vmcnt(0)
    v_cmp_eq_u32 vcc, 0, v2
    s_cbranch_vccz K_AUX_GOT
    s_sub_u32 s3, s3, 1
    s_cmp_lg_u32 s3, 0
    s_cbranch_scc1 K_AUX_POLL
K_AUX_GOT:
    v_readlane_b32 s74, v2, 0
    v_readlane_b32 s75, v2, 1
    s_nop 3
    s_and_b32 s74, s74, 0x7ff
    s_sub_u32 s74, 2047, s74
    s_mul_i32 s74, s74, 1280
    s_mov_b32 m0, 125184
    s_nop 0
    buffer_load_dwordx4 v10, s[12:15], s74 offen lds
    s_mov_b64 exec, 0xffff
    buffer_load_dwordx4 v10, s[12:15], s74 offen offset:1024 lds
    s_mov_b64 exec, -1
    s_and_b32 s75, s75, 0x7ff
    s_sub_u32 s75, 2047, s75
    s_mul_i32 s75, s75, 1280
    s_mov_b32 m0, 126528
    s_nop 0
    buffer_load_dwordx4 v10, s[12:15], s75 offen lds
    s_mov_b64 exec, 0xffff
    buffer_load_dwordx4 v10, s[12:15], s75 offen offset:1024 lds
    s_mov_b64 exec, -1
    s_waitcnt vmcnt(0)
    ds_write_b32 v12, v13 offset:48
    s_setprio 0
    s_branch K_P2
.p2align 12
K_FFN_C:
    s_add_u32 s64, s10, 0x10000
    s_addc_u32 s65, s11, 0
    s_mov_b32 s66, 0x43800
    s_mov_b32 s67, 0x20000
    s_and_b32 s73, s30, 1
    v_lshrrev_b32 v232, 4, v1
    v_bfe_u32 v4, v1, 2, 2
    v_lshl_add_u32 v2, v232, 3, v4
    v_and_b32 v3, 3, v1
    v_lshlrev_b32 v3, 3, v3
    v_lshl_add_u32 v233, v2, 6, v3
    s_lshl_b32 s72, s73, 5
    v_add_u32 v233, s72, v233
    v_lshl_add_u32 v2, v232, 2, v4
    v_bfe_u32 v4, v2, 1, 2
    v_lshl_add_u32 v3, v2, 7, v3
    v_lshl_add_u32 v3, v4, 5, v3
    s_mul_i32 s3, s73, 20480
    s_add_u32 s3, s3, 81920
    v_add_u32 v238, s3, v3
    v_xor_b32 v239, 32, v238
    v_xor_b32 v240, 64, v238
    v_xor_b32 v241, 96, v238
    v_and_b32 v2, 1, v1
    v_mul_u32_u24 v234, 1344, v2
    v_lshl_add_u32 v234, v232, 4, v234
    v_add_u32 v234, 125184, v234
    v_lshlrev_b32 v236, 4, v1
    v_add_u32 v236, 124160, v236
    s_lshl_b32 s3, s73, 3
    v_add_u32 v235, s3, v236
    v_mul_u32_u24 v2, 2560, v2
    v_lshl_add_u32 v237, v232, 4, v2
    s_mul_i32 s3, s44, 5120
    s_mul_i32 s72, s73, 1280
    s_add_u32 s72, s72, s3
    v_lshlrev_b32 v2, 4, v1
    buffer_store_dwordx4 v[16:19], v2, s[64:67], s72 offen offset:0 sc1
    buffer_store_dwordx4 v[16:19], v2, s[64:67], s72 offen offset:2560 sc1
    s_mov_b64 exec, 0xffff
    buffer_store_dwordx4 v[16:19], v2, s[64:67], s72 offen offset:1024 sc1
    buffer_store_dwordx4 v[16:19], v2, s[64:67], s72 offen offset:3584 sc1
    s_mov_b64 exec, -1
    v_add_u32 v5, 40960, v233
    s_mov_b32 s3, 1048576
K_FGD:
    ds_read_b32 v2, v12 offset:56
    s_sleep 2
    s_sub_u32 s3, s3, 1
    s_waitcnt lgkmcnt(0)
    v_readfirstlane_b32 s33, v2
    s_nop 3
    s_cselect_b32 s33, 3, s33
    s_cmp_lt_u32 s33, 3
    s_cbranch_scc1 K_FGD
    s_setprio 3
    ds_read_b64_tr_b16 v[16:17], v233 offset:0
    ds_read_b64_tr_b16 v[18:19], v233 offset:256
    ds_read_b64_tr_b16 v[20:21], v233 offset:2048
    ds_read_b64_tr_b16 v[22:23], v233 offset:2304
    ds_read_b64_tr_b16 v[24:25], v233 offset:4096
    ds_read_b64_tr_b16 v[26:27], v233 offset:4352
    ds_read_b64_tr_b16 v[28:29], v233 offset:6144
    ds_read_b64_tr_b16 v[30:31], v233 offset:6400
    ds_read_b64_tr_b16 v[32:33], v233 offset:8192
    ds_read_b64_tr_b16 v[34:35], v233 offset:8448
    ds_read_b64_tr_b16 v[36:37], v233 offset:10240
    ds_read_b64_tr_b16 v[38:39], v233 offset:10496
    ds_read_b64_tr_b16 v[40:41], v233 offset:12288
    ds_read_b64_tr_b16 v[42:43], v233 offset:12544
    ds_read_b64_tr_b16 v[44:45], v233 offset:14336
    ds_read_b64_tr_b16 v[46:47], v233 offset:14592
    ds_read_b64_tr_b16 v[48:49], v233 offset:16384
    ds_read_b64_tr_b16 v[50:51], v233 offset:16640
    ds_read_b64_tr_b16 v[52:53], v233 offset:18432
    ds_read_b64_tr_b16 v[54:55], v233 offset:18688
    ds_read_b64_tr_b16 v[56:57], v233 offset:20480
    ds_read_b64_tr_b16 v[58:59], v233 offset:20736
    ds_read_b64_tr_b16 v[60:61], v233 offset:22528
    ds_read_b64_tr_b16 v[62:63], v233 offset:22784
    ds_read_b64_tr_b16 v[64:65], v233 offset:24576
    ds_read_b64_tr_b16 v[66:67], v233 offset:24832
    ds_read_b64_tr_b16 v[68:69], v233 offset:26624
    ds_read_b64_tr_b16 v[70:71], v233 offset:26880
    ds_read_b64_tr_b16 v[72:73], v233 offset:28672
    ds_read_b64_tr_b16 v[74:75], v233 offset:28928
    ds_read_b64_tr_b16 v[76:77], v233 offset:30720
    ds_read_b64_tr_b16 v[78:79], v233 offset:30976
    ds_read_b64_tr_b16 v[80:81], v233 offset:32768
    ds_read_b64_tr_b16 v[82:83], v233 offset:33024
    ds_read_b64_tr_b16 v[84:85], v233 offset:34816
    ds_read_b64_tr_b16 v[86:87], v233 offset:35072
    ds_read_b64_tr_b16 v[88:89], v233 offset:36864
    ds_read_b64_tr_b16 v[90:91], v233 offset:37120
    ds_read_b64_tr_b16 v[92:93], v233 offset:38912
    ds_read_b64_tr_b16 v[94:95], v233 offset:39168
    ds_read_b64_tr_b16 v[96:97], v5 offset:0
    ds_read_b64_tr_b16 v[98:99], v5 offset:256
    ds_read_b64_tr_b16 v[100:101], v5 offset:2048
    ds_read_b64_tr_b16 v[102:103], v5 offset:2304
    ds_read_b64_tr_b16 v[104:105], v5 offset:4096
    ds_read_b64_tr_b16 v[106:107], v5 offset:4352
    ds_read_b64_tr_b16 v[108:109], v5 offset:6144
    ds_read_b64_tr_b16 v[110:111], v5 offset:6400
    ds_read_b64_tr_b16 v[112:113], v5 offset:8192
    ds_read_b64_tr_b16 v[114:115], v5 offset:8448
    ds_read_b64_tr_b16 v[116:117], v5 offset:10240
    ds_read_b64_tr_b16 v[118:119], v5 offset:10496
    ds_read_b64_tr_b16 v[120:121], v5 offset:12288
    ds_read_b64_tr_b16 v[122:123], v5 offset:12544
    ds_read_b64_tr_b16 v[124:125], v5 offset:14336
    ds_read_b64_tr_b16 v[126:127], v5 offset:14592
    ds_read_b64_tr_b16 v[128:129], v5 offset:16384
    ds_read_b64_tr_b16 v[130:131], v5 offset:16640
    ds_read_b64_tr_b16 v[132:133], v5 offset:18432
    ds_read_b64_tr_b16 v[134:135], v5 offset:18688
    ds_read_b64_tr_b16 v[136:137], v5 offset:20480
    ds_read_b64_tr_b16 v[138:139], v5 offset:20736
    ds_read_b64_tr_b16 v[140:141], v5 offset:22528
    ds_read_b64_tr_b16 v[142:143], v5 offset:22784
    ds_read_b64_tr_b16 v[144:145], v5 offset:24576
    ds_read_b64_tr_b16 v[146:147], v5 offset:24832
    ds_read_b64_tr_b16 v[148:149], v5 offset:26624
    ds_read_b64_tr_b16 v[150:151], v5 offset:26880
    ds_read_b64_tr_b16 v[152:153], v5 offset:28672
    ds_read_b64_tr_b16 v[154:155], v5 offset:28928
    ds_read_b64_tr_b16 v[156:157], v5 offset:30720
    ds_read_b64_tr_b16 v[158:159], v5 offset:30976
    ds_read_b64_tr_b16 v[160:161], v5 offset:32768
    ds_read_b64_tr_b16 v[162:163], v5 offset:33024
    ds_read_b64_tr_b16 v[164:165], v5 offset:34816
    ds_read_b64_tr_b16 v[166:167], v5 offset:35072
    ds_read_b64_tr_b16 v[168:169], v5 offset:36864
    ds_read_b64_tr_b16 v[170:171], v5 offset:37120
    ds_read_b64_tr_b16 v[172:173], v5 offset:38912
    ds_read_b64_tr_b16 v[174:175], v5 offset:39168
    s_waitcnt vmcnt(0) lgkmcnt(0)
    s_mov_b64 exec, 1
    ds_add_u32 v12, v13 offset:60
    s_mov_b64 exec, -1
    s_mov_b32 s3, 1048576
K_FGK:
    ds_read_b32 v2, v12 offset:48
    s_sleep 1
    s_sub_u32 s3, s3, 1
    s_waitcnt lgkmcnt(0)
    v_readfirstlane_b32 s33, v2
    s_nop 3
    s_cselect_b32 s33, 1, s33
    s_cmp_lt_u32 s33, 1
    s_cbranch_scc1 K_FGK
    ds_read_b128 v[188:191], v234 offset:0
    ds_read_b128 v[192:195], v234 offset:64
    ds_read_b128 v[196:199], v234 offset:128
    ds_read_b128 v[200:203], v234 offset:192
    ds_read_b128 v[204:207], v234 offset:256
    ds_read_b128 v[208:211], v234 offset:320
    ds_read_b128 v[212:215], v234 offset:384
    ds_read_b128 v[216:219], v234 offset:448
    s_waitcnt lgkmcnt(7)
    v_mfma_f32_16x16x32_bf16 v[220:223], v[16:19], v[188:191], 0
    v_mfma_f32_16x16x32_bf16 v[224:227], v[96:99], v[188:191], 0
    ds_read_b128 v[188:191], v234 offset:512
    s_waitcnt lgkmcnt(7)
    v_mfma_f32_16x16x32_bf16 v[220:223], v[20:23], v[192:195], v[220:223]
    v_mfma_f32_16x16x32_bf16 v[224:227], v[100:103], v[192:195], v[224:227]
    ds_read_b128 v[192:195], v234 offset:576
    s_waitcnt lgkmcnt(7)
    v_mfma_f32_16x16x32_bf16 v[220:223], v[24:27], v[196:199], v[220:223]
    v_mfma_f32_16x16x32_bf16 v[224:227], v[104:107], v[196:199], v[224:227]
    ds_read_b128 v[196:199], v234 offset:640
    s_waitcnt lgkmcnt(7)
    v_mfma_f32_16x16x32_bf16 v[220:223], v[28:31], v[200:203], v[220:223]
    v_mfma_f32_16x16x32_bf16 v[224:227], v[108:111], v[200:203], v[224:227]
    ds_read_b128 v[200:203], v234 offset:704
    s_waitcnt lgkmcnt(7)
    v_mfma_f32_16x16x32_bf16 v[220:223], v[32:35], v[204:207], v[220:223]
    v_mfma_f32_16x16x32_bf16 v[224:227], v[112:115], v[204:207], v[224:227]
    ds_read_b128 v[204:207], v234 offset:768
    s_waitcnt lgkmcnt(7)
    v_mfma_f32_16x16x32_bf16 v[220:223], v[36:39], v[208:211], v[220:223]
    v_mfma_f32_16x16x32_bf16 v[224:227], v[116:119], v[208:211], v[224:227]
    ds_read_b128 v[208:211], v234 offset:832
    s_waitcnt lgkmcnt(7)
    v_mfma_f32_16x16x32_bf16 v[220:223], v[40:43], v[212:215], v[220:223]
    v_mfma_f32_16x16x32_bf16 v[224:227], v[120:123], v[212:215], v[224:227]
    ds_read_b128 v[212:215], v234 offset:896
    s_waitcnt lgkmcnt(7)
    v_mfma_f32_16x16x32_bf16 v[220:223], v[44:47], v[216:219], v[220:223]
    v_mfma_f32_16x16x32_bf16 v[224:227], v[124:127], v[216:219], v[224:227]
    ds_read_b128 v[216:219], v234 offset:960
    s_waitcnt lgkmcnt(7)
    v_mfma_f32_16x16x32_bf16 v[220:223], v[48:51], v[188:191], v[220:223]
    v_mfma_f32_16x16x32_bf16 v[224:227], v[128:131], v[188:191], v[224:227]
    ds_read_b128 v[188:191], v234 offset:1024
    s_waitcnt lgkmcnt(7)
    v_mfma_f32_16x16x32_bf16 v[220:223], v[52:55], v[192:195], v[220:223]
    v_mfma_f32_16x16x32_bf16 v[224:227], v[132:135], v[192:195], v[224:227]
    ds_read_b128 v[192:195], v234 offset:1088
    s_waitcnt lgkmcnt(7)
    v_mfma_f32_16x16x32_bf16 v[220:223], v[56:59], v[196:199], v[220:223]
    v_mfma_f32_16x16x32_bf16 v[224:227], v[136:139], v[196:199], v[224:227]
    ds_read_b128 v[196:199], v234 offset:1152
    s_waitcnt lgkmcnt(7)
    v_mfma_f32_16x16x32_bf16 v[220:223], v[60:63], v[200:203], v[220:223]
    v_mfma_f32_16x16x32_bf16 v[224:227], v[140:143], v[200:203], v[224:227]
    ds_read_b128 v[200:203], v234 offset:1216
    s_waitcnt lgkmcnt(7)
    v_mfma_f32_16x16x32_bf16 v[220:223], v[64:67], v[204:207], v[220:223]
    v_mfma_f32_16x16x32_bf16 v[224:227], v[144:147], v[204:207], v[224:227]
    s_waitcnt lgkmcnt(6)
    v_mfma_f32_16x16x32_bf16 v[220:223], v[68:71], v[208:211], v[220:223]
    v_mfma_f32_16x16x32_bf16 v[224:227], v[148:151], v[208:211], v[224:227]
    s_waitcnt lgkmcnt(5)
    v_mfma_f32_16x16x32_bf16 v[220:223], v[72:75], v[212:215], v[220:223]
    v_mfma_f32_16x16x32_bf16 v[224:227], v[152:155], v[212:215], v[224:227]
    s_waitcnt lgkmcnt(4)
    v_mfma_f32_16x16x32_bf16 v[220:223], v[76:79], v[216:219], v[220:223]
    v_mfma_f32_16x16x32_bf16 v[224:227], v[156:159], v[216:219], v[224:227]
    s_waitcnt lgkmcnt(3)
    v_mfma_f32_16x16x32_bf16 v[220:223], v[80:83], v[188:191], v[220:223]
    v_mfma_f32_16x16x32_bf16 v[224:227], v[160:163], v[188:191], v[224:227]
    s_waitcnt lgkmcnt(2)
    v_mfma_f32_16x16x32_bf16 v[220:223], v[84:87], v[192:195], v[220:223]
    v_mfma_f32_16x16x32_bf16 v[224:227], v[164:167], v[192:195], v[224:227]
    s_waitcnt lgkmcnt(1)
    v_mfma_f32_16x16x32_bf16 v[220:223], v[88:91], v[196:199], v[220:223]
    v_mfma_f32_16x16x32_bf16 v[224:227], v[168:171], v[196:199], v[224:227]
    s_waitcnt lgkmcnt(0)
    v_mfma_f32_16x16x32_bf16 v[220:223], v[92:95], v[200:203], v[220:223]
    v_mfma_f32_16x16x32_bf16 v[224:227], v[172:175], v[200:203], v[224:227]
    s_mov_b32 s3, 1048576
K_FGDN:
    ds_read_b32 v2, v12 offset:52
    s_sleep 1
    s_sub_u32 s3, s3, 1
    s_waitcnt lgkmcnt(0)
    v_readfirstlane_b32 s33, v2
    s_nop 3
    s_cselect_b32 s33, 3, s33
    s_cmp_lt_u32 s33, 3
    s_cbranch_scc1 K_FGDN
    ds_read_b64_tr_b16 v[16:17], v238 offset:0
    ds_read_b64_tr_b16 v[18:19], v238 offset:2048
    ds_read_b64_tr_b16 v[20:21], v239 offset:0
    ds_read_b64_tr_b16 v[22:23], v239 offset:2048
    ds_read_b64_tr_b16 v[24:25], v240 offset:0
    ds_read_b64_tr_b16 v[26:27], v240 offset:2048
    ds_read_b64_tr_b16 v[28:29], v241 offset:0
    ds_read_b64_tr_b16 v[30:31], v241 offset:2048
    ds_read_b64_tr_b16 v[32:33], v238 offset:4096
    ds_read_b64_tr_b16 v[34:35], v238 offset:6144
    ds_read_b64_tr_b16 v[36:37], v239 offset:4096
    ds_read_b64_tr_b16 v[38:39], v239 offset:6144
    ds_read_b64_tr_b16 v[40:41], v240 offset:4096
    ds_read_b64_tr_b16 v[42:43], v240 offset:6144
    v_cvt_pk_bf16_f32 v221, v220, v221
    v_lshlrev_b32 v220, 16, v221
    v_and_b32 v221, 0xffff0000, v221
    v_cvt_pk_bf16_f32 v223, v222, v223
    v_lshlrev_b32 v222, 16, v223
    v_and_b32 v223, 0xffff0000, v223
    v_cvt_pk_bf16_f32 v225, v224, v225
    v_lshlrev_b32 v224, 16, v225
    v_and_b32 v225, 0xffff0000, v225
    v_cvt_pk_bf16_f32 v227, v226, v227
    v_lshlrev_b32 v226, 16, v227
    v_and_b32 v227, 0xffff0000, v227
    v_mul_f32 v188, 0xbfb8aa3b, v220
    v_mul_f32 v189, 0xbfb8aa3b, v221
    v_mul_f32 v190, 0xbfb8aa3b, v222
    v_mul_f32 v191, 0xbfb8aa3b, v223
    v_exp_f32 v188, v188
    v_exp_f32 v189, v189
    v_exp_f32 v190, v190
    v_exp_f32 v191, v191
    v_add_f32 v188, 1.0, v188
    v_add_f32 v189, 1.0, v189
    v_add_f32 v190, 1.0, v190
    v_add_f32 v191, 1.0, v191
    v_rcp_f32 v188, v188
    v_rcp_f32 v189, v189
    v_rcp_f32 v190, v190
    v_rcp_f32 v191, v191
    v_mul_f32 v220, v220, v188
    v_mul_f32 v221, v221, v189
    v_mul_f32 v222, v222, v190
    v_mul_f32 v223, v223, v191
    v_cvt_pk_bf16_f32 v221, v220, v221
    v_lshlrev_b32 v220, 16, v221
    v_and_b32 v221, 0xffff0000, v221
    v_cvt_pk_bf16_f32 v223, v222, v223
    v_lshlrev_b32 v222, 16, v223
    v_and_b32 v223, 0xffff0000, v223
    v_mul_f32 v220, v220, v224
    v_mul_f32 v221, v221, v225
    v_mul_f32 v222, v222, v226
    v_mul_f32 v223, v223, v227
    v_cvt_pk_bf16_f32 v228, v220, v221
    v_cvt_pk_bf16_f32 v229, v222, v223
    ds_write_b64 v235, v[228:229]
    s_mov_b64 exec, 1
    ds_add_u32 v12, v13 offset:52
    s_mov_b64 exec, -1
    ds_read_b64_tr_b16 v[44:45], v241 offset:4096
    ds_read_b64_tr_b16 v[46:47], v241 offset:6144
    ds_read_b64_tr_b16 v[48:49], v238 offset:8192
    ds_read_b64_tr_b16 v[50:51], v238 offset:10240
    ds_read_b64_tr_b16 v[52:53], v239 offset:8192
    ds_read_b64_tr_b16 v[54:55], v239 offset:10240
    ds_read_b64_tr_b16 v[56:57], v240 offset:8192
    ds_read_b64_tr_b16 v[58:59], v240 offset:10240
    ds_read_b64_tr_b16 v[60:61], v241 offset:8192
    ds_read_b64_tr_b16 v[62:63], v241 offset:10240
    ds_read_b64_tr_b16 v[64:65], v238 offset:12288
    ds_read_b64_tr_b16 v[66:67], v238 offset:14336
    ds_read_b64_tr_b16 v[68:69], v239 offset:12288
    ds_read_b64_tr_b16 v[70:71], v239 offset:14336
    ds_read_b64_tr_b16 v[72:73], v240 offset:12288
    ds_read_b64_tr_b16 v[74:75], v240 offset:14336
    ds_read_b64_tr_b16 v[76:77], v241 offset:12288
    ds_read_b64_tr_b16 v[78:79], v241 offset:14336
    ds_read_b64_tr_b16 v[80:81], v238 offset:16384
    ds_read_b64_tr_b16 v[82:83], v238 offset:18432
    ds_read_b64_tr_b16 v[84:85], v239 offset:16384
    ds_read_b64_tr_b16 v[86:87], v239 offset:18432
    ds_read_b64_tr_b16 v[88:89], v240 offset:16384
    ds_read_b64_tr_b16 v[90:91], v240 offset:18432
    ds_read_b64_tr_b16 v[92:93], v241 offset:16384
    ds_read_b64_tr_b16 v[94:95], v241 offset:18432
    s_mov_b32 s3, 1048576
K_FGP:
    ds_read_b32 v2, v12 offset:52
    s_sleep 0
    s_sub_u32 s3, s3, 1
    s_waitcnt lgkmcnt(0)
    v_readfirstlane_b32 s33, v2
    s_nop 3
    s_cselect_b32 s33, 5, s33
    s_cmp_lt_u32 s33, 5
    s_cbranch_scc1 K_FGP
    ds_read_b128 v[228:231], v236
    s_waitcnt lgkmcnt(0)
    v_mfma_f32_16x16x32_bf16 v[96:99], v[16:19], v[228:231], 0
    v_mfma_f32_16x16x32_bf16 v[100:103], v[20:23], v[228:231], 0
    v_mfma_f32_16x16x32_bf16 v[104:107], v[24:27], v[228:231], 0
    v_mfma_f32_16x16x32_bf16 v[108:111], v[28:31], v[228:231], 0
    v_mfma_f32_16x16x32_bf16 v[112:115], v[32:35], v[228:231], 0
    v_mfma_f32_16x16x32_bf16 v[116:119], v[36:39], v[228:231], 0
    v_mfma_f32_16x16x32_bf16 v[120:123], v[40:43], v[228:231], 0
    v_mfma_f32_16x16x32_bf16 v[124:127], v[44:47], v[228:231], 0
    v_mfma_f32_16x16x32_bf16 v[128:131], v[48:51], v[228:231], 0
    v_mfma_f32_16x16x32_bf16 v[132:135], v[52:55], v[228:231], 0
    v_mfma_f32_16x16x32_bf16 v[136:139], v[56:59], v[228:231], 0
    v_mfma_f32_16x16x32_bf16 v[140:143], v[60:63], v[228:231], 0
    v_mfma_f32_16x16x32_bf16 v[144:147], v[64:67], v[228:231], 0
    v_mfma_f32_16x16x32_bf16 v[148:151], v[68:71], v[228:231], 0
    v_mfma_f32_16x16x32_bf16 v[152:155], v[72:75], v[228:231], 0
    v_mfma_f32_16x16x32_bf16 v[156:159], v[76:79], v[228:231], 0
    v_mfma_f32_16x16x32_bf16 v[160:163], v[80:83], v[228:231], 0
    v_mfma_f32_16x16x32_bf16 v[164:167], v[84:87], v[228:231], 0
    v_mfma_f32_16x16x32_bf16 v[168:171], v[88:91], v[228:231], 0
    v_mfma_f32_16x16x32_bf16 v[172:175], v[92:95], v[228:231], 0
    s_mov_b32 exec_lo, 0x00030003
    s_mov_b32 exec_hi, 0x00030003
    buffer_store_dwordx4 v[96:99], v237, s[64:67], s72 offen offset:0 sc1
    buffer_store_dwordx4 v[100:103], v237, s[64:67], s72 offen offset:64 sc1
    buffer_store_dwordx4 v[104:107], v237, s[64:67], s72 offen offset:128 sc1
    buffer_store_dwordx4 v[108:111], v237, s[64:67], s72 offen offset:192 sc1
    buffer_store_dwordx4 v[112:115], v237, s[64:67], s72 offen offset:256 sc1
    buffer_store_dwordx4 v[116:119], v237, s[64:67], s72 offen offset:320 sc1
    buffer_store_dwordx4 v[120:123], v237, s[64:67], s72 offen offset:384 sc1
    buffer_store_dwordx4 v[124:127], v237, s[64:67], s72 offen offset:448 sc1
    buffer_store_dwordx4 v[128:131], v237, s[64:67], s72 offen offset:512 sc1
    buffer_store_dwordx4 v[132:135], v237, s[64:67], s72 offen offset:576 sc1
    buffer_store_dwordx4 v[136:139], v237, s[64:67], s72 offen offset:640 sc1
    buffer_store_dwordx4 v[140:143], v237, s[64:67], s72 offen offset:704 sc1
    buffer_store_dwordx4 v[144:147], v237, s[64:67], s72 offen offset:768 sc1
    buffer_store_dwordx4 v[148:151], v237, s[64:67], s72 offen offset:832 sc1
    buffer_store_dwordx4 v[152:155], v237, s[64:67], s72 offen offset:896 sc1
    buffer_store_dwordx4 v[156:159], v237, s[64:67], s72 offen offset:960 sc1
    buffer_store_dwordx4 v[160:163], v237, s[64:67], s72 offen offset:1024 sc1
    buffer_store_dwordx4 v[164:167], v237, s[64:67], s72 offen offset:1088 sc1
    buffer_store_dwordx4 v[168:171], v237, s[64:67], s72 offen offset:1152 sc1
    buffer_store_dwordx4 v[172:175], v237, s[64:67], s72 offen offset:1216 sc1
    s_mov_b64 exec, -1
    s_mul_i32 s3, s73, 2560
    s_lshl2_add_u32 s3, s44, s3
    s_add_u32 s3, s3, 568320
    v_lshl_add_u32 v2, v1, 8, s3
    s_mov_b64 exec, 0x3ff
    s_waitcnt vmcnt(0)
    global_store_dword v2, v13, s[10:11] sc1
    s_mov_b64 exec, -1
    s_branch K_P2_HELP
K_CODE_END:
.section .rodata,"a"
.p2align 6
.amdhsa_kernel gated_mix__sliding_local_dilated__moe_arch_mod__prompt_kernel
  .amdhsa_next_free_vgpr 248
  .amdhsa_next_free_sgpr 79
  .amdhsa_accum_offset 248
  .amdhsa_group_segment_fixed_size 0
  .amdhsa_kernarg_size 96
  .amdhsa_user_sgpr_count 2
  .amdhsa_user_sgpr_kernarg_segment_ptr 1
  .amdhsa_system_sgpr_workgroup_id_x 1
.end_amdhsa_kernel
```

```asm
; @launch grid=(256,1,1) block=(512,1,1) lds=163840
.amdgcn_target "amdgcn-amd-amdhsa--gfx950"
.text
.p2align 12
.p2align 8
.globl gated_mix__sliding_local_dilated__moe_arch_mod__prompt_kernel
.type gated_mix__sliding_local_dilated__moe_arch_mod__prompt_kernel,@function
gated_mix__sliding_local_dilated__moe_arch_mod__prompt_kernel:
    s_cmp_ge_u32 s2, 256
    s_cbranch_scc1 K_EXIT
    s_load_dwordx2 s[12:13], s[0:1], 0
    s_load_dwordx2 s[16:17], s[0:1], 8
    v_readfirstlane_b32 s30, v0
    s_load_dwordx4 s[8:11], s[0:1], 80
    s_load_dwordx2 s[24:25], s[0:1], 16
    s_load_dwordx2 s[6:7], s[0:1], 72
    s_and_b32 s28, s2, 7
    v_and_b32 v1, 63, v0
    s_mov_b32 s14, 0x280000
    s_mov_b32 s15, 0x20000
    s_lshr_b32 s30, s30, 6
    s_cmp_lt_u32 s2, 64
    s_cbranch_scc1 K_SLOW
    s_cmp_lt_u32 s30, 4
    s_cbranch_scc1 K_FAST
K_SLOW:
    s_getpc_b64 s[38:39]
K_PC:
    s_bfe_u32 s3, s2, 0x30003
    s_mul_i32 s3, s3, ((K_CODE_END-gated_mix__sliding_local_dilated__moe_arch_mod__prompt_kernel+1023)/1024)
    s_sub_u32 s38, s38, K_PC-gated_mix__sliding_local_dilated__moe_arch_mod__prompt_kernel
    s_subb_u32 s39, s39, 0
    v_subrev_u32 v3, 256, v0
    v_add_u32 v2, s3, v3
    v_lshlrev_b32 v2, 7, v2
    v_min_u32 v2, K_CODE_END-gated_mix__sliding_local_dilated__moe_arch_mod__prompt_kernel-4, v2
    v_cmp_gt_u32 vcc, ((K_CODE_END-gated_mix__sliding_local_dilated__moe_arch_mod__prompt_kernel+1023)/1024), v3
    s_and_saveexec_b64 s[4:5], vcc
    s_cbranch_execz K_NOPF
    global_load_dword v6, v2, s[38:39]
K_NOPF:
    s_mov_b64 exec, -1
    v_mov_b32 v2, 0
    v_mov_b32 v3, 158752
    ds_write2_b32 v3, v2, v2 offset0:0 offset1:1
    ds_write2_b32 v3, v2, v2 offset0:2 offset1:3
    ds_write2_b32 v3, v2, v2 offset0:4 offset1:5
    ds_write2_b32 v3, v2, v2 offset0:6 offset1:7
    ds_write2_b32 v3, v2, v2 offset0:8 offset1:9
    ds_write2_b32 v3, v2, v2 offset0:10 offset1:11
    s_mov_b32 s43, 1
    s_lshl_b32 s3, s30, 8
    s_add_u32 s3, s3, s2
    s_lshr_b32 s3, s3, 3
    s_cmp_lg_u32 s3, 160
    s_cbranch_scc1 K_COMMON
    s_mul_i32 s3, s2, 6144
    s_add_u32 s3, s3, 527360
    v_lshl_add_u32 v6, v1, 4, s3
    v_mov_b64 v[28:29], 0
    v_mov_b64 v[30:31], 0
    s_waitcnt lgkmcnt(0)
    global_store_dwordx4 v6, v[28:31], s[10:11] offset:-3072 sc1
    global_store_dwordx4 v6, v[28:31], s[10:11] offset:-2048 sc1
    global_store_dwordx4 v6, v[28:31], s[10:11] offset:-1024 sc1
    global_store_dwordx4 v6, v[28:31], s[10:11] offset:0 sc1
    global_store_dwordx4 v6, v[28:31], s[10:11] offset:1024 sc1
    global_store_dwordx4 v6, v[28:31], s[10:11] offset:2048 sc1
    s_lshl_b32 s3, s2, 2
    v_mov_b32 v2, s3
    v_mov_b32 v3, 1
    s_mov_b64 exec, 1
    s_waitcnt vmcnt(0)
    global_store_dword v2, v3, s[8:9] offset:192 sc1
    s_mov_b64 exec, -1
    s_branch K_COMMON
K_FAST:
    s_lshr_b32 s32, s2, 1
    s_and_b32 s32, s32, 28
    v_lshrrev_b32 v3, 4, v1
    s_lshr_b32 s3, s2, 6
    s_mov_b32 s59, 0x59608237
    s_cmp_eq_u32 s3, 2
    s_cselect_b32 s59, 0x26375904, s59
    v_and_b32 v4, 7, v1
    s_cmp_eq_u32 s3, 3
    s_cselect_b32 s59, 0x93042671, s59
    v_lshrrev_b32 v2, 3, v1
    s_lshr_b32 s59, s59, s32
    s_and_b32 s59, s59, 15
    v_xor_b32 v4, v4, v3
    s_lshl_b32 s33, s28, 2
    s_lshr_b32 s33, 0x76543210, s33
    s_and_b32 s33, s33, 15
    s_add_u32 s59, s59, s33
    s_cmp_ge_u32 s59, 10
    v_mul_u32_u24 v2, 1280, v2
    s_cselect_b32 s33, 10, 0
    s_sub_u32 s59, s59, s33
    s_lshr_b32 s53, s28, 1
    v_lshl_add_u32 v44, v4, 4, v2
    s_mul_i32 s53, s53, 655360
    s_lshl2_add_u32 s62, s3, s30
    s_cmp_eq_u32 s62, 15
    s_cselect_b32 s62, 0x800000, 0
    s_add_u32 s62, s62, 40960
    s_mul_i32 s3, s3, 225280
    v_xor_b32 v45, 64, v44
    s_add_u32 s53, s53, s3
    s_mul_i32 s54, s30, 61440
    s_add_u32 s53, s53, s54
    s_sub_u32 s53, s53, 245760
    s_mul_i32 s55, s30, 6144
    s_add_u32 s55, s55, 40960
    s_lshl_b32 s57, s59, 7
    s_add_u32 s57, s57, s53
    s_waitcnt lgkmcnt(0)
    s_add_u32 m0, s55, 0
    s_max_i32 s60, s57, 0
    buffer_load_dwordx4 v44, s[12:15], s60 offen lds
    s_add_u32 s60, s57, 10240
    s_add_u32 m0, s55, 1024
    s_max_i32 s60, s60, 0
    buffer_load_dwordx4 v45, s[12:15], s60 offen lds
    s_add_u32 m0, s55, 2048
    s_add_u32 s60, s57, 20480
    buffer_load_dwordx4 v44, s[12:15], s60 offen lds
    s_add_u32 m0, s55, 3072
    s_add_u32 s60, s57, 30720
    buffer_load_dwordx4 v45, s[12:15], s60 offen lds
    s_add_u32 m0, s55, 4096
    s_add_u32 s60, s57, s62
    buffer_load_dwordx4 v44, s[12:15], s60 offen lds
    s_add_u32 m0, s55, 5120
    s_add_u32 s60, s60, 10240
    buffer_load_dwordx4 v45, s[12:15], s60 offen lds
    v_lshlrev_b32 v2, 1, v3
    s_lshr_b32 s32, 0x64317520, s32
    v_sub_u32 v2, v1, v2
    s_and_b32 s32, s32, 7
    v_and_b32 v2, 15, v2
    s_and_b32 s3, s28, 1
    v_mul_u32_u24 v3, 3840, v3
    s_lshl3_add_u32 s32, s3, s32
    v_mul_u32_u24 v4, 13, v2
    s_mul_i32 s3, s32, 80
    v_lshrrev_b32 v4, 6, v4
    s_add_u32 s54, s54, s3
    v_mul_u32_u24 v4, 1200, v4
    s_lshl_b32 s56, s30, 12
    v_lshl_add_u32 v4, v2, 4, v4
    s_add_u32 s56, s56, 65536
    v_add_u32 v5, 1, v2
    s_mov_b32 s18, 0x258000
    v_and_b32 v5, 16, v5
    s_mov_b32 s19, 0x20000
    v_lshl_add_u32 v4, v5, 24, v4
    v_add_u32 v46, v3, v4
    s_mul_i32 s58, s59, 245760
    s_add_u32 s58, s58, s54
    s_add_u32 s59, s59, 1
    s_cmp_eq_u32 s59, 10
    s_cselect_b32 s59, 0, s59
    s_add_u32 m0, s56, 0
    s_add_u32 s60, s58, 0
    buffer_load_dwordx4 v46, s[16:19], s60 offen lds
    s_add_u32 m0, s56, 1024
    s_add_u32 s60, s58, 15360
    buffer_load_dwordx4 v46, s[16:19], s60 offen lds
    v_xor_b32 v2, 8, v2
    v_mul_u32_u24 v4, 13, v2
    v_lshrrev_b32 v4, 6, v4
    v_mul_u32_u24 v4, 1200, v4
    v_lshl_add_u32 v4, v2, 4, v4
    v_add_u32 v5, 1, v2
    v_and_b32 v5, 16, v5
    v_lshl_add_u32 v4, v5, 24, v4
    v_add_u32 v47, v3, v4
    s_add_u32 m0, s56, 2048
    s_add_u32 s60, s58, 30720
    buffer_load_dwordx4 v47, s[16:19], s60 offen lds
    s_add_u32 m0, s56, 3072
    s_add_u32 s60, s58, 46080
    buffer_load_dwordx4 v47, s[16:19], s60 offen lds
    s_mov_b32 s52, s30
    s_mov_b32 s43, 0
K_COMMON:
    v_mov_b32 v7, 0
    s_lshr_b32 s29, s2, 3
    s_xor_b32 s30, s30, 4
    s_mov_b32 s26, 0xc8000
    s_mov_b32 s27, 0x20000
    s_lshr_b32 s34, s29, 3
    s_lshl_b32 s34, s34, 2
    s_and_b32 s3, s29, 3
    s_add_u32 s34, s34, s3
    s_add_u32 s34, s34, 4
    s_bitcmp1_b32 s29, 2
    s_cselect_b32 s34, -1, s34
    s_cmp_lt_u32 s29, 8
    s_cselect_b32 s34, s29, s34
    s_lshl_b32 s40, s28, 1
    s_cmp_ge_u32 s34, 10
    s_addc_u32 s40, s40, 0
    s_sub_u32 s41, s34, 10
    s_cmp_ge_u32 s34, 10
    s_cselect_b32 s41, s41, s34
    s_mul_i32 s42, s28, 20
    s_add_u32 s42, s42, s34
    s_and_b32 s42, s42, 255
    s_lshl_b32 s42, s42, 8
    s_add_u32 s42, s42, 524288
    s_cmp_lt_u32 s29, 8
    s_cbranch_scc1 K_AUX
    s_lshr_b32 s31, s29, 3
    s_sub_u32 s31, s31, 1
    s_and_b32 s35, s29, 3
    s_and_b32 s3, s29, 4
    s_lshl_b32 s3, s3, 1
    s_add_u32 s35, s35, s3
    s_and_b32 s3, s28, 1
    s_lshl_b32 s3, s3, 2
    s_add_u32 s35, s35, s3
    v_and_b32 v9, 15, v1
    v_lshrrev_b32 v10, 4, v1
    v_bfe_u32 v11, v1, 2, 2
    v_and_b32 v12, 3, v1
    s_waitcnt lgkmcnt(0)
    s_add_u32 s20, s10, 0x100000
    s_addc_u32 s21, s11, 0
    s_mov_b32 s22, 0x280000
    s_mov_b32 s23, 0x20000
    s_and_b32 s3, s30, 3
    s_mul_i32 s3, s3, 3
    s_lshr_b32 s33, s30, 2
    s_lshl1_add_u32 s3, s33, s3
    s_mul_i32 s44, s31, 11
    s_add_u32 s44, s44, s3
    s_cmp_eq_u32 s44, 31
    s_cselect_b32 s51, 4, s30
    s_lshr_b32 s33, s28, 1
    s_lshl_b32 s33, s33, 5
    s_add_u32 s44, s44, s33
    s_mul_i32 s3, s3, 4352
    s_add_u32 s3, s3, 81920
    v_mul_u32_u24 v14, 272, v9
    v_lshl_add_u32 v13, v10, 3, v14
    v_add_u32 v13, s3, v13
    v_add3_u32 v14, v14, 32, s3
    v_cmp_eq_u32 vcc, 0, v10
    v_add_u32 v2, 208, v14
    v_add_u32 v3, 0, v14
    v_add_u32 v4, 40, v14
    v_cndmask_b32 v20, v2, v4, vcc
    v_add_u32 v2, 8, v2
    v_cndmask_b32 v19, v2, v3, vcc
    v_lshl_add_u32 v15, v10, 2, v11
    v_mul_u32_u24 v15, 272, v15
    v_add_u32 v5, s3, v15
    v_lshl_add_u32 v15, v12, 3, v5
    v_add_u32 v2, 240, v5
    v_add_u32 v3, 192, v5
    v_add_u32 v4, 232, v5
    v_add_u32 v5, 248, v5
    v_cmp_eq_u32 vcc, 0, v12
    s_nop 1
    v_cndmask_b32 v21, v5, v3, vcc
    v_cmp_eq_u32 vcc, 1, v12
    s_nop 1
    v_cndmask_b32 v22, v2, v4, vcc
    v_cmp_eq_u32 vcc, 2, v12
    s_nop 1
    v_cndmask_b32 v23, v5, v3, vcc
    v_cmp_eq_u32 vcc, 3, v12
    s_nop 1
    v_cndmask_b32 v24, v2, v4, vcc
    s_lshl_b32 s3, s35, 10
    v_lshl_add_u32 v16, v1, 4, s3
    s_lshl_b32 s3, s35, 8
    s_add_u32 s3, s3, 16384
    v_lshl_add_u32 v17, v9, 4, s3
    v_and_b32 v2, 1, v10
    v_lshl_add_u32 v17, v2, 23, v17
    s_cmp_lt_u32 s51, 4
    s_cselect_b32 s3, 0, 0x800000
    s_add_u32 s3, s3, 20480
    v_lshrrev_b32 v2, 1, v10
    v_mad_u32_u24 v17, v2, s3, v17
    s_mul_i32 s50, s44, 20480
    s_add_u32 s51, s50, s3
    v_mov_b32 v18, 0xf149f2ca
    v_lshlrev_b32 v2, 2, v10
    v_sub_u32 v2, v9, v2
    s_cmp_eq_u32 s44, 0
    s_cselect_b32 s3, 0xf149f2ca, 0
    v_subrev_u32 v3, 0, v2
    v_and_b32 v4, 0x80000001, v3
    v_cmp_eq_u32 vcc, 0, v4
    s_nop 1
    v_cndmask_b32 v32, v18, 0, vcc
    v_cmp_eq_u32 vcc, 0x80000000, v4
    s_nop 1
    v_cndmask_b32 v28, v18, 0, vcc
    v_add_f32 v36, s3, v28
    v_subrev_u32 v3, 1, v2
    v_and_b32 v4, 0x80000001, v3
    v_cmp_eq_u32 vcc, 0, v4
    s_nop 1
    v_cndmask_b32 v33, v18, 0, vcc
    v_cmp_eq_u32 vcc, 0x80000000, v4
    s_nop 1
    v_cndmask_b32 v29, v18, 0, vcc
    v_add_f32 v37, s3, v29
    v_subrev_u32 v3, 2, v2
    v_and_b32 v4, 0x80000001, v3
    v_cmp_eq_u32 vcc, 0, v4
    s_nop 1
    v_cndmask_b32 v34, v18, 0, vcc
    v_cmp_eq_u32 vcc, 0x80000000, v4
    s_nop 1
    v_cndmask_b32 v30, v18, 0, vcc
    v_add_f32 v38, s3, v30
    v_subrev_u32 v3, 3, v2
    v_and_b32 v4, 0x80000001, v3
    v_cmp_eq_u32 vcc, 0, v4
    s_nop 1
    v_cndmask_b32 v35, v18, 0, vcc
    v_cmp_eq_u32 vcc, 0x80000000, v4
    s_nop 1
    v_cndmask_b32 v31, v18, 0, vcc
    v_add_f32 v39, s3, v31
    v_mov_b32 v3, 0x0c0c0c0c
    v_mov_b32 v4, 0xc0c0100
    v_cmp_eq_u32 vcc, 0, v28
    v_mov_b32 v5, 0x1000c0c
    s_nop 0
    v_cndmask_b32 v3, v3, v4, vcc
    v_cmp_eq_u32 vcc, 0, v29
    s_nop 1
    v_cndmask_b32 v40, v3, v5, vcc
    v_mov_b32 v3, 0x0c0c0c0c
    v_mov_b32 v4, 0xc0c0302
    v_cmp_eq_u32 vcc, 0, v30
    v_mov_b32 v5, 0x3020c0c
    s_nop 0
    v_cndmask_b32 v3, v3, v4, vcc
    v_cmp_eq_u32 vcc, 0, v31
    s_nop 1
    v_cndmask_b32 v41, v3, v5, vcc
    v_mov_b32 v3, 0x0c0c0c0c
    v_mov_b32 v4, 0xc0c0100
    v_cmp_eq_u32 vcc, 0, v32
    v_mov_b32 v5, 0x1000c0c
    s_nop 0
    v_cndmask_b32 v3, v3, v4, vcc
    v_cmp_eq_u32 vcc, 0, v33
    s_nop 1
    v_cndmask_b32 v42, v3, v5, vcc
    v_mov_b32 v3, 0x0c0c0c0c
    v_mov_b32 v4, 0xc0c0302
    v_cmp_eq_u32 vcc, 0, v34
    v_mov_b32 v5, 0x3020c0c
    s_nop 0
    v_cndmask_b32 v3, v3, v4, vcc
    v_cmp_eq_u32 vcc, 0, v35
    s_nop 1
    v_cndmask_b32 v43, v3, v5, vcc
    s_mov_b32 s46, 0x3fb8aa3b
    s_mov_b32 s47, s46
    s_mov_b32 s48, 0x3e64f92e
    s_mov_b32 s49, s48
    s_mov_b32 s36, 0xfffff
    s_cmp_lg_u32 s31, 0
    s_cselect_b32 s33, 64, 0
    v_mov_b32 v2, s33
    v_cmp_gt_u32 vcc, 10, v1
    s_lshr_b32 s3, s28, 1
    s_lshl2_add_u32 s3, s3, s31
    v_cndmask_b32 v2, 0, v2, vcc
    v_lshl_add_u32 v2, v1, 8, v2
    s_mul_i32 s3, s3, 2560
    s_lshl2_add_u32 s3, s35, s3
    s_add_u32 s3, s3, 524288
    v_add_u32 v8, s3, v2
    s_cmp_eq_u32 s43, 1
    s_cbranch_scc1 K_CONS
    v_lshrrev_b32 v2, 3, v1
    v_mul_u32_u24 v2, 1280, v2
    v_lshrrev_b32 v3, 4, v1
    v_lshlrev_b32 v3, 1, v3
    v_and_b32 v4, 7, v1
    v_xor_b32 v3, v3, v4
    v_lshl_add_u32 v2, v3, 4, v2
    s_lshl_b32 s33, s41, 7
    v_add_u32 v18, s33, v2
    s_mov_b32 s61, 9
    s_mov_b32 s3, 40960
    s_branch K_LOOPE
K_LOOP:
    s_waitcnt vmcnt(5)
    s_barrier
    s_add_u32 m0, s56, 2048
    s_add_u32 s60, s58, 30720
    buffer_load_dwordx4 v47, s[16:19], s60 offen lds
    s_add_u32 m0, s55, 3072
    s_add_u32 s60, s57, 30720
    buffer_load_dwordx4 v45, s[12:15], s60 offen lds
    s_add_u32 m0, s56, 3072
    s_add_u32 s60, s58, 46080
    buffer_load_dwordx4 v47, s[16:19], s60 offen lds
    s_add_u32 m0, s55, 4096
    s_add_u32 s60, s57, s62
    buffer_load_dwordx4 v44, s[12:15], s60 offen lds
    s_add_u32 m0, s55, 5120
    s_add_u32 s60, s60, 10240
    buffer_load_dwordx4 v45, s[12:15], s60 offen lds
    s_sub_u32 s61, s61, 1
    s_cmp_eq_u32 s61, 0
    s_cbranch_scc1 K_LOOPX
K_LOOPE:
    s_cmp_ge_u32 s55, 81920
    s_cselect_b32 s60, -81920, s3
    s_add_u32 s55, s55, s60
    s_add_u32 s56, s56, s60
    s_lshl_b32 s57, s59, 7
    s_add_u32 s57, s57, s53
    s_mul_i32 s58, s59, 245760
    s_add_u32 s58, s58, s54
    s_add_u32 s59, s59, 1
    s_cmp_eq_u32 s59, 10
    s_cselect_b32 s59, 0, s59
    s_add_u32 m0, s56, 0
    s_add_u32 s60, s58, 0
    buffer_load_dwordx4 v46, s[16:19], s60 offen lds
    s_add_u32 m0, s55, 0
    s_max_i32 s60, s57, 0
    buffer_load_dwordx4 v44, s[12:15], s60 offen lds
    s_add_u32 m0, s56, 1024
    s_add_u32 s60, s58, 15360
    buffer_load_dwordx4 v46, s[16:19], s60 offen lds
    s_add_u32 s60, s57, 10240
    s_add_u32 m0, s55, 1024
    s_max_i32 s60, s60, 0
    buffer_load_dwordx4 v45, s[12:15], s60 offen lds
    s_add_u32 m0, s55, 2048
    s_add_u32 s60, s57, 20480
    buffer_load_dwordx4 v44, s[12:15], s60 offen lds
    s_branch K_LOOP
K_LOOPX:
    v_and_b32 v2, 7, v1
    v_lshlrev_b32 v2, 2, v2
    s_waitcnt vmcnt(0)
    s_barrier
    s_cmp_lt_u32 s30, 6
    s_cbranch_scc1 K_NOSMP
    global_load_dword v7, v2, s[8:9] offset:192 sc1
K_NOSMP:
    s_cmp_eq_u32 s34, -1
    s_cbranch_scc1 K_JOIN_S
    s_cmp_lt_u32 s52, 2
    s_cbranch_scc1 K_WOE
    s_cmp_lg_u32 s30, 7
    s_cbranch_scc1 K_JOIN_S
    s_mov_b32 s52, 2
    s_branch K_W7A
K_WOE:
    s_lshl_b32 s57, s52, 2
    s_lshr_b32 s57, 0x7520, s57
    s_and_b32 s57, s57, 7
    s_mul_i32 s57, s57, 51200
    s_mul_i32 s58, s52, 5120
    s_add_u32 s3, s57, 0
    s_add_u32 m0, s58, 0
    s_nop 0
    buffer_load_dwordx4 v18, s[24:27], s3 offen lds
    s_add_u32 s3, s57, 10240
    s_add_u32 m0, s58, 1024
    s_nop 0
    buffer_load_dwordx4 v18, s[24:27], s3 offen lds
    s_add_u32 s3, s57, 20480
    s_add_u32 m0, s58, 2048
    s_nop 0
    buffer_load_dwordx4 v18, s[24:27], s3 offen lds
    s_add_u32 s3, s57, 30720
    s_add_u32 m0, s58, 3072
    s_nop 0
    buffer_load_dwordx4 v18, s[24:27], s3 offen lds
    s_add_u32 s3, s57, 40960
    s_add_u32 m0, s58, 4096
    s_nop 0
    buffer_load_dwordx4 v18, s[24:27], s3 offen lds
    s_add_u32 s3, s57, 409600
    s_add_u32 m0, s58, 20480
    s_nop 0
    buffer_load_dwordx4 v18, s[24:27], s3 offen lds
    s_add_u32 s3, s57, 419840
    s_add_u32 m0, s58, 21504
    s_nop 0
    buffer_load_dwordx4 v18, s[24:27], s3 offen lds
    s_add_u32 s3, s57, 430080
    s_add_u32 m0, s58, 22528
    s_nop 0
    buffer_load_dwordx4 v18, s[24:27], s3 offen lds
    s_add_u32 s3, s57, 440320
    s_add_u32 m0, s58, 23552
    s_nop 0
    buffer_load_dwordx4 v18, s[24:27], s3 offen lds
    s_add_u32 s3, s57, 450560
    s_add_u32 m0, s58, 24576
    s_nop 0
    buffer_load_dwordx4 v18, s[24:27], s3 offen lds
    s_cmp_lg_u32 s30, 7
    s_cbranch_scc1 K_JOIN_S
    s_add_u32 s52, s52, 1
    s_cmp_lt_u32 s52, 4
    s_cbranch_scc1 K_WOE
    s_mov_b32 s52, 0
K_XD:
    s_lshl_b32 s57, s40, 3
    s_lshl1_add_u32 s57, s52, s57
    s_mul_i32 s57, s57, 20480
    s_lshl_b32 s33, s41, 7
    s_add_u32 s57, s57, s33
    s_lshl_b32 s33, s52, 12
    s_add_u32 m0, s33, 140288
    s_add_u32 s3, s57, 0
    buffer_load_dwordx4 v44, s[12:15], s3 offen lds
    s_add_u32 m0, s33, 141312
    s_add_u32 s3, s57, 10240
    buffer_load_dwordx4 v45, s[12:15], s3 offen lds
    s_add_u32 m0, s33, 142336
    s_add_u32 s3, s57, 20480
    buffer_load_dwordx4 v44, s[12:15], s3 offen lds
    s_add_u32 m0, s33, 143360
    s_add_u32 s3, s57, 30720
    buffer_load_dwordx4 v45, s[12:15], s3 offen lds
    s_add_u32 s52, s52, 1
    s_cmp_lt_u32 s52, 4
    s_cbranch_scc1 K_XD
    s_branch K_W7
.p2align 12
K_CONS:
    s_lshr_b32 s52, s30, 1
    s_and_b32 s53, s30, 1
    v_lshrrev_b32 v2, 1, v9
    v_xor_b32 v2, v2, v10
    v_lshlrev_b32 v2, 4, v2
    v_lshl_add_u32 v2, v9, 7, v2
    s_mul_i32 s3, s52, 12288
    v_add_u32 v44, s3, v2
    v_xor_b32 v45, 64, v44
    v_add_u32 v46, 81920, v44
    v_add_u32 v47, 81920, v45
    v_and_b32 v2, 1, v10
    v_lshl_or_b32 v2, v2, 2, v11
    v_lshl_add_u32 v3, v10, 3, v11
    v_lshlrev_b32 v3, 8, v3
    v_lshl_add_u32 v3, v12, 3, v3
    v_add_u32 v3, 24576, v3
    s_lshl_b32 s3, s53, 2
    v_add_u32 v2, s3, v2
    v_add_u32 v4, 0, v2
    v_and_b32 v4, 7, v4
    v_lshl_add_u32 v48, v4, 5, v3
    v_add_u32 v52, 81920, v48
    v_add_u32 v4, 1, v2
    v_and_b32 v4, 7, v4
    v_lshl_add_u32 v49, v4, 5, v3
    v_add_u32 v53, 81920, v49
    v_add_u32 v4, 2, v2
    v_and_b32 v4, 7, v4
    v_lshl_add_u32 v50, v4, 5, v3
    v_add_u32 v54, 81920, v50
    v_add_u32 v4, 3, v2
    v_and_b32 v4, 7, v4
    v_lshl_add_u32 v51, v4, 5, v3
    v_add_u32 v55, 81920, v51
    v_mul_u32_u24 v56, 272, v9
    v_lshl_add_u32 v56, v10, 3, v56
    s_mul_i32 s3, s52, 26112
    s_lshl_b32 s33, s53, 7
    s_add_u32 s3, s3, s33
    s_add_u32 s3, s3, 81920
    v_add_u32 v56, s3, v56
    v_mov_b64 v[60:61], 0
    v_mov_b64 v[62:63], 0
    v_mov_b64 v[64:65], 0
    v_mov_b64 v[66:67], 0
    v_mov_b64 v[68:69], 0
    v_mov_b64 v[70:71], 0
    v_mov_b64 v[72:73], 0
    v_mov_b64 v[74:75], 0
    v_mov_b64 v[76:77], 0
    v_mov_b64 v[78:79], 0
    v_mov_b64 v[80:81], 0
    v_mov_b64 v[82:83], 0
    v_mov_b64 v[84:85], 0
    v_mov_b64 v[86:87], 0
    v_mov_b64 v[88:89], 0
    v_mov_b64 v[90:91], 0
    v_mov_b64 v[92:93], 0
    v_mov_b64 v[94:95], 0
    v_mov_b64 v[96:97], 0
    v_mov_b64 v[98:99], 0
    v_mov_b64 v[100:101], 0
    v_mov_b64 v[102:103], 0
    v_mov_b64 v[104:105], 0
    v_mov_b64 v[106:107], 0
    v_mov_b64 v[108:109], 0
    v_mov_b64 v[110:111], 0
    v_mov_b64 v[112:113], 0
    v_mov_b64 v[114:115], 0
    v_mov_b64 v[116:117], 0
    v_mov_b64 v[118:119], 0
    v_mov_b64 v[120:121], 0
    v_mov_b64 v[122:123], 0
    v_mov_b64 v[124:125], 0
    v_mov_b64 v[126:127], 0
    v_mov_b64 v[128:129], 0
    v_mov_b64 v[130:131], 0
    v_mov_b64 v[132:133], 0
    v_mov_b64 v[134:135], 0
    v_mov_b64 v[136:137], 0
    v_mov_b64 v[138:139], 0
    v_mov_b64 v[140:141], 0
    v_mov_b64 v[142:143], 0
    v_mov_b64 v[144:145], 0
    v_mov_b64 v[146:147], 0
    v_mov_b64 v[148:149], 0
    v_mov_b64 v[150:151], 0
    v_mov_b64 v[152:153], 0
    v_mov_b64 v[154:155], 0
    s_mov_b32 s54, 3
    s_cmp_lg_u32 s30, 0
    s_cbranch_scc1 K_WARMM0
    s_call_b64 s[38:39], WP_attd
    s_call_b64 s[38:39], WP_p2g
    s_branch K_WARMMX
K_WARMM0:
    s_cmp_lg_u32 s30, 1
    s_cbranch_scc1 K_WARMM1
    s_call_b64 s[38:39], WP_atts
    s_call_b64 s[38:39], WP_early
    s_branch K_WARMMX
K_WARMM1:
    s_cmp_lg_u32 s30, 2
    s_cbranch_scc1 K_WARMM2
    s_call_b64 s[38:39], WP_help
    s_call_b64 s[38:39], WP_flags
    s_branch K_WARMMX
K_WARMM2:
    s_call_b64 s[38:39], WP_spin
K_WARMMX:
    s_barrier
    ds_read_b64_tr_b16 v[204:205], v48 offset:40960
    ds_read_b64_tr_b16 v[206:207], v48 offset:41984
    ds_read_b128 v[156:159], v44 offset:40960
    ds_read_b64_tr_b16 v[208:209], v49 offset:40960
    ds_read_b64_tr_b16 v[210:211], v49 offset:41984
    ds_read_b128 v[160:163], v44 offset:43008
    ds_read_b64_tr_b16 v[212:213], v50 offset:40960
    ds_read_b64_tr_b16 v[214:215], v50 offset:41984
    ds_read_b128 v[164:167], v44 offset:45056
    ds_read_b64_tr_b16 v[216:217], v51 offset:40960
    ds_read_b64_tr_b16 v[218:219], v51 offset:41984
    ds_read_b128 v[168:171], v44 offset:47104
    ds_read_b128 v[172:175], v44 offset:49152
    ds_read_b128 v[176:179], v44 offset:51200
K_CLOOP:
    s_waitcnt lgkmcnt(0)
    v_mfma_f32_16x16x32_bf16 v[60:63], v[204:207], v[156:159], v[60:63]
    ds_read_b64_tr_b16 v[220:221], v48 offset:49152
    v_mfma_f32_16x16x32_bf16 v[64:67], v[208:211], v[156:159], v[64:67]
    ds_read_b64_tr_b16 v[222:223], v48 offset:50176
    v_mfma_f32_16x16x32_bf16 v[68:71], v[212:215], v[156:159], v[68:71]
    ds_read_b128 v[180:183], v45 offset:40960
    v_mfma_f32_16x16x32_bf16 v[72:75], v[216:219], v[156:159], v[72:75]
    ds_read_b64_tr_b16 v[224:225], v49 offset:49152
    v_mfma_f32_16x16x32_bf16 v[88:91], v[216:219], v[160:163], v[88:91]
    ds_read_b64_tr_b16 v[226:227], v49 offset:50176
    v_mfma_f32_16x16x32_bf16 v[84:87], v[212:215], v[160:163], v[84:87]
    ds_read_b128 v[184:187], v45 offset:43008
    v_mfma_f32_16x16x32_bf16 v[80:83], v[208:211], v[160:163], v[80:83]
    ds_read_b64_tr_b16 v[228:229], v50 offset:49152
    v_mfma_f32_16x16x32_bf16 v[76:79], v[204:207], v[160:163], v[76:79]
    ds_read_b64_tr_b16 v[230:231], v50 offset:50176
    v_mfma_f32_16x16x32_bf16 v[92:95], v[204:207], v[164:167], v[92:95]
    ds_read_b128 v[188:191], v45 offset:45056
    v_mfma_f32_16x16x32_bf16 v[96:99], v[208:211], v[164:167], v[96:99]
    ds_read_b64_tr_b16 v[232:233], v51 offset:49152
    v_mfma_f32_16x16x32_bf16 v[100:103], v[212:215], v[164:167], v[100:103]
    ds_read_b64_tr_b16 v[234:235], v51 offset:50176
    v_mfma_f32_16x16x32_bf16 v[104:107], v[216:219], v[164:167], v[104:107]
    ds_read_b128 v[192:195], v45 offset:47104
    v_mfma_f32_16x16x32_bf16 v[120:123], v[216:219], v[168:171], v[120:123]
    ds_read_b128 v[196:199], v45 offset:49152
    v_mfma_f32_16x16x32_bf16 v[116:119], v[212:215], v[168:171], v[116:119]
    ds_read_b128 v[200:203], v45 offset:51200
    v_mfma_f32_16x16x32_bf16 v[112:115], v[208:211], v[168:171], v[112:115]
    v_mfma_f32_16x16x32_bf16 v[108:111], v[204:207], v[168:171], v[108:111]
    v_mfma_f32_16x16x32_bf16 v[124:127], v[204:207], v[172:175], v[124:127]
    v_mfma_f32_16x16x32_bf16 v[128:131], v[208:211], v[172:175], v[128:131]
    v_mfma_f32_16x16x32_bf16 v[132:135], v[212:215], v[172:175], v[132:135]
    v_mfma_f32_16x16x32_bf16 v[136:139], v[216:219], v[172:175], v[136:139]
    v_mfma_f32_16x16x32_bf16 v[152:155], v[216:219], v[176:179], v[152:155]
    v_mfma_f32_16x16x32_bf16 v[148:151], v[212:215], v[176:179], v[148:151]
    v_mfma_f32_16x16x32_bf16 v[144:147], v[208:211], v[176:179], v[144:147]
    v_mfma_f32_16x16x32_bf16 v[140:143], v[204:207], v[176:179], v[140:143]
    s_waitcnt lgkmcnt(0)
    s_barrier
    v_mfma_f32_16x16x32_bf16 v[60:63], v[220:223], v[180:183], v[60:63]
    ds_read_b64_tr_b16 v[204:205], v52 offset:0
    v_mfma_f32_16x16x32_bf16 v[64:67], v[224:227], v[180:183], v[64:67]
    ds_read_b64_tr_b16 v[206:207], v52 offset:1024
    v_mfma_f32_16x16x32_bf16 v[68:71], v[228:231], v[180:183], v[68:71]
    ds_read_b128 v[156:159], v46 offset:0
    v_mfma_f32_16x16x32_bf16 v[72:75], v[232:235], v[180:183], v[72:75]
    ds_read_b64_tr_b16 v[208:209], v53 offset:0
    v_mfma_f32_16x16x32_bf16 v[88:91], v[232:235], v[184:187], v[88:91]
    ds_read_b64_tr_b16 v[210:211], v53 offset:1024
    v_mfma_f32_16x16x32_bf16 v[84:87], v[228:231], v[184:187], v[84:87]
    ds_read_b128 v[160:163], v46 offset:2048
    v_mfma_f32_16x16x32_bf16 v[80:83], v[224:227], v[184:187], v[80:83]
    ds_read_b64_tr_b16 v[212:213], v54 offset:0
    v_mfma_f32_16x16x32_bf16 v[76:79], v[220:223], v[184:187], v[76:79]
    ds_read_b64_tr_b16 v[214:215], v54 offset:1024
    v_mfma_f32_16x16x32_bf16 v[92:95], v[220:223], v[188:191], v[92:95]
    ds_read_b128 v[164:167], v46 offset:4096
    v_mfma_f32_16x16x32_bf16 v[96:99], v[224:227], v[188:191], v[96:99]
    ds_read_b64_tr_b16 v[216:217], v55 offset:0
    v_mfma_f32_16x16x32_bf16 v[100:103], v[228:231], v[188:191], v[100:103]
    ds_read_b64_tr_b16 v[218:219], v55 offset:1024
    v_mfma_f32_16x16x32_bf16 v[104:107], v[232:235], v[188:191], v[104:107]
    ds_read_b128 v[168:171], v46 offset:6144
    v_mfma_f32_16x16x32_bf16 v[120:123], v[232:235], v[192:195], v[120:123]
    ds_read_b128 v[172:175], v46 offset:8192
    v_mfma_f32_16x16x32_bf16 v[116:119], v[228:231], v[192:195], v[116:119]
    ds_read_b128 v[176:179], v46 offset:10240
    v_mfma_f32_16x16x32_bf16 v[112:115], v[224:227], v[192:195], v[112:115]
    v_mfma_f32_16x16x32_bf16 v[108:111], v[220:223], v[192:195], v[108:111]
    v_mfma_f32_16x16x32_bf16 v[124:127], v[220:223], v[196:199], v[124:127]
    v_mfma_f32_16x16x32_bf16 v[128:131], v[224:227], v[196:199], v[128:131]
    v_mfma_f32_16x16x32_bf16 v[132:135], v[228:231], v[196:199], v[132:135]
    v_mfma_f32_16x16x32_bf16 v[136:139], v[232:235], v[196:199], v[136:139]
    v_mfma_f32_16x16x32_bf16 v[152:155], v[232:235], v[200:203], v[152:155]
    v_mfma_f32_16x16x32_bf16 v[148:151], v[228:231], v[200:203], v[148:151]
    v_mfma_f32_16x16x32_bf16 v[144:147], v[224:227], v[200:203], v[144:147]
    v_mfma_f32_16x16x32_bf16 v[140:143], v[220:223], v[200:203], v[140:143]
    s_waitcnt lgkmcnt(0)
    v_mfma_f32_16x16x32_bf16 v[60:63], v[204:207], v[156:159], v[60:63]
    ds_read_b64_tr_b16 v[220:221], v52 offset:8192
    v_mfma_f32_16x16x32_bf16 v[64:67], v[208:211], v[156:159], v[64:67]
    ds_read_b64_tr_b16 v[222:223], v52 offset:9216
    v_mfma_f32_16x16x32_bf16 v[68:71], v[212:215], v[156:159], v[68:71]
    ds_read_b128 v[180:183], v47 offset:0
    v_mfma_f32_16x16x32_bf16 v[72:75], v[216:219], v[156:159], v[72:75]
    ds_read_b64_tr_b16 v[224:225], v53 offset:8192
    v_mfma_f32_16x16x32_bf16 v[88:91], v[216:219], v[160:163], v[88:91]
    ds_read_b64_tr_b16 v[226:227], v53 offset:9216
    v_mfma_f32_16x16x32_bf16 v[84:87], v[212:215], v[160:163], v[84:87]
    ds_read_b128 v[184:187], v47 offset:2048
    v_mfma_f32_16x16x32_bf16 v[80:83], v[208:211], v[160:163], v[80:83]
    ds_read_b64_tr_b16 v[228:229], v54 offset:8192
    v_mfma_f32_16x16x32_bf16 v[76:79], v[204:207], v[160:163], v[76:79]
    ds_read_b64_tr_b16 v[230:231], v54 offset:9216
    v_mfma_f32_16x16x32_bf16 v[92:95], v[204:207], v[164:167], v[92:95]
    ds_read_b128 v[188:191], v47 offset:4096
    v_mfma_f32_16x16x32_bf16 v[96:99], v[208:211], v[164:167], v[96:99]
    ds_read_b64_tr_b16 v[232:233], v55 offset:8192
    v_mfma_f32_16x16x32_bf16 v[100:103], v[212:215], v[164:167], v[100:103]
    ds_read_b64_tr_b16 v[234:235], v55 offset:9216
    v_mfma_f32_16x16x32_bf16 v[104:107], v[216:219], v[164:167], v[104:107]
    ds_read_b128 v[192:195], v47 offset:6144
    v_mfma_f32_16x16x32_bf16 v[120:123], v[216:219], v[168:171], v[120:123]
    ds_read_b128 v[196:199], v47 offset:8192
    v_mfma_f32_16x16x32_bf16 v[116:119], v[212:215], v[168:171], v[116:119]
    ds_read_b128 v[200:203], v47 offset:10240
    v_mfma_f32_16x16x32_bf16 v[112:115], v[208:211], v[168:171], v[112:115]
    v_mfma_f32_16x16x32_bf16 v[108:111], v[204:207], v[168:171], v[108:111]
    v_mfma_f32_16x16x32_bf16 v[124:127], v[204:207], v[172:175], v[124:127]
    v_mfma_f32_16x16x32_bf16 v[128:131], v[208:211], v[172:175], v[128:131]
    v_mfma_f32_16x16x32_bf16 v[132:135], v[212:215], v[172:175], v[132:135]
    v_mfma_f32_16x16x32_bf16 v[136:139], v[216:219], v[172:175], v[136:139]
    v_mfma_f32_16x16x32_bf16 v[152:155], v[216:219], v[176:179], v[152:155]
    v_mfma_f32_16x16x32_bf16 v[148:151], v[212:215], v[176:179], v[148:151]
    v_mfma_f32_16x16x32_bf16 v[144:147], v[208:211], v[176:179], v[144:147]
    v_mfma_f32_16x16x32_bf16 v[140:143], v[204:207], v[176:179], v[140:143]
    s_waitcnt lgkmcnt(0)
    s_barrier
    v_mfma_f32_16x16x32_bf16 v[60:63], v[220:223], v[180:183], v[60:63]
    ds_read_b64_tr_b16 v[204:205], v48 offset:0
    v_mfma_f32_16x16x32_bf16 v[64:67], v[224:227], v[180:183], v[64:67]
    ds_read_b64_tr_b16 v[206:207], v48 offset:1024
    v_mfma_f32_16x16x32_bf16 v[68:71], v[228:231], v[180:183], v[68:71]
    ds_read_b128 v[156:159], v44 offset:0
    v_mfma_f32_16x16x32_bf16 v[72:75], v[232:235], v[180:183], v[72:75]
    ds_read_b64_tr_b16 v[208:209], v49 offset:0
    v_mfma_f32_16x16x32_bf16 v[88:91], v[232:235], v[184:187], v[88:91]
    ds_read_b64_tr_b16 v[210:211], v49 offset:1024
    v_mfma_f32_16x16x32_bf16 v[84:87], v[228:231], v[184:187], v[84:87]
    ds_read_b128 v[160:163], v44 offset:2048
    v_mfma_f32_16x16x32_bf16 v[80:83], v[224:227], v[184:187], v[80:83]
    ds_read_b64_tr_b16 v[212:213], v50 offset:0
    v_mfma_f32_16x16x32_bf16 v[76:79], v[220:223], v[184:187], v[76:79]
    ds_read_b64_tr_b16 v[214:215], v50 offset:1024
    v_mfma_f32_16x16x32_bf16 v[92:95], v[220:223], v[188:191], v[92:95]
    ds_read_b128 v[164:167], v44 offset:4096
    v_mfma_f32_16x16x32_bf16 v[96:99], v[224:227], v[188:191], v[96:99]
    ds_read_b64_tr_b16 v[216:217], v51 offset:0
    v_mfma_f32_16x16x32_bf16 v[100:103], v[228:231], v[188:191], v[100:103]
    ds_read_b64_tr_b16 v[218:219], v51 offset:1024
    v_mfma_f32_16x16x32_bf16 v[104:107], v[232:235], v[188:191], v[104:107]
    ds_read_b128 v[168:171], v44 offset:6144
    v_mfma_f32_16x16x32_bf16 v[120:123], v[232:235], v[192:195], v[120:123]
    ds_read_b128 v[172:175], v44 offset:8192
    v_mfma_f32_16x16x32_bf16 v[116:119], v[228:231], v[192:195], v[116:119]
    ds_read_b128 v[176:179], v44 offset:10240
    v_mfma_f32_16x16x32_bf16 v[112:115], v[224:227], v[192:195], v[112:115]
    v_mfma_f32_16x16x32_bf16 v[108:111], v[220:223], v[192:195], v[108:111]
    v_mfma_f32_16x16x32_bf16 v[124:127], v[220:223], v[196:199], v[124:127]
    v_mfma_f32_16x16x32_bf16 v[128:131], v[224:227], v[196:199], v[128:131]
    v_mfma_f32_16x16x32_bf16 v[132:135], v[228:231], v[196:199], v[132:135]
    v_mfma_f32_16x16x32_bf16 v[136:139], v[232:235], v[196:199], v[136:139]
    v_mfma_f32_16x16x32_bf16 v[152:155], v[232:235], v[200:203], v[152:155]
    v_mfma_f32_16x16x32_bf16 v[148:151], v[228:231], v[200:203], v[148:151]
    v_mfma_f32_16x16x32_bf16 v[144:147], v[224:227], v[200:203], v[144:147]
    v_mfma_f32_16x16x32_bf16 v[140:143], v[220:223], v[200:203], v[140:143]
    s_waitcnt lgkmcnt(0)
    v_mfma_f32_16x16x32_bf16 v[60:63], v[204:207], v[156:159], v[60:63]
    ds_read_b64_tr_b16 v[220:221], v48 offset:8192
    v_mfma_f32_16x16x32_bf16 v[64:67], v[208:211], v[156:159], v[64:67]
    ds_read_b64_tr_b16 v[222:223], v48 offset:9216
    v_mfma_f32_16x16x32_bf16 v[68:71], v[212:215], v[156:159], v[68:71]
    ds_read_b128 v[180:183], v45 offset:0
    v_mfma_f32_16x16x32_bf16 v[72:75], v[216:219], v[156:159], v[72:75]
    ds_read_b64_tr_b16 v[224:225], v49 offset:8192
    v_mfma_f32_16x16x32_bf16 v[88:91], v[216:219], v[160:163], v[88:91]
    ds_read_b64_tr_b16 v[226:227], v49 offset:9216
    v_mfma_f32_16x16x32_bf16 v[84:87], v[212:215], v[160:163], v[84:87]
    ds_read_b128 v[184:187], v45 offset:2048
    v_mfma_f32_16x16x32_bf16 v[80:83], v[208:211], v[160:163], v[80:83]
    ds_read_b64_tr_b16 v[228:229], v50 offset:8192
    v_mfma_f32_16x16x32_bf16 v[76:79], v[204:207], v[160:163], v[76:79]
    ds_read_b64_tr_b16 v[230:231], v50 offset:9216
    v_mfma_f32_16x16x32_bf16 v[92:95], v[204:207], v[164:167], v[92:95]
    ds_read_b128 v[188:191], v45 offset:4096
    v_mfma_f32_16x16x32_bf16 v[96:99], v[208:211], v[164:167], v[96:99]
    ds_read_b64_tr_b16 v[232:233], v51 offset:8192
    v_mfma_f32_16x16x32_bf16 v[100:103], v[212:215], v[164:167], v[100:103]
    ds_read_b64_tr_b16 v[234:235], v51 offset:9216
    v_mfma_f32_16x16x32_bf16 v[104:107], v[216:219], v[164:167], v[104:107]
    ds_read_b128 v[192:195], v45 offset:6144
    v_mfma_f32_16x16x32_bf16 v[120:123], v[216:219], v[168:171], v[120:123]
    ds_read_b128 v[196:199], v45 offset:8192
    v_mfma_f32_16x16x32_bf16 v[116:119], v[212:215], v[168:171], v[116:119]
    ds_read_b128 v[200:203], v45 offset:10240
    v_mfma_f32_16x16x32_bf16 v[112:115], v[208:211], v[168:171], v[112:115]
    v_mfma_f32_16x16x32_bf16 v[108:111], v[204:207], v[168:171], v[108:111]
    v_mfma_f32_16x16x32_bf16 v[124:127], v[204:207], v[172:175], v[124:127]
    v_mfma_f32_16x16x32_bf16 v[128:131], v[208:211], v[172:175], v[128:131]
    v_mfma_f32_16x16x32_bf16 v[132:135], v[212:215], v[172:175], v[132:135]
    v_mfma_f32_16x16x32_bf16 v[136:139], v[216:219], v[172:175], v[136:139]
    v_mfma_f32_16x16x32_bf16 v[152:155], v[216:219], v[176:179], v[152:155]
    v_mfma_f32_16x16x32_bf16 v[148:151], v[212:215], v[176:179], v[148:151]
    v_mfma_f32_16x16x32_bf16 v[144:147], v[208:211], v[176:179], v[144:147]
    v_mfma_f32_16x16x32_bf16 v[140:143], v[204:207], v[176:179], v[140:143]
    s_waitcnt lgkmcnt(0)
    s_barrier
    v_mfma_f32_16x16x32_bf16 v[60:63], v[220:223], v[180:183], v[60:63]
    ds_read_b64_tr_b16 v[204:205], v48 offset:40960
    v_mfma_f32_16x16x32_bf16 v[64:67], v[224:227], v[180:183], v[64:67]
    ds_read_b64_tr_b16 v[206:207], v48 offset:41984
    v_mfma_f32_16x16x32_bf16 v[68:71], v[228:231], v[180:183], v[68:71]
    ds_read_b128 v[156:159], v44 offset:40960
    v_mfma_f32_16x16x32_bf16 v[72:75], v[232:235], v[180:183], v[72:75]
    ds_read_b64_tr_b16 v[208:209], v49 offset:40960
    v_mfma_f32_16x16x32_bf16 v[88:91], v[232:235], v[184:187], v[88:91]
    ds_read_b64_tr_b16 v[210:211], v49 offset:41984
    v_mfma_f32_16x16x32_bf16 v[84:87], v[228:231], v[184:187], v[84:87]
    ds_read_b128 v[160:163], v44 offset:43008
    v_mfma_f32_16x16x32_bf16 v[80:83], v[224:227], v[184:187], v[80:83]
    ds_read_b64_tr_b16 v[212:213], v50 offset:40960
    v_mfma_f32_16x16x32_bf16 v[76:79], v[220:223], v[184:187], v[76:79]
    ds_read_b64_tr_b16 v[214:215], v50 offset:41984
    v_mfma_f32_16x16x32_bf16 v[92:95], v[220:223], v[188:191], v[92:95]
    ds_read_b128 v[164:167], v44 offset:45056
    v_mfma_f32_16x16x32_bf16 v[96:99], v[224:227], v[188:191], v[96:99]
    ds_read_b64_tr_b16 v[216:217], v51 offset:40960
    v_mfma_f32_16x16x32_bf16 v[100:103], v[228:231], v[188:191], v[100:103]
    ds_read_b64_tr_b16 v[218:219], v51 offset:41984
    v_mfma_f32_16x16x32_bf16 v[104:107], v[232:235], v[188:191], v[104:107]
    ds_read_b128 v[168:171], v44 offset:47104
    v_mfma_f32_16x16x32_bf16 v[120:123], v[232:235], v[192:195], v[120:123]
    ds_read_b128 v[172:175], v44 offset:49152
    v_mfma_f32_16x16x32_bf16 v[116:119], v[228:231], v[192:195], v[116:119]
    ds_read_b128 v[176:179], v44 offset:51200
    v_mfma_f32_16x16x32_bf16 v[112:115], v[224:227], v[192:195], v[112:115]
    s_sub_u32 s54, s54, 1
    v_mfma_f32_16x16x32_bf16 v[108:111], v[220:223], v[192:195], v[108:111]
    s_cmp_lg_u32 s54, 0
    v_mfma_f32_16x16x32_bf16 v[124:127], v[220:223], v[196:199], v[124:127]
    v_mfma_f32_16x16x32_bf16 v[128:131], v[224:227], v[196:199], v[128:131]
    v_mfma_f32_16x16x32_bf16 v[132:135], v[228:231], v[196:199], v[132:135]
    v_mfma_f32_16x16x32_bf16 v[136:139], v[232:235], v[196:199], v[136:139]
    v_mfma_f32_16x16x32_bf16 v[152:155], v[232:235], v[200:203], v[152:155]
    v_mfma_f32_16x16x32_bf16 v[148:151], v[228:231], v[200:203], v[148:151]
    v_mfma_f32_16x16x32_bf16 v[144:147], v[224:227], v[200:203], v[144:147]
    v_mfma_f32_16x16x32_bf16 v[140:143], v[220:223], v[200:203], v[140:143]
    s_cbranch_scc1 K_CLOOP
    s_waitcnt lgkmcnt(0)
    v_mfma_f32_16x16x32_bf16 v[60:63], v[204:207], v[156:159], v[60:63]
    ds_read_b128 v[180:183], v45 offset:40960
    ds_read_b64_tr_b16 v[220:221], v48 offset:49152
    v_mfma_f32_16x16x32_bf16 v[64:67], v[208:211], v[156:159], v[64:67]
    ds_read_b64_tr_b16 v[222:223], v48 offset:50176
    ds_read_b64_tr_b16 v[224:225], v49 offset:49152
    v_mfma_f32_16x16x32_bf16 v[68:71], v[212:215], v[156:159], v[68:71]
    ds_read_b64_tr_b16 v[226:227], v49 offset:50176
    ds_read_b64_tr_b16 v[228:229], v50 offset:49152
    v_mfma_f32_16x16x32_bf16 v[72:75], v[216:219], v[156:159], v[72:75]
    ds_read_b64_tr_b16 v[230:231], v50 offset:50176
    ds_read_b64_tr_b16 v[232:233], v51 offset:49152
    v_mfma_f32_16x16x32_bf16 v[76:79], v[204:207], v[160:163], v[76:79]
    ds_read_b64_tr_b16 v[234:235], v51 offset:50176
    ds_read_b128 v[184:187], v45 offset:43008
    v_mfma_f32_16x16x32_bf16 v[80:83], v[208:211], v[160:163], v[80:83]
    ds_read_b128 v[188:191], v45 offset:45056
    ds_read_b128 v[192:195], v45 offset:47104
    v_mfma_f32_16x16x32_bf16 v[84:87], v[212:215], v[160:163], v[84:87]
    ds_read_b128 v[196:199], v45 offset:49152
    ds_read_b128 v[200:203], v45 offset:51200
    v_mfma_f32_16x16x32_bf16 v[88:91], v[216:219], v[160:163], v[88:91]
    s_waitcnt lgkmcnt(11)
    v_mfma_f32_16x16x32_bf16 v[60:63], v[220:223], v[180:183], v[60:63]
    s_nop 1
    s_waitcnt lgkmcnt(9)
    v_mfma_f32_16x16x32_bf16 v[64:67], v[224:227], v[180:183], v[64:67]
    s_nop 1
    s_waitcnt lgkmcnt(7)
    v_mfma_f32_16x16x32_bf16 v[68:71], v[228:231], v[180:183], v[68:71]
    v_cvt_pk_bf16_f32 v60, v60, v61
    v_cvt_pk_bf16_f32 v61, v62, v63
    s_waitcnt lgkmcnt(5)
    v_mfma_f32_16x16x32_bf16 v[72:75], v[232:235], v[180:183], v[72:75]
    ds_write_b64 v56, v[60:61] offset:0
    s_waitcnt lgkmcnt(5)
    v_mfma_f32_16x16x32_bf16 v[76:79], v[220:223], v[184:187], v[76:79]
    v_cvt_pk_bf16_f32 v64, v64, v65
    v_cvt_pk_bf16_f32 v65, v66, v67
    v_mfma_f32_16x16x32_bf16 v[80:83], v[224:227], v[184:187], v[80:83]
    ds_write_b64 v56, v[64:65] offset:32
    v_mfma_f32_16x16x32_bf16 v[84:87], v[228:231], v[184:187], v[84:87]
    v_cvt_pk_bf16_f32 v68, v68, v69
    v_cvt_pk_bf16_f32 v69, v70, v71
    v_mfma_f32_16x16x32_bf16 v[88:91], v[232:235], v[184:187], v[88:91]
    ds_write_b64 v56, v[68:69] offset:64
    v_mfma_f32_16x16x32_bf16 v[92:95], v[204:207], v[164:167], v[92:95]
    v_cvt_pk_bf16_f32 v72, v72, v73
    v_cvt_pk_bf16_f32 v73, v74, v75
    v_mfma_f32_16x16x32_bf16 v[96:99], v[208:211], v[164:167], v[96:99]
    ds_write_b64 v56, v[72:73] offset:96
    v_mfma_f32_16x16x32_bf16 v[100:103], v[212:215], v[164:167], v[100:103]
    v_cvt_pk_bf16_f32 v76, v76, v77
    v_cvt_pk_bf16_f32 v77, v78, v79
    v_mfma_f32_16x16x32_bf16 v[104:107], v[216:219], v[164:167], v[104:107]
    ds_write_b64 v56, v[76:77] offset:4352
    s_waitcnt lgkmcnt(8)
    v_mfma_f32_16x16x32_bf16 v[92:95], v[220:223], v[188:191], v[92:95]
    v_cvt_pk_bf16_f32 v80, v80, v81
    v_cvt_pk_bf16_f32 v81, v82, v83
    v_mfma_f32_16x16x32_bf16 v[96:99], v[224:227], v[188:191], v[96:99]
    ds_write_b64 v56, v[80:81] offset:4384
    v_mfma_f32_16x16x32_bf16 v[100:103], v[228:231], v[188:191], v[100:103]
    v_cvt_pk_bf16_f32 v84, v84, v85
    v_cvt_pk_bf16_f32 v85, v86, v87
    v_mfma_f32_16x16x32_bf16 v[104:107], v[232:235], v[188:191], v[104:107]
    ds_write_b64 v56, v[84:85] offset:4416
    v_mfma_f32_16x16x32_bf16 v[108:111], v[204:207], v[168:171], v[108:111]
    v_cvt_pk_bf16_f32 v88, v88, v89
    v_cvt_pk_bf16_f32 v89, v90, v91
    v_mfma_f32_16x16x32_bf16 v[112:115], v[208:211], v[168:171], v[112:115]
    ds_write_b64 v56, v[88:89] offset:4448
    v_mfma_f32_16x16x32_bf16 v[116:119], v[212:215], v[168:171], v[116:119]
    v_cvt_pk_bf16_f32 v92, v92, v93
    v_cvt_pk_bf16_f32 v93, v94, v95
    v_mfma_f32_16x16x32_bf16 v[120:123], v[216:219], v[168:171], v[120:123]
    ds_write_b64 v56, v[92:93] offset:8704
    s_waitcnt lgkmcnt(11)
    v_mfma_f32_16x16x32_bf16 v[108:111], v[220:223], v[192:195], v[108:111]
    v_cvt_pk_bf16_f32 v96, v96, v97
    v_cvt_pk_bf16_f32 v97, v98, v99
    v_mfma_f32_16x16x32_bf16 v[112:115], v[224:227], v[192:195], v[112:115]
    ds_write_b64 v56, v[96:97] offset:8736
    v_mfma_f32_16x16x32_bf16 v[116:119], v[228:231], v[192:195], v[116:119]
    v_cvt_pk_bf16_f32 v100, v100, v101
    v_cvt_pk_bf16_f32 v101, v102, v103
    v_mfma_f32_16x16x32_bf16 v[120:123], v[232:235], v[192:195], v[120:123]
    ds_write_b64 v56, v[100:101] offset:8768
    v_mfma_f32_16x16x32_bf16 v[124:127], v[204:207], v[172:175], v[124:127]
    v_cvt_pk_bf16_f32 v104, v104, v105
    v_cvt_pk_bf16_f32 v105, v106, v107
    v_mfma_f32_16x16x32_bf16 v[128:131], v[208:211], v[172:175], v[128:131]
    ds_write_b64 v56, v[104:105] offset:8800
    v_mfma_f32_16x16x32_bf16 v[132:135], v[212:215], v[172:175], v[132:135]
    v_cvt_pk_bf16_f32 v108, v108, v109
    v_cvt_pk_bf16_f32 v109, v110, v111
    v_mfma_f32_16x16x32_bf16 v[136:139], v[216:219], v[172:175], v[136:139]
    ds_write_b64 v56, v[108:109] offset:13056
    s_waitcnt lgkmcnt(14)
    v_mfma_f32_16x16x32_bf16 v[124:127], v[220:223], v[196:199], v[124:127]
    v_cvt_pk_bf16_f32 v112, v112, v113
    v_cvt_pk_bf16_f32 v113, v114, v115
    v_mfma_f32_16x16x32_bf16 v[128:131], v[224:227], v[196:199], v[128:131]
    ds_write_b64 v56, v[112:113] offset:13088
    v_mfma_f32_16x16x32_bf16 v[132:135], v[228:231], v[196:199], v[132:135]
    v_cvt_pk_bf16_f32 v116, v116, v117
    v_cvt_pk_bf16_f32 v117, v118, v119
    v_mfma_f32_16x16x32_bf16 v[136:139], v[232:235], v[196:199], v[136:139]
    ds_write_b64 v56, v[116:117] offset:13120
    v_mfma_f32_16x16x32_bf16 v[140:143], v[204:207], v[176:179], v[140:143]
    v_cvt_pk_bf16_f32 v120, v120, v121
    v_cvt_pk_bf16_f32 v121, v122, v123
    v_mfma_f32_16x16x32_bf16 v[144:147], v[208:211], v[176:179], v[144:147]
    ds_write_b64 v56, v[120:121] offset:13152
    v_mfma_f32_16x16x32_bf16 v[148:151], v[212:215], v[176:179], v[148:151]
    v_cvt_pk_bf16_f32 v124, v124, v125
    v_cvt_pk_bf16_f32 v125, v126, v127
    v_mfma_f32_16x16x32_bf16 v[152:155], v[216:219], v[176:179], v[152:155]
    ds_write_b64 v56, v[124:125] offset:17408
    s_waitcnt lgkmcnt(15)
    v_mfma_f32_16x16x32_bf16 v[140:143], v[220:223], v[200:203], v[140:143]
    v_cvt_pk_bf16_f32 v128, v128, v129
    v_cvt_pk_bf16_f32 v129, v130, v131
    v_mfma_f32_16x16x32_bf16 v[144:147], v[224:227], v[200:203], v[144:147]
    ds_write_b64 v56, v[128:129] offset:17440
    v_mfma_f32_16x16x32_bf16 v[148:151], v[228:231], v[200:203], v[148:151]
    v_cvt_pk_bf16_f32 v132, v132, v133
    v_cvt_pk_bf16_f32 v133, v134, v135
    v_mfma_f32_16x16x32_bf16 v[152:155], v[232:235], v[200:203], v[152:155]
    ds_write_b64 v56, v[132:133] offset:17472
    v_cvt_pk_bf16_f32 v136, v136, v137
    v_cvt_pk_bf16_f32 v137, v138, v139
    v_cvt_pk_bf16_f32 v140, v140, v141
    v_cvt_pk_bf16_f32 v141, v142, v143
    v_cvt_pk_bf16_f32 v144, v144, v145
    v_cvt_pk_bf16_f32 v145, v146, v147
    v_cvt_pk_bf16_f32 v148, v148, v149
    v_cvt_pk_bf16_f32 v149, v150, v151
    v_cvt_pk_bf16_f32 v152, v152, v153
    v_cvt_pk_bf16_f32 v153, v154, v155
    ds_write_b64 v56, v[136:137] offset:17504
    ds_write_b64 v56, v[140:141] offset:21760
    ds_write_b64 v56, v[144:145] offset:21792
    ds_write_b64 v56, v[148:149] offset:21824
    ds_write_b64 v56, v[152:153] offset:21856
    s_setprio 0
    s_branch WS_attd
.p2align 12
WP_attd:
    s_setpc_b64 s[38:39]
WS_attd:
    s_waitcnt lgkmcnt(0)
    s_barrier
    ds_read_b64 v[60:61], v13 offset:80
    ds_read_b64 v[62:63], v14 offset:80
    ds_read_b64 v[44:45], v13 offset:4352
    ds_read_b64 v[46:47], v19 offset:4352
    ds_read_b64 v[64:65], v13 offset:4432
    ds_read_b64 v[66:67], v14 offset:4432
    ds_read_b64 v[72:73], v13 offset:120
    ds_read_b64 v[74:75], v14 offset:120
    ds_read_b64 v[48:49], v13 offset:4392
    ds_read_b64 v[50:51], v20 offset:4352
    ds_read_b64 v[76:77], v13 offset:4472
    ds_read_b64 v[78:79], v14 offset:4472
    ds_read_b64 v[52:53], v13 offset:8704
    ds_read_b64 v[54:55], v19 offset:8704
    ds_read_b64 v[68:69], v13 offset:8784
    ds_read_b64 v[70:71], v14 offset:8784
    s_waitcnt lgkmcnt(10)
    v_mfma_f32_16x16x32_bf16 v[116:119], v[60:63], v[44:47], v[36:39]
    v_mfma_f32_16x16x32_bf16 v[120:123], v[64:67], v[44:47], v[32:35]
    ds_read_b64 v[56:57], v13 offset:8744
    ds_read_b64 v[58:59], v20 offset:8704
    ds_read_b64 v[80:81], v13 offset:8824
    ds_read_b64 v[82:83], v14 offset:8824
    s_waitcnt lgkmcnt(8)
    v_mfma_f32_16x16x32_bf16 v[124:127], v[72:75], v[48:51], v[36:39]
    v_mfma_f32_16x16x32_bf16 v[128:131], v[76:79], v[48:51], v[32:35]
    s_waitcnt lgkmcnt(4)
    v_mfma_f32_16x16x32_bf16 v[132:135], v[64:67], v[52:55], v[28:31]
    v_mfma_f32_16x16x32_bf16 v[136:139], v[68:71], v[52:55], v[32:35]
    s_waitcnt lgkmcnt(0)
    v_mfma_f32_16x16x32_bf16 v[140:143], v[76:79], v[56:59], v[28:31]
    v_mfma_f32_16x16x32_bf16 v[144:147], v[80:83], v[56:59], v[32:35]
    ds_read_b64_tr_b16 v[84:85], v15 offset:160
    ds_read_b64_tr_b16 v[86:87], v15 offset:4512
    ds_read_b64_tr_b16 v[100:101], v21 offset:0
    ds_read_b64_tr_b16 v[102:103], v21 offset:4352
    ds_read_b64_tr_b16 v[92:93], v15 offset:200
    ds_read_b64_tr_b16 v[94:95], v15 offset:4552
    ds_read_b64_tr_b16 v[104:105], v22 offset:0
    ds_read_b64_tr_b16 v[106:107], v22 offset:4352
    ds_read_b64_tr_b16 v[88:89], v15 offset:8864
    ds_read_b64_tr_b16 v[108:109], v23 offset:4352
    ds_read_b64_tr_b16 v[110:111], v23 offset:8704
    ds_read_b64_tr_b16 v[96:97], v15 offset:8904
    ds_read_b64_tr_b16 v[112:113], v24 offset:4352
    ds_read_b64_tr_b16 v[114:115], v24 offset:8704
    v_max3_f32 v184, v116, v117, v120
    v_max3_f32 v185, v118, v119, v122
    v_max_f32 v184, v184, v121
    v_max_f32 v185, v185, v123
    v_max3_f32 v186, v124, v125, v128
    v_max3_f32 v187, v126, v127, v130
    v_max_f32 v186, v186, v129
    v_max_f32 v187, v187, v131
    v_max3_f32 v188, v132, v133, v136
    v_max3_f32 v189, v134, v135, v138
    v_max_f32 v188, v188, v137
    v_max_f32 v189, v189, v139
    v_max3_f32 v190, v140, v141, v144
    v_max3_f32 v191, v142, v143, v146
    v_max_f32 v190, v190, v145
    v_max_f32 v191, v191, v147
    v_cvt_pk_bf16_f32 v192, v184, v185
    v_cvt_pk_bf16_f32 v193, v186, v187
    v_cvt_pk_bf16_f32 v194, v188, v189
    v_cvt_pk_bf16_f32 v195, v190, v191
    v_lshlrev_b32 v184, 16, v192
    v_and_b32 v185, 0xffff0000, v192
    v_lshlrev_b32 v186, 16, v193
    v_and_b32 v187, 0xffff0000, v193
    v_lshlrev_b32 v188, 16, v194
    v_and_b32 v189, 0xffff0000, v194
    v_lshlrev_b32 v190, 16, v195
    v_and_b32 v191, 0xffff0000, v195
    v_pk_mul_f32 v[184:185], v[184:185], s[48:49]
    v_pk_mul_f32 v[186:187], v[186:187], s[48:49]
    v_pk_mul_f32 v[188:189], v[188:189], s[48:49]
    v_pk_mul_f32 v[190:191], v[190:191], s[48:49]
    v_cvt_pk_bf16_f32 v192, v184, v185
    v_cvt_pk_bf16_f32 v193, v186, v187
    v_cvt_pk_bf16_f32 v194, v188, v189
    v_cvt_pk_bf16_f32 v195, v190, v191
    v_permlane16_swap_b32 v192, v193
    s_nop 0
    v_permlane16_swap_b32 v194, v195
    s_nop 1
    v_permlane32_swap_b32 v192, v194
    v_permlane32_swap_b32 v193, v195
    v_lshlrev_b32 v184, 16, v192
    v_and_b32 v185, 0xffff0000, v192
    v_lshlrev_b32 v188, 16, v194
    v_and_b32 v189, 0xffff0000, v194
    v_lshlrev_b32 v186, 16, v193
    v_and_b32 v187, 0xffff0000, v193
    v_lshlrev_b32 v190, 16, v195
    v_and_b32 v191, 0xffff0000, v195
    v_max3_f32 v196, v184, v185, v188
    v_max3_f32 v197, v189, v186, v187
    v_max3_f32 v196, v196, v190, v191
    v_max_f32 v196, v196, v197
    v_mul_f32 v196, s46, v196
    v_pk_fma_f32 v[184:185], v[184:185], s[46:47], v[196:197] op_sel_hi:[1,1,0] neg_lo:[0,0,1] neg_hi:[0,0,1]
    v_pk_fma_f32 v[186:187], v[186:187], s[46:47], v[196:197] op_sel_hi:[1,1,0] neg_lo:[0,0,1] neg_hi:[0,0,1]
    v_pk_fma_f32 v[188:189], v[188:189], s[46:47], v[196:197] op_sel_hi:[1,1,0] neg_lo:[0,0,1] neg_hi:[0,0,1]
    v_pk_fma_f32 v[190:191], v[190:191], s[46:47], v[196:197] op_sel_hi:[1,1,0] neg_lo:[0,0,1] neg_hi:[0,0,1]
    v_exp_f32 v184, v184
    v_exp_f32 v185, v185
    v_exp_f32 v186, v186
    v_exp_f32 v187, v187
    v_exp_f32 v188, v188
    v_exp_f32 v189, v189
    v_exp_f32 v190, v190
    v_exp_f32 v191, v191
    v_pk_add_f32 v[200:201], v[184:185], v[186:187]
    v_pk_add_f32 v[202:203], v[188:189], v[190:191]
    v_pk_add_f32 v[200:201], v[200:201], v[202:203]
    v_add_f32 v200, v200, v201
    v_rcp_f32 v200, v200
    s_waitcnt lgkmcnt(0)
    v_pk_mul_f32 v[184:185], v[184:185], v[200:201] op_sel_hi:[1,0]
    v_pk_mul_f32 v[186:187], v[186:187], v[200:201] op_sel_hi:[1,0]
    v_pk_mul_f32 v[188:189], v[188:189], v[200:201] op_sel_hi:[1,0]
    v_pk_mul_f32 v[190:191], v[190:191], v[200:201] op_sel_hi:[1,0]
    v_cvt_pk_bf16_f32 v192, v184, v185
    v_cvt_pk_bf16_f32 v194, v188, v189
    v_cvt_pk_bf16_f32 v193, v186, v187
    v_cvt_pk_bf16_f32 v195, v190, v191
    v_permlane32_swap_b32 v192, v194
    s_nop 0
    v_permlane32_swap_b32 v193, v195
    s_nop 1
    v_permlane16_swap_b32 v192, v193
    v_permlane16_swap_b32 v194, v195
    v_perm_b32 v148, v192, v192, v40
    v_perm_b32 v149, v192, v192, v41
    v_perm_b32 v150, v192, v192, v42
    v_perm_b32 v151, v192, v192, v43
    v_perm_b32 v152, v193, v193, v40
    v_perm_b32 v153, v193, v193, v41
    v_perm_b32 v154, v193, v193, v42
    v_perm_b32 v155, v193, v193, v43
    v_mfma_f32_16x16x32_bf16 v[164:167], v[84:87], v[148:151], 0
    v_mfma_f32_16x16x32_bf16 v[180:183], v[100:103], v[148:151], 0
    v_perm_b32 v156, v194, v194, v40
    v_perm_b32 v157, v194, v194, v41
    v_perm_b32 v158, v194, v194, v42
    v_perm_b32 v159, v194, v194, v43
    v_mfma_f32_16x16x32_bf16 v[168:171], v[92:95], v[152:155], 0
    v_mfma_f32_16x16x32_bf16 v[180:183], v[104:107], v[152:155], v[180:183]
    v_perm_b32 v160, v195, v195, v40
    v_perm_b32 v161, v195, v195, v41
    v_perm_b32 v162, v195, v195, v42
    v_perm_b32 v163, v195, v195, v43
    v_mfma_f32_16x16x32_bf16 v[172:175], v[86:89], v[156:159], 0
    v_mfma_f32_16x16x32_bf16 v[180:183], v[108:111], v[156:159], v[180:183]
    v_mfma_f32_16x16x32_bf16 v[176:179], v[94:97], v[160:163], 0
    v_mfma_f32_16x16x32_bf16 v[180:183], v[112:115], v[160:163], v[180:183]
    v_cvt_pk_bf16_f32 v204, v164, v165
    v_cvt_pk_bf16_f32 v205, v166, v167
    v_cvt_pk_bf16_f32 v206, v168, v169
    v_cvt_pk_bf16_f32 v207, v170, v171
    buffer_store_dwordx4 v[204:207], v16, s[20:23], s50 offen sc1
    v_cvt_pk_bf16_f32 v208, v172, v173
    v_cvt_pk_bf16_f32 v209, v174, v175
    v_cvt_pk_bf16_f32 v210, v176, v177
    v_cvt_pk_bf16_f32 v211, v178, v179
    v_cvt_pk_bf16_f32 v200, v180, v181
    v_cvt_pk_bf16_f32 v201, v182, v183
    v_cvt_pk_bf16_f32 v202, v180, v181
    v_cvt_pk_bf16_f32 v203, v182, v183
    buffer_store_dwordx4 v[208:211], v16, s[20:23], s51 offen sc1
    v_permlane16_swap_b32 v200, v202
    v_permlane16_swap_b32 v201, v203
    buffer_store_dwordx4 v[200:203], v17, s[20:23], s50 offen sc1
    s_cmp_lg_u32 s34, -1
    s_cbranch_scc1 K_P2_EARLY
K_DRAIN:
    s_waitcnt vmcnt(0)
    s_barrier
    s_branch K_END
K_W7A:
    s_waitcnt vmcnt(0)
    v_and_b32 v4, 7, v1
    v_lshlrev_b32 v4, 2, v4
    s_mov_b32 s3, 131072
K_ZPOLL5:
    v_cmp_eq_u32 vcc, 0, v7
    s_cbranch_vccz K_ZOK5
    s_sub_u32 s3, s3, 1
    s_cbranch_scc1 K_ZOK5
    global_load_dword v7, v4, s[8:9] offset:192 sc1
    s_waitcnt vmcnt(0)
    s_branch K_ZPOLL5
K_ZOK5:
    v_mov_b32 v4, 158720
    v_mov_b32 v3, 1
    s_mov_b64 exec, 1
    s_nop 0
    ds_add_rtn_u32 v2, v4, v3 offset:48
    s_mov_b32 exec_lo, s36
    v_mov_b32 v3, 1
    s_waitcnt lgkmcnt(0)
    v_readfirstlane_b32 s33, v2
    s_nop 3
    s_and_b32 s33, s33, 0xff
    s_cmp_lg_u32 s33, 7
    s_cbranch_scc1 K_ARR7
    global_store_dword v8, v3, s[10:11] sc1
K_ARR7:
    s_mov_b64 exec, -1
    s_barrier
    s_branch K_WOE
K_W7:
    v_mov_b32 v3, 0x100
    s_mov_b64 exec, 1
    s_waitcnt vmcnt(0)
    ds_add_u32 v4, v3 offset:48
    s_mov_b64 exec, -1
    s_branch K_P2_HELP
K_FLAG:
    s_waitcnt vmcnt(0)
    v_and_b32 v4, 7, v1
    v_lshlrev_b32 v4, 2, v4
    s_mov_b32 s3, 131072
K_ZPOLL0:
    v_cmp_eq_u32 vcc, 0, v7
    s_cbranch_vccz K_ZOK0
    s_sub_u32 s3, s3, 1
    s_cbranch_scc1 K_ZOK0
    global_load_dword v7, v4, s[8:9] offset:192 sc1
    s_waitcnt vmcnt(0)
    s_branch K_ZPOLL0
K_ZOK0:
    v_mov_b32 v3, 1
    s_mov_b32 exec_lo, s36
    s_mov_b32 exec_hi, 0
    s_setprio 3
    s_barrier
    global_store_dword v8, v3, s[10:11] sc1
    s_mov_b64 exec, -1
    s_branch K_END
WP_atts:
    s_setpc_b64 s[38:39]
K_JOIN_S:
    s_setprio 0
    s_barrier
    s_cmp_eq_u32 s30, 7
    s_cbranch_scc1 K_FLAG
    ds_read_b64 v[52:53], v13 offset:80
    ds_read_b64 v[54:55], v14 offset:80
    ds_read_b64 v[44:45], v13 offset:4352
    ds_read_b64 v[46:47], v19 offset:4352
    ds_read_b64 v[56:57], v13 offset:4432
    ds_read_b64 v[58:59], v14 offset:4432
    ds_read_b64 v[60:61], v13 offset:120
    ds_read_b64 v[62:63], v14 offset:120
    ds_read_b64 v[48:49], v13 offset:4392
    ds_read_b64 v[50:51], v20 offset:4352
    ds_read_b64 v[64:65], v13 offset:4472
    ds_read_b64 v[66:67], v14 offset:4472
    s_waitcnt lgkmcnt(6)
    v_mfma_f32_16x16x32_bf16 v[84:87], v[52:55], v[44:47], v[36:39]
    v_mfma_f32_16x16x32_bf16 v[88:91], v[56:59], v[44:47], v[32:35]
    s_waitcnt lgkmcnt(0)
    v_mfma_f32_16x16x32_bf16 v[92:95], v[60:63], v[48:51], v[36:39]
    v_mfma_f32_16x16x32_bf16 v[96:99], v[64:67], v[48:51], v[32:35]
    ds_read_b64_tr_b16 v[68:69], v15 offset:160
    ds_read_b64_tr_b16 v[70:71], v15 offset:4512
    ds_read_b64_tr_b16 v[76:77], v21 offset:0
    ds_read_b64_tr_b16 v[78:79], v21 offset:4352
    ds_read_b64_tr_b16 v[72:73], v15 offset:200
    ds_read_b64_tr_b16 v[74:75], v15 offset:4552
    ds_read_b64_tr_b16 v[80:81], v22 offset:0
    ds_read_b64_tr_b16 v[82:83], v22 offset:4352
    v_max3_f32 v120, v84, v85, v88
    v_max3_f32 v121, v86, v87, v90
    v_max_f32 v120, v120, v89
    v_max_f32 v121, v121, v91
    v_max3_f32 v122, v92, v93, v96
    v_max3_f32 v123, v94, v95, v98
    v_max_f32 v122, v122, v97
    v_max_f32 v123, v123, v99
    v_cvt_pk_bf16_f32 v124, v120, v121
    v_cvt_pk_bf16_f32 v125, v122, v123
    v_lshlrev_b32 v120, 16, v124
    v_and_b32 v121, 0xffff0000, v124
    v_lshlrev_b32 v122, 16, v125
    v_and_b32 v123, 0xffff0000, v125
    v_pk_mul_f32 v[120:121], v[120:121], s[48:49]
    v_pk_mul_f32 v[122:123], v[122:123], s[48:49]
    v_cvt_pk_bf16_f32 v124, v120, v121
    v_cvt_pk_bf16_f32 v125, v122, v123
    s_nop 1
    v_permlane16_swap_b32 v124, v125
    v_lshlrev_b32 v120, 16, v124
    v_and_b32 v121, 0xffff0000, v124
    v_lshlrev_b32 v122, 16, v125
    v_and_b32 v123, 0xffff0000, v125
    v_max3_f32 v126, v120, v121, v122
    v_max_f32 v126, v126, v123
    v_mov_b32 v127, v126
    s_nop 1
    v_permlane32_swap_b32 v126, v127
    v_max_f32 v126, v126, v127
    v_mul_f32 v126, s46, v126
    v_pk_fma_f32 v[120:121], v[120:121], s[46:47], v[126:127] op_sel_hi:[1,1,0] neg_lo:[0,0,1] neg_hi:[0,0,1]
    v_pk_fma_f32 v[122:123], v[122:123], s[46:47], v[126:127] op_sel_hi:[1,1,0] neg_lo:[0,0,1] neg_hi:[0,0,1]
    v_exp_f32 v120, v120
    v_exp_f32 v121, v121
    v_exp_f32 v122, v122
    v_exp_f32 v123, v123
    s_nop 0
    v_pk_add_f32 v[128:129], v[120:121], v[122:123]
    v_add_f32 v128, v128, v129
    v_mov_b32 v129, v128
    s_nop 1
    v_permlane32_swap_b32 v128, v129
    v_add_f32 v128, v128, v129
    v_rcp_f32 v128, v128
    s_waitcnt lgkmcnt(0)
    v_pk_mul_f32 v[120:121], v[120:121], v[128:129] op_sel_hi:[1,0]
    v_pk_mul_f32 v[122:123], v[122:123], v[128:129] op_sel_hi:[1,0]
    v_cvt_pk_bf16_f32 v124, v120, v121
    v_cvt_pk_bf16_f32 v125, v122, v123
    s_nop 1
    v_permlane16_swap_b32 v124, v125
    v_perm_b32 v100, v124, v124, v40
    v_perm_b32 v101, v124, v124, v41
    v_perm_b32 v102, v124, v124, v42
    v_perm_b32 v103, v124, v124, v43
    v_perm_b32 v104, v125, v125, v40
    v_perm_b32 v105, v125, v125, v41
    v_perm_b32 v106, v125, v125, v42
    v_perm_b32 v107, v125, v125, v43
    v_mfma_f32_16x16x32_bf16 v[108:111], v[68:71], v[100:103], 0
    v_mfma_f32_16x16x32_bf16 v[116:119], v[76:79], v[100:103], 0
    v_mfma_f32_16x16x32_bf16 v[112:115], v[72:75], v[104:107], 0
    v_mfma_f32_16x16x32_bf16 v[116:119], v[80:83], v[104:107], v[116:119]
    s_nop 4
    v_cvt_pk_bf16_f32 v132, v108, v109
    v_cvt_pk_bf16_f32 v133, v110, v111
    v_cvt_pk_bf16_f32 v134, v112, v113
    v_cvt_pk_bf16_f32 v135, v114, v115
    v_cvt_pk_bf16_f32 v128, v116, v117
    v_cvt_pk_bf16_f32 v129, v118, v119
    v_cvt_pk_bf16_f32 v130, v116, v117
    v_cvt_pk_bf16_f32 v131, v118, v119
    buffer_store_dwordx4 v[132:135], v16, s[20:23], s50 offen sc1
    v_permlane16_swap_b32 v128, v130
    v_permlane16_swap_b32 v129, v131
    buffer_store_dwordx4 v[128:131], v17, s[20:23], s50 offen sc1
    s_cmp_eq_u32 s34, -1
    s_cbranch_scc1 K_DRAIN
    s_cmp_lg_u32 s30, 6
    s_cbranch_scc1 K_NOFL
    s_waitcnt vmcnt(2)
    v_and_b32 v4, 7, v1
    v_lshlrev_b32 v4, 2, v4
    s_mov_b32 s3, 131072
K_ZPOLL2:
    v_cmp_eq_u32 vcc, 0, v7
    s_cbranch_vccz K_ZOK2
    s_sub_u32 s3, s3, 1
    s_cbranch_scc1 K_ZOK2
    global_load_dword v7, v4, s[8:9] offset:192 sc1
    s_waitcnt vmcnt(0)
    s_branch K_ZPOLL2
K_ZOK2:
    v_and_b32 v2, 1, v1
    v_lshl_add_u32 v2, v2, 2, s42
    global_load_dword v7, v2, s[10:11] offset:128 sc1
K_NOFL:
    v_mov_b32 v4, 158720
    v_mov_b32 v3, 257
    s_mov_b64 exec, 1
    s_waitcnt vmcnt(0)
    ds_add_rtn_u32 v2, v4, v3 offset:48
    s_mov_b32 exec_lo, s36
    v_mov_b32 v3, 1
    s_waitcnt lgkmcnt(0)
    v_readfirstlane_b32 s33, v2
    s_nop 3
    s_and_b32 s33, s33, 0xff
    s_cmp_lg_u32 s33, 7
    s_cbranch_scc1 K_ARRS
    global_store_dword v8, v3, s[10:11] sc1
K_ARRS:
    s_mov_b64 exec, -1
    s_cmp_ge_u32 s30, 6
    s_cbranch_scc1 K_P2_HELP
    s_branch K_LATE
WP_early:
    s_setpc_b64 s[38:39]
K_P2_EARLY:
    s_lshl_b32 s54, s40, 7
    v_lshrrev_b32 v9, 4, v1
    v_mov_b32 v12, 158720
    s_add_u32 s20, s10, 0x100000
    s_addc_u32 s21, s11, 0
    s_mov_b32 s22, 0x280000
    s_mov_b32 s23, 0x20000
    s_add_u32 s16, s10, 0x1000
    s_addc_u32 s17, s11, 0
    s_mov_b32 s18, 0x2000
    s_mov_b32 s19, 0x20000
    s_mov_b32 s48, s6
    s_mov_b32 s49, s7
    s_mov_b32 s50, 0x280000
    s_mov_b32 s51, 0x20000
    s_lshl_b32 s53, s40, 3
    s_lshl1_add_u32 s53, s30, s53
    s_mov_b32 s55, 20480
    v_bfe_u32 v20, v1, 2, 2
    v_and_b32 v21, 3, v1
    s_mul_i32 s3, s53, 20480
    v_lshl_add_u32 v25, v1, 4, s3
    v_add_u32 v26, 20480, v25
    v_add_u32 v35, 16384, v25
    v_add_u32 v36, 16384, v26
    v_and_b32 v2, 15, v1
    s_lshl_b32 s3, s53, 6
    v_lshl_add_u32 v23, v2, 2, s3
    v_lshl_add_u32 v2, v9, 2, v20
    v_bfe_u32 v3, v2, 1, 2
    v_lshlrev_b32 v2, 7, v2
    v_lshl_add_u32 v2, v21, 3, v2
    v_lshl_add_u32 v24, v3, 5, v2
    v_lshrrev_b32 v3, 1, v20
    v_mul_u32_u24 v2, 40, v9
    v_add3_u32 v2, v2, 16, v20
    v_lshlrev_b32 v2, 7, v2
    v_lshl_add_u32 v2, v21, 3, v2
    v_xor_b32 v4, 0, v3
    v_lshl_add_u32 v60, v4, 5, v2
    v_xor_b32 v4, 1, v3
    v_lshl_add_u32 v61, v4, 5, v2
    v_xor_b32 v4, 2, v3
    v_lshl_add_u32 v62, v4, 5, v2
    v_xor_b32 v4, 3, v3
    v_lshl_add_u32 v63, v4, 5, v2
    v_lshrrev_b32 v3, 4, v1
    v_and_b32 v4, 7, v1
    v_lshrrev_b32 v2, 3, v1
    v_xor_b32 v4, v4, v3
    v_mul_u32_u24 v2, 1280, v2
    v_lshl_add_u32 v27, v4, 4, v2
    v_xor_b32 v28, 64, v27
    s_lshl_b32 s71, s40, 3
    s_lshl1_add_u32 s71, s30, s71
    s_mul_i32 s71, s71, 20480
    s_lshl_b32 s33, s41, 7
    s_add_u32 s71, s71, s33
    s_add_u32 s72, s71, 10240
    s_add_u32 s73, s71, 20480
    s_add_u32 s74, s71, 30720
    s_lshl_b32 s3, s30, 12
    s_add_u32 s3, s3, 140288
    v_lshl_add_u32 v33, v1, 4, s3
    v_and_b32 v2, 15, v1
    v_lshrrev_b32 v3, 1, v2
    v_lshrrev_b32 v4, 5, v1
    v_xor_b32 v3, v3, v4
    v_lshlrev_b32 v3, 4, v3
    v_lshl_add_u32 v3, v2, 7, v3
    v_and_b32 v4, 1, v9
    v_lshl_add_u32 v3, v4, 3, v3
    v_add_u32 v29, s3, v3
    v_xor_b32 v30, 32, v29
    v_xor_b32 v31, 64, v29
    v_xor_b32 v32, 96, v29
    s_and_b32 s33, s40, 3
    s_lshl_b32 s33, s33, 3
    s_lshr_b32 s33, 0x7f06037f, s33
    s_and_b32 s33, s33, 0xff
    s_lshl_b32 s3, s30, 1
    s_cmp_ge_u32 s3, s33
    s_cselect_b32 s64, 16, 0
    s_add_u32 s3, s3, 1
    s_cmp_ge_u32 s3, s33
    s_cselect_b32 s65, 16, 0
    s_mov_b32 s63, 0
    s_mov_b32 s66, 0
    s_mov_b32 s67, 16384
    v_mov_b32 v34, 0
    v_mov_b32 v4, 158720
    v_mov_b32 v3, 1
    s_mov_b64 exec, 1
    s_waitcnt vmcnt(0)
    ds_add_rtn_u32 v2, v4, v3 offset:48
    s_mov_b32 exec_lo, s36
    v_mov_b32 v3, 1
    s_waitcnt lgkmcnt(0)
    v_readfirstlane_b32 s33, v2
    s_nop 3
    s_and_b32 s33, s33, 0xff
    s_cmp_lg_u32 s33, 7
    s_cbranch_scc1 K_ARRD
    global_store_dword v8, v3, s[10:11] sc1
K_ARRD:
    s_mov_b64 exec, -1
    s_mov_b32 s3, 1048576
K_P2_GE:
    ds_read_b32 v2, v12 offset:48
    s_sub_u32 s3, s3, 1
    s_waitcnt lgkmcnt(0)
    v_readfirstlane_b32 s33, v2
    s_nop 3
    s_cselect_b32 s33, 1024, s33
    s_cmp_lt_u32 s33, 1024
    s_cbranch_scc1 K_P2_GE
K_P2_GEMM:
    s_setprio 0
    s_mov_b32 s3, 1048576
K_P2_GS:
    ds_read_b32 v2, v12 offset:40
    s_sub_u32 s3, s3, 1
    s_waitcnt lgkmcnt(0)
    v_readfirstlane_b32 s33, v2
    s_nop 3
    s_cselect_b32 s33, 1, s33
    s_cmp_lt_u32 s33, 1
    s_cbranch_scc1 K_P2_GS
    buffer_load_dword v64, v23, s[16:19], 0 offen offset:0 sc1
    buffer_load_dword v66, v23, s[16:19], 0 offen offset:64 sc1
    ds_read_b128 v[16:19], v12
    ds_read_b64 v[40:41], v29 offset:0
    ds_read_b64 v[42:43], v30 offset:0
    ds_read_b64 v[44:45], v31 offset:0
    ds_read_b64 v[46:47], v32 offset:0
    ds_read_b64 v[48:49], v29 offset:2048
    ds_read_b64 v[50:51], v30 offset:2048
    ds_read_b64 v[52:53], v31 offset:2048
    ds_read_b64 v[54:55], v32 offset:2048
    s_waitcnt lgkmcnt(4)
    v_lshlrev_b32 v72, 16, v40
    v_and_b32 v73, 0xffff0000, v40
    v_lshlrev_b32 v74, 16, v41
    v_and_b32 v75, 0xffff0000, v41
    v_lshlrev_b32 v76, 16, v42
    v_and_b32 v77, 0xffff0000, v42
    v_lshlrev_b32 v78, 16, v43
    v_and_b32 v79, 0xffff0000, v43
    v_lshlrev_b32 v80, 16, v44
    v_and_b32 v81, 0xffff0000, v44
    v_lshlrev_b32 v82, 16, v45
    v_and_b32 v83, 0xffff0000, v45
    v_lshlrev_b32 v84, 16, v46
    v_and_b32 v85, 0xffff0000, v46
    v_lshlrev_b32 v86, 16, v47
    v_and_b32 v87, 0xffff0000, v47
    s_waitcnt lgkmcnt(0)
    v_lshlrev_b32 v88, 16, v48
    v_and_b32 v89, 0xffff0000, v48
    v_lshlrev_b32 v90, 16, v49
    v_and_b32 v91, 0xffff0000, v49
    v_lshlrev_b32 v92, 16, v50
    v_and_b32 v93, 0xffff0000, v50
    v_lshlrev_b32 v94, 16, v51
    v_and_b32 v95, 0xffff0000, v51
    v_lshlrev_b32 v96, 16, v52
    v_and_b32 v97, 0xffff0000, v52
    v_lshlrev_b32 v98, 16, v53
    v_and_b32 v99, 0xffff0000, v53
    v_lshlrev_b32 v100, 16, v54
    v_and_b32 v101, 0xffff0000, v54
    v_lshlrev_b32 v102, 16, v55
    v_and_b32 v103, 0xffff0000, v55
    s_cmp_eq_u32 s63, 0
    s_cbranch_scc1 K_SP0
K_SPR0:
    s_ff1_i32_b32 s33, s63
    s_bitset0_b32 s63, s33
    s_lshl_b32 s75, s33, 10
    buffer_load_dwordx4 v[104:107], v25, s[20:23], s75 offen offset:0 sc1
    buffer_load_dwordx4 v[108:111], v26, s[20:23], s75 offen offset:0 sc1
    v_mad_u32_u24 v56, s75, 5, v24
    v_xor_b32 v58, 64, v56
    v_xor_b32 v57, 32, v56
    v_xor_b32 v59, 96, v56
    ds_read_b64_tr_b16 v[184:185], v56 offset:0
    ds_read_b64_tr_b16 v[186:187], v58 offset:2560
    ds_read_b64_tr_b16 v[188:189], v57 offset:0
    ds_read_b64_tr_b16 v[190:191], v59 offset:2560
    ds_read_b64_tr_b16 v[192:193], v58 offset:0
    ds_read_b64_tr_b16 v[194:195], v56 offset:2560
    ds_read_b64_tr_b16 v[196:197], v59 offset:0
    ds_read_b64_tr_b16 v[198:199], v57 offset:2560
    s_cmp_eq_u32 s63, 0
    s_cbranch_scc1 K_SP1
K_SPR1:
    s_ff1_i32_b32 s33, s63
    s_bitset0_b32 s63, s33
    s_lshl_b32 s76, s33, 10
    buffer_load_dwordx4 v[112:115], v25, s[20:23], s76 offen offset:0 sc1
    buffer_load_dwordx4 v[116:119], v26, s[20:23], s76 offen offset:0 sc1
    v_mad_u32_u24 v56, s76, 5, v24
    v_xor_b32 v58, 64, v56
    v_xor_b32 v57, 32, v56
    v_xor_b32 v59, 96, v56
    ds_read_b64_tr_b16 v[200:201], v56 offset:0
    ds_read_b64_tr_b16 v[202:203], v58 offset:2560
    ds_read_b64_tr_b16 v[204:205], v57 offset:0
    ds_read_b64_tr_b16 v[206:207], v59 offset:2560
    ds_read_b64_tr_b16 v[208:209], v58 offset:0
    ds_read_b64_tr_b16 v[210:211], v56 offset:2560
    ds_read_b64_tr_b16 v[212:213], v59 offset:0
    ds_read_b64_tr_b16 v[214:215], v57 offset:2560
    s_waitcnt vmcnt(4)
    s_mov_b64 exec, 1
    ds_add_u32 v12, v34 offset:44
    s_mov_b64 exec, -1
    v_sub_f32 v68, 1.0, v64
    v_cvt_pk_bf16_f32 v68, v68, v68
    v_lshlrev_b32 v68, 16, v68
    v_sub_f32 v70, 1.0, v66
    v_cvt_pk_bf16_f32 v70, v70, v70
    v_lshlrev_b32 v70, 16, v70
    v_pk_mul_f32 v[72:73], v[72:73], v[68:69] op_sel_hi:[1,0]
    v_pk_mul_f32 v[74:75], v[74:75], v[68:69] op_sel_hi:[1,0]
    v_pk_mul_f32 v[76:77], v[76:77], v[68:69] op_sel_hi:[1,0]
    v_pk_mul_f32 v[78:79], v[78:79], v[68:69] op_sel_hi:[1,0]
    v_pk_mul_f32 v[80:81], v[80:81], v[68:69] op_sel_hi:[1,0]
    v_pk_mul_f32 v[82:83], v[82:83], v[68:69] op_sel_hi:[1,0]
    v_pk_mul_f32 v[84:85], v[84:85], v[68:69] op_sel_hi:[1,0]
    v_pk_mul_f32 v[86:87], v[86:87], v[68:69] op_sel_hi:[1,0]
    v_pk_mul_f32 v[88:89], v[88:89], v[70:71] op_sel_hi:[1,0]
    v_pk_mul_f32 v[90:91], v[90:91], v[70:71] op_sel_hi:[1,0]
    v_pk_mul_f32 v[92:93], v[92:93], v[70:71] op_sel_hi:[1,0]
    v_pk_mul_f32 v[94:95], v[94:95], v[70:71] op_sel_hi:[1,0]
    v_pk_mul_f32 v[96:97], v[96:97], v[70:71] op_sel_hi:[1,0]
    v_pk_mul_f32 v[98:99], v[98:99], v[70:71] op_sel_hi:[1,0]
    v_pk_mul_f32 v[100:101], v[100:101], v[70:71] op_sel_hi:[1,0]
    v_pk_mul_f32 v[102:103], v[102:103], v[70:71] op_sel_hi:[1,0]
    s_cmp_eq_u32 s63, 0
    s_cbranch_scc1 K_SP2
K_SPR2:
    s_ff1_i32_b32 s33, s63
    s_bitset0_b32 s63, s33
    s_lshl_b32 s77, s33, 10
    buffer_load_dwordx4 v[120:123], v25, s[20:23], s77 offen offset:0 sc1
    buffer_load_dwordx4 v[124:127], v26, s[20:23], s77 offen offset:0 sc1
    s_cmp_eq_u32 s63, 0
    s_cbranch_scc1 K_SP3
K_SPR3:
    s_ff1_i32_b32 s33, s63
    s_bitset0_b32 s63, s33
    s_lshl_b32 s78, s33, 10
    buffer_load_dwordx4 v[128:131], v25, s[20:23], s78 offen offset:0 sc1
    buffer_load_dwordx4 v[132:135], v26, s[20:23], s78 offen offset:0 sc1
    s_cmp_eq_u32 s63, 0
    s_cbranch_scc1 K_SP4
K_SPR4:
    s_ff1_i32_b32 s33, s63
    s_bitset0_b32 s63, s33
    s_lshl_b32 s75, s33, 10
    buffer_load_dwordx4 v[136:139], v25, s[20:23], s75 offen offset:0 sc1
    buffer_load_dwordx4 v[140:143], v26, s[20:23], s75 offen offset:0 sc1
    s_branch WS_p2g
.p2align 12
WP_p2g:
    s_setpc_b64 s[38:39]
WS_p2g:
    s_waitcnt vmcnt(8) lgkmcnt(9)
    v_mfma_f32_16x16x32_bf16 v[152:155], v[184:187], v[104:107], 0
    v_mad_u32_u24 v56, s77, 5, v24
    v_xor_b32 v58, 64, v56
    v_xor_b32 v57, 32, v56
    v_mfma_f32_16x16x32_bf16 v[168:171], v[184:187], v[108:111], 0
    v_xor_b32 v59, 96, v56
    ds_read_b64_tr_b16 v[216:217], v56 offset:0
    ds_read_b64_tr_b16 v[218:219], v58 offset:2560
    v_mfma_f32_16x16x32_bf16 v[156:159], v[188:191], v[104:107], 0
    ds_read_b64_tr_b16 v[220:221], v57 offset:0
    ds_read_b64_tr_b16 v[222:223], v59 offset:2560
    ds_read_b64_tr_b16 v[224:225], v58 offset:0
    v_mfma_f32_16x16x32_bf16 v[172:175], v[188:191], v[108:111], 0
    ds_read_b64_tr_b16 v[226:227], v56 offset:2560
    ds_read_b64_tr_b16 v[228:229], v59 offset:0
    v_mfma_f32_16x16x32_bf16 v[160:163], v[192:195], v[104:107], 0
    ds_read_b64_tr_b16 v[230:231], v57 offset:2560
    s_cmp_eq_u32 s63, 0
    v_mfma_f32_16x16x32_bf16 v[176:179], v[192:195], v[108:111], 0
    s_cbranch_scc1 K_SP5
K_SPR5:
    s_ff1_i32_b32 s33, s63
    v_mfma_f32_16x16x32_bf16 v[164:167], v[196:199], v[104:107], 0
    s_bitset0_b32 s63, s33
    s_lshl_b32 s76, s33, 10
    v_mfma_f32_16x16x32_bf16 v[180:183], v[196:199], v[108:111], 0
    buffer_load_dwordx4 v[144:147], v25, s[20:23], s76 offen offset:0 sc1
    buffer_load_dwordx4 v[148:151], v26, s[20:23], s76 offen offset:0 sc1
    s_waitcnt vmcnt(8) lgkmcnt(9)
    v_mfma_f32_16x16x32_bf16 v[152:155], v[200:203], v[112:115], v[152:155]
    v_mad_u32_u24 v56, s78, 5, v24
    v_xor_b32 v58, 64, v56
    v_xor_b32 v57, 32, v56
    v_mfma_f32_16x16x32_bf16 v[168:171], v[200:203], v[116:119], v[168:171]
    v_xor_b32 v59, 96, v56
    ds_read_b64_tr_b16 v[184:185], v56 offset:0
    ds_read_b64_tr_b16 v[186:187], v58 offset:2560
    v_mfma_f32_16x16x32_bf16 v[156:159], v[204:207], v[112:115], v[156:159]
    ds_read_b64_tr_b16 v[188:189], v57 offset:0
    ds_read_b64_tr_b16 v[190:191], v59 offset:2560
    ds_read_b64_tr_b16 v[192:193], v58 offset:0
    v_mfma_f32_16x16x32_bf16 v[172:175], v[204:207], v[116:119], v[172:175]
    ds_read_b64_tr_b16 v[194:195], v56 offset:2560
    ds_read_b64_tr_b16 v[196:197], v59 offset:0
    v_mfma_f32_16x16x32_bf16 v[160:163], v[208:211], v[112:115], v[160:163]
    ds_read_b64_tr_b16 v[198:199], v57 offset:2560
    s_cmp_eq_u32 s63, 0
    v_mfma_f32_16x16x32_bf16 v[176:179], v[208:211], v[116:119], v[176:179]
    s_cbranch_scc1 K_SP6
K_SPR6:
    s_ff1_i32_b32 s33, s63
    v_mfma_f32_16x16x32_bf16 v[164:167], v[212:215], v[112:115], v[164:167]
    s_bitset0_b32 s63, s33
    s_lshl_b32 s77, s33, 10
    v_mfma_f32_16x16x32_bf16 v[180:183], v[212:215], v[116:119], v[180:183]
    buffer_load_dwordx4 v[104:107], v25, s[20:23], s77 offen offset:0 sc1
    buffer_load_dwordx4 v[108:111], v26, s[20:23], s77 offen offset:0 sc1
    s_waitcnt vmcnt(8) lgkmcnt(8)
    v_mfma_f32_16x16x32_bf16 v[152:155], v[216:219], v[120:123], v[152:155]
    v_mad_u32_u24 v56, s75, 5, v24
    v_xor_b32 v58, 64, v56
    v_xor_b32 v57, 32, v56
    v_mfma_f32_16x16x32_bf16 v[168:171], v[216:219], v[124:127], v[168:171]
    v_xor_b32 v59, 96, v56
    ds_read_b64_tr_b16 v[200:201], v56 offset:0
    ds_read_b64_tr_b16 v[202:203], v58 offset:2560
    v_mfma_f32_16x16x32_bf16 v[156:159], v[220:223], v[120:123], v[156:159]
    ds_read_b64_tr_b16 v[204:205], v57 offset:0
    ds_read_b64_tr_b16 v[206:207], v59 offset:2560
    ds_read_b64_tr_b16 v[208:209], v58 offset:0
    v_mfma_f32_16x16x32_bf16 v[172:175], v[220:223], v[124:127], v[172:175]
    ds_read_b64_tr_b16 v[210:211], v56 offset:2560
    ds_read_b64_tr_b16 v[212:213], v59 offset:0
    v_mfma_f32_16x16x32_bf16 v[160:163], v[224:227], v[120:123], v[160:163]
    ds_read_b64_tr_b16 v[214:215], v57 offset:2560
    s_andn2_b32 s33, s66, s63
    v_mfma_f32_16x16x32_bf16 v[176:179], v[224:227], v[124:127], v[176:179]
    s_bfe_u32 s33, s33, 0x40000
    s_cmp_eq_u32 s33, 15
    v_mfma_f32_16x16x32_bf16 v[164:167], v[228:231], v[120:123], v[164:167]
    s_cselect_b32 s78, 0, 1024
    s_xor_b32 s69, s78, 1024
    v_mfma_f32_16x16x32_bf16 v[180:183], v[228:231], v[124:127], v[180:183]
    buffer_load_dwordx4 v[112:115], v35, s[20:23], s78 offen offset:0 sc1
    buffer_load_dwordx4 v[116:119], v36, s[20:23], s78 offen offset:0 sc1
    s_waitcnt vmcnt(8) lgkmcnt(8)
    v_mfma_f32_16x16x32_bf16 v[152:155], v[184:187], v[128:131], v[152:155]
    v_mad_u32_u24 v56, s76, 5, v24
    v_xor_b32 v58, 64, v56
    v_xor_b32 v57, 32, v56
    v_mfma_f32_16x16x32_bf16 v[168:171], v[184:187], v[132:135], v[168:171]
    v_xor_b32 v59, 96, v56
    ds_read_b64_tr_b16 v[216:217], v56 offset:0
    ds_read_b64_tr_b16 v[218:219], v58 offset:2560
    v_mfma_f32_16x16x32_bf16 v[156:159], v[188:191], v[128:131], v[156:159]
    ds_read_b64_tr_b16 v[220:221], v57 offset:0
    ds_read_b64_tr_b16 v[222:223], v59 offset:2560
    ds_read_b64_tr_b16 v[224:225], v58 offset:0
    v_mfma_f32_16x16x32_bf16 v[172:175], v[188:191], v[132:135], v[172:175]
    ds_read_b64_tr_b16 v[226:227], v56 offset:2560
    ds_read_b64_tr_b16 v[228:229], v59 offset:0
    v_mfma_f32_16x16x32_bf16 v[160:163], v[192:195], v[128:131], v[160:163]
    ds_read_b64_tr_b16 v[230:231], v57 offset:2560
    s_cmp_eq_u32 s63, 0
    v_mfma_f32_16x16x32_bf16 v[176:179], v[192:195], v[132:135], v[176:179]
    s_cbranch_scc1 K_SP8
K_SPR8:
    s_ff1_i32_b32 s33, s63
    v_mfma_f32_16x16x32_bf16 v[164:167], v[196:199], v[128:131], v[164:167]
    s_bitset0_b32 s63, s33
    s_lshl_b32 s75, s33, 10
    v_mfma_f32_16x16x32_bf16 v[180:183], v[196:199], v[132:135], v[180:183]
    buffer_load_dwordx4 v[120:123], v25, s[20:23], s75 offen offset:0 sc1
    buffer_load_dwordx4 v[124:127], v26, s[20:23], s75 offen offset:0 sc1
    s_waitcnt vmcnt(8) lgkmcnt(8)
    v_mfma_f32_16x16x32_bf16 v[152:155], v[200:203], v[136:139], v[152:155]
    v_mad_u32_u24 v56, s77, 5, v24
    v_xor_b32 v58, 64, v56
    v_mfma_f32_16x16x32_bf16 v[168:171], v[200:203], v[140:143], v[168:171]
    v_xor_b32 v57, 32, v56
    v_xor_b32 v59, 96, v56
    v_mfma_f32_16x16x32_bf16 v[156:159], v[204:207], v[136:139], v[156:159]
    ds_read_b64_tr_b16 v[184:185], v56 offset:0
    ds_read_b64_tr_b16 v[186:187], v58 offset:2560
    v_mfma_f32_16x16x32_bf16 v[172:175], v[204:207], v[140:143], v[172:175]
    ds_read_b64_tr_b16 v[188:189], v57 offset:0
    ds_read_b64_tr_b16 v[190:191], v59 offset:2560
    v_mfma_f32_16x16x32_bf16 v[160:163], v[208:211], v[136:139], v[160:163]
    ds_read_b64_tr_b16 v[192:193], v58 offset:0
    ds_read_b64_tr_b16 v[194:195], v56 offset:2560
    v_mfma_f32_16x16x32_bf16 v[176:179], v[208:211], v[140:143], v[176:179]
    ds_read_b64_tr_b16 v[196:197], v59 offset:0
    ds_read_b64_tr_b16 v[198:199], v57 offset:2560
    v_mfma_f32_16x16x32_bf16 v[164:167], v[212:215], v[136:139], v[164:167]
    buffer_load_dwordx4 v[128:131], v35, s[20:23], s69 offen offset:0 sc1
    buffer_load_dwordx4 v[132:135], v36, s[20:23], s69 offen offset:0 sc1
    v_mfma_f32_16x16x32_bf16 v[180:183], v[212:215], v[140:143], v[180:183]
    s_waitcnt vmcnt(8) lgkmcnt(8)
    v_mfma_f32_16x16x32_bf16 v[152:155], v[216:219], v[144:147], v[152:155]
    v_mad_u32_u24 v56, s78, 20, v60
    v_xor_b32 v58, 64, v56
    v_xor_b32 v57, 32, v56
    v_mfma_f32_16x16x32_bf16 v[168:171], v[216:219], v[148:151], v[168:171]
    v_xor_b32 v59, 96, v56
    ds_read_b64_tr_b16 v[200:201], v56 offset:0
    ds_read_b64_tr_b16 v[202:203], v58 offset:2560
    v_mfma_f32_16x16x32_bf16 v[156:159], v[220:223], v[144:147], v[156:159]
    ds_read_b64_tr_b16 v[204:205], v57 offset:0
    ds_read_b64_tr_b16 v[206:207], v59 offset:2560
    ds_read_b64_tr_b16 v[208:209], v58 offset:0
    v_mfma_f32_16x16x32_bf16 v[172:175], v[220:223], v[148:151], v[172:175]
    ds_read_b64_tr_b16 v[210:211], v56 offset:2560
    ds_read_b64_tr_b16 v[212:213], v59 offset:0
    v_mfma_f32_16x16x32_bf16 v[160:163], v[224:227], v[144:147], v[160:163]
    ds_read_b64_tr_b16 v[214:215], v57 offset:2560
    s_cmp_eq_u32 s63, 0
    v_mfma_f32_16x16x32_bf16 v[176:179], v[224:227], v[148:151], v[176:179]
    s_cbranch_scc1 K_SP10
K_SPR10:
    s_ff1_i32_b32 s33, s63
    v_mfma_f32_16x16x32_bf16 v[164:167], v[228:231], v[144:147], v[164:167]
    s_bitset0_b32 s63, s33
    s_lshl_b32 s77, s33, 10
    v_mfma_f32_16x16x32_bf16 v[180:183], v[228:231], v[148:151], v[180:183]
    buffer_load_dwordx4 v[136:139], v25, s[20:23], s77 offen offset:0 sc1
    buffer_load_dwordx4 v[140:143], v26, s[20:23], s77 offen offset:0 sc1
    s_waitcnt vmcnt(8) lgkmcnt(8)
    v_mfma_f32_16x16x32_bf16 v[152:155], v[184:187], v[104:107], v[152:155]
    v_mad_u32_u24 v56, s75, 5, v24
    v_xor_b32 v58, 64, v56
    v_xor_b32 v57, 32, v56
    v_mfma_f32_16x16x32_bf16 v[168:171], v[184:187], v[108:111], v[168:171]
    v_xor_b32 v59, 96, v56
    ds_read_b64_tr_b16 v[216:217], v56 offset:0
    ds_read_b64_tr_b16 v[218:219], v58 offset:2560
    v_mfma_f32_16x16x32_bf16 v[156:159], v[188:191], v[104:107], v[156:159]
    ds_read_b64_tr_b16 v[220:221], v57 offset:0
    ds_read_b64_tr_b16 v[222:223], v59 offset:2560
    ds_read_b64_tr_b16 v[224:225], v58 offset:0
    v_mfma_f32_16x16x32_bf16 v[172:175], v[188:191], v[108:111], v[172:175]
    ds_read_b64_tr_b16 v[226:227], v56 offset:2560
    ds_read_b64_tr_b16 v[228:229], v59 offset:0
    v_mfma_f32_16x16x32_bf16 v[160:163], v[192:195], v[104:107], v[160:163]
    ds_read_b64_tr_b16 v[230:231], v57 offset:2560
    s_cmp_eq_u32 s63, 0
    v_mfma_f32_16x16x32_bf16 v[176:179], v[192:195], v[108:111], v[176:179]
    s_cbranch_scc1 K_SP11
K_SPR11:
    s_ff1_i32_b32 s33, s63
    v_mfma_f32_16x16x32_bf16 v[164:167], v[196:199], v[104:107], v[164:167]
    s_bitset0_b32 s63, s33
    s_lshl_b32 s78, s33, 10
    v_mfma_f32_16x16x32_bf16 v[180:183], v[196:199], v[108:111], v[180:183]
    buffer_load_dwordx4 v[144:147], v25, s[20:23], s78 offen offset:0 sc1
    buffer_load_dwordx4 v[148:151], v26, s[20:23], s78 offen offset:0 sc1
    s_waitcnt vmcnt(8) lgkmcnt(8)
    v_mfma_f32_16x16x32_bf16 v[152:155], v[200:203], v[112:115], v[152:155]
    v_mad_u32_u24 v56, s69, 20, v60
    v_xor_b32 v58, 64, v56
    v_xor_b32 v57, 32, v56
    v_mfma_f32_16x16x32_bf16 v[168:171], v[200:203], v[116:119], v[168:171]
    v_xor_b32 v59, 96, v56
    ds_read_b64_tr_b16 v[184:185], v56 offset:0
    ds_read_b64_tr_b16 v[186:187], v58 offset:2560
    v_mfma_f32_16x16x32_bf16 v[156:159], v[204:207], v[112:115], v[156:159]
    ds_read_b64_tr_b16 v[188:189], v57 offset:0
    ds_read_b64_tr_b16 v[190:191], v59 offset:2560
    ds_read_b64_tr_b16 v[192:193], v58 offset:0
    v_mfma_f32_16x16x32_bf16 v[172:175], v[204:207], v[116:119], v[172:175]
    ds_read_b64_tr_b16 v[194:195], v56 offset:2560
    ds_read_b64_tr_b16 v[196:197], v59 offset:0
    v_mfma_f32_16x16x32_bf16 v[160:163], v[208:211], v[112:115], v[160:163]
    ds_read_b64_tr_b16 v[198:199], v57 offset:2560
    s_cmp_eq_u32 s63, 0
    v_mfma_f32_16x16x32_bf16 v[176:179], v[208:211], v[116:119], v[176:179]
    s_cbranch_scc1 K_SP12
K_SPR12:
    s_ff1_i32_b32 s33, s63
    v_mfma_f32_16x16x32_bf16 v[164:167], v[212:215], v[112:115], v[164:167]
    s_bitset0_b32 s63, s33
    s_lshl_b32 s75, s33, 10
    v_mfma_f32_16x16x32_bf16 v[180:183], v[212:215], v[116:119], v[180:183]
    buffer_load_dwordx4 v[104:107], v25, s[20:23], s75 offen offset:0 sc1
    buffer_load_dwordx4 v[108:111], v26, s[20:23], s75 offen offset:0 sc1
    s_mov_b32 s3, 1048576
K_P2_GW:
    ds_read_b32 v2, v12 offset:44
    s_sub_u32 s3, s3, 1
    s_waitcnt lgkmcnt(0)
    v_readfirstlane_b32 s33, v2
    s_nop 3
    s_cselect_b32 s33, 4, s33
    s_cmp_lt_u32 s33, 4
    s_cbranch_scc1 K_P2_GW
    v_readfirstlane_b32 s56, v16
    v_readfirstlane_b32 s57, v17
    s_lshl_b32 s58, s53, 4
    s_waitcnt vmcnt(8)
    v_mfma_f32_16x16x32_bf16 v[152:155], v[216:219], v[120:123], v[152:155]
    v_mad_u32_u24 v56, s77, 5, v24
    v_xor_b32 v58, 64, v56
    v_xor_b32 v57, 32, v56
    v_mfma_f32_16x16x32_bf16 v[168:171], v[216:219], v[124:127], v[168:171]
    v_xor_b32 v59, 96, v56
    ds_read_b64_tr_b16 v[200:201], v56 offset:0
    ds_read_b64_tr_b16 v[202:203], v58 offset:2560
    v_mfma_f32_16x16x32_bf16 v[156:159], v[220:223], v[120:123], v[156:159]
    ds_read_b64_tr_b16 v[204:205], v57 offset:0
    ds_read_b64_tr_b16 v[206:207], v59 offset:2560
    ds_read_b64_tr_b16 v[208:209], v58 offset:0
    v_mfma_f32_16x16x32_bf16 v[172:175], v[220:223], v[124:127], v[172:175]
    ds_read_b64_tr_b16 v[210:211], v56 offset:2560
    ds_read_b64_tr_b16 v[212:213], v59 offset:0
    v_mfma_f32_16x16x32_bf16 v[160:163], v[224:227], v[120:123], v[160:163]
    ds_read_b64_tr_b16 v[214:215], v57 offset:2560
    s_cmp_eq_u32 s63, 0
    v_mfma_f32_16x16x32_bf16 v[176:179], v[224:227], v[124:127], v[176:179]
    s_cbranch_scc1 K_SP13
K_SPR13:
    s_ff1_i32_b32 s33, s63
    v_mfma_f32_16x16x32_bf16 v[164:167], v[228:231], v[120:123], v[164:167]
    s_bitset0_b32 s63, s33
    s_lshl_b32 s76, s33, 10
    v_mfma_f32_16x16x32_bf16 v[180:183], v[228:231], v[124:127], v[180:183]
    buffer_load_dwordx4 v[112:115], v25, s[20:23], s76 offen offset:0 sc1
    buffer_load_dwordx4 v[116:119], v26, s[20:23], s76 offen offset:0 sc1
    s_waitcnt vmcnt(8)
    v_mfma_f32_16x16x32_bf16 v[152:155], v[184:187], v[128:131], v[152:155]
    v_mad_u32_u24 v56, s78, 5, v24
    v_xor_b32 v58, 64, v56
    v_xor_b32 v57, 32, v56
    v_mfma_f32_16x16x32_bf16 v[168:171], v[184:187], v[132:135], v[168:171]
    v_xor_b32 v59, 96, v56
    ds_read_b64_tr_b16 v[216:217], v56 offset:0
    ds_read_b64_tr_b16 v[218:219], v58 offset:2560
    v_mfma_f32_16x16x32_bf16 v[156:159], v[188:191], v[128:131], v[156:159]
    ds_read_b64_tr_b16 v[220:221], v57 offset:0
    ds_read_b64_tr_b16 v[222:223], v59 offset:2560
    ds_read_b64_tr_b16 v[224:225], v58 offset:0
    v_mfma_f32_16x16x32_bf16 v[172:175], v[188:191], v[132:135], v[172:175]
    ds_read_b64_tr_b16 v[226:227], v56 offset:2560
    ds_read_b64_tr_b16 v[228:229], v59 offset:0
    v_mfma_f32_16x16x32_bf16 v[160:163], v[192:195], v[128:131], v[160:163]
    ds_read_b64_tr_b16 v[230:231], v57 offset:2560
    s_cmp_eq_u32 s63, 0
    v_mfma_f32_16x16x32_bf16 v[176:179], v[192:195], v[132:135], v[176:179]
    s_cbranch_scc1 K_SP14
K_SPR14:
    s_ff1_i32_b32 s33, s63
    v_mfma_f32_16x16x32_bf16 v[164:167], v[196:199], v[128:131], v[164:167]
    s_bitset0_b32 s63, s33
    s_lshl_b32 s77, s33, 10
    v_mfma_f32_16x16x32_bf16 v[180:183], v[196:199], v[132:135], v[180:183]
    buffer_load_dwordx4 v[120:123], v25, s[20:23], s77 offen offset:0 sc1
    buffer_load_dwordx4 v[124:127], v26, s[20:23], s77 offen offset:0 sc1
    s_waitcnt vmcnt(8) lgkmcnt(8)
    v_mfma_f32_16x16x32_bf16 v[152:155], v[200:203], v[136:139], v[152:155]
    v_mad_u32_u24 v56, s75, 5, v24
    v_xor_b32 v58, 64, v56
    v_xor_b32 v57, 32, v56
    v_mfma_f32_16x16x32_bf16 v[168:171], v[200:203], v[140:143], v[168:171]
    v_xor_b32 v59, 96, v56
    ds_read_b64_tr_b16 v[184:185], v56 offset:0
    ds_read_b64_tr_b16 v[186:187], v58 offset:2560
    v_mfma_f32_16x16x32_bf16 v[156:159], v[204:207], v[136:139], v[156:159]
    ds_read_b64_tr_b16 v[188:189], v57 offset:0
    ds_read_b64_tr_b16 v[190:191], v59 offset:2560
    ds_read_b64_tr_b16 v[192:193], v58 offset:0
    v_mfma_f32_16x16x32_bf16 v[172:175], v[204:207], v[140:143], v[172:175]
    ds_read_b64_tr_b16 v[194:195], v56 offset:2560
    ds_read_b64_tr_b16 v[196:197], v59 offset:0
    v_mfma_f32_16x16x32_bf16 v[160:163], v[208:211], v[136:139], v[160:163]
    ds_read_b64_tr_b16 v[198:199], v57 offset:2560
    s_cmp_eq_u32 s63, 0
    v_mfma_f32_16x16x32_bf16 v[176:179], v[208:211], v[140:143], v[176:179]
    s_cbranch_scc1 K_SP15
K_SPR15:
    s_ff1_i32_b32 s33, s63
    v_mfma_f32_16x16x32_bf16 v[164:167], v[212:215], v[136:139], v[164:167]
    s_bitset0_b32 s63, s33
    s_lshl_b32 s78, s33, 10
    v_mfma_f32_16x16x32_bf16 v[180:183], v[212:215], v[140:143], v[180:183]
    buffer_load_dwordx4 v[128:131], v25, s[20:23], s78 offen offset:0 sc1
    buffer_load_dwordx4 v[132:135], v26, s[20:23], s78 offen offset:0 sc1
    s_waitcnt vmcnt(8) lgkmcnt(8)
    v_mfma_f32_16x16x32_bf16 v[152:155], v[216:219], v[144:147], v[152:155]
    v_mad_u32_u24 v56, s76, 5, v24
    v_xor_b32 v58, 64, v56
    v_xor_b32 v57, 32, v56
    v_mfma_f32_16x16x32_bf16 v[168:171], v[216:219], v[148:151], v[168:171]
    v_xor_b32 v59, 96, v56
    ds_read_b64_tr_b16 v[200:201], v56 offset:0
    ds_read_b64_tr_b16 v[202:203], v58 offset:2560
    v_mfma_f32_16x16x32_bf16 v[156:159], v[220:223], v[144:147], v[156:159]
    ds_read_b64_tr_b16 v[204:205], v57 offset:0
    ds_read_b64_tr_b16 v[206:207], v59 offset:2560
    ds_read_b64_tr_b16 v[208:209], v58 offset:0
    v_mfma_f32_16x16x32_bf16 v[172:175], v[220:223], v[148:151], v[172:175]
    ds_read_b64_tr_b16 v[210:211], v56 offset:2560
    ds_read_b64_tr_b16 v[212:213], v59 offset:0
    v_mfma_f32_16x16x32_bf16 v[160:163], v[224:227], v[144:147], v[160:163]
    ds_read_b64_tr_b16 v[214:215], v57 offset:2560
    s_cmp_eq_u32 s63, 0
    v_mfma_f32_16x16x32_bf16 v[176:179], v[224:227], v[148:151], v[176:179]
    s_cbranch_scc1 K_SP16
K_SPR16:
    s_ff1_i32_b32 s33, s63
    v_mfma_f32_16x16x32_bf16 v[164:167], v[228:231], v[144:147], v[164:167]
    s_bitset0_b32 s63, s33
    s_lshl_b32 s75, s33, 10
    v_mfma_f32_16x16x32_bf16 v[180:183], v[228:231], v[148:151], v[180:183]
    buffer_load_dwordx4 v[136:139], v25, s[20:23], s75 offen offset:0 sc1
    buffer_load_dwordx4 v[140:143], v26, s[20:23], s75 offen offset:0 sc1
    s_waitcnt vmcnt(8) lgkmcnt(8)
    v_mfma_f32_16x16x32_bf16 v[152:155], v[184:187], v[104:107], v[152:155]
    v_mad_u32_u24 v56, s77, 5, v24
    v_xor_b32 v58, 64, v56
    v_xor_b32 v57, 32, v56
    v_mfma_f32_16x16x32_bf16 v[168:171], v[184:187], v[108:111], v[168:171]
    v_xor_b32 v59, 96, v56
    ds_read_b64_tr_b16 v[216:217], v56 offset:0
    ds_read_b64_tr_b16 v[218:219], v58 offset:2560
    v_mfma_f32_16x16x32_bf16 v[156:159], v[188:191], v[104:107], v[156:159]
    ds_read_b64_tr_b16 v[220:221], v57 offset:0
    ds_read_b64_tr_b16 v[222:223], v59 offset:2560
    ds_read_b64_tr_b16 v[224:225], v58 offset:0
    v_mfma_f32_16x16x32_bf16 v[172:175], v[188:191], v[108:111], v[172:175]
    ds_read_b64_tr_b16 v[226:227], v56 offset:2560
    ds_read_b64_tr_b16 v[228:229], v59 offset:0
    v_mfma_f32_16x16x32_bf16 v[160:163], v[192:195], v[104:107], v[160:163]
    ds_read_b64_tr_b16 v[230:231], v57 offset:2560
    s_andn2_b32 s33, s66, s63
    v_mfma_f32_16x16x32_bf16 v[176:179], v[192:195], v[108:111], v[176:179]
    s_bfe_u32 s33, s33, 0x40008
    s_cmp_eq_u32 s33, 15
    v_mfma_f32_16x16x32_bf16 v[164:167], v[196:199], v[104:107], v[164:167]
    s_cselect_b32 s76, 0, 1024
    s_xor_b32 s69, s76, 1024
    v_mfma_f32_16x16x32_bf16 v[180:183], v[196:199], v[108:111], v[180:183]
    buffer_load_dwordx4 v[144:147], v35, s[20:23], s76 offen offset:2048 sc1
    buffer_load_dwordx4 v[148:151], v36, s[20:23], s76 offen offset:2048 sc1
    s_waitcnt vmcnt(8) lgkmcnt(8)
    v_mfma_f32_16x16x32_bf16 v[152:155], v[200:203], v[112:115], v[152:155]
    v_mad_u32_u24 v56, s78, 5, v24
    v_xor_b32 v58, 64, v56
    v_xor_b32 v57, 32, v56
    v_mfma_f32_16x16x32_bf16 v[168:171], v[200:203], v[116:119], v[168:171]
    v_xor_b32 v59, 96, v56
    ds_read_b64_tr_b16 v[184:185], v56 offset:0
    ds_read_b64_tr_b16 v[186:187], v58 offset:2560
    v_mfma_f32_16x16x32_bf16 v[156:159], v[204:207], v[112:115], v[156:159]
    ds_read_b64_tr_b16 v[188:189], v57 offset:0
    ds_read_b64_tr_b16 v[190:191], v59 offset:2560
    ds_read_b64_tr_b16 v[192:193], v58 offset:0
    v_mfma_f32_16x16x32_bf16 v[172:175], v[204:207], v[116:119], v[172:175]
    ds_read_b64_tr_b16 v[194:195], v56 offset:2560
    ds_read_b64_tr_b16 v[196:197], v59 offset:0
    v_mfma_f32_16x16x32_bf16 v[160:163], v[208:211], v[112:115], v[160:163]
    ds_read_b64_tr_b16 v[198:199], v57 offset:2560
    s_cmp_eq_u32 s63, 0
    v_mfma_f32_16x16x32_bf16 v[176:179], v[208:211], v[116:119], v[176:179]
    s_cbranch_scc1 K_SP18
K_SPR18:
    s_ff1_i32_b32 s33, s63
    v_mfma_f32_16x16x32_bf16 v[164:167], v[212:215], v[112:115], v[164:167]
    s_bitset0_b32 s63, s33
    s_lshl_b32 s77, s33, 10
    v_mfma_f32_16x16x32_bf16 v[180:183], v[212:215], v[116:119], v[180:183]
    buffer_load_dwordx4 v[104:107], v25, s[20:23], s77 offen offset:0 sc1
    buffer_load_dwordx4 v[108:111], v26, s[20:23], s77 offen offset:0 sc1
    s_waitcnt vmcnt(8) lgkmcnt(8)
    v_mfma_f32_16x16x32_bf16 v[152:155], v[216:219], v[120:123], v[152:155]
    v_mad_u32_u24 v56, s75, 5, v24
    v_xor_b32 v58, 64, v56
    v_mfma_f32_16x16x32_bf16 v[168:171], v[216:219], v[124:127], v[168:171]
    v_xor_b32 v57, 32, v56
    v_xor_b32 v59, 96, v56
    v_mfma_f32_16x16x32_bf16 v[156:159], v[220:223], v[120:123], v[156:159]
    ds_read_b64_tr_b16 v[200:201], v56 offset:0
    ds_read_b64_tr_b16 v[202:203], v58 offset:2560
    v_mfma_f32_16x16x32_bf16 v[172:175], v[220:223], v[124:127], v[172:175]
    ds_read_b64_tr_b16 v[204:205], v57 offset:0
    ds_read_b64_tr_b16 v[206:207], v59 offset:2560
    v_mfma_f32_16x16x32_bf16 v[160:163], v[224:227], v[120:123], v[160:163]
    ds_read_b64_tr_b16 v[208:209], v58 offset:0
    ds_read_b64_tr_b16 v[210:211], v56 offset:2560
    v_mfma_f32_16x16x32_bf16 v[176:179], v[224:227], v[124:127], v[176:179]
    ds_read_b64_tr_b16 v[212:213], v59 offset:0
    ds_read_b64_tr_b16 v[214:215], v57 offset:2560
    v_mfma_f32_16x16x32_bf16 v[164:167], v[228:231], v[120:123], v[164:167]
    buffer_load_dwordx4 v[112:115], v35, s[20:23], s69 offen offset:2048 sc1
    buffer_load_dwordx4 v[116:119], v36, s[20:23], s69 offen offset:2048 sc1
    v_mfma_f32_16x16x32_bf16 v[180:183], v[228:231], v[124:127], v[180:183]
    s_waitcnt vmcnt(8) lgkmcnt(8)
    v_mfma_f32_16x16x32_bf16 v[152:155], v[184:187], v[128:131], v[152:155]
    v_mad_u32_u24 v56, s76, 20, v60
    v_xor_b32 v58, 64, v56
    v_mfma_f32_16x16x32_bf16 v[168:171], v[184:187], v[132:135], v[168:171]
    v_xor_b32 v57, 32, v56
    v_xor_b32 v59, 96, v56
    v_mfma_f32_16x16x32_bf16 v[156:159], v[188:191], v[128:131], v[156:159]
    ds_read_b64_tr_b16 v[216:217], v56 offset:40960
    ds_read_b64_tr_b16 v[218:219], v58 offset:43520
    v_mfma_f32_16x16x32_bf16 v[172:175], v[188:191], v[132:135], v[172:175]
    ds_read_b64_tr_b16 v[220:221], v57 offset:40960
    ds_read_b64_tr_b16 v[222:223], v59 offset:43520
    v_mfma_f32_16x16x32_bf16 v[160:163], v[192:195], v[128:131], v[160:163]
    ds_read_b64_tr_b16 v[224:225], v58 offset:40960
    ds_read_b64_tr_b16 v[226:227], v56 offset:43520
    v_mfma_f32_16x16x32_bf16 v[176:179], v[192:195], v[132:135], v[176:179]
    ds_read_b64_tr_b16 v[228:229], v59 offset:40960
    ds_read_b64_tr_b16 v[230:231], v57 offset:43520
    v_mfma_f32_16x16x32_bf16 v[164:167], v[196:199], v[128:131], v[164:167]
    v_mfma_f32_16x16x32_bf16 v[180:183], v[196:199], v[132:135], v[180:183]
    s_waitcnt vmcnt(6) lgkmcnt(8)
    v_mfma_f32_16x16x32_bf16 v[152:155], v[200:203], v[136:139], v[152:155]
    v_mad_u32_u24 v56, s77, 5, v24
    v_xor_b32 v58, 64, v56
    v_mfma_f32_16x16x32_bf16 v[168:171], v[200:203], v[140:143], v[168:171]
    v_xor_b32 v57, 32, v56
    v_xor_b32 v59, 96, v56
    v_mfma_f32_16x16x32_bf16 v[156:159], v[204:207], v[136:139], v[156:159]
    ds_read_b64_tr_b16 v[184:185], v56 offset:0
    ds_read_b64_tr_b16 v[186:187], v58 offset:2560
    v_mfma_f32_16x16x32_bf16 v[172:175], v[204:207], v[140:143], v[172:175]
    ds_read_b64_tr_b16 v[188:189], v57 offset:0
    ds_read_b64_tr_b16 v[190:191], v59 offset:2560
    v_mfma_f32_16x16x32_bf16 v[160:163], v[208:211], v[136:139], v[160:163]
    ds_read_b64_tr_b16 v[192:193], v58 offset:0
    ds_read_b64_tr_b16 v[194:195], v56 offset:2560
    v_mfma_f32_16x16x32_bf16 v[176:179], v[208:211], v[140:143], v[176:179]
    ds_read_b64_tr_b16 v[196:197], v59 offset:0
    ds_read_b64_tr_b16 v[198:199], v57 offset:2560
    v_mfma_f32_16x16x32_bf16 v[164:167], v[212:215], v[136:139], v[164:167]
    v_mfma_f32_16x16x32_bf16 v[180:183], v[212:215], v[140:143], v[180:183]
    s_waitcnt vmcnt(4) lgkmcnt(8)
    v_mfma_f32_16x16x32_bf16 v[152:155], v[216:219], v[144:147], v[152:155]
    v_mad_u32_u24 v56, s69, 20, v60
    v_xor_b32 v58, 64, v56
    v_mfma_f32_16x16x32_bf16 v[168:171], v[216:219], v[148:151], v[168:171]
    v_xor_b32 v57, 32, v56
    v_xor_b32 v59, 96, v56
    v_mfma_f32_16x16x32_bf16 v[156:159], v[220:223], v[144:147], v[156:159]
    ds_read_b64_tr_b16 v[200:201], v56 offset:40960
    ds_read_b64_tr_b16 v[202:203], v58 offset:43520
    v_mfma_f32_16x16x32_bf16 v[172:175], v[220:223], v[148:151], v[172:175]
    ds_read_b64_tr_b16 v[204:205], v57 offset:40960
    ds_read_b64_tr_b16 v[206:207], v59 offset:43520
    v_mfma_f32_16x16x32_bf16 v[160:163], v[224:227], v[144:147], v[160:163]
    ds_read_b64_tr_b16 v[208:209], v58 offset:40960
    ds_read_b64_tr_b16 v[210:211], v56 offset:43520
    v_mfma_f32_16x16x32_bf16 v[176:179], v[224:227], v[148:151], v[176:179]
    ds_read_b64_tr_b16 v[212:213], v59 offset:40960
    ds_read_b64_tr_b16 v[214:215], v57 offset:43520
    v_mfma_f32_16x16x32_bf16 v[164:167], v[228:231], v[144:147], v[164:167]
    v_mfma_f32_16x16x32_bf16 v[180:183], v[228:231], v[148:151], v[180:183]
    s_waitcnt vmcnt(2) lgkmcnt(8)
    v_mfma_f32_16x16x32_bf16 v[152:155], v[184:187], v[104:107], v[152:155]
    v_mfma_f32_16x16x32_bf16 v[156:159], v[188:191], v[104:107], v[156:159]
    v_mfma_f32_16x16x32_bf16 v[160:163], v[192:195], v[104:107], v[160:163]
    v_mfma_f32_16x16x32_bf16 v[164:167], v[196:199], v[104:107], v[164:167]
    s_sub_u32 s59, s56, s58
    s_cmp_lt_u32 s59, 32
    s_cbranch_scc1 K_YROW0
K_NOY0:
    s_sub_u32 s59, s57, s58
    s_cmp_lt_u32 s59, 32
    s_cbranch_scc1 K_YROW1
K_NOY1:
    s_waitcnt vmcnt(0) lgkmcnt(0)
    v_mfma_f32_16x16x32_bf16 v[152:155], v[200:203], v[112:115], v[152:155]
    v_mfma_f32_16x16x32_bf16 v[156:159], v[204:207], v[112:115], v[156:159]
    v_mfma_f32_16x16x32_bf16 v[160:163], v[208:211], v[112:115], v[160:163]
    v_mfma_f32_16x16x32_bf16 v[164:167], v[212:215], v[112:115], v[164:167]
    v_mfma_f32_16x16x32_bf16 v[168:171], v[184:187], v[108:111], v[168:171]
    v_mfma_f32_16x16x32_bf16 v[172:175], v[188:191], v[108:111], v[172:175]
    v_mfma_f32_16x16x32_bf16 v[176:179], v[192:195], v[108:111], v[176:179]
    s_nop 1
    v_fma_f32 v152, v152, v64, v72
    v_fma_f32 v153, v153, v64, v73
    v_fma_f32 v154, v154, v64, v74
    v_mfma_f32_16x16x32_bf16 v[180:183], v[196:199], v[108:111], v[180:183]
    v_fma_f32 v155, v155, v64, v75
    v_cvt_pk_bf16_f32 v40, v152, v153
    v_cvt_pk_bf16_f32 v41, v154, v155
    v_mfma_f32_16x16x32_bf16 v[168:171], v[200:203], v[116:119], v[168:171]
    v_fma_f32 v156, v156, v64, v76
    v_fma_f32 v157, v157, v64, v77
    ds_write_b64 v29, v[40:41] offset:0
    v_mfma_f32_16x16x32_bf16 v[172:175], v[204:207], v[116:119], v[172:175]
    v_fma_f32 v158, v158, v64, v78
    v_fma_f32 v159, v159, v64, v79
    v_cvt_pk_bf16_f32 v42, v156, v157
    v_mfma_f32_16x16x32_bf16 v[176:179], v[208:211], v[116:119], v[176:179]
    v_cvt_pk_bf16_f32 v43, v158, v159
    v_fma_f32 v160, v160, v64, v80
    v_fma_f32 v161, v161, v64, v81
    v_mfma_f32_16x16x32_bf16 v[180:183], v[212:215], v[116:119], v[180:183]
    ds_write_b64 v30, v[42:43] offset:0
    v_fma_f32 v162, v162, v64, v82
    v_fma_f32 v163, v163, v64, v83
    v_cvt_pk_bf16_f32 v44, v160, v161
    v_cvt_pk_bf16_f32 v45, v162, v163
    v_pk_fma_f32 v[164:165], v[164:165], v[64:65], v[84:85] op_sel_hi:[1,0,1]
    v_pk_fma_f32 v[166:167], v[166:167], v[64:65], v[86:87] op_sel_hi:[1,0,1]
    ds_write_b64 v31, v[44:45] offset:0
    v_cvt_pk_bf16_f32 v46, v164, v165
    v_cvt_pk_bf16_f32 v47, v166, v167
    ds_write_b64 v32, v[46:47] offset:0
    ds_read_b128 v[72:75], v33 offset:0
    ds_read_b128 v[76:79], v33 offset:1024
    v_pk_fma_f32 v[168:169], v[168:169], v[66:67], v[88:89] op_sel_hi:[1,0,1]
    v_pk_fma_f32 v[170:171], v[170:171], v[66:67], v[90:91] op_sel_hi:[1,0,1]
    v_cvt_pk_bf16_f32 v48, v168, v169
    v_cvt_pk_bf16_f32 v49, v170, v171
    v_pk_fma_f32 v[172:173], v[172:173], v[66:67], v[92:93] op_sel_hi:[1,0,1]
    v_pk_fma_f32 v[174:175], v[174:175], v[66:67], v[94:95] op_sel_hi:[1,0,1]
    v_cvt_pk_bf16_f32 v50, v172, v173
    v_cvt_pk_bf16_f32 v51, v174, v175
    v_pk_fma_f32 v[176:177], v[176:177], v[66:67], v[96:97] op_sel_hi:[1,0,1]
    v_pk_fma_f32 v[178:179], v[178:179], v[66:67], v[98:99] op_sel_hi:[1,0,1]
    v_cvt_pk_bf16_f32 v52, v176, v177
    v_cvt_pk_bf16_f32 v53, v178, v179
    v_pk_fma_f32 v[180:181], v[180:181], v[66:67], v[100:101] op_sel_hi:[1,0,1]
    v_pk_fma_f32 v[182:183], v[182:183], v[66:67], v[102:103] op_sel_hi:[1,0,1]
    v_cvt_pk_bf16_f32 v54, v180, v181
    v_cvt_pk_bf16_f32 v55, v182, v183
    s_waitcnt lgkmcnt(0)
    buffer_store_dwordx4 v[72:75], v27, s[48:51], s71 offen sc1
    buffer_store_dwordx4 v[76:79], v28, s[48:51], s72 offen sc1
    ds_write_b64 v29, v[48:49] offset:2048
    ds_write_b64 v30, v[50:51] offset:2048
    ds_write_b64 v31, v[52:53] offset:2048
    ds_write_b64 v32, v[54:55] offset:2048
    ds_read_b128 v[88:91], v33 offset:2048
    ds_read_b128 v[92:95], v33 offset:3072
    s_waitcnt lgkmcnt(1)
    buffer_store_dwordx4 v[88:91], v27, s[48:51], s73 offen sc1
    s_waitcnt lgkmcnt(0)
    buffer_store_dwordx4 v[92:95], v28, s[48:51], s74 offen sc1
K_END:
K_EXIT:
    s_endpgm
.p2align 12
WP_spin:
    s_setpc_b64 s[38:39]
K_SP0:
    ds_read_b32 v2, v12 offset:32
    s_waitcnt lgkmcnt(0)
    v_readfirstlane_b32 s33, v2
    s_nop 3
    s_lshr_b32 s63, s33, s64
    s_lshr_b32 s33, s33, s65
    s_and_b32 s63, s63, s33
    s_and_b32 s63, s63, 0xff
    s_andn2_b32 s63, s63, s66
    s_cbranch_scc0 K_SP0
    s_or_b32 s66, s66, s63
    s_branch K_SPR0
K_SP1:
    ds_read_b32 v2, v12 offset:32
    s_waitcnt lgkmcnt(0)
    v_readfirstlane_b32 s33, v2
    s_nop 3
    s_lshr_b32 s63, s33, s64
    s_lshr_b32 s33, s33, s65
    s_and_b32 s63, s63, s33
    s_and_b32 s63, s63, 0xff
    s_andn2_b32 s63, s63, s66
    s_cbranch_scc0 K_SP1
    s_or_b32 s66, s66, s63
    s_branch K_SPR1
K_SP2:
    ds_read_b32 v2, v12 offset:32
    s_waitcnt lgkmcnt(0)
    v_readfirstlane_b32 s33, v2
    s_nop 3
    s_lshr_b32 s63, s33, s64
    s_lshr_b32 s33, s33, s65
    s_and_b32 s63, s63, s33
    s_and_b32 s63, s63, 0xff
    s_andn2_b32 s63, s63, s66
    s_cbranch_scc0 K_SP2
    s_or_b32 s66, s66, s63
    s_branch K_SPR2
K_SP3:
    ds_read_b32 v2, v12 offset:32
    s_waitcnt lgkmcnt(0)
    v_readfirstlane_b32 s33, v2
    s_nop 3
    s_lshr_b32 s63, s33, s64
    s_lshr_b32 s33, s33, s65
    s_and_b32 s63, s63, s33
    s_and_b32 s63, s63, 0xff
    s_andn2_b32 s63, s63, s66
    s_cbranch_scc0 K_SP3
    s_or_b32 s66, s66, s63
    s_branch K_SPR3
K_SP4:
    ds_read_b32 v2, v12 offset:32
    s_waitcnt lgkmcnt(0)
    v_readfirstlane_b32 s33, v2
    s_nop 3
    s_lshr_b32 s63, s33, s64
    s_lshr_b32 s33, s33, s65
    s_and_b32 s63, s63, s33
    s_and_b32 s63, s63, 0xff
    s_andn2_b32 s63, s63, s66
    s_cbranch_scc0 K_SP4
    s_or_b32 s66, s66, s63
    s_branch K_SPR4
K_SP5:
    ds_read_b32 v2, v12 offset:32
    s_waitcnt lgkmcnt(0)
    v_readfirstlane_b32 s33, v2
    s_nop 3
    s_lshr_b32 s63, s33, s64
    s_lshr_b32 s33, s33, s65
    s_and_b32 s63, s63, s33
    s_and_b32 s63, s63, 0xff
    s_andn2_b32 s63, s63, s66
    s_cbranch_scc0 K_SP5
    s_or_b32 s66, s66, s63
    s_branch K_SPR5
K_SP6:
    ds_read_b32 v2, v12 offset:32
    s_waitcnt lgkmcnt(0)
    v_readfirstlane_b32 s33, v2
    s_nop 3
    s_lshr_b32 s63, s33, s64
    s_lshr_b32 s33, s33, s65
    s_and_b32 s63, s63, s33
    s_and_b32 s63, s63, 0xff
    s_andn2_b32 s63, s63, s66
    s_cbranch_scc0 K_SP6
    s_or_b32 s66, s66, s63
    s_branch K_SPR6
K_SP8:
    ds_read_b32 v2, v12 offset:32
    s_waitcnt lgkmcnt(0)
    v_readfirstlane_b32 s33, v2
    s_nop 3
    s_lshr_b32 s63, s33, s64
    s_lshr_b32 s33, s33, s65
    s_and_b32 s63, s63, s33
    s_and_b32 s63, s63, 0xff
    s_andn2_b32 s63, s63, s66
    s_cbranch_scc0 K_SP8
    s_or_b32 s66, s66, s63
    s_branch K_SPR8
K_SP10:
    ds_read_b32 v2, v12 offset:32
    s_waitcnt lgkmcnt(0)
    v_readfirstlane_b32 s33, v2
    s_nop 3
    s_lshr_b32 s63, s33, s64
    s_lshr_b32 s33, s33, s65
    s_and_b32 s63, s63, s33
    s_and_b32 s63, s63, 0xff00
    s_andn2_b32 s63, s63, s66
    s_cbranch_scc0 K_SP10
    s_or_b32 s66, s66, s63
    s_branch K_SPR10
K_SP11:
    ds_read_b32 v2, v12 offset:32
    s_waitcnt lgkmcnt(0)
    v_readfirstlane_b32 s33, v2
    s_nop 3
    s_lshr_b32 s63, s33, s64
    s_lshr_b32 s33, s33, s65
    s_and_b32 s63, s63, s33
    s_and_b32 s63, s63, 0xff00
    s_andn2_b32 s63, s63, s66
    s_cbranch_scc0 K_SP11
    s_or_b32 s66, s66, s63
    s_branch K_SPR11
K_SP12:
    ds_read_b32 v2, v12 offset:32
    s_waitcnt lgkmcnt(0)
    v_readfirstlane_b32 s33, v2
    s_nop 3
    s_lshr_b32 s63, s33, s64
    s_lshr_b32 s33, s33, s65
    s_and_b32 s63, s63, s33
    s_and_b32 s63, s63, 0xff00
    s_andn2_b32 s63, s63, s66
    s_cbranch_scc0 K_SP12
    s_or_b32 s66, s66, s63
    s_branch K_SPR12
K_SP13:
    ds_read_b32 v2, v12 offset:32
    s_waitcnt lgkmcnt(0)
    v_readfirstlane_b32 s33, v2
    s_nop 3
    s_lshr_b32 s63, s33, s64
    s_lshr_b32 s33, s33, s65
    s_and_b32 s63, s63, s33
    s_and_b32 s63, s63, 0xff00
    s_andn2_b32 s63, s63, s66
    s_cbranch_scc0 K_SP13
    s_or_b32 s66, s66, s63
    s_branch K_SPR13
K_SP14:
    ds_read_b32 v2, v12 offset:32
    s_waitcnt lgkmcnt(0)
    v_readfirstlane_b32 s33, v2
    s_nop 3
    s_lshr_b32 s63, s33, s64
    s_lshr_b32 s33, s33, s65
    s_and_b32 s63, s63, s33
    s_and_b32 s63, s63, 0xff00
    s_andn2_b32 s63, s63, s66
    s_cbranch_scc0 K_SP14
    s_or_b32 s66, s66, s63
    s_branch K_SPR14
K_SP15:
    ds_read_b32 v2, v12 offset:32
    s_waitcnt lgkmcnt(0)
    v_readfirstlane_b32 s33, v2
    s_nop 3
    s_lshr_b32 s63, s33, s64
    s_lshr_b32 s33, s33, s65
    s_and_b32 s63, s63, s33
    s_and_b32 s63, s63, 0xff00
    s_andn2_b32 s63, s63, s66
    s_cbranch_scc0 K_SP15
    s_or_b32 s66, s66, s63
    s_branch K_SPR15
K_SP16:
    ds_read_b32 v2, v12 offset:32
    s_waitcnt lgkmcnt(0)
    v_readfirstlane_b32 s33, v2
    s_nop 3
    s_lshr_b32 s63, s33, s64
    s_lshr_b32 s33, s33, s65
    s_and_b32 s63, s63, s33
    s_and_b32 s63, s63, 0xff00
    s_andn2_b32 s63, s63, s66
    s_cbranch_scc0 K_SP16
    s_or_b32 s66, s66, s63
    s_branch K_SPR16
K_SP18:
    ds_read_b32 v2, v12 offset:32
    s_waitcnt lgkmcnt(0)
    v_readfirstlane_b32 s33, v2
    s_nop 3
    s_lshr_b32 s63, s33, s64
    s_lshr_b32 s33, s33, s65
    s_and_b32 s63, s63, s33
    s_and_b32 s63, s63, 0xff00
    s_andn2_b32 s63, s63, s66
    s_cbranch_scc0 K_SP18
    s_or_b32 s66, s66, s63
    s_branch K_SPR18
WP_yr0:
    s_setpc_b64 s[38:39]
K_YROW0:
    v_lshlrev_b32 v5, 4, v9
    v_add_u32 v5, 158976, v5
    v_and_b32 v3, 15, v1
    s_and_b32 s33, s59, 15
    v_cmp_eq_u32 vcc, s33, v3
    s_mov_b32 s3, 1048576
K_P2_GY0:
    ds_read_b32 v2, v12 offset:64
    s_sub_u32 s3, s3, 1
    s_waitcnt lgkmcnt(0)
    v_readfirstlane_b32 s33, v2
    s_nop 3
    s_cselect_b32 s33, 1, s33
    s_cmp_lt_u32 s33, 1
    s_cbranch_scc1 K_P2_GY0
    s_mov_b64 exec, vcc
    s_cmp_ge_u32 s59, 16
    s_cbranch_scc1 K_YR1_0
    ds_read_b128 v[72:75], v5 offset:0
    ds_read_b128 v[76:79], v5 offset:64
    ds_read_b128 v[80:83], v5 offset:128
    ds_read_b128 v[84:87], v5 offset:192
    s_mov_b64 exec, -1
    s_branch K_NOY0
K_YR1_0:
    ds_read_b128 v[88:91], v5 offset:0
    ds_read_b128 v[92:95], v5 offset:64
    ds_read_b128 v[96:99], v5 offset:128
    ds_read_b128 v[100:103], v5 offset:192
    s_mov_b64 exec, -1
    s_branch K_NOY0
K_YROW1:
    v_lshlrev_b32 v5, 4, v9
    v_add_u32 v5, 159232, v5
    v_and_b32 v3, 15, v1
    s_and_b32 s33, s59, 15
    v_cmp_eq_u32 vcc, s33, v3
    s_mov_b32 s3, 1048576
K_P2_GY1:
    ds_read_b32 v2, v12 offset:68
    s_sub_u32 s3, s3, 1
    s_waitcnt lgkmcnt(0)
    v_readfirstlane_b32 s33, v2
    s_nop 3
    s_cselect_b32 s33, 1, s33
    s_cmp_lt_u32 s33, 1
    s_cbranch_scc1 K_P2_GY1
    s_mov_b64 exec, vcc
    s_cmp_ge_u32 s59, 16
    s_cbranch_scc1 K_YR1_1
    ds_read_b128 v[72:75], v5 offset:0
    ds_read_b128 v[76:79], v5 offset:64
    ds_read_b128 v[80:83], v5 offset:128
    ds_read_b128 v[84:87], v5 offset:192
    s_mov_b64 exec, -1
    s_branch K_NOY1
K_YR1_1:
    ds_read_b128 v[88:91], v5 offset:0
    ds_read_b128 v[92:95], v5 offset:64
    ds_read_b128 v[96:99], v5 offset:128
    ds_read_b128 v[100:103], v5 offset:192
    s_mov_b64 exec, -1
    s_branch K_NOY1
.p2align 12
WP_gen:
    s_setpc_b64 s[38:39]
K_P2:
    s_cmp_ge_u32 s30, 4
    s_cbranch_scc1 K_P2_HELP
    v_mov_b32 v12, 158720
    s_cmp_lg_u32 s30, 0
    s_cbranch_scc1 K_P2_W13
    v_lshrrev_b32 v3, 4, v1
    v_and_b32 v4, 7, v1
    v_lshrrev_b32 v2, 3, v1
    v_xor_b32 v4, v4, v3
    v_mul_u32_u24 v2, 1280, v2
    v_lshl_add_u32 v27, v4, 4, v2
    v_xor_b32 v28, 64, v27
    s_mov_b32 s58, 0
K_P2_XD:
    s_lshl_b32 s59, s40, 3
    s_lshl1_add_u32 s59, s58, s59
    s_mul_i32 s59, s59, 20480
    s_lshl_b32 s33, s41, 7
    s_add_u32 s59, s59, s33
    s_lshl_b32 s33, s58, 12
    s_add_u32 m0, s33, 140288
    s_add_u32 s3, s59, 0
    buffer_load_dwordx4 v27, s[12:15], s3 offen lds
    s_add_u32 m0, s33, 141312
    s_add_u32 s3, s59, 10240
    buffer_load_dwordx4 v28, s[12:15], s3 offen lds
    s_add_u32 m0, s33, 142336
    s_add_u32 s3, s59, 20480
    buffer_load_dwordx4 v27, s[12:15], s3 offen lds
    s_add_u32 m0, s33, 143360
    s_add_u32 s3, s59, 30720
    buffer_load_dwordx4 v28, s[12:15], s3 offen lds
    s_add_u32 s58, s58, 1
    s_cmp_lt_u32 s58, 4
    s_cbranch_scc1 K_P2_XD
    s_waitcnt vmcnt(0)
    s_branch K_P2_AUXW
K_P2_W13:
    v_lshrrev_b32 v2, 3, v1
    v_mul_u32_u24 v2, 1280, v2
    v_lshrrev_b32 v3, 4, v1
    v_lshlrev_b32 v3, 1, v3
    v_and_b32 v4, 7, v1
    v_xor_b32 v3, v3, v4
    v_lshl_add_u32 v2, v3, 4, v2
    s_lshl_b32 s33, s41, 7
    v_add_u32 v22, s33, v2
    s_mov_b32 s60, 0xfda87520
    s_mov_b32 s61, 0xecb96431
    s_sub_u32 s58, s30, 1
K_P2_WS:
    s_lshl_b32 s3, s58, 2
    s_lshr_b64 s[4:5], s[60:61], s3
    s_and_b32 s4, s4, 15
    s_mul_i32 s4, s4, 51200
    s_mul_i32 s59, s58, 5120
    s_add_u32 s52, s4, 0
    s_add_u32 m0, s59, 0
    s_waitcnt vmcnt(11)
    buffer_load_dwordx4 v22, s[24:27], s52 offen lds
    s_add_u32 s52, s4, 10240
    s_add_u32 m0, s59, 1024
    s_waitcnt vmcnt(11)
    buffer_load_dwordx4 v22, s[24:27], s52 offen lds
    s_add_u32 s52, s4, 20480
    s_add_u32 m0, s59, 2048
    s_waitcnt vmcnt(11)
    buffer_load_dwordx4 v22, s[24:27], s52 offen lds
    s_add_u32 s52, s4, 30720
    s_add_u32 m0, s59, 3072
    s_waitcnt vmcnt(11)
    buffer_load_dwordx4 v22, s[24:27], s52 offen lds
    s_add_u32 s52, s4, 40960
    s_add_u32 m0, s59, 4096
    s_waitcnt vmcnt(11)
    buffer_load_dwordx4 v22, s[24:27], s52 offen lds
    s_cmp_ge_u32 s58, 3
    s_cbranch_scc1 K_P2_WS1
    v_mov_b32 v3, 1
    s_waitcnt vmcnt(5)
    s_mov_b64 exec, 1
    ds_add_u32 v12, v3 offset:52
    s_mov_b64 exec, -1
K_P2_WS1:
    s_add_u32 s58, s58, 3
    s_cmp_lt_u32 s58, 16
    s_cbranch_scc1 K_P2_WS
K_P2_AUXW:
    v_mov_b32 v34, 1
    s_waitcnt vmcnt(10)
    s_mov_b64 exec, 1
    ds_add_u32 v12, v34 offset:72
    s_mov_b64 exec, -1
    s_lshl_b32 s54, s40, 7
    v_lshrrev_b32 v9, 4, v1
    v_mov_b32 v12, 158720
    s_add_u32 s20, s10, 0x100000
    s_addc_u32 s21, s11, 0
    s_mov_b32 s22, 0x280000
    s_mov_b32 s23, 0x20000
    s_add_u32 s16, s10, 0x1000
    s_addc_u32 s17, s11, 0
    s_mov_b32 s18, 0x2000
    s_mov_b32 s19, 0x20000
    s_mov_b32 s48, s6
    s_mov_b32 s49, s7
    s_mov_b32 s50, 0x280000
    s_mov_b32 s51, 0x20000
    s_lshl_b32 s53, s40, 3
    s_lshl1_add_u32 s53, s30, s53
    s_mov_b32 s55, 20480
    v_bfe_u32 v20, v1, 2, 2
    v_and_b32 v21, 3, v1
    s_mul_i32 s3, s53, 20480
    v_lshl_add_u32 v25, v1, 4, s3
    v_add_u32 v26, 20480, v25
    v_add_u32 v35, 16384, v25
    v_add_u32 v36, 16384, v26
    v_and_b32 v2, 15, v1
    s_lshl_b32 s3, s53, 6
    v_lshl_add_u32 v23, v2, 2, s3
    v_lshl_add_u32 v2, v9, 2, v20
    v_bfe_u32 v3, v2, 1, 2
    v_lshlrev_b32 v2, 7, v2
    v_lshl_add_u32 v2, v21, 3, v2
    v_lshl_add_u32 v24, v3, 5, v2
    v_lshrrev_b32 v3, 1, v20
    v_mul_u32_u24 v2, 40, v9
    v_add3_u32 v2, v2, 16, v20
    v_lshlrev_b32 v2, 7, v2
    v_lshl_add_u32 v2, v21, 3, v2
    v_xor_b32 v4, 0, v3
    v_lshl_add_u32 v60, v4, 5, v2
    v_xor_b32 v4, 1, v3
    v_lshl_add_u32 v61, v4, 5, v2
    v_xor_b32 v4, 2, v3
    v_lshl_add_u32 v62, v4, 5, v2
    v_xor_b32 v4, 3, v3
    v_lshl_add_u32 v63, v4, 5, v2
    v_lshrrev_b32 v3, 4, v1
    v_and_b32 v4, 7, v1
    v_lshrrev_b32 v2, 3, v1
    v_xor_b32 v4, v4, v3
    v_mul_u32_u24 v2, 1280, v2
    v_lshl_add_u32 v27, v4, 4, v2
    v_xor_b32 v28, 64, v27
    s_lshl_b32 s71, s40, 3
    s_lshl1_add_u32 s71, s30, s71
    s_mul_i32 s71, s71, 20480
    s_lshl_b32 s33, s41, 7
    s_add_u32 s71, s71, s33
    s_add_u32 s72, s71, 10240
    s_add_u32 s73, s71, 20480
    s_add_u32 s74, s71, 30720
    s_lshl_b32 s3, s30, 12
    s_add_u32 s3, s3, 140288
    v_lshl_add_u32 v33, v1, 4, s3
    v_and_b32 v2, 15, v1
    v_lshrrev_b32 v3, 1, v2
    v_lshrrev_b32 v4, 5, v1
    v_xor_b32 v3, v3, v4
    v_lshlrev_b32 v3, 4, v3
    v_lshl_add_u32 v3, v2, 7, v3
    v_and_b32 v4, 1, v9
    v_lshl_add_u32 v3, v4, 3, v3
    v_add_u32 v29, s3, v3
    v_xor_b32 v30, 32, v29
    v_xor_b32 v31, 64, v29
    v_xor_b32 v32, 96, v29
    s_and_b32 s33, s40, 3
    s_lshl_b32 s33, s33, 3
    s_lshr_b32 s33, 0x7f06037f, s33
    s_and_b32 s33, s33, 0xff
    s_lshl_b32 s3, s30, 1
    s_cmp_ge_u32 s3, s33
    s_cselect_b32 s64, 16, 0
    s_add_u32 s3, s3, 1
    s_cmp_ge_u32 s3, s33
    s_cselect_b32 s65, 16, 0
    s_mov_b32 s63, 0
    s_mov_b32 s66, 0
    s_mov_b32 s67, 16384
    s_mov_b32 s3, 1048576
K_P2_GWA:
    ds_read_b32 v2, v12 offset:72
    s_sub_u32 s3, s3, 1
    s_waitcnt lgkmcnt(0)
    v_readfirstlane_b32 s33, v2
    s_nop 3
    s_cselect_b32 s33, 4, s33
    s_cmp_lt_u32 s33, 4
    s_cbranch_scc1 K_P2_GWA
    s_branch K_P2_GEMM
WP_help:
    s_setpc_b64 s[38:39]
K_LATE:
    s_sub_u32 s44, s30, 4
K_WOL:
    s_lshl_b32 s50, s44, 2
    s_lshr_b32 s50, 0x6431, s50
    s_and_b32 s50, s50, 7
    s_mul_i32 s50, s50, 51200
    s_mul_i32 s51, s44, 5120
    s_add_u32 s3, s50, 0
    s_add_u32 m0, s51, 40960
    s_waitcnt vmcnt(13)
    buffer_load_dwordx4 v18, s[24:27], s3 offen lds
    s_add_u32 s3, s50, 10240
    s_add_u32 m0, s51, 41984
    s_waitcnt vmcnt(13)
    buffer_load_dwordx4 v18, s[24:27], s3 offen lds
    s_add_u32 s3, s50, 20480
    s_add_u32 m0, s51, 43008
    s_waitcnt vmcnt(13)
    buffer_load_dwordx4 v18, s[24:27], s3 offen lds
    s_add_u32 s3, s50, 30720
    s_add_u32 m0, s51, 44032
    s_waitcnt vmcnt(13)
    buffer_load_dwordx4 v18, s[24:27], s3 offen lds
    s_add_u32 s3, s50, 40960
    s_add_u32 m0, s51, 45056
    s_waitcnt vmcnt(13)
    buffer_load_dwordx4 v18, s[24:27], s3 offen lds
    s_add_u32 s3, s50, 409600
    s_add_u32 m0, s51, 61440
    s_waitcnt vmcnt(13)
    buffer_load_dwordx4 v18, s[24:27], s3 offen lds
    s_add_u32 s3, s50, 419840
    s_add_u32 m0, s51, 62464
    s_waitcnt vmcnt(13)
    buffer_load_dwordx4 v18, s[24:27], s3 offen lds
    s_add_u32 s3, s50, 430080
    s_add_u32 m0, s51, 63488
    s_waitcnt vmcnt(13)
    buffer_load_dwordx4 v18, s[24:27], s3 offen lds
    s_add_u32 s3, s50, 440320
    s_add_u32 m0, s51, 64512
    s_waitcnt vmcnt(13)
    buffer_load_dwordx4 v18, s[24:27], s3 offen lds
    s_add_u32 s3, s50, 450560
    s_add_u32 m0, s51, 65536
    s_waitcnt vmcnt(13)
    buffer_load_dwordx4 v18, s[24:27], s3 offen lds
    s_add_u32 s44, s44, 2
    s_cmp_lt_u32 s44, 4
    s_cbranch_scc1 K_WOL
    v_mov_b32 v2, 158720
    v_mov_b32 v3, 2
    s_waitcnt vmcnt(0)
    s_mov_b64 exec, 1
    ds_add_u32 v2, v3 offset:44
    s_mov_b64 exec, -1
K_P2_HELP:
    s_setprio 3
    s_add_u32 s59, s40, 1
    s_bitcmp1_b32 s59, 1
    s_cselect_b32 s59, 31, 15
    v_and_b32 v10, s59, v1
    v_lshl_add_u32 v10, v10, 2, s42
    s_cmp_lg_u32 s30, 7
    s_cbranch_scc1 K_P2_N7
    v_and_b32 v4, 7, v1
    v_lshlrev_b32 v4, 2, v4
    s_mov_b32 s3, 131072
K_ZPOLL1:
    v_cmp_eq_u32 vcc, 0, v7
    s_cbranch_vccz K_ZOK1
    s_sub_u32 s3, s3, 1
    s_cbranch_scc1 K_ZOK1
    global_load_dword v7, v4, s[8:9] offset:192 sc1
    s_waitcnt vmcnt(0)
    s_branch K_ZPOLL1
K_ZOK1:
    global_load_dword v7, v10, s[10:11] sc1
K_P2_N7:
    s_lshl_b32 s54, s40, 7
    v_lshrrev_b32 v9, 4, v1
    v_mov_b32 v12, 158720
    s_add_u32 s44, s10, 0x10000
    s_addc_u32 s45, s11, 0
    s_mov_b32 s46, 0x43800
    s_mov_b32 s47, 0x20000
    v_mov_b32 v80, 1
    s_cmp_eq_u32 s30, 7
    s_cbranch_scc1 K_P2_FLAGS
    s_cmp_lg_u32 s30, 6
    s_cbranch_scc1 K_END
    s_mov_b32 s3, 131072
K_P2_DPOLL:
    v_cmp_eq_u32 vcc, 0, v7
    s_cbranch_vccz K_P2_DOK
    s_cmp_eq_u32 s3, 131072
    s_cbranch_scc1 K_P2_DNS
    s_sleep 12
K_P2_DNS:
    v_and_b32 v11, 1, v1
    v_lshl_add_u32 v11, v11, 2, s42
    global_load_dword v7, v11, s[10:11] offset:128 sc1
    s_sub_u32 s3, s3, 1
    s_waitcnt vmcnt(0)
    s_cmp_lg_u32 s3, 0
    s_cbranch_scc1 K_P2_DPOLL
K_P2_DOK:
    v_readlane_b32 s58, v7, 0
    v_readlane_b32 s59, v7, 1
    s_nop 3
    s_and_b32 s3, s58, 0x7ff
    s_sub_u32 s3, 2047, s3
    v_mov_b32 v20, s3
    v_mov_b32 v4, s58
    v_and_b32 v4, 0xffff0000, v4
    v_ashrrev_i32 v5, 31, v4
    v_not_b32 v5, v5
    v_or_b32 v5, 0x80000000, v5
    v_xor_b32 v4, v4, v5
    v_and_b32 v4, 0xffff0000, v4
    v_mul_f32 v5, 0xbfb8aa3b, v4
    v_exp_f32 v5, v5
    s_nop 0
    v_add_f32 v5, 1.0, v5
    v_rcp_f32 v4, v5
    s_nop 0
    v_cvt_pk_bf16_f32 v22, v4, v4
    v_lshlrev_b32 v22, 16, v22
    s_and_b32 s3, s59, 0x7ff
    s_sub_u32 s3, 2047, s3
    v_mov_b32 v21, s3
    v_mov_b32 v4, s59
    v_and_b32 v4, 0xffff0000, v4
    v_ashrrev_i32 v5, 31, v4
    v_not_b32 v5, v5
    v_or_b32 v5, 0x80000000, v5
    v_xor_b32 v4, v4, v5
    v_and_b32 v4, 0xffff0000, v4
    v_mul_f32 v5, 0xbfb8aa3b, v4
    v_exp_f32 v5, v5
    s_nop 0
    v_add_f32 v5, 1.0, v5
    v_rcp_f32 v4, v5
    s_nop 0
    v_cvt_pk_bf16_f32 v23, v4, v4
    v_lshlrev_b32 v23, 16, v23
    ds_write_b128 v12, v[20:23]
    ds_write_b32 v12, v80 offset:40
    s_mov_b32 s53, 0
    v_mov_b32 v16, v20
    v_mov_b32 v17, v21
    v_mov_b32 v18, v22
    v_mov_b32 v19, v23
K_P2_HW:
    s_cmp_eq_u32 s53, 0
    s_cselect_b64 vcc, -1, 0
    s_nop 1
    v_cndmask_b32 v2, v17, v16, vcc
    v_cndmask_b32 v5, v19, v18, vcc
    s_nop 0
    v_readfirstlane_b32 s58, v2
    s_nop 3
    s_sub_u32 s3, s58, s54
    s_cmp_lt_u32 s3, 128
    s_cbranch_scc0 K_P2_YN
    s_call_b64 s[38:39], WP_yr0
    s_mul_i32 s3, s58, 1280
    s_lshl_b32 s33, s41, 7
    s_add_u32 s3, s3, s33
    v_and_b32 v2, 15, v1
    v_lshlrev_b32 v2, 3, v2
    buffer_load_dwordx2 v[84:85], v2, s[12:15], s3 offen
    s_lshl_b32 s3, s58, 2
    s_add_u32 s3, s3, 4096
    v_mov_b32 v2, s3
    global_load_dword v88, v2, s[10:11] sc1
    s_lshl1_add_u32 s3, s41, s53
    s_lshl_b32 s3, s3, 8
    s_add_u32 s3, s3, 568320
    v_min_u32 v3, 53, v1
    v_lshl_add_u32 v3, v3, 2, s3
    s_mov_b32 s3, 131072
K_P2_YPOLL:
    global_load_dword v2, v3, s[10:11] sc1
    s_sub_u32 s3, s3, 1
    s_waitcnt vmcnt(0)
    v_cmp_ne_u32 vcc, 1, v2
    s_cbranch_vccz K_P2_YGO
    s_sleep 16
    s_cmp_lg_u32 s3, 0
    s_cbranch_scc1 K_P2_YPOLL
K_P2_YGO:
    v_and_b32 v2, 15, v1
    v_lshlrev_b32 v2, 4, v2
    v_mul_u32_u24 v4, 5120, v9
    s_mov_b32 s59, s53
    s_mul_i32 s33, s59, 2560
    s_lshl_b32 s3, s41, 8
    s_add_u32 s3, s3, s33
    v_add3_u32 v3, v2, v4, s3
    s_mov_b32 s52, 0
    buffer_load_dwordx4 v[24:27], v3, s[44:47], s52 offen sc1
    s_mov_b32 s52, 20480
    buffer_load_dwordx4 v[28:31], v3, s[44:47], s52 offen sc1
    s_mov_b32 s52, 40960
    buffer_load_dwordx4 v[32:35], v3, s[44:47], s52 offen sc1
    s_mov_b32 s52, 61440
    buffer_load_dwordx4 v[36:39], v3, s[44:47], s52 offen sc1
    s_mov_b32 s52, 81920
    buffer_load_dwordx4 v[40:43], v3, s[44:47], s52 offen sc1
    s_mov_b32 s52, 102400
    buffer_load_dwordx4 v[44:47], v3, s[44:47], s52 offen sc1
    s_mov_b32 s52, 122880
    buffer_load_dwordx4 v[48:51], v3, s[44:47], s52 offen sc1
    s_mov_b32 s52, 143360
    buffer_load_dwordx4 v[52:55], v3, s[44:47], s52 offen sc1
    s_mov_b32 s52, 163840
    buffer_load_dwordx4 v[56:59], v3, s[44:47], s52 offen sc1
    s_mov_b32 s52, 184320
    buffer_load_dwordx4 v[60:63], v3, s[44:47], s52 offen sc1
    s_mov_b32 s52, 204800
    buffer_load_dwordx4 v[64:67], v3, s[44:47], s52 offen sc1
    s_mov_b32 s52, 225280
    buffer_load_dwordx4 v[68:71], v3, s[44:47], s52 offen sc1
    s_mov_b32 s52, 245760
    buffer_load_dwordx4 v[72:75], v3, s[44:47], s52 offen sc1
    s_mov_b32 s52, 266240
    buffer_load_dwordx4 v[76:79], v3, s[44:47], s52 offen sc1
    v_sub_f32 v88, 1.0, v88
    v_cvt_pk_bf16_f32 v88, v88, v88
    v_lshlrev_b32 v88, 16, v88
    v_lshlrev_b32 v86, 16, v85
    v_and_b32 v87, 0xffff0000, v85
    v_and_b32 v85, 0xffff0000, v84
    v_lshlrev_b32 v84, 16, v84
    s_waitcnt vmcnt(12)
    v_add_f32 v20, v24, v28
    v_add_f32 v21, v25, v29
    v_add_f32 v22, v26, v30
    v_add_f32 v23, v27, v31
    s_waitcnt vmcnt(11)
    v_add_f32 v20, v20, v32
    v_add_f32 v21, v21, v33
    v_add_f32 v22, v22, v34
    v_add_f32 v23, v23, v35
    s_waitcnt vmcnt(10)
    v_add_f32 v20, v20, v36
    v_add_f32 v21, v21, v37
    v_add_f32 v22, v22, v38
    v_add_f32 v23, v23, v39
    s_waitcnt vmcnt(9)
    v_add_f32 v20, v20, v40
    v_add_f32 v21, v21, v41
    v_add_f32 v22, v22, v42
    v_add_f32 v23, v23, v43
    s_waitcnt vmcnt(8)
    v_add_f32 v20, v20, v44
    v_add_f32 v21, v21, v45
    v_add_f32 v22, v22, v46
    v_add_f32 v23, v23, v47
    s_waitcnt vmcnt(7)
    v_add_f32 v20, v20, v48
    v_add_f32 v21, v21, v49
    v_add_f32 v22, v22, v50
    v_add_f32 v23, v23, v51
    s_waitcnt vmcnt(6)
    v_add_f32 v20, v20, v52
    v_add_f32 v21, v21, v53
    v_add_f32 v22, v22, v54
    v_add_f32 v23, v23, v55
    s_waitcnt vmcnt(5)
    v_add_f32 v20, v20, v56
    v_add_f32 v21, v21, v57
    v_add_f32 v22, v22, v58
    v_add_f32 v23, v23, v59
    s_waitcnt vmcnt(4)
    v_add_f32 v20, v20, v60
    v_add_f32 v21, v21, v61
    v_add_f32 v22, v22, v62
    v_add_f32 v23, v23, v63
    s_waitcnt vmcnt(3)
    v_add_f32 v20, v20, v64
    v_add_f32 v21, v21, v65
    v_add_f32 v22, v22, v66
    v_add_f32 v23, v23, v67
    s_waitcnt vmcnt(2)
    v_add_f32 v20, v20, v68
    v_add_f32 v21, v21, v69
    v_add_f32 v22, v22, v70
    v_add_f32 v23, v23, v71
    s_waitcnt vmcnt(1)
    v_add_f32 v20, v20, v72
    v_add_f32 v21, v21, v73
    v_add_f32 v22, v22, v74
    v_add_f32 v23, v23, v75
    s_waitcnt vmcnt(0)
    v_add_f32 v20, v20, v76
    v_add_f32 v21, v21, v77
    v_add_f32 v22, v22, v78
    v_add_f32 v23, v23, v79
    v_mov_b32 v24, v20
    v_mov_b32 v25, v21
    v_mov_b32 v26, v22
    v_mov_b32 v27, v23
    s_nop 0
    v_permlane16_swap_b32 v20, v24
    v_permlane16_swap_b32 v21, v25
    v_permlane16_swap_b32 v22, v26
    v_permlane16_swap_b32 v23, v27
    v_add_f32 v20, v20, v24
    v_add_f32 v21, v21, v25
    v_add_f32 v22, v22, v26
    v_add_f32 v23, v23, v27
    v_mov_b32 v24, v20
    v_mov_b32 v25, v21
    v_mov_b32 v26, v22
    v_mov_b32 v27, v23
    s_nop 0
    v_permlane32_swap_b32 v20, v24
    v_permlane32_swap_b32 v21, v25
    v_permlane32_swap_b32 v22, v26
    v_permlane32_swap_b32 v23, v27
    v_add_f32 v20, v20, v24
    v_add_f32 v21, v21, v25
    v_add_f32 v22, v22, v26
    v_add_f32 v23, v23, v27
    v_cvt_pk_bf16_f32 v20, v20, v20
    v_lshlrev_b32 v20, 16, v20
    v_mul_f32 v20, v5, v20
    v_cvt_pk_bf16_f32 v20, v20, v20
    v_lshlrev_b32 v20, 16, v20
    v_add_f32 v20, v20, v84
    v_cvt_pk_bf16_f32 v20, v20, v20
    v_lshlrev_b32 v20, 16, v20
    v_mul_f32 v20, v20, v88
    v_cvt_pk_bf16_f32 v21, v21, v21
    v_lshlrev_b32 v21, 16, v21
    v_mul_f32 v21, v5, v21
    v_cvt_pk_bf16_f32 v21, v21, v21
    v_lshlrev_b32 v21, 16, v21
    v_add_f32 v21, v21, v85
    v_cvt_pk_bf16_f32 v21, v21, v21
    v_lshlrev_b32 v21, 16, v21
    v_mul_f32 v21, v21, v88
    v_cvt_pk_bf16_f32 v22, v22, v22
    v_lshlrev_b32 v22, 16, v22
    v_mul_f32 v22, v5, v22
    v_cvt_pk_bf16_f32 v22, v22, v22
    v_lshlrev_b32 v22, 16, v22
    v_add_f32 v22, v22, v86
    v_cvt_pk_bf16_f32 v22, v22, v22
    v_lshlrev_b32 v22, 16, v22
    v_mul_f32 v22, v22, v88
    v_cvt_pk_bf16_f32 v23, v23, v23
    v_lshlrev_b32 v23, 16, v23
    v_mul_f32 v23, v5, v23
    v_cvt_pk_bf16_f32 v23, v23, v23
    v_lshlrev_b32 v23, 16, v23
    v_add_f32 v23, v23, v87
    v_cvt_pk_bf16_f32 v23, v23, v23
    v_lshlrev_b32 v23, 16, v23
    v_mul_f32 v23, v23, v88
    s_lshl_b32 s3, s59, 8
    s_add_u32 s3, s3, 158976
    v_add_u32 v2, s3, v2
    ds_write_b128 v2, v[20:23]
    s_lshl_b32 s3, s59, 2
    v_add_u32 v2, s3, v12
    ds_write_b32 v2, v80 offset:64
K_P2_YN:
    s_add_u32 s53, s53, 1
    s_cmp_lt_u32 s53, 2
    s_cbranch_scc1 K_P2_HW
    s_branch K_END
WP_flags:
    s_setpc_b64 s[38:39]
K_P2_FLAGS:
    s_mov_b32 exec_hi, 0
    s_waitcnt vmcnt(0)
    s_mov_b32 s3, 131072
K_P2_FCHK:
    v_cmp_eq_u32 vcc, 1, v7
    s_nop 1
    v_mov_b32 v2, vcc_lo
    ds_write_b32 v12, v2 offset:32
    s_cmp_eq_u32 vcc_lo, -1
    s_cbranch_scc1 K_P2_FGO
    s_cmp_lg_u32 vcc_lo, 0
    s_cbranch_scc1 K_P2_FS
    s_sleep 4
K_P2_FS:
    s_sleep 6
    global_load_dword v7, v10, s[10:11] sc1
    s_sub_u32 s3, s3, 1
    s_waitcnt vmcnt(0)
    s_cbranch_scc0 K_P2_FCHK
    v_mov_b32 v2, -1
    ds_write_b32 v12, v2 offset:32
K_P2_FGO:
    s_mov_b64 exec, -1
    s_branch K_END
.p2align 12
K_AUX:
    s_load_dwordx8 s[48:55], s[0:1], 32
    s_load_dwordx2 s[56:57], s[0:1], 64
    s_mul_i32 s44, s28, 7
    s_add_u32 s44, s44, s29
    s_sub_u32 s44, s44, 1
    s_cmp_lt_u32 s44, 54
    s_cselect_b32 s44, s44, 63
    s_cmp_eq_u32 s29, 0
    s_cselect_b32 s44, 63, s44
    s_lshl_b32 s74, s28, 8
    s_lshl_b32 s3, s29, 5
    s_add_u32 s74, s74, s3
    v_mov_b32 v12, 158720
    v_mov_b32 v13, 1
    s_cmp_lt_u32 s30, 4
    s_cbranch_scc1 K_AUX_LO
    s_lshl_b32 s3, s30, 3
    s_add_u32 s3, s3, s74
    s_sub_u32 s3, s3, 32
    v_lshrrev_b32 v9, 3, v1
    v_add_u32 v9, s3, v9
    v_and_b32 v11, 7, v1
    v_lshlrev_b32 v11, 4, v11
    v_mul_u32_u24 v10, 1280, v9
    v_add_u32 v10, v10, v11
    s_waitcnt lgkmcnt(0)
    buffer_load_dwordx4 v[16:19], v10, s[12:15], 0 offen offset:0
    buffer_load_dwordx4 v[20:23], v10, s[12:15], 0 offen offset:128
    buffer_load_dwordx4 v[24:27], v10, s[12:15], 0 offen offset:256
    buffer_load_dwordx4 v[28:31], v10, s[12:15], 0 offen offset:384
    buffer_load_dwordx4 v[32:35], v10, s[12:15], 0 offen offset:512
    buffer_load_dwordx4 v[36:39], v10, s[12:15], 0 offen offset:640
    buffer_load_dwordx4 v[40:43], v10, s[12:15], 0 offen offset:768
    buffer_load_dwordx4 v[44:47], v10, s[12:15], 0 offen offset:896
    buffer_load_dwordx4 v[48:51], v10, s[12:15], 0 offen offset:1024
    buffer_load_dwordx4 v[52:55], v10, s[12:15], 0 offen offset:1152
    s_mov_b32 s16, s48
    s_mov_b32 s17, s49
    s_mov_b32 s18, 0x500
    s_mov_b32 s19, 0x20000
    s_mov_b32 s20, s56
    s_mov_b32 s21, s57
    s_mov_b32 s22, 0x500
    s_mov_b32 s23, 0x20000
    buffer_load_dwordx4 v[56:59], v11, s[16:19], 0 offen offset:0
    buffer_load_dwordx4 v[60:63], v11, s[16:19], 0 offen offset:128
    buffer_load_dwordx4 v[64:67], v11, s[16:19], 0 offen offset:256
    buffer_load_dwordx4 v[68:71], v11, s[16:19], 0 offen offset:384
    buffer_load_dwordx4 v[72:75], v11, s[16:19], 0 offen offset:512
    buffer_load_dwordx4 v[76:79], v11, s[16:19], 0 offen offset:640
    buffer_load_dwordx4 v[80:83], v11, s[16:19], 0 offen offset:768
    buffer_load_dwordx4 v[84:87], v11, s[16:19], 0 offen offset:896
    buffer_load_dwordx4 v[88:91], v11, s[16:19], 0 offen offset:1024
    buffer_load_dwordx4 v[92:95], v11, s[16:19], 0 offen offset:1152
    buffer_load_dwordx4 v[96:99], v11, s[20:23], 0 offen offset:0
    buffer_load_dwordx4 v[100:103], v11, s[20:23], 0 offen offset:128
    buffer_load_dwordx4 v[104:107], v11, s[20:23], 0 offen offset:256
    buffer_load_dwordx4 v[108:111], v11, s[20:23], 0 offen offset:384
    buffer_load_dwordx4 v[112:115], v11, s[20:23], 0 offen offset:512
    buffer_load_dwordx4 v[116:119], v11, s[20:23], 0 offen offset:640
    buffer_load_dwordx4 v[120:123], v11, s[20:23], 0 offen offset:768
    buffer_load_dwordx4 v[124:127], v11, s[20:23], 0 offen offset:896
    buffer_load_dwordx4 v[128:131], v11, s[20:23], 0 offen offset:1024
    buffer_load_dwordx4 v[132:135], v11, s[20:23], 0 offen offset:1152
    s_barrier
    v_mov_b32 v180, 0
    v_mov_b32 v181, 0
    v_mov_b32 v182, 0
    v_mov_b32 v183, 0
    v_and_b32 v10, 31, v9
    v_lshlrev_b32 v10, 2, v10
    v_add_u32 v10, 122880, v10
    v_sub_u32 v4, 0x87ff, v9
    s_setprio 2
    s_waitcnt vmcnt(10)
    v_dot2c_f32_bf16 v180, v16, v56
    v_dot2c_f32_bf16 v181, v17, v57
    v_dot2c_f32_bf16 v180, v18, v58
    v_dot2c_f32_bf16 v181, v19, v59
    v_dot2c_f32_bf16 v180, v20, v60
    v_dot2c_f32_bf16 v181, v21, v61
    v_dot2c_f32_bf16 v180, v22, v62
    v_dot2c_f32_bf16 v181, v23, v63
    v_dot2c_f32_bf16 v180, v24, v64
    v_dot2c_f32_bf16 v181, v25, v65
    v_dot2c_f32_bf16 v180, v26, v66
    v_dot2c_f32_bf16 v181, v27, v67
    v_dot2c_f32_bf16 v180, v28, v68
    v_dot2c_f32_bf16 v181, v29, v69
    v_dot2c_f32_bf16 v180, v30, v70
    v_dot2c_f32_bf16 v181, v31, v71
    v_dot2c_f32_bf16 v180, v32, v72
    v_dot2c_f32_bf16 v181, v33, v73
    v_dot2c_f32_bf16 v180, v34, v74
    v_dot2c_f32_bf16 v181, v35, v75
    v_dot2c_f32_bf16 v180, v36, v76
    v_dot2c_f32_bf16 v181, v37, v77
    v_dot2c_f32_bf16 v180, v38, v78
    v_dot2c_f32_bf16 v181, v39, v79
    v_dot2c_f32_bf16 v180, v40, v80
    v_dot2c_f32_bf16 v181, v41, v81
    v_dot2c_f32_bf16 v180, v42, v82
    v_dot2c_f32_bf16 v181, v43, v83
    v_dot2c_f32_bf16 v180, v44, v84
    v_dot2c_f32_bf16 v181, v45, v85
    v_dot2c_f32_bf16 v180, v46, v86
    v_dot2c_f32_bf16 v181, v47, v87
    v_dot2c_f32_bf16 v180, v48, v88
    v_dot2c_f32_bf16 v181, v49, v89
    v_dot2c_f32_bf16 v180, v50, v90
    v_dot2c_f32_bf16 v181, v51, v91
    v_dot2c_f32_bf16 v180, v52, v92
    v_dot2c_f32_bf16 v181, v53, v93
    v_dot2c_f32_bf16 v180, v54, v94
    v_dot2c_f32_bf16 v181, v55, v95
    s_waitcnt vmcnt(0)
    v_dot2c_f32_bf16 v182, v16, v96
    v_dot2c_f32_bf16 v183, v17, v97
    v_dot2c_f32_bf16 v182, v18, v98
    v_dot2c_f32_bf16 v183, v19, v99
    v_dot2c_f32_bf16 v182, v20, v100
    v_dot2c_f32_bf16 v183, v21, v101
    v_dot2c_f32_bf16 v182, v22, v102
    v_dot2c_f32_bf16 v183, v23, v103
    v_dot2c_f32_bf16 v182, v24, v104
    v_dot2c_f32_bf16 v183, v25, v105
    v_dot2c_f32_bf16 v182, v26, v106
    v_dot2c_f32_bf16 v183, v27, v107
    v_dot2c_f32_bf16 v182, v28, v108
    v_dot2c_f32_bf16 v183, v29, v109
    v_dot2c_f32_bf16 v182, v30, v110
    v_dot2c_f32_bf16 v183, v31, v111
    v_dot2c_f32_bf16 v182, v32, v112
    v_dot2c_f32_bf16 v183, v33, v113
    v_dot2c_f32_bf16 v182, v34, v114
    v_dot2c_f32_bf16 v183, v35, v115
    v_dot2c_f32_bf16 v182, v36, v116
    v_dot2c_f32_bf16 v183, v37, v117
    v_dot2c_f32_bf16 v182, v38, v118
    v_dot2c_f32_bf16 v183, v39, v119
    v_dot2c_f32_bf16 v182, v40, v120
    v_dot2c_f32_bf16 v183, v41, v121
    v_dot2c_f32_bf16 v182, v42, v122
    v_dot2c_f32_bf16 v183, v43, v123
    v_dot2c_f32_bf16 v182, v44, v124
    v_dot2c_f32_bf16 v183, v45, v125
    v_dot2c_f32_bf16 v182, v46, v126
    v_dot2c_f32_bf16 v183, v47, v127
    v_dot2c_f32_bf16 v182, v48, v128
    v_dot2c_f32_bf16 v183, v49, v129
    v_dot2c_f32_bf16 v182, v50, v130
    v_dot2c_f32_bf16 v183, v51, v131
    v_dot2c_f32_bf16 v182, v52, v132
    v_dot2c_f32_bf16 v183, v53, v133
    v_dot2c_f32_bf16 v182, v54, v134
    v_dot2c_f32_bf16 v183, v55, v135
    s_nop 2
    v_add_f32 v180, v180, v181
    v_add_f32 v182, v182, v183
    s_nop 0
    v_add_f32_dpp v180, v180, v180 quad_perm:[1,0,3,2] row_mask:0xf bank_mask:0xf
    v_add_f32_dpp v182, v182, v182 quad_perm:[1,0,3,2] row_mask:0xf bank_mask:0xf
    s_nop 0
    v_add_f32_dpp v180, v180, v180 quad_perm:[2,3,0,1] row_mask:0xf bank_mask:0xf
    v_add_f32_dpp v182, v182, v182 quad_perm:[2,3,0,1] row_mask:0xf bank_mask:0xf
    s_nop 0
    v_add_f32_dpp v180, v180, v180 row_half_mirror row_mask:0xf bank_mask:0xf
    v_add_f32_dpp v182, v182, v182 row_half_mirror row_mask:0xf bank_mask:0xf
    v_cvt_pk_bf16_f32 v2, v180, v180
    v_lshlrev_b32 v2, 16, v2
    v_ashrrev_i32 v3, 31, v2
    v_or_b32 v3, 0x80000000, v3
    v_xor_b32 v2, v2, v3
    v_and_b32 v2, 0xffff0000, v2
    v_or_b32 v2, v2, v4
    ds_write2_b32 v10, v2, v182 offset0:0 offset1:32
    s_mov_b64 exec, 1
    ds_add_u32 v12, v13 offset:36
    s_mov_b64 exec, -1
    s_setprio 0
    s_cmp_lg_u32 s30, 4
    s_cbranch_scc1 K_WARMA0
    s_call_b64 s[38:39], WP_p2g
    s_branch K_WARMAX
K_WARMA0:
    s_cmp_lg_u32 s30, 5
    s_cbranch_scc1 K_WARMA1
    s_call_b64 s[38:39], WP_gen
    s_branch K_WARMAX
K_WARMA1:
    s_cmp_lg_u32 s30, 6
    s_cbranch_scc1 K_WARMA2
    s_call_b64 s[38:39], WP_help
    s_call_b64 s[38:39], WP_flags
    s_branch K_WARMAX
K_WARMA2:
    s_call_b64 s[38:39], WP_spin
K_WARMAX:
    s_cmp_ge_u32 s30, 6
    s_cselect_b32 s44, 63, s44
    s_cmp_lg_u32 s44, 63
    s_cbranch_scc1 K_FFN_C
    s_mov_b32 s3, 1048576
K_FGH:
    ds_read_b32 v2, v12 offset:48
    s_sleep 8
    s_sub_u32 s3, s3, 1
    s_waitcnt lgkmcnt(0)
    v_readfirstlane_b32 s33, v2
    s_nop 3
    s_cselect_b32 s33, 1, s33
    s_cmp_lt_u32 s33, 1
    s_cbranch_scc1 K_FGH
    s_cmp_eq_u32 s30, 6
    s_cbranch_scc1 K_P2_HELP
    v_mov_b32 v7, 1
    s_branch K_P2_HELP
K_AUX_LO:
    s_waitcnt lgkmcnt(0)
    s_cmp_eq_u32 s30, 0
    s_cbranch_scc1 K_AUX_PUB
    s_cmp_eq_u32 s44, 63
    s_cbranch_scc1 K_AUX_NOF
    s_and_b32 s3, s44, 1
    s_cmp_eq_u32 s3, 0
    s_cselect_b64 s[60:61], s[50:51], s[52:53]
    s_cselect_b64 s[64:65], s[52:53], s[50:51]
    s_cselect_b32 s75, 0, 40960
    s_mov_b32 s62, 0x21c000
    s_mov_b32 s63, 0x20000
    s_mov_b32 s66, 0x21c000
    s_mov_b32 s67, 0x20000
    v_lshrrev_b32 v2, 2, v1
    v_mul_u32_u24 v184, 3456, v2
    v_and_b32 v2, 3, v1
    v_lshl_add_u32 v184, v2, 4, v184
    s_lshl_b32 s72, s44, 6
    v_add_u32 v184, s72, v184
    s_sub_u32 s74, s30, 1
K_FSA0:
    s_lshl_b32 s73, s74, 10
    s_mul_i32 s72, s74, 55296
    s_add_u32 m0, s73, s75
    s_waitcnt vmcnt(7)
    buffer_load_dwordx4 v184, s[60:63], s72 offen lds
    s_add_u32 s74, s74, 3
    s_cmp_lt_u32 s74, 24
    s_cbranch_scc1 K_FSA0
    s_barrier
    s_mov_b32 s3, 1048576
K_FGPB:
    ds_read_b32 v2, v12 offset:36
    s_sleep 1
    s_sub_u32 s3, s3, 1
    s_waitcnt lgkmcnt(0)
    v_readfirstlane_b32 s33, v2
    s_nop 3
    s_cselect_b32 s33, 5, s33
    s_cmp_lt_u32 s33, 5
    s_cbranch_scc1 K_FGPB
K_FSA:
    s_lshl_b32 s73, s74, 10
    s_mul_i32 s72, s74, 55296
    s_add_u32 m0, s73, s75
    s_waitcnt vmcnt(7)
    buffer_load_dwordx4 v184, s[60:63], s72 offen lds
    s_add_u32 s74, s74, 3
    s_cmp_lt_u32 s74, 40
    s_cbranch_scc1 K_FSA
    s_sub_u32 s74, s74, 40
    s_xor_b32 s75, s75, 40960
    s_mov_b32 s68, s54
    s_mov_b32 s69, s55
    s_mov_b32 s70, 0x21c000
    s_mov_b32 s71, 0x20000
    s_mul_i32 s3, s44, 40960
    v_lshrrev_b32 v2, 3, v1
    v_mul_u32_u24 v2, 1280, v2
    v_lshrrev_b32 v3, 4, v1
    v_lshlrev_b32 v3, 1, v3
    v_and_b32 v4, 7, v1
    v_xor_b32 v3, v3, v4
    v_lshl_add_u32 v2, v3, 4, v2
    v_add_u32 v185, s3, v2
K_FSB:
    s_lshl_b32 s73, s74, 10
    s_mul_i32 s72, s74, 55296
    s_add_u32 m0, s73, s75
    s_waitcnt vmcnt(7)
    buffer_load_dwordx4 v184, s[64:67], s72 offen lds
    s_add_u32 s74, s74, 3
    s_cmp_lt_u32 s74, 40
    s_cbranch_scc1 K_FSB
    s_sub_u32 s74, s74, 40
    s_mov_b32 s75, 81920
K_FSD0:
    s_lshl_b32 s73, s74, 10
    s_and_b32 s72, s74, 3
    s_mul_i32 s72, s72, 10208
    s_lshl_b32 s3, s74, 5
    s_add_u32 s72, s72, s3
    s_add_u32 m0, s73, s75
    s_waitcnt vmcnt(7)
    buffer_load_dwordx4 v185, s[68:71], s72 offen lds
    s_add_u32 s74, s74, 3
    s_cmp_lt_u32 s74, 24
    s_cbranch_scc1 K_FSD0
    s_waitcnt vmcnt(8)
    s_mov_b64 exec, 1
    ds_add_u32 v12, v13 offset:56
    s_mov_b64 exec, -1
K_FSD:
    s_lshl_b32 s73, s74, 10
    s_and_b32 s72, s74, 3
    s_mul_i32 s72, s72, 10208
    s_lshl_b32 s3, s74, 5
    s_add_u32 s72, s72, s3
    s_add_u32 m0, s73, s75
    s_waitcnt vmcnt(7)
    buffer_load_dwordx4 v185, s[68:71], s72 offen lds
    s_add_u32 s74, s74, 3
    s_cmp_lt_u32 s74, 40
    s_cbranch_scc1 K_FSD
    s_mul_i32 s3, s29, 96
    s_lshl_b32 s72, s30, 5
    s_add_u32 s3, s3, s72
    s_sub_u32 s3, s3, 128
    v_lshrrev_b32 v2, 1, v1
    v_add_u32 v2, s3, v2
    v_mul_u32_u24 v2, 1280, v2
    v_and_b32 v3, 1, v1
    v_lshl_add_u32 v2, v3, 7, v2
    buffer_load_dword v6, v2, s[24:27], 0 offen offset:1024
K_AUX_WR:
    s_mov_b32 s3, 1048576
K_FGR:
    ds_read_b32 v2, v12 offset:60
    s_sleep 2
    s_sub_u32 s3, s3, 1
    s_waitcnt lgkmcnt(0)
    v_readfirstlane_b32 s33, v2
    s_nop 3
    s_cselect_b32 s33, 2, s33
    s_cmp_lt_u32 s33, 2
    s_cbranch_scc1 K_FGR
    s_branch K_P2
K_AUX_NOF:
    s_cmp_lg_u32 s2, 63
    s_cbranch_scc1 K_AUX_NOZ
    s_cmp_lg_u32 s30, 1
    s_cbranch_scc1 K_AUX_NOZ
    s_add_u32 s60, s10, 0x80000
    s_addc_u32 s61, s11, 0
    s_mov_b32 s62, 0xc000
    s_mov_b32 s63, 0x20000
    v_mov_b32 v9, 786432
    global_load_dword v10, v9, s[10:11] sc1
    v_lshlrev_b32 v11, 4, v1
    v_add_u32 v11, 790528, v11
    global_load_dword v6, v11, s[10:11] sc1
    s_barrier
    s_mov_b32 s3, 1048576
K_FGZ:
    ds_read_b32 v2, v12 offset:36
    s_sleep 2
    s_sub_u32 s3, s3, 1
    s_waitcnt lgkmcnt(0)
    v_readfirstlane_b32 s33, v2
    s_nop 3
    s_cselect_b32 s33, 4, s33
    s_cmp_lt_u32 s33, 4
    s_cbranch_scc1 K_FGZ
    v_and_b32 v4, 7, v1
    v_lshlrev_b32 v4, 2, v4
    global_load_dword v7, v4, s[8:9] offset:192 sc1
    s_waitcnt vmcnt(1)
    v_add_u32 v10, 1, v10
    s_mov_b32 s3, 131072
    s_setprio 3
K_AG2_POLL:
    global_load_dwordx4 v[16:19], v11, s[10:11] sc1
    s_waitcnt vmcnt(0)
    v_xor_b32 v2, v10, v17
    v_xor_b32 v3, v10, v19
    v_or_b32 v2, v2, v3
    v_cmp_ne_u32 vcc, 0, v2
    s_cbranch_vccz K_AG2_GOT
    s_sleep 2
    s_sub_u32 s3, s3, 1
    s_cmp_lg_u32 s3, 0
    s_cbranch_scc1 K_AG2_POLL
K_AG2_GOT:
    s_nop 1
    v_max_u32_dpp v3, v16, v16 quad_perm:[1,0,3,2] row_mask:0xf bank_mask:0xf
    s_nop 1
    v_max_u32_dpp v3, v3, v3 quad_perm:[2,3,0,1] row_mask:0xf bank_mask:0xf
    s_nop 1
    v_max_u32_dpp v3, v3, v3 row_half_mirror row_mask:0xf bank_mask:0xf
    s_nop 1
    v_max_u32_dpp v3, v3, v3 row_mirror row_mask:0xf bank_mask:0xf
    s_nop 1
    v_readlane_b32 s74, v3, 0
    v_readlane_b32 s76, v3, 16
    v_readlane_b32 s77, v3, 32
    v_readlane_b32 s78, v3, 48
    s_nop 3
    s_max_u32 s74, s74, s76
    s_max_u32 s77, s77, s78
    s_max_u32 s74, s74, s77
    v_cmp_ne_u32 vcc, s74, v16
    s_nop 1
    v_cndmask_b32 v2, v18, v16, vcc
    s_nop 1
    v_max_u32_dpp v3, v2, v2 quad_perm:[1,0,3,2] row_mask:0xf bank_mask:0xf
    s_nop 1
    v_max_u32_dpp v3, v3, v3 quad_perm:[2,3,0,1] row_mask:0xf bank_mask:0xf
    s_nop 1
    v_max_u32_dpp v3, v3, v3 row_half_mirror row_mask:0xf bank_mask:0xf
    s_nop 1
    v_max_u32_dpp v3, v3, v3 row_mirror row_mask:0xf bank_mask:0xf
    s_nop 1
    v_readlane_b32 s75, v3, 0
    v_readlane_b32 s76, v3, 16
    v_readlane_b32 s77, v3, 32
    v_readlane_b32 s78, v3, 48
    s_nop 3
    s_max_u32 s75, s75, s76
    s_max_u32 s77, s77, s78
    s_max_u32 s75, s75, s77
    v_mov_b32 v176, s74
    v_mov_b32 v177, s75
    v_and_b32 v4, 7, v1
    v_lshlrev_b32 v4, 2, v4
    s_mov_b32 s3, 131072
K_ZPOLL4:
    v_cmp_eq_u32 vcc, 0, v7
    s_cbranch_vccz K_ZOK4
    s_sub_u32 s3, s3, 1
    s_cbranch_scc1 K_ZOK4
    global_load_dword v7, v4, s[8:9] offset:192 sc1
    s_waitcnt vmcnt(0)
    s_branch K_ZPOLL4
K_ZOK4:
    v_and_b32 v2, 7, v1
    v_mul_u32_u24 v2, 20, v2
    v_lshrrev_b32 v3, 3, v1
    v_add_lshl_u32 v2, v2, v3, 8
    buffer_store_dwordx2 v[176:177], v2, s[60:63], 0 offen offset:136 sc1
    s_mov_b64 exec, 1
    global_store_dword v9, v10, s[10:11] sc1
    s_mov_b64 exec, -1
    v_lshlrev_b32 v4, 2, v1
    s_mov_b32 s72, 43008
    s_mov_b32 s3, 131072
K_AGG_POLL:
    s_sleep 8
    buffer_load_dword v2, v4, s[60:63], s72 offen sc1
    s_waitcnt vmcnt(0)
    v_cmp_eq_u32 vcc, 0, v2
    s_cbranch_vccz K_AGG_GOT
    s_sub_u32 s3, s3, 1
    s_cmp_lg_u32 s3, 0
    s_cbranch_scc1 K_AGG_POLL
K_AGG_GOT:
    s_mov_b32 s62, 40960
    v_lshlrev_b32 v3, 8, v1
    s_mov_b32 s3, 0
    buffer_store_dwordx2 v[176:177], v3, s[60:63], s3 offen offset:128 sc1
    s_mov_b32 s3, 16384
    buffer_store_dwordx2 v[176:177], v3, s[60:63], s3 offen offset:128 sc1
    s_mov_b32 s3, 32768
    buffer_store_dwordx2 v[176:177], v3, s[60:63], s3 offen offset:128 sc1
    s_setprio 0
    s_branch K_AUX_NOK
K_AUX_NOZ:
    s_barrier
K_AUX_NOK:
    s_mov_b32 s3, 1048576
K_FGWD:
    ds_read_b32 v2, v12 offset:48
    s_sleep 4
    s_sub_u32 s3, s3, 1
    s_waitcnt lgkmcnt(0)
    v_readfirstlane_b32 s33, v2
    s_nop 3
    s_cselect_b32 s33, 1, s33
    s_cmp_lt_u32 s33, 1
    s_cbranch_scc1 K_FGWD
    s_branch K_P2
K_AUX_PUB:
    s_add_u32 s60, s10, 0x1000
    s_addc_u32 s61, s11, 0
    s_mov_b32 s62, 0x2000
    s_mov_b32 s63, 0x20000
    v_and_b32 v3, 31, v1
    v_lshlrev_b32 v10, 2, v3
    v_add_u32 v11, 122880, v10
    s_lshl_b32 s72, s74, 2
    v_mov_b32 v2, 786432
    global_load_dword v17, v2, s[10:11] sc1
    s_lshl_b32 s3, s2, 2
    s_add_u32 s3, s3, 567296
    v_mov_b32 v9, s3
    s_lshl_b32 s3, s2, 4
    s_add_u32 s3, s3, 790528
    v_lshl_add_u32 v20, v1, 4, s3
    v_and_b32 v5, 7, v1
    v_lshlrev_b32 v5, 2, v5
    s_barrier
    s_setprio 3
    s_waitcnt vmcnt(0)
    v_add_u32 v17, 1, v17
    v_mov_b32 v19, v17
    s_mov_b32 s3, 1048576
K_FGRT:
    ds_read_b32 v2, v12 offset:36
    s_sleep 0
    s_sub_u32 s3, s3, 1
    s_waitcnt lgkmcnt(0)
    v_readfirstlane_b32 s33, v2
    s_nop 3
    s_cselect_b32 s33, 4, s33
    s_cmp_lt_u32 s33, 4
    s_cbranch_scc1 K_FGRT
    ds_read2_b32 v[176:177], v11 offset0:0 offset1:32
    s_waitcnt lgkmcnt(0)
    s_nop 1
    v_max_u32_dpp v3, v176, v176 quad_perm:[1,0,3,2] row_mask:0xf bank_mask:0xf
    s_nop 1
    v_max_u32_dpp v3, v3, v3 quad_perm:[2,3,0,1] row_mask:0xf bank_mask:0xf
    s_nop 1
    v_max_u32_dpp v3, v3, v3 row_half_mirror row_mask:0xf bank_mask:0xf
    s_nop 1
    v_max_u32_dpp v3, v3, v3 row_mirror row_mask:0xf bank_mask:0xf
    s_nop 1
    v_readlane_b32 s74, v3, 0
    v_readlane_b32 s76, v3, 16
    v_readlane_b32 s77, v3, 32
    v_readlane_b32 s78, v3, 48
    s_nop 3
    s_max_u32 s74, s74, s76
    s_max_u32 s77, s77, s78
    s_max_u32 s74, s74, s77
    v_cmp_ne_u32 vcc, s74, v176
    s_nop 1
    v_cndmask_b32 v176, 0, v176, vcc
    s_nop 1
    v_max_u32_dpp v3, v176, v176 quad_perm:[1,0,3,2] row_mask:0xf bank_mask:0xf
    s_nop 1
    v_max_u32_dpp v3, v3, v3 quad_perm:[2,3,0,1] row_mask:0xf bank_mask:0xf
    s_nop 1
    v_max_u32_dpp v3, v3, v3 row_half_mirror row_mask:0xf bank_mask:0xf
    s_nop 1
    v_max_u32_dpp v3, v3, v3 row_mirror row_mask:0xf bank_mask:0xf
    s_nop 1
    v_readlane_b32 s75, v3, 0
    v_readlane_b32 s76, v3, 16
    v_readlane_b32 s77, v3, 32
    v_readlane_b32 s78, v3, 48
    s_nop 3
    s_max_u32 s75, s75, s76
    s_max_u32 s77, s77, s78
    s_max_u32 s75, s75, s77
    v_mov_b32 v16, s74
    v_mov_b32 v18, s75
    s_mov_b64 exec, 1
    global_store_dwordx4 v20, v[16:19], s[10:11] sc1
    s_mov_b64 exec, -1
    s_mov_b64 exec, 1
    ds_add_u32 v12, v13 offset:36
    s_mov_b64 exec, -1
    global_load_dword v7, v5, s[8:9] offset:192 sc1
    v_cvt_pk_bf16_f32 v177, v177, v177
    v_lshlrev_b32 v177, 16, v177
    v_mul_f32 v3, 0xbfb8aa3b, v177
    v_exp_f32 v3, v3
    s_nop 0
    v_add_f32 v3, 1.0, v3
    v_rcp_f32 v177, v3
    s_nop 0
    v_cvt_pk_bf16_f32 v177, v177, v177
    v_lshlrev_b32 v177, 16, v177
    s_mov_b32 exec_hi, 0
    buffer_store_dword v177, v10, s[60:63], s72 offen sc1
    s_mov_b64 exec, -1
    s_waitcnt vmcnt(0)
    v_and_b32 v4, 7, v1
    v_lshlrev_b32 v4, 2, v4
    s_mov_b32 s3, 131072
K_ZPOLL3:
    v_cmp_eq_u32 vcc, 0, v7
    s_cbranch_vccz K_ZOK3
    s_sub_u32 s3, s3, 1
    s_cbranch_scc1 K_ZOK3
    global_load_dword v7, v4, s[8:9] offset:192 sc1
    s_waitcnt vmcnt(0)
    s_branch K_ZPOLL3
K_ZOK3:
    s_mov_b64 exec, 1
    global_store_dword v9, v13, s[10:11] sc1
    s_mov_b64 exec, -1
    v_and_b32 v3, 1, v1
    v_lshl_add_u32 v3, v3, 2, s42
    v_lshlrev_b32 v10, 4, v1
    s_mov_b32 s3, 131072
K_AUX_POLL:
    s_sleep 6
    global_load_dword v2, v3, s[10:11] offset:136 sc1
    s_waitcnt vmcnt(0)
    v_cmp_eq_u32 vcc, 0, v2
    s_cbranch_vccz K_AUX_GOT
    s_sub_u32 s3, s3, 1
    s_cmp_lg_u32 s3, 0
    s_cbranch_scc1 K_AUX_POLL
K_AUX_GOT:
    v_readlane_b32 s74, v2, 0
    v_readlane_b32 s75, v2, 1
    s_nop 3
    s_and_b32 s74, s74, 0x7ff
    s_sub_u32 s74, 2047, s74
    s_mul_i32 s74, s74, 1280
    s_mov_b32 m0, 125184
    s_nop 0
    buffer_load_dwordx4 v10, s[12:15], s74 offen lds
    s_mov_b64 exec, 0xffff
    buffer_load_dwordx4 v10, s[12:15], s74 offen offset:1024 lds
    s_mov_b64 exec, -1
    s_and_b32 s75, s75, 0x7ff
    s_sub_u32 s75, 2047, s75
    s_mul_i32 s75, s75, 1280
    s_mov_b32 m0, 126528
    s_nop 0
    buffer_load_dwordx4 v10, s[12:15], s75 offen lds
    s_mov_b64 exec, 0xffff
    buffer_load_dwordx4 v10, s[12:15], s75 offen offset:1024 lds
    s_mov_b64 exec, -1
    s_waitcnt vmcnt(0)
    ds_write_b32 v12, v13 offset:48
    s_setprio 0
    s_branch K_P2
.p2align 12
K_FFN_C:
    s_add_u32 s64, s10, 0x10000
    s_addc_u32 s65, s11, 0
    s_mov_b32 s66, 0x43800
    s_mov_b32 s67, 0x20000
    s_and_b32 s73, s30, 1
    v_lshrrev_b32 v232, 4, v1
    v_bfe_u32 v4, v1, 2, 2
    v_lshl_add_u32 v2, v232, 3, v4
    v_and_b32 v3, 3, v1
    v_lshlrev_b32 v3, 3, v3
    v_lshl_add_u32 v233, v2, 6, v3
    s_lshl_b32 s72, s73, 5
    v_add_u32 v233, s72, v233
    v_lshl_add_u32 v2, v232, 2, v4
    v_bfe_u32 v4, v2, 1, 2
    v_lshl_add_u32 v3, v2, 7, v3
    v_lshl_add_u32 v3, v4, 5, v3
    s_mul_i32 s3, s73, 20480
    s_add_u32 s3, s3, 81920
    v_add_u32 v238, s3, v3
    v_xor_b32 v239, 32, v238
    v_xor_b32 v240, 64, v238
    v_xor_b32 v241, 96, v238
    v_and_b32 v2, 1, v1
    v_mul_u32_u24 v234, 1344, v2
    v_lshl_add_u32 v234, v232, 4, v234
    v_add_u32 v234, 125184, v234
    v_lshlrev_b32 v236, 4, v1
    v_add_u32 v236, 124160, v236
    s_lshl_b32 s3, s73, 3
    v_add_u32 v235, s3, v236
    v_mul_u32_u24 v2, 2560, v2
    v_lshl_add_u32 v237, v232, 4, v2
    s_mul_i32 s3, s44, 5120
    s_mul_i32 s72, s73, 1280
    s_add_u32 s72, s72, s3
    v_lshlrev_b32 v2, 4, v1
    buffer_store_dwordx4 v[16:19], v2, s[64:67], s72 offen offset:0 sc1
    buffer_store_dwordx4 v[16:19], v2, s[64:67], s72 offen offset:2560 sc1
    s_mov_b64 exec, 0xffff
    buffer_store_dwordx4 v[16:19], v2, s[64:67], s72 offen offset:1024 sc1
    buffer_store_dwordx4 v[16:19], v2, s[64:67], s72 offen offset:3584 sc1
    s_mov_b64 exec, -1
    v_add_u32 v5, 40960, v233
    s_mov_b32 s3, 1048576
K_FGD:
    ds_read_b32 v2, v12 offset:56
    s_sleep 2
    s_sub_u32 s3, s3, 1
    s_waitcnt lgkmcnt(0)
    v_readfirstlane_b32 s33, v2
    s_nop 3
    s_cselect_b32 s33, 3, s33
    s_cmp_lt_u32 s33, 3
    s_cbranch_scc1 K_FGD
    s_setprio 3
    ds_read_b64_tr_b16 v[16:17], v233 offset:0
    ds_read_b64_tr_b16 v[18:19], v233 offset:256
    ds_read_b64_tr_b16 v[20:21], v233 offset:2048
    ds_read_b64_tr_b16 v[22:23], v233 offset:2304
    ds_read_b64_tr_b16 v[24:25], v233 offset:4096
    ds_read_b64_tr_b16 v[26:27], v233 offset:4352
    ds_read_b64_tr_b16 v[28:29], v233 offset:6144
    ds_read_b64_tr_b16 v[30:31], v233 offset:6400
    ds_read_b64_tr_b16 v[32:33], v233 offset:8192
    ds_read_b64_tr_b16 v[34:35], v233 offset:8448
    ds_read_b64_tr_b16 v[36:37], v233 offset:10240
    ds_read_b64_tr_b16 v[38:39], v233 offset:10496
    ds_read_b64_tr_b16 v[40:41], v233 offset:12288
    ds_read_b64_tr_b16 v[42:43], v233 offset:12544
    ds_read_b64_tr_b16 v[44:45], v233 offset:14336
    ds_read_b64_tr_b16 v[46:47], v233 offset:14592
    ds_read_b64_tr_b16 v[48:49], v233 offset:16384
    ds_read_b64_tr_b16 v[50:51], v233 offset:16640
    ds_read_b64_tr_b16 v[52:53], v233 offset:18432
    ds_read_b64_tr_b16 v[54:55], v233 offset:18688
    ds_read_b64_tr_b16 v[56:57], v233 offset:20480
    ds_read_b64_tr_b16 v[58:59], v233 offset:20736
    ds_read_b64_tr_b16 v[60:61], v233 offset:22528
    ds_read_b64_tr_b16 v[62:63], v233 offset:22784
    ds_read_b64_tr_b16 v[64:65], v233 offset:24576
    ds_read_b64_tr_b16 v[66:67], v233 offset:24832
    ds_read_b64_tr_b16 v[68:69], v233 offset:26624
    ds_read_b64_tr_b16 v[70:71], v233 offset:26880
    ds_read_b64_tr_b16 v[72:73], v233 offset:28672
    ds_read_b64_tr_b16 v[74:75], v233 offset:28928
    ds_read_b64_tr_b16 v[76:77], v233 offset:30720
    ds_read_b64_tr_b16 v[78:79], v233 offset:30976
    ds_read_b64_tr_b16 v[80:81], v233 offset:32768
    ds_read_b64_tr_b16 v[82:83], v233 offset:33024
    ds_read_b64_tr_b16 v[84:85], v233 offset:34816
    ds_read_b64_tr_b16 v[86:87], v233 offset:35072
    ds_read_b64_tr_b16 v[88:89], v233 offset:36864
    ds_read_b64_tr_b16 v[90:91], v233 offset:37120
    ds_read_b64_tr_b16 v[92:93], v233 offset:38912
    ds_read_b64_tr_b16 v[94:95], v233 offset:39168
    ds_read_b64_tr_b16 v[96:97], v5 offset:0
    ds_read_b64_tr_b16 v[98:99], v5 offset:256
    ds_read_b64_tr_b16 v[100:101], v5 offset:2048
    ds_read_b64_tr_b16 v[102:103], v5 offset:2304
    ds_read_b64_tr_b16 v[104:105], v5 offset:4096
    ds_read_b64_tr_b16 v[106:107], v5 offset:4352
    ds_read_b64_tr_b16 v[108:109], v5 offset:6144
    ds_read_b64_tr_b16 v[110:111], v5 offset:6400
    ds_read_b64_tr_b16 v[112:113], v5 offset:8192
    ds_read_b64_tr_b16 v[114:115], v5 offset:8448
    ds_read_b64_tr_b16 v[116:117], v5 offset:10240
    ds_read_b64_tr_b16 v[118:119], v5 offset:10496
    ds_read_b64_tr_b16 v[120:121], v5 offset:12288
    ds_read_b64_tr_b16 v[122:123], v5 offset:12544
    ds_read_b64_tr_b16 v[124:125], v5 offset:14336
    ds_read_b64_tr_b16 v[126:127], v5 offset:14592
    ds_read_b64_tr_b16 v[128:129], v5 offset:16384
    ds_read_b64_tr_b16 v[130:131], v5 offset:16640
    ds_read_b64_tr_b16 v[132:133], v5 offset:18432
    ds_read_b64_tr_b16 v[134:135], v5 offset:18688
    ds_read_b64_tr_b16 v[136:137], v5 offset:20480
    ds_read_b64_tr_b16 v[138:139], v5 offset:20736
    ds_read_b64_tr_b16 v[140:141], v5 offset:22528
    ds_read_b64_tr_b16 v[142:143], v5 offset:22784
    ds_read_b64_tr_b16 v[144:145], v5 offset:24576
    ds_read_b64_tr_b16 v[146:147], v5 offset:24832
    ds_read_b64_tr_b16 v[148:149], v5 offset:26624
    ds_read_b64_tr_b16 v[150:151], v5 offset:26880
    ds_read_b64_tr_b16 v[152:153], v5 offset:28672
    ds_read_b64_tr_b16 v[154:155], v5 offset:28928
    ds_read_b64_tr_b16 v[156:157], v5 offset:30720
    ds_read_b64_tr_b16 v[158:159], v5 offset:30976
    ds_read_b64_tr_b16 v[160:161], v5 offset:32768
    ds_read_b64_tr_b16 v[162:163], v5 offset:33024
    ds_read_b64_tr_b16 v[164:165], v5 offset:34816
    ds_read_b64_tr_b16 v[166:167], v5 offset:35072
    ds_read_b64_tr_b16 v[168:169], v5 offset:36864
    ds_read_b64_tr_b16 v[170:171], v5 offset:37120
    ds_read_b64_tr_b16 v[172:173], v5 offset:38912
    ds_read_b64_tr_b16 v[174:175], v5 offset:39168
    s_waitcnt vmcnt(0) lgkmcnt(0)
    s_mov_b64 exec, 1
    ds_add_u32 v12, v13 offset:60
    s_mov_b64 exec, -1
    s_mov_b32 s3, 1048576
K_FGK:
    ds_read_b32 v2, v12 offset:48
    s_sleep 1
    s_sub_u32 s3, s3, 1
    s_waitcnt lgkmcnt(0)
    v_readfirstlane_b32 s33, v2
    s_nop 3
    s_cselect_b32 s33, 1, s33
    s_cmp_lt_u32 s33, 1
    s_cbranch_scc1 K_FGK
    ds_read_b128 v[188:191], v234 offset:0
    ds_read_b128 v[192:195], v234 offset:64
    ds_read_b128 v[196:199], v234 offset:128
    ds_read_b128 v[200:203], v234 offset:192
    ds_read_b128 v[204:207], v234 offset:256
    ds_read_b128 v[208:211], v234 offset:320
    ds_read_b128 v[212:215], v234 offset:384
    ds_read_b128 v[216:219], v234 offset:448
    s_waitcnt lgkmcnt(7)
    v_mfma_f32_16x16x32_bf16 v[220:223], v[16:19], v[188:191], 0
    v_mfma_f32_16x16x32_bf16 v[224:227], v[96:99], v[188:191], 0
    ds_read_b128 v[188:191], v234 offset:512
    s_waitcnt lgkmcnt(7)
    v_mfma_f32_16x16x32_bf16 v[220:223], v[20:23], v[192:195], v[220:223]
    v_mfma_f32_16x16x32_bf16 v[224:227], v[100:103], v[192:195], v[224:227]
    ds_read_b128 v[192:195], v234 offset:576
    s_waitcnt lgkmcnt(7)
    v_mfma_f32_16x16x32_bf16 v[220:223], v[24:27], v[196:199], v[220:223]
    v_mfma_f32_16x16x32_bf16 v[224:227], v[104:107], v[196:199], v[224:227]
    ds_read_b128 v[196:199], v234 offset:640
    s_waitcnt lgkmcnt(7)
    v_mfma_f32_16x16x32_bf16 v[220:223], v[28:31], v[200:203], v[220:223]
    v_mfma_f32_16x16x32_bf16 v[224:227], v[108:111], v[200:203], v[224:227]
    ds_read_b128 v[200:203], v234 offset:704
    s_waitcnt lgkmcnt(7)
    v_mfma_f32_16x16x32_bf16 v[220:223], v[32:35], v[204:207], v[220:223]
    v_mfma_f32_16x16x32_bf16 v[224:227], v[112:115], v[204:207], v[224:227]
    ds_read_b128 v[204:207], v234 offset:768
    s_waitcnt lgkmcnt(7)
    v_mfma_f32_16x16x32_bf16 v[220:223], v[36:39], v[208:211], v[220:223]
    v_mfma_f32_16x16x32_bf16 v[224:227], v[116:119], v[208:211], v[224:227]
    ds_read_b128 v[208:211], v234 offset:832
    s_waitcnt lgkmcnt(7)
    v_mfma_f32_16x16x32_bf16 v[220:223], v[40:43], v[212:215], v[220:223]
    v_mfma_f32_16x16x32_bf16 v[224:227], v[120:123], v[212:215], v[224:227]
    ds_read_b128 v[212:215], v234 offset:896
    s_waitcnt lgkmcnt(7)
    v_mfma_f32_16x16x32_bf16 v[220:223], v[44:47], v[216:219], v[220:223]
    v_mfma_f32_16x16x32_bf16 v[224:227], v[124:127], v[216:219], v[224:227]
    ds_read_b128 v[216:219], v234 offset:960
    s_waitcnt lgkmcnt(7)
    v_mfma_f32_16x16x32_bf16 v[220:223], v[48:51], v[188:191], v[220:223]
    v_mfma_f32_16x16x32_bf16 v[224:227], v[128:131], v[188:191], v[224:227]
    ds_read_b128 v[188:191], v234 offset:1024
    s_waitcnt lgkmcnt(7)
    v_mfma_f32_16x16x32_bf16 v[220:223], v[52:55], v[192:195], v[220:223]
    v_mfma_f32_16x16x32_bf16 v[224:227], v[132:135], v[192:195], v[224:227]
    ds_read_b128 v[192:195], v234 offset:1088
    s_waitcnt lgkmcnt(7)
    v_mfma_f32_16x16x32_bf16 v[220:223], v[56:59], v[196:199], v[220:223]
    v_mfma_f32_16x16x32_bf16 v[224:227], v[136:139], v[196:199], v[224:227]
    ds_read_b128 v[196:199], v234 offset:1152
    s_waitcnt lgkmcnt(7)
    v_mfma_f32_16x16x32_bf16 v[220:223], v[60:63], v[200:203], v[220:223]
    v_mfma_f32_16x16x32_bf16 v[224:227], v[140:143], v[200:203], v[224:227]
    ds_read_b128 v[200:203], v234 offset:1216
    s_waitcnt lgkmcnt(7)
    v_mfma_f32_16x16x32_bf16 v[220:223], v[64:67], v[204:207], v[220:223]
    v_mfma_f32_16x16x32_bf16 v[224:227], v[144:147], v[204:207], v[224:227]
    s_waitcnt lgkmcnt(6)
    v_mfma_f32_16x16x32_bf16 v[220:223], v[68:71], v[208:211], v[220:223]
    v_mfma_f32_16x16x32_bf16 v[224:227], v[148:151], v[208:211], v[224:227]
    s_waitcnt lgkmcnt(5)
    v_mfma_f32_16x16x32_bf16 v[220:223], v[72:75], v[212:215], v[220:223]
    v_mfma_f32_16x16x32_bf16 v[224:227], v[152:155], v[212:215], v[224:227]
    s_waitcnt lgkmcnt(4)
    v_mfma_f32_16x16x32_bf16 v[220:223], v[76:79], v[216:219], v[220:223]
    v_mfma_f32_16x16x32_bf16 v[224:227], v[156:159], v[216:219], v[224:227]
    s_waitcnt lgkmcnt(3)
    v_mfma_f32_16x16x32_bf16 v[220:223], v[80:83], v[188:191], v[220:223]
    v_mfma_f32_16x16x32_bf16 v[224:227], v[160:163], v[188:191], v[224:227]
    s_waitcnt lgkmcnt(2)
    v_mfma_f32_16x16x32_bf16 v[220:223], v[84:87], v[192:195], v[220:223]
    v_mfma_f32_16x16x32_bf16 v[224:227], v[164:167], v[192:195], v[224:227]
    s_waitcnt lgkmcnt(1)
    v_mfma_f32_16x16x32_bf16 v[220:223], v[88:91], v[196:199], v[220:223]
    v_mfma_f32_16x16x32_bf16 v[224:227], v[168:171], v[196:199], v[224:227]
    s_waitcnt lgkmcnt(0)
    v_mfma_f32_16x16x32_bf16 v[220:223], v[92:95], v[200:203], v[220:223]
    v_mfma_f32_16x16x32_bf16 v[224:227], v[172:175], v[200:203], v[224:227]
    s_mov_b32 s3, 1048576
K_FGDN:
    ds_read_b32 v2, v12 offset:52
    s_sleep 1
    s_sub_u32 s3, s3, 1
    s_waitcnt lgkmcnt(0)
    v_readfirstlane_b32 s33, v2
    s_nop 3
    s_cselect_b32 s33, 3, s33
    s_cmp_lt_u32 s33, 3
    s_cbranch_scc1 K_FGDN
    ds_read_b64_tr_b16 v[16:17], v238 offset:0
    ds_read_b64_tr_b16 v[18:19], v238 offset:2048
    ds_read_b64_tr_b16 v[20:21], v239 offset:0
    ds_read_b64_tr_b16 v[22:23], v239 offset:2048
    ds_read_b64_tr_b16 v[24:25], v240 offset:0
    ds_read_b64_tr_b16 v[26:27], v240 offset:2048
    ds_read_b64_tr_b16 v[28:29], v241 offset:0
    ds_read_b64_tr_b16 v[30:31], v241 offset:2048
    ds_read_b64_tr_b16 v[32:33], v238 offset:4096
    ds_read_b64_tr_b16 v[34:35], v238 offset:6144
    ds_read_b64_tr_b16 v[36:37], v239 offset:4096
    ds_read_b64_tr_b16 v[38:39], v239 offset:6144
    ds_read_b64_tr_b16 v[40:41], v240 offset:4096
    ds_read_b64_tr_b16 v[42:43], v240 offset:6144
    v_cvt_pk_bf16_f32 v221, v220, v221
    v_lshlrev_b32 v220, 16, v221
    v_and_b32 v221, 0xffff0000, v221
    v_cvt_pk_bf16_f32 v223, v222, v223
    v_lshlrev_b32 v222, 16, v223
    v_and_b32 v223, 0xffff0000, v223
    v_cvt_pk_bf16_f32 v225, v224, v225
    v_lshlrev_b32 v224, 16, v225
    v_and_b32 v225, 0xffff0000, v225
    v_cvt_pk_bf16_f32 v227, v226, v227
    v_lshlrev_b32 v226, 16, v227
    v_and_b32 v227, 0xffff0000, v227
    v_mul_f32 v188, 0xbfb8aa3b, v220
    v_mul_f32 v189, 0xbfb8aa3b, v221
    v_mul_f32 v190, 0xbfb8aa3b, v222
    v_mul_f32 v191, 0xbfb8aa3b, v223
    v_exp_f32 v188, v188
    v_exp_f32 v189, v189
    v_exp_f32 v190, v190
    v_exp_f32 v191, v191
    v_add_f32 v188, 1.0, v188
    v_add_f32 v189, 1.0, v189
    v_add_f32 v190, 1.0, v190
    v_add_f32 v191, 1.0, v191
    v_rcp_f32 v188, v188
    v_rcp_f32 v189, v189
    v_rcp_f32 v190, v190
    v_rcp_f32 v191, v191
    v_mul_f32 v220, v220, v188
    v_mul_f32 v221, v221, v189
    v_mul_f32 v222, v222, v190
    v_mul_f32 v223, v223, v191
    v_cvt_pk_bf16_f32 v221, v220, v221
    v_lshlrev_b32 v220, 16, v221
    v_and_b32 v221, 0xffff0000, v221
    v_cvt_pk_bf16_f32 v223, v222, v223
    v_lshlrev_b32 v222, 16, v223
    v_and_b32 v223, 0xffff0000, v223
    v_mul_f32 v220, v220, v224
    v_mul_f32 v221, v221, v225
    v_mul_f32 v222, v222, v226
    v_mul_f32 v223, v223, v227
    v_cvt_pk_bf16_f32 v228, v220, v221
    v_cvt_pk_bf16_f32 v229, v222, v223
    ds_write_b64 v235, v[228:229]
    s_mov_b64 exec, 1
    ds_add_u32 v12, v13 offset:52
    s_mov_b64 exec, -1
    ds_read_b64_tr_b16 v[44:45], v241 offset:4096
    ds_read_b64_tr_b16 v[46:47], v241 offset:6144
    ds_read_b64_tr_b16 v[48:49], v238 offset:8192
    ds_read_b64_tr_b16 v[50:51], v238 offset:10240
    ds_read_b64_tr_b16 v[52:53], v239 offset:8192
    ds_read_b64_tr_b16 v[54:55], v239 offset:10240
    ds_read_b64_tr_b16 v[56:57], v240 offset:8192
    ds_read_b64_tr_b16 v[58:59], v240 offset:10240
    ds_read_b64_tr_b16 v[60:61], v241 offset:8192
    ds_read_b64_tr_b16 v[62:63], v241 offset:10240
    ds_read_b64_tr_b16 v[64:65], v238 offset:12288
    ds_read_b64_tr_b16 v[66:67], v238 offset:14336
    ds_read_b64_tr_b16 v[68:69], v239 offset:12288
    ds_read_b64_tr_b16 v[70:71], v239 offset:14336
    ds_read_b64_tr_b16 v[72:73], v240 offset:12288
    ds_read_b64_tr_b16 v[74:75], v240 offset:14336
    ds_read_b64_tr_b16 v[76:77], v241 offset:12288
    ds_read_b64_tr_b16 v[78:79], v241 offset:14336
    ds_read_b64_tr_b16 v[80:81], v238 offset:16384
    ds_read_b64_tr_b16 v[82:83], v238 offset:18432
    ds_read_b64_tr_b16 v[84:85], v239 offset:16384
    ds_read_b64_tr_b16 v[86:87], v239 offset:18432
    ds_read_b64_tr_b16 v[88:89], v240 offset:16384
    ds_read_b64_tr_b16 v[90:91], v240 offset:18432
    ds_read_b64_tr_b16 v[92:93], v241 offset:16384
    ds_read_b64_tr_b16 v[94:95], v241 offset:18432
    s_mov_b32 s3, 1048576
K_FGP:
    ds_read_b32 v2, v12 offset:52
    s_sleep 0
    s_sub_u32 s3, s3, 1
    s_waitcnt lgkmcnt(0)
    v_readfirstlane_b32 s33, v2
    s_nop 3
    s_cselect_b32 s33, 5, s33
    s_cmp_lt_u32 s33, 5
    s_cbranch_scc1 K_FGP
    ds_read_b128 v[228:231], v236
    s_waitcnt lgkmcnt(0)
    v_mfma_f32_16x16x32_bf16 v[96:99], v[16:19], v[228:231], 0
    v_mfma_f32_16x16x32_bf16 v[100:103], v[20:23], v[228:231], 0
    v_mfma_f32_16x16x32_bf16 v[104:107], v[24:27], v[228:231], 0
    v_mfma_f32_16x16x32_bf16 v[108:111], v[28:31], v[228:231], 0
    v_mfma_f32_16x16x32_bf16 v[112:115], v[32:35], v[228:231], 0
    v_mfma_f32_16x16x32_bf16 v[116:119], v[36:39], v[228:231], 0
    v_mfma_f32_16x16x32_bf16 v[120:123], v[40:43], v[228:231], 0
    v_mfma_f32_16x16x32_bf16 v[124:127], v[44:47], v[228:231], 0
    v_mfma_f32_16x16x32_bf16 v[128:131], v[48:51], v[228:231], 0
    v_mfma_f32_16x16x32_bf16 v[132:135], v[52:55], v[228:231], 0
    v_mfma_f32_16x16x32_bf16 v[136:139], v[56:59], v[228:231], 0
    v_mfma_f32_16x16x32_bf16 v[140:143], v[60:63], v[228:231], 0
    v_mfma_f32_16x16x32_bf16 v[144:147], v[64:67], v[228:231], 0
    v_mfma_f32_16x16x32_bf16 v[148:151], v[68:71], v[228:231], 0
    v_mfma_f32_16x16x32_bf16 v[152:155], v[72:75], v[228:231], 0
    v_mfma_f32_16x16x32_bf16 v[156:159], v[76:79], v[228:231], 0
    v_mfma_f32_16x16x32_bf16 v[160:163], v[80:83], v[228:231], 0
    v_mfma_f32_16x16x32_bf16 v[164:167], v[84:87], v[228:231], 0
    v_mfma_f32_16x16x32_bf16 v[168:171], v[88:91], v[228:231], 0
    v_mfma_f32_16x16x32_bf16 v[172:175], v[92:95], v[228:231], 0
    s_mov_b32 exec_lo, 0x00030003
    s_mov_b32 exec_hi, 0x00030003
    buffer_store_dwordx4 v[96:99], v237, s[64:67], s72 offen offset:0 sc1
    buffer_store_dwordx4 v[100:103], v237, s[64:67], s72 offen offset:64 sc1
    buffer_store_dwordx4 v[104:107], v237, s[64:67], s72 offen offset:128 sc1
    buffer_store_dwordx4 v[108:111], v237, s[64:67], s72 offen offset:192 sc1
    buffer_store_dwordx4 v[112:115], v237, s[64:67], s72 offen offset:256 sc1
    buffer_store_dwordx4 v[116:119], v237, s[64:67], s72 offen offset:320 sc1
    buffer_store_dwordx4 v[120:123], v237, s[64:67], s72 offen offset:384 sc1
    buffer_store_dwordx4 v[124:127], v237, s[64:67], s72 offen offset:448 sc1
    buffer_store_dwordx4 v[128:131], v237, s[64:67], s72 offen offset:512 sc1
    buffer_store_dwordx4 v[132:135], v237, s[64:67], s72 offen offset:576 sc1
    buffer_store_dwordx4 v[136:139], v237, s[64:67], s72 offen offset:640 sc1
    buffer_store_dwordx4 v[140:143], v237, s[64:67], s72 offen offset:704 sc1
    buffer_store_dwordx4 v[144:147], v237, s[64:67], s72 offen offset:768 sc1
    buffer_store_dwordx4 v[148:151], v237, s[64:67], s72 offen offset:832 sc1
    buffer_store_dwordx4 v[152:155], v237, s[64:67], s72 offen offset:896 sc1
    buffer_store_dwordx4 v[156:159], v237, s[64:67], s72 offen offset:960 sc1
    buffer_store_dwordx4 v[160:163], v237, s[64:67], s72 offen offset:1024 sc1
    buffer_store_dwordx4 v[164:167], v237, s[64:67], s72 offen offset:1088 sc1
    buffer_store_dwordx4 v[168:171], v237, s[64:67], s72 offen offset:1152 sc1
    buffer_store_dwordx4 v[172:175], v237, s[64:67], s72 offen offset:1216 sc1
    s_mov_b64 exec, -1
    s_mul_i32 s3, s73, 2560
    s_lshl2_add_u32 s3, s44, s3
    s_add_u32 s3, s3, 568320
    v_lshl_add_u32 v2, v1, 8, s3
    s_mov_b64 exec, 0x3ff
    s_waitcnt vmcnt(0)
    global_store_dword v2, v13, s[10:11] sc1
    s_mov_b64 exec, -1
    s_branch K_P2_HELP
K_CODE_END:
.section .rodata,"a"
.p2align 6
.amdhsa_kernel gated_mix__sliding_local_dilated__moe_arch_mod__prompt_kernel
  .amdhsa_next_free_vgpr 248
  .amdhsa_next_free_sgpr 79
  .amdhsa_accum_offset 248
  .amdhsa_group_segment_fixed_size 0
  .amdhsa_kernarg_size 96
  .amdhsa_user_sgpr_count 2
  .amdhsa_user_sgpr_kernarg_segment_ptr 1
  .amdhsa_system_sgpr_workgroup_id_x 1
.end_amdhsa_kernel
```

```asm
; @launch grid=(256,1,1) block=(512,1,1) lds=163840
.amdgcn_target "amdgcn-amd-amdhsa--gfx950"
.text
.p2align 12
.p2align 8
.globl gated_mix__sliding_local_dilated__moe_arch_mod__prompt_kernel
.type gated_mix__sliding_local_dilated__moe_arch_mod__prompt_kernel,@function
gated_mix__sliding_local_dilated__moe_arch_mod__prompt_kernel:
    s_cmp_ge_u32 s2, 256
    s_cbranch_scc1 K_EXIT
    s_load_dwordx2 s[12:13], s[0:1], 0
    s_load_dwordx2 s[16:17], s[0:1], 8
    v_readfirstlane_b32 s30, v0
    s_load_dwordx4 s[8:11], s[0:1], 80
    s_load_dwordx2 s[24:25], s[0:1], 16
    s_load_dwordx2 s[6:7], s[0:1], 72
    s_and_b32 s28, s2, 7
    v_and_b32 v1, 63, v0
    s_mov_b32 s14, 0x280000
    s_mov_b32 s15, 0x20000
    s_lshr_b32 s30, s30, 6
    s_cmp_lt_u32 s2, 64
    s_cbranch_scc1 K_SLOW
    s_cmp_lt_u32 s30, 4
    s_cbranch_scc1 K_FAST
K_SLOW:
    s_getpc_b64 s[38:39]
K_PC:
    s_bfe_u32 s3, s2, 0x30003
    s_mul_i32 s3, s3, ((K_CODE_END-gated_mix__sliding_local_dilated__moe_arch_mod__prompt_kernel+1023)/1024)
    s_sub_u32 s38, s38, K_PC-gated_mix__sliding_local_dilated__moe_arch_mod__prompt_kernel
    s_subb_u32 s39, s39, 0
    v_subrev_u32 v3, 256, v0
    v_add_u32 v2, s3, v3
    v_lshlrev_b32 v2, 7, v2
    v_min_u32 v2, K_CODE_END-gated_mix__sliding_local_dilated__moe_arch_mod__prompt_kernel-4, v2
    v_cmp_gt_u32 vcc, ((K_CODE_END-gated_mix__sliding_local_dilated__moe_arch_mod__prompt_kernel+1023)/1024), v3
    s_and_saveexec_b64 s[4:5], vcc
    s_cbranch_execz K_NOPF
    global_load_dword v6, v2, s[38:39]
K_NOPF:
    s_mov_b64 exec, -1
    v_mov_b64 v[2:3], 0
    v_mov_b64 v[4:5], 0
    v_mov_b32 v7, 158752
    ds_write_b128 v7, v[2:5] offset:0
    ds_write_b128 v7, v[2:5] offset:16
    ds_write_b128 v7, v[2:5] offset:32
    ds_write_b128 v7, v[2:5] offset:48
    s_mov_b32 s43, 1
    s_lshl_b32 s3, s30, 8
    s_add_u32 s3, s3, s2
    s_lshr_b32 s3, s3, 3
    s_cmp_lg_u32 s3, 160
    s_cbranch_scc1 K_COMMON
    s_mul_i32 s3, s2, 6144
    s_add_u32 s3, s3, 527360
    v_lshl_add_u32 v6, v1, 4, s3
    v_mov_b64 v[24:25], 0
    v_mov_b64 v[26:27], 0
    s_waitcnt lgkmcnt(0)
    global_store_dwordx4 v6, v[24:27], s[10:11] offset:-3072 sc1
    global_store_dwordx4 v6, v[24:27], s[10:11] offset:-2048 sc1
    global_store_dwordx4 v6, v[24:27], s[10:11] offset:-1024 sc1
    global_store_dwordx4 v6, v[24:27], s[10:11] offset:0 sc1
    global_store_dwordx4 v6, v[24:27], s[10:11] offset:1024 sc1
    global_store_dwordx4 v6, v[24:27], s[10:11] offset:2048 sc1
    s_lshl_b32 s3, s2, 2
    v_mov_b32 v2, s3
    v_mov_b32 v3, 1
    s_mov_b64 exec, 1
    s_waitcnt vmcnt(0)
    global_store_dword v2, v3, s[8:9] offset:192 sc1
    s_mov_b64 exec, -1
    s_branch K_COMMON
K_FAST:
    s_lshr_b32 s32, s2, 1
    s_and_b32 s32, s32, 28
    v_lshrrev_b32 v3, 4, v1
    s_lshr_b32 s3, s2, 6
    s_mov_b32 s59, 0x59608237
    s_cmp_eq_u32 s3, 2
    s_cselect_b32 s59, 0x26375904, s59
    v_and_b32 v4, 7, v1
    s_cmp_eq_u32 s3, 3
    s_cselect_b32 s59, 0x93042671, s59
    v_lshrrev_b32 v2, 3, v1
    s_lshr_b32 s59, s59, s32
    s_and_b32 s59, s59, 15
    v_xor_b32 v4, v4, v3
    s_lshl_b32 s33, s28, 2
    s_lshr_b32 s33, 0x76543210, s33
    s_and_b32 s33, s33, 15
    s_add_u32 s59, s59, s33
    s_cmp_ge_u32 s59, 10
    v_mul_u32_u24 v2, 1280, v2
    s_cselect_b32 s33, 10, 0
    s_sub_u32 s59, s59, s33
    s_lshr_b32 s53, s28, 1
    v_lshl_add_u32 v40, v4, 4, v2
    s_mul_i32 s53, s53, 655360
    s_lshl2_add_u32 s62, s3, s30
    s_cmp_eq_u32 s62, 15
    s_cselect_b32 s62, 0x800000, 0
    s_add_u32 s62, s62, 40960
    s_mul_i32 s3, s3, 225280
    v_xor_b32 v41, 64, v40
    s_add_u32 s53, s53, s3
    s_mul_i32 s54, s30, 61440
    s_add_u32 s53, s53, s54
    s_sub_u32 s53, s53, 245760
    s_mul_i32 s55, s30, 6144
    s_add_u32 s55, s55, 49152
    s_lshl_b32 s57, s59, 7
    s_add_u32 s57, s57, s53
    s_waitcnt lgkmcnt(0)
    s_add_u32 m0, s55, 0
    s_max_i32 s60, s57, 0
    buffer_load_dwordx4 v40, s[12:15], s60 offen lds
    s_add_u32 s60, s57, 10240
    s_add_u32 m0, s55, 1024
    s_max_i32 s60, s60, 0
    buffer_load_dwordx4 v41, s[12:15], s60 offen lds
    s_add_u32 m0, s55, 2048
    s_add_u32 s60, s57, 20480
    buffer_load_dwordx4 v40, s[12:15], s60 offen lds
    s_add_u32 m0, s55, 3072
    s_add_u32 s60, s57, 30720
    buffer_load_dwordx4 v41, s[12:15], s60 offen lds
    s_add_u32 m0, s55, 4096
    s_add_u32 s60, s57, s62
    buffer_load_dwordx4 v40, s[12:15], s60 offen lds
    s_add_u32 m0, s55, 5120
    s_add_u32 s60, s60, 10240
    buffer_load_dwordx4 v41, s[12:15], s60 offen lds
    v_lshlrev_b32 v2, 1, v3
    s_lshr_b32 s32, 0x64317520, s32
    v_sub_u32 v2, v1, v2
    s_and_b32 s32, s32, 7
    v_and_b32 v2, 15, v2
    s_and_b32 s3, s28, 1
    v_mul_u32_u24 v3, 3840, v3
    s_lshl3_add_u32 s32, s3, s32
    v_mul_u32_u24 v4, 13, v2
    s_mul_i32 s3, s32, 80
    v_lshrrev_b32 v4, 6, v4
    s_add_u32 s54, s54, s3
    v_mul_u32_u24 v4, 1200, v4
    s_lshl_b32 s56, s30, 12
    v_lshl_add_u32 v4, v2, 4, v4
    s_add_u32 s56, s56, 106496
    v_add_u32 v5, 1, v2
    s_mov_b32 s18, 0x258000
    v_and_b32 v5, 16, v5
    s_mov_b32 s19, 0x20000
    v_lshl_add_u32 v4, v5, 24, v4
    v_add_u32 v42, v3, v4
    s_mul_i32 s58, s59, 245760
    s_add_u32 s58, s58, s54
    s_add_u32 s59, s59, 1
    s_cmp_eq_u32 s59, 10
    s_cselect_b32 s59, 0, s59
    s_add_u32 m0, s56, 0
    s_add_u32 s60, s58, 0
    buffer_load_dwordx4 v42, s[16:19], s60 offen lds
    s_add_u32 m0, s56, 1024
    s_add_u32 s60, s58, 15360
    buffer_load_dwordx4 v42, s[16:19], s60 offen lds
    v_xor_b32 v2, 8, v2
    v_mul_u32_u24 v4, 13, v2
    v_lshrrev_b32 v4, 6, v4
    v_mul_u32_u24 v4, 1200, v4
    v_lshl_add_u32 v4, v2, 4, v4
    v_add_u32 v5, 1, v2
    v_and_b32 v5, 16, v5
    v_lshl_add_u32 v4, v5, 24, v4
    v_add_u32 v43, v3, v4
    s_add_u32 m0, s56, 2048
    s_add_u32 s60, s58, 30720
    buffer_load_dwordx4 v43, s[16:19], s60 offen lds
    s_add_u32 m0, s56, 3072
    s_add_u32 s60, s58, 46080
    buffer_load_dwordx4 v43, s[16:19], s60 offen lds
    s_mov_b32 s52, s30
    s_mov_b32 s43, 0
K_COMMON:
    v_mov_b32 v7, 0
    s_lshr_b32 s29, s2, 3
    s_xor_b32 s30, s30, 4
    s_mov_b32 s26, 0xc8000
    s_mov_b32 s27, 0x20000
    s_lshr_b32 s34, s29, 3
    s_lshl_b32 s34, s34, 2
    s_and_b32 s3, s29, 3
    s_add_u32 s34, s34, s3
    s_add_u32 s34, s34, 4
    s_bitcmp1_b32 s29, 2
    s_cselect_b32 s34, -1, s34
    s_cmp_lt_u32 s29, 8
    s_cselect_b32 s34, s29, s34
    s_lshl_b32 s40, s28, 1
    s_cmp_ge_u32 s34, 10
    s_addc_u32 s40, s40, 0
    s_sub_u32 s41, s34, 10
    s_cmp_ge_u32 s34, 10
    s_cselect_b32 s41, s41, s34
    s_mul_i32 s42, s28, 20
    s_add_u32 s42, s42, s34
    s_and_b32 s42, s42, 255
    s_lshl_b32 s42, s42, 8
    s_add_u32 s42, s42, 524288
    s_cmp_lt_u32 s29, 8
    s_cbranch_scc1 K_AUX
    s_lshr_b32 s31, s29, 3
    s_sub_u32 s31, s31, 1
    s_and_b32 s35, s29, 3
    s_and_b32 s3, s29, 4
    s_lshl_b32 s3, s3, 1
    s_add_u32 s35, s35, s3
    s_and_b32 s3, s28, 1
    s_lshl_b32 s3, s3, 2
    s_add_u32 s35, s35, s3
    v_and_b32 v9, 15, v1
    v_lshrrev_b32 v10, 4, v1
    v_bfe_u32 v11, v1, 2, 2
    v_and_b32 v12, 3, v1
    s_waitcnt lgkmcnt(0)
    s_add_u32 s20, s10, 0x100000
    s_addc_u32 s21, s11, 0
    s_mov_b32 s22, 0x280000
    s_mov_b32 s23, 0x20000
    s_and_b32 s3, s30, 3
    s_mul_i32 s3, s3, 3
    s_lshr_b32 s33, s30, 2
    s_lshl1_add_u32 s3, s33, s3
    s_mul_i32 s44, s31, 11
    s_add_u32 s44, s44, s3
    s_cmp_eq_u32 s44, 31
    s_cselect_b32 s51, 4, s30
    s_lshr_b32 s33, s28, 1
    s_lshl_b32 s33, s33, 5
    s_add_u32 s44, s44, s33
    s_lshl_b32 s3, s3, 10
    s_add_u32 s3, s3, 122880
    v_lshl_add_u32 v13, v1, 4, s3
    v_lshl_add_u32 v2, v9, 4, s3
    v_add_u32 v2, 520, v2
    v_add_u32 v3, 512, v13
    v_cmp_eq_u32 vcc, 0, v10
    s_nop 1
    v_cndmask_b32 v18, v2, v3, vcc
    v_cmp_eq_u32 vcc, 1, v10
    s_nop 1
    v_cndmask_b32 v19, v2, v3, vcc
    v_lshl_add_u32 v5, v10, 2, v11
    v_lshl_add_u32 v5, v5, 4, s3
    v_add_u32 v2, 520, v5
    v_add_u32 v3, 8, v5
    v_add_u32 v4, 264, v5
    s_cmp_lt_u32 s30, 4
    s_cselect_b32 s33, 0, 3
    s_sub_u32 s33, s30, s33
    s_mul_i32 s33, s33, 5120
    s_add_u32 s33, s33, 79872
    v_lshl_add_u32 v14, v1, 3, s33
    v_cmp_eq_u32 vcc, 0, v12
    s_nop 1
    v_cndmask_b32 v20, v2, v3, vcc
    v_cmp_eq_u32 vcc, 1, v12
    s_nop 1
    v_cndmask_b32 v21, v2, v4, vcc
    v_cmp_eq_u32 vcc, 2, v12
    s_nop 1
    v_cndmask_b32 v22, v2, v3, vcc
    v_cmp_eq_u32 vcc, 3, v12
    s_nop 1
    v_cndmask_b32 v23, v2, v4, vcc
    s_lshl_b32 s3, s35, 10
    v_lshl_add_u32 v15, v1, 4, s3
    s_lshl_b32 s3, s35, 8
    s_add_u32 s3, s3, 16384
    v_lshl_add_u32 v16, v9, 4, s3
    v_and_b32 v2, 1, v10
    v_lshl_add_u32 v16, v2, 23, v16
    s_cmp_lt_u32 s51, 4
    s_cselect_b32 s3, 0, 0x800000
    s_add_u32 s3, s3, 20480
    v_lshrrev_b32 v2, 1, v10
    v_mad_u32_u24 v16, v2, s3, v16
    s_mul_i32 s50, s44, 20480
    s_add_u32 s51, s50, s3
    v_mov_b32 v17, 0xf149f2ca
    v_lshlrev_b32 v2, 2, v10
    v_sub_u32 v2, v9, v2
    s_cmp_eq_u32 s44, 0
    s_cselect_b32 s3, 0xf149f2ca, 0
    v_subrev_u32 v3, 0, v2
    v_and_b32 v4, 0x80000001, v3
    v_cmp_eq_u32 vcc, 0, v4
    s_nop 1
    v_cndmask_b32 v28, v17, 0, vcc
    v_cmp_eq_u32 vcc, 0x80000000, v4
    s_nop 1
    v_cndmask_b32 v24, v17, 0, vcc
    v_add_f32 v32, s3, v24
    v_subrev_u32 v3, 1, v2
    v_and_b32 v4, 0x80000001, v3
    v_cmp_eq_u32 vcc, 0, v4
    s_nop 1
    v_cndmask_b32 v29, v17, 0, vcc
    v_cmp_eq_u32 vcc, 0x80000000, v4
    s_nop 1
    v_cndmask_b32 v25, v17, 0, vcc
    v_add_f32 v33, s3, v25
    v_subrev_u32 v3, 2, v2
    v_and_b32 v4, 0x80000001, v3
    v_cmp_eq_u32 vcc, 0, v4
    s_nop 1
    v_cndmask_b32 v30, v17, 0, vcc
    v_cmp_eq_u32 vcc, 0x80000000, v4
    s_nop 1
    v_cndmask_b32 v26, v17, 0, vcc
    v_add_f32 v34, s3, v26
    v_subrev_u32 v3, 3, v2
    v_and_b32 v4, 0x80000001, v3
    v_cmp_eq_u32 vcc, 0, v4
    s_nop 1
    v_cndmask_b32 v31, v17, 0, vcc
    v_cmp_eq_u32 vcc, 0x80000000, v4
    s_nop 1
    v_cndmask_b32 v27, v17, 0, vcc
    v_add_f32 v35, s3, v27
    v_mov_b32 v3, 0x0c0c0c0c
    v_mov_b32 v4, 0xc0c0100
    v_cmp_eq_u32 vcc, 0, v24
    v_mov_b32 v5, 0x1000c0c
    s_nop 0
    v_cndmask_b32 v3, v3, v4, vcc
    v_cmp_eq_u32 vcc, 0, v25
    s_nop 1
    v_cndmask_b32 v36, v3, v5, vcc
    v_mov_b32 v3, 0x0c0c0c0c
    v_mov_b32 v4, 0xc0c0302
    v_cmp_eq_u32 vcc, 0, v26
    v_mov_b32 v5, 0x3020c0c
    s_nop 0
    v_cndmask_b32 v3, v3, v4, vcc
    v_cmp_eq_u32 vcc, 0, v27
    s_nop 1
    v_cndmask_b32 v37, v3, v5, vcc
    v_mov_b32 v3, 0x0c0c0c0c
    v_mov_b32 v4, 0xc0c0100
    v_cmp_eq_u32 vcc, 0, v28
    v_mov_b32 v5, 0x1000c0c
    s_nop 0
    v_cndmask_b32 v3, v3, v4, vcc
    v_cmp_eq_u32 vcc, 0, v29
    s_nop 1
    v_cndmask_b32 v38, v3, v5, vcc
    v_mov_b32 v3, 0x0c0c0c0c
    v_mov_b32 v4, 0xc0c0302
    v_cmp_eq_u32 vcc, 0, v30
    v_mov_b32 v5, 0x3020c0c
    s_nop 0
    v_cndmask_b32 v3, v3, v4, vcc
    v_cmp_eq_u32 vcc, 0, v31
    s_nop 1
    v_cndmask_b32 v39, v3, v5, vcc
    s_mov_b32 s46, 0x3fb8aa3b
    s_mov_b32 s47, s46
    s_mov_b32 s48, 0x3e64f92e
    s_mov_b32 s49, s48
    s_mov_b32 s36, 0xfffff
    s_cmp_lg_u32 s31, 0
    s_cselect_b32 s33, 64, 0
    v_mov_b32 v2, s33
    v_cmp_gt_u32 vcc, 10, v1
    s_lshr_b32 s3, s28, 1
    s_lshl2_add_u32 s3, s3, s31
    v_cndmask_b32 v2, 0, v2, vcc
    v_lshl_add_u32 v2, v1, 8, v2
    s_mul_i32 s3, s3, 2560
    s_lshl2_add_u32 s3, s35, s3
    s_add_u32 s3, s3, 524288
    v_add_u32 v8, s3, v2
    s_cmp_eq_u32 s43, 1
    s_cbranch_scc1 K_CONS
    v_lshrrev_b32 v2, 3, v1
    v_mul_u32_u24 v2, 1280, v2
    v_lshrrev_b32 v3, 4, v1
    v_lshlrev_b32 v3, 1, v3
    v_and_b32 v4, 7, v1
    v_xor_b32 v3, v3, v4
    v_lshl_add_u32 v2, v3, 4, v2
    s_lshl_b32 s33, s41, 7
    v_add_u32 v17, s33, v2
    s_mov_b32 s61, 9
    s_branch K_LOOPE
K_LOOP:
    s_waitcnt vmcnt(5)
    s_barrier
    s_add_u32 m0, s56, 2048
    s_add_u32 s60, s58, 30720
    buffer_load_dwordx4 v43, s[16:19], s60 offen lds
    s_add_u32 m0, s55, 3072
    s_add_u32 s60, s57, 30720
    buffer_load_dwordx4 v41, s[12:15], s60 offen lds
    s_add_u32 m0, s56, 3072
    s_add_u32 s60, s58, 46080
    buffer_load_dwordx4 v43, s[16:19], s60 offen lds
    s_add_u32 m0, s55, 4096
    s_add_u32 s60, s57, s62
    buffer_load_dwordx4 v40, s[12:15], s60 offen lds
    s_add_u32 m0, s55, 5120
    s_add_u32 s60, s60, 10240
    buffer_load_dwordx4 v41, s[12:15], s60 offen lds
    s_sub_u32 s61, s61, 1
    s_cmp_eq_u32 s61, 0
    s_cbranch_scc1 K_LOOPX
K_LOOPE:
    s_cmp_ge_u32 s55, 49152
    s_cselect_b32 s60, -2, 1
    s_mul_i32 s3, s60, 24576
    s_add_u32 s55, s55, s3
    s_lshl_b32 s60, s60, 14
    s_add_u32 s56, s56, s60
    s_lshl_b32 s57, s59, 7
    s_add_u32 s57, s57, s53
    s_mul_i32 s58, s59, 245760
    s_add_u32 s58, s58, s54
    s_add_u32 s59, s59, 1
    s_cmp_eq_u32 s59, 10
    s_cselect_b32 s59, 0, s59
    s_add_u32 m0, s56, 0
    s_add_u32 s60, s58, 0
    buffer_load_dwordx4 v42, s[16:19], s60 offen lds
    s_add_u32 m0, s55, 0
    s_max_i32 s60, s57, 0
    buffer_load_dwordx4 v40, s[12:15], s60 offen lds
    s_add_u32 m0, s56, 1024
    s_add_u32 s60, s58, 15360
    buffer_load_dwordx4 v42, s[16:19], s60 offen lds
    s_add_u32 s60, s57, 10240
    s_add_u32 m0, s55, 1024
    s_max_i32 s60, s60, 0
    buffer_load_dwordx4 v41, s[12:15], s60 offen lds
    s_add_u32 m0, s55, 2048
    s_add_u32 s60, s57, 20480
    buffer_load_dwordx4 v40, s[12:15], s60 offen lds
    s_branch K_LOOP
K_LOOPX:
    v_and_b32 v2, 7, v1
    v_lshlrev_b32 v2, 2, v2
    s_waitcnt vmcnt(0)
    s_barrier
    s_cmp_lt_u32 s30, 6
    s_cbranch_scc1 K_NOSMP
    global_load_dword v7, v2, s[8:9] offset:192 sc1
K_NOSMP:
    s_cmp_eq_u32 s34, -1
    s_cbranch_scc1 K_JOIN_S
    s_cmp_lt_u32 s52, 2
    s_cbranch_scc1 K_WOE
    s_cmp_lg_u32 s30, 7
    s_cbranch_scc1 K_JOIN_S
    s_mov_b32 s52, 2
    s_branch K_W7A
K_WOE:
    s_lshl_b32 s57, s52, 2
    s_lshr_b32 s57, 0x7520, s57
    s_and_b32 s57, s57, 7
    s_mul_i32 s57, s57, 51200
    s_mul_i32 s58, s52, 5120
    s_add_u32 s3, s57, 0
    s_add_u32 m0, s58, 0
    s_nop 0
    buffer_load_dwordx4 v17, s[24:27], s3 offen lds
    s_add_u32 s3, s57, 10240
    s_add_u32 m0, s58, 1024
    s_nop 0
    buffer_load_dwordx4 v17, s[24:27], s3 offen lds
    s_add_u32 s3, s57, 20480
    s_add_u32 m0, s58, 2048
    s_nop 0
    buffer_load_dwordx4 v17, s[24:27], s3 offen lds
    s_add_u32 s3, s57, 30720
    s_add_u32 m0, s58, 3072
    s_nop 0
    buffer_load_dwordx4 v17, s[24:27], s3 offen lds
    s_add_u32 s3, s57, 40960
    s_add_u32 m0, s58, 4096
    s_nop 0
    buffer_load_dwordx4 v17, s[24:27], s3 offen lds
    s_add_u32 s3, s57, 409600
    s_add_u32 m0, s58, 20480
    s_nop 0
    buffer_load_dwordx4 v17, s[24:27], s3 offen lds
    s_add_u32 s3, s57, 419840
    s_add_u32 m0, s58, 21504
    s_nop 0
    buffer_load_dwordx4 v17, s[24:27], s3 offen lds
    s_add_u32 s3, s57, 430080
    s_add_u32 m0, s58, 22528
    s_nop 0
    buffer_load_dwordx4 v17, s[24:27], s3 offen lds
    s_add_u32 s3, s57, 440320
    s_add_u32 m0, s58, 23552
    s_nop 0
    buffer_load_dwordx4 v17, s[24:27], s3 offen lds
    s_add_u32 s3, s57, 450560
    s_add_u32 m0, s58, 24576
    s_nop 0
    buffer_load_dwordx4 v17, s[24:27], s3 offen lds
    s_cmp_lg_u32 s30, 7
    s_cbranch_scc1 K_JOIN_S
    s_add_u32 s52, s52, 1
    s_cmp_lt_u32 s52, 4
    s_cbranch_scc1 K_WOE
    s_mov_b32 s52, 0
K_XD:
    s_lshl_b32 s57, s40, 3
    s_lshl1_add_u32 s57, s52, s57
    s_mul_i32 s57, s57, 20480
    s_lshl_b32 s33, s41, 7
    s_add_u32 s57, s57, s33
    s_lshl_b32 s33, s52, 12
    s_add_u32 m0, s33, 140288
    s_add_u32 s3, s57, 0
    buffer_load_dwordx4 v40, s[12:15], s3 offen lds
    s_add_u32 m0, s33, 141312
    s_add_u32 s3, s57, 10240
    buffer_load_dwordx4 v41, s[12:15], s3 offen lds
    s_add_u32 m0, s33, 142336
    s_add_u32 s3, s57, 20480
    buffer_load_dwordx4 v40, s[12:15], s3 offen lds
    s_add_u32 m0, s33, 143360
    s_add_u32 s3, s57, 30720
    buffer_load_dwordx4 v41, s[12:15], s3 offen lds
    s_add_u32 s52, s52, 1
    s_cmp_lt_u32 s52, 4
    s_cbranch_scc1 K_XD
    s_branch K_W7
.p2align 12
K_CONS:
    v_lshrrev_b32 v2, 1, v9
    v_xor_b32 v2, v2, v10
    v_lshlrev_b32 v2, 4, v2
    v_lshl_add_u32 v2, v9, 7, v2
    s_mul_i32 s3, s30, 6144
    v_add_u32 v40, s3, v2
    v_xor_b32 v41, 64, v40
    v_and_b32 v2, 1, v10
    v_lshl_or_b32 v2, v2, 2, v11
    v_lshlrev_b32 v2, 5, v2
    v_lshl_add_u32 v3, v10, 3, v11
    v_lshlrev_b32 v3, 8, v3
    v_add_u32 v3, 73728, v3
    v_lshlrev_b32 v5, 3, v12
    s_movk_i32 s33, 0xff
    s_mov_b32 s3, 0x48209870
    v_lshrrev_b32 v4, v5, s3
    v_add_u32 v4, v4, v2
    v_and_or_b32 v42, v4, s33, v3
    s_mov_b32 s3, 0xf8f0e8c0
    v_lshrrev_b32 v4, v5, s3
    v_add_u32 v4, v4, v2
    v_and_or_b32 v43, v4, s33, v3
    v_add_u32 v2, v2, v5
    v_add_u32 v4, 80, v2
    v_and_or_b32 v44, v4, s33, v3
    v_add_u32 v4, 120, v2
    v_and_or_b32 v45, v4, s33, v3
    v_add_u32 v4, 0, v2
    v_and_or_b32 v46, v4, s33, v3
    v_add_u32 v4, 40, v2
    v_and_or_b32 v47, v4, s33, v3
    v_add_u32 v4, 160, v2
    v_and_or_b32 v48, v4, s33, v3
    v_add_u32 v4, 200, v2
    v_and_or_b32 v49, v4, s33, v3
    s_lshl_b32 s3, s30, 2
    s_add_u32 s3, s3, 158800
    v_mov_b32 v50, s3
    v_mov_b32 v4, 1
    v_mov_b32 v5, 2
    v_mov_b64 v[52:53], 0
    v_mov_b64 v[54:55], 0
    v_mov_b64 v[56:57], 0
    v_mov_b64 v[58:59], 0
    v_mov_b64 v[60:61], 0
    v_mov_b64 v[62:63], 0
    v_mov_b64 v[64:65], 0
    v_mov_b64 v[66:67], 0
    v_mov_b64 v[68:69], 0
    v_mov_b64 v[70:71], 0
    v_mov_b64 v[72:73], 0
    v_mov_b64 v[74:75], 0
    v_mov_b64 v[76:77], 0
    v_mov_b64 v[78:79], 0
    v_mov_b64 v[80:81], 0
    v_mov_b64 v[82:83], 0
    v_mov_b64 v[84:85], 0
    v_mov_b64 v[86:87], 0
    v_mov_b64 v[88:89], 0
    v_mov_b64 v[90:91], 0
    v_mov_b64 v[92:93], 0
    v_mov_b64 v[94:95], 0
    v_mov_b64 v[96:97], 0
    v_mov_b64 v[98:99], 0
    v_mov_b64 v[100:101], 0
    v_mov_b64 v[102:103], 0
    v_mov_b64 v[104:105], 0
    v_mov_b64 v[106:107], 0
    v_mov_b64 v[108:109], 0
    v_mov_b64 v[110:111], 0
    v_mov_b64 v[112:113], 0
    v_mov_b64 v[114:115], 0
    v_mov_b64 v[116:117], 0
    v_mov_b64 v[118:119], 0
    v_mov_b64 v[120:121], 0
    v_mov_b64 v[122:123], 0
    v_mov_b64 v[124:125], 0
    v_mov_b64 v[126:127], 0
    v_mov_b64 v[128:129], 0
    v_mov_b64 v[130:131], 0
    v_mov_b64 v[132:133], 0
    v_mov_b64 v[134:135], 0
    v_mov_b64 v[136:137], 0
    v_mov_b64 v[138:139], 0
    v_mov_b64 v[140:141], 0
    v_mov_b64 v[142:143], 0
    v_mov_b64 v[144:145], 0
    v_mov_b64 v[146:147], 0
    s_mov_b32 s52, 3
    s_cmp_lg_u32 s30, 0
    s_cbranch_scc1 K_WARMM0
    s_call_b64 s[38:39], WP_attd
    s_call_b64 s[38:39], WP_p2g
    s_branch K_WARMMX
K_WARMM0:
    s_cmp_lg_u32 s30, 1
    s_cbranch_scc1 K_WARMM1
    s_call_b64 s[38:39], WP_atts
    s_call_b64 s[38:39], WP_early
    s_branch K_WARMMX
K_WARMM1:
    s_cmp_lg_u32 s30, 2
    s_cbranch_scc1 K_WARMM2
    s_call_b64 s[38:39], WP_help
    s_call_b64 s[38:39], WP_flags
    s_branch K_WARMMX
K_WARMM2:
    s_call_b64 s[38:39], WP_spin
K_WARMMX:
    s_barrier
    ds_read_b128 v[148:151], v40 offset:49152
    ds_read_b64_tr_b16 v[172:173], v42 offset:32768
    ds_read_b64_tr_b16 v[174:175], v42 offset:33792
    ds_read_b128 v[152:155], v40 offset:51200
    ds_read_b128 v[156:159], v40 offset:53248
    ds_read_b64_tr_b16 v[176:177], v43 offset:32768
    ds_read_b64_tr_b16 v[178:179], v43 offset:33792
    ds_read_b64_tr_b16 v[180:181], v44 offset:32768
    ds_read_b64_tr_b16 v[182:183], v44 offset:33792
    ds_read_b64_tr_b16 v[184:185], v45 offset:32768
    ds_read_b64_tr_b16 v[186:187], v45 offset:33792
    ds_read_b64_tr_b16 v[188:189], v46 offset:32768
    ds_read_b64_tr_b16 v[190:191], v46 offset:33792
    ds_read_b64_tr_b16 v[192:193], v47 offset:32768
    ds_read_b64_tr_b16 v[194:195], v47 offset:33792
    ds_read_b64_tr_b16 v[196:197], v48 offset:32768
    ds_read_b64_tr_b16 v[198:199], v48 offset:33792
    ds_read_b64_tr_b16 v[200:201], v49 offset:32768
    ds_read_b64_tr_b16 v[202:203], v49 offset:33792
K_CLOOP:
    s_waitcnt lgkmcnt(0)
    v_mfma_f32_16x16x32_bf16 v[52:55], v[172:175], v[148:151], v[52:55]
    ds_read_b128 v[160:163], v41 offset:49152
    v_mfma_f32_16x16x32_bf16 v[56:59], v[176:179], v[148:151], v[56:59]
    ds_read_b64_tr_b16 v[204:205], v42 offset:40960
    v_mfma_f32_16x16x32_bf16 v[60:63], v[180:183], v[148:151], v[60:63]
    ds_read_b64_tr_b16 v[206:207], v42 offset:41984
    v_mfma_f32_16x16x32_bf16 v[64:67], v[184:187], v[148:151], v[64:67]
    ds_read_b128 v[164:167], v41 offset:51200
    v_mfma_f32_16x16x32_bf16 v[68:71], v[188:191], v[148:151], v[68:71]
    ds_read_b128 v[168:171], v41 offset:53248
    v_mfma_f32_16x16x32_bf16 v[72:75], v[192:195], v[148:151], v[72:75]
    ds_read_b64_tr_b16 v[208:209], v43 offset:40960
    v_mfma_f32_16x16x32_bf16 v[76:79], v[148:151], v[196:199], v[76:79]
    ds_read_b64_tr_b16 v[210:211], v43 offset:41984
    v_mfma_f32_16x16x32_bf16 v[80:83], v[148:151], v[200:203], v[80:83]
    ds_read_b64_tr_b16 v[212:213], v44 offset:40960
    v_mfma_f32_16x16x32_bf16 v[112:115], v[152:155], v[200:203], v[112:115]
    ds_read_b64_tr_b16 v[214:215], v44 offset:41984
    v_mfma_f32_16x16x32_bf16 v[108:111], v[152:155], v[196:199], v[108:111]
    ds_read_b64_tr_b16 v[216:217], v45 offset:40960
    v_mfma_f32_16x16x32_bf16 v[104:107], v[192:195], v[152:155], v[104:107]
    ds_read_b64_tr_b16 v[218:219], v45 offset:41984
    v_mfma_f32_16x16x32_bf16 v[100:103], v[188:191], v[152:155], v[100:103]
    ds_read_b64_tr_b16 v[220:221], v46 offset:40960
    v_mfma_f32_16x16x32_bf16 v[96:99], v[184:187], v[152:155], v[96:99]
    ds_read_b64_tr_b16 v[222:223], v46 offset:41984
    v_mfma_f32_16x16x32_bf16 v[92:95], v[180:183], v[152:155], v[92:95]
    ds_read_b64_tr_b16 v[224:225], v47 offset:40960
    v_mfma_f32_16x16x32_bf16 v[88:91], v[176:179], v[152:155], v[88:91]
    ds_read_b64_tr_b16 v[226:227], v47 offset:41984
    v_mfma_f32_16x16x32_bf16 v[84:87], v[172:175], v[152:155], v[84:87]
    ds_read_b64_tr_b16 v[228:229], v48 offset:40960
    v_mfma_f32_16x16x32_bf16 v[116:119], v[172:175], v[156:159], v[116:119]
    ds_read_b64_tr_b16 v[230:231], v48 offset:41984
    v_mfma_f32_16x16x32_bf16 v[120:123], v[176:179], v[156:159], v[120:123]
    ds_read_b64_tr_b16 v[232:233], v49 offset:40960
    v_mfma_f32_16x16x32_bf16 v[124:127], v[180:183], v[156:159], v[124:127]
    ds_read_b64_tr_b16 v[234:235], v49 offset:41984
    v_mfma_f32_16x16x32_bf16 v[128:131], v[184:187], v[156:159], v[128:131]
    v_mfma_f32_16x16x32_bf16 v[132:135], v[188:191], v[156:159], v[132:135]
    v_mfma_f32_16x16x32_bf16 v[136:139], v[192:195], v[156:159], v[136:139]
    v_mfma_f32_16x16x32_bf16 v[140:143], v[156:159], v[196:199], v[140:143]
    v_mfma_f32_16x16x32_bf16 v[144:147], v[156:159], v[200:203], v[144:147]
    s_waitcnt lgkmcnt(0)
    s_barrier
    v_mfma_f32_16x16x32_bf16 v[52:55], v[204:207], v[160:163], v[52:55]
    ds_read_b128 v[148:151], v40 offset:0
    v_mfma_f32_16x16x32_bf16 v[56:59], v[208:211], v[160:163], v[56:59]
    ds_read_b64_tr_b16 v[172:173], v42 offset:0
    v_mfma_f32_16x16x32_bf16 v[60:63], v[212:215], v[160:163], v[60:63]
    ds_read_b64_tr_b16 v[174:175], v42 offset:1024
    v_mfma_f32_16x16x32_bf16 v[64:67], v[216:219], v[160:163], v[64:67]
    ds_read_b128 v[152:155], v40 offset:2048
    v_mfma_f32_16x16x32_bf16 v[68:71], v[220:223], v[160:163], v[68:71]
    ds_read_b128 v[156:159], v40 offset:4096
    v_mfma_f32_16x16x32_bf16 v[72:75], v[224:227], v[160:163], v[72:75]
    ds_read_b64_tr_b16 v[176:177], v43 offset:0
    v_mfma_f32_16x16x32_bf16 v[76:79], v[160:163], v[228:231], v[76:79]
    ds_read_b64_tr_b16 v[178:179], v43 offset:1024
    v_mfma_f32_16x16x32_bf16 v[80:83], v[160:163], v[232:235], v[80:83]
    ds_read_b64_tr_b16 v[180:181], v44 offset:0
    v_mfma_f32_16x16x32_bf16 v[112:115], v[164:167], v[232:235], v[112:115]
    ds_read_b64_tr_b16 v[182:183], v44 offset:1024
    v_mfma_f32_16x16x32_bf16 v[108:111], v[164:167], v[228:231], v[108:111]
    ds_read_b64_tr_b16 v[184:185], v45 offset:0
    v_mfma_f32_16x16x32_bf16 v[104:107], v[224:227], v[164:167], v[104:107]
    ds_read_b64_tr_b16 v[186:187], v45 offset:1024
    v_mfma_f32_16x16x32_bf16 v[100:103], v[220:223], v[164:167], v[100:103]
    ds_read_b64_tr_b16 v[188:189], v46 offset:0
    v_mfma_f32_16x16x32_bf16 v[96:99], v[216:219], v[164:167], v[96:99]
    ds_read_b64_tr_b16 v[190:191], v46 offset:1024
    v_mfma_f32_16x16x32_bf16 v[92:95], v[212:215], v[164:167], v[92:95]
    ds_read_b64_tr_b16 v[192:193], v47 offset:0
    v_mfma_f32_16x16x32_bf16 v[88:91], v[208:211], v[164:167], v[88:91]
    ds_read_b64_tr_b16 v[194:195], v47 offset:1024
    v_mfma_f32_16x16x32_bf16 v[84:87], v[204:207], v[164:167], v[84:87]
    ds_read_b64_tr_b16 v[196:197], v48 offset:0
    v_mfma_f32_16x16x32_bf16 v[116:119], v[204:207], v[168:171], v[116:119]
    ds_read_b64_tr_b16 v[198:199], v48 offset:1024
    v_mfma_f32_16x16x32_bf16 v[120:123], v[208:211], v[168:171], v[120:123]
    ds_read_b64_tr_b16 v[200:201], v49 offset:0
    v_mfma_f32_16x16x32_bf16 v[124:127], v[212:215], v[168:171], v[124:127]
    ds_read_b64_tr_b16 v[202:203], v49 offset:1024
    v_mfma_f32_16x16x32_bf16 v[128:131], v[216:219], v[168:171], v[128:131]
    v_mfma_f32_16x16x32_bf16 v[132:135], v[220:223], v[168:171], v[132:135]
    v_mfma_f32_16x16x32_bf16 v[136:139], v[224:227], v[168:171], v[136:139]
    v_mfma_f32_16x16x32_bf16 v[140:143], v[168:171], v[228:231], v[140:143]
    v_mfma_f32_16x16x32_bf16 v[144:147], v[168:171], v[232:235], v[144:147]
    s_waitcnt lgkmcnt(0)
    v_mfma_f32_16x16x32_bf16 v[52:55], v[172:175], v[148:151], v[52:55]
    ds_read_b128 v[160:163], v41 offset:0
    v_mfma_f32_16x16x32_bf16 v[56:59], v[176:179], v[148:151], v[56:59]
    ds_read_b64_tr_b16 v[204:205], v42 offset:8192
    v_mfma_f32_16x16x32_bf16 v[60:63], v[180:183], v[148:151], v[60:63]
    ds_read_b64_tr_b16 v[206:207], v42 offset:9216
    v_mfma_f32_16x16x32_bf16 v[64:67], v[184:187], v[148:151], v[64:67]
    ds_read_b128 v[164:167], v41 offset:2048
    v_mfma_f32_16x16x32_bf16 v[68:71], v[188:191], v[148:151], v[68:71]
    ds_read_b128 v[168:171], v41 offset:4096
    v_mfma_f32_16x16x32_bf16 v[72:75], v[192:195], v[148:151], v[72:75]
    ds_read_b64_tr_b16 v[208:209], v43 offset:8192
    v_mfma_f32_16x16x32_bf16 v[76:79], v[148:151], v[196:199], v[76:79]
    ds_read_b64_tr_b16 v[210:211], v43 offset:9216
    v_mfma_f32_16x16x32_bf16 v[80:83], v[148:151], v[200:203], v[80:83]
    ds_read_b64_tr_b16 v[212:213], v44 offset:8192
    v_mfma_f32_16x16x32_bf16 v[112:115], v[152:155], v[200:203], v[112:115]
    ds_read_b64_tr_b16 v[214:215], v44 offset:9216
    v_mfma_f32_16x16x32_bf16 v[108:111], v[152:155], v[196:199], v[108:111]
    ds_read_b64_tr_b16 v[216:217], v45 offset:8192
    v_mfma_f32_16x16x32_bf16 v[104:107], v[192:195], v[152:155], v[104:107]
    ds_read_b64_tr_b16 v[218:219], v45 offset:9216
    v_mfma_f32_16x16x32_bf16 v[100:103], v[188:191], v[152:155], v[100:103]
    ds_read_b64_tr_b16 v[220:221], v46 offset:8192
    v_mfma_f32_16x16x32_bf16 v[96:99], v[184:187], v[152:155], v[96:99]
    ds_read_b64_tr_b16 v[222:223], v46 offset:9216
    v_mfma_f32_16x16x32_bf16 v[92:95], v[180:183], v[152:155], v[92:95]
    ds_read_b64_tr_b16 v[224:225], v47 offset:8192
    v_mfma_f32_16x16x32_bf16 v[88:91], v[176:179], v[152:155], v[88:91]
    ds_read_b64_tr_b16 v[226:227], v47 offset:9216
    v_mfma_f32_16x16x32_bf16 v[84:87], v[172:175], v[152:155], v[84:87]
    ds_read_b64_tr_b16 v[228:229], v48 offset:8192
    v_mfma_f32_16x16x32_bf16 v[116:119], v[172:175], v[156:159], v[116:119]
    ds_read_b64_tr_b16 v[230:231], v48 offset:9216
    v_mfma_f32_16x16x32_bf16 v[120:123], v[176:179], v[156:159], v[120:123]
    ds_read_b64_tr_b16 v[232:233], v49 offset:8192
    v_mfma_f32_16x16x32_bf16 v[124:127], v[180:183], v[156:159], v[124:127]
    ds_read_b64_tr_b16 v[234:235], v49 offset:9216
    v_mfma_f32_16x16x32_bf16 v[128:131], v[184:187], v[156:159], v[128:131]
    v_mfma_f32_16x16x32_bf16 v[132:135], v[188:191], v[156:159], v[132:135]
    v_mfma_f32_16x16x32_bf16 v[136:139], v[192:195], v[156:159], v[136:139]
    v_mfma_f32_16x16x32_bf16 v[140:143], v[156:159], v[196:199], v[140:143]
    v_mfma_f32_16x16x32_bf16 v[144:147], v[156:159], v[200:203], v[144:147]
    s_waitcnt lgkmcnt(0)
    s_barrier
    v_mfma_f32_16x16x32_bf16 v[52:55], v[204:207], v[160:163], v[52:55]
    ds_read_b128 v[148:151], v40 offset:24576
    v_mfma_f32_16x16x32_bf16 v[56:59], v[208:211], v[160:163], v[56:59]
    ds_read_b64_tr_b16 v[172:173], v42 offset:16384
    v_mfma_f32_16x16x32_bf16 v[60:63], v[212:215], v[160:163], v[60:63]
    ds_read_b64_tr_b16 v[174:175], v42 offset:17408
    v_mfma_f32_16x16x32_bf16 v[64:67], v[216:219], v[160:163], v[64:67]
    ds_read_b128 v[152:155], v40 offset:26624
    v_mfma_f32_16x16x32_bf16 v[68:71], v[220:223], v[160:163], v[68:71]
    ds_read_b128 v[156:159], v40 offset:28672
    v_mfma_f32_16x16x32_bf16 v[72:75], v[224:227], v[160:163], v[72:75]
    ds_read_b64_tr_b16 v[176:177], v43 offset:16384
    v_mfma_f32_16x16x32_bf16 v[76:79], v[160:163], v[228:231], v[76:79]
    ds_read_b64_tr_b16 v[178:179], v43 offset:17408
    v_mfma_f32_16x16x32_bf16 v[80:83], v[160:163], v[232:235], v[80:83]
    ds_read_b64_tr_b16 v[180:181], v44 offset:16384
    v_mfma_f32_16x16x32_bf16 v[112:115], v[164:167], v[232:235], v[112:115]
    ds_read_b64_tr_b16 v[182:183], v44 offset:17408
    v_mfma_f32_16x16x32_bf16 v[108:111], v[164:167], v[228:231], v[108:111]
    ds_read_b64_tr_b16 v[184:185], v45 offset:16384
    v_mfma_f32_16x16x32_bf16 v[104:107], v[224:227], v[164:167], v[104:107]
    ds_read_b64_tr_b16 v[186:187], v45 offset:17408
    v_mfma_f32_16x16x32_bf16 v[100:103], v[220:223], v[164:167], v[100:103]
    ds_read_b64_tr_b16 v[188:189], v46 offset:16384
    v_mfma_f32_16x16x32_bf16 v[96:99], v[216:219], v[164:167], v[96:99]
    ds_read_b64_tr_b16 v[190:191], v46 offset:17408
    v_mfma_f32_16x16x32_bf16 v[92:95], v[212:215], v[164:167], v[92:95]
    ds_read_b64_tr_b16 v[192:193], v47 offset:16384
    v_mfma_f32_16x16x32_bf16 v[88:91], v[208:211], v[164:167], v[88:91]
    ds_read_b64_tr_b16 v[194:195], v47 offset:17408
    v_mfma_f32_16x16x32_bf16 v[84:87], v[204:207], v[164:167], v[84:87]
    ds_read_b64_tr_b16 v[196:197], v48 offset:16384
    v_mfma_f32_16x16x32_bf16 v[116:119], v[204:207], v[168:171], v[116:119]
    ds_read_b64_tr_b16 v[198:199], v48 offset:17408
    v_mfma_f32_16x16x32_bf16 v[120:123], v[208:211], v[168:171], v[120:123]
    ds_read_b64_tr_b16 v[200:201], v49 offset:16384
    v_mfma_f32_16x16x32_bf16 v[124:127], v[212:215], v[168:171], v[124:127]
    ds_read_b64_tr_b16 v[202:203], v49 offset:17408
    v_mfma_f32_16x16x32_bf16 v[128:131], v[216:219], v[168:171], v[128:131]
    v_mfma_f32_16x16x32_bf16 v[132:135], v[220:223], v[168:171], v[132:135]
    v_mfma_f32_16x16x32_bf16 v[136:139], v[224:227], v[168:171], v[136:139]
    v_mfma_f32_16x16x32_bf16 v[140:143], v[168:171], v[228:231], v[140:143]
    v_mfma_f32_16x16x32_bf16 v[144:147], v[168:171], v[232:235], v[144:147]
    s_waitcnt lgkmcnt(0)
    v_mfma_f32_16x16x32_bf16 v[52:55], v[172:175], v[148:151], v[52:55]
    ds_read_b128 v[160:163], v41 offset:24576
    v_mfma_f32_16x16x32_bf16 v[56:59], v[176:179], v[148:151], v[56:59]
    ds_read_b64_tr_b16 v[204:205], v42 offset:24576
    v_mfma_f32_16x16x32_bf16 v[60:63], v[180:183], v[148:151], v[60:63]
    ds_read_b64_tr_b16 v[206:207], v42 offset:25600
    v_mfma_f32_16x16x32_bf16 v[64:67], v[184:187], v[148:151], v[64:67]
    ds_read_b128 v[164:167], v41 offset:26624
    v_mfma_f32_16x16x32_bf16 v[68:71], v[188:191], v[148:151], v[68:71]
    ds_read_b128 v[168:171], v41 offset:28672
    v_mfma_f32_16x16x32_bf16 v[72:75], v[192:195], v[148:151], v[72:75]
    ds_read_b64_tr_b16 v[208:209], v43 offset:24576
    v_mfma_f32_16x16x32_bf16 v[76:79], v[148:151], v[196:199], v[76:79]
    ds_read_b64_tr_b16 v[210:211], v43 offset:25600
    v_mfma_f32_16x16x32_bf16 v[80:83], v[148:151], v[200:203], v[80:83]
    ds_read_b64_tr_b16 v[212:213], v44 offset:24576
    v_mfma_f32_16x16x32_bf16 v[112:115], v[152:155], v[200:203], v[112:115]
    ds_read_b64_tr_b16 v[214:215], v44 offset:25600
    v_mfma_f32_16x16x32_bf16 v[108:111], v[152:155], v[196:199], v[108:111]
    ds_read_b64_tr_b16 v[216:217], v45 offset:24576
    v_mfma_f32_16x16x32_bf16 v[104:107], v[192:195], v[152:155], v[104:107]
    ds_read_b64_tr_b16 v[218:219], v45 offset:25600
    v_mfma_f32_16x16x32_bf16 v[100:103], v[188:191], v[152:155], v[100:103]
    ds_read_b64_tr_b16 v[220:221], v46 offset:24576
    v_mfma_f32_16x16x32_bf16 v[96:99], v[184:187], v[152:155], v[96:99]
    ds_read_b64_tr_b16 v[222:223], v46 offset:25600
    v_mfma_f32_16x16x32_bf16 v[92:95], v[180:183], v[152:155], v[92:95]
    ds_read_b64_tr_b16 v[224:225], v47 offset:24576
    v_mfma_f32_16x16x32_bf16 v[88:91], v[176:179], v[152:155], v[88:91]
    ds_read_b64_tr_b16 v[226:227], v47 offset:25600
    v_mfma_f32_16x16x32_bf16 v[84:87], v[172:175], v[152:155], v[84:87]
    ds_read_b64_tr_b16 v[228:229], v48 offset:24576
    v_mfma_f32_16x16x32_bf16 v[116:119], v[172:175], v[156:159], v[116:119]
    ds_read_b64_tr_b16 v[230:231], v48 offset:25600
    v_mfma_f32_16x16x32_bf16 v[120:123], v[176:179], v[156:159], v[120:123]
    ds_read_b64_tr_b16 v[232:233], v49 offset:24576
    v_mfma_f32_16x16x32_bf16 v[124:127], v[180:183], v[156:159], v[124:127]
    ds_read_b64_tr_b16 v[234:235], v49 offset:25600
    v_mfma_f32_16x16x32_bf16 v[128:131], v[184:187], v[156:159], v[128:131]
    v_mfma_f32_16x16x32_bf16 v[132:135], v[188:191], v[156:159], v[132:135]
    v_mfma_f32_16x16x32_bf16 v[136:139], v[192:195], v[156:159], v[136:139]
    v_mfma_f32_16x16x32_bf16 v[140:143], v[156:159], v[196:199], v[140:143]
    v_mfma_f32_16x16x32_bf16 v[144:147], v[156:159], v[200:203], v[144:147]
    s_waitcnt lgkmcnt(0)
    s_barrier
    v_mfma_f32_16x16x32_bf16 v[52:55], v[204:207], v[160:163], v[52:55]
    ds_read_b128 v[148:151], v40 offset:49152
    v_mfma_f32_16x16x32_bf16 v[56:59], v[208:211], v[160:163], v[56:59]
    ds_read_b64_tr_b16 v[172:173], v42 offset:32768
    v_mfma_f32_16x16x32_bf16 v[60:63], v[212:215], v[160:163], v[60:63]
    ds_read_b64_tr_b16 v[174:175], v42 offset:33792
    v_mfma_f32_16x16x32_bf16 v[64:67], v[216:219], v[160:163], v[64:67]
    ds_read_b128 v[152:155], v40 offset:51200
    v_mfma_f32_16x16x32_bf16 v[68:71], v[220:223], v[160:163], v[68:71]
    ds_read_b128 v[156:159], v40 offset:53248
    v_mfma_f32_16x16x32_bf16 v[72:75], v[224:227], v[160:163], v[72:75]
    ds_read_b64_tr_b16 v[176:177], v43 offset:32768
    v_mfma_f32_16x16x32_bf16 v[76:79], v[160:163], v[228:231], v[76:79]
    ds_read_b64_tr_b16 v[178:179], v43 offset:33792
    v_mfma_f32_16x16x32_bf16 v[80:83], v[160:163], v[232:235], v[80:83]
    ds_read_b64_tr_b16 v[180:181], v44 offset:32768
    v_mfma_f32_16x16x32_bf16 v[112:115], v[164:167], v[232:235], v[112:115]
    ds_read_b64_tr_b16 v[182:183], v44 offset:33792
    v_mfma_f32_16x16x32_bf16 v[108:111], v[164:167], v[228:231], v[108:111]
    ds_read_b64_tr_b16 v[184:185], v45 offset:32768
    v_mfma_f32_16x16x32_bf16 v[104:107], v[224:227], v[164:167], v[104:107]
    ds_read_b64_tr_b16 v[186:187], v45 offset:33792
    v_mfma_f32_16x16x32_bf16 v[100:103], v[220:223], v[164:167], v[100:103]
    ds_read_b64_tr_b16 v[188:189], v46 offset:32768
    v_mfma_f32_16x16x32_bf16 v[96:99], v[216:219], v[164:167], v[96:99]
    ds_read_b64_tr_b16 v[190:191], v46 offset:33792
    v_mfma_f32_16x16x32_bf16 v[92:95], v[212:215], v[164:167], v[92:95]
    ds_read_b64_tr_b16 v[192:193], v47 offset:32768
    v_mfma_f32_16x16x32_bf16 v[88:91], v[208:211], v[164:167], v[88:91]
    ds_read_b64_tr_b16 v[194:195], v47 offset:33792
    v_mfma_f32_16x16x32_bf16 v[84:87], v[204:207], v[164:167], v[84:87]
    ds_read_b64_tr_b16 v[196:197], v48 offset:32768
    v_mfma_f32_16x16x32_bf16 v[116:119], v[204:207], v[168:171], v[116:119]
    ds_read_b64_tr_b16 v[198:199], v48 offset:33792
    v_mfma_f32_16x16x32_bf16 v[120:123], v[208:211], v[168:171], v[120:123]
    ds_read_b64_tr_b16 v[200:201], v49 offset:32768
    v_mfma_f32_16x16x32_bf16 v[124:127], v[212:215], v[168:171], v[124:127]
    ds_read_b64_tr_b16 v[202:203], v49 offset:33792
    v_mfma_f32_16x16x32_bf16 v[128:131], v[216:219], v[168:171], v[128:131]
    s_sub_u32 s52, s52, 1
    v_mfma_f32_16x16x32_bf16 v[132:135], v[220:223], v[168:171], v[132:135]
    s_cmp_lg_u32 s52, 0
    v_mfma_f32_16x16x32_bf16 v[136:139], v[224:227], v[168:171], v[136:139]
    v_mfma_f32_16x16x32_bf16 v[140:143], v[168:171], v[228:231], v[140:143]
    v_mfma_f32_16x16x32_bf16 v[144:147], v[168:171], v[232:235], v[144:147]
    s_cbranch_scc1 K_CLOOP
    s_waitcnt lgkmcnt(0)
    v_mfma_f32_16x16x32_bf16 v[52:55], v[172:175], v[148:151], v[52:55]
    ds_read_b128 v[160:163], v41 offset:49152
    ds_read_b64_tr_b16 v[204:205], v42 offset:40960
    v_mfma_f32_16x16x32_bf16 v[116:119], v[172:175], v[156:159], v[116:119]
    ds_read_b64_tr_b16 v[206:207], v42 offset:41984
    ds_read_b128 v[164:167], v41 offset:51200
    v_mfma_f32_16x16x32_bf16 v[84:87], v[172:175], v[152:155], v[84:87]
    ds_read_b128 v[168:171], v41 offset:53248
    ds_read_b64_tr_b16 v[208:209], v43 offset:40960
    v_mfma_f32_16x16x32_bf16 v[56:59], v[176:179], v[148:151], v[56:59]
    ds_read_b64_tr_b16 v[210:211], v43 offset:41984
    ds_read_b64_tr_b16 v[212:213], v44 offset:40960
    v_mfma_f32_16x16x32_bf16 v[120:123], v[176:179], v[156:159], v[120:123]
    ds_read_b64_tr_b16 v[214:215], v44 offset:41984
    ds_read_b64_tr_b16 v[216:217], v45 offset:40960
    v_mfma_f32_16x16x32_bf16 v[88:91], v[176:179], v[152:155], v[88:91]
    ds_read_b64_tr_b16 v[218:219], v45 offset:41984
    ds_read_b64_tr_b16 v[220:221], v46 offset:40960
    v_mfma_f32_16x16x32_bf16 v[60:63], v[180:183], v[148:151], v[60:63]
    ds_read_b64_tr_b16 v[222:223], v46 offset:41984
    ds_read_b64_tr_b16 v[224:225], v47 offset:40960
    v_mfma_f32_16x16x32_bf16 v[124:127], v[180:183], v[156:159], v[124:127]
    ds_read_b64_tr_b16 v[226:227], v47 offset:41984
    ds_read_b64_tr_b16 v[228:229], v48 offset:40960
    v_mfma_f32_16x16x32_bf16 v[92:95], v[180:183], v[152:155], v[92:95]
    ds_read_b64_tr_b16 v[230:231], v48 offset:41984
    ds_read_b64_tr_b16 v[232:233], v49 offset:40960
    v_mfma_f32_16x16x32_bf16 v[64:67], v[184:187], v[148:151], v[64:67]
    ds_read_b64_tr_b16 v[234:235], v49 offset:41984
    v_mfma_f32_16x16x32_bf16 v[128:131], v[184:187], v[156:159], v[128:131]
    s_nop 1
    v_mfma_f32_16x16x32_bf16 v[96:99], v[184:187], v[152:155], v[96:99]
    s_nop 1
    s_waitcnt lgkmcnt(15)
    v_mfma_f32_16x16x32_bf16 v[52:55], v[204:207], v[160:163], v[52:55]
    s_nop 1
    s_waitcnt lgkmcnt(12)
    v_mfma_f32_16x16x32_bf16 v[56:59], v[208:211], v[160:163], v[56:59]
    s_nop 1
    v_mfma_f32_16x16x32_bf16 v[116:119], v[204:207], v[168:171], v[116:119]
    s_nop 1
    v_mfma_f32_16x16x32_bf16 v[120:123], v[208:211], v[168:171], v[120:123]
    s_nop 1
    v_mfma_f32_16x16x32_bf16 v[84:87], v[204:207], v[164:167], v[84:87]
    v_cvt_pk_bf16_f32 v52, v52, v53
    v_cvt_pk_bf16_f32 v53, v54, v55
    v_mfma_f32_16x16x32_bf16 v[88:91], v[208:211], v[164:167], v[88:91]
    v_cvt_pk_bf16_f32 v54, v56, v57
    v_cvt_pk_bf16_f32 v55, v58, v59
    s_waitcnt lgkmcnt(10)
    v_mfma_f32_16x16x32_bf16 v[60:63], v[212:215], v[160:163], v[60:63]
    ds_write_b128 v13, v[52:55] offset:0
    s_waitcnt lgkmcnt(9)
    v_mfma_f32_16x16x32_bf16 v[64:67], v[216:219], v[160:163], v[64:67]
    v_cvt_pk_bf16_f32 v116, v116, v117
    v_cvt_pk_bf16_f32 v117, v118, v119
    v_mfma_f32_16x16x32_bf16 v[124:127], v[212:215], v[168:171], v[124:127]
    v_cvt_pk_bf16_f32 v118, v120, v121
    v_cvt_pk_bf16_f32 v119, v122, v123
    v_mfma_f32_16x16x32_bf16 v[128:131], v[216:219], v[168:171], v[128:131]
    ds_write_b128 v13, v[116:119] offset:2048
    v_mfma_f32_16x16x32_bf16 v[92:95], v[212:215], v[164:167], v[92:95]
    v_cvt_pk_bf16_f32 v84, v84, v85
    v_cvt_pk_bf16_f32 v85, v86, v87
    v_mfma_f32_16x16x32_bf16 v[96:99], v[216:219], v[164:167], v[96:99]
    v_cvt_pk_bf16_f32 v86, v88, v89
    v_cvt_pk_bf16_f32 v87, v90, v91
    v_mfma_f32_16x16x32_bf16 v[68:71], v[188:191], v[148:151], v[68:71]
    ds_write_b128 v13, v[84:87] offset:1024
    v_mfma_f32_16x16x32_bf16 v[72:75], v[192:195], v[148:151], v[72:75]
    v_cvt_pk_bf16_f32 v60, v60, v61
    v_cvt_pk_bf16_f32 v61, v62, v63
    s_waitcnt lgkmcnt(9)
    v_mfma_f32_16x16x32_bf16 v[68:71], v[220:223], v[160:163], v[68:71]
    v_cvt_pk_bf16_f32 v64, v64, v65
    v_cvt_pk_bf16_f32 v65, v66, v67
    s_waitcnt lgkmcnt(7)
    v_mfma_f32_16x16x32_bf16 v[72:75], v[224:227], v[160:163], v[72:75]
    ds_write2st64_b64 v14, v[60:61], v[64:65] offset0:4 offset1:5
    v_mfma_f32_16x16x32_bf16 v[132:135], v[188:191], v[156:159], v[132:135]
    ds_read_b64 v[62:63], v13 offset:0
    ds_read_b64 v[66:67], v13 offset:0
    v_mfma_f32_16x16x32_bf16 v[136:139], v[192:195], v[156:159], v[136:139]
    v_cvt_pk_bf16_f32 v124, v124, v125
    v_cvt_pk_bf16_f32 v125, v126, v127
    v_mfma_f32_16x16x32_bf16 v[132:135], v[220:223], v[168:171], v[132:135]
    v_cvt_pk_bf16_f32 v128, v128, v129
    v_cvt_pk_bf16_f32 v129, v130, v131
    v_mfma_f32_16x16x32_bf16 v[136:139], v[224:227], v[168:171], v[136:139]
    ds_write2st64_b64 v14, v[124:125], v[128:129] offset0:10 offset1:11
    v_mfma_f32_16x16x32_bf16 v[100:103], v[188:191], v[152:155], v[100:103]
    ds_read_b64 v[126:127], v13 offset:2048
    ds_read_b64 v[130:131], v13 offset:2048
    v_mfma_f32_16x16x32_bf16 v[104:107], v[192:195], v[152:155], v[104:107]
    v_cvt_pk_bf16_f32 v92, v92, v93
    v_cvt_pk_bf16_f32 v93, v94, v95
    v_mfma_f32_16x16x32_bf16 v[100:103], v[220:223], v[164:167], v[100:103]
    v_cvt_pk_bf16_f32 v96, v96, v97
    v_cvt_pk_bf16_f32 v97, v98, v99
    v_mfma_f32_16x16x32_bf16 v[104:107], v[224:227], v[164:167], v[104:107]
    ds_read_b64 v[94:95], v13 offset:1024
    ds_read_b64 v[98:99], v13 offset:1024
    v_mfma_f32_16x16x32_bf16 v[76:79], v[148:151], v[196:199], v[76:79]
    v_cvt_pk_bf16_f32 v68, v68, v69
    v_cvt_pk_bf16_f32 v69, v70, v71
    v_mfma_f32_16x16x32_bf16 v[80:83], v[148:151], v[200:203], v[80:83]
    v_cvt_pk_bf16_f32 v72, v72, v73
    v_cvt_pk_bf16_f32 v73, v74, v75
    s_waitcnt lgkmcnt(13)
    v_mfma_f32_16x16x32_bf16 v[76:79], v[160:163], v[228:231], v[76:79]
    ds_write2st64_b64 v14, v[68:69], v[72:73] offset0:8 offset1:9
    s_waitcnt lgkmcnt(12)
    v_mfma_f32_16x16x32_bf16 v[80:83], v[160:163], v[232:235], v[80:83]
    ds_write_b32 v50, v4
    v_cvt_pk_bf16_f32 v132, v132, v133
    v_mfma_f32_16x16x32_bf16 v[140:143], v[156:159], v[196:199], v[140:143]
    v_cvt_pk_bf16_f32 v133, v134, v135
    v_cvt_pk_bf16_f32 v136, v136, v137
    v_mfma_f32_16x16x32_bf16 v[144:147], v[156:159], v[200:203], v[144:147]
    v_cvt_pk_bf16_f32 v137, v138, v139
    ds_read_b64 v[134:135], v18 offset:2048
    v_mfma_f32_16x16x32_bf16 v[140:143], v[168:171], v[228:231], v[140:143]
    ds_read_b64 v[138:139], v19 offset:2048
    v_cvt_pk_bf16_f32 v100, v100, v101
    v_mfma_f32_16x16x32_bf16 v[144:147], v[168:171], v[232:235], v[144:147]
    v_cvt_pk_bf16_f32 v101, v102, v103
    v_cvt_pk_bf16_f32 v104, v104, v105
    v_mfma_f32_16x16x32_bf16 v[108:111], v[152:155], v[196:199], v[108:111]
    v_cvt_pk_bf16_f32 v105, v106, v107
    ds_read_b64 v[102:103], v18 offset:1024
    v_mfma_f32_16x16x32_bf16 v[112:115], v[152:155], v[200:203], v[112:115]
    ds_read_b64 v[106:107], v19 offset:1024
    v_cvt_pk_bf16_f32 v236, v76, v77
    v_mfma_f32_16x16x32_bf16 v[108:111], v[164:167], v[228:231], v[108:111]
    v_cvt_pk_bf16_f32 v237, v78, v79
    v_cvt_pk_bf16_f32 v242, v80, v81
    v_mfma_f32_16x16x32_bf16 v[112:115], v[164:167], v[232:235], v[112:115]
    v_cvt_pk_bf16_f32 v243, v82, v83
    v_cvt_pk_bf16_f32 v240, v140, v141
    s_branch WS_attd
.p2align 12
WP_attd:
    s_setpc_b64 s[38:39]
WS_attd:
    s_waitcnt lgkmcnt(3)
    v_mfma_f32_16x16x32_bf16 v[208:211], v[124:127], v[132:135], v[28:31]
    ds_write2st64_b64 v14, v[236:237], v[242:243] offset0:6 offset1:7
    v_mfma_f32_16x16x32_bf16 v[204:207], v[92:95], v[132:135], v[24:27]
    v_cvt_pk_bf16_f32 v241, v142, v143
    v_cvt_pk_bf16_f32 v246, v144, v145
    s_waitcnt lgkmcnt(3)
    v_mfma_f32_16x16x32_bf16 v[216:219], v[128:131], v[136:139], v[28:31]
    v_cvt_pk_bf16_f32 v247, v146, v147
    v_cvt_pk_bf16_f32 v238, v108, v109
    v_mfma_f32_16x16x32_bf16 v[212:215], v[96:99], v[136:139], v[24:27]
    ds_write2st64_b64 v14, v[240:241], v[246:247] offset0:12 offset1:13
    s_waitcnt lgkmcnt(3)
    v_mfma_f32_16x16x32_bf16 v[176:179], v[92:95], v[100:103], v[28:31]
    ds_write_b32 v50, v5
    v_cvt_pk_bf16_f32 v239, v110, v111
    v_mfma_f32_16x16x32_bf16 v[172:175], v[60:63], v[100:103], v[32:35]
    v_cvt_pk_bf16_f32 v244, v112, v113
    v_cvt_pk_bf16_f32 v245, v114, v115
    s_waitcnt lgkmcnt(3)
    v_mfma_f32_16x16x32_bf16 v[184:187], v[96:99], v[104:107], v[28:31]
    ds_read_b64_tr_b16 v[188:189], v20 offset:0
    ds_read_b64_tr_b16 v[190:191], v20 offset:1024
    v_mfma_f32_16x16x32_bf16 v[180:183], v[64:67], v[104:107], v[32:35]
    ds_read_b64_tr_b16 v[192:193], v21 offset:0
    ds_read_b64_tr_b16 v[194:195], v21 offset:1024
    v_max3_f32 v68, v172, v173, v176
    ds_read_b64_tr_b16 v[220:221], v22 offset:1024
    v_max3_f32 v69, v174, v175, v178
    ds_read_b64_tr_b16 v[222:223], v22 offset:2048
    v_max_f32 v68, v68, v177
    ds_read_b64_tr_b16 v[224:225], v23 offset:1024
    v_max_f32 v69, v69, v179
    ds_read_b64_tr_b16 v[226:227], v23 offset:2048
    v_max3_f32 v70, v180, v181, v184
    v_max3_f32 v71, v182, v183, v186
    v_max_f32 v70, v70, v185
    v_max_f32 v71, v71, v187
    v_max3_f32 v72, v204, v205, v208
    v_max3_f32 v73, v206, v207, v210
    v_max_f32 v72, v72, v209
    v_max_f32 v73, v73, v211
    v_max3_f32 v74, v212, v213, v216
    v_max3_f32 v75, v214, v215, v218
    v_max_f32 v74, v74, v217
    v_max_f32 v75, v75, v219
    v_cvt_pk_bf16_f32 v88, v68, v69
    v_cvt_pk_bf16_f32 v89, v70, v71
    v_cvt_pk_bf16_f32 v90, v72, v73
    v_cvt_pk_bf16_f32 v91, v74, v75
    v_lshlrev_b32 v68, 16, v88
    v_and_b32 v69, 0xffff0000, v88
    v_lshlrev_b32 v70, 16, v89
    v_and_b32 v71, 0xffff0000, v89
    v_lshlrev_b32 v72, 16, v90
    v_and_b32 v73, 0xffff0000, v90
    v_lshlrev_b32 v74, 16, v91
    v_and_b32 v75, 0xffff0000, v91
    v_pk_mul_f32 v[68:69], v[68:69], s[48:49]
    v_pk_mul_f32 v[70:71], v[70:71], s[48:49]
    v_pk_mul_f32 v[72:73], v[72:73], s[48:49]
    v_pk_mul_f32 v[74:75], v[74:75], s[48:49]
    v_cvt_pk_bf16_f32 v88, v68, v69
    v_cvt_pk_bf16_f32 v89, v70, v71
    v_cvt_pk_bf16_f32 v90, v72, v73
    v_cvt_pk_bf16_f32 v91, v74, v75
    v_permlane16_swap_b32 v88, v89
    s_nop 0
    v_permlane16_swap_b32 v90, v91
    s_nop 1
    v_permlane32_swap_b32 v88, v90
    v_permlane32_swap_b32 v89, v91
    v_lshlrev_b32 v68, 16, v88
    v_and_b32 v69, 0xffff0000, v88
    v_lshlrev_b32 v72, 16, v90
    v_and_b32 v73, 0xffff0000, v90
    v_lshlrev_b32 v70, 16, v89
    v_and_b32 v71, 0xffff0000, v89
    v_lshlrev_b32 v74, 16, v91
    v_and_b32 v75, 0xffff0000, v91
    v_max3_f32 v120, v68, v69, v72
    v_max3_f32 v121, v73, v70, v71
    v_max3_f32 v120, v120, v74, v75
    v_max_f32 v120, v120, v121
    v_mul_f32 v120, s46, v120
    v_pk_fma_f32 v[68:69], v[68:69], s[46:47], v[120:121] op_sel_hi:[1,1,0] neg_lo:[0,0,1] neg_hi:[0,0,1]
    v_pk_fma_f32 v[70:71], v[70:71], s[46:47], v[120:121] op_sel_hi:[1,1,0] neg_lo:[0,0,1] neg_hi:[0,0,1]
    v_pk_fma_f32 v[72:73], v[72:73], s[46:47], v[120:121] op_sel_hi:[1,1,0] neg_lo:[0,0,1] neg_hi:[0,0,1]
    v_pk_fma_f32 v[74:75], v[74:75], s[46:47], v[120:121] op_sel_hi:[1,1,0] neg_lo:[0,0,1] neg_hi:[0,0,1]
    v_exp_f32 v68, v68
    v_exp_f32 v69, v69
    v_exp_f32 v70, v70
    v_exp_f32 v71, v71
    v_exp_f32 v72, v72
    v_exp_f32 v73, v73
    v_exp_f32 v74, v74
    v_exp_f32 v75, v75
    v_pk_add_f32 v[56:57], v[68:69], v[70:71]
    v_pk_add_f32 v[58:59], v[72:73], v[74:75]
    v_pk_add_f32 v[56:57], v[56:57], v[58:59]
    v_add_f32 v56, v56, v57
    v_rcp_f32 v56, v56
    s_nop 0
    v_pk_mul_f32 v[68:69], v[68:69], v[56:57] op_sel_hi:[1,0]
    v_pk_mul_f32 v[70:71], v[70:71], v[56:57] op_sel_hi:[1,0]
    v_pk_mul_f32 v[72:73], v[72:73], v[56:57] op_sel_hi:[1,0]
    v_pk_mul_f32 v[74:75], v[74:75], v[56:57] op_sel_hi:[1,0]
    v_cvt_pk_bf16_f32 v88, v68, v69
    v_cvt_pk_bf16_f32 v90, v72, v73
    v_cvt_pk_bf16_f32 v89, v70, v71
    v_cvt_pk_bf16_f32 v91, v74, v75
    v_permlane32_swap_b32 v88, v90
    s_nop 0
    v_permlane32_swap_b32 v89, v91
    s_nop 1
    v_permlane16_swap_b32 v88, v89
    v_permlane16_swap_b32 v90, v91
    v_perm_b32 v148, v88, v88, v36
    v_perm_b32 v149, v88, v88, v37
    v_perm_b32 v150, v88, v88, v38
    v_perm_b32 v151, v88, v88, v39
    v_perm_b32 v152, v89, v89, v36
    v_perm_b32 v153, v89, v89, v37
    v_perm_b32 v154, v89, v89, v38
    v_perm_b32 v155, v89, v89, v39
    v_mfma_f32_16x16x32_bf16 v[100:103], v[236:239], v[148:151], 0
    s_waitcnt lgkmcnt(6)
    v_mfma_f32_16x16x32_bf16 v[156:159], v[188:191], v[148:151], 0
    v_perm_b32 v160, v90, v90, v36
    v_perm_b32 v161, v90, v90, v37
    v_perm_b32 v162, v90, v90, v38
    v_perm_b32 v163, v90, v90, v39
    v_mfma_f32_16x16x32_bf16 v[104:107], v[242:245], v[152:155], 0
    s_waitcnt lgkmcnt(4)
    v_mfma_f32_16x16x32_bf16 v[156:159], v[192:195], v[152:155], v[156:159]
    v_perm_b32 v164, v91, v91, v36
    v_perm_b32 v165, v91, v91, v37
    v_perm_b32 v166, v91, v91, v38
    v_perm_b32 v167, v91, v91, v39
    v_mfma_f32_16x16x32_bf16 v[132:135], v[238:241], v[160:163], 0
    s_waitcnt lgkmcnt(2)
    v_mfma_f32_16x16x32_bf16 v[156:159], v[220:223], v[160:163], v[156:159]
    v_mfma_f32_16x16x32_bf16 v[136:139], v[244:247], v[164:167], 0
    s_waitcnt lgkmcnt(0)
    v_mfma_f32_16x16x32_bf16 v[156:159], v[224:227], v[164:167], v[156:159]
    v_cvt_pk_bf16_f32 v60, v100, v101
    v_cvt_pk_bf16_f32 v61, v102, v103
    v_cvt_pk_bf16_f32 v62, v104, v105
    v_cvt_pk_bf16_f32 v63, v106, v107
    buffer_store_dwordx4 v[60:63], v15, s[20:23], s50 offen sc1
    v_cvt_pk_bf16_f32 v64, v132, v133
    v_cvt_pk_bf16_f32 v65, v134, v135
    v_cvt_pk_bf16_f32 v66, v136, v137
    v_cvt_pk_bf16_f32 v67, v138, v139
    v_cvt_pk_bf16_f32 v56, v156, v157
    v_cvt_pk_bf16_f32 v57, v158, v159
    v_cvt_pk_bf16_f32 v58, v156, v157
    v_cvt_pk_bf16_f32 v59, v158, v159
    buffer_store_dwordx4 v[64:67], v15, s[20:23], s51 offen sc1
    v_permlane16_swap_b32 v56, v58
    v_permlane16_swap_b32 v57, v59
    buffer_store_dwordx4 v[56:59], v16, s[20:23], s50 offen sc1
    s_cmp_lg_u32 s34, -1
    s_cbranch_scc1 K_P2_EARLY
K_DRAIN:
    s_waitcnt vmcnt(0)
    s_barrier
    s_branch K_END
K_W7A:
    s_waitcnt vmcnt(0)
    v_and_b32 v4, 7, v1
    v_lshlrev_b32 v4, 2, v4
    s_mov_b32 s3, 131072
K_ZPOLL5:
    v_cmp_eq_u32 vcc, 0, v7
    s_cbranch_vccz K_ZOK5
    s_sub_u32 s3, s3, 1
    s_cbranch_scc1 K_ZOK5
    global_load_dword v7, v4, s[8:9] offset:192 sc1
    s_waitcnt vmcnt(0)
    s_branch K_ZPOLL5
K_ZOK5:
    v_mov_b32 v4, 158720
    v_mov_b32 v3, 1
    s_mov_b64 exec, 1
    s_nop 0
    ds_add_rtn_u32 v2, v4, v3 offset:48
    s_mov_b32 exec_lo, s36
    v_mov_b32 v3, 1
    s_waitcnt lgkmcnt(0)
    v_readfirstlane_b32 s33, v2
    s_nop 3
    s_and_b32 s33, s33, 0xff
    s_cmp_lg_u32 s33, 7
    s_cbranch_scc1 K_ARR7
    global_store_dword v8, v3, s[10:11] sc1
K_ARR7:
    s_mov_b64 exec, -1
    v_mov_b32 v6, 158800
    s_mov_b32 s3, 1048576
K_XG7:
    ds_read_b128 v[2:5], v6
    s_sleep 1
    s_sub_u32 s3, s3, 1
    s_waitcnt lgkmcnt(0)
    v_min3_u32 v2, v2, v4, v5
    v_min_u32 v2, v2, v3
    s_nop 0
    v_readfirstlane_b32 s33, v2
    s_nop 3
    s_cselect_b32 s33, 1, s33
    s_cmp_lt_u32 s33, 1
    s_cbranch_scc1 K_XG7
    v_mov_b32 v4, 158720
    s_branch K_WOE
K_W7:
    v_mov_b32 v3, 0x100
    s_mov_b64 exec, 1
    s_waitcnt vmcnt(0)
    ds_add_u32 v4, v3 offset:48
    s_mov_b64 exec, -1
    s_branch K_P2_HELP
K_FLAG:
    s_waitcnt vmcnt(0)
    v_and_b32 v4, 7, v1
    v_lshlrev_b32 v4, 2, v4
    s_mov_b32 s3, 131072
K_ZPOLL0:
    v_cmp_eq_u32 vcc, 0, v7
    s_cbranch_vccz K_ZOK0
    s_sub_u32 s3, s3, 1
    s_cbranch_scc1 K_ZOK0
    global_load_dword v7, v4, s[8:9] offset:192 sc1
    s_waitcnt vmcnt(0)
    s_branch K_ZPOLL0
K_ZOK0:
    v_mov_b32 v3, 1
    s_mov_b32 exec_lo, s36
    s_mov_b32 exec_hi, 0
    s_setprio 3
    s_barrier
    global_store_dword v8, v3, s[10:11] sc1
    s_mov_b64 exec, -1
    s_branch K_END
WP_atts:
    s_setpc_b64 s[38:39]
K_JOIN_S:
    s_setprio 0
    s_cmp_eq_u32 s30, 7
    s_cbranch_scc1 K_FLAG
    s_lshl_b32 s3, s30, 2
    s_add_u32 s3, s3, 158784
    v_mov_b32 v6, s3
    s_mov_b32 s3, 1048576
K_XG1:
    ds_read2_b32 v[2:3], v6 offset0:0 offset1:1
    s_sleep 1
    s_sub_u32 s3, s3, 1
    s_waitcnt lgkmcnt(0)
    v_min_u32 v2, v2, v3
    s_nop 0
    v_readfirstlane_b32 s33, v2
    s_nop 3
    s_cselect_b32 s33, 1, s33
    s_cmp_lt_u32 s33, 1
    s_cbranch_scc1 K_XG1
    ds_read_b64 v[40:41], v14 offset:4096
    ds_read_b64 v[42:43], v18 offset:1024
    ds_read_b64 v[48:49], v14 offset:0
    ds_read_b64 v[50:51], v13 offset:0
    ds_read_b64 v[52:53], v14 offset:2048
    ds_read_b64 v[54:55], v13 offset:1024
    ds_read_b64 v[44:45], v14 offset:4608
    ds_read_b64 v[46:47], v19 offset:1024
    ds_read_b64 v[56:57], v14 offset:512
    ds_read_b64 v[58:59], v13 offset:0
    ds_read_b64 v[60:61], v14 offset:2560
    ds_read_b64 v[62:63], v13 offset:1024
    s_waitcnt lgkmcnt(8)
    v_mfma_f32_16x16x32_bf16 v[80:83], v[48:51], v[40:43], v[24:27]
    s_waitcnt lgkmcnt(6)
    v_mfma_f32_16x16x32_bf16 v[84:87], v[52:55], v[40:43], v[28:31]
    s_waitcnt lgkmcnt(2)
    v_mfma_f32_16x16x32_bf16 v[88:91], v[56:59], v[44:47], v[24:27]
    s_waitcnt lgkmcnt(0)
    v_mfma_f32_16x16x32_bf16 v[92:95], v[60:63], v[44:47], v[28:31]
    ds_read_b64_tr_b16 v[72:73], v20 offset:0
    ds_read_b64_tr_b16 v[74:75], v20 offset:1024
    ds_read_b64_tr_b16 v[76:77], v21 offset:0
    ds_read_b64_tr_b16 v[78:79], v21 offset:1024
    v_max3_f32 v116, v80, v81, v84
    v_max3_f32 v117, v82, v83, v86
    v_max_f32 v116, v116, v85
    v_max_f32 v117, v117, v87
    v_max3_f32 v118, v88, v89, v92
    v_max3_f32 v119, v90, v91, v94
    v_max_f32 v118, v118, v93
    v_max_f32 v119, v119, v95
    v_cvt_pk_bf16_f32 v128, v116, v117
    v_cvt_pk_bf16_f32 v129, v118, v119
    v_lshlrev_b32 v116, 16, v128
    v_and_b32 v117, 0xffff0000, v128
    v_lshlrev_b32 v118, 16, v129
    v_and_b32 v119, 0xffff0000, v129
    v_pk_mul_f32 v[116:117], v[116:117], s[48:49]
    v_pk_mul_f32 v[118:119], v[118:119], s[48:49]
    v_cvt_pk_bf16_f32 v128, v116, v117
    v_cvt_pk_bf16_f32 v129, v118, v119
    s_nop 1
    v_permlane16_swap_b32 v128, v129
    v_lshlrev_b32 v116, 16, v128
    v_and_b32 v117, 0xffff0000, v128
    v_lshlrev_b32 v118, 16, v129
    v_and_b32 v119, 0xffff0000, v129
    v_max3_f32 v130, v116, v117, v118
    v_max_f32 v130, v130, v119
    v_mov_b32 v131, v130
    s_nop 1
    v_permlane32_swap_b32 v130, v131
    v_max_f32 v130, v130, v131
    v_mul_f32 v130, s46, v130
    v_pk_fma_f32 v[116:117], v[116:117], s[46:47], v[130:131] op_sel_hi:[1,1,0] neg_lo:[0,0,1] neg_hi:[0,0,1]
    v_pk_fma_f32 v[118:119], v[118:119], s[46:47], v[130:131] op_sel_hi:[1,1,0] neg_lo:[0,0,1] neg_hi:[0,0,1]
    v_exp_f32 v116, v116
    v_exp_f32 v117, v117
    v_exp_f32 v118, v118
    v_exp_f32 v119, v119
    s_nop 0
    v_pk_add_f32 v[120:121], v[116:117], v[118:119]
    v_add_f32 v120, v120, v121
    v_mov_b32 v121, v120
    s_nop 1
    v_permlane32_swap_b32 v120, v121
    v_add_f32 v120, v120, v121
    v_rcp_f32 v120, v120
    s_nop 0
    v_pk_mul_f32 v[116:117], v[116:117], v[120:121] op_sel_hi:[1,0]
    v_pk_mul_f32 v[118:119], v[118:119], v[120:121] op_sel_hi:[1,0]
    v_cvt_pk_bf16_f32 v128, v116, v117
    v_cvt_pk_bf16_f32 v129, v118, v119
    s_nop 1
    v_permlane16_swap_b32 v128, v129
    s_mov_b32 s3, 1048576
K_XG2:
    ds_read2_b32 v[2:3], v6 offset0:0 offset1:1
    s_sleep 1
    s_sub_u32 s3, s3, 1
    s_waitcnt lgkmcnt(0)
    v_min_u32 v2, v2, v3
    s_nop 0
    v_readfirstlane_b32 s33, v2
    s_nop 3
    s_cselect_b32 s33, 2, s33
    s_cmp_lt_u32 s33, 2
    s_cbranch_scc1 K_XG2
    ds_read_b64 v[64:65], v14 offset:1024
    ds_read_b64 v[66:67], v14 offset:3072
    ds_read_b64 v[68:69], v14 offset:1536
    ds_read_b64 v[70:71], v14 offset:3584
    v_perm_b32 v96, v128, v128, v36
    v_perm_b32 v97, v128, v128, v37
    v_perm_b32 v98, v128, v128, v38
    v_perm_b32 v99, v128, v128, v39
    v_perm_b32 v100, v129, v129, v36
    v_perm_b32 v101, v129, v129, v37
    v_perm_b32 v102, v129, v129, v38
    v_perm_b32 v103, v129, v129, v39
    s_waitcnt lgkmcnt(2)
    v_mfma_f32_16x16x32_bf16 v[104:107], v[64:67], v[96:99], 0
    v_mfma_f32_16x16x32_bf16 v[112:115], v[72:75], v[96:99], 0
    s_waitcnt lgkmcnt(0)
    v_mfma_f32_16x16x32_bf16 v[108:111], v[68:71], v[100:103], 0
    v_mfma_f32_16x16x32_bf16 v[112:115], v[76:79], v[100:103], v[112:115]
    s_nop 3
    v_cvt_pk_bf16_f32 v124, v104, v105
    v_cvt_pk_bf16_f32 v125, v106, v107
    s_nop 0
    v_cvt_pk_bf16_f32 v126, v108, v109
    v_cvt_pk_bf16_f32 v127, v110, v111
    v_cvt_pk_bf16_f32 v120, v112, v113
    v_cvt_pk_bf16_f32 v121, v114, v115
    v_cvt_pk_bf16_f32 v122, v112, v113
    v_cvt_pk_bf16_f32 v123, v114, v115
    buffer_store_dwordx4 v[124:127], v15, s[20:23], s50 offen sc1
    v_permlane16_swap_b32 v120, v122
    v_permlane16_swap_b32 v121, v123
    buffer_store_dwordx4 v[120:123], v16, s[20:23], s50 offen sc1
    s_cmp_eq_u32 s34, -1
    s_cbranch_scc1 K_DRAIN
    s_cmp_lg_u32 s30, 6
    s_cbranch_scc1 K_NOFL
    s_waitcnt vmcnt(2)
    v_and_b32 v4, 7, v1
    v_lshlrev_b32 v4, 2, v4
    s_mov_b32 s3, 131072
K_ZPOLL2:
    v_cmp_eq_u32 vcc, 0, v7
    s_cbranch_vccz K_ZOK2
    s_sub_u32 s3, s3, 1
    s_cbranch_scc1 K_ZOK2
    global_load_dword v7, v4, s[8:9] offset:192 sc1
    s_waitcnt vmcnt(0)
    s_branch K_ZPOLL2
K_ZOK2:
    v_and_b32 v2, 1, v1
    v_lshl_add_u32 v2, v2, 2, s42
    global_load_dword v7, v2, s[10:11] offset:128 sc1
K_NOFL:
    v_mov_b32 v4, 158720
    v_mov_b32 v3, 257
    s_mov_b64 exec, 1
    s_waitcnt vmcnt(0)
    ds_add_rtn_u32 v2, v4, v3 offset:48
    s_mov_b32 exec_lo, s36
    v_mov_b32 v3, 1
    s_waitcnt lgkmcnt(0)
    v_readfirstlane_b32 s33, v2
    s_nop 3
    s_and_b32 s33, s33, 0xff
    s_cmp_lg_u32 s33, 7
    s_cbranch_scc1 K_ARRS
    global_store_dword v8, v3, s[10:11] sc1
K_ARRS:
    s_mov_b64 exec, -1
    s_cmp_ge_u32 s30, 6
    s_cbranch_scc1 K_P2_HELP
    s_branch K_LATE
WP_early:
    s_setpc_b64 s[38:39]
K_P2_EARLY:
    s_lshl_b32 s54, s40, 7
    v_lshrrev_b32 v9, 4, v1
    v_mov_b32 v12, 158720
    s_add_u32 s20, s10, 0x100000
    s_addc_u32 s21, s11, 0
    s_mov_b32 s22, 0x280000
    s_mov_b32 s23, 0x20000
    s_add_u32 s16, s10, 0x1000
    s_addc_u32 s17, s11, 0
    s_mov_b32 s18, 0x2000
    s_mov_b32 s19, 0x20000
    s_mov_b32 s48, s6
    s_mov_b32 s49, s7
    s_mov_b32 s50, 0x280000
    s_mov_b32 s51, 0x20000
    s_lshl_b32 s53, s40, 3
    s_lshl1_add_u32 s53, s30, s53
    s_mov_b32 s55, 20480
    v_bfe_u32 v20, v1, 2, 2
    v_and_b32 v21, 3, v1
    s_mul_i32 s3, s53, 20480
    v_lshl_add_u32 v25, v1, 4, s3
    v_add_u32 v26, 20480, v25
    v_add_u32 v35, 16384, v25
    v_add_u32 v36, 16384, v26
    v_and_b32 v2, 15, v1
    s_lshl_b32 s3, s53, 6
    v_lshl_add_u32 v23, v2, 2, s3
    v_lshl_add_u32 v2, v9, 2, v20
    v_bfe_u32 v3, v2, 1, 2
    v_lshlrev_b32 v2, 7, v2
    v_lshl_add_u32 v2, v21, 3, v2
    v_lshl_add_u32 v24, v3, 5, v2
    v_lshrrev_b32 v3, 1, v20
    v_mul_u32_u24 v2, 40, v9
    v_add3_u32 v2, v2, 16, v20
    v_lshlrev_b32 v2, 7, v2
    v_lshl_add_u32 v2, v21, 3, v2
    v_xor_b32 v4, 0, v3
    v_lshl_add_u32 v60, v4, 5, v2
    v_xor_b32 v4, 1, v3
    v_lshl_add_u32 v61, v4, 5, v2
    v_xor_b32 v4, 2, v3
    v_lshl_add_u32 v62, v4, 5, v2
    v_xor_b32 v4, 3, v3
    v_lshl_add_u32 v63, v4, 5, v2
    v_lshrrev_b32 v3, 4, v1
    v_and_b32 v4, 7, v1
    v_lshrrev_b32 v2, 3, v1
    v_xor_b32 v4, v4, v3
    v_mul_u32_u24 v2, 1280, v2
    v_lshl_add_u32 v27, v4, 4, v2
    v_xor_b32 v28, 64, v27
    s_lshl_b32 s71, s40, 3
    s_lshl1_add_u32 s71, s30, s71
    s_mul_i32 s71, s71, 20480
    s_lshl_b32 s33, s41, 7
    s_add_u32 s71, s71, s33
    s_add_u32 s72, s71, 10240
    s_add_u32 s73, s71, 20480
    s_add_u32 s74, s71, 30720
    s_lshl_b32 s3, s30, 12
    s_add_u32 s3, s3, 140288
    v_lshl_add_u32 v33, v1, 4, s3
    v_and_b32 v2, 15, v1
    v_lshrrev_b32 v3, 1, v2
    v_lshrrev_b32 v4, 5, v1
    v_xor_b32 v3, v3, v4
    v_lshlrev_b32 v3, 4, v3
    v_lshl_add_u32 v3, v2, 7, v3
    v_and_b32 v4, 1, v9
    v_lshl_add_u32 v3, v4, 3, v3
    v_add_u32 v29, s3, v3
    v_xor_b32 v30, 32, v29
    v_xor_b32 v31, 64, v29
    v_xor_b32 v32, 96, v29
    s_and_b32 s33, s40, 3
    s_lshl_b32 s33, s33, 3
    s_lshr_b32 s33, 0x7f06037f, s33
    s_and_b32 s33, s33, 0xff
    s_lshl_b32 s3, s30, 1
    s_cmp_ge_u32 s3, s33
    s_cselect_b32 s64, 16, 0
    s_add_u32 s3, s3, 1
    s_cmp_ge_u32 s3, s33
    s_cselect_b32 s65, 16, 0
    s_mov_b32 s63, 0
    s_mov_b32 s66, 0
    s_mov_b32 s67, 16384
    v_mov_b32 v34, 0
    v_mov_b32 v4, 158720
    v_mov_b32 v3, 1
    s_mov_b64 exec, 1
    s_waitcnt vmcnt(0)
    ds_add_rtn_u32 v2, v4, v3 offset:48
    s_mov_b32 exec_lo, s36
    v_mov_b32 v3, 1
    s_waitcnt lgkmcnt(0)
    v_readfirstlane_b32 s33, v2
    s_nop 3
    s_and_b32 s33, s33, 0xff
    s_cmp_lg_u32 s33, 7
    s_cbranch_scc1 K_ARRD
    global_store_dword v8, v3, s[10:11] sc1
K_ARRD:
    s_mov_b64 exec, -1
    s_mov_b32 s3, 1048576
K_P2_GE:
    ds_read_b32 v2, v12 offset:48
    s_sub_u32 s3, s3, 1
    s_waitcnt lgkmcnt(0)
    v_readfirstlane_b32 s33, v2
    s_nop 3
    s_cselect_b32 s33, 1024, s33
    s_cmp_lt_u32 s33, 1024
    s_cbranch_scc1 K_P2_GE
K_P2_GEMM:
    s_setprio 0
    s_mov_b32 s3, 1048576
K_P2_GS:
    ds_read_b32 v2, v12 offset:40
    s_sub_u32 s3, s3, 1
    s_waitcnt lgkmcnt(0)
    v_readfirstlane_b32 s33, v2
    s_nop 3
    s_cselect_b32 s33, 1, s33
    s_cmp_lt_u32 s33, 1
    s_cbranch_scc1 K_P2_GS
    buffer_load_dword v64, v23, s[16:19], 0 offen offset:0 sc1
    buffer_load_dword v66, v23, s[16:19], 0 offen offset:64 sc1
    ds_read_b128 v[16:19], v12
    ds_read_b64 v[40:41], v29 offset:0
    ds_read_b64 v[42:43], v30 offset:0
    ds_read_b64 v[44:45], v31 offset:0
    ds_read_b64 v[46:47], v32 offset:0
    ds_read_b64 v[48:49], v29 offset:2048
    ds_read_b64 v[50:51], v30 offset:2048
    ds_read_b64 v[52:53], v31 offset:2048
    ds_read_b64 v[54:55], v32 offset:2048
    s_waitcnt lgkmcnt(4)
    v_lshlrev_b32 v72, 16, v40
    v_and_b32 v73, 0xffff0000, v40
    v_lshlrev_b32 v74, 16, v41
    v_and_b32 v75, 0xffff0000, v41
    v_lshlrev_b32 v76, 16, v42
    v_and_b32 v77, 0xffff0000, v42
    v_lshlrev_b32 v78, 16, v43
    v_and_b32 v79, 0xffff0000, v43
    v_lshlrev_b32 v80, 16, v44
    v_and_b32 v81, 0xffff0000, v44
    v_lshlrev_b32 v82, 16, v45
    v_and_b32 v83, 0xffff0000, v45
    v_lshlrev_b32 v84, 16, v46
    v_and_b32 v85, 0xffff0000, v46
    v_lshlrev_b32 v86, 16, v47
    v_and_b32 v87, 0xffff0000, v47
    s_waitcnt lgkmcnt(0)
    v_lshlrev_b32 v88, 16, v48
    v_and_b32 v89, 0xffff0000, v48
    v_lshlrev_b32 v90, 16, v49
    v_and_b32 v91, 0xffff0000, v49
    v_lshlrev_b32 v92, 16, v50
    v_and_b32 v93, 0xffff0000, v50
    v_lshlrev_b32 v94, 16, v51
    v_and_b32 v95, 0xffff0000, v51
    v_lshlrev_b32 v96, 16, v52
    v_and_b32 v97, 0xffff0000, v52
    v_lshlrev_b32 v98, 16, v53
    v_and_b32 v99, 0xffff0000, v53
    v_lshlrev_b32 v100, 16, v54
    v_and_b32 v101, 0xffff0000, v54
    v_lshlrev_b32 v102, 16, v55
    v_and_b32 v103, 0xffff0000, v55
    s_cmp_eq_u32 s63, 0
    s_cbranch_scc1 K_SP0
K_SPR0:
    s_ff1_i32_b32 s33, s63
    s_bitset0_b32 s63, s33
    s_lshl_b32 s75, s33, 10
    buffer_load_dwordx4 v[104:107], v25, s[20:23], s75 offen offset:0 sc1
    buffer_load_dwordx4 v[108:111], v26, s[20:23], s75 offen offset:0 sc1
    v_mad_u32_u24 v56, s75, 5, v24
    v_xor_b32 v58, 64, v56
    v_xor_b32 v57, 32, v56
    v_xor_b32 v59, 96, v56
    ds_read_b64_tr_b16 v[184:185], v56 offset:0
    ds_read_b64_tr_b16 v[186:187], v58 offset:2560
    ds_read_b64_tr_b16 v[188:189], v57 offset:0
    ds_read_b64_tr_b16 v[190:191], v59 offset:2560
    ds_read_b64_tr_b16 v[192:193], v58 offset:0
    ds_read_b64_tr_b16 v[194:195], v56 offset:2560
    ds_read_b64_tr_b16 v[196:197], v59 offset:0
    ds_read_b64_tr_b16 v[198:199], v57 offset:2560
    s_cmp_eq_u32 s63, 0
    s_cbranch_scc1 K_SP1
K_SPR1:
    s_ff1_i32_b32 s33, s63
    s_bitset0_b32 s63, s33
    s_lshl_b32 s76, s33, 10
    buffer_load_dwordx4 v[112:115], v25, s[20:23], s76 offen offset:0 sc1
    buffer_load_dwordx4 v[116:119], v26, s[20:23], s76 offen offset:0 sc1
    v_mad_u32_u24 v56, s76, 5, v24
    v_xor_b32 v58, 64, v56
    v_xor_b32 v57, 32, v56
    v_xor_b32 v59, 96, v56
    ds_read_b64_tr_b16 v[200:201], v56 offset:0
    ds_read_b64_tr_b16 v[202:203], v58 offset:2560
    ds_read_b64_tr_b16 v[204:205], v57 offset:0
    ds_read_b64_tr_b16 v[206:207], v59 offset:2560
    ds_read_b64_tr_b16 v[208:209], v58 offset:0
    ds_read_b64_tr_b16 v[210:211], v56 offset:2560
    ds_read_b64_tr_b16 v[212:213], v59 offset:0
    ds_read_b64_tr_b16 v[214:215], v57 offset:2560
    s_waitcnt vmcnt(4)
    s_mov_b64 exec, 1
    ds_add_u32 v12, v34 offset:44
    s_mov_b64 exec, -1
    v_sub_f32 v68, 1.0, v64
    v_cvt_pk_bf16_f32 v68, v68, v68
    v_lshlrev_b32 v68, 16, v68
    v_sub_f32 v70, 1.0, v66
    v_cvt_pk_bf16_f32 v70, v70, v70
    v_lshlrev_b32 v70, 16, v70
    v_pk_mul_f32 v[72:73], v[72:73], v[68:69] op_sel_hi:[1,0]
    v_pk_mul_f32 v[74:75], v[74:75], v[68:69] op_sel_hi:[1,0]
    v_pk_mul_f32 v[76:77], v[76:77], v[68:69] op_sel_hi:[1,0]
    v_pk_mul_f32 v[78:79], v[78:79], v[68:69] op_sel_hi:[1,0]
    v_pk_mul_f32 v[80:81], v[80:81], v[68:69] op_sel_hi:[1,0]
    v_pk_mul_f32 v[82:83], v[82:83], v[68:69] op_sel_hi:[1,0]
    v_pk_mul_f32 v[84:85], v[84:85], v[68:69] op_sel_hi:[1,0]
    v_pk_mul_f32 v[86:87], v[86:87], v[68:69] op_sel_hi:[1,0]
    v_pk_mul_f32 v[88:89], v[88:89], v[70:71] op_sel_hi:[1,0]
    v_pk_mul_f32 v[90:91], v[90:91], v[70:71] op_sel_hi:[1,0]
    v_pk_mul_f32 v[92:93], v[92:93], v[70:71] op_sel_hi:[1,0]
    v_pk_mul_f32 v[94:95], v[94:95], v[70:71] op_sel_hi:[1,0]
    v_pk_mul_f32 v[96:97], v[96:97], v[70:71] op_sel_hi:[1,0]
    v_pk_mul_f32 v[98:99], v[98:99], v[70:71] op_sel_hi:[1,0]
    v_pk_mul_f32 v[100:101], v[100:101], v[70:71] op_sel_hi:[1,0]
    v_pk_mul_f32 v[102:103], v[102:103], v[70:71] op_sel_hi:[1,0]
    s_cmp_eq_u32 s63, 0
    s_cbranch_scc1 K_SP2
K_SPR2:
    s_ff1_i32_b32 s33, s63
    s_bitset0_b32 s63, s33
    s_lshl_b32 s77, s33, 10
    buffer_load_dwordx4 v[120:123], v25, s[20:23], s77 offen offset:0 sc1
    buffer_load_dwordx4 v[124:127], v26, s[20:23], s77 offen offset:0 sc1
    s_cmp_eq_u32 s63, 0
    s_cbranch_scc1 K_SP3
K_SPR3:
    s_ff1_i32_b32 s33, s63
    s_bitset0_b32 s63, s33
    s_lshl_b32 s78, s33, 10
    buffer_load_dwordx4 v[128:131], v25, s[20:23], s78 offen offset:0 sc1
    buffer_load_dwordx4 v[132:135], v26, s[20:23], s78 offen offset:0 sc1
    s_cmp_eq_u32 s63, 0
    s_cbranch_scc1 K_SP4
K_SPR4:
    s_ff1_i32_b32 s33, s63
    s_bitset0_b32 s63, s33
    s_lshl_b32 s75, s33, 10
    buffer_load_dwordx4 v[136:139], v25, s[20:23], s75 offen offset:0 sc1
    buffer_load_dwordx4 v[140:143], v26, s[20:23], s75 offen offset:0 sc1
    s_branch WS_p2g
.p2align 12
WP_p2g:
    s_setpc_b64 s[38:39]
WS_p2g:
    s_waitcnt vmcnt(8) lgkmcnt(9)
    v_mfma_f32_16x16x32_bf16 v[152:155], v[184:187], v[104:107], 0
    v_mad_u32_u24 v56, s77, 5, v24
    v_xor_b32 v58, 64, v56
    v_xor_b32 v57, 32, v56
    v_mfma_f32_16x16x32_bf16 v[168:171], v[184:187], v[108:111], 0
    v_xor_b32 v59, 96, v56
    ds_read_b64_tr_b16 v[216:217], v56 offset:0
    ds_read_b64_tr_b16 v[218:219], v58 offset:2560
    v_mfma_f32_16x16x32_bf16 v[156:159], v[188:191], v[104:107], 0
    ds_read_b64_tr_b16 v[220:221], v57 offset:0
    ds_read_b64_tr_b16 v[222:223], v59 offset:2560
    ds_read_b64_tr_b16 v[224:225], v58 offset:0
    v_mfma_f32_16x16x32_bf16 v[172:175], v[188:191], v[108:111], 0
    ds_read_b64_tr_b16 v[226:227], v56 offset:2560
    ds_read_b64_tr_b16 v[228:229], v59 offset:0
    v_mfma_f32_16x16x32_bf16 v[160:163], v[192:195], v[104:107], 0
    ds_read_b64_tr_b16 v[230:231], v57 offset:2560
    s_cmp_eq_u32 s63, 0
    v_mfma_f32_16x16x32_bf16 v[176:179], v[192:195], v[108:111], 0
    s_cbranch_scc1 K_SP5
K_SPR5:
    s_ff1_i32_b32 s33, s63
    v_mfma_f32_16x16x32_bf16 v[164:167], v[196:199], v[104:107], 0
    s_bitset0_b32 s63, s33
    s_lshl_b32 s76, s33, 10
    v_mfma_f32_16x16x32_bf16 v[180:183], v[196:199], v[108:111], 0
    buffer_load_dwordx4 v[144:147], v25, s[20:23], s76 offen offset:0 sc1
    buffer_load_dwordx4 v[148:151], v26, s[20:23], s76 offen offset:0 sc1
    s_waitcnt vmcnt(8) lgkmcnt(9)
    v_mfma_f32_16x16x32_bf16 v[152:155], v[200:203], v[112:115], v[152:155]
    v_mad_u32_u24 v56, s78, 5, v24
    v_xor_b32 v58, 64, v56
    v_xor_b32 v57, 32, v56
    v_mfma_f32_16x16x32_bf16 v[168:171], v[200:203], v[116:119], v[168:171]
    v_xor_b32 v59, 96, v56
    ds_read_b64_tr_b16 v[184:185], v56 offset:0
    ds_read_b64_tr_b16 v[186:187], v58 offset:2560
    v_mfma_f32_16x16x32_bf16 v[156:159], v[204:207], v[112:115], v[156:159]
    ds_read_b64_tr_b16 v[188:189], v57 offset:0
    ds_read_b64_tr_b16 v[190:191], v59 offset:2560
    ds_read_b64_tr_b16 v[192:193], v58 offset:0
    v_mfma_f32_16x16x32_bf16 v[172:175], v[204:207], v[116:119], v[172:175]
    ds_read_b64_tr_b16 v[194:195], v56 offset:2560
    ds_read_b64_tr_b16 v[196:197], v59 offset:0
    v_mfma_f32_16x16x32_bf16 v[160:163], v[208:211], v[112:115], v[160:163]
    ds_read_b64_tr_b16 v[198:199], v57 offset:2560
    s_cmp_eq_u32 s63, 0
    v_mfma_f32_16x16x32_bf16 v[176:179], v[208:211], v[116:119], v[176:179]
    s_cbranch_scc1 K_SP6
K_SPR6:
    s_ff1_i32_b32 s33, s63
    v_mfma_f32_16x16x32_bf16 v[164:167], v[212:215], v[112:115], v[164:167]
    s_bitset0_b32 s63, s33
    s_lshl_b32 s77, s33, 10
    v_mfma_f32_16x16x32_bf16 v[180:183], v[212:215], v[116:119], v[180:183]
    buffer_load_dwordx4 v[104:107], v25, s[20:23], s77 offen offset:0 sc1
    buffer_load_dwordx4 v[108:111], v26, s[20:23], s77 offen offset:0 sc1
    s_waitcnt vmcnt(8) lgkmcnt(8)
    v_mfma_f32_16x16x32_bf16 v[152:155], v[216:219], v[120:123], v[152:155]
    v_mad_u32_u24 v56, s75, 5, v24
    v_xor_b32 v58, 64, v56
    v_xor_b32 v57, 32, v56
    v_mfma_f32_16x16x32_bf16 v[168:171], v[216:219], v[124:127], v[168:171]
    v_xor_b32 v59, 96, v56
    ds_read_b64_tr_b16 v[200:201], v56 offset:0
    ds_read_b64_tr_b16 v[202:203], v58 offset:2560
    v_mfma_f32_16x16x32_bf16 v[156:159], v[220:223], v[120:123], v[156:159]
    ds_read_b64_tr_b16 v[204:205], v57 offset:0
    ds_read_b64_tr_b16 v[206:207], v59 offset:2560
    ds_read_b64_tr_b16 v[208:209], v58 offset:0
    v_mfma_f32_16x16x32_bf16 v[172:175], v[220:223], v[124:127], v[172:175]
    ds_read_b64_tr_b16 v[210:211], v56 offset:2560
    ds_read_b64_tr_b16 v[212:213], v59 offset:0
    v_mfma_f32_16x16x32_bf16 v[160:163], v[224:227], v[120:123], v[160:163]
    ds_read_b64_tr_b16 v[214:215], v57 offset:2560
    s_andn2_b32 s33, s66, s63
    v_mfma_f32_16x16x32_bf16 v[176:179], v[224:227], v[124:127], v[176:179]
    s_bfe_u32 s33, s33, 0x40000
    s_cmp_eq_u32 s33, 15
    v_mfma_f32_16x16x32_bf16 v[164:167], v[228:231], v[120:123], v[164:167]
    s_cselect_b32 s78, 0, 1024
    s_xor_b32 s69, s78, 1024
    v_mfma_f32_16x16x32_bf16 v[180:183], v[228:231], v[124:127], v[180:183]
    buffer_load_dwordx4 v[112:115], v35, s[20:23], s78 offen offset:0 sc1
    buffer_load_dwordx4 v[116:119], v36, s[20:23], s78 offen offset:0 sc1
    s_waitcnt vmcnt(8) lgkmcnt(8)
    v_mfma_f32_16x16x32_bf16 v[152:155], v[184:187], v[128:131], v[152:155]
    v_mad_u32_u24 v56, s76, 5, v24
    v_xor_b32 v58, 64, v56
    v_xor_b32 v57, 32, v56
    v_mfma_f32_16x16x32_bf16 v[168:171], v[184:187], v[132:135], v[168:171]
    v_xor_b32 v59, 96, v56
    ds_read_b64_tr_b16 v[216:217], v56 offset:0
    ds_read_b64_tr_b16 v[218:219], v58 offset:2560
    v_mfma_f32_16x16x32_bf16 v[156:159], v[188:191], v[128:131], v[156:159]
    ds_read_b64_tr_b16 v[220:221], v57 offset:0
    ds_read_b64_tr_b16 v[222:223], v59 offset:2560
    ds_read_b64_tr_b16 v[224:225], v58 offset:0
    v_mfma_f32_16x16x32_bf16 v[172:175], v[188:191], v[132:135], v[172:175]
    ds_read_b64_tr_b16 v[226:227], v56 offset:2560
    ds_read_b64_tr_b16 v[228:229], v59 offset:0
    v_mfma_f32_16x16x32_bf16 v[160:163], v[192:195], v[128:131], v[160:163]
    ds_read_b64_tr_b16 v[230:231], v57 offset:2560
    s_cmp_eq_u32 s63, 0
    v_mfma_f32_16x16x32_bf16 v[176:179], v[192:195], v[132:135], v[176:179]
    s_cbranch_scc1 K_SP8
K_SPR8:
    s_ff1_i32_b32 s33, s63
    v_mfma_f32_16x16x32_bf16 v[164:167], v[196:199], v[128:131], v[164:167]
    s_bitset0_b32 s63, s33
    s_lshl_b32 s75, s33, 10
    v_mfma_f32_16x16x32_bf16 v[180:183], v[196:199], v[132:135], v[180:183]
    buffer_load_dwordx4 v[120:123], v25, s[20:23], s75 offen offset:0 sc1
    buffer_load_dwordx4 v[124:127], v26, s[20:23], s75 offen offset:0 sc1
    s_waitcnt vmcnt(8) lgkmcnt(8)
    v_mfma_f32_16x16x32_bf16 v[152:155], v[200:203], v[136:139], v[152:155]
    v_mad_u32_u24 v56, s77, 5, v24
    v_xor_b32 v58, 64, v56
    v_mfma_f32_16x16x32_bf16 v[168:171], v[200:203], v[140:143], v[168:171]
    v_xor_b32 v57, 32, v56
    v_xor_b32 v59, 96, v56
    v_mfma_f32_16x16x32_bf16 v[156:159], v[204:207], v[136:139], v[156:159]
    ds_read_b64_tr_b16 v[184:185], v56 offset:0
    ds_read_b64_tr_b16 v[186:187], v58 offset:2560
    v_mfma_f32_16x16x32_bf16 v[172:175], v[204:207], v[140:143], v[172:175]
    ds_read_b64_tr_b16 v[188:189], v57 offset:0
    ds_read_b64_tr_b16 v[190:191], v59 offset:2560
    v_mfma_f32_16x16x32_bf16 v[160:163], v[208:211], v[136:139], v[160:163]
    ds_read_b64_tr_b16 v[192:193], v58 offset:0
    ds_read_b64_tr_b16 v[194:195], v56 offset:2560
    v_mfma_f32_16x16x32_bf16 v[176:179], v[208:211], v[140:143], v[176:179]
    ds_read_b64_tr_b16 v[196:197], v59 offset:0
    ds_read_b64_tr_b16 v[198:199], v57 offset:2560
    v_mfma_f32_16x16x32_bf16 v[164:167], v[212:215], v[136:139], v[164:167]
    buffer_load_dwordx4 v[128:131], v35, s[20:23], s69 offen offset:0 sc1
    buffer_load_dwordx4 v[132:135], v36, s[20:23], s69 offen offset:0 sc1
    v_mfma_f32_16x16x32_bf16 v[180:183], v[212:215], v[140:143], v[180:183]
    s_waitcnt vmcnt(8) lgkmcnt(8)
    v_mfma_f32_16x16x32_bf16 v[152:155], v[216:219], v[144:147], v[152:155]
    v_mad_u32_u24 v56, s78, 20, v60
    v_xor_b32 v58, 64, v56
    v_xor_b32 v57, 32, v56
    v_mfma_f32_16x16x32_bf16 v[168:171], v[216:219], v[148:151], v[168:171]
    v_xor_b32 v59, 96, v56
    ds_read_b64_tr_b16 v[200:201], v56 offset:0
    ds_read_b64_tr_b16 v[202:203], v58 offset:2560
    v_mfma_f32_16x16x32_bf16 v[156:159], v[220:223], v[144:147], v[156:159]
    ds_read_b64_tr_b16 v[204:205], v57 offset:0
    ds_read_b64_tr_b16 v[206:207], v59 offset:2560
    ds_read_b64_tr_b16 v[208:209], v58 offset:0
    v_mfma_f32_16x16x32_bf16 v[172:175], v[220:223], v[148:151], v[172:175]
    ds_read_b64_tr_b16 v[210:211], v56 offset:2560
    ds_read_b64_tr_b16 v[212:213], v59 offset:0
    v_mfma_f32_16x16x32_bf16 v[160:163], v[224:227], v[144:147], v[160:163]
    ds_read_b64_tr_b16 v[214:215], v57 offset:2560
    s_cmp_eq_u32 s63, 0
    v_mfma_f32_16x16x32_bf16 v[176:179], v[224:227], v[148:151], v[176:179]
    s_cbranch_scc1 K_SP10
K_SPR10:
    s_ff1_i32_b32 s33, s63
    v_mfma_f32_16x16x32_bf16 v[164:167], v[228:231], v[144:147], v[164:167]
    s_bitset0_b32 s63, s33
    s_lshl_b32 s77, s33, 10
    v_mfma_f32_16x16x32_bf16 v[180:183], v[228:231], v[148:151], v[180:183]
    buffer_load_dwordx4 v[136:139], v25, s[20:23], s77 offen offset:0 sc1
    buffer_load_dwordx4 v[140:143], v26, s[20:23], s77 offen offset:0 sc1
    s_waitcnt vmcnt(8) lgkmcnt(8)
    v_mfma_f32_16x16x32_bf16 v[152:155], v[184:187], v[104:107], v[152:155]
    v_mad_u32_u24 v56, s75, 5, v24
    v_xor_b32 v58, 64, v56
    v_xor_b32 v57, 32, v56
    v_mfma_f32_16x16x32_bf16 v[168:171], v[184:187], v[108:111], v[168:171]
    v_xor_b32 v59, 96, v56
    ds_read_b64_tr_b16 v[216:217], v56 offset:0
    ds_read_b64_tr_b16 v[218:219], v58 offset:2560
    v_mfma_f32_16x16x32_bf16 v[156:159], v[188:191], v[104:107], v[156:159]
    ds_read_b64_tr_b16 v[220:221], v57 offset:0
    ds_read_b64_tr_b16 v[222:223], v59 offset:2560
    ds_read_b64_tr_b16 v[224:225], v58 offset:0
    v_mfma_f32_16x16x32_bf16 v[172:175], v[188:191], v[108:111], v[172:175]
    ds_read_b64_tr_b16 v[226:227], v56 offset:2560
    ds_read_b64_tr_b16 v[228:229], v59 offset:0
    v_mfma_f32_16x16x32_bf16 v[160:163], v[192:195], v[104:107], v[160:163]
    ds_read_b64_tr_b16 v[230:231], v57 offset:2560
    s_cmp_eq_u32 s63, 0
    v_mfma_f32_16x16x32_bf16 v[176:179], v[192:195], v[108:111], v[176:179]
    s_cbranch_scc1 K_SP11
K_SPR11:
    s_ff1_i32_b32 s33, s63
    v_mfma_f32_16x16x32_bf16 v[164:167], v[196:199], v[104:107], v[164:167]
    s_bitset0_b32 s63, s33
    s_lshl_b32 s78, s33, 10
    v_mfma_f32_16x16x32_bf16 v[180:183], v[196:199], v[108:111], v[180:183]
    buffer_load_dwordx4 v[144:147], v25, s[20:23], s78 offen offset:0 sc1
    buffer_load_dwordx4 v[148:151], v26, s[20:23], s78 offen offset:0 sc1
    s_waitcnt vmcnt(8) lgkmcnt(8)
    v_mfma_f32_16x16x32_bf16 v[152:155], v[200:203], v[112:115], v[152:155]
    v_mad_u32_u24 v56, s69, 20, v60
    v_xor_b32 v58, 64, v56
    v_xor_b32 v57, 32, v56
    v_mfma_f32_16x16x32_bf16 v[168:171], v[200:203], v[116:119], v[168:171]
    v_xor_b32 v59, 96, v56
    ds_read_b64_tr_b16 v[184:185], v56 offset:0
    ds_read_b64_tr_b16 v[186:187], v58 offset:2560
    v_mfma_f32_16x16x32_bf16 v[156:159], v[204:207], v[112:115], v[156:159]
    ds_read_b64_tr_b16 v[188:189], v57 offset:0
    ds_read_b64_tr_b16 v[190:191], v59 offset:2560
    ds_read_b64_tr_b16 v[192:193], v58 offset:0
    v_mfma_f32_16x16x32_bf16 v[172:175], v[204:207], v[116:119], v[172:175]
    ds_read_b64_tr_b16 v[194:195], v56 offset:2560
    ds_read_b64_tr_b16 v[196:197], v59 offset:0
    v_mfma_f32_16x16x32_bf16 v[160:163], v[208:211], v[112:115], v[160:163]
    ds_read_b64_tr_b16 v[198:199], v57 offset:2560
    s_cmp_eq_u32 s63, 0
    v_mfma_f32_16x16x32_bf16 v[176:179], v[208:211], v[116:119], v[176:179]
    s_cbranch_scc1 K_SP12
K_SPR12:
    s_ff1_i32_b32 s33, s63
    v_mfma_f32_16x16x32_bf16 v[164:167], v[212:215], v[112:115], v[164:167]
    s_bitset0_b32 s63, s33
    s_lshl_b32 s75, s33, 10
    v_mfma_f32_16x16x32_bf16 v[180:183], v[212:215], v[116:119], v[180:183]
    buffer_load_dwordx4 v[104:107], v25, s[20:23], s75 offen offset:0 sc1
    buffer_load_dwordx4 v[108:111], v26, s[20:23], s75 offen offset:0 sc1
    s_mov_b32 s3, 1048576
K_P2_GW:
    ds_read_b32 v2, v12 offset:44
    s_sub_u32 s3, s3, 1
    s_waitcnt lgkmcnt(0)
    v_readfirstlane_b32 s33, v2
    s_nop 3
    s_cselect_b32 s33, 4, s33
    s_cmp_lt_u32 s33, 4
    s_cbranch_scc1 K_P2_GW
    v_readfirstlane_b32 s56, v16
    v_readfirstlane_b32 s57, v17
    s_lshl_b32 s58, s53, 4
    s_waitcnt vmcnt(8)
    v_mfma_f32_16x16x32_bf16 v[152:155], v[216:219], v[120:123], v[152:155]
    v_mad_u32_u24 v56, s77, 5, v24
    v_xor_b32 v58, 64, v56
    v_xor_b32 v57, 32, v56
    v_mfma_f32_16x16x32_bf16 v[168:171], v[216:219], v[124:127], v[168:171]
    v_xor_b32 v59, 96, v56
    ds_read_b64_tr_b16 v[200:201], v56 offset:0
    ds_read_b64_tr_b16 v[202:203], v58 offset:2560
    v_mfma_f32_16x16x32_bf16 v[156:159], v[220:223], v[120:123], v[156:159]
    ds_read_b64_tr_b16 v[204:205], v57 offset:0
    ds_read_b64_tr_b16 v[206:207], v59 offset:2560
    ds_read_b64_tr_b16 v[208:209], v58 offset:0
    v_mfma_f32_16x16x32_bf16 v[172:175], v[220:223], v[124:127], v[172:175]
    ds_read_b64_tr_b16 v[210:211], v56 offset:2560
    ds_read_b64_tr_b16 v[212:213], v59 offset:0
    v_mfma_f32_16x16x32_bf16 v[160:163], v[224:227], v[120:123], v[160:163]
    ds_read_b64_tr_b16 v[214:215], v57 offset:2560
    s_cmp_eq_u32 s63, 0
    v_mfma_f32_16x16x32_bf16 v[176:179], v[224:227], v[124:127], v[176:179]
    s_cbranch_scc1 K_SP13
K_SPR13:
    s_ff1_i32_b32 s33, s63
    v_mfma_f32_16x16x32_bf16 v[164:167], v[228:231], v[120:123], v[164:167]
    s_bitset0_b32 s63, s33
    s_lshl_b32 s76, s33, 10
    v_mfma_f32_16x16x32_bf16 v[180:183], v[228:231], v[124:127], v[180:183]
    buffer_load_dwordx4 v[112:115], v25, s[20:23], s76 offen offset:0 sc1
    buffer_load_dwordx4 v[116:119], v26, s[20:23], s76 offen offset:0 sc1
    s_waitcnt vmcnt(8)
    v_mfma_f32_16x16x32_bf16 v[152:155], v[184:187], v[128:131], v[152:155]
    v_mad_u32_u24 v56, s78, 5, v24
    v_xor_b32 v58, 64, v56
    v_xor_b32 v57, 32, v56
    v_mfma_f32_16x16x32_bf16 v[168:171], v[184:187], v[132:135], v[168:171]
    v_xor_b32 v59, 96, v56
    ds_read_b64_tr_b16 v[216:217], v56 offset:0
    ds_read_b64_tr_b16 v[218:219], v58 offset:2560
    v_mfma_f32_16x16x32_bf16 v[156:159], v[188:191], v[128:131], v[156:159]
    ds_read_b64_tr_b16 v[220:221], v57 offset:0
    ds_read_b64_tr_b16 v[222:223], v59 offset:2560
    ds_read_b64_tr_b16 v[224:225], v58 offset:0
    v_mfma_f32_16x16x32_bf16 v[172:175], v[188:191], v[132:135], v[172:175]
    ds_read_b64_tr_b16 v[226:227], v56 offset:2560
    ds_read_b64_tr_b16 v[228:229], v59 offset:0
    v_mfma_f32_16x16x32_bf16 v[160:163], v[192:195], v[128:131], v[160:163]
    ds_read_b64_tr_b16 v[230:231], v57 offset:2560
    s_cmp_eq_u32 s63, 0
    v_mfma_f32_16x16x32_bf16 v[176:179], v[192:195], v[132:135], v[176:179]
    s_cbranch_scc1 K_SP14
K_SPR14:
    s_ff1_i32_b32 s33, s63
    v_mfma_f32_16x16x32_bf16 v[164:167], v[196:199], v[128:131], v[164:167]
    s_bitset0_b32 s63, s33
    s_lshl_b32 s77, s33, 10
    v_mfma_f32_16x16x32_bf16 v[180:183], v[196:199], v[132:135], v[180:183]
    buffer_load_dwordx4 v[120:123], v25, s[20:23], s77 offen offset:0 sc1
    buffer_load_dwordx4 v[124:127], v26, s[20:23], s77 offen offset:0 sc1
    s_waitcnt vmcnt(8) lgkmcnt(8)
    v_mfma_f32_16x16x32_bf16 v[152:155], v[200:203], v[136:139], v[152:155]
    v_mad_u32_u24 v56, s75, 5, v24
    v_xor_b32 v58, 64, v56
    v_xor_b32 v57, 32, v56
    v_mfma_f32_16x16x32_bf16 v[168:171], v[200:203], v[140:143], v[168:171]
    v_xor_b32 v59, 96, v56
    ds_read_b64_tr_b16 v[184:185], v56 offset:0
    ds_read_b64_tr_b16 v[186:187], v58 offset:2560
    v_mfma_f32_16x16x32_bf16 v[156:159], v[204:207], v[136:139], v[156:159]
    ds_read_b64_tr_b16 v[188:189], v57 offset:0
    ds_read_b64_tr_b16 v[190:191], v59 offset:2560
    ds_read_b64_tr_b16 v[192:193], v58 offset:0
    v_mfma_f32_16x16x32_bf16 v[172:175], v[204:207], v[140:143], v[172:175]
    ds_read_b64_tr_b16 v[194:195], v56 offset:2560
    ds_read_b64_tr_b16 v[196:197], v59 offset:0
    v_mfma_f32_16x16x32_bf16 v[160:163], v[208:211], v[136:139], v[160:163]
    ds_read_b64_tr_b16 v[198:199], v57 offset:2560
    s_cmp_eq_u32 s63, 0
    v_mfma_f32_16x16x32_bf16 v[176:179], v[208:211], v[140:143], v[176:179]
    s_cbranch_scc1 K_SP15
K_SPR15:
    s_ff1_i32_b32 s33, s63
    v_mfma_f32_16x16x32_bf16 v[164:167], v[212:215], v[136:139], v[164:167]
    s_bitset0_b32 s63, s33
    s_lshl_b32 s78, s33, 10
    v_mfma_f32_16x16x32_bf16 v[180:183], v[212:215], v[140:143], v[180:183]
    buffer_load_dwordx4 v[128:131], v25, s[20:23], s78 offen offset:0 sc1
    buffer_load_dwordx4 v[132:135], v26, s[20:23], s78 offen offset:0 sc1
    s_waitcnt vmcnt(8) lgkmcnt(8)
    v_mfma_f32_16x16x32_bf16 v[152:155], v[216:219], v[144:147], v[152:155]
    v_mad_u32_u24 v56, s76, 5, v24
    v_xor_b32 v58, 64, v56
    v_xor_b32 v57, 32, v56
    v_mfma_f32_16x16x32_bf16 v[168:171], v[216:219], v[148:151], v[168:171]
    v_xor_b32 v59, 96, v56
    ds_read_b64_tr_b16 v[200:201], v56 offset:0
    ds_read_b64_tr_b16 v[202:203], v58 offset:2560
    v_mfma_f32_16x16x32_bf16 v[156:159], v[220:223], v[144:147], v[156:159]
    ds_read_b64_tr_b16 v[204:205], v57 offset:0
    ds_read_b64_tr_b16 v[206:207], v59 offset:2560
    ds_read_b64_tr_b16 v[208:209], v58 offset:0
    v_mfma_f32_16x16x32_bf16 v[172:175], v[220:223], v[148:151], v[172:175]
    ds_read_b64_tr_b16 v[210:211], v56 offset:2560
    ds_read_b64_tr_b16 v[212:213], v59 offset:0
    v_mfma_f32_16x16x32_bf16 v[160:163], v[224:227], v[144:147], v[160:163]
    ds_read_b64_tr_b16 v[214:215], v57 offset:2560
    s_cmp_eq_u32 s63, 0
    v_mfma_f32_16x16x32_bf16 v[176:179], v[224:227], v[148:151], v[176:179]
    s_cbranch_scc1 K_SP16
K_SPR16:
    s_ff1_i32_b32 s33, s63
    v_mfma_f32_16x16x32_bf16 v[164:167], v[228:231], v[144:147], v[164:167]
    s_bitset0_b32 s63, s33
    s_lshl_b32 s75, s33, 10
    v_mfma_f32_16x16x32_bf16 v[180:183], v[228:231], v[148:151], v[180:183]
    buffer_load_dwordx4 v[136:139], v25, s[20:23], s75 offen offset:0 sc1
    buffer_load_dwordx4 v[140:143], v26, s[20:23], s75 offen offset:0 sc1
    s_waitcnt vmcnt(8) lgkmcnt(8)
    v_mfma_f32_16x16x32_bf16 v[152:155], v[184:187], v[104:107], v[152:155]
    v_mad_u32_u24 v56, s77, 5, v24
    v_xor_b32 v58, 64, v56
    v_xor_b32 v57, 32, v56
    v_mfma_f32_16x16x32_bf16 v[168:171], v[184:187], v[108:111], v[168:171]
    v_xor_b32 v59, 96, v56
    ds_read_b64_tr_b16 v[216:217], v56 offset:0
    ds_read_b64_tr_b16 v[218:219], v58 offset:2560
    v_mfma_f32_16x16x32_bf16 v[156:159], v[188:191], v[104:107], v[156:159]
    ds_read_b64_tr_b16 v[220:221], v57 offset:0
    ds_read_b64_tr_b16 v[222:223], v59 offset:2560
    ds_read_b64_tr_b16 v[224:225], v58 offset:0
    v_mfma_f32_16x16x32_bf16 v[172:175], v[188:191], v[108:111], v[172:175]
    ds_read_b64_tr_b16 v[226:227], v56 offset:2560
    ds_read_b64_tr_b16 v[228:229], v59 offset:0
    v_mfma_f32_16x16x32_bf16 v[160:163], v[192:195], v[104:107], v[160:163]
    ds_read_b64_tr_b16 v[230:231], v57 offset:2560
    s_andn2_b32 s33, s66, s63
    v_mfma_f32_16x16x32_bf16 v[176:179], v[192:195], v[108:111], v[176:179]
    s_bfe_u32 s33, s33, 0x40008
    s_cmp_eq_u32 s33, 15
    v_mfma_f32_16x16x32_bf16 v[164:167], v[196:199], v[104:107], v[164:167]
    s_cselect_b32 s76, 0, 1024
    s_xor_b32 s69, s76, 1024
    v_mfma_f32_16x16x32_bf16 v[180:183], v[196:199], v[108:111], v[180:183]
    buffer_load_dwordx4 v[144:147], v35, s[20:23], s76 offen offset:2048 sc1
    buffer_load_dwordx4 v[148:151], v36, s[20:23], s76 offen offset:2048 sc1
    s_waitcnt vmcnt(8) lgkmcnt(8)
    v_mfma_f32_16x16x32_bf16 v[152:155], v[200:203], v[112:115], v[152:155]
    v_mad_u32_u24 v56, s78, 5, v24
    v_xor_b32 v58, 64, v56
    v_xor_b32 v57, 32, v56
    v_mfma_f32_16x16x32_bf16 v[168:171], v[200:203], v[116:119], v[168:171]
    v_xor_b32 v59, 96, v56
    ds_read_b64_tr_b16 v[184:185], v56 offset:0
    ds_read_b64_tr_b16 v[186:187], v58 offset:2560
    v_mfma_f32_16x16x32_bf16 v[156:159], v[204:207], v[112:115], v[156:159]
    ds_read_b64_tr_b16 v[188:189], v57 offset:0
    ds_read_b64_tr_b16 v[190:191], v59 offset:2560
    ds_read_b64_tr_b16 v[192:193], v58 offset:0
    v_mfma_f32_16x16x32_bf16 v[172:175], v[204:207], v[116:119], v[172:175]
    ds_read_b64_tr_b16 v[194:195], v56 offset:2560
    ds_read_b64_tr_b16 v[196:197], v59 offset:0
    v_mfma_f32_16x16x32_bf16 v[160:163], v[208:211], v[112:115], v[160:163]
    ds_read_b64_tr_b16 v[198:199], v57 offset:2560
    s_cmp_eq_u32 s63, 0
    v_mfma_f32_16x16x32_bf16 v[176:179], v[208:211], v[116:119], v[176:179]
    s_cbranch_scc1 K_SP18
K_SPR18:
    s_ff1_i32_b32 s33, s63
    v_mfma_f32_16x16x32_bf16 v[164:167], v[212:215], v[112:115], v[164:167]
    s_bitset0_b32 s63, s33
    s_lshl_b32 s77, s33, 10
    v_mfma_f32_16x16x32_bf16 v[180:183], v[212:215], v[116:119], v[180:183]
    buffer_load_dwordx4 v[104:107], v25, s[20:23], s77 offen offset:0 sc1
    buffer_load_dwordx4 v[108:111], v26, s[20:23], s77 offen offset:0 sc1
    s_waitcnt vmcnt(8) lgkmcnt(8)
    v_mfma_f32_16x16x32_bf16 v[152:155], v[216:219], v[120:123], v[152:155]
    v_mad_u32_u24 v56, s75, 5, v24
    v_xor_b32 v58, 64, v56
    v_mfma_f32_16x16x32_bf16 v[168:171], v[216:219], v[124:127], v[168:171]
    v_xor_b32 v57, 32, v56
    v_xor_b32 v59, 96, v56
    v_mfma_f32_16x16x32_bf16 v[156:159], v[220:223], v[120:123], v[156:159]
    ds_read_b64_tr_b16 v[200:201], v56 offset:0
    ds_read_b64_tr_b16 v[202:203], v58 offset:2560
    v_mfma_f32_16x16x32_bf16 v[172:175], v[220:223], v[124:127], v[172:175]
    ds_read_b64_tr_b16 v[204:205], v57 offset:0
    ds_read_b64_tr_b16 v[206:207], v59 offset:2560
    v_mfma_f32_16x16x32_bf16 v[160:163], v[224:227], v[120:123], v[160:163]
    ds_read_b64_tr_b16 v[208:209], v58 offset:0
    ds_read_b64_tr_b16 v[210:211], v56 offset:2560
    v_mfma_f32_16x16x32_bf16 v[176:179], v[224:227], v[124:127], v[176:179]
    ds_read_b64_tr_b16 v[212:213], v59 offset:0
    ds_read_b64_tr_b16 v[214:215], v57 offset:2560
    v_mfma_f32_16x16x32_bf16 v[164:167], v[228:231], v[120:123], v[164:167]
    buffer_load_dwordx4 v[112:115], v35, s[20:23], s69 offen offset:2048 sc1
    buffer_load_dwordx4 v[116:119], v36, s[20:23], s69 offen offset:2048 sc1
    v_mfma_f32_16x16x32_bf16 v[180:183], v[228:231], v[124:127], v[180:183]
    s_waitcnt vmcnt(8) lgkmcnt(8)
    v_mfma_f32_16x16x32_bf16 v[152:155], v[184:187], v[128:131], v[152:155]
    v_mad_u32_u24 v56, s76, 20, v60
    v_xor_b32 v58, 64, v56
    v_mfma_f32_16x16x32_bf16 v[168:171], v[184:187], v[132:135], v[168:171]
    v_xor_b32 v57, 32, v56
    v_xor_b32 v59, 96, v56
    v_mfma_f32_16x16x32_bf16 v[156:159], v[188:191], v[128:131], v[156:159]
    ds_read_b64_tr_b16 v[216:217], v56 offset:40960
    ds_read_b64_tr_b16 v[218:219], v58 offset:43520
    v_mfma_f32_16x16x32_bf16 v[172:175], v[188:191], v[132:135], v[172:175]
    ds_read_b64_tr_b16 v[220:221], v57 offset:40960
    ds_read_b64_tr_b16 v[222:223], v59 offset:43520
    v_mfma_f32_16x16x32_bf16 v[160:163], v[192:195], v[128:131], v[160:163]
    ds_read_b64_tr_b16 v[224:225], v58 offset:40960
    ds_read_b64_tr_b16 v[226:227], v56 offset:43520
    v_mfma_f32_16x16x32_bf16 v[176:179], v[192:195], v[132:135], v[176:179]
    ds_read_b64_tr_b16 v[228:229], v59 offset:40960
    ds_read_b64_tr_b16 v[230:231], v57 offset:43520
    v_mfma_f32_16x16x32_bf16 v[164:167], v[196:199], v[128:131], v[164:167]
    v_mfma_f32_16x16x32_bf16 v[180:183], v[196:199], v[132:135], v[180:183]
    s_waitcnt vmcnt(6) lgkmcnt(8)
    v_mfma_f32_16x16x32_bf16 v[152:155], v[200:203], v[136:139], v[152:155]
    v_mad_u32_u24 v56, s77, 5, v24
    v_xor_b32 v58, 64, v56
    v_mfma_f32_16x16x32_bf16 v[168:171], v[200:203], v[140:143], v[168:171]
    v_xor_b32 v57, 32, v56
    v_xor_b32 v59, 96, v56
    v_mfma_f32_16x16x32_bf16 v[156:159], v[204:207], v[136:139], v[156:159]
    ds_read_b64_tr_b16 v[184:185], v56 offset:0
    ds_read_b64_tr_b16 v[186:187], v58 offset:2560
    v_mfma_f32_16x16x32_bf16 v[172:175], v[204:207], v[140:143], v[172:175]
    ds_read_b64_tr_b16 v[188:189], v57 offset:0
    ds_read_b64_tr_b16 v[190:191], v59 offset:2560
    v_mfma_f32_16x16x32_bf16 v[160:163], v[208:211], v[136:139], v[160:163]
    ds_read_b64_tr_b16 v[192:193], v58 offset:0
    ds_read_b64_tr_b16 v[194:195], v56 offset:2560
    v_mfma_f32_16x16x32_bf16 v[176:179], v[208:211], v[140:143], v[176:179]
    ds_read_b64_tr_b16 v[196:197], v59 offset:0
    ds_read_b64_tr_b16 v[198:199], v57 offset:2560
    v_mfma_f32_16x16x32_bf16 v[164:167], v[212:215], v[136:139], v[164:167]
    v_mfma_f32_16x16x32_bf16 v[180:183], v[212:215], v[140:143], v[180:183]
    s_waitcnt vmcnt(4) lgkmcnt(8)
    v_mfma_f32_16x16x32_bf16 v[152:155], v[216:219], v[144:147], v[152:155]
    v_mad_u32_u24 v56, s69, 20, v60
    v_xor_b32 v58, 64, v56
    v_mfma_f32_16x16x32_bf16 v[168:171], v[216:219], v[148:151], v[168:171]
    v_xor_b32 v57, 32, v56
    v_xor_b32 v59, 96, v56
    v_mfma_f32_16x16x32_bf16 v[156:159], v[220:223], v[144:147], v[156:159]
    ds_read_b64_tr_b16 v[200:201], v56 offset:40960
    ds_read_b64_tr_b16 v[202:203], v58 offset:43520
    v_mfma_f32_16x16x32_bf16 v[172:175], v[220:223], v[148:151], v[172:175]
    ds_read_b64_tr_b16 v[204:205], v57 offset:40960
    ds_read_b64_tr_b16 v[206:207], v59 offset:43520
    v_mfma_f32_16x16x32_bf16 v[160:163], v[224:227], v[144:147], v[160:163]
    ds_read_b64_tr_b16 v[208:209], v58 offset:40960
    ds_read_b64_tr_b16 v[210:211], v56 offset:43520
    v_mfma_f32_16x16x32_bf16 v[176:179], v[224:227], v[148:151], v[176:179]
    ds_read_b64_tr_b16 v[212:213], v59 offset:40960
    ds_read_b64_tr_b16 v[214:215], v57 offset:43520
    v_mfma_f32_16x16x32_bf16 v[164:167], v[228:231], v[144:147], v[164:167]
    v_mfma_f32_16x16x32_bf16 v[180:183], v[228:231], v[148:151], v[180:183]
    s_waitcnt vmcnt(2) lgkmcnt(8)
    v_mfma_f32_16x16x32_bf16 v[152:155], v[184:187], v[104:107], v[152:155]
    v_mfma_f32_16x16x32_bf16 v[156:159], v[188:191], v[104:107], v[156:159]
    v_mfma_f32_16x16x32_bf16 v[160:163], v[192:195], v[104:107], v[160:163]
    v_mfma_f32_16x16x32_bf16 v[164:167], v[196:199], v[104:107], v[164:167]
    s_sub_u32 s59, s56, s58
    s_cmp_lt_u32 s59, 32
    s_cbranch_scc1 K_YROW0
K_NOY0:
    s_sub_u32 s59, s57, s58
    s_cmp_lt_u32 s59, 32
    s_cbranch_scc1 K_YROW1
K_NOY1:
    s_waitcnt vmcnt(0) lgkmcnt(0)
    v_mfma_f32_16x16x32_bf16 v[152:155], v[200:203], v[112:115], v[152:155]
    v_mfma_f32_16x16x32_bf16 v[156:159], v[204:207], v[112:115], v[156:159]
    v_mfma_f32_16x16x32_bf16 v[160:163], v[208:211], v[112:115], v[160:163]
    v_mfma_f32_16x16x32_bf16 v[164:167], v[212:215], v[112:115], v[164:167]
    v_mfma_f32_16x16x32_bf16 v[168:171], v[184:187], v[108:111], v[168:171]
    v_mfma_f32_16x16x32_bf16 v[172:175], v[188:191], v[108:111], v[172:175]
    v_mfma_f32_16x16x32_bf16 v[176:179], v[192:195], v[108:111], v[176:179]
    s_nop 1
    v_fma_f32 v152, v152, v64, v72
    v_fma_f32 v153, v153, v64, v73
    v_fma_f32 v154, v154, v64, v74
    v_mfma_f32_16x16x32_bf16 v[180:183], v[196:199], v[108:111], v[180:183]
    v_fma_f32 v155, v155, v64, v75
    v_cvt_pk_bf16_f32 v40, v152, v153
    v_cvt_pk_bf16_f32 v41, v154, v155
    v_mfma_f32_16x16x32_bf16 v[168:171], v[200:203], v[116:119], v[168:171]
    v_fma_f32 v156, v156, v64, v76
    v_fma_f32 v157, v157, v64, v77
    ds_write_b64 v29, v[40:41] offset:0
    v_mfma_f32_16x16x32_bf16 v[172:175], v[204:207], v[116:119], v[172:175]
    v_fma_f32 v158, v158, v64, v78
    v_fma_f32 v159, v159, v64, v79
    v_cvt_pk_bf16_f32 v42, v156, v157
    v_mfma_f32_16x16x32_bf16 v[176:179], v[208:211], v[116:119], v[176:179]
    v_cvt_pk_bf16_f32 v43, v158, v159
    v_fma_f32 v160, v160, v64, v80
    v_fma_f32 v161, v161, v64, v81
    v_mfma_f32_16x16x32_bf16 v[180:183], v[212:215], v[116:119], v[180:183]
    ds_write_b64 v30, v[42:43] offset:0
    v_fma_f32 v162, v162, v64, v82
    v_fma_f32 v163, v163, v64, v83
    v_cvt_pk_bf16_f32 v44, v160, v161
    v_cvt_pk_bf16_f32 v45, v162, v163
    v_pk_fma_f32 v[164:165], v[164:165], v[64:65], v[84:85] op_sel_hi:[1,0,1]
    v_pk_fma_f32 v[166:167], v[166:167], v[64:65], v[86:87] op_sel_hi:[1,0,1]
    ds_write_b64 v31, v[44:45] offset:0
    v_cvt_pk_bf16_f32 v46, v164, v165
    v_cvt_pk_bf16_f32 v47, v166, v167
    ds_write_b64 v32, v[46:47] offset:0
    ds_read_b128 v[72:75], v33 offset:0
    ds_read_b128 v[76:79], v33 offset:1024
    v_pk_fma_f32 v[168:169], v[168:169], v[66:67], v[88:89] op_sel_hi:[1,0,1]
    v_pk_fma_f32 v[170:171], v[170:171], v[66:67], v[90:91] op_sel_hi:[1,0,1]
    v_cvt_pk_bf16_f32 v48, v168, v169
    v_cvt_pk_bf16_f32 v49, v170, v171
    v_pk_fma_f32 v[172:173], v[172:173], v[66:67], v[92:93] op_sel_hi:[1,0,1]
    v_pk_fma_f32 v[174:175], v[174:175], v[66:67], v[94:95] op_sel_hi:[1,0,1]
    v_cvt_pk_bf16_f32 v50, v172, v173
    v_cvt_pk_bf16_f32 v51, v174, v175
    v_pk_fma_f32 v[176:177], v[176:177], v[66:67], v[96:97] op_sel_hi:[1,0,1]
    v_pk_fma_f32 v[178:179], v[178:179], v[66:67], v[98:99] op_sel_hi:[1,0,1]
    v_cvt_pk_bf16_f32 v52, v176, v177
    v_cvt_pk_bf16_f32 v53, v178, v179
    v_pk_fma_f32 v[180:181], v[180:181], v[66:67], v[100:101] op_sel_hi:[1,0,1]
    v_pk_fma_f32 v[182:183], v[182:183], v[66:67], v[102:103] op_sel_hi:[1,0,1]
    v_cvt_pk_bf16_f32 v54, v180, v181
    v_cvt_pk_bf16_f32 v55, v182, v183
    s_waitcnt lgkmcnt(0)
    buffer_store_dwordx4 v[72:75], v27, s[48:51], s71 offen sc1
    buffer_store_dwordx4 v[76:79], v28, s[48:51], s72 offen sc1
    ds_write_b64 v29, v[48:49] offset:2048
    ds_write_b64 v30, v[50:51] offset:2048
    ds_write_b64 v31, v[52:53] offset:2048
    ds_write_b64 v32, v[54:55] offset:2048
    ds_read_b128 v[88:91], v33 offset:2048
    ds_read_b128 v[92:95], v33 offset:3072
    s_waitcnt lgkmcnt(1)
    buffer_store_dwordx4 v[88:91], v27, s[48:51], s73 offen sc1
    s_waitcnt lgkmcnt(0)
    buffer_store_dwordx4 v[92:95], v28, s[48:51], s74 offen sc1
K_END:
K_EXIT:
    s_endpgm
.p2align 12
WP_spin:
    s_setpc_b64 s[38:39]
K_SP0:
    ds_read_b32 v2, v12 offset:32
    s_waitcnt lgkmcnt(0)
    v_readfirstlane_b32 s33, v2
    s_nop 3
    s_lshr_b32 s63, s33, s64
    s_lshr_b32 s33, s33, s65
    s_and_b32 s63, s63, s33
    s_and_b32 s63, s63, 0xff
    s_andn2_b32 s63, s63, s66
    s_cbranch_scc0 K_SP0
    s_or_b32 s66, s66, s63
    s_branch K_SPR0
K_SP1:
    ds_read_b32 v2, v12 offset:32
    s_waitcnt lgkmcnt(0)
    v_readfirstlane_b32 s33, v2
    s_nop 3
    s_lshr_b32 s63, s33, s64
    s_lshr_b32 s33, s33, s65
    s_and_b32 s63, s63, s33
    s_and_b32 s63, s63, 0xff
    s_andn2_b32 s63, s63, s66
    s_cbranch_scc0 K_SP1
    s_or_b32 s66, s66, s63
    s_branch K_SPR1
K_SP2:
    ds_read_b32 v2, v12 offset:32
    s_waitcnt lgkmcnt(0)
    v_readfirstlane_b32 s33, v2
    s_nop 3
    s_lshr_b32 s63, s33, s64
    s_lshr_b32 s33, s33, s65
    s_and_b32 s63, s63, s33
    s_and_b32 s63, s63, 0xff
    s_andn2_b32 s63, s63, s66
    s_cbranch_scc0 K_SP2
    s_or_b32 s66, s66, s63
    s_branch K_SPR2
K_SP3:
    ds_read_b32 v2, v12 offset:32
    s_waitcnt lgkmcnt(0)
    v_readfirstlane_b32 s33, v2
    s_nop 3
    s_lshr_b32 s63, s33, s64
    s_lshr_b32 s33, s33, s65
    s_and_b32 s63, s63, s33
    s_and_b32 s63, s63, 0xff
    s_andn2_b32 s63, s63, s66
    s_cbranch_scc0 K_SP3
    s_or_b32 s66, s66, s63
    s_branch K_SPR3
K_SP4:
    ds_read_b32 v2, v12 offset:32
    s_waitcnt lgkmcnt(0)
    v_readfirstlane_b32 s33, v2
    s_nop 3
    s_lshr_b32 s63, s33, s64
    s_lshr_b32 s33, s33, s65
    s_and_b32 s63, s63, s33
    s_and_b32 s63, s63, 0xff
    s_andn2_b32 s63, s63, s66
    s_cbranch_scc0 K_SP4
    s_or_b32 s66, s66, s63
    s_branch K_SPR4
K_SP5:
    ds_read_b32 v2, v12 offset:32
    s_waitcnt lgkmcnt(0)
    v_readfirstlane_b32 s33, v2
    s_nop 3
    s_lshr_b32 s63, s33, s64
    s_lshr_b32 s33, s33, s65
    s_and_b32 s63, s63, s33
    s_and_b32 s63, s63, 0xff
    s_andn2_b32 s63, s63, s66
    s_cbranch_scc0 K_SP5
    s_or_b32 s66, s66, s63
    s_branch K_SPR5
K_SP6:
    ds_read_b32 v2, v12 offset:32
    s_waitcnt lgkmcnt(0)
    v_readfirstlane_b32 s33, v2
    s_nop 3
    s_lshr_b32 s63, s33, s64
    s_lshr_b32 s33, s33, s65
    s_and_b32 s63, s63, s33
    s_and_b32 s63, s63, 0xff
    s_andn2_b32 s63, s63, s66
    s_cbranch_scc0 K_SP6
    s_or_b32 s66, s66, s63
    s_branch K_SPR6
K_SP8:
    ds_read_b32 v2, v12 offset:32
    s_waitcnt lgkmcnt(0)
    v_readfirstlane_b32 s33, v2
    s_nop 3
    s_lshr_b32 s63, s33, s64
    s_lshr_b32 s33, s33, s65
    s_and_b32 s63, s63, s33
    s_and_b32 s63, s63, 0xff
    s_andn2_b32 s63, s63, s66
    s_cbranch_scc0 K_SP8
    s_or_b32 s66, s66, s63
    s_branch K_SPR8
K_SP10:
    ds_read_b32 v2, v12 offset:32
    s_waitcnt lgkmcnt(0)
    v_readfirstlane_b32 s33, v2
    s_nop 3
    s_lshr_b32 s63, s33, s64
    s_lshr_b32 s33, s33, s65
    s_and_b32 s63, s63, s33
    s_and_b32 s63, s63, 0xff00
    s_andn2_b32 s63, s63, s66
    s_cbranch_scc0 K_SP10
    s_or_b32 s66, s66, s63
    s_branch K_SPR10
K_SP11:
    ds_read_b32 v2, v12 offset:32
    s_waitcnt lgkmcnt(0)
    v_readfirstlane_b32 s33, v2
    s_nop 3
    s_lshr_b32 s63, s33, s64
    s_lshr_b32 s33, s33, s65
    s_and_b32 s63, s63, s33
    s_and_b32 s63, s63, 0xff00
    s_andn2_b32 s63, s63, s66
    s_cbranch_scc0 K_SP11
    s_or_b32 s66, s66, s63
    s_branch K_SPR11
K_SP12:
    ds_read_b32 v2, v12 offset:32
    s_waitcnt lgkmcnt(0)
    v_readfirstlane_b32 s33, v2
    s_nop 3
    s_lshr_b32 s63, s33, s64
    s_lshr_b32 s33, s33, s65
    s_and_b32 s63, s63, s33
    s_and_b32 s63, s63, 0xff00
    s_andn2_b32 s63, s63, s66
    s_cbranch_scc0 K_SP12
    s_or_b32 s66, s66, s63
    s_branch K_SPR12
K_SP13:
    ds_read_b32 v2, v12 offset:32
    s_waitcnt lgkmcnt(0)
    v_readfirstlane_b32 s33, v2
    s_nop 3
    s_lshr_b32 s63, s33, s64
    s_lshr_b32 s33, s33, s65
    s_and_b32 s63, s63, s33
    s_and_b32 s63, s63, 0xff00
    s_andn2_b32 s63, s63, s66
    s_cbranch_scc0 K_SP13
    s_or_b32 s66, s66, s63
    s_branch K_SPR13
K_SP14:
    ds_read_b32 v2, v12 offset:32
    s_waitcnt lgkmcnt(0)
    v_readfirstlane_b32 s33, v2
    s_nop 3
    s_lshr_b32 s63, s33, s64
    s_lshr_b32 s33, s33, s65
    s_and_b32 s63, s63, s33
    s_and_b32 s63, s63, 0xff00
    s_andn2_b32 s63, s63, s66
    s_cbranch_scc0 K_SP14
    s_or_b32 s66, s66, s63
    s_branch K_SPR14
K_SP15:
    ds_read_b32 v2, v12 offset:32
    s_waitcnt lgkmcnt(0)
    v_readfirstlane_b32 s33, v2
    s_nop 3
    s_lshr_b32 s63, s33, s64
    s_lshr_b32 s33, s33, s65
    s_and_b32 s63, s63, s33
    s_and_b32 s63, s63, 0xff00
    s_andn2_b32 s63, s63, s66
    s_cbranch_scc0 K_SP15
    s_or_b32 s66, s66, s63
    s_branch K_SPR15
K_SP16:
    ds_read_b32 v2, v12 offset:32
    s_waitcnt lgkmcnt(0)
    v_readfirstlane_b32 s33, v2
    s_nop 3
    s_lshr_b32 s63, s33, s64
    s_lshr_b32 s33, s33, s65
    s_and_b32 s63, s63, s33
    s_and_b32 s63, s63, 0xff00
    s_andn2_b32 s63, s63, s66
    s_cbranch_scc0 K_SP16
    s_or_b32 s66, s66, s63
    s_branch K_SPR16
K_SP18:
    ds_read_b32 v2, v12 offset:32
    s_waitcnt lgkmcnt(0)
    v_readfirstlane_b32 s33, v2
    s_nop 3
    s_lshr_b32 s63, s33, s64
    s_lshr_b32 s33, s33, s65
    s_and_b32 s63, s63, s33
    s_and_b32 s63, s63, 0xff00
    s_andn2_b32 s63, s63, s66
    s_cbranch_scc0 K_SP18
    s_or_b32 s66, s66, s63
    s_branch K_SPR18
WP_yr0:
    s_setpc_b64 s[38:39]
K_YROW0:
    v_lshlrev_b32 v5, 4, v9
    v_add_u32 v5, 158976, v5
    v_and_b32 v3, 15, v1
    s_and_b32 s33, s59, 15
    v_cmp_eq_u32 vcc, s33, v3
    s_mov_b32 s3, 1048576
K_P2_GY0:
    ds_read_b32 v2, v12 offset:64
    s_sub_u32 s3, s3, 1
    s_waitcnt lgkmcnt(0)
    v_readfirstlane_b32 s33, v2
    s_nop 3
    s_cselect_b32 s33, 1, s33
    s_cmp_lt_u32 s33, 1
    s_cbranch_scc1 K_P2_GY0
    s_mov_b64 exec, vcc
    s_cmp_ge_u32 s59, 16
    s_cbranch_scc1 K_YR1_0
    ds_read_b128 v[72:75], v5 offset:0
    ds_read_b128 v[76:79], v5 offset:64
    ds_read_b128 v[80:83], v5 offset:128
    ds_read_b128 v[84:87], v5 offset:192
    s_mov_b64 exec, -1
    s_branch K_NOY0
K_YR1_0:
    ds_read_b128 v[88:91], v5 offset:0
    ds_read_b128 v[92:95], v5 offset:64
    ds_read_b128 v[96:99], v5 offset:128
    ds_read_b128 v[100:103], v5 offset:192
    s_mov_b64 exec, -1
    s_branch K_NOY0
K_YROW1:
    v_lshlrev_b32 v5, 4, v9
    v_add_u32 v5, 159232, v5
    v_and_b32 v3, 15, v1
    s_and_b32 s33, s59, 15
    v_cmp_eq_u32 vcc, s33, v3
    s_mov_b32 s3, 1048576
K_P2_GY1:
    ds_read_b32 v2, v12 offset:68
    s_sub_u32 s3, s3, 1
    s_waitcnt lgkmcnt(0)
    v_readfirstlane_b32 s33, v2
    s_nop 3
    s_cselect_b32 s33, 1, s33
    s_cmp_lt_u32 s33, 1
    s_cbranch_scc1 K_P2_GY1
    s_mov_b64 exec, vcc
    s_cmp_ge_u32 s59, 16
    s_cbranch_scc1 K_YR1_1
    ds_read_b128 v[72:75], v5 offset:0
    ds_read_b128 v[76:79], v5 offset:64
    ds_read_b128 v[80:83], v5 offset:128
    ds_read_b128 v[84:87], v5 offset:192
    s_mov_b64 exec, -1
    s_branch K_NOY1
K_YR1_1:
    ds_read_b128 v[88:91], v5 offset:0
    ds_read_b128 v[92:95], v5 offset:64
    ds_read_b128 v[96:99], v5 offset:128
    ds_read_b128 v[100:103], v5 offset:192
    s_mov_b64 exec, -1
    s_branch K_NOY1
.p2align 12
WP_gen:
    s_setpc_b64 s[38:39]
K_P2:
    s_cmp_ge_u32 s30, 4
    s_cbranch_scc1 K_P2_HELP
    v_mov_b32 v12, 158720
    s_cmp_lg_u32 s30, 0
    s_cbranch_scc1 K_P2_W13
    v_lshrrev_b32 v3, 4, v1
    v_and_b32 v4, 7, v1
    v_lshrrev_b32 v2, 3, v1
    v_xor_b32 v4, v4, v3
    v_mul_u32_u24 v2, 1280, v2
    v_lshl_add_u32 v27, v4, 4, v2
    v_xor_b32 v28, 64, v27
    s_mov_b32 s58, 0
K_P2_XD:
    s_lshl_b32 s59, s40, 3
    s_lshl1_add_u32 s59, s58, s59
    s_mul_i32 s59, s59, 20480
    s_lshl_b32 s33, s41, 7
    s_add_u32 s59, s59, s33
    s_lshl_b32 s33, s58, 12
    s_add_u32 m0, s33, 140288
    s_add_u32 s3, s59, 0
    buffer_load_dwordx4 v27, s[12:15], s3 offen lds
    s_add_u32 m0, s33, 141312
    s_add_u32 s3, s59, 10240
    buffer_load_dwordx4 v28, s[12:15], s3 offen lds
    s_add_u32 m0, s33, 142336
    s_add_u32 s3, s59, 20480
    buffer_load_dwordx4 v27, s[12:15], s3 offen lds
    s_add_u32 m0, s33, 143360
    s_add_u32 s3, s59, 30720
    buffer_load_dwordx4 v28, s[12:15], s3 offen lds
    s_add_u32 s58, s58, 1
    s_cmp_lt_u32 s58, 4
    s_cbranch_scc1 K_P2_XD
    s_waitcnt vmcnt(0)
    s_branch K_P2_AUXW
K_P2_W13:
    v_lshrrev_b32 v2, 3, v1
    v_mul_u32_u24 v2, 1280, v2
    v_lshrrev_b32 v3, 4, v1
    v_lshlrev_b32 v3, 1, v3
    v_and_b32 v4, 7, v1
    v_xor_b32 v3, v3, v4
    v_lshl_add_u32 v2, v3, 4, v2
    s_lshl_b32 s33, s41, 7
    v_add_u32 v22, s33, v2
    s_mov_b32 s60, 0xfda87520
    s_mov_b32 s61, 0xecb96431
    s_sub_u32 s58, s30, 1
K_P2_WS:
    s_lshl_b32 s3, s58, 2
    s_lshr_b64 s[4:5], s[60:61], s3
    s_and_b32 s4, s4, 15
    s_mul_i32 s4, s4, 51200
    s_mul_i32 s59, s58, 5120
    s_add_u32 s52, s4, 0
    s_add_u32 m0, s59, 0
    s_waitcnt vmcnt(11)
    buffer_load_dwordx4 v22, s[24:27], s52 offen lds
    s_add_u32 s52, s4, 10240
    s_add_u32 m0, s59, 1024
    s_waitcnt vmcnt(11)
    buffer_load_dwordx4 v22, s[24:27], s52 offen lds
    s_add_u32 s52, s4, 20480
    s_add_u32 m0, s59, 2048
    s_waitcnt vmcnt(11)
    buffer_load_dwordx4 v22, s[24:27], s52 offen lds
    s_add_u32 s52, s4, 30720
    s_add_u32 m0, s59, 3072
    s_waitcnt vmcnt(11)
    buffer_load_dwordx4 v22, s[24:27], s52 offen lds
    s_add_u32 s52, s4, 40960
    s_add_u32 m0, s59, 4096
    s_waitcnt vmcnt(11)
    buffer_load_dwordx4 v22, s[24:27], s52 offen lds
    s_cmp_ge_u32 s58, 3
    s_cbranch_scc1 K_P2_WS1
    v_mov_b32 v3, 1
    s_waitcnt vmcnt(5)
    s_mov_b64 exec, 1
    ds_add_u32 v12, v3 offset:52
    s_mov_b64 exec, -1
K_P2_WS1:
    s_add_u32 s58, s58, 3
    s_cmp_lt_u32 s58, 16
    s_cbranch_scc1 K_P2_WS
K_P2_AUXW:
    v_mov_b32 v34, 1
    s_waitcnt vmcnt(10)
    s_mov_b64 exec, 1
    ds_add_u32 v12, v34 offset:72
    s_mov_b64 exec, -1
    s_lshl_b32 s54, s40, 7
    v_lshrrev_b32 v9, 4, v1
    v_mov_b32 v12, 158720
    s_add_u32 s20, s10, 0x100000
    s_addc_u32 s21, s11, 0
    s_mov_b32 s22, 0x280000
    s_mov_b32 s23, 0x20000
    s_add_u32 s16, s10, 0x1000
    s_addc_u32 s17, s11, 0
    s_mov_b32 s18, 0x2000
    s_mov_b32 s19, 0x20000
    s_mov_b32 s48, s6
    s_mov_b32 s49, s7
    s_mov_b32 s50, 0x280000
    s_mov_b32 s51, 0x20000
    s_lshl_b32 s53, s40, 3
    s_lshl1_add_u32 s53, s30, s53
    s_mov_b32 s55, 20480
    v_bfe_u32 v20, v1, 2, 2
    v_and_b32 v21, 3, v1
    s_mul_i32 s3, s53, 20480
    v_lshl_add_u32 v25, v1, 4, s3
    v_add_u32 v26, 20480, v25
    v_add_u32 v35, 16384, v25
    v_add_u32 v36, 16384, v26
    v_and_b32 v2, 15, v1
    s_lshl_b32 s3, s53, 6
    v_lshl_add_u32 v23, v2, 2, s3
    v_lshl_add_u32 v2, v9, 2, v20
    v_bfe_u32 v3, v2, 1, 2
    v_lshlrev_b32 v2, 7, v2
    v_lshl_add_u32 v2, v21, 3, v2
    v_lshl_add_u32 v24, v3, 5, v2
    v_lshrrev_b32 v3, 1, v20
    v_mul_u32_u24 v2, 40, v9
    v_add3_u32 v2, v2, 16, v20
    v_lshlrev_b32 v2, 7, v2
    v_lshl_add_u32 v2, v21, 3, v2
    v_xor_b32 v4, 0, v3
    v_lshl_add_u32 v60, v4, 5, v2
    v_xor_b32 v4, 1, v3
    v_lshl_add_u32 v61, v4, 5, v2
    v_xor_b32 v4, 2, v3
    v_lshl_add_u32 v62, v4, 5, v2
    v_xor_b32 v4, 3, v3
    v_lshl_add_u32 v63, v4, 5, v2
    v_lshrrev_b32 v3, 4, v1
    v_and_b32 v4, 7, v1
    v_lshrrev_b32 v2, 3, v1
    v_xor_b32 v4, v4, v3
    v_mul_u32_u24 v2, 1280, v2
    v_lshl_add_u32 v27, v4, 4, v2
    v_xor_b32 v28, 64, v27
    s_lshl_b32 s71, s40, 3
    s_lshl1_add_u32 s71, s30, s71
    s_mul_i32 s71, s71, 20480
    s_lshl_b32 s33, s41, 7
    s_add_u32 s71, s71, s33
    s_add_u32 s72, s71, 10240
    s_add_u32 s73, s71, 20480
    s_add_u32 s74, s71, 30720
    s_lshl_b32 s3, s30, 12
    s_add_u32 s3, s3, 140288
    v_lshl_add_u32 v33, v1, 4, s3
    v_and_b32 v2, 15, v1
    v_lshrrev_b32 v3, 1, v2
    v_lshrrev_b32 v4, 5, v1
    v_xor_b32 v3, v3, v4
    v_lshlrev_b32 v3, 4, v3
    v_lshl_add_u32 v3, v2, 7, v3
    v_and_b32 v4, 1, v9
    v_lshl_add_u32 v3, v4, 3, v3
    v_add_u32 v29, s3, v3
    v_xor_b32 v30, 32, v29
    v_xor_b32 v31, 64, v29
    v_xor_b32 v32, 96, v29
    s_and_b32 s33, s40, 3
    s_lshl_b32 s33, s33, 3
    s_lshr_b32 s33, 0x7f06037f, s33
    s_and_b32 s33, s33, 0xff
    s_lshl_b32 s3, s30, 1
    s_cmp_ge_u32 s3, s33
    s_cselect_b32 s64, 16, 0
    s_add_u32 s3, s3, 1
    s_cmp_ge_u32 s3, s33
    s_cselect_b32 s65, 16, 0
    s_mov_b32 s63, 0
    s_mov_b32 s66, 0
    s_mov_b32 s67, 16384
    s_mov_b32 s3, 1048576
K_P2_GWA:
    ds_read_b32 v2, v12 offset:72
    s_sub_u32 s3, s3, 1
    s_waitcnt lgkmcnt(0)
    v_readfirstlane_b32 s33, v2
    s_nop 3
    s_cselect_b32 s33, 4, s33
    s_cmp_lt_u32 s33, 4
    s_cbranch_scc1 K_P2_GWA
    s_branch K_P2_GEMM
WP_help:
    s_setpc_b64 s[38:39]
K_LATE:
    v_mov_b32 v6, 158800
    s_mov_b32 s3, 1048576
K_XGL:
    ds_read_b128 v[2:5], v6
    s_sleep 1
    s_sub_u32 s3, s3, 1
    s_waitcnt lgkmcnt(0)
    v_min3_u32 v2, v2, v4, v5
    v_min_u32 v2, v2, v3
    s_nop 0
    v_readfirstlane_b32 s33, v2
    s_nop 3
    s_cselect_b32 s33, 1, s33
    s_cmp_lt_u32 s33, 1
    s_cbranch_scc1 K_XGL
    s_sub_u32 s44, s30, 4
K_WOL:
    s_lshl_b32 s50, s44, 2
    s_lshr_b32 s50, 0x6431, s50
    s_and_b32 s50, s50, 7
    s_mul_i32 s50, s50, 51200
    s_mul_i32 s51, s44, 5120
    s_add_u32 s3, s50, 0
    s_add_u32 m0, s51, 40960
    s_waitcnt vmcnt(13)
    buffer_load_dwordx4 v17, s[24:27], s3 offen lds
    s_add_u32 s3, s50, 10240
    s_add_u32 m0, s51, 41984
    s_waitcnt vmcnt(13)
    buffer_load_dwordx4 v17, s[24:27], s3 offen lds
    s_add_u32 s3, s50, 20480
    s_add_u32 m0, s51, 43008
    s_waitcnt vmcnt(13)
    buffer_load_dwordx4 v17, s[24:27], s3 offen lds
    s_add_u32 s3, s50, 30720
    s_add_u32 m0, s51, 44032
    s_waitcnt vmcnt(13)
    buffer_load_dwordx4 v17, s[24:27], s3 offen lds
    s_add_u32 s3, s50, 40960
    s_add_u32 m0, s51, 45056
    s_waitcnt vmcnt(13)
    buffer_load_dwordx4 v17, s[24:27], s3 offen lds
    s_add_u32 s3, s50, 409600
    s_add_u32 m0, s51, 61440
    s_waitcnt vmcnt(13)
    buffer_load_dwordx4 v17, s[24:27], s3 offen lds
    s_add_u32 s3, s50, 419840
    s_add_u32 m0, s51, 62464
    s_waitcnt vmcnt(13)
    buffer_load_dwordx4 v17, s[24:27], s3 offen lds
    s_add_u32 s3, s50, 430080
    s_add_u32 m0, s51, 63488
    s_waitcnt vmcnt(13)
    buffer_load_dwordx4 v17, s[24:27], s3 offen lds
    s_add_u32 s3, s50, 440320
    s_add_u32 m0, s51, 64512
    s_waitcnt vmcnt(13)
    buffer_load_dwordx4 v17, s[24:27], s3 offen lds
    s_add_u32 s3, s50, 450560
    s_add_u32 m0, s51, 65536
    s_waitcnt vmcnt(13)
    buffer_load_dwordx4 v17, s[24:27], s3 offen lds
    s_add_u32 s44, s44, 2
    s_cmp_lt_u32 s44, 4
    s_cbranch_scc1 K_WOL
    v_mov_b32 v2, 158720
    v_mov_b32 v3, 2
    s_waitcnt vmcnt(0)
    s_mov_b64 exec, 1
    ds_add_u32 v2, v3 offset:44
    s_mov_b64 exec, -1
K_P2_HELP:
    s_setprio 3
    s_add_u32 s59, s40, 1
    s_bitcmp1_b32 s59, 1
    s_cselect_b32 s59, 31, 15
    v_and_b32 v10, s59, v1
    v_lshl_add_u32 v10, v10, 2, s42
    s_cmp_lg_u32 s30, 7
    s_cbranch_scc1 K_P2_N7
    v_and_b32 v4, 7, v1
    v_lshlrev_b32 v4, 2, v4
    s_mov_b32 s3, 131072
K_ZPOLL1:
    v_cmp_eq_u32 vcc, 0, v7
    s_cbranch_vccz K_ZOK1
    s_sub_u32 s3, s3, 1
    s_cbranch_scc1 K_ZOK1
    global_load_dword v7, v4, s[8:9] offset:192 sc1
    s_waitcnt vmcnt(0)
    s_branch K_ZPOLL1
K_ZOK1:
    global_load_dword v7, v10, s[10:11] sc1
K_P2_N7:
    s_lshl_b32 s54, s40, 7
    v_lshrrev_b32 v9, 4, v1
    v_mov_b32 v12, 158720
    s_add_u32 s44, s10, 0x10000
    s_addc_u32 s45, s11, 0
    s_mov_b32 s46, 0x43800
    s_mov_b32 s47, 0x20000
    v_mov_b32 v80, 1
    s_cmp_eq_u32 s30, 7
    s_cbranch_scc1 K_P2_FLAGS
    s_cmp_lg_u32 s30, 6
    s_cbranch_scc1 K_END
    s_mov_b32 s3, 131072
K_P2_DPOLL:
    v_cmp_eq_u32 vcc, 0, v7
    s_cbranch_vccz K_P2_DOK
    s_cmp_eq_u32 s3, 131072
    s_cbranch_scc1 K_P2_DNS
    s_sleep 12
K_P2_DNS:
    v_and_b32 v11, 1, v1
    v_lshl_add_u32 v11, v11, 2, s42
    global_load_dword v7, v11, s[10:11] offset:128 sc1
    s_sub_u32 s3, s3, 1
    s_waitcnt vmcnt(0)
    s_cmp_lg_u32 s3, 0
    s_cbranch_scc1 K_P2_DPOLL
K_P2_DOK:
    v_readlane_b32 s58, v7, 0
    v_readlane_b32 s59, v7, 1
    s_nop 3
    s_and_b32 s3, s58, 0x7ff
    s_sub_u32 s3, 2047, s3
    v_mov_b32 v20, s3
    v_mov_b32 v4, s58
    v_and_b32 v4, 0xffff0000, v4
    v_ashrrev_i32 v5, 31, v4
    v_not_b32 v5, v5
    v_or_b32 v5, 0x80000000, v5
    v_xor_b32 v4, v4, v5
    v_and_b32 v4, 0xffff0000, v4
    v_mul_f32 v5, 0xbfb8aa3b, v4
    v_exp_f32 v5, v5
    s_nop 0
    v_add_f32 v5, 1.0, v5
    v_rcp_f32 v4, v5
    s_nop 0
    v_cvt_pk_bf16_f32 v22, v4, v4
    v_lshlrev_b32 v22, 16, v22
    s_and_b32 s3, s59, 0x7ff
    s_sub_u32 s3, 2047, s3
    v_mov_b32 v21, s3
    v_mov_b32 v4, s59
    v_and_b32 v4, 0xffff0000, v4
    v_ashrrev_i32 v5, 31, v4
    v_not_b32 v5, v5
    v_or_b32 v5, 0x80000000, v5
    v_xor_b32 v4, v4, v5
    v_and_b32 v4, 0xffff0000, v4
    v_mul_f32 v5, 0xbfb8aa3b, v4
    v_exp_f32 v5, v5
    s_nop 0
    v_add_f32 v5, 1.0, v5
    v_rcp_f32 v4, v5
    s_nop 0
    v_cvt_pk_bf16_f32 v23, v4, v4
    v_lshlrev_b32 v23, 16, v23
    ds_write_b128 v12, v[20:23]
    ds_write_b32 v12, v80 offset:40
    s_mov_b32 s53, 0
    v_mov_b32 v16, v20
    v_mov_b32 v17, v21
    v_mov_b32 v18, v22
    v_mov_b32 v19, v23
K_P2_HW:
    s_cmp_eq_u32 s53, 0
    s_cselect_b64 vcc, -1, 0
    s_nop 1
    v_cndmask_b32 v2, v17, v16, vcc
    v_cndmask_b32 v5, v19, v18, vcc
    s_nop 0
    v_readfirstlane_b32 s58, v2
    s_nop 3
    s_sub_u32 s3, s58, s54
    s_cmp_lt_u32 s3, 128
    s_cbranch_scc0 K_P2_YN
    s_call_b64 s[38:39], WP_yr0
    s_mul_i32 s3, s58, 1280
    s_lshl_b32 s33, s41, 7
    s_add_u32 s3, s3, s33
    v_and_b32 v2, 15, v1
    v_lshlrev_b32 v2, 3, v2
    buffer_load_dwordx2 v[84:85], v2, s[12:15], s3 offen
    s_lshl_b32 s3, s58, 2
    s_add_u32 s3, s3, 4096
    v_mov_b32 v2, s3
    global_load_dword v88, v2, s[10:11] sc1
    s_lshl1_add_u32 s3, s41, s53
    s_lshl_b32 s3, s3, 8
    s_add_u32 s3, s3, 568320
    v_min_u32 v3, 53, v1
    v_lshl_add_u32 v3, v3, 2, s3
    s_mov_b32 s3, 131072
K_P2_YPOLL:
    global_load_dword v2, v3, s[10:11] sc1
    s_sub_u32 s3, s3, 1
    s_waitcnt vmcnt(0)
    v_cmp_ne_u32 vcc, 1, v2
    s_cbranch_vccz K_P2_YGO
    s_sleep 16
    s_cmp_lg_u32 s3, 0
    s_cbranch_scc1 K_P2_YPOLL
K_P2_YGO:
    v_and_b32 v2, 15, v1
    v_lshlrev_b32 v2, 4, v2
    v_mul_u32_u24 v4, 5120, v9
    s_mov_b32 s59, s53
    s_mul_i32 s33, s59, 2560
    s_lshl_b32 s3, s41, 8
    s_add_u32 s3, s3, s33
    v_add3_u32 v3, v2, v4, s3
    s_mov_b32 s52, 0
    buffer_load_dwordx4 v[24:27], v3, s[44:47], s52 offen sc1
    s_mov_b32 s52, 20480
    buffer_load_dwordx4 v[28:31], v3, s[44:47], s52 offen sc1
    s_mov_b32 s52, 40960
    buffer_load_dwordx4 v[32:35], v3, s[44:47], s52 offen sc1
    s_mov_b32 s52, 61440
    buffer_load_dwordx4 v[36:39], v3, s[44:47], s52 offen sc1
    s_mov_b32 s52, 81920
    buffer_load_dwordx4 v[40:43], v3, s[44:47], s52 offen sc1
    s_mov_b32 s52, 102400
    buffer_load_dwordx4 v[44:47], v3, s[44:47], s52 offen sc1
    s_mov_b32 s52, 122880
    buffer_load_dwordx4 v[48:51], v3, s[44:47], s52 offen sc1
    s_mov_b32 s52, 143360
    buffer_load_dwordx4 v[52:55], v3, s[44:47], s52 offen sc1
    s_mov_b32 s52, 163840
    buffer_load_dwordx4 v[56:59], v3, s[44:47], s52 offen sc1
    s_mov_b32 s52, 184320
    buffer_load_dwordx4 v[60:63], v3, s[44:47], s52 offen sc1
    s_mov_b32 s52, 204800
    buffer_load_dwordx4 v[64:67], v3, s[44:47], s52 offen sc1
    s_mov_b32 s52, 225280
    buffer_load_dwordx4 v[68:71], v3, s[44:47], s52 offen sc1
    s_mov_b32 s52, 245760
    buffer_load_dwordx4 v[72:75], v3, s[44:47], s52 offen sc1
    s_mov_b32 s52, 266240
    buffer_load_dwordx4 v[76:79], v3, s[44:47], s52 offen sc1
    v_sub_f32 v88, 1.0, v88
    v_cvt_pk_bf16_f32 v88, v88, v88
    v_lshlrev_b32 v88, 16, v88
    v_lshlrev_b32 v86, 16, v85
    v_and_b32 v87, 0xffff0000, v85
    v_and_b32 v85, 0xffff0000, v84
    v_lshlrev_b32 v84, 16, v84
    s_waitcnt vmcnt(12)
    v_add_f32 v20, v24, v28
    v_add_f32 v21, v25, v29
    v_add_f32 v22, v26, v30
    v_add_f32 v23, v27, v31
    s_waitcnt vmcnt(11)
    v_add_f32 v20, v20, v32
    v_add_f32 v21, v21, v33
    v_add_f32 v22, v22, v34
    v_add_f32 v23, v23, v35
    s_waitcnt vmcnt(10)
    v_add_f32 v20, v20, v36
    v_add_f32 v21, v21, v37
    v_add_f32 v22, v22, v38
    v_add_f32 v23, v23, v39
    s_waitcnt vmcnt(9)
    v_add_f32 v20, v20, v40
    v_add_f32 v21, v21, v41
    v_add_f32 v22, v22, v42
    v_add_f32 v23, v23, v43
    s_waitcnt vmcnt(8)
    v_add_f32 v20, v20, v44
    v_add_f32 v21, v21, v45
    v_add_f32 v22, v22, v46
    v_add_f32 v23, v23, v47
    s_waitcnt vmcnt(7)
    v_add_f32 v20, v20, v48
    v_add_f32 v21, v21, v49
    v_add_f32 v22, v22, v50
    v_add_f32 v23, v23, v51
    s_waitcnt vmcnt(6)
    v_add_f32 v20, v20, v52
    v_add_f32 v21, v21, v53
    v_add_f32 v22, v22, v54
    v_add_f32 v23, v23, v55
    s_waitcnt vmcnt(5)
    v_add_f32 v20, v20, v56
    v_add_f32 v21, v21, v57
    v_add_f32 v22, v22, v58
    v_add_f32 v23, v23, v59
    s_waitcnt vmcnt(4)
    v_add_f32 v20, v20, v60
    v_add_f32 v21, v21, v61
    v_add_f32 v22, v22, v62
    v_add_f32 v23, v23, v63
    s_waitcnt vmcnt(3)
    v_add_f32 v20, v20, v64
    v_add_f32 v21, v21, v65
    v_add_f32 v22, v22, v66
    v_add_f32 v23, v23, v67
    s_waitcnt vmcnt(2)
    v_add_f32 v20, v20, v68
    v_add_f32 v21, v21, v69
    v_add_f32 v22, v22, v70
    v_add_f32 v23, v23, v71
    s_waitcnt vmcnt(1)
    v_add_f32 v20, v20, v72
    v_add_f32 v21, v21, v73
    v_add_f32 v22, v22, v74
    v_add_f32 v23, v23, v75
    s_waitcnt vmcnt(0)
    v_add_f32 v20, v20, v76
    v_add_f32 v21, v21, v77
    v_add_f32 v22, v22, v78
    v_add_f32 v23, v23, v79
    v_mov_b32 v24, v20
    v_mov_b32 v25, v21
    v_mov_b32 v26, v22
    v_mov_b32 v27, v23
    s_nop 0
    v_permlane16_swap_b32 v20, v24
    v_permlane16_swap_b32 v21, v25
    v_permlane16_swap_b32 v22, v26
    v_permlane16_swap_b32 v23, v27
    v_add_f32 v20, v20, v24
    v_add_f32 v21, v21, v25
    v_add_f32 v22, v22, v26
    v_add_f32 v23, v23, v27
    v_mov_b32 v24, v20
    v_mov_b32 v25, v21
    v_mov_b32 v26, v22
    v_mov_b32 v27, v23
    s_nop 0
    v_permlane32_swap_b32 v20, v24
    v_permlane32_swap_b32 v21, v25
    v_permlane32_swap_b32 v22, v26
    v_permlane32_swap_b32 v23, v27
    v_add_f32 v20, v20, v24
    v_add_f32 v21, v21, v25
    v_add_f32 v22, v22, v26
    v_add_f32 v23, v23, v27
    v_cvt_pk_bf16_f32 v20, v20, v20
    v_lshlrev_b32 v20, 16, v20
    v_mul_f32 v20, v5, v20
    v_cvt_pk_bf16_f32 v20, v20, v20
    v_lshlrev_b32 v20, 16, v20
    v_add_f32 v20, v20, v84
    v_cvt_pk_bf16_f32 v20, v20, v20
    v_lshlrev_b32 v20, 16, v20
    v_mul_f32 v20, v20, v88
    v_cvt_pk_bf16_f32 v21, v21, v21
    v_lshlrev_b32 v21, 16, v21
    v_mul_f32 v21, v5, v21
    v_cvt_pk_bf16_f32 v21, v21, v21
    v_lshlrev_b32 v21, 16, v21
    v_add_f32 v21, v21, v85
    v_cvt_pk_bf16_f32 v21, v21, v21
    v_lshlrev_b32 v21, 16, v21
    v_mul_f32 v21, v21, v88
    v_cvt_pk_bf16_f32 v22, v22, v22
    v_lshlrev_b32 v22, 16, v22
    v_mul_f32 v22, v5, v22
    v_cvt_pk_bf16_f32 v22, v22, v22
    v_lshlrev_b32 v22, 16, v22
    v_add_f32 v22, v22, v86
    v_cvt_pk_bf16_f32 v22, v22, v22
    v_lshlrev_b32 v22, 16, v22
    v_mul_f32 v22, v22, v88
    v_cvt_pk_bf16_f32 v23, v23, v23
    v_lshlrev_b32 v23, 16, v23
    v_mul_f32 v23, v5, v23
    v_cvt_pk_bf16_f32 v23, v23, v23
    v_lshlrev_b32 v23, 16, v23
    v_add_f32 v23, v23, v87
    v_cvt_pk_bf16_f32 v23, v23, v23
    v_lshlrev_b32 v23, 16, v23
    v_mul_f32 v23, v23, v88
    s_lshl_b32 s3, s59, 8
    s_add_u32 s3, s3, 158976
    v_add_u32 v2, s3, v2
    ds_write_b128 v2, v[20:23]
    s_lshl_b32 s3, s59, 2
    v_add_u32 v2, s3, v12
    ds_write_b32 v2, v80 offset:64
K_P2_YN:
    s_add_u32 s53, s53, 1
    s_cmp_lt_u32 s53, 2
    s_cbranch_scc1 K_P2_HW
    s_branch K_END
WP_flags:
    s_setpc_b64 s[38:39]
K_P2_FLAGS:
    s_mov_b32 exec_hi, 0
    s_waitcnt vmcnt(0)
    s_mov_b32 s3, 131072
K_P2_FCHK:
    v_cmp_eq_u32 vcc, 1, v7
    s_nop 1
    v_mov_b32 v2, vcc_lo
    ds_write_b32 v12, v2 offset:32
    s_cmp_eq_u32 vcc_lo, -1
    s_cbranch_scc1 K_P2_FGO
    s_cmp_lg_u32 vcc_lo, 0
    s_cbranch_scc1 K_P2_FS
    s_sleep 4
K_P2_FS:
    s_sleep 6
    global_load_dword v7, v10, s[10:11] sc1
    s_sub_u32 s3, s3, 1
    s_waitcnt vmcnt(0)
    s_cbranch_scc0 K_P2_FCHK
    v_mov_b32 v2, -1
    ds_write_b32 v12, v2 offset:32
K_P2_FGO:
    s_mov_b64 exec, -1
    s_branch K_END
.p2align 12
K_AUX:
    s_load_dwordx8 s[48:55], s[0:1], 32
    s_load_dwordx2 s[56:57], s[0:1], 64
    s_mul_i32 s44, s28, 7
    s_add_u32 s44, s44, s29
    s_sub_u32 s44, s44, 1
    s_cmp_lt_u32 s44, 54
    s_cselect_b32 s44, s44, 63
    s_cmp_eq_u32 s29, 0
    s_cselect_b32 s44, 63, s44
    s_lshl_b32 s74, s28, 8
    s_lshl_b32 s3, s29, 5
    s_add_u32 s74, s74, s3
    v_mov_b32 v12, 158720
    v_mov_b32 v13, 1
    s_cmp_lt_u32 s30, 4
    s_cbranch_scc1 K_AUX_LO
    s_lshl_b32 s3, s30, 3
    s_add_u32 s3, s3, s74
    s_sub_u32 s3, s3, 32
    v_lshrrev_b32 v9, 3, v1
    v_add_u32 v9, s3, v9
    v_and_b32 v11, 7, v1
    v_lshlrev_b32 v11, 4, v11
    v_mul_u32_u24 v10, 1280, v9
    v_add_u32 v10, v10, v11
    s_waitcnt lgkmcnt(0)
    buffer_load_dwordx4 v[16:19], v10, s[12:15], 0 offen offset:0
    buffer_load_dwordx4 v[20:23], v10, s[12:15], 0 offen offset:128
    buffer_load_dwordx4 v[24:27], v10, s[12:15], 0 offen offset:256
    buffer_load_dwordx4 v[28:31], v10, s[12:15], 0 offen offset:384
    buffer_load_dwordx4 v[32:35], v10, s[12:15], 0 offen offset:512
    buffer_load_dwordx4 v[36:39], v10, s[12:15], 0 offen offset:640
    buffer_load_dwordx4 v[40:43], v10, s[12:15], 0 offen offset:768
    buffer_load_dwordx4 v[44:47], v10, s[12:15], 0 offen offset:896
    buffer_load_dwordx4 v[48:51], v10, s[12:15], 0 offen offset:1024
    buffer_load_dwordx4 v[52:55], v10, s[12:15], 0 offen offset:1152
    s_mov_b32 s16, s48
    s_mov_b32 s17, s49
    s_mov_b32 s18, 0x500
    s_mov_b32 s19, 0x20000
    s_mov_b32 s20, s56
    s_mov_b32 s21, s57
    s_mov_b32 s22, 0x500
    s_mov_b32 s23, 0x20000
    buffer_load_dwordx4 v[56:59], v11, s[16:19], 0 offen offset:0
    buffer_load_dwordx4 v[60:63], v11, s[16:19], 0 offen offset:128
    buffer_load_dwordx4 v[64:67], v11, s[16:19], 0 offen offset:256
    buffer_load_dwordx4 v[68:71], v11, s[16:19], 0 offen offset:384
    buffer_load_dwordx4 v[72:75], v11, s[16:19], 0 offen offset:512
    buffer_load_dwordx4 v[76:79], v11, s[16:19], 0 offen offset:640
    buffer_load_dwordx4 v[80:83], v11, s[16:19], 0 offen offset:768
    buffer_load_dwordx4 v[84:87], v11, s[16:19], 0 offen offset:896
    buffer_load_dwordx4 v[88:91], v11, s[16:19], 0 offen offset:1024
    buffer_load_dwordx4 v[92:95], v11, s[16:19], 0 offen offset:1152
    buffer_load_dwordx4 v[96:99], v11, s[20:23], 0 offen offset:0
    buffer_load_dwordx4 v[100:103], v11, s[20:23], 0 offen offset:128
    buffer_load_dwordx4 v[104:107], v11, s[20:23], 0 offen offset:256
    buffer_load_dwordx4 v[108:111], v11, s[20:23], 0 offen offset:384
    buffer_load_dwordx4 v[112:115], v11, s[20:23], 0 offen offset:512
    buffer_load_dwordx4 v[116:119], v11, s[20:23], 0 offen offset:640
    buffer_load_dwordx4 v[120:123], v11, s[20:23], 0 offen offset:768
    buffer_load_dwordx4 v[124:127], v11, s[20:23], 0 offen offset:896
    buffer_load_dwordx4 v[128:131], v11, s[20:23], 0 offen offset:1024
    buffer_load_dwordx4 v[132:135], v11, s[20:23], 0 offen offset:1152
    s_barrier
    v_mov_b32 v180, 0
    v_mov_b32 v181, 0
    v_mov_b32 v182, 0
    v_mov_b32 v183, 0
    v_and_b32 v10, 31, v9
    v_lshlrev_b32 v10, 2, v10
    v_add_u32 v10, 122880, v10
    v_sub_u32 v4, 0x87ff, v9
    s_setprio 2
    s_waitcnt vmcnt(10)
    v_dot2c_f32_bf16 v180, v16, v56
    v_dot2c_f32_bf16 v181, v17, v57
    v_dot2c_f32_bf16 v180, v18, v58
    v_dot2c_f32_bf16 v181, v19, v59
    v_dot2c_f32_bf16 v180, v20, v60
    v_dot2c_f32_bf16 v181, v21, v61
    v_dot2c_f32_bf16 v180, v22, v62
    v_dot2c_f32_bf16 v181, v23, v63
    v_dot2c_f32_bf16 v180, v24, v64
    v_dot2c_f32_bf16 v181, v25, v65
    v_dot2c_f32_bf16 v180, v26, v66
    v_dot2c_f32_bf16 v181, v27, v67
    v_dot2c_f32_bf16 v180, v28, v68
    v_dot2c_f32_bf16 v181, v29, v69
    v_dot2c_f32_bf16 v180, v30, v70
    v_dot2c_f32_bf16 v181, v31, v71
    v_dot2c_f32_bf16 v180, v32, v72
    v_dot2c_f32_bf16 v181, v33, v73
    v_dot2c_f32_bf16 v180, v34, v74
    v_dot2c_f32_bf16 v181, v35, v75
    v_dot2c_f32_bf16 v180, v36, v76
    v_dot2c_f32_bf16 v181, v37, v77
    v_dot2c_f32_bf16 v180, v38, v78
    v_dot2c_f32_bf16 v181, v39, v79
    v_dot2c_f32_bf16 v180, v40, v80
    v_dot2c_f32_bf16 v181, v41, v81
    v_dot2c_f32_bf16 v180, v42, v82
    v_dot2c_f32_bf16 v181, v43, v83
    v_dot2c_f32_bf16 v180, v44, v84
    v_dot2c_f32_bf16 v181, v45, v85
    v_dot2c_f32_bf16 v180, v46, v86
    v_dot2c_f32_bf16 v181, v47, v87
    v_dot2c_f32_bf16 v180, v48, v88
    v_dot2c_f32_bf16 v181, v49, v89
    v_dot2c_f32_bf16 v180, v50, v90
    v_dot2c_f32_bf16 v181, v51, v91
    v_dot2c_f32_bf16 v180, v52, v92
    v_dot2c_f32_bf16 v181, v53, v93
    v_dot2c_f32_bf16 v180, v54, v94
    v_dot2c_f32_bf16 v181, v55, v95
    s_waitcnt vmcnt(0)
    v_dot2c_f32_bf16 v182, v16, v96
    v_dot2c_f32_bf16 v183, v17, v97
    v_dot2c_f32_bf16 v182, v18, v98
    v_dot2c_f32_bf16 v183, v19, v99
    v_dot2c_f32_bf16 v182, v20, v100
    v_dot2c_f32_bf16 v183, v21, v101
    v_dot2c_f32_bf16 v182, v22, v102
    v_dot2c_f32_bf16 v183, v23, v103
    v_dot2c_f32_bf16 v182, v24, v104
    v_dot2c_f32_bf16 v183, v25, v105
    v_dot2c_f32_bf16 v182, v26, v106
    v_dot2c_f32_bf16 v183, v27, v107
    v_dot2c_f32_bf16 v182, v28, v108
    v_dot2c_f32_bf16 v183, v29, v109
    v_dot2c_f32_bf16 v182, v30, v110
    v_dot2c_f32_bf16 v183, v31, v111
    v_dot2c_f32_bf16 v182, v32, v112
    v_dot2c_f32_bf16 v183, v33, v113
    v_dot2c_f32_bf16 v182, v34, v114
    v_dot2c_f32_bf16 v183, v35, v115
    v_dot2c_f32_bf16 v182, v36, v116
    v_dot2c_f32_bf16 v183, v37, v117
    v_dot2c_f32_bf16 v182, v38, v118
    v_dot2c_f32_bf16 v183, v39, v119
    v_dot2c_f32_bf16 v182, v40, v120
    v_dot2c_f32_bf16 v183, v41, v121
    v_dot2c_f32_bf16 v182, v42, v122
    v_dot2c_f32_bf16 v183, v43, v123
    v_dot2c_f32_bf16 v182, v44, v124
    v_dot2c_f32_bf16 v183, v45, v125
    v_dot2c_f32_bf16 v182, v46, v126
    v_dot2c_f32_bf16 v183, v47, v127
    v_dot2c_f32_bf16 v182, v48, v128
    v_dot2c_f32_bf16 v183, v49, v129
    v_dot2c_f32_bf16 v182, v50, v130
    v_dot2c_f32_bf16 v183, v51, v131
    v_dot2c_f32_bf16 v182, v52, v132
    v_dot2c_f32_bf16 v183, v53, v133
    v_dot2c_f32_bf16 v182, v54, v134
    v_dot2c_f32_bf16 v183, v55, v135
    s_nop 2
    v_add_f32 v180, v180, v181
    v_add_f32 v182, v182, v183
    s_nop 0
    v_add_f32_dpp v180, v180, v180 quad_perm:[1,0,3,2] row_mask:0xf bank_mask:0xf
    v_add_f32_dpp v182, v182, v182 quad_perm:[1,0,3,2] row_mask:0xf bank_mask:0xf
    s_nop 0
    v_add_f32_dpp v180, v180, v180 quad_perm:[2,3,0,1] row_mask:0xf bank_mask:0xf
    v_add_f32_dpp v182, v182, v182 quad_perm:[2,3,0,1] row_mask:0xf bank_mask:0xf
    s_nop 0
    v_add_f32_dpp v180, v180, v180 row_half_mirror row_mask:0xf bank_mask:0xf
    v_add_f32_dpp v182, v182, v182 row_half_mirror row_mask:0xf bank_mask:0xf
    v_cvt_pk_bf16_f32 v2, v180, v180
    v_lshlrev_b32 v2, 16, v2
    v_ashrrev_i32 v3, 31, v2
    v_or_b32 v3, 0x80000000, v3
    v_xor_b32 v2, v2, v3
    v_and_b32 v2, 0xffff0000, v2
    v_or_b32 v2, v2, v4
    ds_write2_b32 v10, v2, v182 offset0:0 offset1:32
    s_mov_b64 exec, 1
    ds_add_u32 v12, v13 offset:36
    s_mov_b64 exec, -1
    s_setprio 0
    s_cmp_lg_u32 s30, 4
    s_cbranch_scc1 K_WARMA0
    s_call_b64 s[38:39], WP_p2g
    s_branch K_WARMAX
K_WARMA0:
    s_cmp_lg_u32 s30, 5
    s_cbranch_scc1 K_WARMA1
    s_call_b64 s[38:39], WP_gen
    s_branch K_WARMAX
K_WARMA1:
    s_cmp_lg_u32 s30, 6
    s_cbranch_scc1 K_WARMA2
    s_call_b64 s[38:39], WP_help
    s_call_b64 s[38:39], WP_flags
    s_branch K_WARMAX
K_WARMA2:
    s_call_b64 s[38:39], WP_spin
K_WARMAX:
    s_cmp_ge_u32 s30, 6
    s_cselect_b32 s44, 63, s44
    s_cmp_lg_u32 s44, 63
    s_cbranch_scc1 K_FFN_C
    s_mov_b32 s3, 1048576
K_FGH:
    ds_read_b32 v2, v12 offset:48
    s_sleep 8
    s_sub_u32 s3, s3, 1
    s_waitcnt lgkmcnt(0)
    v_readfirstlane_b32 s33, v2
    s_nop 3
    s_cselect_b32 s33, 1, s33
    s_cmp_lt_u32 s33, 1
    s_cbranch_scc1 K_FGH
    s_cmp_eq_u32 s30, 6
    s_cbranch_scc1 K_P2_HELP
    v_mov_b32 v7, 1
    s_branch K_P2_HELP
K_AUX_LO:
    s_waitcnt lgkmcnt(0)
    s_cmp_eq_u32 s30, 0
    s_cbranch_scc1 K_AUX_PUB
    s_cmp_eq_u32 s44, 63
    s_cbranch_scc1 K_AUX_NOF
    s_and_b32 s3, s44, 1
    s_cmp_eq_u32 s3, 0
    s_cselect_b64 s[60:61], s[50:51], s[52:53]
    s_cselect_b64 s[64:65], s[52:53], s[50:51]
    s_cselect_b32 s75, 0, 40960
    s_mov_b32 s62, 0x21c000
    s_mov_b32 s63, 0x20000
    s_mov_b32 s66, 0x21c000
    s_mov_b32 s67, 0x20000
    v_lshrrev_b32 v2, 2, v1
    v_mul_u32_u24 v184, 3456, v2
    v_and_b32 v2, 3, v1
    v_lshl_add_u32 v184, v2, 4, v184
    s_lshl_b32 s72, s44, 6
    v_add_u32 v184, s72, v184
    s_sub_u32 s74, s30, 1
K_FSA0:
    s_lshl_b32 s73, s74, 10
    s_mul_i32 s72, s74, 55296
    s_add_u32 m0, s73, s75
    s_waitcnt vmcnt(7)
    buffer_load_dwordx4 v184, s[60:63], s72 offen lds
    s_add_u32 s74, s74, 3
    s_cmp_lt_u32 s74, 24
    s_cbranch_scc1 K_FSA0
    s_barrier
    s_mov_b32 s3, 1048576
K_FGPB:
    ds_read_b32 v2, v12 offset:36
    s_sleep 1
    s_sub_u32 s3, s3, 1
    s_waitcnt lgkmcnt(0)
    v_readfirstlane_b32 s33, v2
    s_nop 3
    s_cselect_b32 s33, 5, s33
    s_cmp_lt_u32 s33, 5
    s_cbranch_scc1 K_FGPB
K_FSA:
    s_lshl_b32 s73, s74, 10
    s_mul_i32 s72, s74, 55296
    s_add_u32 m0, s73, s75
    s_waitcnt vmcnt(7)
    buffer_load_dwordx4 v184, s[60:63], s72 offen lds
    s_add_u32 s74, s74, 3
    s_cmp_lt_u32 s74, 40
    s_cbranch_scc1 K_FSA
    s_sub_u32 s74, s74, 40
    s_xor_b32 s75, s75, 40960
    s_mov_b32 s68, s54
    s_mov_b32 s69, s55
    s_mov_b32 s70, 0x21c000
    s_mov_b32 s71, 0x20000
    s_mul_i32 s3, s44, 40960
    v_lshrrev_b32 v2, 3, v1
    v_mul_u32_u24 v2, 1280, v2
    v_lshrrev_b32 v3, 4, v1
    v_lshlrev_b32 v3, 1, v3
    v_and_b32 v4, 7, v1
    v_xor_b32 v3, v3, v4
    v_lshl_add_u32 v2, v3, 4, v2
    v_add_u32 v185, s3, v2
K_FSB:
    s_lshl_b32 s73, s74, 10
    s_mul_i32 s72, s74, 55296
    s_add_u32 m0, s73, s75
    s_waitcnt vmcnt(7)
    buffer_load_dwordx4 v184, s[64:67], s72 offen lds
    s_add_u32 s74, s74, 3
    s_cmp_lt_u32 s74, 40
    s_cbranch_scc1 K_FSB
    s_sub_u32 s74, s74, 40
    s_mov_b32 s75, 81920
K_FSD0:
    s_lshl_b32 s73, s74, 10
    s_and_b32 s72, s74, 3
    s_mul_i32 s72, s72, 10208
    s_lshl_b32 s3, s74, 5
    s_add_u32 s72, s72, s3
    s_add_u32 m0, s73, s75
    s_waitcnt vmcnt(7)
    buffer_load_dwordx4 v185, s[68:71], s72 offen lds
    s_add_u32 s74, s74, 3
    s_cmp_lt_u32 s74, 24
    s_cbranch_scc1 K_FSD0
    s_waitcnt vmcnt(8)
    s_mov_b64 exec, 1
    ds_add_u32 v12, v13 offset:56
    s_mov_b64 exec, -1
K_FSD:
    s_lshl_b32 s73, s74, 10
    s_and_b32 s72, s74, 3
    s_mul_i32 s72, s72, 10208
    s_lshl_b32 s3, s74, 5
    s_add_u32 s72, s72, s3
    s_add_u32 m0, s73, s75
    s_waitcnt vmcnt(7)
    buffer_load_dwordx4 v185, s[68:71], s72 offen lds
    s_add_u32 s74, s74, 3
    s_cmp_lt_u32 s74, 40
    s_cbranch_scc1 K_FSD
    s_mul_i32 s3, s29, 96
    s_lshl_b32 s72, s30, 5
    s_add_u32 s3, s3, s72
    s_sub_u32 s3, s3, 128
    v_lshrrev_b32 v2, 1, v1
    v_add_u32 v2, s3, v2
    v_mul_u32_u24 v2, 1280, v2
    v_and_b32 v3, 1, v1
    v_lshl_add_u32 v2, v3, 7, v2
    buffer_load_dword v6, v2, s[24:27], 0 offen offset:1024
K_AUX_WR:
    s_mov_b32 s3, 1048576
K_FGR:
    ds_read_b32 v2, v12 offset:60
    s_sleep 2
    s_sub_u32 s3, s3, 1
    s_waitcnt lgkmcnt(0)
    v_readfirstlane_b32 s33, v2
    s_nop 3
    s_cselect_b32 s33, 2, s33
    s_cmp_lt_u32 s33, 2
    s_cbranch_scc1 K_FGR
    s_branch K_P2
K_AUX_NOF:
    s_cmp_lg_u32 s2, 63
    s_cbranch_scc1 K_AUX_NOZ
    s_cmp_lg_u32 s30, 1
    s_cbranch_scc1 K_AUX_NOZ
    s_add_u32 s60, s10, 0x80000
    s_addc_u32 s61, s11, 0
    s_mov_b32 s62, 0xc000
    s_mov_b32 s63, 0x20000
    v_mov_b32 v9, 786432
    global_load_dword v10, v9, s[10:11] sc1
    v_lshlrev_b32 v11, 4, v1
    v_add_u32 v11, 790528, v11
    global_load_dword v6, v11, s[10:11] sc1
    s_barrier
    s_mov_b32 s3, 1048576
K_FGZ:
    ds_read_b32 v2, v12 offset:36
    s_sleep 2
    s_sub_u32 s3, s3, 1
    s_waitcnt lgkmcnt(0)
    v_readfirstlane_b32 s33, v2
    s_nop 3
    s_cselect_b32 s33, 4, s33
    s_cmp_lt_u32 s33, 4
    s_cbranch_scc1 K_FGZ
    v_and_b32 v4, 7, v1
    v_lshlrev_b32 v4, 2, v4
    global_load_dword v7, v4, s[8:9] offset:192 sc1
    s_waitcnt vmcnt(1)
    v_add_u32 v10, 1, v10
    s_mov_b32 s3, 131072
    s_setprio 3
K_AG2_POLL:
    global_load_dwordx4 v[16:19], v11, s[10:11] sc1
    s_waitcnt vmcnt(0)
    v_xor_b32 v2, v10, v17
    v_xor_b32 v3, v10, v19
    v_or_b32 v2, v2, v3
    v_cmp_ne_u32 vcc, 0, v2
    s_cbranch_vccz K_AG2_GOT
    s_sleep 2
    s_sub_u32 s3, s3, 1
    s_cmp_lg_u32 s3, 0
    s_cbranch_scc1 K_AG2_POLL
K_AG2_GOT:
    s_nop 1
    v_max_u32_dpp v3, v16, v16 quad_perm:[1,0,3,2] row_mask:0xf bank_mask:0xf
    s_nop 1
    v_max_u32_dpp v3, v3, v3 quad_perm:[2,3,0,1] row_mask:0xf bank_mask:0xf
    s_nop 1
    v_max_u32_dpp v3, v3, v3 row_half_mirror row_mask:0xf bank_mask:0xf
    s_nop 1
    v_max_u32_dpp v3, v3, v3 row_mirror row_mask:0xf bank_mask:0xf
    s_nop 1
    v_readlane_b32 s74, v3, 0
    v_readlane_b32 s76, v3, 16
    v_readlane_b32 s77, v3, 32
    v_readlane_b32 s78, v3, 48
    s_nop 3
    s_max_u32 s74, s74, s76
    s_max_u32 s77, s77, s78
    s_max_u32 s74, s74, s77
    v_cmp_ne_u32 vcc, s74, v16
    s_nop 1
    v_cndmask_b32 v2, v18, v16, vcc
    s_nop 1
    v_max_u32_dpp v3, v2, v2 quad_perm:[1,0,3,2] row_mask:0xf bank_mask:0xf
    s_nop 1
    v_max_u32_dpp v3, v3, v3 quad_perm:[2,3,0,1] row_mask:0xf bank_mask:0xf
    s_nop 1
    v_max_u32_dpp v3, v3, v3 row_half_mirror row_mask:0xf bank_mask:0xf
    s_nop 1
    v_max_u32_dpp v3, v3, v3 row_mirror row_mask:0xf bank_mask:0xf
    s_nop 1
    v_readlane_b32 s75, v3, 0
    v_readlane_b32 s76, v3, 16
    v_readlane_b32 s77, v3, 32
    v_readlane_b32 s78, v3, 48
    s_nop 3
    s_max_u32 s75, s75, s76
    s_max_u32 s77, s77, s78
    s_max_u32 s75, s75, s77
    v_mov_b32 v176, s74
    v_mov_b32 v177, s75
    v_and_b32 v4, 7, v1
    v_lshlrev_b32 v4, 2, v4
    s_mov_b32 s3, 131072
K_ZPOLL4:
    v_cmp_eq_u32 vcc, 0, v7
    s_cbranch_vccz K_ZOK4
    s_sub_u32 s3, s3, 1
    s_cbranch_scc1 K_ZOK4
    global_load_dword v7, v4, s[8:9] offset:192 sc1
    s_waitcnt vmcnt(0)
    s_branch K_ZPOLL4
K_ZOK4:
    v_and_b32 v2, 7, v1
    v_mul_u32_u24 v2, 20, v2
    v_lshrrev_b32 v3, 3, v1
    v_add_lshl_u32 v2, v2, v3, 8
    buffer_store_dwordx2 v[176:177], v2, s[60:63], 0 offen offset:136 sc1
    s_mov_b64 exec, 1
    global_store_dword v9, v10, s[10:11] sc1
    s_mov_b64 exec, -1
    v_lshlrev_b32 v4, 2, v1
    s_mov_b32 s72, 43008
    s_mov_b32 s3, 131072
K_AGG_POLL:
    s_sleep 8
    buffer_load_dword v2, v4, s[60:63], s72 offen sc1
    s_waitcnt vmcnt(0)
    v_cmp_eq_u32 vcc, 0, v2
    s_cbranch_vccz K_AGG_GOT
    s_sub_u32 s3, s3, 1
    s_cmp_lg_u32 s3, 0
    s_cbranch_scc1 K_AGG_POLL
K_AGG_GOT:
    s_mov_b32 s62, 40960
    v_lshlrev_b32 v3, 8, v1
    s_mov_b32 s3, 0
    buffer_store_dwordx2 v[176:177], v3, s[60:63], s3 offen offset:128 sc1
    s_mov_b32 s3, 16384
    buffer_store_dwordx2 v[176:177], v3, s[60:63], s3 offen offset:128 sc1
    s_mov_b32 s3, 32768
    buffer_store_dwordx2 v[176:177], v3, s[60:63], s3 offen offset:128 sc1
    s_setprio 0
    s_branch K_AUX_NOK
K_AUX_NOZ:
    s_barrier
K_AUX_NOK:
    s_mov_b32 s3, 1048576
K_FGWD:
    ds_read_b32 v2, v12 offset:48
    s_sleep 4
    s_sub_u32 s3, s3, 1
    s_waitcnt lgkmcnt(0)
    v_readfirstlane_b32 s33, v2
    s_nop 3
    s_cselect_b32 s33, 1, s33
    s_cmp_lt_u32 s33, 1
    s_cbranch_scc1 K_FGWD
    s_branch K_P2
K_AUX_PUB:
    s_add_u32 s60, s10, 0x1000
    s_addc_u32 s61, s11, 0
    s_mov_b32 s62, 0x2000
    s_mov_b32 s63, 0x20000
    v_and_b32 v3, 31, v1
    v_lshlrev_b32 v10, 2, v3
    v_add_u32 v11, 122880, v10
    s_lshl_b32 s72, s74, 2
    v_mov_b32 v2, 786432
    global_load_dword v17, v2, s[10:11] sc1
    s_lshl_b32 s3, s2, 2
    s_add_u32 s3, s3, 567296
    v_mov_b32 v9, s3
    s_lshl_b32 s3, s2, 4
    s_add_u32 s3, s3, 790528
    v_lshl_add_u32 v20, v1, 4, s3
    v_and_b32 v5, 7, v1
    v_lshlrev_b32 v5, 2, v5
    s_barrier
    s_setprio 3
    s_waitcnt vmcnt(0)
    v_add_u32 v17, 1, v17
    v_mov_b32 v19, v17
    s_mov_b32 s3, 1048576
K_FGRT:
    ds_read_b32 v2, v12 offset:36
    s_sleep 0
    s_sub_u32 s3, s3, 1
    s_waitcnt lgkmcnt(0)
    v_readfirstlane_b32 s33, v2
    s_nop 3
    s_cselect_b32 s33, 4, s33
    s_cmp_lt_u32 s33, 4
    s_cbranch_scc1 K_FGRT
    ds_read2_b32 v[176:177], v11 offset0:0 offset1:32
    s_waitcnt lgkmcnt(0)
    s_nop 1
    v_max_u32_dpp v3, v176, v176 quad_perm:[1,0,3,2] row_mask:0xf bank_mask:0xf
    s_nop 1
    v_max_u32_dpp v3, v3, v3 quad_perm:[2,3,0,1] row_mask:0xf bank_mask:0xf
    s_nop 1
    v_max_u32_dpp v3, v3, v3 row_half_mirror row_mask:0xf bank_mask:0xf
    s_nop 1
    v_max_u32_dpp v3, v3, v3 row_mirror row_mask:0xf bank_mask:0xf
    s_nop 1
    v_readlane_b32 s74, v3, 0
    v_readlane_b32 s76, v3, 16
    v_readlane_b32 s77, v3, 32
    v_readlane_b32 s78, v3, 48
    s_nop 3
    s_max_u32 s74, s74, s76
    s_max_u32 s77, s77, s78
    s_max_u32 s74, s74, s77
    v_cmp_ne_u32 vcc, s74, v176
    s_nop 1
    v_cndmask_b32 v176, 0, v176, vcc
    s_nop 1
    v_max_u32_dpp v3, v176, v176 quad_perm:[1,0,3,2] row_mask:0xf bank_mask:0xf
    s_nop 1
    v_max_u32_dpp v3, v3, v3 quad_perm:[2,3,0,1] row_mask:0xf bank_mask:0xf
    s_nop 1
    v_max_u32_dpp v3, v3, v3 row_half_mirror row_mask:0xf bank_mask:0xf
    s_nop 1
    v_max_u32_dpp v3, v3, v3 row_mirror row_mask:0xf bank_mask:0xf
    s_nop 1
    v_readlane_b32 s75, v3, 0
    v_readlane_b32 s76, v3, 16
    v_readlane_b32 s77, v3, 32
    v_readlane_b32 s78, v3, 48
    s_nop 3
    s_max_u32 s75, s75, s76
    s_max_u32 s77, s77, s78
    s_max_u32 s75, s75, s77
    v_mov_b32 v16, s74
    v_mov_b32 v18, s75
    s_mov_b64 exec, 1
    global_store_dwordx4 v20, v[16:19], s[10:11] sc1
    s_mov_b64 exec, -1
    s_mov_b64 exec, 1
    ds_add_u32 v12, v13 offset:36
    s_mov_b64 exec, -1
    global_load_dword v7, v5, s[8:9] offset:192 sc1
    v_cvt_pk_bf16_f32 v177, v177, v177
    v_lshlrev_b32 v177, 16, v177
    v_mul_f32 v3, 0xbfb8aa3b, v177
    v_exp_f32 v3, v3
    s_nop 0
    v_add_f32 v3, 1.0, v3
    v_rcp_f32 v177, v3
    s_nop 0
    v_cvt_pk_bf16_f32 v177, v177, v177
    v_lshlrev_b32 v177, 16, v177
    s_mov_b32 exec_hi, 0
    buffer_store_dword v177, v10, s[60:63], s72 offen sc1
    s_mov_b64 exec, -1
    s_waitcnt vmcnt(0)
    v_and_b32 v4, 7, v1
    v_lshlrev_b32 v4, 2, v4
    s_mov_b32 s3, 131072
K_ZPOLL3:
    v_cmp_eq_u32 vcc, 0, v7
    s_cbranch_vccz K_ZOK3
    s_sub_u32 s3, s3, 1
    s_cbranch_scc1 K_ZOK3
    global_load_dword v7, v4, s[8:9] offset:192 sc1
    s_waitcnt vmcnt(0)
    s_branch K_ZPOLL3
K_ZOK3:
    s_mov_b64 exec, 1
    global_store_dword v9, v13, s[10:11] sc1
    s_mov_b64 exec, -1
    v_and_b32 v3, 1, v1
    v_lshl_add_u32 v3, v3, 2, s42
    v_lshlrev_b32 v10, 4, v1
    s_mov_b32 s3, 131072
K_AUX_POLL:
    s_sleep 6
    global_load_dword v2, v3, s[10:11] offset:136 sc1
    s_waitcnt vmcnt(0)
    v_cmp_eq_u32 vcc, 0, v2
    s_cbranch_vccz K_AUX_GOT
    s_sub_u32 s3, s3, 1
    s_cmp_lg_u32 s3, 0
    s_cbranch_scc1 K_AUX_POLL
K_AUX_GOT:
    v_readlane_b32 s74, v2, 0
    v_readlane_b32 s75, v2, 1
    s_nop 3
    s_and_b32 s74, s74, 0x7ff
    s_sub_u32 s74, 2047, s74
    s_mul_i32 s74, s74, 1280
    s_mov_b32 m0, 125184
    s_nop 0
    buffer_load_dwordx4 v10, s[12:15], s74 offen lds
    s_mov_b64 exec, 0xffff
    buffer_load_dwordx4 v10, s[12:15], s74 offen offset:1024 lds
    s_mov_b64 exec, -1
    s_and_b32 s75, s75, 0x7ff
    s_sub_u32 s75, 2047, s75
    s_mul_i32 s75, s75, 1280
    s_mov_b32 m0, 126528
    s_nop 0
    buffer_load_dwordx4 v10, s[12:15], s75 offen lds
    s_mov_b64 exec, 0xffff
    buffer_load_dwordx4 v10, s[12:15], s75 offen offset:1024 lds
    s_mov_b64 exec, -1
    s_waitcnt vmcnt(0)
    ds_write_b32 v12, v13 offset:48
    s_setprio 0
    s_branch K_P2
.p2align 12
K_FFN_C:
    s_add_u32 s64, s10, 0x10000
    s_addc_u32 s65, s11, 0
    s_mov_b32 s66, 0x43800
    s_mov_b32 s67, 0x20000
    s_and_b32 s73, s30, 1
    v_lshrrev_b32 v232, 4, v1
    v_bfe_u32 v4, v1, 2, 2
    v_lshl_add_u32 v2, v232, 3, v4
    v_and_b32 v3, 3, v1
    v_lshlrev_b32 v3, 3, v3
    v_lshl_add_u32 v233, v2, 6, v3
    s_lshl_b32 s72, s73, 5
    v_add_u32 v233, s72, v233
    v_lshl_add_u32 v2, v232, 2, v4
    v_bfe_u32 v4, v2, 1, 2
    v_lshl_add_u32 v3, v2, 7, v3
    v_lshl_add_u32 v3, v4, 5, v3
    s_mul_i32 s3, s73, 20480
    s_add_u32 s3, s3, 81920
    v_add_u32 v238, s3, v3
    v_xor_b32 v239, 32, v238
    v_xor_b32 v240, 64, v238
    v_xor_b32 v241, 96, v238
    v_and_b32 v2, 1, v1
    v_mul_u32_u24 v234, 1344, v2
    v_lshl_add_u32 v234, v232, 4, v234
    v_add_u32 v234, 125184, v234
    v_lshlrev_b32 v236, 4, v1
    v_add_u32 v236, 124160, v236
    s_lshl_b32 s3, s73, 3
    v_add_u32 v235, s3, v236
    v_mul_u32_u24 v2, 2560, v2
    v_lshl_add_u32 v237, v232, 4, v2
    s_mul_i32 s3, s44, 5120
    s_mul_i32 s72, s73, 1280
    s_add_u32 s72, s72, s3
    v_lshlrev_b32 v2, 4, v1
    buffer_store_dwordx4 v[16:19], v2, s[64:67], s72 offen offset:0 sc1
    buffer_store_dwordx4 v[16:19], v2, s[64:67], s72 offen offset:2560 sc1
    s_mov_b64 exec, 0xffff
    buffer_store_dwordx4 v[16:19], v2, s[64:67], s72 offen offset:1024 sc1
    buffer_store_dwordx4 v[16:19], v2, s[64:67], s72 offen offset:3584 sc1
    s_mov_b64 exec, -1
    v_add_u32 v5, 40960, v233
    s_mov_b32 s3, 1048576
K_FGD:
    ds_read_b32 v2, v12 offset:56
    s_sleep 2
    s_sub_u32 s3, s3, 1
    s_waitcnt lgkmcnt(0)
    v_readfirstlane_b32 s33, v2
    s_nop 3
    s_cselect_b32 s33, 3, s33
    s_cmp_lt_u32 s33, 3
    s_cbranch_scc1 K_FGD
    s_setprio 3
    ds_read_b64_tr_b16 v[16:17], v233 offset:0
    ds_read_b64_tr_b16 v[18:19], v233 offset:256
    ds_read_b64_tr_b16 v[20:21], v233 offset:2048
    ds_read_b64_tr_b16 v[22:23], v233 offset:2304
    ds_read_b64_tr_b16 v[24:25], v233 offset:4096
    ds_read_b64_tr_b16 v[26:27], v233 offset:4352
    ds_read_b64_tr_b16 v[28:29], v233 offset:6144
    ds_read_b64_tr_b16 v[30:31], v233 offset:6400
    ds_read_b64_tr_b16 v[32:33], v233 offset:8192
    ds_read_b64_tr_b16 v[34:35], v233 offset:8448
    ds_read_b64_tr_b16 v[36:37], v233 offset:10240
    ds_read_b64_tr_b16 v[38:39], v233 offset:10496
    ds_read_b64_tr_b16 v[40:41], v233 offset:12288
    ds_read_b64_tr_b16 v[42:43], v233 offset:12544
    ds_read_b64_tr_b16 v[44:45], v233 offset:14336
    ds_read_b64_tr_b16 v[46:47], v233 offset:14592
    ds_read_b64_tr_b16 v[48:49], v233 offset:16384
    ds_read_b64_tr_b16 v[50:51], v233 offset:16640
    ds_read_b64_tr_b16 v[52:53], v233 offset:18432
    ds_read_b64_tr_b16 v[54:55], v233 offset:18688
    ds_read_b64_tr_b16 v[56:57], v233 offset:20480
    ds_read_b64_tr_b16 v[58:59], v233 offset:20736
    ds_read_b64_tr_b16 v[60:61], v233 offset:22528
    ds_read_b64_tr_b16 v[62:63], v233 offset:22784
    ds_read_b64_tr_b16 v[64:65], v233 offset:24576
    ds_read_b64_tr_b16 v[66:67], v233 offset:24832
    ds_read_b64_tr_b16 v[68:69], v233 offset:26624
    ds_read_b64_tr_b16 v[70:71], v233 offset:26880
    ds_read_b64_tr_b16 v[72:73], v233 offset:28672
    ds_read_b64_tr_b16 v[74:75], v233 offset:28928
    ds_read_b64_tr_b16 v[76:77], v233 offset:30720
    ds_read_b64_tr_b16 v[78:79], v233 offset:30976
    ds_read_b64_tr_b16 v[80:81], v233 offset:32768
    ds_read_b64_tr_b16 v[82:83], v233 offset:33024
    ds_read_b64_tr_b16 v[84:85], v233 offset:34816
    ds_read_b64_tr_b16 v[86:87], v233 offset:35072
    ds_read_b64_tr_b16 v[88:89], v233 offset:36864
    ds_read_b64_tr_b16 v[90:91], v233 offset:37120
    ds_read_b64_tr_b16 v[92:93], v233 offset:38912
    ds_read_b64_tr_b16 v[94:95], v233 offset:39168
    ds_read_b64_tr_b16 v[96:97], v5 offset:0
    ds_read_b64_tr_b16 v[98:99], v5 offset:256
    ds_read_b64_tr_b16 v[100:101], v5 offset:2048
    ds_read_b64_tr_b16 v[102:103], v5 offset:2304
    ds_read_b64_tr_b16 v[104:105], v5 offset:4096
    ds_read_b64_tr_b16 v[106:107], v5 offset:4352
    ds_read_b64_tr_b16 v[108:109], v5 offset:6144
    ds_read_b64_tr_b16 v[110:111], v5 offset:6400
    ds_read_b64_tr_b16 v[112:113], v5 offset:8192
    ds_read_b64_tr_b16 v[114:115], v5 offset:8448
    ds_read_b64_tr_b16 v[116:117], v5 offset:10240
    ds_read_b64_tr_b16 v[118:119], v5 offset:10496
    ds_read_b64_tr_b16 v[120:121], v5 offset:12288
    ds_read_b64_tr_b16 v[122:123], v5 offset:12544
    ds_read_b64_tr_b16 v[124:125], v5 offset:14336
    ds_read_b64_tr_b16 v[126:127], v5 offset:14592
    ds_read_b64_tr_b16 v[128:129], v5 offset:16384
    ds_read_b64_tr_b16 v[130:131], v5 offset:16640
    ds_read_b64_tr_b16 v[132:133], v5 offset:18432
    ds_read_b64_tr_b16 v[134:135], v5 offset:18688
    ds_read_b64_tr_b16 v[136:137], v5 offset:20480
    ds_read_b64_tr_b16 v[138:139], v5 offset:20736
    ds_read_b64_tr_b16 v[140:141], v5 offset:22528
    ds_read_b64_tr_b16 v[142:143], v5 offset:22784
    ds_read_b64_tr_b16 v[144:145], v5 offset:24576
    ds_read_b64_tr_b16 v[146:147], v5 offset:24832
    ds_read_b64_tr_b16 v[148:149], v5 offset:26624
    ds_read_b64_tr_b16 v[150:151], v5 offset:26880
    ds_read_b64_tr_b16 v[152:153], v5 offset:28672
    ds_read_b64_tr_b16 v[154:155], v5 offset:28928
    ds_read_b64_tr_b16 v[156:157], v5 offset:30720
    ds_read_b64_tr_b16 v[158:159], v5 offset:30976
    ds_read_b64_tr_b16 v[160:161], v5 offset:32768
    ds_read_b64_tr_b16 v[162:163], v5 offset:33024
    ds_read_b64_tr_b16 v[164:165], v5 offset:34816
    ds_read_b64_tr_b16 v[166:167], v5 offset:35072
    ds_read_b64_tr_b16 v[168:169], v5 offset:36864
    ds_read_b64_tr_b16 v[170:171], v5 offset:37120
    ds_read_b64_tr_b16 v[172:173], v5 offset:38912
    ds_read_b64_tr_b16 v[174:175], v5 offset:39168
    s_waitcnt vmcnt(0) lgkmcnt(0)
    s_mov_b64 exec, 1
    ds_add_u32 v12, v13 offset:60
    s_mov_b64 exec, -1
    s_mov_b32 s3, 1048576
K_FGK:
    ds_read_b32 v2, v12 offset:48
    s_sleep 1
    s_sub_u32 s3, s3, 1
    s_waitcnt lgkmcnt(0)
    v_readfirstlane_b32 s33, v2
    s_nop 3
    s_cselect_b32 s33, 1, s33
    s_cmp_lt_u32 s33, 1
    s_cbranch_scc1 K_FGK
    ds_read_b128 v[188:191], v234 offset:0
    ds_read_b128 v[192:195], v234 offset:64
    ds_read_b128 v[196:199], v234 offset:128
    ds_read_b128 v[200:203], v234 offset:192
    ds_read_b128 v[204:207], v234 offset:256
    ds_read_b128 v[208:211], v234 offset:320
    ds_read_b128 v[212:215], v234 offset:384
    ds_read_b128 v[216:219], v234 offset:448
    s_waitcnt lgkmcnt(7)
    v_mfma_f32_16x16x32_bf16 v[220:223], v[16:19], v[188:191], 0
    v_mfma_f32_16x16x32_bf16 v[224:227], v[96:99], v[188:191], 0
    ds_read_b128 v[188:191], v234 offset:512
    s_waitcnt lgkmcnt(7)
    v_mfma_f32_16x16x32_bf16 v[220:223], v[20:23], v[192:195], v[220:223]
    v_mfma_f32_16x16x32_bf16 v[224:227], v[100:103], v[192:195], v[224:227]
    ds_read_b128 v[192:195], v234 offset:576
    s_waitcnt lgkmcnt(7)
    v_mfma_f32_16x16x32_bf16 v[220:223], v[24:27], v[196:199], v[220:223]
    v_mfma_f32_16x16x32_bf16 v[224:227], v[104:107], v[196:199], v[224:227]
    ds_read_b128 v[196:199], v234 offset:640
    s_waitcnt lgkmcnt(7)
    v_mfma_f32_16x16x32_bf16 v[220:223], v[28:31], v[200:203], v[220:223]
    v_mfma_f32_16x16x32_bf16 v[224:227], v[108:111], v[200:203], v[224:227]
    ds_read_b128 v[200:203], v234 offset:704
    s_waitcnt lgkmcnt(7)
    v_mfma_f32_16x16x32_bf16 v[220:223], v[32:35], v[204:207], v[220:223]
    v_mfma_f32_16x16x32_bf16 v[224:227], v[112:115], v[204:207], v[224:227]
    ds_read_b128 v[204:207], v234 offset:768
    s_waitcnt lgkmcnt(7)
    v_mfma_f32_16x16x32_bf16 v[220:223], v[36:39], v[208:211], v[220:223]
    v_mfma_f32_16x16x32_bf16 v[224:227], v[116:119], v[208:211], v[224:227]
    ds_read_b128 v[208:211], v234 offset:832
    s_waitcnt lgkmcnt(7)
    v_mfma_f32_16x16x32_bf16 v[220:223], v[40:43], v[212:215], v[220:223]
    v_mfma_f32_16x16x32_bf16 v[224:227], v[120:123], v[212:215], v[224:227]
    ds_read_b128 v[212:215], v234 offset:896
    s_waitcnt lgkmcnt(7)
    v_mfma_f32_16x16x32_bf16 v[220:223], v[44:47], v[216:219], v[220:223]
    v_mfma_f32_16x16x32_bf16 v[224:227], v[124:127], v[216:219], v[224:227]
    ds_read_b128 v[216:219], v234 offset:960
    s_waitcnt lgkmcnt(7)
    v_mfma_f32_16x16x32_bf16 v[220:223], v[48:51], v[188:191], v[220:223]
    v_mfma_f32_16x16x32_bf16 v[224:227], v[128:131], v[188:191], v[224:227]
    ds_read_b128 v[188:191], v234 offset:1024
    s_waitcnt lgkmcnt(7)
    v_mfma_f32_16x16x32_bf16 v[220:223], v[52:55], v[192:195], v[220:223]
    v_mfma_f32_16x16x32_bf16 v[224:227], v[132:135], v[192:195], v[224:227]
    ds_read_b128 v[192:195], v234 offset:1088
    s_waitcnt lgkmcnt(7)
    v_mfma_f32_16x16x32_bf16 v[220:223], v[56:59], v[196:199], v[220:223]
    v_mfma_f32_16x16x32_bf16 v[224:227], v[136:139], v[196:199], v[224:227]
    ds_read_b128 v[196:199], v234 offset:1152
    s_waitcnt lgkmcnt(7)
    v_mfma_f32_16x16x32_bf16 v[220:223], v[60:63], v[200:203], v[220:223]
    v_mfma_f32_16x16x32_bf16 v[224:227], v[140:143], v[200:203], v[224:227]
    ds_read_b128 v[200:203], v234 offset:1216
    s_waitcnt lgkmcnt(7)
    v_mfma_f32_16x16x32_bf16 v[220:223], v[64:67], v[204:207], v[220:223]
    v_mfma_f32_16x16x32_bf16 v[224:227], v[144:147], v[204:207], v[224:227]
    s_waitcnt lgkmcnt(6)
    v_mfma_f32_16x16x32_bf16 v[220:223], v[68:71], v[208:211], v[220:223]
    v_mfma_f32_16x16x32_bf16 v[224:227], v[148:151], v[208:211], v[224:227]
    s_waitcnt lgkmcnt(5)
    v_mfma_f32_16x16x32_bf16 v[220:223], v[72:75], v[212:215], v[220:223]
    v_mfma_f32_16x16x32_bf16 v[224:227], v[152:155], v[212:215], v[224:227]
    s_waitcnt lgkmcnt(4)
    v_mfma_f32_16x16x32_bf16 v[220:223], v[76:79], v[216:219], v[220:223]
    v_mfma_f32_16x16x32_bf16 v[224:227], v[156:159], v[216:219], v[224:227]
    s_waitcnt lgkmcnt(3)
    v_mfma_f32_16x16x32_bf16 v[220:223], v[80:83], v[188:191], v[220:223]
    v_mfma_f32_16x16x32_bf16 v[224:227], v[160:163], v[188:191], v[224:227]
    s_waitcnt lgkmcnt(2)
    v_mfma_f32_16x16x32_bf16 v[220:223], v[84:87], v[192:195], v[220:223]
    v_mfma_f32_16x16x32_bf16 v[224:227], v[164:167], v[192:195], v[224:227]
    s_waitcnt lgkmcnt(1)
    v_mfma_f32_16x16x32_bf16 v[220:223], v[88:91], v[196:199], v[220:223]
    v_mfma_f32_16x16x32_bf16 v[224:227], v[168:171], v[196:199], v[224:227]
    s_waitcnt lgkmcnt(0)
    v_mfma_f32_16x16x32_bf16 v[220:223], v[92:95], v[200:203], v[220:223]
    v_mfma_f32_16x16x32_bf16 v[224:227], v[172:175], v[200:203], v[224:227]
    s_mov_b32 s3, 1048576
K_FGDN:
    ds_read_b32 v2, v12 offset:52
    s_sleep 1
    s_sub_u32 s3, s3, 1
    s_waitcnt lgkmcnt(0)
    v_readfirstlane_b32 s33, v2
    s_nop 3
    s_cselect_b32 s33, 3, s33
    s_cmp_lt_u32 s33, 3
    s_cbranch_scc1 K_FGDN
    ds_read_b64_tr_b16 v[16:17], v238 offset:0
    ds_read_b64_tr_b16 v[18:19], v238 offset:2048
    ds_read_b64_tr_b16 v[20:21], v239 offset:0
    ds_read_b64_tr_b16 v[22:23], v239 offset:2048
    ds_read_b64_tr_b16 v[24:25], v240 offset:0
    ds_read_b64_tr_b16 v[26:27], v240 offset:2048
    ds_read_b64_tr_b16 v[28:29], v241 offset:0
    ds_read_b64_tr_b16 v[30:31], v241 offset:2048
    ds_read_b64_tr_b16 v[32:33], v238 offset:4096
    ds_read_b64_tr_b16 v[34:35], v238 offset:6144
    ds_read_b64_tr_b16 v[36:37], v239 offset:4096
    ds_read_b64_tr_b16 v[38:39], v239 offset:6144
    ds_read_b64_tr_b16 v[40:41], v240 offset:4096
    ds_read_b64_tr_b16 v[42:43], v240 offset:6144
    v_cvt_pk_bf16_f32 v221, v220, v221
    v_lshlrev_b32 v220, 16, v221
    v_and_b32 v221, 0xffff0000, v221
    v_cvt_pk_bf16_f32 v223, v222, v223
    v_lshlrev_b32 v222, 16, v223
    v_and_b32 v223, 0xffff0000, v223
    v_cvt_pk_bf16_f32 v225, v224, v225
    v_lshlrev_b32 v224, 16, v225
    v_and_b32 v225, 0xffff0000, v225
    v_cvt_pk_bf16_f32 v227, v226, v227
    v_lshlrev_b32 v226, 16, v227
    v_and_b32 v227, 0xffff0000, v227
    v_mul_f32 v188, 0xbfb8aa3b, v220
    v_mul_f32 v189, 0xbfb8aa3b, v221
    v_mul_f32 v190, 0xbfb8aa3b, v222
    v_mul_f32 v191, 0xbfb8aa3b, v223
    v_exp_f32 v188, v188
    v_exp_f32 v189, v189
    v_exp_f32 v190, v190
    v_exp_f32 v191, v191
    v_add_f32 v188, 1.0, v188
    v_add_f32 v189, 1.0, v189
    v_add_f32 v190, 1.0, v190
    v_add_f32 v191, 1.0, v191
    v_rcp_f32 v188, v188
    v_rcp_f32 v189, v189
    v_rcp_f32 v190, v190
    v_rcp_f32 v191, v191
    v_mul_f32 v220, v220, v188
    v_mul_f32 v221, v221, v189
    v_mul_f32 v222, v222, v190
    v_mul_f32 v223, v223, v191
    v_cvt_pk_bf16_f32 v221, v220, v221
    v_lshlrev_b32 v220, 16, v221
    v_and_b32 v221, 0xffff0000, v221
    v_cvt_pk_bf16_f32 v223, v222, v223
    v_lshlrev_b32 v222, 16, v223
    v_and_b32 v223, 0xffff0000, v223
    v_mul_f32 v220, v220, v224
    v_mul_f32 v221, v221, v225
    v_mul_f32 v222, v222, v226
    v_mul_f32 v223, v223, v227
    v_cvt_pk_bf16_f32 v228, v220, v221
    v_cvt_pk_bf16_f32 v229, v222, v223
    ds_write_b64 v235, v[228:229]
    s_mov_b64 exec, 1
    ds_add_u32 v12, v13 offset:52
    s_mov_b64 exec, -1
    ds_read_b64_tr_b16 v[44:45], v241 offset:4096
    ds_read_b64_tr_b16 v[46:47], v241 offset:6144
    ds_read_b64_tr_b16 v[48:49], v238 offset:8192
    ds_read_b64_tr_b16 v[50:51], v238 offset:10240
    ds_read_b64_tr_b16 v[52:53], v239 offset:8192
    ds_read_b64_tr_b16 v[54:55], v239 offset:10240
    ds_read_b64_tr_b16 v[56:57], v240 offset:8192
    ds_read_b64_tr_b16 v[58:59], v240 offset:10240
    ds_read_b64_tr_b16 v[60:61], v241 offset:8192
    ds_read_b64_tr_b16 v[62:63], v241 offset:10240
    ds_read_b64_tr_b16 v[64:65], v238 offset:12288
    ds_read_b64_tr_b16 v[66:67], v238 offset:14336
    ds_read_b64_tr_b16 v[68:69], v239 offset:12288
    ds_read_b64_tr_b16 v[70:71], v239 offset:14336
    ds_read_b64_tr_b16 v[72:73], v240 offset:12288
    ds_read_b64_tr_b16 v[74:75], v240 offset:14336
    ds_read_b64_tr_b16 v[76:77], v241 offset:12288
    ds_read_b64_tr_b16 v[78:79], v241 offset:14336
    ds_read_b64_tr_b16 v[80:81], v238 offset:16384
    ds_read_b64_tr_b16 v[82:83], v238 offset:18432
    ds_read_b64_tr_b16 v[84:85], v239 offset:16384
    ds_read_b64_tr_b16 v[86:87], v239 offset:18432
    ds_read_b64_tr_b16 v[88:89], v240 offset:16384
    ds_read_b64_tr_b16 v[90:91], v240 offset:18432
    ds_read_b64_tr_b16 v[92:93], v241 offset:16384
    ds_read_b64_tr_b16 v[94:95], v241 offset:18432
    s_mov_b32 s3, 1048576
K_FGP:
    ds_read_b32 v2, v12 offset:52
    s_sleep 0
    s_sub_u32 s3, s3, 1
    s_waitcnt lgkmcnt(0)
    v_readfirstlane_b32 s33, v2
    s_nop 3
    s_cselect_b32 s33, 5, s33
    s_cmp_lt_u32 s33, 5
    s_cbranch_scc1 K_FGP
    ds_read_b128 v[228:231], v236
    s_waitcnt lgkmcnt(0)
    v_mfma_f32_16x16x32_bf16 v[96:99], v[16:19], v[228:231], 0
    v_mfma_f32_16x16x32_bf16 v[100:103], v[20:23], v[228:231], 0
    v_mfma_f32_16x16x32_bf16 v[104:107], v[24:27], v[228:231], 0
    v_mfma_f32_16x16x32_bf16 v[108:111], v[28:31], v[228:231], 0
    v_mfma_f32_16x16x32_bf16 v[112:115], v[32:35], v[228:231], 0
    v_mfma_f32_16x16x32_bf16 v[116:119], v[36:39], v[228:231], 0
    v_mfma_f32_16x16x32_bf16 v[120:123], v[40:43], v[228:231], 0
    v_mfma_f32_16x16x32_bf16 v[124:127], v[44:47], v[228:231], 0
    v_mfma_f32_16x16x32_bf16 v[128:131], v[48:51], v[228:231], 0
    v_mfma_f32_16x16x32_bf16 v[132:135], v[52:55], v[228:231], 0
    v_mfma_f32_16x16x32_bf16 v[136:139], v[56:59], v[228:231], 0
    v_mfma_f32_16x16x32_bf16 v[140:143], v[60:63], v[228:231], 0
    v_mfma_f32_16x16x32_bf16 v[144:147], v[64:67], v[228:231], 0
    v_mfma_f32_16x16x32_bf16 v[148:151], v[68:71], v[228:231], 0
    v_mfma_f32_16x16x32_bf16 v[152:155], v[72:75], v[228:231], 0
    v_mfma_f32_16x16x32_bf16 v[156:159], v[76:79], v[228:231], 0
    v_mfma_f32_16x16x32_bf16 v[160:163], v[80:83], v[228:231], 0
    v_mfma_f32_16x16x32_bf16 v[164:167], v[84:87], v[228:231], 0
    v_mfma_f32_16x16x32_bf16 v[168:171], v[88:91], v[228:231], 0
    v_mfma_f32_16x16x32_bf16 v[172:175], v[92:95], v[228:231], 0
    s_mov_b32 exec_lo, 0x00030003
    s_mov_b32 exec_hi, 0x00030003
    buffer_store_dwordx4 v[96:99], v237, s[64:67], s72 offen offset:0 sc1
    buffer_store_dwordx4 v[100:103], v237, s[64:67], s72 offen offset:64 sc1
    buffer_store_dwordx4 v[104:107], v237, s[64:67], s72 offen offset:128 sc1
    buffer_store_dwordx4 v[108:111], v237, s[64:67], s72 offen offset:192 sc1
    buffer_store_dwordx4 v[112:115], v237, s[64:67], s72 offen offset:256 sc1
    buffer_store_dwordx4 v[116:119], v237, s[64:67], s72 offen offset:320 sc1
    buffer_store_dwordx4 v[120:123], v237, s[64:67], s72 offen offset:384 sc1
    buffer_store_dwordx4 v[124:127], v237, s[64:67], s72 offen offset:448 sc1
    buffer_store_dwordx4 v[128:131], v237, s[64:67], s72 offen offset:512 sc1
    buffer_store_dwordx4 v[132:135], v237, s[64:67], s72 offen offset:576 sc1
    buffer_store_dwordx4 v[136:139], v237, s[64:67], s72 offen offset:640 sc1
    buffer_store_dwordx4 v[140:143], v237, s[64:67], s72 offen offset:704 sc1
    buffer_store_dwordx4 v[144:147], v237, s[64:67], s72 offen offset:768 sc1
    buffer_store_dwordx4 v[148:151], v237, s[64:67], s72 offen offset:832 sc1
    buffer_store_dwordx4 v[152:155], v237, s[64:67], s72 offen offset:896 sc1
    buffer_store_dwordx4 v[156:159], v237, s[64:67], s72 offen offset:960 sc1
    buffer_store_dwordx4 v[160:163], v237, s[64:67], s72 offen offset:1024 sc1
    buffer_store_dwordx4 v[164:167], v237, s[64:67], s72 offen offset:1088 sc1
    buffer_store_dwordx4 v[168:171], v237, s[64:67], s72 offen offset:1152 sc1
    buffer_store_dwordx4 v[172:175], v237, s[64:67], s72 offen offset:1216 sc1
    s_mov_b64 exec, -1
    s_mul_i32 s3, s73, 2560
    s_lshl2_add_u32 s3, s44, s3
    s_add_u32 s3, s3, 568320
    v_lshl_add_u32 v2, v1, 8, s3
    s_mov_b64 exec, 0x3ff
    s_waitcnt vmcnt(0)
    global_store_dword v2, v13, s[10:11] sc1
    s_mov_b64 exec, -1
    s_branch K_P2_HELP
K_CODE_END:
.section .rodata,"a"
.p2align 6
.amdhsa_kernel gated_mix__sliding_local_dilated__moe_arch_mod__prompt_kernel
  .amdhsa_next_free_vgpr 248
  .amdhsa_next_free_sgpr 79
  .amdhsa_accum_offset 248
  .amdhsa_group_segment_fixed_size 0
  .amdhsa_kernarg_size 96
  .amdhsa_user_sgpr_count 2
  .amdhsa_user_sgpr_kernarg_segment_ptr 1
  .amdhsa_system_sgpr_workgroup_id_x 1
.end_amdhsa_kernel
```

```asm
; @launch grid=(256,1,1) block=(512,1,1) lds=163840
.amdgcn_target "amdgcn-amd-amdhsa--gfx950"
.text
.p2align 12
.p2align 8
.globl gated_mix__sliding_local_dilated__moe_arch_mod__prompt_kernel
.type gated_mix__sliding_local_dilated__moe_arch_mod__prompt_kernel,@function
gated_mix__sliding_local_dilated__moe_arch_mod__prompt_kernel:
    s_cmp_ge_u32 s2, 256
    s_cbranch_scc1 K_EXIT
    s_load_dwordx2 s[12:13], s[0:1], 0
    s_load_dwordx2 s[16:17], s[0:1], 8
    v_readfirstlane_b32 s30, v0
    s_load_dwordx4 s[8:11], s[0:1], 80
    s_load_dwordx2 s[24:25], s[0:1], 16
    s_load_dwordx2 s[6:7], s[0:1], 72
    s_and_b32 s28, s2, 7
    v_and_b32 v1, 63, v0
    s_mov_b32 s14, 0x280000
    s_mov_b32 s15, 0x20000
    s_lshr_b32 s30, s30, 6
    s_cmp_lt_u32 s2, 64
    s_cbranch_scc1 K_SLOW
    s_cmp_lt_u32 s30, 4
    s_cbranch_scc1 K_FAST
K_SLOW:
    s_getpc_b64 s[38:39]
K_PC:
    s_bfe_u32 s3, s2, 0x30003
    s_mul_i32 s3, s3, ((K_CODE_END-gated_mix__sliding_local_dilated__moe_arch_mod__prompt_kernel+1023)/1024)
    s_sub_u32 s38, s38, K_PC-gated_mix__sliding_local_dilated__moe_arch_mod__prompt_kernel
    s_subb_u32 s39, s39, 0
    v_subrev_u32 v3, 256, v0
    v_add_u32 v2, s3, v3
    v_lshlrev_b32 v2, 7, v2
    v_min_u32 v2, K_CODE_END-gated_mix__sliding_local_dilated__moe_arch_mod__prompt_kernel-4, v2
    v_cmp_gt_u32 vcc, ((K_CODE_END-gated_mix__sliding_local_dilated__moe_arch_mod__prompt_kernel+1023)/1024), v3
    s_and_saveexec_b64 s[4:5], vcc
    s_cbranch_execz K_NOPF
    global_load_dword v6, v2, s[38:39]
K_NOPF:
    s_mov_b64 exec, -1
    v_mov_b64 v[2:3], 0
    v_mov_b64 v[4:5], 0
    v_mov_b32 v7, 158752
    ds_write_b128 v7, v[2:5] offset:0
    ds_write_b128 v7, v[2:5] offset:16
    ds_write_b128 v7, v[2:5] offset:32
    ds_write_b128 v7, v[2:5] offset:48
    s_mov_b32 s43, 1
    s_lshl_b32 s3, s30, 8
    s_add_u32 s3, s3, s2
    s_lshr_b32 s3, s3, 3
    s_cmp_lg_u32 s3, 160
    s_cbranch_scc1 K_COMMON
    s_mul_i32 s3, s2, 6144
    s_add_u32 s3, s3, 527360
    v_lshl_add_u32 v6, v1, 4, s3
    v_mov_b64 v[24:25], 0
    v_mov_b64 v[26:27], 0
    s_waitcnt lgkmcnt(0)
    global_store_dwordx4 v6, v[24:27], s[10:11] offset:-3072 sc1
    global_store_dwordx4 v6, v[24:27], s[10:11] offset:-2048 sc1
    global_store_dwordx4 v6, v[24:27], s[10:11] offset:-1024 sc1
    global_store_dwordx4 v6, v[24:27], s[10:11] offset:0 sc1
    global_store_dwordx4 v6, v[24:27], s[10:11] offset:1024 sc1
    global_store_dwordx4 v6, v[24:27], s[10:11] offset:2048 sc1
    s_lshl_b32 s3, s2, 2
    v_mov_b32 v2, s3
    v_mov_b32 v3, 1
    s_mov_b64 exec, 1
    s_waitcnt vmcnt(0)
    global_store_dword v2, v3, s[8:9] offset:192 sc1
    s_mov_b64 exec, -1
    s_branch K_COMMON
K_FAST:
    s_lshr_b32 s32, s2, 1
    s_and_b32 s32, s32, 28
    v_lshrrev_b32 v3, 4, v1
    s_lshr_b32 s3, s2, 6
    s_mov_b32 s59, 0x59608237
    s_cmp_eq_u32 s3, 2
    s_cselect_b32 s59, 0x26375904, s59
    v_and_b32 v4, 7, v1
    s_cmp_eq_u32 s3, 3
    s_cselect_b32 s59, 0x93042671, s59
    v_lshrrev_b32 v2, 3, v1
    s_lshr_b32 s59, s59, s32
    s_and_b32 s59, s59, 15
    v_xor_b32 v4, v4, v3
    s_lshl_b32 s33, s28, 2
    s_lshr_b32 s33, 0x76543210, s33
    s_and_b32 s33, s33, 15
    s_add_u32 s59, s59, s33
    s_cmp_ge_u32 s59, 10
    v_mul_u32_u24 v2, 1280, v2
    s_cselect_b32 s33, 10, 0
    s_sub_u32 s59, s59, s33
    s_lshr_b32 s53, s28, 1
    v_lshl_add_u32 v40, v4, 4, v2
    s_mul_i32 s53, s53, 655360
    s_lshl2_add_u32 s62, s3, s30
    s_cmp_eq_u32 s62, 15
    s_cselect_b32 s62, 0x800000, 0
    s_add_u32 s62, s62, 40960
    s_mul_i32 s3, s3, 225280
    v_xor_b32 v41, 64, v40
    s_add_u32 s53, s53, s3
    s_mul_i32 s54, s30, 61440
    s_add_u32 s53, s53, s54
    s_sub_u32 s53, s53, 245760
    s_mul_i32 s55, s30, 6144
    s_add_u32 s55, s55, 49152
    s_lshl_b32 s57, s59, 7
    s_add_u32 s57, s57, s53
    s_waitcnt lgkmcnt(0)
    s_add_u32 m0, s55, 0
    s_max_i32 s60, s57, 0
    buffer_load_dwordx4 v40, s[12:15], s60 offen lds
    s_add_u32 s60, s57, 10240
    s_add_u32 m0, s55, 1024
    s_max_i32 s60, s60, 0
    buffer_load_dwordx4 v41, s[12:15], s60 offen lds
    s_add_u32 m0, s55, 2048
    s_add_u32 s60, s57, 20480
    buffer_load_dwordx4 v40, s[12:15], s60 offen lds
    s_add_u32 m0, s55, 3072
    s_add_u32 s60, s57, 30720
    buffer_load_dwordx4 v41, s[12:15], s60 offen lds
    s_add_u32 m0, s55, 4096
    s_add_u32 s60, s57, s62
    buffer_load_dwordx4 v40, s[12:15], s60 offen lds
    s_add_u32 m0, s55, 5120
    s_add_u32 s60, s60, 10240
    buffer_load_dwordx4 v41, s[12:15], s60 offen lds
    v_lshlrev_b32 v2, 1, v3
    s_lshr_b32 s32, 0x64317520, s32
    v_sub_u32 v2, v1, v2
    s_and_b32 s32, s32, 7
    v_and_b32 v2, 15, v2
    s_and_b32 s3, s28, 1
    v_mul_u32_u24 v3, 3840, v3
    s_lshl3_add_u32 s32, s3, s32
    v_mul_u32_u24 v4, 13, v2
    s_mul_i32 s3, s32, 80
    v_lshrrev_b32 v4, 6, v4
    s_add_u32 s54, s54, s3
    v_mul_u32_u24 v4, 1200, v4
    s_lshl_b32 s56, s30, 12
    v_lshl_add_u32 v4, v2, 4, v4
    s_add_u32 s56, s56, 106496
    v_add_u32 v5, 1, v2
    s_mov_b32 s18, 0x258000
    v_and_b32 v5, 16, v5
    s_mov_b32 s19, 0x20000
    v_lshl_add_u32 v4, v5, 24, v4
    v_add_u32 v42, v3, v4
    s_mul_i32 s58, s59, 245760
    s_add_u32 s58, s58, s54
    s_add_u32 s59, s59, 1
    s_cmp_eq_u32 s59, 10
    s_cselect_b32 s59, 0, s59
    s_add_u32 m0, s56, 0
    s_add_u32 s60, s58, 0
    buffer_load_dwordx4 v42, s[16:19], s60 offen lds
    s_add_u32 m0, s56, 1024
    s_add_u32 s60, s58, 15360
    buffer_load_dwordx4 v42, s[16:19], s60 offen lds
    v_xor_b32 v2, 8, v2
    v_mul_u32_u24 v4, 13, v2
    v_lshrrev_b32 v4, 6, v4
    v_mul_u32_u24 v4, 1200, v4
    v_lshl_add_u32 v4, v2, 4, v4
    v_add_u32 v5, 1, v2
    v_and_b32 v5, 16, v5
    v_lshl_add_u32 v4, v5, 24, v4
    v_add_u32 v43, v3, v4
    s_add_u32 m0, s56, 2048
    s_add_u32 s60, s58, 30720
    buffer_load_dwordx4 v43, s[16:19], s60 offen lds
    s_add_u32 m0, s56, 3072
    s_add_u32 s60, s58, 46080
    buffer_load_dwordx4 v43, s[16:19], s60 offen lds
    s_mov_b32 s52, s30
    s_mov_b32 s43, 0
K_COMMON:
    v_mov_b32 v7, 0
    s_lshr_b32 s29, s2, 3
    s_xor_b32 s30, s30, 4
    s_mov_b32 s26, 0xc8000
    s_mov_b32 s27, 0x20000
    s_lshr_b32 s34, s29, 3
    s_lshl_b32 s34, s34, 2
    s_and_b32 s3, s29, 3
    s_add_u32 s34, s34, s3
    s_add_u32 s34, s34, 4
    s_bitcmp1_b32 s29, 2
    s_cselect_b32 s34, -1, s34
    s_cmp_lt_u32 s29, 8
    s_cselect_b32 s34, s29, s34
    s_lshl_b32 s40, s28, 1
    s_cmp_ge_u32 s34, 10
    s_addc_u32 s40, s40, 0
    s_sub_u32 s41, s34, 10
    s_cmp_ge_u32 s34, 10
    s_cselect_b32 s41, s41, s34
    s_mul_i32 s42, s28, 20
    s_add_u32 s42, s42, s34
    s_and_b32 s42, s42, 255
    s_lshl_b32 s42, s42, 8
    s_add_u32 s42, s42, 524288
    s_cmp_lt_u32 s29, 8
    s_cbranch_scc1 K_AUX
    s_lshr_b32 s31, s29, 3
    s_sub_u32 s31, s31, 1
    s_and_b32 s35, s29, 3
    s_and_b32 s3, s29, 4
    s_lshl_b32 s3, s3, 1
    s_add_u32 s35, s35, s3
    s_and_b32 s3, s28, 1
    s_lshl_b32 s3, s3, 2
    s_add_u32 s35, s35, s3
    v_and_b32 v9, 15, v1
    v_lshrrev_b32 v10, 4, v1
    v_bfe_u32 v11, v1, 2, 2
    v_and_b32 v12, 3, v1
    s_waitcnt lgkmcnt(0)
    s_add_u32 s20, s10, 0x100000
    s_addc_u32 s21, s11, 0
    s_mov_b32 s22, 0x280000
    s_mov_b32 s23, 0x20000
    s_and_b32 s3, s30, 3
    s_mul_i32 s3, s3, 3
    s_lshr_b32 s33, s30, 2
    s_lshl1_add_u32 s3, s33, s3
    s_mul_i32 s44, s31, 11
    s_add_u32 s44, s44, s3
    s_cmp_eq_u32 s44, 31
    s_cselect_b32 s51, 4, s30
    s_lshr_b32 s33, s28, 1
    s_lshl_b32 s33, s33, 5
    s_add_u32 s44, s44, s33
    s_lshl_b32 s3, s3, 10
    s_add_u32 s3, s3, 122880
    v_lshl_add_u32 v13, v1, 4, s3
    v_lshl_add_u32 v2, v9, 4, s3
    v_add_u32 v2, 520, v2
    v_add_u32 v3, 512, v13
    v_cmp_eq_u32 vcc, 0, v10
    s_nop 1
    v_cndmask_b32 v18, v2, v3, vcc
    v_cmp_eq_u32 vcc, 1, v10
    s_nop 1
    v_cndmask_b32 v19, v2, v3, vcc
    v_lshl_add_u32 v5, v10, 2, v11
    v_lshl_add_u32 v5, v5, 4, s3
    v_add_u32 v2, 520, v5
    v_add_u32 v3, 8, v5
    v_add_u32 v4, 264, v5
    s_cmp_lt_u32 s30, 4
    s_cselect_b32 s33, 0, 3
    s_sub_u32 s33, s30, s33
    s_mul_i32 s33, s33, 5120
    s_add_u32 s33, s33, 79872
    v_lshl_add_u32 v14, v1, 3, s33
    v_cmp_eq_u32 vcc, 0, v12
    s_nop 1
    v_cndmask_b32 v20, v2, v3, vcc
    v_cmp_eq_u32 vcc, 1, v12
    s_nop 1
    v_cndmask_b32 v21, v2, v4, vcc
    v_cmp_eq_u32 vcc, 2, v12
    s_nop 1
    v_cndmask_b32 v22, v2, v3, vcc
    v_cmp_eq_u32 vcc, 3, v12
    s_nop 1
    v_cndmask_b32 v23, v2, v4, vcc
    s_lshl_b32 s3, s35, 10
    v_lshl_add_u32 v15, v1, 4, s3
    s_lshl_b32 s3, s35, 8
    s_add_u32 s3, s3, 16384
    v_lshl_add_u32 v16, v9, 4, s3
    v_and_b32 v2, 1, v10
    v_lshl_add_u32 v16, v2, 23, v16
    s_cmp_lt_u32 s51, 4
    s_cselect_b32 s3, 0, 0x800000
    s_add_u32 s3, s3, 20480
    v_lshrrev_b32 v2, 1, v10
    v_mad_u32_u24 v16, v2, s3, v16
    s_mul_i32 s50, s44, 20480
    s_add_u32 s51, s50, s3
    v_mov_b32 v17, 0xf149f2ca
    v_lshlrev_b32 v2, 2, v10
    v_sub_u32 v2, v9, v2
    s_cmp_eq_u32 s44, 0
    s_cselect_b32 s3, 0xf149f2ca, 0
    v_subrev_u32 v3, 0, v2
    v_and_b32 v4, 0x80000001, v3
    v_cmp_eq_u32 vcc, 0, v4
    s_nop 1
    v_cndmask_b32 v28, v17, 0, vcc
    v_cmp_eq_u32 vcc, 0x80000000, v4
    s_nop 1
    v_cndmask_b32 v24, v17, 0, vcc
    v_add_f32 v32, s3, v24
    v_subrev_u32 v3, 1, v2
    v_and_b32 v4, 0x80000001, v3
    v_cmp_eq_u32 vcc, 0, v4
    s_nop 1
    v_cndmask_b32 v29, v17, 0, vcc
    v_cmp_eq_u32 vcc, 0x80000000, v4
    s_nop 1
    v_cndmask_b32 v25, v17, 0, vcc
    v_add_f32 v33, s3, v25
    v_subrev_u32 v3, 2, v2
    v_and_b32 v4, 0x80000001, v3
    v_cmp_eq_u32 vcc, 0, v4
    s_nop 1
    v_cndmask_b32 v30, v17, 0, vcc
    v_cmp_eq_u32 vcc, 0x80000000, v4
    s_nop 1
    v_cndmask_b32 v26, v17, 0, vcc
    v_add_f32 v34, s3, v26
    v_subrev_u32 v3, 3, v2
    v_and_b32 v4, 0x80000001, v3
    v_cmp_eq_u32 vcc, 0, v4
    s_nop 1
    v_cndmask_b32 v31, v17, 0, vcc
    v_cmp_eq_u32 vcc, 0x80000000, v4
    s_nop 1
    v_cndmask_b32 v27, v17, 0, vcc
    v_add_f32 v35, s3, v27
    v_mov_b32 v3, 0x0c0c0c0c
    v_mov_b32 v4, 0xc0c0100
    v_cmp_eq_u32 vcc, 0, v24
    v_mov_b32 v5, 0x1000c0c
    s_nop 0
    v_cndmask_b32 v3, v3, v4, vcc
    v_cmp_eq_u32 vcc, 0, v25
    s_nop 1
    v_cndmask_b32 v36, v3, v5, vcc
    v_mov_b32 v3, 0x0c0c0c0c
    v_mov_b32 v4, 0xc0c0302
    v_cmp_eq_u32 vcc, 0, v26
    v_mov_b32 v5, 0x3020c0c
    s_nop 0
    v_cndmask_b32 v3, v3, v4, vcc
    v_cmp_eq_u32 vcc, 0, v27
    s_nop 1
    v_cndmask_b32 v37, v3, v5, vcc
    v_mov_b32 v3, 0x0c0c0c0c
    v_mov_b32 v4, 0xc0c0100
    v_cmp_eq_u32 vcc, 0, v28
    v_mov_b32 v5, 0x1000c0c
    s_nop 0
    v_cndmask_b32 v3, v3, v4, vcc
    v_cmp_eq_u32 vcc, 0, v29
    s_nop 1
    v_cndmask_b32 v38, v3, v5, vcc
    v_mov_b32 v3, 0x0c0c0c0c
    v_mov_b32 v4, 0xc0c0302
    v_cmp_eq_u32 vcc, 0, v30
    v_mov_b32 v5, 0x3020c0c
    s_nop 0
    v_cndmask_b32 v3, v3, v4, vcc
    v_cmp_eq_u32 vcc, 0, v31
    s_nop 1
    v_cndmask_b32 v39, v3, v5, vcc
    s_mov_b32 s46, 0x3ea52b5c
    s_mov_b32 s47, s46
    s_mov_b32 s48, 0x3e64f92e
    s_mov_b32 s49, s48
    s_mov_b32 s36, 0xfffff
    s_cmp_lg_u32 s31, 0
    s_cselect_b32 s33, 64, 0
    v_mov_b32 v2, s33
    v_cmp_gt_u32 vcc, 10, v1
    s_lshr_b32 s3, s28, 1
    s_lshl2_add_u32 s3, s3, s31
    v_cndmask_b32 v2, 0, v2, vcc
    v_lshl_add_u32 v2, v1, 8, v2
    s_mul_i32 s3, s3, 2560
    s_lshl2_add_u32 s3, s35, s3
    s_add_u32 s3, s3, 524288
    v_add_u32 v8, s3, v2
    s_cmp_eq_u32 s43, 1
    s_cbranch_scc1 K_CONS
    v_lshrrev_b32 v2, 3, v1
    v_mul_u32_u24 v2, 1280, v2
    v_lshrrev_b32 v3, 4, v1
    v_lshlrev_b32 v3, 1, v3
    v_and_b32 v4, 7, v1
    v_xor_b32 v3, v3, v4
    v_lshl_add_u32 v2, v3, 4, v2
    s_lshl_b32 s33, s41, 7
    v_add_u32 v17, s33, v2
    s_mov_b32 s61, 9
    s_branch K_LOOPE
K_LOOP:
    s_waitcnt vmcnt(5)
    s_barrier
    s_add_u32 m0, s56, 2048
    s_add_u32 s60, s58, 30720
    buffer_load_dwordx4 v43, s[16:19], s60 offen lds
    s_add_u32 m0, s55, 3072
    s_add_u32 s60, s57, 30720
    buffer_load_dwordx4 v41, s[12:15], s60 offen lds
    s_add_u32 m0, s56, 3072
    s_add_u32 s60, s58, 46080
    buffer_load_dwordx4 v43, s[16:19], s60 offen lds
    s_add_u32 m0, s55, 4096
    s_add_u32 s60, s57, s62
    buffer_load_dwordx4 v40, s[12:15], s60 offen lds
    s_add_u32 m0, s55, 5120
    s_add_u32 s60, s60, 10240
    buffer_load_dwordx4 v41, s[12:15], s60 offen lds
    s_sub_u32 s61, s61, 1
    s_cmp_eq_u32 s61, 0
    s_cbranch_scc1 K_LOOPX
K_LOOPE:
    s_cmp_ge_u32 s55, 49152
    s_cselect_b32 s60, -2, 1
    s_mul_i32 s3, s60, 24576
    s_add_u32 s55, s55, s3
    s_lshl_b32 s60, s60, 14
    s_add_u32 s56, s56, s60
    s_lshl_b32 s57, s59, 7
    s_add_u32 s57, s57, s53
    s_mul_i32 s58, s59, 245760
    s_add_u32 s58, s58, s54
    s_add_u32 s59, s59, 1
    s_cmp_eq_u32 s59, 10
    s_cselect_b32 s59, 0, s59
    s_add_u32 m0, s56, 0
    s_add_u32 s60, s58, 0
    buffer_load_dwordx4 v42, s[16:19], s60 offen lds
    s_add_u32 m0, s55, 0
    s_max_i32 s60, s57, 0
    buffer_load_dwordx4 v40, s[12:15], s60 offen lds
    s_add_u32 m0, s56, 1024
    s_add_u32 s60, s58, 15360
    buffer_load_dwordx4 v42, s[16:19], s60 offen lds
    s_add_u32 s60, s57, 10240
    s_add_u32 m0, s55, 1024
    s_max_i32 s60, s60, 0
    buffer_load_dwordx4 v41, s[12:15], s60 offen lds
    s_add_u32 m0, s55, 2048
    s_add_u32 s60, s57, 20480
    buffer_load_dwordx4 v40, s[12:15], s60 offen lds
    s_branch K_LOOP
K_LOOPX:
    v_and_b32 v2, 7, v1
    v_lshlrev_b32 v2, 2, v2
    s_waitcnt vmcnt(0)
    s_barrier
    s_cmp_lt_u32 s30, 6
    s_cbranch_scc1 K_NOSMP
    global_load_dword v7, v2, s[8:9] offset:192 sc1
K_NOSMP:
    s_cmp_eq_u32 s34, -1
    s_cbranch_scc1 K_JOIN_S
    s_cmp_lt_u32 s52, 2
    s_cbranch_scc1 K_WOE
    s_cmp_lg_u32 s30, 7
    s_cbranch_scc1 K_JOIN_S
    s_mov_b32 s52, 2
    s_branch K_W7A
K_WOE:
    s_lshl_b32 s57, s52, 2
    s_lshr_b32 s57, 0x7520, s57
    s_and_b32 s57, s57, 7
    s_mul_i32 s57, s57, 51200
    s_mul_i32 s58, s52, 5120
    s_add_u32 s3, s57, 0
    s_add_u32 m0, s58, 0
    s_nop 0
    buffer_load_dwordx4 v17, s[24:27], s3 offen lds
    s_add_u32 s3, s57, 10240
    s_add_u32 m0, s58, 1024
    s_nop 0
    buffer_load_dwordx4 v17, s[24:27], s3 offen lds
    s_add_u32 s3, s57, 20480
    s_add_u32 m0, s58, 2048
    s_nop 0
    buffer_load_dwordx4 v17, s[24:27], s3 offen lds
    s_add_u32 s3, s57, 30720
    s_add_u32 m0, s58, 3072
    s_nop 0
    buffer_load_dwordx4 v17, s[24:27], s3 offen lds
    s_add_u32 s3, s57, 40960
    s_add_u32 m0, s58, 4096
    s_nop 0
    buffer_load_dwordx4 v17, s[24:27], s3 offen lds
    s_add_u32 s3, s57, 409600
    s_add_u32 m0, s58, 20480
    s_nop 0
    buffer_load_dwordx4 v17, s[24:27], s3 offen lds
    s_add_u32 s3, s57, 419840
    s_add_u32 m0, s58, 21504
    s_nop 0
    buffer_load_dwordx4 v17, s[24:27], s3 offen lds
    s_add_u32 s3, s57, 430080
    s_add_u32 m0, s58, 22528
    s_nop 0
    buffer_load_dwordx4 v17, s[24:27], s3 offen lds
    s_add_u32 s3, s57, 440320
    s_add_u32 m0, s58, 23552
    s_nop 0
    buffer_load_dwordx4 v17, s[24:27], s3 offen lds
    s_add_u32 s3, s57, 450560
    s_add_u32 m0, s58, 24576
    s_nop 0
    buffer_load_dwordx4 v17, s[24:27], s3 offen lds
    s_cmp_lg_u32 s30, 7
    s_cbranch_scc1 K_JOIN_S
    s_add_u32 s52, s52, 1
    s_cmp_lt_u32 s52, 4
    s_cbranch_scc1 K_WOE
    s_mov_b32 s52, 0
K_XD:
    s_lshl_b32 s57, s40, 3
    s_lshl1_add_u32 s57, s52, s57
    s_mul_i32 s57, s57, 20480
    s_lshl_b32 s33, s41, 7
    s_add_u32 s57, s57, s33
    s_lshl_b32 s33, s52, 12
    s_add_u32 m0, s33, 140288
    s_add_u32 s3, s57, 0
    buffer_load_dwordx4 v40, s[12:15], s3 offen lds
    s_add_u32 m0, s33, 141312
    s_add_u32 s3, s57, 10240
    buffer_load_dwordx4 v41, s[12:15], s3 offen lds
    s_add_u32 m0, s33, 142336
    s_add_u32 s3, s57, 20480
    buffer_load_dwordx4 v40, s[12:15], s3 offen lds
    s_add_u32 m0, s33, 143360
    s_add_u32 s3, s57, 30720
    buffer_load_dwordx4 v41, s[12:15], s3 offen lds
    s_add_u32 s52, s52, 1
    s_cmp_lt_u32 s52, 4
    s_cbranch_scc1 K_XD
    s_branch K_W7
.p2align 12
K_CONS:
    v_lshrrev_b32 v2, 1, v9
    v_xor_b32 v2, v2, v10
    v_lshlrev_b32 v2, 4, v2
    v_lshl_add_u32 v2, v9, 7, v2
    s_mul_i32 s3, s30, 6144
    v_add_u32 v40, s3, v2
    v_xor_b32 v41, 64, v40
    v_and_b32 v2, 1, v10
    v_lshl_or_b32 v2, v2, 2, v11
    v_lshlrev_b32 v2, 5, v2
    v_lshl_add_u32 v3, v10, 3, v11
    v_lshlrev_b32 v3, 8, v3
    v_add_u32 v3, 73728, v3
    v_lshlrev_b32 v5, 3, v12
    s_movk_i32 s33, 0xff
    s_mov_b32 s3, 0x48209870
    v_lshrrev_b32 v4, v5, s3
    v_add_u32 v4, v4, v2
    v_and_or_b32 v42, v4, s33, v3
    s_mov_b32 s3, 0xf8f0e8c0
    v_lshrrev_b32 v4, v5, s3
    v_add_u32 v4, v4, v2
    v_and_or_b32 v43, v4, s33, v3
    v_add_u32 v2, v2, v5
    v_add_u32 v4, 80, v2
    v_and_or_b32 v44, v4, s33, v3
    v_add_u32 v4, 120, v2
    v_and_or_b32 v45, v4, s33, v3
    v_add_u32 v4, 0, v2
    v_and_or_b32 v46, v4, s33, v3
    v_add_u32 v4, 40, v2
    v_and_or_b32 v47, v4, s33, v3
    v_add_u32 v4, 160, v2
    v_and_or_b32 v48, v4, s33, v3
    v_add_u32 v4, 200, v2
    v_and_or_b32 v49, v4, s33, v3
    s_lshl_b32 s3, s30, 2
    s_add_u32 s3, s3, 158800
    v_mov_b32 v50, s3
    v_mov_b32 v4, 1
    v_mov_b32 v5, 2
    v_mov_b64 v[52:53], 0
    v_mov_b64 v[54:55], 0
    v_mov_b64 v[56:57], 0
    v_mov_b64 v[58:59], 0
    v_mov_b64 v[60:61], 0
    v_mov_b64 v[62:63], 0
    v_mov_b64 v[64:65], 0
    v_mov_b64 v[66:67], 0
    v_mov_b64 v[68:69], 0
    v_mov_b64 v[70:71], 0
    v_mov_b64 v[72:73], 0
    v_mov_b64 v[74:75], 0
    v_mov_b64 v[76:77], 0
    v_mov_b64 v[78:79], 0
    v_mov_b64 v[80:81], 0
    v_mov_b64 v[82:83], 0
    v_mov_b64 v[84:85], 0
    v_mov_b64 v[86:87], 0
    v_mov_b64 v[88:89], 0
    v_mov_b64 v[90:91], 0
    v_mov_b64 v[92:93], 0
    v_mov_b64 v[94:95], 0
    v_mov_b64 v[96:97], 0
    v_mov_b64 v[98:99], 0
    v_mov_b64 v[100:101], 0
    v_mov_b64 v[102:103], 0
    v_mov_b64 v[104:105], 0
    v_mov_b64 v[106:107], 0
    v_mov_b64 v[108:109], 0
    v_mov_b64 v[110:111], 0
    v_mov_b64 v[112:113], 0
    v_mov_b64 v[114:115], 0
    v_mov_b64 v[116:117], 0
    v_mov_b64 v[118:119], 0
    v_mov_b64 v[120:121], 0
    v_mov_b64 v[122:123], 0
    v_mov_b64 v[124:125], 0
    v_mov_b64 v[126:127], 0
    v_mov_b64 v[128:129], 0
    v_mov_b64 v[130:131], 0
    v_mov_b64 v[132:133], 0
    v_mov_b64 v[134:135], 0
    v_mov_b64 v[136:137], 0
    v_mov_b64 v[138:139], 0
    v_mov_b64 v[140:141], 0
    v_mov_b64 v[142:143], 0
    v_mov_b64 v[144:145], 0
    v_mov_b64 v[146:147], 0
    s_mov_b32 s52, 3
    s_cmp_lg_u32 s30, 0
    s_cbranch_scc1 K_WARMM0
    s_call_b64 s[38:39], WP_attd
    s_call_b64 s[38:39], WP_p2g
    s_branch K_WARMMX
K_WARMM0:
    s_cmp_lg_u32 s30, 1
    s_cbranch_scc1 K_WARMM1
    s_call_b64 s[38:39], WP_atts
    s_call_b64 s[38:39], WP_early
    s_branch K_WARMMX
K_WARMM1:
    s_cmp_lg_u32 s30, 2
    s_cbranch_scc1 K_WARMM2
    s_call_b64 s[38:39], WP_help
    s_call_b64 s[38:39], WP_flags
    s_branch K_WARMMX
K_WARMM2:
    s_call_b64 s[38:39], WP_spin
K_WARMMX:
    s_barrier
    ds_read_b128 v[148:151], v40 offset:49152
    ds_read_b64_tr_b16 v[172:173], v42 offset:32768
    ds_read_b64_tr_b16 v[174:175], v42 offset:33792
    ds_read_b128 v[152:155], v40 offset:51200
    ds_read_b128 v[156:159], v40 offset:53248
    ds_read_b64_tr_b16 v[176:177], v43 offset:32768
    ds_read_b64_tr_b16 v[178:179], v43 offset:33792
    ds_read_b64_tr_b16 v[180:181], v44 offset:32768
    ds_read_b64_tr_b16 v[182:183], v44 offset:33792
    ds_read_b64_tr_b16 v[184:185], v45 offset:32768
    ds_read_b64_tr_b16 v[186:187], v45 offset:33792
    ds_read_b64_tr_b16 v[188:189], v46 offset:32768
    ds_read_b64_tr_b16 v[190:191], v46 offset:33792
    ds_read_b64_tr_b16 v[192:193], v47 offset:32768
    ds_read_b64_tr_b16 v[194:195], v47 offset:33792
    ds_read_b64_tr_b16 v[196:197], v48 offset:32768
    ds_read_b64_tr_b16 v[198:199], v48 offset:33792
    ds_read_b64_tr_b16 v[200:201], v49 offset:32768
    ds_read_b64_tr_b16 v[202:203], v49 offset:33792
K_CLOOP:
    s_waitcnt lgkmcnt(0)
    v_mfma_f32_16x16x32_bf16 v[52:55], v[172:175], v[148:151], v[52:55]
    ds_read_b128 v[160:163], v41 offset:49152
    v_mfma_f32_16x16x32_bf16 v[56:59], v[176:179], v[148:151], v[56:59]
    ds_read_b64_tr_b16 v[204:205], v42 offset:40960
    v_mfma_f32_16x16x32_bf16 v[60:63], v[180:183], v[148:151], v[60:63]
    ds_read_b64_tr_b16 v[206:207], v42 offset:41984
    v_mfma_f32_16x16x32_bf16 v[64:67], v[184:187], v[148:151], v[64:67]
    ds_read_b128 v[164:167], v41 offset:51200
    v_mfma_f32_16x16x32_bf16 v[68:71], v[188:191], v[148:151], v[68:71]
    ds_read_b128 v[168:171], v41 offset:53248
    v_mfma_f32_16x16x32_bf16 v[72:75], v[192:195], v[148:151], v[72:75]
    ds_read_b64_tr_b16 v[208:209], v43 offset:40960
    v_mfma_f32_16x16x32_bf16 v[76:79], v[148:151], v[196:199], v[76:79]
    ds_read_b64_tr_b16 v[210:211], v43 offset:41984
    v_mfma_f32_16x16x32_bf16 v[80:83], v[148:151], v[200:203], v[80:83]
    ds_read_b64_tr_b16 v[212:213], v44 offset:40960
    v_mfma_f32_16x16x32_bf16 v[112:115], v[152:155], v[200:203], v[112:115]
    ds_read_b64_tr_b16 v[214:215], v44 offset:41984
    v_mfma_f32_16x16x32_bf16 v[108:111], v[152:155], v[196:199], v[108:111]
    ds_read_b64_tr_b16 v[216:217], v45 offset:40960
    v_mfma_f32_16x16x32_bf16 v[104:107], v[192:195], v[152:155], v[104:107]
    ds_read_b64_tr_b16 v[218:219], v45 offset:41984
    v_mfma_f32_16x16x32_bf16 v[100:103], v[188:191], v[152:155], v[100:103]
    ds_read_b64_tr_b16 v[220:221], v46 offset:40960
    v_mfma_f32_16x16x32_bf16 v[96:99], v[184:187], v[152:155], v[96:99]
    ds_read_b64_tr_b16 v[222:223], v46 offset:41984
    v_mfma_f32_16x16x32_bf16 v[92:95], v[180:183], v[152:155], v[92:95]
    ds_read_b64_tr_b16 v[224:225], v47 offset:40960
    v_mfma_f32_16x16x32_bf16 v[88:91], v[176:179], v[152:155], v[88:91]
    ds_read_b64_tr_b16 v[226:227], v47 offset:41984
    v_mfma_f32_16x16x32_bf16 v[84:87], v[172:175], v[152:155], v[84:87]
    ds_read_b64_tr_b16 v[228:229], v48 offset:40960
    v_mfma_f32_16x16x32_bf16 v[116:119], v[172:175], v[156:159], v[116:119]
    ds_read_b64_tr_b16 v[230:231], v48 offset:41984
    v_mfma_f32_16x16x32_bf16 v[120:123], v[176:179], v[156:159], v[120:123]
    ds_read_b64_tr_b16 v[232:233], v49 offset:40960
    v_mfma_f32_16x16x32_bf16 v[124:127], v[180:183], v[156:159], v[124:127]
    ds_read_b64_tr_b16 v[234:235], v49 offset:41984
    v_mfma_f32_16x16x32_bf16 v[128:131], v[184:187], v[156:159], v[128:131]
    v_mfma_f32_16x16x32_bf16 v[132:135], v[188:191], v[156:159], v[132:135]
    v_mfma_f32_16x16x32_bf16 v[136:139], v[192:195], v[156:159], v[136:139]
    v_mfma_f32_16x16x32_bf16 v[140:143], v[156:159], v[196:199], v[140:143]
    v_mfma_f32_16x16x32_bf16 v[144:147], v[156:159], v[200:203], v[144:147]
    s_waitcnt lgkmcnt(0)
    s_barrier
    v_mfma_f32_16x16x32_bf16 v[52:55], v[204:207], v[160:163], v[52:55]
    ds_read_b128 v[148:151], v40 offset:0
    v_mfma_f32_16x16x32_bf16 v[56:59], v[208:211], v[160:163], v[56:59]
    ds_read_b64_tr_b16 v[172:173], v42 offset:0
    v_mfma_f32_16x16x32_bf16 v[60:63], v[212:215], v[160:163], v[60:63]
    ds_read_b64_tr_b16 v[174:175], v42 offset:1024
    v_mfma_f32_16x16x32_bf16 v[64:67], v[216:219], v[160:163], v[64:67]
    ds_read_b128 v[152:155], v40 offset:2048
    v_mfma_f32_16x16x32_bf16 v[68:71], v[220:223], v[160:163], v[68:71]
    ds_read_b128 v[156:159], v40 offset:4096
    v_mfma_f32_16x16x32_bf16 v[72:75], v[224:227], v[160:163], v[72:75]
    ds_read_b64_tr_b16 v[176:177], v43 offset:0
    v_mfma_f32_16x16x32_bf16 v[76:79], v[160:163], v[228:231], v[76:79]
    ds_read_b64_tr_b16 v[178:179], v43 offset:1024
    v_mfma_f32_16x16x32_bf16 v[80:83], v[160:163], v[232:235], v[80:83]
    ds_read_b64_tr_b16 v[180:181], v44 offset:0
    v_mfma_f32_16x16x32_bf16 v[112:115], v[164:167], v[232:235], v[112:115]
    ds_read_b64_tr_b16 v[182:183], v44 offset:1024
    v_mfma_f32_16x16x32_bf16 v[108:111], v[164:167], v[228:231], v[108:111]
    ds_read_b64_tr_b16 v[184:185], v45 offset:0
    v_mfma_f32_16x16x32_bf16 v[104:107], v[224:227], v[164:167], v[104:107]
    ds_read_b64_tr_b16 v[186:187], v45 offset:1024
    v_mfma_f32_16x16x32_bf16 v[100:103], v[220:223], v[164:167], v[100:103]
    ds_read_b64_tr_b16 v[188:189], v46 offset:0
    v_mfma_f32_16x16x32_bf16 v[96:99], v[216:219], v[164:167], v[96:99]
    ds_read_b64_tr_b16 v[190:191], v46 offset:1024
    v_mfma_f32_16x16x32_bf16 v[92:95], v[212:215], v[164:167], v[92:95]
    ds_read_b64_tr_b16 v[192:193], v47 offset:0
    v_mfma_f32_16x16x32_bf16 v[88:91], v[208:211], v[164:167], v[88:91]
    ds_read_b64_tr_b16 v[194:195], v47 offset:1024
    v_mfma_f32_16x16x32_bf16 v[84:87], v[204:207], v[164:167], v[84:87]
    ds_read_b64_tr_b16 v[196:197], v48 offset:0
    v_mfma_f32_16x16x32_bf16 v[116:119], v[204:207], v[168:171], v[116:119]
    ds_read_b64_tr_b16 v[198:199], v48 offset:1024
    v_mfma_f32_16x16x32_bf16 v[120:123], v[208:211], v[168:171], v[120:123]
    ds_read_b64_tr_b16 v[200:201], v49 offset:0
    v_mfma_f32_16x16x32_bf16 v[124:127], v[212:215], v[168:171], v[124:127]
    ds_read_b64_tr_b16 v[202:203], v49 offset:1024
    v_mfma_f32_16x16x32_bf16 v[128:131], v[216:219], v[168:171], v[128:131]
    v_mfma_f32_16x16x32_bf16 v[132:135], v[220:223], v[168:171], v[132:135]
    v_mfma_f32_16x16x32_bf16 v[136:139], v[224:227], v[168:171], v[136:139]
    v_mfma_f32_16x16x32_bf16 v[140:143], v[168:171], v[228:231], v[140:143]
    v_mfma_f32_16x16x32_bf16 v[144:147], v[168:171], v[232:235], v[144:147]
    s_waitcnt lgkmcnt(0)
    v_mfma_f32_16x16x32_bf16 v[52:55], v[172:175], v[148:151], v[52:55]
    ds_read_b128 v[160:163], v41 offset:0
    v_mfma_f32_16x16x32_bf16 v[56:59], v[176:179], v[148:151], v[56:59]
    ds_read_b64_tr_b16 v[204:205], v42 offset:8192
    v_mfma_f32_16x16x32_bf16 v[60:63], v[180:183], v[148:151], v[60:63]
    ds_read_b64_tr_b16 v[206:207], v42 offset:9216
    v_mfma_f32_16x16x32_bf16 v[64:67], v[184:187], v[148:151], v[64:67]
    ds_read_b128 v[164:167], v41 offset:2048
    v_mfma_f32_16x16x32_bf16 v[68:71], v[188:191], v[148:151], v[68:71]
    ds_read_b128 v[168:171], v41 offset:4096
    v_mfma_f32_16x16x32_bf16 v[72:75], v[192:195], v[148:151], v[72:75]
    ds_read_b64_tr_b16 v[208:209], v43 offset:8192
    v_mfma_f32_16x16x32_bf16 v[76:79], v[148:151], v[196:199], v[76:79]
    ds_read_b64_tr_b16 v[210:211], v43 offset:9216
    v_mfma_f32_16x16x32_bf16 v[80:83], v[148:151], v[200:203], v[80:83]
    ds_read_b64_tr_b16 v[212:213], v44 offset:8192
    v_mfma_f32_16x16x32_bf16 v[112:115], v[152:155], v[200:203], v[112:115]
    ds_read_b64_tr_b16 v[214:215], v44 offset:9216
    v_mfma_f32_16x16x32_bf16 v[108:111], v[152:155], v[196:199], v[108:111]
    ds_read_b64_tr_b16 v[216:217], v45 offset:8192
    v_mfma_f32_16x16x32_bf16 v[104:107], v[192:195], v[152:155], v[104:107]
    ds_read_b64_tr_b16 v[218:219], v45 offset:9216
    v_mfma_f32_16x16x32_bf16 v[100:103], v[188:191], v[152:155], v[100:103]
    ds_read_b64_tr_b16 v[220:221], v46 offset:8192
    v_mfma_f32_16x16x32_bf16 v[96:99], v[184:187], v[152:155], v[96:99]
    ds_read_b64_tr_b16 v[222:223], v46 offset:9216
    v_mfma_f32_16x16x32_bf16 v[92:95], v[180:183], v[152:155], v[92:95]
    ds_read_b64_tr_b16 v[224:225], v47 offset:8192
    v_mfma_f32_16x16x32_bf16 v[88:91], v[176:179], v[152:155], v[88:91]
    ds_read_b64_tr_b16 v[226:227], v47 offset:9216
    v_mfma_f32_16x16x32_bf16 v[84:87], v[172:175], v[152:155], v[84:87]
    ds_read_b64_tr_b16 v[228:229], v48 offset:8192
    v_mfma_f32_16x16x32_bf16 v[116:119], v[172:175], v[156:159], v[116:119]
    ds_read_b64_tr_b16 v[230:231], v48 offset:9216
    v_mfma_f32_16x16x32_bf16 v[120:123], v[176:179], v[156:159], v[120:123]
    ds_read_b64_tr_b16 v[232:233], v49 offset:8192
    v_mfma_f32_16x16x32_bf16 v[124:127], v[180:183], v[156:159], v[124:127]
    ds_read_b64_tr_b16 v[234:235], v49 offset:9216
    v_mfma_f32_16x16x32_bf16 v[128:131], v[184:187], v[156:159], v[128:131]
    v_mfma_f32_16x16x32_bf16 v[132:135], v[188:191], v[156:159], v[132:135]
    v_mfma_f32_16x16x32_bf16 v[136:139], v[192:195], v[156:159], v[136:139]
    v_mfma_f32_16x16x32_bf16 v[140:143], v[156:159], v[196:199], v[140:143]
    v_mfma_f32_16x16x32_bf16 v[144:147], v[156:159], v[200:203], v[144:147]
    s_waitcnt lgkmcnt(0)
    s_barrier
    v_mfma_f32_16x16x32_bf16 v[52:55], v[204:207], v[160:163], v[52:55]
    ds_read_b128 v[148:151], v40 offset:24576
    v_mfma_f32_16x16x32_bf16 v[56:59], v[208:211], v[160:163], v[56:59]
    ds_read_b64_tr_b16 v[172:173], v42 offset:16384
    v_mfma_f32_16x16x32_bf16 v[60:63], v[212:215], v[160:163], v[60:63]
    ds_read_b64_tr_b16 v[174:175], v42 offset:17408
    v_mfma_f32_16x16x32_bf16 v[64:67], v[216:219], v[160:163], v[64:67]
    ds_read_b128 v[152:155], v40 offset:26624
    v_mfma_f32_16x16x32_bf16 v[68:71], v[220:223], v[160:163], v[68:71]
    ds_read_b128 v[156:159], v40 offset:28672
    v_mfma_f32_16x16x32_bf16 v[72:75], v[224:227], v[160:163], v[72:75]
    ds_read_b64_tr_b16 v[176:177], v43 offset:16384
    v_mfma_f32_16x16x32_bf16 v[76:79], v[160:163], v[228:231], v[76:79]
    ds_read_b64_tr_b16 v[178:179], v43 offset:17408
    v_mfma_f32_16x16x32_bf16 v[80:83], v[160:163], v[232:235], v[80:83]
    ds_read_b64_tr_b16 v[180:181], v44 offset:16384
    v_mfma_f32_16x16x32_bf16 v[112:115], v[164:167], v[232:235], v[112:115]
    ds_read_b64_tr_b16 v[182:183], v44 offset:17408
    v_mfma_f32_16x16x32_bf16 v[108:111], v[164:167], v[228:231], v[108:111]
    ds_read_b64_tr_b16 v[184:185], v45 offset:16384
    v_mfma_f32_16x16x32_bf16 v[104:107], v[224:227], v[164:167], v[104:107]
    ds_read_b64_tr_b16 v[186:187], v45 offset:17408
    v_mfma_f32_16x16x32_bf16 v[100:103], v[220:223], v[164:167], v[100:103]
    ds_read_b64_tr_b16 v[188:189], v46 offset:16384
    v_mfma_f32_16x16x32_bf16 v[96:99], v[216:219], v[164:167], v[96:99]
    ds_read_b64_tr_b16 v[190:191], v46 offset:17408
    v_mfma_f32_16x16x32_bf16 v[92:95], v[212:215], v[164:167], v[92:95]
    ds_read_b64_tr_b16 v[192:193], v47 offset:16384
    v_mfma_f32_16x16x32_bf16 v[88:91], v[208:211], v[164:167], v[88:91]
    ds_read_b64_tr_b16 v[194:195], v47 offset:17408
    v_mfma_f32_16x16x32_bf16 v[84:87], v[204:207], v[164:167], v[84:87]
    ds_read_b64_tr_b16 v[196:197], v48 offset:16384
    v_mfma_f32_16x16x32_bf16 v[116:119], v[204:207], v[168:171], v[116:119]
    ds_read_b64_tr_b16 v[198:199], v48 offset:17408
    v_mfma_f32_16x16x32_bf16 v[120:123], v[208:211], v[168:171], v[120:123]
    ds_read_b64_tr_b16 v[200:201], v49 offset:16384
    v_mfma_f32_16x16x32_bf16 v[124:127], v[212:215], v[168:171], v[124:127]
    ds_read_b64_tr_b16 v[202:203], v49 offset:17408
    v_mfma_f32_16x16x32_bf16 v[128:131], v[216:219], v[168:171], v[128:131]
    v_mfma_f32_16x16x32_bf16 v[132:135], v[220:223], v[168:171], v[132:135]
    v_mfma_f32_16x16x32_bf16 v[136:139], v[224:227], v[168:171], v[136:139]
    v_mfma_f32_16x16x32_bf16 v[140:143], v[168:171], v[228:231], v[140:143]
    v_mfma_f32_16x16x32_bf16 v[144:147], v[168:171], v[232:235], v[144:147]
    s_waitcnt lgkmcnt(0)
    v_mfma_f32_16x16x32_bf16 v[52:55], v[172:175], v[148:151], v[52:55]
    ds_read_b128 v[160:163], v41 offset:24576
    v_mfma_f32_16x16x32_bf16 v[56:59], v[176:179], v[148:151], v[56:59]
    ds_read_b64_tr_b16 v[204:205], v42 offset:24576
    v_mfma_f32_16x16x32_bf16 v[60:63], v[180:183], v[148:151], v[60:63]
    ds_read_b64_tr_b16 v[206:207], v42 offset:25600
    v_mfma_f32_16x16x32_bf16 v[64:67], v[184:187], v[148:151], v[64:67]
    ds_read_b128 v[164:167], v41 offset:26624
    v_mfma_f32_16x16x32_bf16 v[68:71], v[188:191], v[148:151], v[68:71]
    ds_read_b128 v[168:171], v41 offset:28672
    v_mfma_f32_16x16x32_bf16 v[72:75], v[192:195], v[148:151], v[72:75]
    ds_read_b64_tr_b16 v[208:209], v43 offset:24576
    v_mfma_f32_16x16x32_bf16 v[76:79], v[148:151], v[196:199], v[76:79]
    ds_read_b64_tr_b16 v[210:211], v43 offset:25600
    v_mfma_f32_16x16x32_bf16 v[80:83], v[148:151], v[200:203], v[80:83]
    ds_read_b64_tr_b16 v[212:213], v44 offset:24576
    v_mfma_f32_16x16x32_bf16 v[112:115], v[152:155], v[200:203], v[112:115]
    ds_read_b64_tr_b16 v[214:215], v44 offset:25600
    v_mfma_f32_16x16x32_bf16 v[108:111], v[152:155], v[196:199], v[108:111]
    ds_read_b64_tr_b16 v[216:217], v45 offset:24576
    v_mfma_f32_16x16x32_bf16 v[104:107], v[192:195], v[152:155], v[104:107]
    ds_read_b64_tr_b16 v[218:219], v45 offset:25600
    v_mfma_f32_16x16x32_bf16 v[100:103], v[188:191], v[152:155], v[100:103]
    ds_read_b64_tr_b16 v[220:221], v46 offset:24576
    v_mfma_f32_16x16x32_bf16 v[96:99], v[184:187], v[152:155], v[96:99]
    ds_read_b64_tr_b16 v[222:223], v46 offset:25600
    v_mfma_f32_16x16x32_bf16 v[92:95], v[180:183], v[152:155], v[92:95]
    ds_read_b64_tr_b16 v[224:225], v47 offset:24576
    v_mfma_f32_16x16x32_bf16 v[88:91], v[176:179], v[152:155], v[88:91]
    ds_read_b64_tr_b16 v[226:227], v47 offset:25600
    v_mfma_f32_16x16x32_bf16 v[84:87], v[172:175], v[152:155], v[84:87]
    ds_read_b64_tr_b16 v[228:229], v48 offset:24576
    v_mfma_f32_16x16x32_bf16 v[116:119], v[172:175], v[156:159], v[116:119]
    ds_read_b64_tr_b16 v[230:231], v48 offset:25600
    v_mfma_f32_16x16x32_bf16 v[120:123], v[176:179], v[156:159], v[120:123]
    ds_read_b64_tr_b16 v[232:233], v49 offset:24576
    v_mfma_f32_16x16x32_bf16 v[124:127], v[180:183], v[156:159], v[124:127]
    ds_read_b64_tr_b16 v[234:235], v49 offset:25600
    v_mfma_f32_16x16x32_bf16 v[128:131], v[184:187], v[156:159], v[128:131]
    v_mfma_f32_16x16x32_bf16 v[132:135], v[188:191], v[156:159], v[132:135]
    v_mfma_f32_16x16x32_bf16 v[136:139], v[192:195], v[156:159], v[136:139]
    v_mfma_f32_16x16x32_bf16 v[140:143], v[156:159], v[196:199], v[140:143]
    v_mfma_f32_16x16x32_bf16 v[144:147], v[156:159], v[200:203], v[144:147]
    s_waitcnt lgkmcnt(0)
    s_barrier
    v_mfma_f32_16x16x32_bf16 v[52:55], v[204:207], v[160:163], v[52:55]
    ds_read_b128 v[148:151], v40 offset:49152
    v_mfma_f32_16x16x32_bf16 v[56:59], v[208:211], v[160:163], v[56:59]
    ds_read_b64_tr_b16 v[172:173], v42 offset:32768
    v_mfma_f32_16x16x32_bf16 v[60:63], v[212:215], v[160:163], v[60:63]
    ds_read_b64_tr_b16 v[174:175], v42 offset:33792
    v_mfma_f32_16x16x32_bf16 v[64:67], v[216:219], v[160:163], v[64:67]
    ds_read_b128 v[152:155], v40 offset:51200
    v_mfma_f32_16x16x32_bf16 v[68:71], v[220:223], v[160:163], v[68:71]
    ds_read_b128 v[156:159], v40 offset:53248
    v_mfma_f32_16x16x32_bf16 v[72:75], v[224:227], v[160:163], v[72:75]
    ds_read_b64_tr_b16 v[176:177], v43 offset:32768
    v_mfma_f32_16x16x32_bf16 v[76:79], v[160:163], v[228:231], v[76:79]
    ds_read_b64_tr_b16 v[178:179], v43 offset:33792
    v_mfma_f32_16x16x32_bf16 v[80:83], v[160:163], v[232:235], v[80:83]
    ds_read_b64_tr_b16 v[180:181], v44 offset:32768
    v_mfma_f32_16x16x32_bf16 v[112:115], v[164:167], v[232:235], v[112:115]
    ds_read_b64_tr_b16 v[182:183], v44 offset:33792
    v_mfma_f32_16x16x32_bf16 v[108:111], v[164:167], v[228:231], v[108:111]
    ds_read_b64_tr_b16 v[184:185], v45 offset:32768
    v_mfma_f32_16x16x32_bf16 v[104:107], v[224:227], v[164:167], v[104:107]
    ds_read_b64_tr_b16 v[186:187], v45 offset:33792
    v_mfma_f32_16x16x32_bf16 v[100:103], v[220:223], v[164:167], v[100:103]
    ds_read_b64_tr_b16 v[188:189], v46 offset:32768
    v_mfma_f32_16x16x32_bf16 v[96:99], v[216:219], v[164:167], v[96:99]
    ds_read_b64_tr_b16 v[190:191], v46 offset:33792
    v_mfma_f32_16x16x32_bf16 v[92:95], v[212:215], v[164:167], v[92:95]
    ds_read_b64_tr_b16 v[192:193], v47 offset:32768
    v_mfma_f32_16x16x32_bf16 v[88:91], v[208:211], v[164:167], v[88:91]
    ds_read_b64_tr_b16 v[194:195], v47 offset:33792
    v_mfma_f32_16x16x32_bf16 v[84:87], v[204:207], v[164:167], v[84:87]
    ds_read_b64_tr_b16 v[196:197], v48 offset:32768
    v_mfma_f32_16x16x32_bf16 v[116:119], v[204:207], v[168:171], v[116:119]
    ds_read_b64_tr_b16 v[198:199], v48 offset:33792
    v_mfma_f32_16x16x32_bf16 v[120:123], v[208:211], v[168:171], v[120:123]
    ds_read_b64_tr_b16 v[200:201], v49 offset:32768
    v_mfma_f32_16x16x32_bf16 v[124:127], v[212:215], v[168:171], v[124:127]
    ds_read_b64_tr_b16 v[202:203], v49 offset:33792
    v_mfma_f32_16x16x32_bf16 v[128:131], v[216:219], v[168:171], v[128:131]
    s_sub_u32 s52, s52, 1
    v_mfma_f32_16x16x32_bf16 v[132:135], v[220:223], v[168:171], v[132:135]
    s_cmp_lg_u32 s52, 0
    v_mfma_f32_16x16x32_bf16 v[136:139], v[224:227], v[168:171], v[136:139]
    v_mfma_f32_16x16x32_bf16 v[140:143], v[168:171], v[228:231], v[140:143]
    v_mfma_f32_16x16x32_bf16 v[144:147], v[168:171], v[232:235], v[144:147]
    s_cbranch_scc1 K_CLOOP
    s_waitcnt lgkmcnt(0)
    v_mfma_f32_16x16x32_bf16 v[52:55], v[172:175], v[148:151], v[52:55]
    ds_read_b128 v[160:163], v41 offset:49152
    ds_read_b64_tr_b16 v[204:205], v42 offset:40960
    v_mfma_f32_16x16x32_bf16 v[116:119], v[172:175], v[156:159], v[116:119]
    ds_read_b64_tr_b16 v[206:207], v42 offset:41984
    ds_read_b128 v[164:167], v41 offset:51200
    v_mfma_f32_16x16x32_bf16 v[84:87], v[172:175], v[152:155], v[84:87]
    ds_read_b128 v[168:171], v41 offset:53248
    ds_read_b64_tr_b16 v[208:209], v43 offset:40960
    v_mfma_f32_16x16x32_bf16 v[56:59], v[176:179], v[148:151], v[56:59]
    ds_read_b64_tr_b16 v[210:211], v43 offset:41984
    ds_read_b64_tr_b16 v[212:213], v44 offset:40960
    v_mfma_f32_16x16x32_bf16 v[120:123], v[176:179], v[156:159], v[120:123]
    ds_read_b64_tr_b16 v[214:215], v44 offset:41984
    ds_read_b64_tr_b16 v[216:217], v45 offset:40960
    v_mfma_f32_16x16x32_bf16 v[88:91], v[176:179], v[152:155], v[88:91]
    ds_read_b64_tr_b16 v[218:219], v45 offset:41984
    ds_read_b64_tr_b16 v[220:221], v46 offset:40960
    v_mfma_f32_16x16x32_bf16 v[60:63], v[180:183], v[148:151], v[60:63]
    ds_read_b64_tr_b16 v[222:223], v46 offset:41984
    ds_read_b64_tr_b16 v[224:225], v47 offset:40960
    v_mfma_f32_16x16x32_bf16 v[124:127], v[180:183], v[156:159], v[124:127]
    ds_read_b64_tr_b16 v[226:227], v47 offset:41984
    ds_read_b64_tr_b16 v[228:229], v48 offset:40960
    v_mfma_f32_16x16x32_bf16 v[92:95], v[180:183], v[152:155], v[92:95]
    ds_read_b64_tr_b16 v[230:231], v48 offset:41984
    ds_read_b64_tr_b16 v[232:233], v49 offset:40960
    v_mfma_f32_16x16x32_bf16 v[64:67], v[184:187], v[148:151], v[64:67]
    ds_read_b64_tr_b16 v[234:235], v49 offset:41984
    v_mfma_f32_16x16x32_bf16 v[128:131], v[184:187], v[156:159], v[128:131]
    s_nop 1
    v_mfma_f32_16x16x32_bf16 v[96:99], v[184:187], v[152:155], v[96:99]
    s_nop 1
    s_waitcnt lgkmcnt(15)
    v_mfma_f32_16x16x32_bf16 v[52:55], v[204:207], v[160:163], v[52:55]
    s_nop 1
    s_waitcnt lgkmcnt(12)
    v_mfma_f32_16x16x32_bf16 v[56:59], v[208:211], v[160:163], v[56:59]
    s_nop 1
    v_mfma_f32_16x16x32_bf16 v[116:119], v[204:207], v[168:171], v[116:119]
    s_nop 1
    v_mfma_f32_16x16x32_bf16 v[120:123], v[208:211], v[168:171], v[120:123]
    s_nop 1
    v_mfma_f32_16x16x32_bf16 v[84:87], v[204:207], v[164:167], v[84:87]
    v_cvt_pk_bf16_f32 v52, v52, v53
    v_cvt_pk_bf16_f32 v53, v54, v55
    v_mfma_f32_16x16x32_bf16 v[88:91], v[208:211], v[164:167], v[88:91]
    v_cvt_pk_bf16_f32 v54, v56, v57
    v_cvt_pk_bf16_f32 v55, v58, v59
    s_waitcnt lgkmcnt(10)
    v_mfma_f32_16x16x32_bf16 v[60:63], v[212:215], v[160:163], v[60:63]
    ds_write_b128 v13, v[52:55] offset:0
    s_waitcnt lgkmcnt(9)
    v_mfma_f32_16x16x32_bf16 v[64:67], v[216:219], v[160:163], v[64:67]
    v_cvt_pk_bf16_f32 v116, v116, v117
    v_cvt_pk_bf16_f32 v117, v118, v119
    v_mfma_f32_16x16x32_bf16 v[124:127], v[212:215], v[168:171], v[124:127]
    v_cvt_pk_bf16_f32 v118, v120, v121
    v_cvt_pk_bf16_f32 v119, v122, v123
    v_mfma_f32_16x16x32_bf16 v[128:131], v[216:219], v[168:171], v[128:131]
    ds_write_b128 v13, v[116:119] offset:2048
    v_mfma_f32_16x16x32_bf16 v[92:95], v[212:215], v[164:167], v[92:95]
    v_cvt_pk_bf16_f32 v84, v84, v85
    v_cvt_pk_bf16_f32 v85, v86, v87
    v_mfma_f32_16x16x32_bf16 v[96:99], v[216:219], v[164:167], v[96:99]
    v_cvt_pk_bf16_f32 v86, v88, v89
    v_cvt_pk_bf16_f32 v87, v90, v91
    v_mfma_f32_16x16x32_bf16 v[68:71], v[188:191], v[148:151], v[68:71]
    ds_write_b128 v13, v[84:87] offset:1024
    v_mfma_f32_16x16x32_bf16 v[72:75], v[192:195], v[148:151], v[72:75]
    v_cvt_pk_bf16_f32 v60, v60, v61
    v_cvt_pk_bf16_f32 v61, v62, v63
    s_waitcnt lgkmcnt(9)
    v_mfma_f32_16x16x32_bf16 v[68:71], v[220:223], v[160:163], v[68:71]
    v_cvt_pk_bf16_f32 v64, v64, v65
    v_cvt_pk_bf16_f32 v65, v66, v67
    s_waitcnt lgkmcnt(7)
    v_mfma_f32_16x16x32_bf16 v[72:75], v[224:227], v[160:163], v[72:75]
    ds_write2st64_b64 v14, v[60:61], v[64:65] offset0:4 offset1:5
    v_mfma_f32_16x16x32_bf16 v[132:135], v[188:191], v[156:159], v[132:135]
    ds_read_b64 v[62:63], v13 offset:0
    ds_read_b64 v[66:67], v13 offset:0
    v_mfma_f32_16x16x32_bf16 v[136:139], v[192:195], v[156:159], v[136:139]
    v_cvt_pk_bf16_f32 v124, v124, v125
    v_cvt_pk_bf16_f32 v125, v126, v127
    v_mfma_f32_16x16x32_bf16 v[132:135], v[220:223], v[168:171], v[132:135]
    v_cvt_pk_bf16_f32 v128, v128, v129
    v_cvt_pk_bf16_f32 v129, v130, v131
    v_mfma_f32_16x16x32_bf16 v[136:139], v[224:227], v[168:171], v[136:139]
    ds_write2st64_b64 v14, v[124:125], v[128:129] offset0:10 offset1:11
    v_mfma_f32_16x16x32_bf16 v[100:103], v[188:191], v[152:155], v[100:103]
    ds_read_b64 v[126:127], v13 offset:2048
    ds_read_b64 v[130:131], v13 offset:2048
    v_mfma_f32_16x16x32_bf16 v[104:107], v[192:195], v[152:155], v[104:107]
    v_cvt_pk_bf16_f32 v92, v92, v93
    v_cvt_pk_bf16_f32 v93, v94, v95
    v_mfma_f32_16x16x32_bf16 v[100:103], v[220:223], v[164:167], v[100:103]
    v_cvt_pk_bf16_f32 v96, v96, v97
    v_cvt_pk_bf16_f32 v97, v98, v99
    v_mfma_f32_16x16x32_bf16 v[104:107], v[224:227], v[164:167], v[104:107]
    ds_read_b64 v[94:95], v13 offset:1024
    ds_read_b64 v[98:99], v13 offset:1024
    v_mfma_f32_16x16x32_bf16 v[76:79], v[148:151], v[196:199], v[76:79]
    v_cvt_pk_bf16_f32 v68, v68, v69
    v_cvt_pk_bf16_f32 v69, v70, v71
    v_mfma_f32_16x16x32_bf16 v[80:83], v[148:151], v[200:203], v[80:83]
    v_cvt_pk_bf16_f32 v72, v72, v73
    v_cvt_pk_bf16_f32 v73, v74, v75
    s_waitcnt lgkmcnt(13)
    v_mfma_f32_16x16x32_bf16 v[76:79], v[160:163], v[228:231], v[76:79]
    ds_write2st64_b64 v14, v[68:69], v[72:73] offset0:8 offset1:9
    s_waitcnt lgkmcnt(12)
    v_mfma_f32_16x16x32_bf16 v[80:83], v[160:163], v[232:235], v[80:83]
    ds_write_b32 v50, v4
    v_cvt_pk_bf16_f32 v132, v132, v133
    v_mfma_f32_16x16x32_bf16 v[140:143], v[156:159], v[196:199], v[140:143]
    v_cvt_pk_bf16_f32 v133, v134, v135
    v_cvt_pk_bf16_f32 v136, v136, v137
    v_mfma_f32_16x16x32_bf16 v[144:147], v[156:159], v[200:203], v[144:147]
    v_cvt_pk_bf16_f32 v137, v138, v139
    ds_read_b64 v[134:135], v18 offset:2048
    v_mfma_f32_16x16x32_bf16 v[140:143], v[168:171], v[228:231], v[140:143]
    ds_read_b64 v[138:139], v19 offset:2048
    v_cvt_pk_bf16_f32 v100, v100, v101
    v_mfma_f32_16x16x32_bf16 v[144:147], v[168:171], v[232:235], v[144:147]
    v_cvt_pk_bf16_f32 v101, v102, v103
    v_cvt_pk_bf16_f32 v104, v104, v105
    v_mfma_f32_16x16x32_bf16 v[108:111], v[152:155], v[196:199], v[108:111]
    v_cvt_pk_bf16_f32 v105, v106, v107
    ds_read_b64 v[102:103], v18 offset:1024
    v_mfma_f32_16x16x32_bf16 v[112:115], v[152:155], v[200:203], v[112:115]
    ds_read_b64 v[106:107], v19 offset:1024
    v_cvt_pk_bf16_f32 v236, v76, v77
    v_mfma_f32_16x16x32_bf16 v[108:111], v[164:167], v[228:231], v[108:111]
    v_cvt_pk_bf16_f32 v237, v78, v79
    v_cvt_pk_bf16_f32 v242, v80, v81
    v_mfma_f32_16x16x32_bf16 v[112:115], v[164:167], v[232:235], v[112:115]
    v_cvt_pk_bf16_f32 v243, v82, v83
    v_cvt_pk_bf16_f32 v240, v140, v141
    s_branch WS_attd
.p2align 12
WP_attd:
    s_setpc_b64 s[38:39]
WS_attd:
    s_waitcnt lgkmcnt(3)
    v_mfma_f32_16x16x32_bf16 v[208:211], v[124:127], v[132:135], v[28:31]
    ds_write2st64_b64 v14, v[236:237], v[242:243] offset0:6 offset1:7
    v_mfma_f32_16x16x32_bf16 v[204:207], v[92:95], v[132:135], v[24:27]
    v_cvt_pk_bf16_f32 v241, v142, v143
    v_cvt_pk_bf16_f32 v246, v144, v145
    s_waitcnt lgkmcnt(3)
    v_mfma_f32_16x16x32_bf16 v[216:219], v[128:131], v[136:139], v[28:31]
    v_cvt_pk_bf16_f32 v247, v146, v147
    v_cvt_pk_bf16_f32 v238, v108, v109
    v_mfma_f32_16x16x32_bf16 v[212:215], v[96:99], v[136:139], v[24:27]
    ds_write2st64_b64 v14, v[240:241], v[246:247] offset0:12 offset1:13
    s_waitcnt lgkmcnt(3)
    v_mfma_f32_16x16x32_bf16 v[176:179], v[92:95], v[100:103], v[28:31]
    ds_write_b32 v50, v5
    v_cvt_pk_bf16_f32 v239, v110, v111
    v_mfma_f32_16x16x32_bf16 v[172:175], v[60:63], v[100:103], v[32:35]
    v_cvt_pk_bf16_f32 v244, v112, v113
    v_cvt_pk_bf16_f32 v245, v114, v115
    s_waitcnt lgkmcnt(3)
    v_mfma_f32_16x16x32_bf16 v[184:187], v[96:99], v[104:107], v[28:31]
    ds_read_b64_tr_b16 v[188:189], v20 offset:0
    ds_read_b64_tr_b16 v[190:191], v20 offset:1024
    v_mfma_f32_16x16x32_bf16 v[180:183], v[64:67], v[104:107], v[32:35]
    ds_read_b64_tr_b16 v[192:193], v21 offset:0
    ds_read_b64_tr_b16 v[194:195], v21 offset:1024
    v_max3_f32 v68, v172, v173, v176
    ds_read_b64_tr_b16 v[220:221], v22 offset:1024
    v_max3_f32 v69, v174, v175, v178
    ds_read_b64_tr_b16 v[222:223], v22 offset:2048
    v_max_f32 v68, v68, v177
    ds_read_b64_tr_b16 v[224:225], v23 offset:1024
    v_max_f32 v69, v69, v179
    ds_read_b64_tr_b16 v[226:227], v23 offset:2048
    v_max3_f32 v70, v180, v181, v184
    v_max3_f32 v71, v182, v183, v186
    v_max_f32 v70, v70, v185
    v_max_f32 v71, v71, v187
    v_max3_f32 v72, v204, v205, v208
    v_max3_f32 v73, v206, v207, v210
    v_max_f32 v72, v72, v209
    v_max_f32 v73, v73, v211
    v_max3_f32 v74, v212, v213, v216
    v_max3_f32 v75, v214, v215, v218
    v_max_f32 v74, v74, v217
    v_max_f32 v75, v75, v219
    v_cvt_pk_bf16_f32 v88, v68, v69
    v_cvt_pk_bf16_f32 v89, v70, v71
    v_cvt_pk_bf16_f32 v90, v72, v73
    v_cvt_pk_bf16_f32 v91, v74, v75
    v_permlane16_swap_b32 v88, v89
    s_nop 0
    v_permlane16_swap_b32 v90, v91
    s_nop 1
    v_permlane32_swap_b32 v88, v90
    v_permlane32_swap_b32 v89, v91
    v_lshlrev_b32 v68, 16, v88
    v_and_b32 v69, 0xffff0000, v88
    v_lshlrev_b32 v72, 16, v90
    v_and_b32 v73, 0xffff0000, v90
    v_lshlrev_b32 v70, 16, v89
    v_and_b32 v71, 0xffff0000, v89
    v_lshlrev_b32 v74, 16, v91
    v_and_b32 v75, 0xffff0000, v91
    v_max3_f32 v120, v68, v69, v72
    v_max3_f32 v121, v73, v70, v71
    v_max3_f32 v120, v120, v74, v75
    v_max_f32 v120, v120, v121
    v_mul_f32 v120, s46, v120
    v_pk_fma_f32 v[68:69], v[68:69], s[46:47], v[120:121] op_sel_hi:[1,1,0] neg_lo:[0,0,1] neg_hi:[0,0,1]
    v_pk_fma_f32 v[70:71], v[70:71], s[46:47], v[120:121] op_sel_hi:[1,1,0] neg_lo:[0,0,1] neg_hi:[0,0,1]
    v_pk_fma_f32 v[72:73], v[72:73], s[46:47], v[120:121] op_sel_hi:[1,1,0] neg_lo:[0,0,1] neg_hi:[0,0,1]
    v_pk_fma_f32 v[74:75], v[74:75], s[46:47], v[120:121] op_sel_hi:[1,1,0] neg_lo:[0,0,1] neg_hi:[0,0,1]
    v_exp_f32 v68, v68
    v_exp_f32 v69, v69
    v_exp_f32 v70, v70
    v_exp_f32 v71, v71
    v_exp_f32 v72, v72
    v_exp_f32 v73, v73
    v_exp_f32 v74, v74
    v_exp_f32 v75, v75
    v_pk_add_f32 v[56:57], v[68:69], v[70:71]
    v_pk_add_f32 v[58:59], v[72:73], v[74:75]
    v_pk_add_f32 v[56:57], v[56:57], v[58:59]
    v_add_f32 v56, v56, v57
    v_rcp_f32 v56, v56
    s_nop 0
    v_pk_mul_f32 v[68:69], v[68:69], v[56:57] op_sel_hi:[1,0]
    v_pk_mul_f32 v[70:71], v[70:71], v[56:57] op_sel_hi:[1,0]
    v_pk_mul_f32 v[72:73], v[72:73], v[56:57] op_sel_hi:[1,0]
    v_pk_mul_f32 v[74:75], v[74:75], v[56:57] op_sel_hi:[1,0]
    v_cvt_pk_bf16_f32 v88, v68, v69
    v_cvt_pk_bf16_f32 v90, v72, v73
    v_cvt_pk_bf16_f32 v89, v70, v71
    v_cvt_pk_bf16_f32 v91, v74, v75
    v_permlane32_swap_b32 v88, v90
    s_nop 0
    v_permlane32_swap_b32 v89, v91
    s_nop 1
    v_permlane16_swap_b32 v88, v89
    v_permlane16_swap_b32 v90, v91
    v_perm_b32 v148, v88, v88, v36
    v_perm_b32 v149, v88, v88, v37
    v_perm_b32 v150, v88, v88, v38
    v_perm_b32 v151, v88, v88, v39
    v_perm_b32 v152, v89, v89, v36
    v_perm_b32 v153, v89, v89, v37
    v_perm_b32 v154, v89, v89, v38
    v_perm_b32 v155, v89, v89, v39
    v_mfma_f32_16x16x32_bf16 v[100:103], v[236:239], v[148:151], 0
    s_waitcnt lgkmcnt(6)
    v_mfma_f32_16x16x32_bf16 v[156:159], v[188:191], v[148:151], 0
    v_perm_b32 v160, v90, v90, v36
    v_perm_b32 v161, v90, v90, v37
    v_perm_b32 v162, v90, v90, v38
    v_perm_b32 v163, v90, v90, v39
    v_mfma_f32_16x16x32_bf16 v[104:107], v[242:245], v[152:155], 0
    s_waitcnt lgkmcnt(4)
    v_mfma_f32_16x16x32_bf16 v[156:159], v[192:195], v[152:155], v[156:159]
    v_perm_b32 v164, v91, v91, v36
    v_perm_b32 v165, v91, v91, v37
    v_perm_b32 v166, v91, v91, v38
    v_perm_b32 v167, v91, v91, v39
    v_mfma_f32_16x16x32_bf16 v[132:135], v[238:241], v[160:163], 0
    s_waitcnt lgkmcnt(2)
    v_mfma_f32_16x16x32_bf16 v[156:159], v[220:223], v[160:163], v[156:159]
    v_mfma_f32_16x16x32_bf16 v[136:139], v[244:247], v[164:167], 0
    s_waitcnt lgkmcnt(0)
    v_mfma_f32_16x16x32_bf16 v[156:159], v[224:227], v[164:167], v[156:159]
    v_cvt_pk_bf16_f32 v60, v100, v101
    v_cvt_pk_bf16_f32 v61, v102, v103
    v_cvt_pk_bf16_f32 v62, v104, v105
    v_cvt_pk_bf16_f32 v63, v106, v107
    buffer_store_dwordx4 v[60:63], v15, s[20:23], s50 offen sc1
    v_cvt_pk_bf16_f32 v64, v132, v133
    v_cvt_pk_bf16_f32 v65, v134, v135
    v_cvt_pk_bf16_f32 v66, v136, v137
    v_cvt_pk_bf16_f32 v67, v138, v139
    v_cvt_pk_bf16_f32 v56, v156, v157
    v_cvt_pk_bf16_f32 v57, v158, v159
    v_cvt_pk_bf16_f32 v58, v156, v157
    v_cvt_pk_bf16_f32 v59, v158, v159
    buffer_store_dwordx4 v[64:67], v15, s[20:23], s51 offen sc1
    v_permlane16_swap_b32 v56, v58
    v_permlane16_swap_b32 v57, v59
    buffer_store_dwordx4 v[56:59], v16, s[20:23], s50 offen sc1
    s_cmp_lg_u32 s34, -1
    s_cbranch_scc1 K_P2_EARLY
K_DRAIN:
    s_waitcnt vmcnt(0)
    s_barrier
    s_branch K_END
K_W7A:
    s_waitcnt vmcnt(0)
    v_and_b32 v4, 7, v1
    v_lshlrev_b32 v4, 2, v4
    s_mov_b32 s3, 131072
K_ZPOLL5:
    v_cmp_eq_u32 vcc, 0, v7
    s_cbranch_vccz K_ZOK5
    s_sub_u32 s3, s3, 1
    s_cbranch_scc1 K_ZOK5
    global_load_dword v7, v4, s[8:9] offset:192 sc1
    s_waitcnt vmcnt(0)
    s_branch K_ZPOLL5
K_ZOK5:
    v_mov_b32 v4, 158720
    v_mov_b32 v3, 1
    s_mov_b64 exec, 1
    s_nop 0
    ds_add_rtn_u32 v2, v4, v3 offset:48
    s_mov_b32 exec_lo, s36
    v_mov_b32 v3, 1
    s_waitcnt lgkmcnt(0)
    v_readfirstlane_b32 s33, v2
    s_nop 3
    s_and_b32 s33, s33, 0xff
    s_cmp_lg_u32 s33, 7
    s_cbranch_scc1 K_ARR7
    global_store_dword v8, v3, s[10:11] sc1
K_ARR7:
    s_mov_b64 exec, -1
    v_mov_b32 v6, 158800
    s_mov_b32 s3, 1048576
K_XG7:
    ds_read_b128 v[2:5], v6
    s_sleep 1
    s_sub_u32 s3, s3, 1
    s_waitcnt lgkmcnt(0)
    v_min3_u32 v2, v2, v4, v5
    v_min_u32 v2, v2, v3
    s_nop 0
    v_readfirstlane_b32 s33, v2
    s_nop 3
    s_cselect_b32 s33, 1, s33
    s_cmp_lt_u32 s33, 1
    s_cbranch_scc1 K_XG7
    v_mov_b32 v4, 158720
    s_branch K_WOE
K_W7:
    v_mov_b32 v3, 0x100
    s_mov_b64 exec, 1
    s_waitcnt vmcnt(0)
    ds_add_u32 v4, v3 offset:48
    s_mov_b64 exec, -1
    s_branch K_P2_HELP
K_FLAG:
    s_waitcnt vmcnt(0)
    v_and_b32 v4, 7, v1
    v_lshlrev_b32 v4, 2, v4
    s_mov_b32 s3, 131072
K_ZPOLL0:
    v_cmp_eq_u32 vcc, 0, v7
    s_cbranch_vccz K_ZOK0
    s_sub_u32 s3, s3, 1
    s_cbranch_scc1 K_ZOK0
    global_load_dword v7, v4, s[8:9] offset:192 sc1
    s_waitcnt vmcnt(0)
    s_branch K_ZPOLL0
K_ZOK0:
    v_mov_b32 v3, 1
    s_mov_b32 exec_lo, s36
    s_mov_b32 exec_hi, 0
    s_setprio 3
    s_barrier
    global_store_dword v8, v3, s[10:11] sc1
    s_mov_b64 exec, -1
    s_branch K_END
WP_atts:
    s_setpc_b64 s[38:39]
K_JOIN_S:
    s_setprio 0
    s_cmp_eq_u32 s30, 7
    s_cbranch_scc1 K_FLAG
    s_lshl_b32 s3, s30, 2
    s_add_u32 s3, s3, 158784
    v_mov_b32 v6, s3
    s_mov_b32 s3, 1048576
K_XG1:
    ds_read2_b32 v[2:3], v6 offset0:0 offset1:1
    s_sleep 1
    s_sub_u32 s3, s3, 1
    s_waitcnt lgkmcnt(0)
    v_min_u32 v2, v2, v3
    s_nop 0
    v_readfirstlane_b32 s33, v2
    s_nop 3
    s_cselect_b32 s33, 1, s33
    s_cmp_lt_u32 s33, 1
    s_cbranch_scc1 K_XG1
    ds_read_b64 v[40:41], v14 offset:4096
    ds_read_b64 v[42:43], v18 offset:1024
    ds_read_b64 v[48:49], v14 offset:0
    ds_read_b64 v[50:51], v13 offset:0
    ds_read_b64 v[52:53], v14 offset:2048
    ds_read_b64 v[54:55], v13 offset:1024
    ds_read_b64 v[44:45], v14 offset:4608
    ds_read_b64 v[46:47], v19 offset:1024
    ds_read_b64 v[56:57], v14 offset:512
    ds_read_b64 v[58:59], v13 offset:0
    ds_read_b64 v[60:61], v14 offset:2560
    ds_read_b64 v[62:63], v13 offset:1024
    s_waitcnt lgkmcnt(8)
    v_mfma_f32_16x16x32_bf16 v[80:83], v[48:51], v[40:43], v[24:27]
    s_waitcnt lgkmcnt(6)
    v_mfma_f32_16x16x32_bf16 v[84:87], v[52:55], v[40:43], v[28:31]
    s_waitcnt lgkmcnt(2)
    v_mfma_f32_16x16x32_bf16 v[88:91], v[56:59], v[44:47], v[24:27]
    s_waitcnt lgkmcnt(0)
    v_mfma_f32_16x16x32_bf16 v[92:95], v[60:63], v[44:47], v[28:31]
    ds_read_b64_tr_b16 v[72:73], v20 offset:0
    ds_read_b64_tr_b16 v[74:75], v20 offset:1024
    ds_read_b64_tr_b16 v[76:77], v21 offset:0
    ds_read_b64_tr_b16 v[78:79], v21 offset:1024
    v_max3_f32 v116, v80, v81, v84
    v_max3_f32 v117, v82, v83, v86
    v_max_f32 v116, v116, v85
    v_max_f32 v117, v117, v87
    v_max3_f32 v118, v88, v89, v92
    v_max3_f32 v119, v90, v91, v94
    v_max_f32 v118, v118, v93
    v_max_f32 v119, v119, v95
    v_cvt_pk_bf16_f32 v128, v116, v117
    v_cvt_pk_bf16_f32 v129, v118, v119
    s_nop 1
    v_permlane16_swap_b32 v128, v129
    v_lshlrev_b32 v116, 16, v128
    v_and_b32 v117, 0xffff0000, v128
    v_lshlrev_b32 v118, 16, v129
    v_and_b32 v119, 0xffff0000, v129
    v_max3_f32 v130, v116, v117, v118
    v_max_f32 v130, v130, v119
    v_mov_b32 v131, v130
    s_nop 1
    v_permlane32_swap_b32 v130, v131
    v_max_f32 v130, v130, v131
    v_mul_f32 v130, s46, v130
    v_pk_fma_f32 v[116:117], v[116:117], s[46:47], v[130:131] op_sel_hi:[1,1,0] neg_lo:[0,0,1] neg_hi:[0,0,1]
    v_pk_fma_f32 v[118:119], v[118:119], s[46:47], v[130:131] op_sel_hi:[1,1,0] neg_lo:[0,0,1] neg_hi:[0,0,1]
    v_exp_f32 v116, v116
    v_exp_f32 v117, v117
    v_exp_f32 v118, v118
    v_exp_f32 v119, v119
    s_nop 0
    v_pk_add_f32 v[120:121], v[116:117], v[118:119]
    v_add_f32 v120, v120, v121
    v_mov_b32 v121, v120
    s_nop 1
    v_permlane32_swap_b32 v120, v121
    v_add_f32 v120, v120, v121
    v_rcp_f32 v120, v120
    s_nop 0
    v_pk_mul_f32 v[116:117], v[116:117], v[120:121] op_sel_hi:[1,0]
    v_pk_mul_f32 v[118:119], v[118:119], v[120:121] op_sel_hi:[1,0]
    v_cvt_pk_bf16_f32 v128, v116, v117
    v_cvt_pk_bf16_f32 v129, v118, v119
    s_nop 1
    v_permlane16_swap_b32 v128, v129
    s_mov_b32 s3, 1048576
K_XG2:
    ds_read2_b32 v[2:3], v6 offset0:0 offset1:1
    s_sleep 1
    s_sub_u32 s3, s3, 1
    s_waitcnt lgkmcnt(0)
    v_min_u32 v2, v2, v3
    s_nop 0
    v_readfirstlane_b32 s33, v2
    s_nop 3
    s_cselect_b32 s33, 2, s33
    s_cmp_lt_u32 s33, 2
    s_cbranch_scc1 K_XG2
    ds_read_b64 v[64:65], v14 offset:1024
    ds_read_b64 v[66:67], v14 offset:3072
    ds_read_b64 v[68:69], v14 offset:1536
    ds_read_b64 v[70:71], v14 offset:3584
    v_perm_b32 v96, v128, v128, v36
    v_perm_b32 v97, v128, v128, v37
    v_perm_b32 v98, v128, v128, v38
    v_perm_b32 v99, v128, v128, v39
    v_perm_b32 v100, v129, v129, v36
    v_perm_b32 v101, v129, v129, v37
    v_perm_b32 v102, v129, v129, v38
    v_perm_b32 v103, v129, v129, v39
    s_waitcnt lgkmcnt(2)
    v_mfma_f32_16x16x32_bf16 v[104:107], v[64:67], v[96:99], 0
    v_mfma_f32_16x16x32_bf16 v[112:115], v[72:75], v[96:99], 0
    s_waitcnt lgkmcnt(0)
    v_mfma_f32_16x16x32_bf16 v[108:111], v[68:71], v[100:103], 0
    v_mfma_f32_16x16x32_bf16 v[112:115], v[76:79], v[100:103], v[112:115]
    s_nop 3
    v_cvt_pk_bf16_f32 v124, v104, v105
    v_cvt_pk_bf16_f32 v125, v106, v107
    s_nop 0
    v_cvt_pk_bf16_f32 v126, v108, v109
    v_cvt_pk_bf16_f32 v127, v110, v111
    v_cvt_pk_bf16_f32 v120, v112, v113
    v_cvt_pk_bf16_f32 v121, v114, v115
    v_cvt_pk_bf16_f32 v122, v112, v113
    v_cvt_pk_bf16_f32 v123, v114, v115
    buffer_store_dwordx4 v[124:127], v15, s[20:23], s50 offen sc1
    v_permlane16_swap_b32 v120, v122
    v_permlane16_swap_b32 v121, v123
    buffer_store_dwordx4 v[120:123], v16, s[20:23], s50 offen sc1
    s_cmp_eq_u32 s34, -1
    s_cbranch_scc1 K_DRAIN
    s_cmp_lg_u32 s30, 6
    s_cbranch_scc1 K_NOFL
    s_waitcnt vmcnt(2)
    v_and_b32 v4, 7, v1
    v_lshlrev_b32 v4, 2, v4
    s_mov_b32 s3, 131072
K_ZPOLL2:
    v_cmp_eq_u32 vcc, 0, v7
    s_cbranch_vccz K_ZOK2
    s_sub_u32 s3, s3, 1
    s_cbranch_scc1 K_ZOK2
    global_load_dword v7, v4, s[8:9] offset:192 sc1
    s_waitcnt vmcnt(0)
    s_branch K_ZPOLL2
K_ZOK2:
    v_and_b32 v2, 1, v1
    v_lshl_add_u32 v2, v2, 2, s42
    global_load_dword v7, v2, s[10:11] offset:128 sc1
K_NOFL:
    v_mov_b32 v4, 158720
    v_mov_b32 v3, 257
    s_mov_b64 exec, 1
    s_waitcnt vmcnt(0)
    ds_add_rtn_u32 v2, v4, v3 offset:48
    s_mov_b32 exec_lo, s36
    v_mov_b32 v3, 1
    s_waitcnt lgkmcnt(0)
    v_readfirstlane_b32 s33, v2
    s_nop 3
    s_and_b32 s33, s33, 0xff
    s_cmp_lg_u32 s33, 7
    s_cbranch_scc1 K_ARRS
    global_store_dword v8, v3, s[10:11] sc1
K_ARRS:
    s_mov_b64 exec, -1
    s_cmp_ge_u32 s30, 6
    s_cbranch_scc1 K_P2_HELP
    s_branch K_LATE
WP_early:
    s_setpc_b64 s[38:39]
K_P2_EARLY:
    s_lshl_b32 s54, s40, 7
    v_lshrrev_b32 v9, 4, v1
    v_mov_b32 v12, 158720
    s_add_u32 s20, s10, 0x100000
    s_addc_u32 s21, s11, 0
    s_mov_b32 s22, 0x280000
    s_mov_b32 s23, 0x20000
    s_add_u32 s16, s10, 0x1000
    s_addc_u32 s17, s11, 0
    s_mov_b32 s18, 0x2000
    s_mov_b32 s19, 0x20000
    s_mov_b32 s48, s6
    s_mov_b32 s49, s7
    s_mov_b32 s50, 0x280000
    s_mov_b32 s51, 0x20000
    s_lshl_b32 s53, s40, 3
    s_lshl1_add_u32 s53, s30, s53
    s_mov_b32 s55, 20480
    v_bfe_u32 v20, v1, 2, 2
    v_and_b32 v21, 3, v1
    s_mul_i32 s3, s53, 20480
    v_lshl_add_u32 v25, v1, 4, s3
    v_add_u32 v26, 20480, v25
    v_add_u32 v35, 16384, v25
    v_add_u32 v36, 16384, v26
    v_and_b32 v2, 15, v1
    s_lshl_b32 s3, s53, 6
    v_lshl_add_u32 v23, v2, 2, s3
    v_lshl_add_u32 v2, v9, 2, v20
    v_bfe_u32 v3, v2, 1, 2
    v_lshlrev_b32 v2, 7, v2
    v_lshl_add_u32 v2, v21, 3, v2
    v_lshl_add_u32 v24, v3, 5, v2
    v_lshrrev_b32 v3, 1, v20
    v_mul_u32_u24 v2, 40, v9
    v_add3_u32 v2, v2, 16, v20
    v_lshlrev_b32 v2, 7, v2
    v_lshl_add_u32 v2, v21, 3, v2
    v_xor_b32 v4, 0, v3
    v_lshl_add_u32 v60, v4, 5, v2
    v_xor_b32 v4, 1, v3
    v_lshl_add_u32 v61, v4, 5, v2
    v_xor_b32 v4, 2, v3
    v_lshl_add_u32 v62, v4, 5, v2
    v_xor_b32 v4, 3, v3
    v_lshl_add_u32 v63, v4, 5, v2
    v_lshrrev_b32 v3, 4, v1
    v_and_b32 v4, 7, v1
    v_lshrrev_b32 v2, 3, v1
    v_xor_b32 v4, v4, v3
    v_mul_u32_u24 v2, 1280, v2
    v_lshl_add_u32 v27, v4, 4, v2
    v_xor_b32 v28, 64, v27
    s_lshl_b32 s71, s40, 3
    s_lshl1_add_u32 s71, s30, s71
    s_mul_i32 s71, s71, 20480
    s_lshl_b32 s33, s41, 7
    s_add_u32 s71, s71, s33
    s_add_u32 s72, s71, 10240
    s_add_u32 s73, s71, 20480
    s_add_u32 s74, s71, 30720
    s_lshl_b32 s3, s30, 12
    s_add_u32 s3, s3, 140288
    v_lshl_add_u32 v33, v1, 4, s3
    v_and_b32 v2, 15, v1
    v_lshrrev_b32 v3, 1, v2
    v_lshrrev_b32 v4, 5, v1
    v_xor_b32 v3, v3, v4
    v_lshlrev_b32 v3, 4, v3
    v_lshl_add_u32 v3, v2, 7, v3
    v_and_b32 v4, 1, v9
    v_lshl_add_u32 v3, v4, 3, v3
    v_add_u32 v29, s3, v3
    v_xor_b32 v30, 32, v29
    v_xor_b32 v31, 64, v29
    v_xor_b32 v32, 96, v29
    s_and_b32 s33, s40, 3
    s_lshl_b32 s33, s33, 3
    s_lshr_b32 s33, 0x7f06037f, s33
    s_and_b32 s33, s33, 0xff
    s_lshl_b32 s3, s30, 1
    s_cmp_ge_u32 s3, s33
    s_cselect_b32 s64, 16, 0
    s_add_u32 s3, s3, 1
    s_cmp_ge_u32 s3, s33
    s_cselect_b32 s65, 16, 0
    s_mov_b32 s63, 0
    s_mov_b32 s66, 0
    s_mov_b32 s67, 16384
    v_mov_b32 v34, 0
    v_mov_b32 v4, 158720
    v_mov_b32 v3, 1
    s_mov_b64 exec, 1
    s_waitcnt vmcnt(0)
    ds_add_rtn_u32 v2, v4, v3 offset:48
    s_mov_b32 exec_lo, s36
    v_mov_b32 v3, 1
    s_waitcnt lgkmcnt(0)
    v_readfirstlane_b32 s33, v2
    s_nop 3
    s_and_b32 s33, s33, 0xff
    s_cmp_lg_u32 s33, 7
    s_cbranch_scc1 K_ARRD
    global_store_dword v8, v3, s[10:11] sc1
K_ARRD:
    s_mov_b64 exec, -1
    s_mov_b32 s3, 1048576
K_P2_GE:
    ds_read_b32 v2, v12 offset:48
    s_sub_u32 s3, s3, 1
    s_waitcnt lgkmcnt(0)
    v_readfirstlane_b32 s33, v2
    s_nop 3
    s_cselect_b32 s33, 1024, s33
    s_cmp_lt_u32 s33, 1024
    s_cbranch_scc1 K_P2_GE
K_P2_GEMM:
    s_setprio 0
    s_mov_b32 s3, 1048576
K_P2_GS:
    ds_read_b32 v2, v12 offset:40
    s_sub_u32 s3, s3, 1
    s_waitcnt lgkmcnt(0)
    v_readfirstlane_b32 s33, v2
    s_nop 3
    s_cselect_b32 s33, 1, s33
    s_cmp_lt_u32 s33, 1
    s_cbranch_scc1 K_P2_GS
    buffer_load_dword v64, v23, s[16:19], 0 offen offset:0 sc1
    buffer_load_dword v66, v23, s[16:19], 0 offen offset:64 sc1
    ds_read_b128 v[16:19], v12
    ds_read_b64 v[40:41], v29 offset:0
    ds_read_b64 v[42:43], v30 offset:0
    ds_read_b64 v[44:45], v31 offset:0
    ds_read_b64 v[46:47], v32 offset:0
    ds_read_b64 v[48:49], v29 offset:2048
    ds_read_b64 v[50:51], v30 offset:2048
    ds_read_b64 v[52:53], v31 offset:2048
    ds_read_b64 v[54:55], v32 offset:2048
    s_waitcnt lgkmcnt(4)
    v_lshlrev_b32 v72, 16, v40
    v_and_b32 v73, 0xffff0000, v40
    v_lshlrev_b32 v74, 16, v41
    v_and_b32 v75, 0xffff0000, v41
    v_lshlrev_b32 v76, 16, v42
    v_and_b32 v77, 0xffff0000, v42
    v_lshlrev_b32 v78, 16, v43
    v_and_b32 v79, 0xffff0000, v43
    v_lshlrev_b32 v80, 16, v44
    v_and_b32 v81, 0xffff0000, v44
    v_lshlrev_b32 v82, 16, v45
    v_and_b32 v83, 0xffff0000, v45
    v_lshlrev_b32 v84, 16, v46
    v_and_b32 v85, 0xffff0000, v46
    v_lshlrev_b32 v86, 16, v47
    v_and_b32 v87, 0xffff0000, v47
    s_waitcnt lgkmcnt(0)
    v_lshlrev_b32 v88, 16, v48
    v_and_b32 v89, 0xffff0000, v48
    v_lshlrev_b32 v90, 16, v49
    v_and_b32 v91, 0xffff0000, v49
    v_lshlrev_b32 v92, 16, v50
    v_and_b32 v93, 0xffff0000, v50
    v_lshlrev_b32 v94, 16, v51
    v_and_b32 v95, 0xffff0000, v51
    v_lshlrev_b32 v96, 16, v52
    v_and_b32 v97, 0xffff0000, v52
    v_lshlrev_b32 v98, 16, v53
    v_and_b32 v99, 0xffff0000, v53
    v_lshlrev_b32 v100, 16, v54
    v_and_b32 v101, 0xffff0000, v54
    v_lshlrev_b32 v102, 16, v55
    v_and_b32 v103, 0xffff0000, v55
    s_cmp_eq_u32 s63, 0
    s_cbranch_scc1 K_SP0
K_SPR0:
    s_ff1_i32_b32 s33, s63
    s_bitset0_b32 s63, s33
    s_lshl_b32 s75, s33, 10
    buffer_load_dwordx4 v[104:107], v25, s[20:23], s75 offen offset:0 sc1
    buffer_load_dwordx4 v[108:111], v26, s[20:23], s75 offen offset:0 sc1
    v_mad_u32_u24 v56, s75, 5, v24
    v_xor_b32 v58, 64, v56
    v_xor_b32 v57, 32, v56
    v_xor_b32 v59, 96, v56
    ds_read_b64_tr_b16 v[184:185], v56 offset:0
    ds_read_b64_tr_b16 v[186:187], v58 offset:2560
    ds_read_b64_tr_b16 v[188:189], v57 offset:0
    ds_read_b64_tr_b16 v[190:191], v59 offset:2560
    ds_read_b64_tr_b16 v[192:193], v58 offset:0
    ds_read_b64_tr_b16 v[194:195], v56 offset:2560
    ds_read_b64_tr_b16 v[196:197], v59 offset:0
    ds_read_b64_tr_b16 v[198:199], v57 offset:2560
    s_cmp_eq_u32 s63, 0
    s_cbranch_scc1 K_SP1
K_SPR1:
    s_ff1_i32_b32 s33, s63
    s_bitset0_b32 s63, s33
    s_lshl_b32 s76, s33, 10
    buffer_load_dwordx4 v[112:115], v25, s[20:23], s76 offen offset:0 sc1
    buffer_load_dwordx4 v[116:119], v26, s[20:23], s76 offen offset:0 sc1
    v_mad_u32_u24 v56, s76, 5, v24
    v_xor_b32 v58, 64, v56
    v_xor_b32 v57, 32, v56
    v_xor_b32 v59, 96, v56
    ds_read_b64_tr_b16 v[200:201], v56 offset:0
    ds_read_b64_tr_b16 v[202:203], v58 offset:2560
    ds_read_b64_tr_b16 v[204:205], v57 offset:0
    ds_read_b64_tr_b16 v[206:207], v59 offset:2560
    ds_read_b64_tr_b16 v[208:209], v58 offset:0
    ds_read_b64_tr_b16 v[210:211], v56 offset:2560
    ds_read_b64_tr_b16 v[212:213], v59 offset:0
    ds_read_b64_tr_b16 v[214:215], v57 offset:2560
    s_waitcnt vmcnt(4)
    s_mov_b64 exec, 1
    ds_add_u32 v12, v34 offset:44
    s_mov_b64 exec, -1
    v_sub_f32 v68, 1.0, v64
    v_cvt_pk_bf16_f32 v68, v68, v68
    v_lshlrev_b32 v68, 16, v68
    v_sub_f32 v70, 1.0, v66
    v_cvt_pk_bf16_f32 v70, v70, v70
    v_lshlrev_b32 v70, 16, v70
    v_pk_mul_f32 v[72:73], v[72:73], v[68:69] op_sel_hi:[1,0]
    v_pk_mul_f32 v[74:75], v[74:75], v[68:69] op_sel_hi:[1,0]
    v_pk_mul_f32 v[76:77], v[76:77], v[68:69] op_sel_hi:[1,0]
    v_pk_mul_f32 v[78:79], v[78:79], v[68:69] op_sel_hi:[1,0]
    v_pk_mul_f32 v[80:81], v[80:81], v[68:69] op_sel_hi:[1,0]
    v_pk_mul_f32 v[82:83], v[82:83], v[68:69] op_sel_hi:[1,0]
    v_pk_mul_f32 v[84:85], v[84:85], v[68:69] op_sel_hi:[1,0]
    v_pk_mul_f32 v[86:87], v[86:87], v[68:69] op_sel_hi:[1,0]
    v_pk_mul_f32 v[88:89], v[88:89], v[70:71] op_sel_hi:[1,0]
    v_pk_mul_f32 v[90:91], v[90:91], v[70:71] op_sel_hi:[1,0]
    v_pk_mul_f32 v[92:93], v[92:93], v[70:71] op_sel_hi:[1,0]
    v_pk_mul_f32 v[94:95], v[94:95], v[70:71] op_sel_hi:[1,0]
    v_pk_mul_f32 v[96:97], v[96:97], v[70:71] op_sel_hi:[1,0]
    v_pk_mul_f32 v[98:99], v[98:99], v[70:71] op_sel_hi:[1,0]
    v_pk_mul_f32 v[100:101], v[100:101], v[70:71] op_sel_hi:[1,0]
    v_pk_mul_f32 v[102:103], v[102:103], v[70:71] op_sel_hi:[1,0]
    s_cmp_eq_u32 s63, 0
    s_cbranch_scc1 K_SP2
K_SPR2:
    s_ff1_i32_b32 s33, s63
    s_bitset0_b32 s63, s33
    s_lshl_b32 s77, s33, 10
    buffer_load_dwordx4 v[120:123], v25, s[20:23], s77 offen offset:0 sc1
    buffer_load_dwordx4 v[124:127], v26, s[20:23], s77 offen offset:0 sc1
    s_cmp_eq_u32 s63, 0
    s_cbranch_scc1 K_SP3
K_SPR3:
    s_ff1_i32_b32 s33, s63
    s_bitset0_b32 s63, s33
    s_lshl_b32 s78, s33, 10
    buffer_load_dwordx4 v[128:131], v25, s[20:23], s78 offen offset:0 sc1
    buffer_load_dwordx4 v[132:135], v26, s[20:23], s78 offen offset:0 sc1
    s_cmp_eq_u32 s63, 0
    s_cbranch_scc1 K_SP4
K_SPR4:
    s_ff1_i32_b32 s33, s63
    s_bitset0_b32 s63, s33
    s_lshl_b32 s75, s33, 10
    buffer_load_dwordx4 v[136:139], v25, s[20:23], s75 offen offset:0 sc1
    buffer_load_dwordx4 v[140:143], v26, s[20:23], s75 offen offset:0 sc1
    s_branch WS_p2g
.p2align 12
WP_p2g:
    s_setpc_b64 s[38:39]
WS_p2g:
    s_waitcnt vmcnt(8) lgkmcnt(9)
    v_mfma_f32_16x16x32_bf16 v[152:155], v[184:187], v[104:107], 0
    v_mad_u32_u24 v56, s77, 5, v24
    v_xor_b32 v58, 64, v56
    v_xor_b32 v57, 32, v56
    v_mfma_f32_16x16x32_bf16 v[168:171], v[184:187], v[108:111], 0
    v_xor_b32 v59, 96, v56
    ds_read_b64_tr_b16 v[216:217], v56 offset:0
    ds_read_b64_tr_b16 v[218:219], v58 offset:2560
    v_mfma_f32_16x16x32_bf16 v[156:159], v[188:191], v[104:107], 0
    ds_read_b64_tr_b16 v[220:221], v57 offset:0
    ds_read_b64_tr_b16 v[222:223], v59 offset:2560
    ds_read_b64_tr_b16 v[224:225], v58 offset:0
    v_mfma_f32_16x16x32_bf16 v[172:175], v[188:191], v[108:111], 0
    ds_read_b64_tr_b16 v[226:227], v56 offset:2560
    ds_read_b64_tr_b16 v[228:229], v59 offset:0
    v_mfma_f32_16x16x32_bf16 v[160:163], v[192:195], v[104:107], 0
    ds_read_b64_tr_b16 v[230:231], v57 offset:2560
    s_cmp_eq_u32 s63, 0
    v_mfma_f32_16x16x32_bf16 v[176:179], v[192:195], v[108:111], 0
    s_cbranch_scc1 K_SP5
K_SPR5:
    s_ff1_i32_b32 s33, s63
    v_mfma_f32_16x16x32_bf16 v[164:167], v[196:199], v[104:107], 0
    s_bitset0_b32 s63, s33
    s_lshl_b32 s76, s33, 10
    v_mfma_f32_16x16x32_bf16 v[180:183], v[196:199], v[108:111], 0
    buffer_load_dwordx4 v[144:147], v25, s[20:23], s76 offen offset:0 sc1
    buffer_load_dwordx4 v[148:151], v26, s[20:23], s76 offen offset:0 sc1
    s_waitcnt vmcnt(8) lgkmcnt(9)
    v_mfma_f32_16x16x32_bf16 v[152:155], v[200:203], v[112:115], v[152:155]
    v_mad_u32_u24 v56, s78, 5, v24
    v_xor_b32 v58, 64, v56
    v_xor_b32 v57, 32, v56
    v_mfma_f32_16x16x32_bf16 v[168:171], v[200:203], v[116:119], v[168:171]
    v_xor_b32 v59, 96, v56
    ds_read_b64_tr_b16 v[184:185], v56 offset:0
    ds_read_b64_tr_b16 v[186:187], v58 offset:2560
    v_mfma_f32_16x16x32_bf16 v[156:159], v[204:207], v[112:115], v[156:159]
    ds_read_b64_tr_b16 v[188:189], v57 offset:0
    ds_read_b64_tr_b16 v[190:191], v59 offset:2560
    ds_read_b64_tr_b16 v[192:193], v58 offset:0
    v_mfma_f32_16x16x32_bf16 v[172:175], v[204:207], v[116:119], v[172:175]
    ds_read_b64_tr_b16 v[194:195], v56 offset:2560
    ds_read_b64_tr_b16 v[196:197], v59 offset:0
    v_mfma_f32_16x16x32_bf16 v[160:163], v[208:211], v[112:115], v[160:163]
    ds_read_b64_tr_b16 v[198:199], v57 offset:2560
    s_cmp_eq_u32 s63, 0
    v_mfma_f32_16x16x32_bf16 v[176:179], v[208:211], v[116:119], v[176:179]
    s_cbranch_scc1 K_SP6
K_SPR6:
    s_ff1_i32_b32 s33, s63
    v_mfma_f32_16x16x32_bf16 v[164:167], v[212:215], v[112:115], v[164:167]
    s_bitset0_b32 s63, s33
    s_lshl_b32 s77, s33, 10
    v_mfma_f32_16x16x32_bf16 v[180:183], v[212:215], v[116:119], v[180:183]
    buffer_load_dwordx4 v[104:107], v25, s[20:23], s77 offen offset:0 sc1
    buffer_load_dwordx4 v[108:111], v26, s[20:23], s77 offen offset:0 sc1
    s_waitcnt vmcnt(8) lgkmcnt(8)
    v_mfma_f32_16x16x32_bf16 v[152:155], v[216:219], v[120:123], v[152:155]
    v_mad_u32_u24 v56, s75, 5, v24
    v_xor_b32 v58, 64, v56
    v_xor_b32 v57, 32, v56
    v_mfma_f32_16x16x32_bf16 v[168:171], v[216:219], v[124:127], v[168:171]
    v_xor_b32 v59, 96, v56
    ds_read_b64_tr_b16 v[200:201], v56 offset:0
    ds_read_b64_tr_b16 v[202:203], v58 offset:2560
    v_mfma_f32_16x16x32_bf16 v[156:159], v[220:223], v[120:123], v[156:159]
    ds_read_b64_tr_b16 v[204:205], v57 offset:0
    ds_read_b64_tr_b16 v[206:207], v59 offset:2560
    ds_read_b64_tr_b16 v[208:209], v58 offset:0
    v_mfma_f32_16x16x32_bf16 v[172:175], v[220:223], v[124:127], v[172:175]
    ds_read_b64_tr_b16 v[210:211], v56 offset:2560
    ds_read_b64_tr_b16 v[212:213], v59 offset:0
    v_mfma_f32_16x16x32_bf16 v[160:163], v[224:227], v[120:123], v[160:163]
    ds_read_b64_tr_b16 v[214:215], v57 offset:2560
    s_andn2_b32 s33, s66, s63
    v_mfma_f32_16x16x32_bf16 v[176:179], v[224:227], v[124:127], v[176:179]
    s_bfe_u32 s33, s33, 0x40000
    s_cmp_eq_u32 s33, 15
    v_mfma_f32_16x16x32_bf16 v[164:167], v[228:231], v[120:123], v[164:167]
    s_cselect_b32 s78, 0, 1024
    s_xor_b32 s69, s78, 1024
    v_mfma_f32_16x16x32_bf16 v[180:183], v[228:231], v[124:127], v[180:183]
    buffer_load_dwordx4 v[112:115], v35, s[20:23], s78 offen offset:0 sc1
    buffer_load_dwordx4 v[116:119], v36, s[20:23], s78 offen offset:0 sc1
    s_waitcnt vmcnt(8) lgkmcnt(8)
    v_mfma_f32_16x16x32_bf16 v[152:155], v[184:187], v[128:131], v[152:155]
    v_mad_u32_u24 v56, s76, 5, v24
    v_xor_b32 v58, 64, v56
    v_xor_b32 v57, 32, v56
    v_mfma_f32_16x16x32_bf16 v[168:171], v[184:187], v[132:135], v[168:171]
    v_xor_b32 v59, 96, v56
    ds_read_b64_tr_b16 v[216:217], v56 offset:0
    ds_read_b64_tr_b16 v[218:219], v58 offset:2560
    v_mfma_f32_16x16x32_bf16 v[156:159], v[188:191], v[128:131], v[156:159]
    ds_read_b64_tr_b16 v[220:221], v57 offset:0
    ds_read_b64_tr_b16 v[222:223], v59 offset:2560
    ds_read_b64_tr_b16 v[224:225], v58 offset:0
    v_mfma_f32_16x16x32_bf16 v[172:175], v[188:191], v[132:135], v[172:175]
    ds_read_b64_tr_b16 v[226:227], v56 offset:2560
    ds_read_b64_tr_b16 v[228:229], v59 offset:0
    v_mfma_f32_16x16x32_bf16 v[160:163], v[192:195], v[128:131], v[160:163]
    ds_read_b64_tr_b16 v[230:231], v57 offset:2560
    s_cmp_eq_u32 s63, 0
    v_mfma_f32_16x16x32_bf16 v[176:179], v[192:195], v[132:135], v[176:179]
    s_cbranch_scc1 K_SP8
K_SPR8:
    s_ff1_i32_b32 s33, s63
    v_mfma_f32_16x16x32_bf16 v[164:167], v[196:199], v[128:131], v[164:167]
    s_bitset0_b32 s63, s33
    s_lshl_b32 s75, s33, 10
    v_mfma_f32_16x16x32_bf16 v[180:183], v[196:199], v[132:135], v[180:183]
    buffer_load_dwordx4 v[120:123], v25, s[20:23], s75 offen offset:0 sc1
    buffer_load_dwordx4 v[124:127], v26, s[20:23], s75 offen offset:0 sc1
    s_waitcnt vmcnt(8) lgkmcnt(8)
    v_mfma_f32_16x16x32_bf16 v[152:155], v[200:203], v[136:139], v[152:155]
    v_mad_u32_u24 v56, s77, 5, v24
    v_xor_b32 v58, 64, v56
    v_mfma_f32_16x16x32_bf16 v[168:171], v[200:203], v[140:143], v[168:171]
    v_xor_b32 v57, 32, v56
    v_xor_b32 v59, 96, v56
    v_mfma_f32_16x16x32_bf16 v[156:159], v[204:207], v[136:139], v[156:159]
    ds_read_b64_tr_b16 v[184:185], v56 offset:0
    ds_read_b64_tr_b16 v[186:187], v58 offset:2560
    v_mfma_f32_16x16x32_bf16 v[172:175], v[204:207], v[140:143], v[172:175]
    ds_read_b64_tr_b16 v[188:189], v57 offset:0
    ds_read_b64_tr_b16 v[190:191], v59 offset:2560
    v_mfma_f32_16x16x32_bf16 v[160:163], v[208:211], v[136:139], v[160:163]
    ds_read_b64_tr_b16 v[192:193], v58 offset:0
    ds_read_b64_tr_b16 v[194:195], v56 offset:2560
    v_mfma_f32_16x16x32_bf16 v[176:179], v[208:211], v[140:143], v[176:179]
    ds_read_b64_tr_b16 v[196:197], v59 offset:0
    ds_read_b64_tr_b16 v[198:199], v57 offset:2560
    v_mfma_f32_16x16x32_bf16 v[164:167], v[212:215], v[136:139], v[164:167]
    buffer_load_dwordx4 v[128:131], v35, s[20:23], s69 offen offset:0 sc1
    buffer_load_dwordx4 v[132:135], v36, s[20:23], s69 offen offset:0 sc1
    v_mfma_f32_16x16x32_bf16 v[180:183], v[212:215], v[140:143], v[180:183]
    s_waitcnt vmcnt(8) lgkmcnt(8)
    v_mfma_f32_16x16x32_bf16 v[152:155], v[216:219], v[144:147], v[152:155]
    v_mad_u32_u24 v56, s78, 20, v60
    v_xor_b32 v58, 64, v56
    v_xor_b32 v57, 32, v56
    v_mfma_f32_16x16x32_bf16 v[168:171], v[216:219], v[148:151], v[168:171]
    v_xor_b32 v59, 96, v56
    ds_read_b64_tr_b16 v[200:201], v56 offset:0
    ds_read_b64_tr_b16 v[202:203], v58 offset:2560
    v_mfma_f32_16x16x32_bf16 v[156:159], v[220:223], v[144:147], v[156:159]
    ds_read_b64_tr_b16 v[204:205], v57 offset:0
    ds_read_b64_tr_b16 v[206:207], v59 offset:2560
    ds_read_b64_tr_b16 v[208:209], v58 offset:0
    v_mfma_f32_16x16x32_bf16 v[172:175], v[220:223], v[148:151], v[172:175]
    ds_read_b64_tr_b16 v[210:211], v56 offset:2560
    ds_read_b64_tr_b16 v[212:213], v59 offset:0
    v_mfma_f32_16x16x32_bf16 v[160:163], v[224:227], v[144:147], v[160:163]
    ds_read_b64_tr_b16 v[214:215], v57 offset:2560
    s_cmp_eq_u32 s63, 0
    v_mfma_f32_16x16x32_bf16 v[176:179], v[224:227], v[148:151], v[176:179]
    s_cbranch_scc1 K_SP10
K_SPR10:
    s_ff1_i32_b32 s33, s63
    v_mfma_f32_16x16x32_bf16 v[164:167], v[228:231], v[144:147], v[164:167]
    s_bitset0_b32 s63, s33
    s_lshl_b32 s77, s33, 10
    v_mfma_f32_16x16x32_bf16 v[180:183], v[228:231], v[148:151], v[180:183]
    buffer_load_dwordx4 v[136:139], v25, s[20:23], s77 offen offset:0 sc1
    buffer_load_dwordx4 v[140:143], v26, s[20:23], s77 offen offset:0 sc1
    s_waitcnt vmcnt(8) lgkmcnt(8)
    v_mfma_f32_16x16x32_bf16 v[152:155], v[184:187], v[104:107], v[152:155]
    v_mad_u32_u24 v56, s75, 5, v24
    v_xor_b32 v58, 64, v56
    v_xor_b32 v57, 32, v56
    v_mfma_f32_16x16x32_bf16 v[168:171], v[184:187], v[108:111], v[168:171]
    v_xor_b32 v59, 96, v56
    ds_read_b64_tr_b16 v[216:217], v56 offset:0
    ds_read_b64_tr_b16 v[218:219], v58 offset:2560
    v_mfma_f32_16x16x32_bf16 v[156:159], v[188:191], v[104:107], v[156:159]
    ds_read_b64_tr_b16 v[220:221], v57 offset:0
    ds_read_b64_tr_b16 v[222:223], v59 offset:2560
    ds_read_b64_tr_b16 v[224:225], v58 offset:0
    v_mfma_f32_16x16x32_bf16 v[172:175], v[188:191], v[108:111], v[172:175]
    ds_read_b64_tr_b16 v[226:227], v56 offset:2560
    ds_read_b64_tr_b16 v[228:229], v59 offset:0
    v_mfma_f32_16x16x32_bf16 v[160:163], v[192:195], v[104:107], v[160:163]
    ds_read_b64_tr_b16 v[230:231], v57 offset:2560
    s_cmp_eq_u32 s63, 0
    v_mfma_f32_16x16x32_bf16 v[176:179], v[192:195], v[108:111], v[176:179]
    s_cbranch_scc1 K_SP11
K_SPR11:
    s_ff1_i32_b32 s33, s63
    v_mfma_f32_16x16x32_bf16 v[164:167], v[196:199], v[104:107], v[164:167]
    s_bitset0_b32 s63, s33
    s_lshl_b32 s78, s33, 10
    v_mfma_f32_16x16x32_bf16 v[180:183], v[196:199], v[108:111], v[180:183]
    buffer_load_dwordx4 v[144:147], v25, s[20:23], s78 offen offset:0 sc1
    buffer_load_dwordx4 v[148:151], v26, s[20:23], s78 offen offset:0 sc1
    s_waitcnt vmcnt(8) lgkmcnt(8)
    v_mfma_f32_16x16x32_bf16 v[152:155], v[200:203], v[112:115], v[152:155]
    v_mad_u32_u24 v56, s69, 20, v60
    v_xor_b32 v58, 64, v56
    v_xor_b32 v57, 32, v56
    v_mfma_f32_16x16x32_bf16 v[168:171], v[200:203], v[116:119], v[168:171]
    v_xor_b32 v59, 96, v56
    ds_read_b64_tr_b16 v[184:185], v56 offset:0
    ds_read_b64_tr_b16 v[186:187], v58 offset:2560
    v_mfma_f32_16x16x32_bf16 v[156:159], v[204:207], v[112:115], v[156:159]
    ds_read_b64_tr_b16 v[188:189], v57 offset:0
    ds_read_b64_tr_b16 v[190:191], v59 offset:2560
    ds_read_b64_tr_b16 v[192:193], v58 offset:0
    v_mfma_f32_16x16x32_bf16 v[172:175], v[204:207], v[116:119], v[172:175]
    ds_read_b64_tr_b16 v[194:195], v56 offset:2560
    ds_read_b64_tr_b16 v[196:197], v59 offset:0
    v_mfma_f32_16x16x32_bf16 v[160:163], v[208:211], v[112:115], v[160:163]
    ds_read_b64_tr_b16 v[198:199], v57 offset:2560
    s_cmp_eq_u32 s63, 0
    v_mfma_f32_16x16x32_bf16 v[176:179], v[208:211], v[116:119], v[176:179]
    s_cbranch_scc1 K_SP12
K_SPR12:
    s_ff1_i32_b32 s33, s63
    v_mfma_f32_16x16x32_bf16 v[164:167], v[212:215], v[112:115], v[164:167]
    s_bitset0_b32 s63, s33
    s_lshl_b32 s75, s33, 10
    v_mfma_f32_16x16x32_bf16 v[180:183], v[212:215], v[116:119], v[180:183]
    buffer_load_dwordx4 v[104:107], v25, s[20:23], s75 offen offset:0 sc1
    buffer_load_dwordx4 v[108:111], v26, s[20:23], s75 offen offset:0 sc1
    s_mov_b32 s3, 1048576
K_P2_GW:
    ds_read_b32 v2, v12 offset:44
    s_sub_u32 s3, s3, 1
    s_waitcnt lgkmcnt(0)
    v_readfirstlane_b32 s33, v2
    s_nop 3
    s_cselect_b32 s33, 4, s33
    s_cmp_lt_u32 s33, 4
    s_cbranch_scc1 K_P2_GW
    v_readfirstlane_b32 s56, v16
    v_readfirstlane_b32 s57, v17
    s_lshl_b32 s58, s53, 4
    s_waitcnt vmcnt(8)
    v_mfma_f32_16x16x32_bf16 v[152:155], v[216:219], v[120:123], v[152:155]
    v_mad_u32_u24 v56, s77, 5, v24
    v_xor_b32 v58, 64, v56
    v_xor_b32 v57, 32, v56
    v_mfma_f32_16x16x32_bf16 v[168:171], v[216:219], v[124:127], v[168:171]
    v_xor_b32 v59, 96, v56
    ds_read_b64_tr_b16 v[200:201], v56 offset:0
    ds_read_b64_tr_b16 v[202:203], v58 offset:2560
    v_mfma_f32_16x16x32_bf16 v[156:159], v[220:223], v[120:123], v[156:159]
    ds_read_b64_tr_b16 v[204:205], v57 offset:0
    ds_read_b64_tr_b16 v[206:207], v59 offset:2560
    ds_read_b64_tr_b16 v[208:209], v58 offset:0
    v_mfma_f32_16x16x32_bf16 v[172:175], v[220:223], v[124:127], v[172:175]
    ds_read_b64_tr_b16 v[210:211], v56 offset:2560
    ds_read_b64_tr_b16 v[212:213], v59 offset:0
    v_mfma_f32_16x16x32_bf16 v[160:163], v[224:227], v[120:123], v[160:163]
    ds_read_b64_tr_b16 v[214:215], v57 offset:2560
    s_cmp_eq_u32 s63, 0
    v_mfma_f32_16x16x32_bf16 v[176:179], v[224:227], v[124:127], v[176:179]
    s_cbranch_scc1 K_SP13
K_SPR13:
    s_ff1_i32_b32 s33, s63
    v_mfma_f32_16x16x32_bf16 v[164:167], v[228:231], v[120:123], v[164:167]
    s_bitset0_b32 s63, s33
    s_lshl_b32 s76, s33, 10
    v_mfma_f32_16x16x32_bf16 v[180:183], v[228:231], v[124:127], v[180:183]
    buffer_load_dwordx4 v[112:115], v25, s[20:23], s76 offen offset:0 sc1
    buffer_load_dwordx4 v[116:119], v26, s[20:23], s76 offen offset:0 sc1
    s_waitcnt vmcnt(8)
    v_mfma_f32_16x16x32_bf16 v[152:155], v[184:187], v[128:131], v[152:155]
    v_mad_u32_u24 v56, s78, 5, v24
    v_xor_b32 v58, 64, v56
    v_xor_b32 v57, 32, v56
    v_mfma_f32_16x16x32_bf16 v[168:171], v[184:187], v[132:135], v[168:171]
    v_xor_b32 v59, 96, v56
    ds_read_b64_tr_b16 v[216:217], v56 offset:0
    ds_read_b64_tr_b16 v[218:219], v58 offset:2560
    v_mfma_f32_16x16x32_bf16 v[156:159], v[188:191], v[128:131], v[156:159]
    ds_read_b64_tr_b16 v[220:221], v57 offset:0
    ds_read_b64_tr_b16 v[222:223], v59 offset:2560
    ds_read_b64_tr_b16 v[224:225], v58 offset:0
    v_mfma_f32_16x16x32_bf16 v[172:175], v[188:191], v[132:135], v[172:175]
    ds_read_b64_tr_b16 v[226:227], v56 offset:2560
    ds_read_b64_tr_b16 v[228:229], v59 offset:0
    v_mfma_f32_16x16x32_bf16 v[160:163], v[192:195], v[128:131], v[160:163]
    ds_read_b64_tr_b16 v[230:231], v57 offset:2560
    s_cmp_eq_u32 s63, 0
    v_mfma_f32_16x16x32_bf16 v[176:179], v[192:195], v[132:135], v[176:179]
    s_cbranch_scc1 K_SP14
K_SPR14:
    s_ff1_i32_b32 s33, s63
    v_mfma_f32_16x16x32_bf16 v[164:167], v[196:199], v[128:131], v[164:167]
    s_bitset0_b32 s63, s33
    s_lshl_b32 s77, s33, 10
    v_mfma_f32_16x16x32_bf16 v[180:183], v[196:199], v[132:135], v[180:183]
    buffer_load_dwordx4 v[120:123], v25, s[20:23], s77 offen offset:0 sc1
    buffer_load_dwordx4 v[124:127], v26, s[20:23], s77 offen offset:0 sc1
    s_waitcnt vmcnt(8) lgkmcnt(8)
    v_mfma_f32_16x16x32_bf16 v[152:155], v[200:203], v[136:139], v[152:155]
    v_mad_u32_u24 v56, s75, 5, v24
    v_xor_b32 v58, 64, v56
    v_xor_b32 v57, 32, v56
    v_mfma_f32_16x16x32_bf16 v[168:171], v[200:203], v[140:143], v[168:171]
    v_xor_b32 v59, 96, v56
    ds_read_b64_tr_b16 v[184:185], v56 offset:0
    ds_read_b64_tr_b16 v[186:187], v58 offset:2560
    v_mfma_f32_16x16x32_bf16 v[156:159], v[204:207], v[136:139], v[156:159]
    ds_read_b64_tr_b16 v[188:189], v57 offset:0
    ds_read_b64_tr_b16 v[190:191], v59 offset:2560
    ds_read_b64_tr_b16 v[192:193], v58 offset:0
    v_mfma_f32_16x16x32_bf16 v[172:175], v[204:207], v[140:143], v[172:175]
    ds_read_b64_tr_b16 v[194:195], v56 offset:2560
    ds_read_b64_tr_b16 v[196:197], v59 offset:0
    v_mfma_f32_16x16x32_bf16 v[160:163], v[208:211], v[136:139], v[160:163]
    ds_read_b64_tr_b16 v[198:199], v57 offset:2560
    s_cmp_eq_u32 s63, 0
    v_mfma_f32_16x16x32_bf16 v[176:179], v[208:211], v[140:143], v[176:179]
    s_cbranch_scc1 K_SP15
K_SPR15:
    s_ff1_i32_b32 s33, s63
    v_mfma_f32_16x16x32_bf16 v[164:167], v[212:215], v[136:139], v[164:167]
    s_bitset0_b32 s63, s33
    s_lshl_b32 s78, s33, 10
    v_mfma_f32_16x16x32_bf16 v[180:183], v[212:215], v[140:143], v[180:183]
    buffer_load_dwordx4 v[128:131], v25, s[20:23], s78 offen offset:0 sc1
    buffer_load_dwordx4 v[132:135], v26, s[20:23], s78 offen offset:0 sc1
    s_waitcnt vmcnt(8) lgkmcnt(8)
    v_mfma_f32_16x16x32_bf16 v[152:155], v[216:219], v[144:147], v[152:155]
    v_mad_u32_u24 v56, s76, 5, v24
    v_xor_b32 v58, 64, v56
    v_xor_b32 v57, 32, v56
    v_mfma_f32_16x16x32_bf16 v[168:171], v[216:219], v[148:151], v[168:171]
    v_xor_b32 v59, 96, v56
    ds_read_b64_tr_b16 v[200:201], v56 offset:0
    ds_read_b64_tr_b16 v[202:203], v58 offset:2560
    v_mfma_f32_16x16x32_bf16 v[156:159], v[220:223], v[144:147], v[156:159]
    ds_read_b64_tr_b16 v[204:205], v57 offset:0
    ds_read_b64_tr_b16 v[206:207], v59 offset:2560
    ds_read_b64_tr_b16 v[208:209], v58 offset:0
    v_mfma_f32_16x16x32_bf16 v[172:175], v[220:223], v[148:151], v[172:175]
    ds_read_b64_tr_b16 v[210:211], v56 offset:2560
    ds_read_b64_tr_b16 v[212:213], v59 offset:0
    v_mfma_f32_16x16x32_bf16 v[160:163], v[224:227], v[144:147], v[160:163]
    ds_read_b64_tr_b16 v[214:215], v57 offset:2560
    s_cmp_eq_u32 s63, 0
    v_mfma_f32_16x16x32_bf16 v[176:179], v[224:227], v[148:151], v[176:179]
    s_cbranch_scc1 K_SP16
K_SPR16:
    s_ff1_i32_b32 s33, s63
    v_mfma_f32_16x16x32_bf16 v[164:167], v[228:231], v[144:147], v[164:167]
    s_bitset0_b32 s63, s33
    s_lshl_b32 s75, s33, 10
    v_mfma_f32_16x16x32_bf16 v[180:183], v[228:231], v[148:151], v[180:183]
    buffer_load_dwordx4 v[136:139], v25, s[20:23], s75 offen offset:0 sc1
    buffer_load_dwordx4 v[140:143], v26, s[20:23], s75 offen offset:0 sc1
    s_waitcnt vmcnt(8) lgkmcnt(8)
    v_mfma_f32_16x16x32_bf16 v[152:155], v[184:187], v[104:107], v[152:155]
    v_mad_u32_u24 v56, s77, 5, v24
    v_xor_b32 v58, 64, v56
    v_xor_b32 v57, 32, v56
    v_mfma_f32_16x16x32_bf16 v[168:171], v[184:187], v[108:111], v[168:171]
    v_xor_b32 v59, 96, v56
    ds_read_b64_tr_b16 v[216:217], v56 offset:0
    ds_read_b64_tr_b16 v[218:219], v58 offset:2560
    v_mfma_f32_16x16x32_bf16 v[156:159], v[188:191], v[104:107], v[156:159]
    ds_read_b64_tr_b16 v[220:221], v57 offset:0
    ds_read_b64_tr_b16 v[222:223], v59 offset:2560
    ds_read_b64_tr_b16 v[224:225], v58 offset:0
    v_mfma_f32_16x16x32_bf16 v[172:175], v[188:191], v[108:111], v[172:175]
    ds_read_b64_tr_b16 v[226:227], v56 offset:2560
    ds_read_b64_tr_b16 v[228:229], v59 offset:0
    v_mfma_f32_16x16x32_bf16 v[160:163], v[192:195], v[104:107], v[160:163]
    ds_read_b64_tr_b16 v[230:231], v57 offset:2560
    s_andn2_b32 s33, s66, s63
    v_mfma_f32_16x16x32_bf16 v[176:179], v[192:195], v[108:111], v[176:179]
    s_bfe_u32 s33, s33, 0x40008
    s_cmp_eq_u32 s33, 15
    v_mfma_f32_16x16x32_bf16 v[164:167], v[196:199], v[104:107], v[164:167]
    s_cselect_b32 s76, 0, 1024
    s_xor_b32 s69, s76, 1024
    v_mfma_f32_16x16x32_bf16 v[180:183], v[196:199], v[108:111], v[180:183]
    buffer_load_dwordx4 v[144:147], v35, s[20:23], s76 offen offset:2048 sc1
    buffer_load_dwordx4 v[148:151], v36, s[20:23], s76 offen offset:2048 sc1
    s_waitcnt vmcnt(8) lgkmcnt(8)
    v_mfma_f32_16x16x32_bf16 v[152:155], v[200:203], v[112:115], v[152:155]
    v_mad_u32_u24 v56, s78, 5, v24
    v_xor_b32 v58, 64, v56
    v_xor_b32 v57, 32, v56
    v_mfma_f32_16x16x32_bf16 v[168:171], v[200:203], v[116:119], v[168:171]
    v_xor_b32 v59, 96, v56
    ds_read_b64_tr_b16 v[184:185], v56 offset:0
    ds_read_b64_tr_b16 v[186:187], v58 offset:2560
    v_mfma_f32_16x16x32_bf16 v[156:159], v[204:207], v[112:115], v[156:159]
    ds_read_b64_tr_b16 v[188:189], v57 offset:0
    ds_read_b64_tr_b16 v[190:191], v59 offset:2560
    ds_read_b64_tr_b16 v[192:193], v58 offset:0
    v_mfma_f32_16x16x32_bf16 v[172:175], v[204:207], v[116:119], v[172:175]
    ds_read_b64_tr_b16 v[194:195], v56 offset:2560
    ds_read_b64_tr_b16 v[196:197], v59 offset:0
    v_mfma_f32_16x16x32_bf16 v[160:163], v[208:211], v[112:115], v[160:163]
    ds_read_b64_tr_b16 v[198:199], v57 offset:2560
    s_cmp_eq_u32 s63, 0
    v_mfma_f32_16x16x32_bf16 v[176:179], v[208:211], v[116:119], v[176:179]
    s_cbranch_scc1 K_SP18
K_SPR18:
    s_ff1_i32_b32 s33, s63
    v_mfma_f32_16x16x32_bf16 v[164:167], v[212:215], v[112:115], v[164:167]
    s_bitset0_b32 s63, s33
    s_lshl_b32 s77, s33, 10
    v_mfma_f32_16x16x32_bf16 v[180:183], v[212:215], v[116:119], v[180:183]
    buffer_load_dwordx4 v[104:107], v25, s[20:23], s77 offen offset:0 sc1
    buffer_load_dwordx4 v[108:111], v26, s[20:23], s77 offen offset:0 sc1
    s_waitcnt vmcnt(8) lgkmcnt(8)
    v_mfma_f32_16x16x32_bf16 v[152:155], v[216:219], v[120:123], v[152:155]
    v_mad_u32_u24 v56, s75, 5, v24
    v_xor_b32 v58, 64, v56
    v_mfma_f32_16x16x32_bf16 v[168:171], v[216:219], v[124:127], v[168:171]
    v_xor_b32 v57, 32, v56
    v_xor_b32 v59, 96, v56
    v_mfma_f32_16x16x32_bf16 v[156:159], v[220:223], v[120:123], v[156:159]
    ds_read_b64_tr_b16 v[200:201], v56 offset:0
    ds_read_b64_tr_b16 v[202:203], v58 offset:2560
    v_mfma_f32_16x16x32_bf16 v[172:175], v[220:223], v[124:127], v[172:175]
    ds_read_b64_tr_b16 v[204:205], v57 offset:0
    ds_read_b64_tr_b16 v[206:207], v59 offset:2560
    v_mfma_f32_16x16x32_bf16 v[160:163], v[224:227], v[120:123], v[160:163]
    ds_read_b64_tr_b16 v[208:209], v58 offset:0
    ds_read_b64_tr_b16 v[210:211], v56 offset:2560
    v_mfma_f32_16x16x32_bf16 v[176:179], v[224:227], v[124:127], v[176:179]
    ds_read_b64_tr_b16 v[212:213], v59 offset:0
    ds_read_b64_tr_b16 v[214:215], v57 offset:2560
    v_mfma_f32_16x16x32_bf16 v[164:167], v[228:231], v[120:123], v[164:167]
    buffer_load_dwordx4 v[112:115], v35, s[20:23], s69 offen offset:2048 sc1
    buffer_load_dwordx4 v[116:119], v36, s[20:23], s69 offen offset:2048 sc1
    v_mfma_f32_16x16x32_bf16 v[180:183], v[228:231], v[124:127], v[180:183]
    s_waitcnt vmcnt(8) lgkmcnt(8)
    v_mfma_f32_16x16x32_bf16 v[152:155], v[184:187], v[128:131], v[152:155]
    v_mad_u32_u24 v56, s76, 20, v60
    v_xor_b32 v58, 64, v56
    v_mfma_f32_16x16x32_bf16 v[168:171], v[184:187], v[132:135], v[168:171]
    v_xor_b32 v57, 32, v56
    v_xor_b32 v59, 96, v56
    v_mfma_f32_16x16x32_bf16 v[156:159], v[188:191], v[128:131], v[156:159]
    ds_read_b64_tr_b16 v[216:217], v56 offset:40960
    ds_read_b64_tr_b16 v[218:219], v58 offset:43520
    v_mfma_f32_16x16x32_bf16 v[172:175], v[188:191], v[132:135], v[172:175]
    ds_read_b64_tr_b16 v[220:221], v57 offset:40960
    ds_read_b64_tr_b16 v[222:223], v59 offset:43520
    v_mfma_f32_16x16x32_bf16 v[160:163], v[192:195], v[128:131], v[160:163]
    ds_read_b64_tr_b16 v[224:225], v58 offset:40960
    ds_read_b64_tr_b16 v[226:227], v56 offset:43520
    v_mfma_f32_16x16x32_bf16 v[176:179], v[192:195], v[132:135], v[176:179]
    ds_read_b64_tr_b16 v[228:229], v59 offset:40960
    ds_read_b64_tr_b16 v[230:231], v57 offset:43520
    v_mfma_f32_16x16x32_bf16 v[164:167], v[196:199], v[128:131], v[164:167]
    v_mfma_f32_16x16x32_bf16 v[180:183], v[196:199], v[132:135], v[180:183]
    s_waitcnt vmcnt(6) lgkmcnt(8)
    v_mfma_f32_16x16x32_bf16 v[152:155], v[200:203], v[136:139], v[152:155]
    v_mad_u32_u24 v56, s77, 5, v24
    v_xor_b32 v58, 64, v56
    v_mfma_f32_16x16x32_bf16 v[168:171], v[200:203], v[140:143], v[168:171]
    v_xor_b32 v57, 32, v56
    v_xor_b32 v59, 96, v56
    v_mfma_f32_16x16x32_bf16 v[156:159], v[204:207], v[136:139], v[156:159]
    ds_read_b64_tr_b16 v[184:185], v56 offset:0
    ds_read_b64_tr_b16 v[186:187], v58 offset:2560
    v_mfma_f32_16x16x32_bf16 v[172:175], v[204:207], v[140:143], v[172:175]
    ds_read_b64_tr_b16 v[188:189], v57 offset:0
    ds_read_b64_tr_b16 v[190:191], v59 offset:2560
    v_mfma_f32_16x16x32_bf16 v[160:163], v[208:211], v[136:139], v[160:163]
    ds_read_b64_tr_b16 v[192:193], v58 offset:0
    ds_read_b64_tr_b16 v[194:195], v56 offset:2560
    v_mfma_f32_16x16x32_bf16 v[176:179], v[208:211], v[140:143], v[176:179]
    ds_read_b64_tr_b16 v[196:197], v59 offset:0
    ds_read_b64_tr_b16 v[198:199], v57 offset:2560
    v_mfma_f32_16x16x32_bf16 v[164:167], v[212:215], v[136:139], v[164:167]
    v_mfma_f32_16x16x32_bf16 v[180:183], v[212:215], v[140:143], v[180:183]
    s_waitcnt vmcnt(4) lgkmcnt(8)
    v_mfma_f32_16x16x32_bf16 v[152:155], v[216:219], v[144:147], v[152:155]
    v_mad_u32_u24 v56, s69, 20, v60
    v_xor_b32 v58, 64, v56
    v_mfma_f32_16x16x32_bf16 v[168:171], v[216:219], v[148:151], v[168:171]
    v_xor_b32 v57, 32, v56
    v_xor_b32 v59, 96, v56
    v_mfma_f32_16x16x32_bf16 v[156:159], v[220:223], v[144:147], v[156:159]
    ds_read_b64_tr_b16 v[200:201], v56 offset:40960
    ds_read_b64_tr_b16 v[202:203], v58 offset:43520
    v_mfma_f32_16x16x32_bf16 v[172:175], v[220:223], v[148:151], v[172:175]
    ds_read_b64_tr_b16 v[204:205], v57 offset:40960
    ds_read_b64_tr_b16 v[206:207], v59 offset:43520
    v_mfma_f32_16x16x32_bf16 v[160:163], v[224:227], v[144:147], v[160:163]
    ds_read_b64_tr_b16 v[208:209], v58 offset:40960
    ds_read_b64_tr_b16 v[210:211], v56 offset:43520
    v_mfma_f32_16x16x32_bf16 v[176:179], v[224:227], v[148:151], v[176:179]
    ds_read_b64_tr_b16 v[212:213], v59 offset:40960
    ds_read_b64_tr_b16 v[214:215], v57 offset:43520
    v_mfma_f32_16x16x32_bf16 v[164:167], v[228:231], v[144:147], v[164:167]
    v_mfma_f32_16x16x32_bf16 v[180:183], v[228:231], v[148:151], v[180:183]
    s_waitcnt vmcnt(2) lgkmcnt(8)
    v_mfma_f32_16x16x32_bf16 v[152:155], v[184:187], v[104:107], v[152:155]
    v_mfma_f32_16x16x32_bf16 v[156:159], v[188:191], v[104:107], v[156:159]
    v_mfma_f32_16x16x32_bf16 v[160:163], v[192:195], v[104:107], v[160:163]
    v_mfma_f32_16x16x32_bf16 v[164:167], v[196:199], v[104:107], v[164:167]
    s_sub_u32 s59, s56, s58
    s_cmp_lt_u32 s59, 32
    s_cbranch_scc1 K_YROW0
K_NOY0:
    s_sub_u32 s59, s57, s58
    s_cmp_lt_u32 s59, 32
    s_cbranch_scc1 K_YROW1
K_NOY1:
    s_waitcnt vmcnt(0) lgkmcnt(0)
    v_mfma_f32_16x16x32_bf16 v[152:155], v[200:203], v[112:115], v[152:155]
    v_mfma_f32_16x16x32_bf16 v[156:159], v[204:207], v[112:115], v[156:159]
    v_mfma_f32_16x16x32_bf16 v[160:163], v[208:211], v[112:115], v[160:163]
    v_mfma_f32_16x16x32_bf16 v[164:167], v[212:215], v[112:115], v[164:167]
    v_mfma_f32_16x16x32_bf16 v[168:171], v[184:187], v[108:111], v[168:171]
    v_mfma_f32_16x16x32_bf16 v[172:175], v[188:191], v[108:111], v[172:175]
    v_mfma_f32_16x16x32_bf16 v[176:179], v[192:195], v[108:111], v[176:179]
    s_nop 1
    v_fma_f32 v152, v152, v64, v72
    v_fma_f32 v153, v153, v64, v73
    v_fma_f32 v154, v154, v64, v74
    v_mfma_f32_16x16x32_bf16 v[180:183], v[196:199], v[108:111], v[180:183]
    v_fma_f32 v155, v155, v64, v75
    v_cvt_pk_bf16_f32 v40, v152, v153
    v_cvt_pk_bf16_f32 v41, v154, v155
    v_mfma_f32_16x16x32_bf16 v[168:171], v[200:203], v[116:119], v[168:171]
    v_fma_f32 v156, v156, v64, v76
    v_fma_f32 v157, v157, v64, v77
    ds_write_b64 v29, v[40:41] offset:0
    v_mfma_f32_16x16x32_bf16 v[172:175], v[204:207], v[116:119], v[172:175]
    v_fma_f32 v158, v158, v64, v78
    v_fma_f32 v159, v159, v64, v79
    v_cvt_pk_bf16_f32 v42, v156, v157
    v_mfma_f32_16x16x32_bf16 v[176:179], v[208:211], v[116:119], v[176:179]
    v_cvt_pk_bf16_f32 v43, v158, v159
    v_fma_f32 v160, v160, v64, v80
    v_fma_f32 v161, v161, v64, v81
    v_mfma_f32_16x16x32_bf16 v[180:183], v[212:215], v[116:119], v[180:183]
    ds_write_b64 v30, v[42:43] offset:0
    v_fma_f32 v162, v162, v64, v82
    v_fma_f32 v163, v163, v64, v83
    v_cvt_pk_bf16_f32 v44, v160, v161
    v_cvt_pk_bf16_f32 v45, v162, v163
    v_pk_fma_f32 v[164:165], v[164:165], v[64:65], v[84:85] op_sel_hi:[1,0,1]
    v_pk_fma_f32 v[166:167], v[166:167], v[64:65], v[86:87] op_sel_hi:[1,0,1]
    ds_write_b64 v31, v[44:45] offset:0
    v_cvt_pk_bf16_f32 v46, v164, v165
    v_cvt_pk_bf16_f32 v47, v166, v167
    ds_write_b64 v32, v[46:47] offset:0
    ds_read_b128 v[72:75], v33 offset:0
    ds_read_b128 v[76:79], v33 offset:1024
    v_pk_fma_f32 v[168:169], v[168:169], v[66:67], v[88:89] op_sel_hi:[1,0,1]
    v_pk_fma_f32 v[170:171], v[170:171], v[66:67], v[90:91] op_sel_hi:[1,0,1]
    v_cvt_pk_bf16_f32 v48, v168, v169
    v_cvt_pk_bf16_f32 v49, v170, v171
    v_pk_fma_f32 v[172:173], v[172:173], v[66:67], v[92:93] op_sel_hi:[1,0,1]
    v_pk_fma_f32 v[174:175], v[174:175], v[66:67], v[94:95] op_sel_hi:[1,0,1]
    v_cvt_pk_bf16_f32 v50, v172, v173
    v_cvt_pk_bf16_f32 v51, v174, v175
    v_pk_fma_f32 v[176:177], v[176:177], v[66:67], v[96:97] op_sel_hi:[1,0,1]
    v_pk_fma_f32 v[178:179], v[178:179], v[66:67], v[98:99] op_sel_hi:[1,0,1]
    v_cvt_pk_bf16_f32 v52, v176, v177
    v_cvt_pk_bf16_f32 v53, v178, v179
    v_pk_fma_f32 v[180:181], v[180:181], v[66:67], v[100:101] op_sel_hi:[1,0,1]
    v_pk_fma_f32 v[182:183], v[182:183], v[66:67], v[102:103] op_sel_hi:[1,0,1]
    v_cvt_pk_bf16_f32 v54, v180, v181
    v_cvt_pk_bf16_f32 v55, v182, v183
    s_waitcnt lgkmcnt(0)
    buffer_store_dwordx4 v[72:75], v27, s[48:51], s71 offen sc1
    buffer_store_dwordx4 v[76:79], v28, s[48:51], s72 offen sc1
    ds_write_b64 v29, v[48:49] offset:2048
    ds_write_b64 v30, v[50:51] offset:2048
    ds_write_b64 v31, v[52:53] offset:2048
    ds_write_b64 v32, v[54:55] offset:2048
    ds_read_b128 v[88:91], v33 offset:2048
    ds_read_b128 v[92:95], v33 offset:3072
    s_waitcnt lgkmcnt(1)
    buffer_store_dwordx4 v[88:91], v27, s[48:51], s73 offen sc1
    s_waitcnt lgkmcnt(0)
    buffer_store_dwordx4 v[92:95], v28, s[48:51], s74 offen sc1
K_END:
K_EXIT:
    s_endpgm
.p2align 12
WP_spin:
    s_setpc_b64 s[38:39]
K_SP0:
    ds_read_b32 v2, v12 offset:32
    s_waitcnt lgkmcnt(0)
    v_readfirstlane_b32 s33, v2
    s_nop 3
    s_lshr_b32 s63, s33, s64
    s_lshr_b32 s33, s33, s65
    s_and_b32 s63, s63, s33
    s_and_b32 s63, s63, 0xff
    s_andn2_b32 s63, s63, s66
    s_cbranch_scc0 K_SP0
    s_or_b32 s66, s66, s63
    s_branch K_SPR0
K_SP1:
    ds_read_b32 v2, v12 offset:32
    s_waitcnt lgkmcnt(0)
    v_readfirstlane_b32 s33, v2
    s_nop 3
    s_lshr_b32 s63, s33, s64
    s_lshr_b32 s33, s33, s65
    s_and_b32 s63, s63, s33
    s_and_b32 s63, s63, 0xff
    s_andn2_b32 s63, s63, s66
    s_cbranch_scc0 K_SP1
    s_or_b32 s66, s66, s63
    s_branch K_SPR1
K_SP2:
    ds_read_b32 v2, v12 offset:32
    s_waitcnt lgkmcnt(0)
    v_readfirstlane_b32 s33, v2
    s_nop 3
    s_lshr_b32 s63, s33, s64
    s_lshr_b32 s33, s33, s65
    s_and_b32 s63, s63, s33
    s_and_b32 s63, s63, 0xff
    s_andn2_b32 s63, s63, s66
    s_cbranch_scc0 K_SP2
    s_or_b32 s66, s66, s63
    s_branch K_SPR2
K_SP3:
    ds_read_b32 v2, v12 offset:32
    s_waitcnt lgkmcnt(0)
    v_readfirstlane_b32 s33, v2
    s_nop 3
    s_lshr_b32 s63, s33, s64
    s_lshr_b32 s33, s33, s65
    s_and_b32 s63, s63, s33
    s_and_b32 s63, s63, 0xff
    s_andn2_b32 s63, s63, s66
    s_cbranch_scc0 K_SP3
    s_or_b32 s66, s66, s63
    s_branch K_SPR3
K_SP4:
    ds_read_b32 v2, v12 offset:32
    s_waitcnt lgkmcnt(0)
    v_readfirstlane_b32 s33, v2
    s_nop 3
    s_lshr_b32 s63, s33, s64
    s_lshr_b32 s33, s33, s65
    s_and_b32 s63, s63, s33
    s_and_b32 s63, s63, 0xff
    s_andn2_b32 s63, s63, s66
    s_cbranch_scc0 K_SP4
    s_or_b32 s66, s66, s63
    s_branch K_SPR4
K_SP5:
    ds_read_b32 v2, v12 offset:32
    s_waitcnt lgkmcnt(0)
    v_readfirstlane_b32 s33, v2
    s_nop 3
    s_lshr_b32 s63, s33, s64
    s_lshr_b32 s33, s33, s65
    s_and_b32 s63, s63, s33
    s_and_b32 s63, s63, 0xff
    s_andn2_b32 s63, s63, s66
    s_cbranch_scc0 K_SP5
    s_or_b32 s66, s66, s63
    s_branch K_SPR5
K_SP6:
    ds_read_b32 v2, v12 offset:32
    s_waitcnt lgkmcnt(0)
    v_readfirstlane_b32 s33, v2
    s_nop 3
    s_lshr_b32 s63, s33, s64
    s_lshr_b32 s33, s33, s65
    s_and_b32 s63, s63, s33
    s_and_b32 s63, s63, 0xff
    s_andn2_b32 s63, s63, s66
    s_cbranch_scc0 K_SP6
    s_or_b32 s66, s66, s63
    s_branch K_SPR6
K_SP8:
    ds_read_b32 v2, v12 offset:32
    s_waitcnt lgkmcnt(0)
    v_readfirstlane_b32 s33, v2
    s_nop 3
    s_lshr_b32 s63, s33, s64
    s_lshr_b32 s33, s33, s65
    s_and_b32 s63, s63, s33
    s_and_b32 s63, s63, 0xff
    s_andn2_b32 s63, s63, s66
    s_cbranch_scc0 K_SP8
    s_or_b32 s66, s66, s63
    s_branch K_SPR8
K_SP10:
    ds_read_b32 v2, v12 offset:32
    s_waitcnt lgkmcnt(0)
    v_readfirstlane_b32 s33, v2
    s_nop 3
    s_lshr_b32 s63, s33, s64
    s_lshr_b32 s33, s33, s65
    s_and_b32 s63, s63, s33
    s_and_b32 s63, s63, 0xff00
    s_andn2_b32 s63, s63, s66
    s_cbranch_scc0 K_SP10
    s_or_b32 s66, s66, s63
    s_branch K_SPR10
K_SP11:
    ds_read_b32 v2, v12 offset:32
    s_waitcnt lgkmcnt(0)
    v_readfirstlane_b32 s33, v2
    s_nop 3
    s_lshr_b32 s63, s33, s64
    s_lshr_b32 s33, s33, s65
    s_and_b32 s63, s63, s33
    s_and_b32 s63, s63, 0xff00
    s_andn2_b32 s63, s63, s66
    s_cbranch_scc0 K_SP11
    s_or_b32 s66, s66, s63
    s_branch K_SPR11
K_SP12:
    ds_read_b32 v2, v12 offset:32
    s_waitcnt lgkmcnt(0)
    v_readfirstlane_b32 s33, v2
    s_nop 3
    s_lshr_b32 s63, s33, s64
    s_lshr_b32 s33, s33, s65
    s_and_b32 s63, s63, s33
    s_and_b32 s63, s63, 0xff00
    s_andn2_b32 s63, s63, s66
    s_cbranch_scc0 K_SP12
    s_or_b32 s66, s66, s63
    s_branch K_SPR12
K_SP13:
    ds_read_b32 v2, v12 offset:32
    s_waitcnt lgkmcnt(0)
    v_readfirstlane_b32 s33, v2
    s_nop 3
    s_lshr_b32 s63, s33, s64
    s_lshr_b32 s33, s33, s65
    s_and_b32 s63, s63, s33
    s_and_b32 s63, s63, 0xff00
    s_andn2_b32 s63, s63, s66
    s_cbranch_scc0 K_SP13
    s_or_b32 s66, s66, s63
    s_branch K_SPR13
K_SP14:
    ds_read_b32 v2, v12 offset:32
    s_waitcnt lgkmcnt(0)
    v_readfirstlane_b32 s33, v2
    s_nop 3
    s_lshr_b32 s63, s33, s64
    s_lshr_b32 s33, s33, s65
    s_and_b32 s63, s63, s33
    s_and_b32 s63, s63, 0xff00
    s_andn2_b32 s63, s63, s66
    s_cbranch_scc0 K_SP14
    s_or_b32 s66, s66, s63
    s_branch K_SPR14
K_SP15:
    ds_read_b32 v2, v12 offset:32
    s_waitcnt lgkmcnt(0)
    v_readfirstlane_b32 s33, v2
    s_nop 3
    s_lshr_b32 s63, s33, s64
    s_lshr_b32 s33, s33, s65
    s_and_b32 s63, s63, s33
    s_and_b32 s63, s63, 0xff00
    s_andn2_b32 s63, s63, s66
    s_cbranch_scc0 K_SP15
    s_or_b32 s66, s66, s63
    s_branch K_SPR15
K_SP16:
    ds_read_b32 v2, v12 offset:32
    s_waitcnt lgkmcnt(0)
    v_readfirstlane_b32 s33, v2
    s_nop 3
    s_lshr_b32 s63, s33, s64
    s_lshr_b32 s33, s33, s65
    s_and_b32 s63, s63, s33
    s_and_b32 s63, s63, 0xff00
    s_andn2_b32 s63, s63, s66
    s_cbranch_scc0 K_SP16
    s_or_b32 s66, s66, s63
    s_branch K_SPR16
K_SP18:
    ds_read_b32 v2, v12 offset:32
    s_waitcnt lgkmcnt(0)
    v_readfirstlane_b32 s33, v2
    s_nop 3
    s_lshr_b32 s63, s33, s64
    s_lshr_b32 s33, s33, s65
    s_and_b32 s63, s63, s33
    s_and_b32 s63, s63, 0xff00
    s_andn2_b32 s63, s63, s66
    s_cbranch_scc0 K_SP18
    s_or_b32 s66, s66, s63
    s_branch K_SPR18
WP_yr0:
    s_setpc_b64 s[38:39]
K_YROW0:
    v_lshlrev_b32 v5, 4, v9
    v_add_u32 v5, 158976, v5
    v_and_b32 v3, 15, v1
    s_and_b32 s33, s59, 15
    v_cmp_eq_u32 vcc, s33, v3
    s_mov_b32 s3, 1048576
K_P2_GY0:
    ds_read_b32 v2, v12 offset:64
    s_sub_u32 s3, s3, 1
    s_waitcnt lgkmcnt(0)
    v_readfirstlane_b32 s33, v2
    s_nop 3
    s_cselect_b32 s33, 1, s33
    s_cmp_lt_u32 s33, 1
    s_cbranch_scc1 K_P2_GY0
    s_mov_b64 exec, vcc
    s_cmp_ge_u32 s59, 16
    s_cbranch_scc1 K_YR1_0
    ds_read_b128 v[72:75], v5 offset:0
    ds_read_b128 v[76:79], v5 offset:64
    ds_read_b128 v[80:83], v5 offset:128
    ds_read_b128 v[84:87], v5 offset:192
    s_mov_b64 exec, -1
    s_branch K_NOY0
K_YR1_0:
    ds_read_b128 v[88:91], v5 offset:0
    ds_read_b128 v[92:95], v5 offset:64
    ds_read_b128 v[96:99], v5 offset:128
    ds_read_b128 v[100:103], v5 offset:192
    s_mov_b64 exec, -1
    s_branch K_NOY0
K_YROW1:
    v_lshlrev_b32 v5, 4, v9
    v_add_u32 v5, 159232, v5
    v_and_b32 v3, 15, v1
    s_and_b32 s33, s59, 15
    v_cmp_eq_u32 vcc, s33, v3
    s_mov_b32 s3, 1048576
K_P2_GY1:
    ds_read_b32 v2, v12 offset:68
    s_sub_u32 s3, s3, 1
    s_waitcnt lgkmcnt(0)
    v_readfirstlane_b32 s33, v2
    s_nop 3
    s_cselect_b32 s33, 1, s33
    s_cmp_lt_u32 s33, 1
    s_cbranch_scc1 K_P2_GY1
    s_mov_b64 exec, vcc
    s_cmp_ge_u32 s59, 16
    s_cbranch_scc1 K_YR1_1
    ds_read_b128 v[72:75], v5 offset:0
    ds_read_b128 v[76:79], v5 offset:64
    ds_read_b128 v[80:83], v5 offset:128
    ds_read_b128 v[84:87], v5 offset:192
    s_mov_b64 exec, -1
    s_branch K_NOY1
K_YR1_1:
    ds_read_b128 v[88:91], v5 offset:0
    ds_read_b128 v[92:95], v5 offset:64
    ds_read_b128 v[96:99], v5 offset:128
    ds_read_b128 v[100:103], v5 offset:192
    s_mov_b64 exec, -1
    s_branch K_NOY1
.p2align 12
WP_gen:
    s_setpc_b64 s[38:39]
K_P2:
    s_cmp_ge_u32 s30, 4
    s_cbranch_scc1 K_P2_HELP
    v_mov_b32 v12, 158720
    s_cmp_lg_u32 s30, 0
    s_cbranch_scc1 K_P2_W13
    v_lshrrev_b32 v3, 4, v1
    v_and_b32 v4, 7, v1
    v_lshrrev_b32 v2, 3, v1
    v_xor_b32 v4, v4, v3
    v_mul_u32_u24 v2, 1280, v2
    v_lshl_add_u32 v27, v4, 4, v2
    v_xor_b32 v28, 64, v27
    s_mov_b32 s58, 0
K_P2_XD:
    s_lshl_b32 s59, s40, 3
    s_lshl1_add_u32 s59, s58, s59
    s_mul_i32 s59, s59, 20480
    s_lshl_b32 s33, s41, 7
    s_add_u32 s59, s59, s33
    s_lshl_b32 s33, s58, 12
    s_add_u32 m0, s33, 140288
    s_add_u32 s3, s59, 0
    buffer_load_dwordx4 v27, s[12:15], s3 offen lds
    s_add_u32 m0, s33, 141312
    s_add_u32 s3, s59, 10240
    buffer_load_dwordx4 v28, s[12:15], s3 offen lds
    s_add_u32 m0, s33, 142336
    s_add_u32 s3, s59, 20480
    buffer_load_dwordx4 v27, s[12:15], s3 offen lds
    s_add_u32 m0, s33, 143360
    s_add_u32 s3, s59, 30720
    buffer_load_dwordx4 v28, s[12:15], s3 offen lds
    s_add_u32 s58, s58, 1
    s_cmp_lt_u32 s58, 4
    s_cbranch_scc1 K_P2_XD
    s_waitcnt vmcnt(0)
    s_branch K_P2_AUXW
K_P2_W13:
    v_lshrrev_b32 v2, 3, v1
    v_mul_u32_u24 v2, 1280, v2
    v_lshrrev_b32 v3, 4, v1
    v_lshlrev_b32 v3, 1, v3
    v_and_b32 v4, 7, v1
    v_xor_b32 v3, v3, v4
    v_lshl_add_u32 v2, v3, 4, v2
    s_lshl_b32 s33, s41, 7
    v_add_u32 v22, s33, v2
    s_mov_b32 s60, 0xfda87520
    s_mov_b32 s61, 0xecb96431
    s_sub_u32 s58, s30, 1
K_P2_WS:
    s_lshl_b32 s3, s58, 2
    s_lshr_b64 s[4:5], s[60:61], s3
    s_and_b32 s4, s4, 15
    s_mul_i32 s4, s4, 51200
    s_mul_i32 s59, s58, 5120
    s_add_u32 s52, s4, 0
    s_add_u32 m0, s59, 0
    s_waitcnt vmcnt(11)
    buffer_load_dwordx4 v22, s[24:27], s52 offen lds
    s_add_u32 s52, s4, 10240
    s_add_u32 m0, s59, 1024
    s_waitcnt vmcnt(11)
    buffer_load_dwordx4 v22, s[24:27], s52 offen lds
    s_add_u32 s52, s4, 20480
    s_add_u32 m0, s59, 2048
    s_waitcnt vmcnt(11)
    buffer_load_dwordx4 v22, s[24:27], s52 offen lds
    s_add_u32 s52, s4, 30720
    s_add_u32 m0, s59, 3072
    s_waitcnt vmcnt(11)
    buffer_load_dwordx4 v22, s[24:27], s52 offen lds
    s_add_u32 s52, s4, 40960
    s_add_u32 m0, s59, 4096
    s_waitcnt vmcnt(11)
    buffer_load_dwordx4 v22, s[24:27], s52 offen lds
    s_cmp_ge_u32 s58, 3
    s_cbranch_scc1 K_P2_WS1
    v_mov_b32 v3, 1
    s_waitcnt vmcnt(5)
    s_mov_b64 exec, 1
    ds_add_u32 v12, v3 offset:52
    s_mov_b64 exec, -1
K_P2_WS1:
    s_add_u32 s58, s58, 3
    s_cmp_lt_u32 s58, 16
    s_cbranch_scc1 K_P2_WS
K_P2_AUXW:
    v_mov_b32 v34, 1
    s_waitcnt vmcnt(10)
    s_mov_b64 exec, 1
    ds_add_u32 v12, v34 offset:72
    s_mov_b64 exec, -1
    s_lshl_b32 s54, s40, 7
    v_lshrrev_b32 v9, 4, v1
    v_mov_b32 v12, 158720
    s_add_u32 s20, s10, 0x100000
    s_addc_u32 s21, s11, 0
    s_mov_b32 s22, 0x280000
    s_mov_b32 s23, 0x20000
    s_add_u32 s16, s10, 0x1000
    s_addc_u32 s17, s11, 0
    s_mov_b32 s18, 0x2000
    s_mov_b32 s19, 0x20000
    s_mov_b32 s48, s6
    s_mov_b32 s49, s7
    s_mov_b32 s50, 0x280000
    s_mov_b32 s51, 0x20000
    s_lshl_b32 s53, s40, 3
    s_lshl1_add_u32 s53, s30, s53
    s_mov_b32 s55, 20480
    v_bfe_u32 v20, v1, 2, 2
    v_and_b32 v21, 3, v1
    s_mul_i32 s3, s53, 20480
    v_lshl_add_u32 v25, v1, 4, s3
    v_add_u32 v26, 20480, v25
    v_add_u32 v35, 16384, v25
    v_add_u32 v36, 16384, v26
    v_and_b32 v2, 15, v1
    s_lshl_b32 s3, s53, 6
    v_lshl_add_u32 v23, v2, 2, s3
    v_lshl_add_u32 v2, v9, 2, v20
    v_bfe_u32 v3, v2, 1, 2
    v_lshlrev_b32 v2, 7, v2
    v_lshl_add_u32 v2, v21, 3, v2
    v_lshl_add_u32 v24, v3, 5, v2
    v_lshrrev_b32 v3, 1, v20
    v_mul_u32_u24 v2, 40, v9
    v_add3_u32 v2, v2, 16, v20
    v_lshlrev_b32 v2, 7, v2
    v_lshl_add_u32 v2, v21, 3, v2
    v_xor_b32 v4, 0, v3
    v_lshl_add_u32 v60, v4, 5, v2
    v_xor_b32 v4, 1, v3
    v_lshl_add_u32 v61, v4, 5, v2
    v_xor_b32 v4, 2, v3
    v_lshl_add_u32 v62, v4, 5, v2
    v_xor_b32 v4, 3, v3
    v_lshl_add_u32 v63, v4, 5, v2
    v_lshrrev_b32 v3, 4, v1
    v_and_b32 v4, 7, v1
    v_lshrrev_b32 v2, 3, v1
    v_xor_b32 v4, v4, v3
    v_mul_u32_u24 v2, 1280, v2
    v_lshl_add_u32 v27, v4, 4, v2
    v_xor_b32 v28, 64, v27
    s_lshl_b32 s71, s40, 3
    s_lshl1_add_u32 s71, s30, s71
    s_mul_i32 s71, s71, 20480
    s_lshl_b32 s33, s41, 7
    s_add_u32 s71, s71, s33
    s_add_u32 s72, s71, 10240
    s_add_u32 s73, s71, 20480
    s_add_u32 s74, s71, 30720
    s_lshl_b32 s3, s30, 12
    s_add_u32 s3, s3, 140288
    v_lshl_add_u32 v33, v1, 4, s3
    v_and_b32 v2, 15, v1
    v_lshrrev_b32 v3, 1, v2
    v_lshrrev_b32 v4, 5, v1
    v_xor_b32 v3, v3, v4
    v_lshlrev_b32 v3, 4, v3
    v_lshl_add_u32 v3, v2, 7, v3
    v_and_b32 v4, 1, v9
    v_lshl_add_u32 v3, v4, 3, v3
    v_add_u32 v29, s3, v3
    v_xor_b32 v30, 32, v29
    v_xor_b32 v31, 64, v29
    v_xor_b32 v32, 96, v29
    s_and_b32 s33, s40, 3
    s_lshl_b32 s33, s33, 3
    s_lshr_b32 s33, 0x7f06037f, s33
    s_and_b32 s33, s33, 0xff
    s_lshl_b32 s3, s30, 1
    s_cmp_ge_u32 s3, s33
    s_cselect_b32 s64, 16, 0
    s_add_u32 s3, s3, 1
    s_cmp_ge_u32 s3, s33
    s_cselect_b32 s65, 16, 0
    s_mov_b32 s63, 0
    s_mov_b32 s66, 0
    s_mov_b32 s67, 16384
    s_mov_b32 s3, 1048576
K_P2_GWA:
    ds_read_b32 v2, v12 offset:72
    s_sub_u32 s3, s3, 1
    s_waitcnt lgkmcnt(0)
    v_readfirstlane_b32 s33, v2
    s_nop 3
    s_cselect_b32 s33, 4, s33
    s_cmp_lt_u32 s33, 4
    s_cbranch_scc1 K_P2_GWA
    s_branch K_P2_GEMM
WP_help:
    s_setpc_b64 s[38:39]
K_LATE:
    v_mov_b32 v6, 158800
    s_mov_b32 s3, 1048576
K_XGL:
    ds_read_b128 v[2:5], v6
    s_sleep 1
    s_sub_u32 s3, s3, 1
    s_waitcnt lgkmcnt(0)
    v_min3_u32 v2, v2, v4, v5
    v_min_u32 v2, v2, v3
    s_nop 0
    v_readfirstlane_b32 s33, v2
    s_nop 3
    s_cselect_b32 s33, 1, s33
    s_cmp_lt_u32 s33, 1
    s_cbranch_scc1 K_XGL
    s_sub_u32 s44, s30, 4
K_WOL:
    s_lshl_b32 s50, s44, 2
    s_lshr_b32 s50, 0x6431, s50
    s_and_b32 s50, s50, 7
    s_mul_i32 s50, s50, 51200
    s_mul_i32 s51, s44, 5120
    s_add_u32 s3, s50, 0
    s_add_u32 m0, s51, 40960
    s_waitcnt vmcnt(13)
    buffer_load_dwordx4 v17, s[24:27], s3 offen lds
    s_add_u32 s3, s50, 10240
    s_add_u32 m0, s51, 41984
    s_waitcnt vmcnt(13)
    buffer_load_dwordx4 v17, s[24:27], s3 offen lds
    s_add_u32 s3, s50, 20480
    s_add_u32 m0, s51, 43008
    s_waitcnt vmcnt(13)
    buffer_load_dwordx4 v17, s[24:27], s3 offen lds
    s_add_u32 s3, s50, 30720
    s_add_u32 m0, s51, 44032
    s_waitcnt vmcnt(13)
    buffer_load_dwordx4 v17, s[24:27], s3 offen lds
    s_add_u32 s3, s50, 40960
    s_add_u32 m0, s51, 45056
    s_waitcnt vmcnt(13)
    buffer_load_dwordx4 v17, s[24:27], s3 offen lds
    s_add_u32 s3, s50, 409600
    s_add_u32 m0, s51, 61440
    s_waitcnt vmcnt(13)
    buffer_load_dwordx4 v17, s[24:27], s3 offen lds
    s_add_u32 s3, s50, 419840
    s_add_u32 m0, s51, 62464
    s_waitcnt vmcnt(13)
    buffer_load_dwordx4 v17, s[24:27], s3 offen lds
    s_add_u32 s3, s50, 430080
    s_add_u32 m0, s51, 63488
    s_waitcnt vmcnt(13)
    buffer_load_dwordx4 v17, s[24:27], s3 offen lds
    s_add_u32 s3, s50, 440320
    s_add_u32 m0, s51, 64512
    s_waitcnt vmcnt(13)
    buffer_load_dwordx4 v17, s[24:27], s3 offen lds
    s_add_u32 s3, s50, 450560
    s_add_u32 m0, s51, 65536
    s_waitcnt vmcnt(13)
    buffer_load_dwordx4 v17, s[24:27], s3 offen lds
    s_add_u32 s44, s44, 2
    s_cmp_lt_u32 s44, 4
    s_cbranch_scc1 K_WOL
    v_mov_b32 v2, 158720
    v_mov_b32 v3, 2
    s_waitcnt vmcnt(0)
    s_mov_b64 exec, 1
    ds_add_u32 v2, v3 offset:44
    s_mov_b64 exec, -1
K_P2_HELP:
    s_setprio 3
    s_add_u32 s59, s40, 1
    s_bitcmp1_b32 s59, 1
    s_cselect_b32 s59, 31, 15
    v_and_b32 v10, s59, v1
    v_lshl_add_u32 v10, v10, 2, s42
    s_cmp_lg_u32 s30, 7
    s_cbranch_scc1 K_P2_N7
    v_and_b32 v4, 7, v1
    v_lshlrev_b32 v4, 2, v4
    s_mov_b32 s3, 131072
K_ZPOLL1:
    v_cmp_eq_u32 vcc, 0, v7
    s_cbranch_vccz K_ZOK1
    s_sub_u32 s3, s3, 1
    s_cbranch_scc1 K_ZOK1
    global_load_dword v7, v4, s[8:9] offset:192 sc1
    s_waitcnt vmcnt(0)
    s_branch K_ZPOLL1
K_ZOK1:
    global_load_dword v7, v10, s[10:11] sc1
K_P2_N7:
    s_lshl_b32 s54, s40, 7
    v_lshrrev_b32 v9, 4, v1
    v_mov_b32 v12, 158720
    s_add_u32 s44, s10, 0x10000
    s_addc_u32 s45, s11, 0
    s_mov_b32 s46, 0x43800
    s_mov_b32 s47, 0x20000
    v_mov_b32 v80, 1
    s_cmp_eq_u32 s30, 7
    s_cbranch_scc1 K_P2_FLAGS
    s_cmp_lg_u32 s30, 6
    s_cbranch_scc1 K_END
    s_mov_b32 s3, 131072
K_P2_DPOLL:
    v_cmp_eq_u32 vcc, 0, v7
    s_cbranch_vccz K_P2_DOK
    s_cmp_eq_u32 s3, 131072
    s_cbranch_scc1 K_P2_DNS
    s_sleep 12
K_P2_DNS:
    v_and_b32 v11, 1, v1
    v_lshl_add_u32 v11, v11, 2, s42
    global_load_dword v7, v11, s[10:11] offset:128 sc1
    s_sub_u32 s3, s3, 1
    s_waitcnt vmcnt(0)
    s_cmp_lg_u32 s3, 0
    s_cbranch_scc1 K_P2_DPOLL
K_P2_DOK:
    v_readlane_b32 s58, v7, 0
    v_readlane_b32 s59, v7, 1
    s_nop 3
    s_and_b32 s3, s58, 0x7ff
    s_sub_u32 s3, 2047, s3
    v_mov_b32 v20, s3
    v_mov_b32 v4, s58
    v_and_b32 v4, 0xffff0000, v4
    v_ashrrev_i32 v5, 31, v4
    v_not_b32 v5, v5
    v_or_b32 v5, 0x80000000, v5
    v_xor_b32 v4, v4, v5
    v_and_b32 v4, 0xffff0000, v4
    v_mul_f32 v5, 0xbfb8aa3b, v4
    v_exp_f32 v5, v5
    s_nop 0
    v_add_f32 v5, 1.0, v5
    v_rcp_f32 v4, v5
    s_nop 0
    v_cvt_pk_bf16_f32 v22, v4, v4
    v_lshlrev_b32 v22, 16, v22
    s_and_b32 s3, s59, 0x7ff
    s_sub_u32 s3, 2047, s3
    v_mov_b32 v21, s3
    v_mov_b32 v4, s59
    v_and_b32 v4, 0xffff0000, v4
    v_ashrrev_i32 v5, 31, v4
    v_not_b32 v5, v5
    v_or_b32 v5, 0x80000000, v5
    v_xor_b32 v4, v4, v5
    v_and_b32 v4, 0xffff0000, v4
    v_mul_f32 v5, 0xbfb8aa3b, v4
    v_exp_f32 v5, v5
    s_nop 0
    v_add_f32 v5, 1.0, v5
    v_rcp_f32 v4, v5
    s_nop 0
    v_cvt_pk_bf16_f32 v23, v4, v4
    v_lshlrev_b32 v23, 16, v23
    ds_write_b128 v12, v[20:23]
    ds_write_b32 v12, v80 offset:40
    s_mov_b32 s53, 0
    v_mov_b32 v16, v20
    v_mov_b32 v17, v21
    v_mov_b32 v18, v22
    v_mov_b32 v19, v23
K_P2_HW:
    s_cmp_eq_u32 s53, 0
    s_cselect_b64 vcc, -1, 0
    s_nop 1
    v_cndmask_b32 v2, v17, v16, vcc
    v_cndmask_b32 v5, v19, v18, vcc
    s_nop 0
    v_readfirstlane_b32 s58, v2
    s_nop 3
    s_sub_u32 s3, s58, s54
    s_cmp_lt_u32 s3, 128
    s_cbranch_scc0 K_P2_YN
    s_call_b64 s[38:39], WP_yr0
    s_mul_i32 s3, s58, 1280
    s_lshl_b32 s33, s41, 7
    s_add_u32 s3, s3, s33
    v_and_b32 v2, 15, v1
    v_lshlrev_b32 v2, 3, v2
    buffer_load_dwordx2 v[84:85], v2, s[12:15], s3 offen
    s_lshl_b32 s3, s58, 2
    s_add_u32 s3, s3, 4096
    v_mov_b32 v2, s3
    global_load_dword v88, v2, s[10:11] sc1
    s_lshl1_add_u32 s3, s41, s53
    s_lshl_b32 s3, s3, 8
    s_add_u32 s3, s3, 568320
    v_min_u32 v3, 53, v1
    v_lshl_add_u32 v3, v3, 2, s3
    s_mov_b32 s3, 131072
K_P2_YPOLL:
    global_load_dword v2, v3, s[10:11] sc1
    s_sub_u32 s3, s3, 1
    s_waitcnt vmcnt(0)
    v_cmp_ne_u32 vcc, 1, v2
    s_cbranch_vccz K_P2_YGO
    s_sleep 16
    s_cmp_lg_u32 s3, 0
    s_cbranch_scc1 K_P2_YPOLL
K_P2_YGO:
    v_and_b32 v2, 15, v1
    v_lshlrev_b32 v2, 4, v2
    v_mul_u32_u24 v4, 5120, v9
    s_mov_b32 s59, s53
    s_mul_i32 s33, s59, 2560
    s_lshl_b32 s3, s41, 8
    s_add_u32 s3, s3, s33
    v_add3_u32 v3, v2, v4, s3
    s_mov_b32 s52, 0
    buffer_load_dwordx4 v[24:27], v3, s[44:47], s52 offen sc1
    s_mov_b32 s52, 20480
    buffer_load_dwordx4 v[28:31], v3, s[44:47], s52 offen sc1
    s_mov_b32 s52, 40960
    buffer_load_dwordx4 v[32:35], v3, s[44:47], s52 offen sc1
    s_mov_b32 s52, 61440
    buffer_load_dwordx4 v[36:39], v3, s[44:47], s52 offen sc1
    s_mov_b32 s52, 81920
    buffer_load_dwordx4 v[40:43], v3, s[44:47], s52 offen sc1
    s_mov_b32 s52, 102400
    buffer_load_dwordx4 v[44:47], v3, s[44:47], s52 offen sc1
    s_mov_b32 s52, 122880
    buffer_load_dwordx4 v[48:51], v3, s[44:47], s52 offen sc1
    s_mov_b32 s52, 143360
    buffer_load_dwordx4 v[52:55], v3, s[44:47], s52 offen sc1
    s_mov_b32 s52, 163840
    buffer_load_dwordx4 v[56:59], v3, s[44:47], s52 offen sc1
    s_mov_b32 s52, 184320
    buffer_load_dwordx4 v[60:63], v3, s[44:47], s52 offen sc1
    s_mov_b32 s52, 204800
    buffer_load_dwordx4 v[64:67], v3, s[44:47], s52 offen sc1
    s_mov_b32 s52, 225280
    buffer_load_dwordx4 v[68:71], v3, s[44:47], s52 offen sc1
    s_mov_b32 s52, 245760
    buffer_load_dwordx4 v[72:75], v3, s[44:47], s52 offen sc1
    s_mov_b32 s52, 266240
    buffer_load_dwordx4 v[76:79], v3, s[44:47], s52 offen sc1
    v_sub_f32 v88, 1.0, v88
    v_cvt_pk_bf16_f32 v88, v88, v88
    v_lshlrev_b32 v88, 16, v88
    v_lshlrev_b32 v86, 16, v85
    v_and_b32 v87, 0xffff0000, v85
    v_and_b32 v85, 0xffff0000, v84
    v_lshlrev_b32 v84, 16, v84
    s_waitcnt vmcnt(12)
    v_add_f32 v20, v24, v28
    v_add_f32 v21, v25, v29
    v_add_f32 v22, v26, v30
    v_add_f32 v23, v27, v31
    s_waitcnt vmcnt(11)
    v_add_f32 v20, v20, v32
    v_add_f32 v21, v21, v33
    v_add_f32 v22, v22, v34
    v_add_f32 v23, v23, v35
    s_waitcnt vmcnt(10)
    v_add_f32 v20, v20, v36
    v_add_f32 v21, v21, v37
    v_add_f32 v22, v22, v38
    v_add_f32 v23, v23, v39
    s_waitcnt vmcnt(9)
    v_add_f32 v20, v20, v40
    v_add_f32 v21, v21, v41
    v_add_f32 v22, v22, v42
    v_add_f32 v23, v23, v43
    s_waitcnt vmcnt(8)
    v_add_f32 v20, v20, v44
    v_add_f32 v21, v21, v45
    v_add_f32 v22, v22, v46
    v_add_f32 v23, v23, v47
    s_waitcnt vmcnt(7)
    v_add_f32 v20, v20, v48
    v_add_f32 v21, v21, v49
    v_add_f32 v22, v22, v50
    v_add_f32 v23, v23, v51
    s_waitcnt vmcnt(6)
    v_add_f32 v20, v20, v52
    v_add_f32 v21, v21, v53
    v_add_f32 v22, v22, v54
    v_add_f32 v23, v23, v55
    s_waitcnt vmcnt(5)
    v_add_f32 v20, v20, v56
    v_add_f32 v21, v21, v57
    v_add_f32 v22, v22, v58
    v_add_f32 v23, v23, v59
    s_waitcnt vmcnt(4)
    v_add_f32 v20, v20, v60
    v_add_f32 v21, v21, v61
    v_add_f32 v22, v22, v62
    v_add_f32 v23, v23, v63
    s_waitcnt vmcnt(3)
    v_add_f32 v20, v20, v64
    v_add_f32 v21, v21, v65
    v_add_f32 v22, v22, v66
    v_add_f32 v23, v23, v67
    s_waitcnt vmcnt(2)
    v_add_f32 v20, v20, v68
    v_add_f32 v21, v21, v69
    v_add_f32 v22, v22, v70
    v_add_f32 v23, v23, v71
    s_waitcnt vmcnt(1)
    v_add_f32 v20, v20, v72
    v_add_f32 v21, v21, v73
    v_add_f32 v22, v22, v74
    v_add_f32 v23, v23, v75
    s_waitcnt vmcnt(0)
    v_add_f32 v20, v20, v76
    v_add_f32 v21, v21, v77
    v_add_f32 v22, v22, v78
    v_add_f32 v23, v23, v79
    v_mov_b32 v24, v20
    v_mov_b32 v25, v21
    v_mov_b32 v26, v22
    v_mov_b32 v27, v23
    s_nop 0
    v_permlane16_swap_b32 v20, v24
    v_permlane16_swap_b32 v21, v25
    v_permlane16_swap_b32 v22, v26
    v_permlane16_swap_b32 v23, v27
    v_add_f32 v20, v20, v24
    v_add_f32 v21, v21, v25
    v_add_f32 v22, v22, v26
    v_add_f32 v23, v23, v27
    v_mov_b32 v24, v20
    v_mov_b32 v25, v21
    v_mov_b32 v26, v22
    v_mov_b32 v27, v23
    s_nop 0
    v_permlane32_swap_b32 v20, v24
    v_permlane32_swap_b32 v21, v25
    v_permlane32_swap_b32 v22, v26
    v_permlane32_swap_b32 v23, v27
    v_add_f32 v20, v20, v24
    v_add_f32 v21, v21, v25
    v_add_f32 v22, v22, v26
    v_add_f32 v23, v23, v27
    v_cvt_pk_bf16_f32 v20, v20, v20
    v_lshlrev_b32 v20, 16, v20
    v_mul_f32 v20, v5, v20
    v_cvt_pk_bf16_f32 v20, v20, v20
    v_lshlrev_b32 v20, 16, v20
    v_add_f32 v20, v20, v84
    v_cvt_pk_bf16_f32 v20, v20, v20
    v_lshlrev_b32 v20, 16, v20
    v_mul_f32 v20, v20, v88
    v_cvt_pk_bf16_f32 v21, v21, v21
    v_lshlrev_b32 v21, 16, v21
    v_mul_f32 v21, v5, v21
    v_cvt_pk_bf16_f32 v21, v21, v21
    v_lshlrev_b32 v21, 16, v21
    v_add_f32 v21, v21, v85
    v_cvt_pk_bf16_f32 v21, v21, v21
    v_lshlrev_b32 v21, 16, v21
    v_mul_f32 v21, v21, v88
    v_cvt_pk_bf16_f32 v22, v22, v22
    v_lshlrev_b32 v22, 16, v22
    v_mul_f32 v22, v5, v22
    v_cvt_pk_bf16_f32 v22, v22, v22
    v_lshlrev_b32 v22, 16, v22
    v_add_f32 v22, v22, v86
    v_cvt_pk_bf16_f32 v22, v22, v22
    v_lshlrev_b32 v22, 16, v22
    v_mul_f32 v22, v22, v88
    v_cvt_pk_bf16_f32 v23, v23, v23
    v_lshlrev_b32 v23, 16, v23
    v_mul_f32 v23, v5, v23
    v_cvt_pk_bf16_f32 v23, v23, v23
    v_lshlrev_b32 v23, 16, v23
    v_add_f32 v23, v23, v87
    v_cvt_pk_bf16_f32 v23, v23, v23
    v_lshlrev_b32 v23, 16, v23
    v_mul_f32 v23, v23, v88
    s_lshl_b32 s3, s59, 8
    s_add_u32 s3, s3, 158976
    v_add_u32 v2, s3, v2
    ds_write_b128 v2, v[20:23]
    s_lshl_b32 s3, s59, 2
    v_add_u32 v2, s3, v12
    ds_write_b32 v2, v80 offset:64
K_P2_YN:
    s_add_u32 s53, s53, 1
    s_cmp_lt_u32 s53, 2
    s_cbranch_scc1 K_P2_HW
    s_branch K_END
WP_flags:
    s_setpc_b64 s[38:39]
K_P2_FLAGS:
    s_mov_b32 exec_hi, 0
    s_waitcnt vmcnt(0)
    s_mov_b32 s3, 131072
K_P2_FCHK:
    v_cmp_eq_u32 vcc, 1, v7
    s_nop 1
    v_mov_b32 v2, vcc_lo
    ds_write_b32 v12, v2 offset:32
    s_cmp_eq_u32 vcc_lo, -1
    s_cbranch_scc1 K_P2_FGO
    s_cmp_lg_u32 vcc_lo, 0
    s_cbranch_scc1 K_P2_FS
    s_sleep 4
K_P2_FS:
    s_sleep 6
    global_load_dword v7, v10, s[10:11] sc1
    s_sub_u32 s3, s3, 1
    s_waitcnt vmcnt(0)
    s_cbranch_scc0 K_P2_FCHK
    v_mov_b32 v2, -1
    ds_write_b32 v12, v2 offset:32
K_P2_FGO:
    s_mov_b64 exec, -1
    s_branch K_END
.p2align 12
K_AUX:
    s_load_dwordx8 s[48:55], s[0:1], 32
    s_load_dwordx2 s[56:57], s[0:1], 64
    s_mul_i32 s44, s28, 7
    s_add_u32 s44, s44, s29
    s_sub_u32 s44, s44, 1
    s_cmp_lt_u32 s44, 54
    s_cselect_b32 s44, s44, 63
    s_cmp_eq_u32 s29, 0
    s_cselect_b32 s44, 63, s44
    s_lshl_b32 s74, s28, 8
    s_lshl_b32 s3, s29, 5
    s_add_u32 s74, s74, s3
    v_mov_b32 v12, 158720
    v_mov_b32 v13, 1
    s_cmp_lt_u32 s30, 4
    s_cbranch_scc1 K_AUX_LO
    s_lshl_b32 s3, s30, 3
    s_add_u32 s3, s3, s74
    s_sub_u32 s3, s3, 32
    v_lshrrev_b32 v9, 3, v1
    v_add_u32 v9, s3, v9
    v_and_b32 v11, 7, v1
    v_lshlrev_b32 v11, 4, v11
    v_mul_u32_u24 v10, 1280, v9
    v_add_u32 v10, v10, v11
    s_waitcnt lgkmcnt(0)
    buffer_load_dwordx4 v[16:19], v10, s[12:15], 0 offen offset:0
    buffer_load_dwordx4 v[20:23], v10, s[12:15], 0 offen offset:128
    buffer_load_dwordx4 v[24:27], v10, s[12:15], 0 offen offset:256
    buffer_load_dwordx4 v[28:31], v10, s[12:15], 0 offen offset:384
    buffer_load_dwordx4 v[32:35], v10, s[12:15], 0 offen offset:512
    buffer_load_dwordx4 v[36:39], v10, s[12:15], 0 offen offset:640
    buffer_load_dwordx4 v[40:43], v10, s[12:15], 0 offen offset:768
    buffer_load_dwordx4 v[44:47], v10, s[12:15], 0 offen offset:896
    buffer_load_dwordx4 v[48:51], v10, s[12:15], 0 offen offset:1024
    buffer_load_dwordx4 v[52:55], v10, s[12:15], 0 offen offset:1152
    s_mov_b32 s16, s48
    s_mov_b32 s17, s49
    s_mov_b32 s18, 0x500
    s_mov_b32 s19, 0x20000
    s_mov_b32 s20, s56
    s_mov_b32 s21, s57
    s_mov_b32 s22, 0x500
    s_mov_b32 s23, 0x20000
    buffer_load_dwordx4 v[56:59], v11, s[16:19], 0 offen offset:0
    buffer_load_dwordx4 v[60:63], v11, s[16:19], 0 offen offset:128
    buffer_load_dwordx4 v[64:67], v11, s[16:19], 0 offen offset:256
    buffer_load_dwordx4 v[68:71], v11, s[16:19], 0 offen offset:384
    buffer_load_dwordx4 v[72:75], v11, s[16:19], 0 offen offset:512
    buffer_load_dwordx4 v[76:79], v11, s[16:19], 0 offen offset:640
    buffer_load_dwordx4 v[80:83], v11, s[16:19], 0 offen offset:768
    buffer_load_dwordx4 v[84:87], v11, s[16:19], 0 offen offset:896
    buffer_load_dwordx4 v[88:91], v11, s[16:19], 0 offen offset:1024
    buffer_load_dwordx4 v[92:95], v11, s[16:19], 0 offen offset:1152
    buffer_load_dwordx4 v[96:99], v11, s[20:23], 0 offen offset:0
    buffer_load_dwordx4 v[100:103], v11, s[20:23], 0 offen offset:128
    buffer_load_dwordx4 v[104:107], v11, s[20:23], 0 offen offset:256
    buffer_load_dwordx4 v[108:111], v11, s[20:23], 0 offen offset:384
    buffer_load_dwordx4 v[112:115], v11, s[20:23], 0 offen offset:512
    buffer_load_dwordx4 v[116:119], v11, s[20:23], 0 offen offset:640
    buffer_load_dwordx4 v[120:123], v11, s[20:23], 0 offen offset:768
    buffer_load_dwordx4 v[124:127], v11, s[20:23], 0 offen offset:896
    buffer_load_dwordx4 v[128:131], v11, s[20:23], 0 offen offset:1024
    buffer_load_dwordx4 v[132:135], v11, s[20:23], 0 offen offset:1152
    s_barrier
    v_mov_b32 v180, 0
    v_mov_b32 v181, 0
    v_mov_b32 v182, 0
    v_mov_b32 v183, 0
    v_and_b32 v10, 31, v9
    v_lshlrev_b32 v10, 2, v10
    v_add_u32 v10, 122880, v10
    v_sub_u32 v4, 0x87ff, v9
    s_setprio 2
    s_waitcnt vmcnt(10)
    v_dot2c_f32_bf16 v180, v16, v56
    v_dot2c_f32_bf16 v181, v17, v57
    v_dot2c_f32_bf16 v180, v18, v58
    v_dot2c_f32_bf16 v181, v19, v59
    v_dot2c_f32_bf16 v180, v20, v60
    v_dot2c_f32_bf16 v181, v21, v61
    v_dot2c_f32_bf16 v180, v22, v62
    v_dot2c_f32_bf16 v181, v23, v63
    v_dot2c_f32_bf16 v180, v24, v64
    v_dot2c_f32_bf16 v181, v25, v65
    v_dot2c_f32_bf16 v180, v26, v66
    v_dot2c_f32_bf16 v181, v27, v67
    v_dot2c_f32_bf16 v180, v28, v68
    v_dot2c_f32_bf16 v181, v29, v69
    v_dot2c_f32_bf16 v180, v30, v70
    v_dot2c_f32_bf16 v181, v31, v71
    v_dot2c_f32_bf16 v180, v32, v72
    v_dot2c_f32_bf16 v181, v33, v73
    v_dot2c_f32_bf16 v180, v34, v74
    v_dot2c_f32_bf16 v181, v35, v75
    v_dot2c_f32_bf16 v180, v36, v76
    v_dot2c_f32_bf16 v181, v37, v77
    v_dot2c_f32_bf16 v180, v38, v78
    v_dot2c_f32_bf16 v181, v39, v79
    v_dot2c_f32_bf16 v180, v40, v80
    v_dot2c_f32_bf16 v181, v41, v81
    v_dot2c_f32_bf16 v180, v42, v82
    v_dot2c_f32_bf16 v181, v43, v83
    v_dot2c_f32_bf16 v180, v44, v84
    v_dot2c_f32_bf16 v181, v45, v85
    v_dot2c_f32_bf16 v180, v46, v86
    v_dot2c_f32_bf16 v181, v47, v87
    v_dot2c_f32_bf16 v180, v48, v88
    v_dot2c_f32_bf16 v181, v49, v89
    v_dot2c_f32_bf16 v180, v50, v90
    v_dot2c_f32_bf16 v181, v51, v91
    v_dot2c_f32_bf16 v180, v52, v92
    v_dot2c_f32_bf16 v181, v53, v93
    v_dot2c_f32_bf16 v180, v54, v94
    v_dot2c_f32_bf16 v181, v55, v95
    s_waitcnt vmcnt(0)
    v_dot2c_f32_bf16 v182, v16, v96
    v_dot2c_f32_bf16 v183, v17, v97
    v_dot2c_f32_bf16 v182, v18, v98
    v_dot2c_f32_bf16 v183, v19, v99
    v_dot2c_f32_bf16 v182, v20, v100
    v_dot2c_f32_bf16 v183, v21, v101
    v_dot2c_f32_bf16 v182, v22, v102
    v_dot2c_f32_bf16 v183, v23, v103
    v_dot2c_f32_bf16 v182, v24, v104
    v_dot2c_f32_bf16 v183, v25, v105
    v_dot2c_f32_bf16 v182, v26, v106
    v_dot2c_f32_bf16 v183, v27, v107
    v_dot2c_f32_bf16 v182, v28, v108
    v_dot2c_f32_bf16 v183, v29, v109
    v_dot2c_f32_bf16 v182, v30, v110
    v_dot2c_f32_bf16 v183, v31, v111
    v_dot2c_f32_bf16 v182, v32, v112
    v_dot2c_f32_bf16 v183, v33, v113
    v_dot2c_f32_bf16 v182, v34, v114
    v_dot2c_f32_bf16 v183, v35, v115
    v_dot2c_f32_bf16 v182, v36, v116
    v_dot2c_f32_bf16 v183, v37, v117
    v_dot2c_f32_bf16 v182, v38, v118
    v_dot2c_f32_bf16 v183, v39, v119
    v_dot2c_f32_bf16 v182, v40, v120
    v_dot2c_f32_bf16 v183, v41, v121
    v_dot2c_f32_bf16 v182, v42, v122
    v_dot2c_f32_bf16 v183, v43, v123
    v_dot2c_f32_bf16 v182, v44, v124
    v_dot2c_f32_bf16 v183, v45, v125
    v_dot2c_f32_bf16 v182, v46, v126
    v_dot2c_f32_bf16 v183, v47, v127
    v_dot2c_f32_bf16 v182, v48, v128
    v_dot2c_f32_bf16 v183, v49, v129
    v_dot2c_f32_bf16 v182, v50, v130
    v_dot2c_f32_bf16 v183, v51, v131
    v_dot2c_f32_bf16 v182, v52, v132
    v_dot2c_f32_bf16 v183, v53, v133
    v_dot2c_f32_bf16 v182, v54, v134
    v_dot2c_f32_bf16 v183, v55, v135
    s_nop 2
    v_add_f32 v180, v180, v181
    v_add_f32 v182, v182, v183
    s_nop 0
    v_add_f32_dpp v180, v180, v180 quad_perm:[1,0,3,2] row_mask:0xf bank_mask:0xf
    v_add_f32_dpp v182, v182, v182 quad_perm:[1,0,3,2] row_mask:0xf bank_mask:0xf
    s_nop 0
    v_add_f32_dpp v180, v180, v180 quad_perm:[2,3,0,1] row_mask:0xf bank_mask:0xf
    v_add_f32_dpp v182, v182, v182 quad_perm:[2,3,0,1] row_mask:0xf bank_mask:0xf
    s_nop 0
    v_add_f32_dpp v180, v180, v180 row_half_mirror row_mask:0xf bank_mask:0xf
    v_add_f32_dpp v182, v182, v182 row_half_mirror row_mask:0xf bank_mask:0xf
    v_cvt_pk_bf16_f32 v2, v180, v180
    v_lshlrev_b32 v2, 16, v2
    v_ashrrev_i32 v3, 31, v2
    v_or_b32 v3, 0x80000000, v3
    v_xor_b32 v2, v2, v3
    v_and_b32 v2, 0xffff0000, v2
    v_or_b32 v2, v2, v4
    ds_write2_b32 v10, v2, v182 offset0:0 offset1:32
    s_mov_b64 exec, 1
    ds_add_u32 v12, v13 offset:36
    s_mov_b64 exec, -1
    s_setprio 0
    s_cmp_lg_u32 s30, 4
    s_cbranch_scc1 K_WARMA0
    s_call_b64 s[38:39], WP_p2g
    s_branch K_WARMAX
K_WARMA0:
    s_cmp_lg_u32 s30, 5
    s_cbranch_scc1 K_WARMA1
    s_call_b64 s[38:39], WP_gen
    s_branch K_WARMAX
K_WARMA1:
    s_cmp_lg_u32 s30, 6
    s_cbranch_scc1 K_WARMA2
    s_call_b64 s[38:39], WP_help
    s_call_b64 s[38:39], WP_flags
    s_branch K_WARMAX
K_WARMA2:
    s_call_b64 s[38:39], WP_spin
K_WARMAX:
    s_cmp_ge_u32 s30, 6
    s_cselect_b32 s44, 63, s44
    s_cmp_lg_u32 s44, 63
    s_cbranch_scc1 K_FFN_C
    s_mov_b32 s3, 1048576
K_FGH:
    ds_read_b32 v2, v12 offset:48
    s_sleep 8
    s_sub_u32 s3, s3, 1
    s_waitcnt lgkmcnt(0)
    v_readfirstlane_b32 s33, v2
    s_nop 3
    s_cselect_b32 s33, 1, s33
    s_cmp_lt_u32 s33, 1
    s_cbranch_scc1 K_FGH
    s_cmp_eq_u32 s30, 6
    s_cbranch_scc1 K_P2_HELP
    v_mov_b32 v7, 1
    s_branch K_P2_HELP
K_AUX_LO:
    s_waitcnt lgkmcnt(0)
    s_cmp_eq_u32 s30, 0
    s_cbranch_scc1 K_AUX_PUB
    s_cmp_eq_u32 s44, 63
    s_cbranch_scc1 K_AUX_NOF
    s_and_b32 s3, s44, 1
    s_cmp_eq_u32 s3, 0
    s_cselect_b64 s[60:61], s[50:51], s[52:53]
    s_cselect_b64 s[64:65], s[52:53], s[50:51]
    s_cselect_b32 s75, 0, 40960
    s_mov_b32 s62, 0x21c000
    s_mov_b32 s63, 0x20000
    s_mov_b32 s66, 0x21c000
    s_mov_b32 s67, 0x20000
    v_lshrrev_b32 v2, 2, v1
    v_mul_u32_u24 v184, 3456, v2
    v_and_b32 v2, 3, v1
    v_lshl_add_u32 v184, v2, 4, v184
    s_lshl_b32 s72, s44, 6
    v_add_u32 v184, s72, v184
    s_sub_u32 s74, s30, 1
K_FSA0:
    s_lshl_b32 s73, s74, 10
    s_mul_i32 s72, s74, 55296
    s_add_u32 m0, s73, s75
    s_waitcnt vmcnt(7)
    buffer_load_dwordx4 v184, s[60:63], s72 offen lds
    s_add_u32 s74, s74, 3
    s_cmp_lt_u32 s74, 24
    s_cbranch_scc1 K_FSA0
    s_barrier
    s_mov_b32 s3, 1048576
K_FGPB:
    ds_read_b32 v2, v12 offset:36
    s_sleep 1
    s_sub_u32 s3, s3, 1
    s_waitcnt lgkmcnt(0)
    v_readfirstlane_b32 s33, v2
    s_nop 3
    s_cselect_b32 s33, 5, s33
    s_cmp_lt_u32 s33, 5
    s_cbranch_scc1 K_FGPB
K_FSA:
    s_lshl_b32 s73, s74, 10
    s_mul_i32 s72, s74, 55296
    s_add_u32 m0, s73, s75
    s_waitcnt vmcnt(7)
    buffer_load_dwordx4 v184, s[60:63], s72 offen lds
    s_add_u32 s74, s74, 3
    s_cmp_lt_u32 s74, 40
    s_cbranch_scc1 K_FSA
    s_sub_u32 s74, s74, 40
    s_xor_b32 s75, s75, 40960
    s_mov_b32 s68, s54
    s_mov_b32 s69, s55
    s_mov_b32 s70, 0x21c000
    s_mov_b32 s71, 0x20000
    s_mul_i32 s3, s44, 40960
    v_lshrrev_b32 v2, 3, v1
    v_mul_u32_u24 v2, 1280, v2
    v_lshrrev_b32 v3, 4, v1
    v_lshlrev_b32 v3, 1, v3
    v_and_b32 v4, 7, v1
    v_xor_b32 v3, v3, v4
    v_lshl_add_u32 v2, v3, 4, v2
    v_add_u32 v185, s3, v2
K_FSB:
    s_lshl_b32 s73, s74, 10
    s_mul_i32 s72, s74, 55296
    s_add_u32 m0, s73, s75
    s_waitcnt vmcnt(7)
    buffer_load_dwordx4 v184, s[64:67], s72 offen lds
    s_add_u32 s74, s74, 3
    s_cmp_lt_u32 s74, 40
    s_cbranch_scc1 K_FSB
    s_sub_u32 s74, s74, 40
    s_mov_b32 s75, 81920
K_FSD0:
    s_lshl_b32 s73, s74, 10
    s_and_b32 s72, s74, 3
    s_mul_i32 s72, s72, 10208
    s_lshl_b32 s3, s74, 5
    s_add_u32 s72, s72, s3
    s_add_u32 m0, s73, s75
    s_waitcnt vmcnt(7)
    buffer_load_dwordx4 v185, s[68:71], s72 offen lds
    s_add_u32 s74, s74, 3
    s_cmp_lt_u32 s74, 24
    s_cbranch_scc1 K_FSD0
    s_waitcnt vmcnt(8)
    s_mov_b64 exec, 1
    ds_add_u32 v12, v13 offset:56
    s_mov_b64 exec, -1
K_FSD:
    s_lshl_b32 s73, s74, 10
    s_and_b32 s72, s74, 3
    s_mul_i32 s72, s72, 10208
    s_lshl_b32 s3, s74, 5
    s_add_u32 s72, s72, s3
    s_add_u32 m0, s73, s75
    s_waitcnt vmcnt(7)
    buffer_load_dwordx4 v185, s[68:71], s72 offen lds
    s_add_u32 s74, s74, 3
    s_cmp_lt_u32 s74, 40
    s_cbranch_scc1 K_FSD
    s_mul_i32 s3, s29, 96
    s_lshl_b32 s72, s30, 5
    s_add_u32 s3, s3, s72
    s_sub_u32 s3, s3, 128
    v_lshrrev_b32 v2, 1, v1
    v_add_u32 v2, s3, v2
    v_mul_u32_u24 v2, 1280, v2
    v_and_b32 v3, 1, v1
    v_lshl_add_u32 v2, v3, 7, v2
    buffer_load_dword v6, v2, s[24:27], 0 offen offset:1024
K_AUX_WR:
    s_mov_b32 s3, 1048576
K_FGR:
    ds_read_b32 v2, v12 offset:60
    s_sleep 2
    s_sub_u32 s3, s3, 1
    s_waitcnt lgkmcnt(0)
    v_readfirstlane_b32 s33, v2
    s_nop 3
    s_cselect_b32 s33, 2, s33
    s_cmp_lt_u32 s33, 2
    s_cbranch_scc1 K_FGR
    s_branch K_P2
K_AUX_NOF:
    s_cmp_lg_u32 s2, 63
    s_cbranch_scc1 K_AUX_NOZ
    s_cmp_lg_u32 s30, 1
    s_cbranch_scc1 K_AUX_NOZ
    s_add_u32 s60, s10, 0x80000
    s_addc_u32 s61, s11, 0
    s_mov_b32 s62, 0xc000
    s_mov_b32 s63, 0x20000
    v_mov_b32 v9, 786432
    global_load_dword v10, v9, s[10:11] sc1
    v_lshlrev_b32 v11, 4, v1
    v_add_u32 v11, 790528, v11
    global_load_dword v6, v11, s[10:11] sc1
    s_barrier
    s_mov_b32 s3, 1048576
K_FGZ:
    ds_read_b32 v2, v12 offset:36
    s_sleep 2
    s_sub_u32 s3, s3, 1
    s_waitcnt lgkmcnt(0)
    v_readfirstlane_b32 s33, v2
    s_nop 3
    s_cselect_b32 s33, 4, s33
    s_cmp_lt_u32 s33, 4
    s_cbranch_scc1 K_FGZ
    v_and_b32 v4, 7, v1
    v_lshlrev_b32 v4, 2, v4
    global_load_dword v7, v4, s[8:9] offset:192 sc1
    s_waitcnt vmcnt(1)
    v_add_u32 v10, 1, v10
    s_mov_b32 s3, 131072
    s_setprio 3
K_AG2_POLL:
    global_load_dwordx4 v[16:19], v11, s[10:11] sc1
    s_waitcnt vmcnt(0)
    v_xor_b32 v2, v10, v17
    v_xor_b32 v3, v10, v19
    v_or_b32 v2, v2, v3
    v_cmp_ne_u32 vcc, 0, v2
    s_cbranch_vccz K_AG2_GOT
    s_sleep 2
    s_sub_u32 s3, s3, 1
    s_cmp_lg_u32 s3, 0
    s_cbranch_scc1 K_AG2_POLL
K_AG2_GOT:
    s_nop 1
    v_max_u32_dpp v3, v16, v16 quad_perm:[1,0,3,2] row_mask:0xf bank_mask:0xf
    s_nop 1
    v_max_u32_dpp v3, v3, v3 quad_perm:[2,3,0,1] row_mask:0xf bank_mask:0xf
    s_nop 1
    v_max_u32_dpp v3, v3, v3 row_half_mirror row_mask:0xf bank_mask:0xf
    s_nop 1
    v_max_u32_dpp v3, v3, v3 row_mirror row_mask:0xf bank_mask:0xf
    s_nop 1
    v_readlane_b32 s74, v3, 0
    v_readlane_b32 s76, v3, 16
    v_readlane_b32 s77, v3, 32
    v_readlane_b32 s78, v3, 48
    s_nop 3
    s_max_u32 s74, s74, s76
    s_max_u32 s77, s77, s78
    s_max_u32 s74, s74, s77
    v_cmp_ne_u32 vcc, s74, v16
    s_nop 1
    v_cndmask_b32 v2, v18, v16, vcc
    s_nop 1
    v_max_u32_dpp v3, v2, v2 quad_perm:[1,0,3,2] row_mask:0xf bank_mask:0xf
    s_nop 1
    v_max_u32_dpp v3, v3, v3 quad_perm:[2,3,0,1] row_mask:0xf bank_mask:0xf
    s_nop 1
    v_max_u32_dpp v3, v3, v3 row_half_mirror row_mask:0xf bank_mask:0xf
    s_nop 1
    v_max_u32_dpp v3, v3, v3 row_mirror row_mask:0xf bank_mask:0xf
    s_nop 1
    v_readlane_b32 s75, v3, 0
    v_readlane_b32 s76, v3, 16
    v_readlane_b32 s77, v3, 32
    v_readlane_b32 s78, v3, 48
    s_nop 3
    s_max_u32 s75, s75, s76
    s_max_u32 s77, s77, s78
    s_max_u32 s75, s75, s77
    v_mov_b32 v176, s74
    v_mov_b32 v177, s75
    v_and_b32 v4, 7, v1
    v_lshlrev_b32 v4, 2, v4
    s_mov_b32 s3, 131072
K_ZPOLL4:
    v_cmp_eq_u32 vcc, 0, v7
    s_cbranch_vccz K_ZOK4
    s_sub_u32 s3, s3, 1
    s_cbranch_scc1 K_ZOK4
    global_load_dword v7, v4, s[8:9] offset:192 sc1
    s_waitcnt vmcnt(0)
    s_branch K_ZPOLL4
K_ZOK4:
    v_and_b32 v2, 7, v1
    v_mul_u32_u24 v2, 20, v2
    v_lshrrev_b32 v3, 3, v1
    v_add_lshl_u32 v2, v2, v3, 8
    buffer_store_dwordx2 v[176:177], v2, s[60:63], 0 offen offset:136 sc1
    s_mov_b64 exec, 1
    global_store_dword v9, v10, s[10:11] sc1
    s_mov_b64 exec, -1
    v_lshlrev_b32 v4, 2, v1
    s_mov_b32 s72, 43008
    s_mov_b32 s3, 131072
K_AGG_POLL:
    s_sleep 8
    buffer_load_dword v2, v4, s[60:63], s72 offen sc1
    s_waitcnt vmcnt(0)
    v_cmp_eq_u32 vcc, 0, v2
    s_cbranch_vccz K_AGG_GOT
    s_sub_u32 s3, s3, 1
    s_cmp_lg_u32 s3, 0
    s_cbranch_scc1 K_AGG_POLL
K_AGG_GOT:
    s_mov_b32 s62, 40960
    v_lshlrev_b32 v3, 8, v1
    s_mov_b32 s3, 0
    buffer_store_dwordx2 v[176:177], v3, s[60:63], s3 offen offset:128 sc1
    s_mov_b32 s3, 16384
    buffer_store_dwordx2 v[176:177], v3, s[60:63], s3 offen offset:128 sc1
    s_mov_b32 s3, 32768
    buffer_store_dwordx2 v[176:177], v3, s[60:63], s3 offen offset:128 sc1
    s_setprio 0
    s_branch K_AUX_NOK
K_AUX_NOZ:
    s_barrier
K_AUX_NOK:
    s_mov_b32 s3, 1048576
K_FGWD:
    ds_read_b32 v2, v12 offset:48
    s_sleep 4
    s_sub_u32 s3, s3, 1
    s_waitcnt lgkmcnt(0)
    v_readfirstlane_b32 s33, v2
    s_nop 3
    s_cselect_b32 s33, 1, s33
    s_cmp_lt_u32 s33, 1
    s_cbranch_scc1 K_FGWD
    s_branch K_P2
K_AUX_PUB:
    s_add_u32 s60, s10, 0x1000
    s_addc_u32 s61, s11, 0
    s_mov_b32 s62, 0x2000
    s_mov_b32 s63, 0x20000
    v_and_b32 v3, 31, v1
    v_lshlrev_b32 v10, 2, v3
    v_add_u32 v11, 122880, v10
    s_lshl_b32 s72, s74, 2
    v_mov_b32 v2, 786432
    global_load_dword v17, v2, s[10:11] sc1
    s_lshl_b32 s3, s2, 2
    s_add_u32 s3, s3, 567296
    v_mov_b32 v9, s3
    s_lshl_b32 s3, s2, 4
    s_add_u32 s3, s3, 790528
    v_lshl_add_u32 v20, v1, 4, s3
    v_and_b32 v5, 7, v1
    v_lshlrev_b32 v5, 2, v5
    s_barrier
    s_setprio 3
    s_waitcnt vmcnt(0)
    v_add_u32 v17, 1, v17
    v_mov_b32 v19, v17
    s_mov_b32 s3, 1048576
K_FGRT:
    ds_read_b32 v2, v12 offset:36
    s_sleep 0
    s_sub_u32 s3, s3, 1
    s_waitcnt lgkmcnt(0)
    v_readfirstlane_b32 s33, v2
    s_nop 3
    s_cselect_b32 s33, 4, s33
    s_cmp_lt_u32 s33, 4
    s_cbranch_scc1 K_FGRT
    ds_read2_b32 v[176:177], v11 offset0:0 offset1:32
    s_waitcnt lgkmcnt(0)
    s_nop 1
    v_max_u32_dpp v3, v176, v176 quad_perm:[1,0,3,2] row_mask:0xf bank_mask:0xf
    s_nop 1
    v_max_u32_dpp v3, v3, v3 quad_perm:[2,3,0,1] row_mask:0xf bank_mask:0xf
    s_nop 1
    v_max_u32_dpp v3, v3, v3 row_half_mirror row_mask:0xf bank_mask:0xf
    s_nop 1
    v_max_u32_dpp v3, v3, v3 row_mirror row_mask:0xf bank_mask:0xf
    s_nop 1
    v_readlane_b32 s74, v3, 0
    v_readlane_b32 s76, v3, 16
    v_readlane_b32 s77, v3, 32
    v_readlane_b32 s78, v3, 48
    s_nop 3
    s_max_u32 s74, s74, s76
    s_max_u32 s77, s77, s78
    s_max_u32 s74, s74, s77
    v_cmp_ne_u32 vcc, s74, v176
    s_nop 1
    v_cndmask_b32 v176, 0, v176, vcc
    s_nop 1
    v_max_u32_dpp v3, v176, v176 quad_perm:[1,0,3,2] row_mask:0xf bank_mask:0xf
    s_nop 1
    v_max_u32_dpp v3, v3, v3 quad_perm:[2,3,0,1] row_mask:0xf bank_mask:0xf
    s_nop 1
    v_max_u32_dpp v3, v3, v3 row_half_mirror row_mask:0xf bank_mask:0xf
    s_nop 1
    v_max_u32_dpp v3, v3, v3 row_mirror row_mask:0xf bank_mask:0xf
    s_nop 1
    v_readlane_b32 s75, v3, 0
    v_readlane_b32 s76, v3, 16
    v_readlane_b32 s77, v3, 32
    v_readlane_b32 s78, v3, 48
    s_nop 3
    s_max_u32 s75, s75, s76
    s_max_u32 s77, s77, s78
    s_max_u32 s75, s75, s77
    v_mov_b32 v16, s74
    v_mov_b32 v18, s75
    s_mov_b64 exec, 1
    global_store_dwordx4 v20, v[16:19], s[10:11] sc1
    s_mov_b64 exec, -1
    s_mov_b64 exec, 1
    ds_add_u32 v12, v13 offset:36
    s_mov_b64 exec, -1
    global_load_dword v7, v5, s[8:9] offset:192 sc1
    v_cvt_pk_bf16_f32 v177, v177, v177
    v_lshlrev_b32 v177, 16, v177
    v_mul_f32 v3, 0xbfb8aa3b, v177
    v_exp_f32 v3, v3
    s_nop 0
    v_add_f32 v3, 1.0, v3
    v_rcp_f32 v177, v3
    s_nop 0
    v_cvt_pk_bf16_f32 v177, v177, v177
    v_lshlrev_b32 v177, 16, v177
    s_mov_b32 exec_hi, 0
    buffer_store_dword v177, v10, s[60:63], s72 offen sc1
    s_mov_b64 exec, -1
    s_waitcnt vmcnt(0)
    v_and_b32 v4, 7, v1
    v_lshlrev_b32 v4, 2, v4
    s_mov_b32 s3, 131072
K_ZPOLL3:
    v_cmp_eq_u32 vcc, 0, v7
    s_cbranch_vccz K_ZOK3
    s_sub_u32 s3, s3, 1
    s_cbranch_scc1 K_ZOK3
    global_load_dword v7, v4, s[8:9] offset:192 sc1
    s_waitcnt vmcnt(0)
    s_branch K_ZPOLL3
K_ZOK3:
    s_mov_b64 exec, 1
    global_store_dword v9, v13, s[10:11] sc1
    s_mov_b64 exec, -1
    v_and_b32 v3, 1, v1
    v_lshl_add_u32 v3, v3, 2, s42
    v_lshlrev_b32 v10, 4, v1
    s_mov_b32 s3, 131072
K_AUX_POLL:
    s_sleep 6
    global_load_dword v2, v3, s[10:11] offset:136 sc1
    s_waitcnt vmcnt(0)
    v_cmp_eq_u32 vcc, 0, v2
    s_cbranch_vccz K_AUX_GOT
    s_sub_u32 s3, s3, 1
    s_cmp_lg_u32 s3, 0
    s_cbranch_scc1 K_AUX_POLL
K_AUX_GOT:
    v_readlane_b32 s74, v2, 0
    v_readlane_b32 s75, v2, 1
    s_nop 3
    s_and_b32 s74, s74, 0x7ff
    s_sub_u32 s74, 2047, s74
    s_mul_i32 s74, s74, 1280
    s_mov_b32 m0, 125184
    s_nop 0
    buffer_load_dwordx4 v10, s[12:15], s74 offen lds
    s_mov_b64 exec, 0xffff
    buffer_load_dwordx4 v10, s[12:15], s74 offen offset:1024 lds
    s_mov_b64 exec, -1
    s_and_b32 s75, s75, 0x7ff
    s_sub_u32 s75, 2047, s75
    s_mul_i32 s75, s75, 1280
    s_mov_b32 m0, 126528
    s_nop 0
    buffer_load_dwordx4 v10, s[12:15], s75 offen lds
    s_mov_b64 exec, 0xffff
    buffer_load_dwordx4 v10, s[12:15], s75 offen offset:1024 lds
    s_mov_b64 exec, -1
    s_waitcnt vmcnt(0)
    ds_write_b32 v12, v13 offset:48
    s_setprio 0
    s_branch K_P2
.p2align 12
K_FFN_C:
    s_add_u32 s64, s10, 0x10000
    s_addc_u32 s65, s11, 0
    s_mov_b32 s66, 0x43800
    s_mov_b32 s67, 0x20000
    s_and_b32 s73, s30, 1
    v_lshrrev_b32 v232, 4, v1
    v_bfe_u32 v4, v1, 2, 2
    v_lshl_add_u32 v2, v232, 3, v4
    v_and_b32 v3, 3, v1
    v_lshlrev_b32 v3, 3, v3
    v_lshl_add_u32 v233, v2, 6, v3
    s_lshl_b32 s72, s73, 5
    v_add_u32 v233, s72, v233
    v_lshl_add_u32 v2, v232, 2, v4
    v_bfe_u32 v4, v2, 1, 2
    v_lshl_add_u32 v3, v2, 7, v3
    v_lshl_add_u32 v3, v4, 5, v3
    s_mul_i32 s3, s73, 20480
    s_add_u32 s3, s3, 81920
    v_add_u32 v238, s3, v3
    v_xor_b32 v239, 32, v238
    v_xor_b32 v240, 64, v238
    v_xor_b32 v241, 96, v238
    v_and_b32 v2, 1, v1
    v_mul_u32_u24 v234, 1344, v2
    v_lshl_add_u32 v234, v232, 4, v234
    v_add_u32 v234, 125184, v234
    v_lshlrev_b32 v236, 4, v1
    v_add_u32 v236, 124160, v236
    s_lshl_b32 s3, s73, 3
    v_add_u32 v235, s3, v236
    v_mul_u32_u24 v2, 2560, v2
    v_lshl_add_u32 v237, v232, 4, v2
    s_mul_i32 s3, s44, 5120
    s_mul_i32 s72, s73, 1280
    s_add_u32 s72, s72, s3
    v_lshlrev_b32 v2, 4, v1
    buffer_store_dwordx4 v[16:19], v2, s[64:67], s72 offen offset:0 sc1
    buffer_store_dwordx4 v[16:19], v2, s[64:67], s72 offen offset:2560 sc1
    s_mov_b64 exec, 0xffff
    buffer_store_dwordx4 v[16:19], v2, s[64:67], s72 offen offset:1024 sc1
    buffer_store_dwordx4 v[16:19], v2, s[64:67], s72 offen offset:3584 sc1
    s_mov_b64 exec, -1
    v_add_u32 v5, 40960, v233
    s_mov_b32 s3, 1048576
K_FGD:
    ds_read_b32 v2, v12 offset:56
    s_sleep 2
    s_sub_u32 s3, s3, 1
    s_waitcnt lgkmcnt(0)
    v_readfirstlane_b32 s33, v2
    s_nop 3
    s_cselect_b32 s33, 3, s33
    s_cmp_lt_u32 s33, 3
    s_cbranch_scc1 K_FGD
    s_setprio 3
    ds_read_b64_tr_b16 v[16:17], v233 offset:0
    ds_read_b64_tr_b16 v[18:19], v233 offset:256
    ds_read_b64_tr_b16 v[20:21], v233 offset:2048
    ds_read_b64_tr_b16 v[22:23], v233 offset:2304
    ds_read_b64_tr_b16 v[24:25], v233 offset:4096
    ds_read_b64_tr_b16 v[26:27], v233 offset:4352
    ds_read_b64_tr_b16 v[28:29], v233 offset:6144
    ds_read_b64_tr_b16 v[30:31], v233 offset:6400
    ds_read_b64_tr_b16 v[32:33], v233 offset:8192
    ds_read_b64_tr_b16 v[34:35], v233 offset:8448
    ds_read_b64_tr_b16 v[36:37], v233 offset:10240
    ds_read_b64_tr_b16 v[38:39], v233 offset:10496
    ds_read_b64_tr_b16 v[40:41], v233 offset:12288
    ds_read_b64_tr_b16 v[42:43], v233 offset:12544
    ds_read_b64_tr_b16 v[44:45], v233 offset:14336
    ds_read_b64_tr_b16 v[46:47], v233 offset:14592
    ds_read_b64_tr_b16 v[48:49], v233 offset:16384
    ds_read_b64_tr_b16 v[50:51], v233 offset:16640
    ds_read_b64_tr_b16 v[52:53], v233 offset:18432
    ds_read_b64_tr_b16 v[54:55], v233 offset:18688
    ds_read_b64_tr_b16 v[56:57], v233 offset:20480
    ds_read_b64_tr_b16 v[58:59], v233 offset:20736
    ds_read_b64_tr_b16 v[60:61], v233 offset:22528
    ds_read_b64_tr_b16 v[62:63], v233 offset:22784
    ds_read_b64_tr_b16 v[64:65], v233 offset:24576
    ds_read_b64_tr_b16 v[66:67], v233 offset:24832
    ds_read_b64_tr_b16 v[68:69], v233 offset:26624
    ds_read_b64_tr_b16 v[70:71], v233 offset:26880
    ds_read_b64_tr_b16 v[72:73], v233 offset:28672
    ds_read_b64_tr_b16 v[74:75], v233 offset:28928
    ds_read_b64_tr_b16 v[76:77], v233 offset:30720
    ds_read_b64_tr_b16 v[78:79], v233 offset:30976
    ds_read_b64_tr_b16 v[80:81], v233 offset:32768
    ds_read_b64_tr_b16 v[82:83], v233 offset:33024
    ds_read_b64_tr_b16 v[84:85], v233 offset:34816
    ds_read_b64_tr_b16 v[86:87], v233 offset:35072
    ds_read_b64_tr_b16 v[88:89], v233 offset:36864
    ds_read_b64_tr_b16 v[90:91], v233 offset:37120
    ds_read_b64_tr_b16 v[92:93], v233 offset:38912
    ds_read_b64_tr_b16 v[94:95], v233 offset:39168
    ds_read_b64_tr_b16 v[96:97], v5 offset:0
    ds_read_b64_tr_b16 v[98:99], v5 offset:256
    ds_read_b64_tr_b16 v[100:101], v5 offset:2048
    ds_read_b64_tr_b16 v[102:103], v5 offset:2304
    ds_read_b64_tr_b16 v[104:105], v5 offset:4096
    ds_read_b64_tr_b16 v[106:107], v5 offset:4352
    ds_read_b64_tr_b16 v[108:109], v5 offset:6144
    ds_read_b64_tr_b16 v[110:111], v5 offset:6400
    ds_read_b64_tr_b16 v[112:113], v5 offset:8192
    ds_read_b64_tr_b16 v[114:115], v5 offset:8448
    ds_read_b64_tr_b16 v[116:117], v5 offset:10240
    ds_read_b64_tr_b16 v[118:119], v5 offset:10496
    ds_read_b64_tr_b16 v[120:121], v5 offset:12288
    ds_read_b64_tr_b16 v[122:123], v5 offset:12544
    ds_read_b64_tr_b16 v[124:125], v5 offset:14336
    ds_read_b64_tr_b16 v[126:127], v5 offset:14592
    ds_read_b64_tr_b16 v[128:129], v5 offset:16384
    ds_read_b64_tr_b16 v[130:131], v5 offset:16640
    ds_read_b64_tr_b16 v[132:133], v5 offset:18432
    ds_read_b64_tr_b16 v[134:135], v5 offset:18688
    ds_read_b64_tr_b16 v[136:137], v5 offset:20480
    ds_read_b64_tr_b16 v[138:139], v5 offset:20736
    ds_read_b64_tr_b16 v[140:141], v5 offset:22528
    ds_read_b64_tr_b16 v[142:143], v5 offset:22784
    ds_read_b64_tr_b16 v[144:145], v5 offset:24576
    ds_read_b64_tr_b16 v[146:147], v5 offset:24832
    ds_read_b64_tr_b16 v[148:149], v5 offset:26624
    ds_read_b64_tr_b16 v[150:151], v5 offset:26880
    ds_read_b64_tr_b16 v[152:153], v5 offset:28672
    ds_read_b64_tr_b16 v[154:155], v5 offset:28928
    ds_read_b64_tr_b16 v[156:157], v5 offset:30720
    ds_read_b64_tr_b16 v[158:159], v5 offset:30976
    ds_read_b64_tr_b16 v[160:161], v5 offset:32768
    ds_read_b64_tr_b16 v[162:163], v5 offset:33024
    ds_read_b64_tr_b16 v[164:165], v5 offset:34816
    ds_read_b64_tr_b16 v[166:167], v5 offset:35072
    ds_read_b64_tr_b16 v[168:169], v5 offset:36864
    ds_read_b64_tr_b16 v[170:171], v5 offset:37120
    ds_read_b64_tr_b16 v[172:173], v5 offset:38912
    ds_read_b64_tr_b16 v[174:175], v5 offset:39168
    s_waitcnt vmcnt(0) lgkmcnt(0)
    s_mov_b64 exec, 1
    ds_add_u32 v12, v13 offset:60
    s_mov_b64 exec, -1
    s_mov_b32 s3, 1048576
K_FGK:
    ds_read_b32 v2, v12 offset:48
    s_sleep 1
    s_sub_u32 s3, s3, 1
    s_waitcnt lgkmcnt(0)
    v_readfirstlane_b32 s33, v2
    s_nop 3
    s_cselect_b32 s33, 1, s33
    s_cmp_lt_u32 s33, 1
    s_cbranch_scc1 K_FGK
    ds_read_b128 v[188:191], v234 offset:0
    ds_read_b128 v[192:195], v234 offset:64
    ds_read_b128 v[196:199], v234 offset:128
    ds_read_b128 v[200:203], v234 offset:192
    ds_read_b128 v[204:207], v234 offset:256
    ds_read_b128 v[208:211], v234 offset:320
    ds_read_b128 v[212:215], v234 offset:384
    ds_read_b128 v[216:219], v234 offset:448
    s_waitcnt lgkmcnt(7)
    v_mfma_f32_16x16x32_bf16 v[220:223], v[16:19], v[188:191], 0
    v_mfma_f32_16x16x32_bf16 v[224:227], v[96:99], v[188:191], 0
    ds_read_b128 v[188:191], v234 offset:512
    s_waitcnt lgkmcnt(7)
    v_mfma_f32_16x16x32_bf16 v[220:223], v[20:23], v[192:195], v[220:223]
    v_mfma_f32_16x16x32_bf16 v[224:227], v[100:103], v[192:195], v[224:227]
    ds_read_b128 v[192:195], v234 offset:576
    s_waitcnt lgkmcnt(7)
    v_mfma_f32_16x16x32_bf16 v[220:223], v[24:27], v[196:199], v[220:223]
    v_mfma_f32_16x16x32_bf16 v[224:227], v[104:107], v[196:199], v[224:227]
    ds_read_b128 v[196:199], v234 offset:640
    s_waitcnt lgkmcnt(7)
    v_mfma_f32_16x16x32_bf16 v[220:223], v[28:31], v[200:203], v[220:223]
    v_mfma_f32_16x16x32_bf16 v[224:227], v[108:111], v[200:203], v[224:227]
    ds_read_b128 v[200:203], v234 offset:704
    s_waitcnt lgkmcnt(7)
    v_mfma_f32_16x16x32_bf16 v[220:223], v[32:35], v[204:207], v[220:223]
    v_mfma_f32_16x16x32_bf16 v[224:227], v[112:115], v[204:207], v[224:227]
    ds_read_b128 v[204:207], v234 offset:768
    s_waitcnt lgkmcnt(7)
    v_mfma_f32_16x16x32_bf16 v[220:223], v[36:39], v[208:211], v[220:223]
    v_mfma_f32_16x16x32_bf16 v[224:227], v[116:119], v[208:211], v[224:227]
    ds_read_b128 v[208:211], v234 offset:832
    s_waitcnt lgkmcnt(7)
    v_mfma_f32_16x16x32_bf16 v[220:223], v[40:43], v[212:215], v[220:223]
    v_mfma_f32_16x16x32_bf16 v[224:227], v[120:123], v[212:215], v[224:227]
    ds_read_b128 v[212:215], v234 offset:896
    s_waitcnt lgkmcnt(7)
    v_mfma_f32_16x16x32_bf16 v[220:223], v[44:47], v[216:219], v[220:223]
    v_mfma_f32_16x16x32_bf16 v[224:227], v[124:127], v[216:219], v[224:227]
    ds_read_b128 v[216:219], v234 offset:960
    s_waitcnt lgkmcnt(7)
    v_mfma_f32_16x16x32_bf16 v[220:223], v[48:51], v[188:191], v[220:223]
    v_mfma_f32_16x16x32_bf16 v[224:227], v[128:131], v[188:191], v[224:227]
    ds_read_b128 v[188:191], v234 offset:1024
    s_waitcnt lgkmcnt(7)
    v_mfma_f32_16x16x32_bf16 v[220:223], v[52:55], v[192:195], v[220:223]
    v_mfma_f32_16x16x32_bf16 v[224:227], v[132:135], v[192:195], v[224:227]
    ds_read_b128 v[192:195], v234 offset:1088
    s_waitcnt lgkmcnt(7)
    v_mfma_f32_16x16x32_bf16 v[220:223], v[56:59], v[196:199], v[220:223]
    v_mfma_f32_16x16x32_bf16 v[224:227], v[136:139], v[196:199], v[224:227]
    ds_read_b128 v[196:199], v234 offset:1152
    s_waitcnt lgkmcnt(7)
    v_mfma_f32_16x16x32_bf16 v[220:223], v[60:63], v[200:203], v[220:223]
    v_mfma_f32_16x16x32_bf16 v[224:227], v[140:143], v[200:203], v[224:227]
    ds_read_b128 v[200:203], v234 offset:1216
    s_waitcnt lgkmcnt(7)
    v_mfma_f32_16x16x32_bf16 v[220:223], v[64:67], v[204:207], v[220:223]
    v_mfma_f32_16x16x32_bf16 v[224:227], v[144:147], v[204:207], v[224:227]
    s_waitcnt lgkmcnt(6)
    v_mfma_f32_16x16x32_bf16 v[220:223], v[68:71], v[208:211], v[220:223]
    v_mfma_f32_16x16x32_bf16 v[224:227], v[148:151], v[208:211], v[224:227]
    s_waitcnt lgkmcnt(5)
    v_mfma_f32_16x16x32_bf16 v[220:223], v[72:75], v[212:215], v[220:223]
    v_mfma_f32_16x16x32_bf16 v[224:227], v[152:155], v[212:215], v[224:227]
    s_waitcnt lgkmcnt(4)
    v_mfma_f32_16x16x32_bf16 v[220:223], v[76:79], v[216:219], v[220:223]
    v_mfma_f32_16x16x32_bf16 v[224:227], v[156:159], v[216:219], v[224:227]
    s_waitcnt lgkmcnt(3)
    v_mfma_f32_16x16x32_bf16 v[220:223], v[80:83], v[188:191], v[220:223]
    v_mfma_f32_16x16x32_bf16 v[224:227], v[160:163], v[188:191], v[224:227]
    s_waitcnt lgkmcnt(2)
    v_mfma_f32_16x16x32_bf16 v[220:223], v[84:87], v[192:195], v[220:223]
    v_mfma_f32_16x16x32_bf16 v[224:227], v[164:167], v[192:195], v[224:227]
    s_waitcnt lgkmcnt(1)
    v_mfma_f32_16x16x32_bf16 v[220:223], v[88:91], v[196:199], v[220:223]
    v_mfma_f32_16x16x32_bf16 v[224:227], v[168:171], v[196:199], v[224:227]
    s_waitcnt lgkmcnt(0)
    v_mfma_f32_16x16x32_bf16 v[220:223], v[92:95], v[200:203], v[220:223]
    v_mfma_f32_16x16x32_bf16 v[224:227], v[172:175], v[200:203], v[224:227]
    s_mov_b32 s3, 1048576
K_FGDN:
    ds_read_b32 v2, v12 offset:52
    s_sleep 1
    s_sub_u32 s3, s3, 1
    s_waitcnt lgkmcnt(0)
    v_readfirstlane_b32 s33, v2
    s_nop 3
    s_cselect_b32 s33, 3, s33
    s_cmp_lt_u32 s33, 3
    s_cbranch_scc1 K_FGDN
    ds_read_b64_tr_b16 v[16:17], v238 offset:0
    ds_read_b64_tr_b16 v[18:19], v238 offset:2048
    ds_read_b64_tr_b16 v[20:21], v239 offset:0
    ds_read_b64_tr_b16 v[22:23], v239 offset:2048
    ds_read_b64_tr_b16 v[24:25], v240 offset:0
    ds_read_b64_tr_b16 v[26:27], v240 offset:2048
    ds_read_b64_tr_b16 v[28:29], v241 offset:0
    ds_read_b64_tr_b16 v[30:31], v241 offset:2048
    ds_read_b64_tr_b16 v[32:33], v238 offset:4096
    ds_read_b64_tr_b16 v[34:35], v238 offset:6144
    ds_read_b64_tr_b16 v[36:37], v239 offset:4096
    ds_read_b64_tr_b16 v[38:39], v239 offset:6144
    ds_read_b64_tr_b16 v[40:41], v240 offset:4096
    ds_read_b64_tr_b16 v[42:43], v240 offset:6144
    v_cvt_pk_bf16_f32 v221, v220, v221
    v_lshlrev_b32 v220, 16, v221
    v_and_b32 v221, 0xffff0000, v221
    v_cvt_pk_bf16_f32 v223, v222, v223
    v_lshlrev_b32 v222, 16, v223
    v_and_b32 v223, 0xffff0000, v223
    v_cvt_pk_bf16_f32 v225, v224, v225
    v_lshlrev_b32 v224, 16, v225
    v_and_b32 v225, 0xffff0000, v225
    v_cvt_pk_bf16_f32 v227, v226, v227
    v_lshlrev_b32 v226, 16, v227
    v_and_b32 v227, 0xffff0000, v227
    v_mul_f32 v188, 0xbfb8aa3b, v220
    v_mul_f32 v189, 0xbfb8aa3b, v221
    v_mul_f32 v190, 0xbfb8aa3b, v222
    v_mul_f32 v191, 0xbfb8aa3b, v223
    v_exp_f32 v188, v188
    v_exp_f32 v189, v189
    v_exp_f32 v190, v190
    v_exp_f32 v191, v191
    v_add_f32 v188, 1.0, v188
    v_add_f32 v189, 1.0, v189
    v_add_f32 v190, 1.0, v190
    v_add_f32 v191, 1.0, v191
    v_rcp_f32 v188, v188
    v_rcp_f32 v189, v189
    v_rcp_f32 v190, v190
    v_rcp_f32 v191, v191
    v_mul_f32 v220, v220, v188
    v_mul_f32 v221, v221, v189
    v_mul_f32 v222, v222, v190
    v_mul_f32 v223, v223, v191
    v_cvt_pk_bf16_f32 v221, v220, v221
    v_lshlrev_b32 v220, 16, v221
    v_and_b32 v221, 0xffff0000, v221
    v_cvt_pk_bf16_f32 v223, v222, v223
    v_lshlrev_b32 v222, 16, v223
    v_and_b32 v223, 0xffff0000, v223
    v_mul_f32 v220, v220, v224
    v_mul_f32 v221, v221, v225
    v_mul_f32 v222, v222, v226
    v_mul_f32 v223, v223, v227
    v_cvt_pk_bf16_f32 v228, v220, v221
    v_cvt_pk_bf16_f32 v229, v222, v223
    ds_write_b64 v235, v[228:229]
    s_mov_b64 exec, 1
    ds_add_u32 v12, v13 offset:52
    s_mov_b64 exec, -1
    ds_read_b64_tr_b16 v[44:45], v241 offset:4096
    ds_read_b64_tr_b16 v[46:47], v241 offset:6144
    ds_read_b64_tr_b16 v[48:49], v238 offset:8192
    ds_read_b64_tr_b16 v[50:51], v238 offset:10240
    ds_read_b64_tr_b16 v[52:53], v239 offset:8192
    ds_read_b64_tr_b16 v[54:55], v239 offset:10240
    ds_read_b64_tr_b16 v[56:57], v240 offset:8192
    ds_read_b64_tr_b16 v[58:59], v240 offset:10240
    ds_read_b64_tr_b16 v[60:61], v241 offset:8192
    ds_read_b64_tr_b16 v[62:63], v241 offset:10240
    ds_read_b64_tr_b16 v[64:65], v238 offset:12288
    ds_read_b64_tr_b16 v[66:67], v238 offset:14336
    ds_read_b64_tr_b16 v[68:69], v239 offset:12288
    ds_read_b64_tr_b16 v[70:71], v239 offset:14336
    ds_read_b64_tr_b16 v[72:73], v240 offset:12288
    ds_read_b64_tr_b16 v[74:75], v240 offset:14336
    ds_read_b64_tr_b16 v[76:77], v241 offset:12288
    ds_read_b64_tr_b16 v[78:79], v241 offset:14336
    ds_read_b64_tr_b16 v[80:81], v238 offset:16384
    ds_read_b64_tr_b16 v[82:83], v238 offset:18432
    ds_read_b64_tr_b16 v[84:85], v239 offset:16384
    ds_read_b64_tr_b16 v[86:87], v239 offset:18432
    ds_read_b64_tr_b16 v[88:89], v240 offset:16384
    ds_read_b64_tr_b16 v[90:91], v240 offset:18432
    ds_read_b64_tr_b16 v[92:93], v241 offset:16384
    ds_read_b64_tr_b16 v[94:95], v241 offset:18432
    s_mov_b32 s3, 1048576
K_FGP:
    ds_read_b32 v2, v12 offset:52
    s_sleep 0
    s_sub_u32 s3, s3, 1
    s_waitcnt lgkmcnt(0)
    v_readfirstlane_b32 s33, v2
    s_nop 3
    s_cselect_b32 s33, 5, s33
    s_cmp_lt_u32 s33, 5
    s_cbranch_scc1 K_FGP
    ds_read_b128 v[228:231], v236
    s_waitcnt lgkmcnt(0)
    v_mfma_f32_16x16x32_bf16 v[96:99], v[16:19], v[228:231], 0
    v_mfma_f32_16x16x32_bf16 v[100:103], v[20:23], v[228:231], 0
    v_mfma_f32_16x16x32_bf16 v[104:107], v[24:27], v[228:231], 0
    v_mfma_f32_16x16x32_bf16 v[108:111], v[28:31], v[228:231], 0
    v_mfma_f32_16x16x32_bf16 v[112:115], v[32:35], v[228:231], 0
    v_mfma_f32_16x16x32_bf16 v[116:119], v[36:39], v[228:231], 0
    v_mfma_f32_16x16x32_bf16 v[120:123], v[40:43], v[228:231], 0
    v_mfma_f32_16x16x32_bf16 v[124:127], v[44:47], v[228:231], 0
    v_mfma_f32_16x16x32_bf16 v[128:131], v[48:51], v[228:231], 0
    v_mfma_f32_16x16x32_bf16 v[132:135], v[52:55], v[228:231], 0
    v_mfma_f32_16x16x32_bf16 v[136:139], v[56:59], v[228:231], 0
    v_mfma_f32_16x16x32_bf16 v[140:143], v[60:63], v[228:231], 0
    v_mfma_f32_16x16x32_bf16 v[144:147], v[64:67], v[228:231], 0
    v_mfma_f32_16x16x32_bf16 v[148:151], v[68:71], v[228:231], 0
    v_mfma_f32_16x16x32_bf16 v[152:155], v[72:75], v[228:231], 0
    v_mfma_f32_16x16x32_bf16 v[156:159], v[76:79], v[228:231], 0
    v_mfma_f32_16x16x32_bf16 v[160:163], v[80:83], v[228:231], 0
    v_mfma_f32_16x16x32_bf16 v[164:167], v[84:87], v[228:231], 0
    v_mfma_f32_16x16x32_bf16 v[168:171], v[88:91], v[228:231], 0
    v_mfma_f32_16x16x32_bf16 v[172:175], v[92:95], v[228:231], 0
    s_mov_b32 exec_lo, 0x00030003
    s_mov_b32 exec_hi, 0x00030003
    buffer_store_dwordx4 v[96:99], v237, s[64:67], s72 offen offset:0 sc1
    buffer_store_dwordx4 v[100:103], v237, s[64:67], s72 offen offset:64 sc1
    buffer_store_dwordx4 v[104:107], v237, s[64:67], s72 offen offset:128 sc1
    buffer_store_dwordx4 v[108:111], v237, s[64:67], s72 offen offset:192 sc1
    buffer_store_dwordx4 v[112:115], v237, s[64:67], s72 offen offset:256 sc1
    buffer_store_dwordx4 v[116:119], v237, s[64:67], s72 offen offset:320 sc1
    buffer_store_dwordx4 v[120:123], v237, s[64:67], s72 offen offset:384 sc1
    buffer_store_dwordx4 v[124:127], v237, s[64:67], s72 offen offset:448 sc1
    buffer_store_dwordx4 v[128:131], v237, s[64:67], s72 offen offset:512 sc1
    buffer_store_dwordx4 v[132:135], v237, s[64:67], s72 offen offset:576 sc1
    buffer_store_dwordx4 v[136:139], v237, s[64:67], s72 offen offset:640 sc1
    buffer_store_dwordx4 v[140:143], v237, s[64:67], s72 offen offset:704 sc1
    buffer_store_dwordx4 v[144:147], v237, s[64:67], s72 offen offset:768 sc1
    buffer_store_dwordx4 v[148:151], v237, s[64:67], s72 offen offset:832 sc1
    buffer_store_dwordx4 v[152:155], v237, s[64:67], s72 offen offset:896 sc1
    buffer_store_dwordx4 v[156:159], v237, s[64:67], s72 offen offset:960 sc1
    buffer_store_dwordx4 v[160:163], v237, s[64:67], s72 offen offset:1024 sc1
    buffer_store_dwordx4 v[164:167], v237, s[64:67], s72 offen offset:1088 sc1
    buffer_store_dwordx4 v[168:171], v237, s[64:67], s72 offen offset:1152 sc1
    buffer_store_dwordx4 v[172:175], v237, s[64:67], s72 offen offset:1216 sc1
    s_mov_b64 exec, -1
    s_mul_i32 s3, s73, 2560
    s_lshl2_add_u32 s3, s44, s3
    s_add_u32 s3, s3, 568320
    v_lshl_add_u32 v2, v1, 8, s3
    s_mov_b64 exec, 0x3ff
    s_waitcnt vmcnt(0)
    global_store_dword v2, v13, s[10:11] sc1
    s_mov_b64 exec, -1
    s_branch K_P2_HELP
K_CODE_END:
.section .rodata,"a"
.p2align 6
.amdhsa_kernel gated_mix__sliding_local_dilated__moe_arch_mod__prompt_kernel
  .amdhsa_next_free_vgpr 248
  .amdhsa_next_free_sgpr 79
  .amdhsa_accum_offset 248
  .amdhsa_group_segment_fixed_size 0
  .amdhsa_kernarg_size 96
  .amdhsa_user_sgpr_count 2
  .amdhsa_user_sgpr_kernarg_segment_ptr 1
  .amdhsa_system_sgpr_workgroup_id_x 1
.end_amdhsa_kernel
```

```asm
; @launch grid=(256,1,1) block=(512,1,1) lds=163840
.amdgcn_target "amdgcn-amd-amdhsa--gfx950"
.text
.p2align 12
.p2align 8
.globl gated_mix__sliding_local_dilated__moe_arch_mod__prompt_kernel
.type gated_mix__sliding_local_dilated__moe_arch_mod__prompt_kernel,@function
gated_mix__sliding_local_dilated__moe_arch_mod__prompt_kernel:
    s_cmp_ge_u32 s2, 256
    s_cbranch_scc1 K_EXIT
    s_load_dwordx2 s[12:13], s[0:1], 0
    s_load_dwordx2 s[16:17], s[0:1], 8
    v_readfirstlane_b32 s30, v0
    s_load_dwordx4 s[8:11], s[0:1], 80
    s_load_dwordx2 s[24:25], s[0:1], 16
    s_load_dwordx2 s[6:7], s[0:1], 72
    s_and_b32 s28, s2, 7
    v_and_b32 v1, 63, v0
    s_mov_b32 s14, 0x280000
    s_mov_b32 s15, 0x20000
    s_lshr_b32 s30, s30, 6
    s_cmp_lt_u32 s2, 64
    s_cbranch_scc1 K_SLOW
    s_cmp_lt_u32 s30, 4
    s_cbranch_scc1 K_FAST
K_SLOW:
    s_getpc_b64 s[38:39]
K_PC:
    s_bfe_u32 s3, s2, 0x30003
    s_mul_i32 s3, s3, ((K_CODE_END-gated_mix__sliding_local_dilated__moe_arch_mod__prompt_kernel+1023)/1024)
    s_sub_u32 s38, s38, K_PC-gated_mix__sliding_local_dilated__moe_arch_mod__prompt_kernel
    s_subb_u32 s39, s39, 0
    v_subrev_u32 v3, 256, v0
    v_add_u32 v2, s3, v3
    v_lshlrev_b32 v2, 7, v2
    v_min_u32 v2, K_CODE_END-gated_mix__sliding_local_dilated__moe_arch_mod__prompt_kernel-4, v2
    v_cmp_gt_u32 vcc, ((K_CODE_END-gated_mix__sliding_local_dilated__moe_arch_mod__prompt_kernel+1023)/1024), v3
    s_and_saveexec_b64 s[4:5], vcc
    s_cbranch_execz K_NOPF
    global_load_dword v6, v2, s[38:39]
K_NOPF:
    s_mov_b64 exec, -1
    v_mov_b64 v[2:3], 0
    v_mov_b64 v[4:5], 0
    v_mov_b32 v7, 158752
    ds_write_b128 v7, v[2:5] offset:0
    ds_write_b128 v7, v[2:5] offset:16
    ds_write_b128 v7, v[2:5] offset:32
    ds_write_b128 v7, v[2:5] offset:48
    s_mov_b32 s43, 1
    s_lshl_b32 s3, s30, 8
    s_add_u32 s3, s3, s2
    s_lshr_b32 s3, s3, 3
    s_cmp_lg_u32 s3, 160
    s_cbranch_scc1 K_COMMON
    s_mul_i32 s3, s2, 6144
    s_add_u32 s3, s3, 527360
    v_lshl_add_u32 v6, v1, 4, s3
    v_mov_b64 v[24:25], 0
    v_mov_b64 v[26:27], 0
    s_waitcnt lgkmcnt(0)
    global_store_dwordx4 v6, v[24:27], s[10:11] offset:-3072 sc1
    global_store_dwordx4 v6, v[24:27], s[10:11] offset:-2048 sc1
    global_store_dwordx4 v6, v[24:27], s[10:11] offset:-1024 sc1
    global_store_dwordx4 v6, v[24:27], s[10:11] offset:0 sc1
    global_store_dwordx4 v6, v[24:27], s[10:11] offset:1024 sc1
    global_store_dwordx4 v6, v[24:27], s[10:11] offset:2048 sc1
    s_lshl_b32 s3, s2, 2
    v_mov_b32 v2, s3
    v_mov_b32 v3, 1
    s_mov_b64 exec, 1
    s_waitcnt vmcnt(0)
    global_store_dword v2, v3, s[8:9] offset:192 sc1
    s_mov_b64 exec, -1
    s_branch K_COMMON
K_FAST:
    s_lshr_b32 s32, s2, 1
    s_and_b32 s32, s32, 28
    v_lshrrev_b32 v3, 4, v1
    s_lshr_b32 s3, s2, 6
    s_mov_b32 s59, 0x59608237
    s_cmp_eq_u32 s3, 2
    s_cselect_b32 s59, 0x26375904, s59
    v_and_b32 v4, 7, v1
    s_cmp_eq_u32 s3, 3
    s_cselect_b32 s59, 0x93042671, s59
    v_lshrrev_b32 v2, 3, v1
    s_lshr_b32 s59, s59, s32
    s_and_b32 s59, s59, 15
    v_xor_b32 v4, v4, v3
    s_lshl_b32 s33, s28, 2
    s_lshr_b32 s33, 0x76543210, s33
    s_and_b32 s33, s33, 15
    s_add_u32 s59, s59, s33
    s_cmp_ge_u32 s59, 10
    v_mul_u32_u24 v2, 1280, v2
    s_cselect_b32 s33, 10, 0
    s_sub_u32 s59, s59, s33
    s_lshr_b32 s53, s28, 1
    v_lshl_add_u32 v40, v4, 4, v2
    s_mul_i32 s53, s53, 655360
    s_lshl2_add_u32 s62, s3, s30
    s_cmp_eq_u32 s62, 15
    s_cselect_b32 s62, 0x800000, 0
    s_add_u32 s62, s62, 40960
    s_mul_i32 s3, s3, 225280
    v_xor_b32 v41, 64, v40
    s_add_u32 s53, s53, s3
    s_mul_i32 s54, s30, 61440
    s_add_u32 s53, s53, s54
    s_sub_u32 s53, s53, 245760
    s_mul_i32 s55, s30, 6144
    s_add_u32 s55, s55, 49152
    s_lshl_b32 s57, s59, 7
    s_add_u32 s57, s57, s53
    s_waitcnt lgkmcnt(0)
    s_add_u32 m0, s55, 0
    s_max_i32 s60, s57, 0
    buffer_load_dwordx4 v40, s[12:15], s60 offen lds
    s_add_u32 s60, s57, 10240
    s_add_u32 m0, s55, 1024
    s_max_i32 s60, s60, 0
    buffer_load_dwordx4 v41, s[12:15], s60 offen lds
    s_add_u32 m0, s55, 2048
    s_add_u32 s60, s57, 20480
    buffer_load_dwordx4 v40, s[12:15], s60 offen lds
    s_add_u32 m0, s55, 3072
    s_add_u32 s60, s57, 30720
    buffer_load_dwordx4 v41, s[12:15], s60 offen lds
    s_add_u32 m0, s55, 4096
    s_add_u32 s60, s57, s62
    buffer_load_dwordx4 v40, s[12:15], s60 offen lds
    s_add_u32 m0, s55, 5120
    s_add_u32 s60, s60, 10240
    buffer_load_dwordx4 v41, s[12:15], s60 offen lds
    v_lshlrev_b32 v2, 1, v3
    s_lshr_b32 s32, 0x64317520, s32
    v_sub_u32 v2, v1, v2
    s_and_b32 s32, s32, 7
    v_and_b32 v2, 15, v2
    s_and_b32 s3, s28, 1
    v_mul_u32_u24 v3, 3840, v3
    s_lshl3_add_u32 s32, s3, s32
    v_mul_u32_u24 v4, 13, v2
    s_mul_i32 s3, s32, 80
    v_lshrrev_b32 v4, 6, v4
    s_add_u32 s54, s54, s3
    v_mul_u32_u24 v4, 1200, v4
    s_lshl_b32 s56, s30, 12
    v_lshl_add_u32 v4, v2, 4, v4
    s_add_u32 s56, s56, 106496
    v_add_u32 v5, 1, v2
    s_mov_b32 s18, 0x258000
    v_and_b32 v5, 16, v5
    s_mov_b32 s19, 0x20000
    v_lshl_add_u32 v4, v5, 24, v4
    v_add_u32 v42, v3, v4
    s_mul_i32 s58, s59, 245760
    s_add_u32 s58, s58, s54
    s_add_u32 s59, s59, 1
    s_cmp_eq_u32 s59, 10
    s_cselect_b32 s59, 0, s59
    s_add_u32 m0, s56, 0
    s_add_u32 s60, s58, 0
    buffer_load_dwordx4 v42, s[16:19], s60 offen lds
    s_add_u32 m0, s56, 1024
    s_add_u32 s60, s58, 15360
    buffer_load_dwordx4 v42, s[16:19], s60 offen lds
    v_xor_b32 v2, 8, v2
    v_mul_u32_u24 v4, 13, v2
    v_lshrrev_b32 v4, 6, v4
    v_mul_u32_u24 v4, 1200, v4
    v_lshl_add_u32 v4, v2, 4, v4
    v_add_u32 v5, 1, v2
    v_and_b32 v5, 16, v5
    v_lshl_add_u32 v4, v5, 24, v4
    v_add_u32 v43, v3, v4
    s_add_u32 m0, s56, 2048
    s_add_u32 s60, s58, 30720
    buffer_load_dwordx4 v43, s[16:19], s60 offen lds
    s_add_u32 m0, s56, 3072
    s_add_u32 s60, s58, 46080
    buffer_load_dwordx4 v43, s[16:19], s60 offen lds
    s_mov_b32 s52, s30
    s_mov_b32 s43, 0
K_COMMON:
    v_mov_b32 v7, 0
    s_lshr_b32 s29, s2, 3
    s_xor_b32 s30, s30, 4
    s_mov_b32 s26, 0xc8000
    s_mov_b32 s27, 0x20000
    s_lshr_b32 s34, s29, 3
    s_lshl_b32 s34, s34, 2
    s_and_b32 s3, s29, 3
    s_add_u32 s34, s34, s3
    s_add_u32 s34, s34, 4
    s_bitcmp1_b32 s29, 2
    s_cselect_b32 s34, -1, s34
    s_cmp_lt_u32 s29, 8
    s_cselect_b32 s34, s29, s34
    s_lshl_b32 s40, s28, 1
    s_cmp_ge_u32 s34, 10
    s_addc_u32 s40, s40, 0
    s_sub_u32 s41, s34, 10
    s_cmp_ge_u32 s34, 10
    s_cselect_b32 s41, s41, s34
    s_mul_i32 s42, s28, 20
    s_add_u32 s42, s42, s34
    s_and_b32 s42, s42, 255
    s_lshl_b32 s42, s42, 8
    s_add_u32 s42, s42, 524288
    s_cmp_lt_u32 s29, 8
    s_cbranch_scc1 K_AUX
    s_lshr_b32 s31, s29, 3
    s_sub_u32 s31, s31, 1
    s_and_b32 s35, s29, 3
    s_and_b32 s3, s29, 4
    s_lshl_b32 s3, s3, 1
    s_add_u32 s35, s35, s3
    s_and_b32 s3, s28, 1
    s_lshl_b32 s3, s3, 2
    s_add_u32 s35, s35, s3
    v_and_b32 v9, 15, v1
    v_lshrrev_b32 v10, 4, v1
    v_bfe_u32 v11, v1, 2, 2
    v_and_b32 v12, 3, v1
    s_waitcnt lgkmcnt(0)
    s_add_u32 s20, s10, 0x100000
    s_addc_u32 s21, s11, 0
    s_mov_b32 s22, 0x280000
    s_mov_b32 s23, 0x20000
    s_and_b32 s3, s30, 3
    s_mul_i32 s3, s3, 3
    s_lshr_b32 s33, s30, 2
    s_lshl1_add_u32 s3, s33, s3
    s_mul_i32 s44, s31, 11
    s_add_u32 s44, s44, s3
    s_cmp_eq_u32 s44, 31
    s_cselect_b32 s51, 4, s30
    s_lshr_b32 s33, s28, 1
    s_lshl_b32 s33, s33, 5
    s_add_u32 s44, s44, s33
    s_lshl_b32 s3, s3, 10
    s_add_u32 s3, s3, 122880
    v_lshl_add_u32 v13, v1, 4, s3
    v_lshl_add_u32 v2, v9, 4, s3
    v_add_u32 v2, 520, v2
    v_add_u32 v3, 512, v13
    v_cmp_eq_u32 vcc, 0, v10
    s_nop 1
    v_cndmask_b32 v18, v2, v3, vcc
    v_cmp_eq_u32 vcc, 1, v10
    s_nop 1
    v_cndmask_b32 v19, v2, v3, vcc
    v_lshl_add_u32 v5, v10, 2, v11
    v_lshl_add_u32 v5, v5, 4, s3
    v_add_u32 v2, 520, v5
    v_add_u32 v3, 8, v5
    v_add_u32 v4, 264, v5
    s_cmp_lt_u32 s30, 4
    s_cselect_b32 s33, 0, 3
    s_sub_u32 s33, s30, s33
    s_mul_i32 s33, s33, 5120
    s_add_u32 s33, s33, 79872
    v_lshl_add_u32 v14, v1, 3, s33
    v_cmp_eq_u32 vcc, 0, v12
    s_nop 1
    v_cndmask_b32 v20, v2, v3, vcc
    v_cmp_eq_u32 vcc, 1, v12
    s_nop 1
    v_cndmask_b32 v21, v2, v4, vcc
    v_cmp_eq_u32 vcc, 2, v12
    s_nop 1
    v_cndmask_b32 v22, v2, v3, vcc
    v_cmp_eq_u32 vcc, 3, v12
    s_nop 1
    v_cndmask_b32 v23, v2, v4, vcc
    s_lshl_b32 s3, s35, 10
    v_lshl_add_u32 v15, v1, 4, s3
    s_lshl_b32 s3, s35, 8
    s_add_u32 s3, s3, 16384
    v_lshl_add_u32 v16, v9, 4, s3
    v_and_b32 v2, 1, v10
    v_lshl_add_u32 v16, v2, 23, v16
    s_cmp_lt_u32 s51, 4
    s_cselect_b32 s3, 0, 0x800000
    s_add_u32 s3, s3, 20480
    v_lshrrev_b32 v2, 1, v10
    v_mad_u32_u24 v16, v2, s3, v16
    s_mul_i32 s50, s44, 20480
    s_add_u32 s51, s50, s3
    v_mov_b32 v17, 0xf149f2ca
    v_lshlrev_b32 v2, 2, v10
    v_sub_u32 v2, v9, v2
    s_cmp_eq_u32 s44, 0
    s_cselect_b32 s3, 0xf149f2ca, 0
    v_subrev_u32 v3, 0, v2
    v_and_b32 v4, 0x80000001, v3
    v_cmp_eq_u32 vcc, 0, v4
    s_nop 1
    v_cndmask_b32 v28, v17, 0, vcc
    v_cmp_eq_u32 vcc, 0x80000000, v4
    s_nop 1
    v_cndmask_b32 v24, v17, 0, vcc
    v_add_f32 v32, s3, v24
    v_subrev_u32 v3, 1, v2
    v_and_b32 v4, 0x80000001, v3
    v_cmp_eq_u32 vcc, 0, v4
    s_nop 1
    v_cndmask_b32 v29, v17, 0, vcc
    v_cmp_eq_u32 vcc, 0x80000000, v4
    s_nop 1
    v_cndmask_b32 v25, v17, 0, vcc
    v_add_f32 v33, s3, v25
    v_subrev_u32 v3, 2, v2
    v_and_b32 v4, 0x80000001, v3
    v_cmp_eq_u32 vcc, 0, v4
    s_nop 1
    v_cndmask_b32 v30, v17, 0, vcc
    v_cmp_eq_u32 vcc, 0x80000000, v4
    s_nop 1
    v_cndmask_b32 v26, v17, 0, vcc
    v_add_f32 v34, s3, v26
    v_subrev_u32 v3, 3, v2
    v_and_b32 v4, 0x80000001, v3
    v_cmp_eq_u32 vcc, 0, v4
    s_nop 1
    v_cndmask_b32 v31, v17, 0, vcc
    v_cmp_eq_u32 vcc, 0x80000000, v4
    s_nop 1
    v_cndmask_b32 v27, v17, 0, vcc
    v_add_f32 v35, s3, v27
    v_mov_b32 v3, 0x0c0c0c0c
    v_mov_b32 v4, 0xc0c0100
    v_cmp_eq_u32 vcc, 0, v24
    v_mov_b32 v5, 0x1000c0c
    s_nop 0
    v_cndmask_b32 v3, v3, v4, vcc
    v_cmp_eq_u32 vcc, 0, v25
    s_nop 1
    v_cndmask_b32 v36, v3, v5, vcc
    v_mov_b32 v3, 0x0c0c0c0c
    v_mov_b32 v4, 0xc0c0302
    v_cmp_eq_u32 vcc, 0, v26
    v_mov_b32 v5, 0x3020c0c
    s_nop 0
    v_cndmask_b32 v3, v3, v4, vcc
    v_cmp_eq_u32 vcc, 0, v27
    s_nop 1
    v_cndmask_b32 v37, v3, v5, vcc
    v_mov_b32 v3, 0x0c0c0c0c
    v_mov_b32 v4, 0xc0c0100
    v_cmp_eq_u32 vcc, 0, v28
    v_mov_b32 v5, 0x1000c0c
    s_nop 0
    v_cndmask_b32 v3, v3, v4, vcc
    v_cmp_eq_u32 vcc, 0, v29
    s_nop 1
    v_cndmask_b32 v38, v3, v5, vcc
    v_mov_b32 v3, 0x0c0c0c0c
    v_mov_b32 v4, 0xc0c0302
    v_cmp_eq_u32 vcc, 0, v30
    v_mov_b32 v5, 0x3020c0c
    s_nop 0
    v_cndmask_b32 v3, v3, v4, vcc
    v_cmp_eq_u32 vcc, 0, v31
    s_nop 1
    v_cndmask_b32 v39, v3, v5, vcc
    s_mov_b32 s46, 0x3ea52b5c
    s_mov_b32 s47, s46
    s_mov_b32 s48, 0x3e64f92e
    s_mov_b32 s49, s48
    s_mov_b32 s36, 0xfffff
    s_cmp_lg_u32 s31, 0
    s_cselect_b32 s33, 64, 0
    v_mov_b32 v2, s33
    v_cmp_gt_u32 vcc, 10, v1
    s_lshr_b32 s3, s28, 1
    s_lshl2_add_u32 s3, s3, s31
    v_cndmask_b32 v2, 0, v2, vcc
    v_lshl_add_u32 v2, v1, 8, v2
    s_mul_i32 s3, s3, 2560
    s_lshl2_add_u32 s3, s35, s3
    s_add_u32 s3, s3, 524288
    v_add_u32 v8, s3, v2
    s_cmp_eq_u32 s43, 1
    s_cbranch_scc1 K_CONS
    v_lshrrev_b32 v2, 3, v1
    v_mul_u32_u24 v2, 1280, v2
    v_lshrrev_b32 v3, 4, v1
    v_lshlrev_b32 v3, 1, v3
    v_and_b32 v4, 7, v1
    v_xor_b32 v3, v3, v4
    v_lshl_add_u32 v2, v3, 4, v2
    s_lshl_b32 s33, s41, 7
    v_add_u32 v17, s33, v2
    s_mov_b32 s61, 9
    s_branch K_LOOPE
K_LOOP:
    s_waitcnt vmcnt(5)
    s_barrier
    s_add_u32 m0, s56, 2048
    s_add_u32 s60, s58, 30720
    buffer_load_dwordx4 v43, s[16:19], s60 offen lds
    s_add_u32 m0, s55, 3072
    s_add_u32 s60, s57, 30720
    buffer_load_dwordx4 v41, s[12:15], s60 offen lds
    s_add_u32 m0, s56, 3072
    s_add_u32 s60, s58, 46080
    buffer_load_dwordx4 v43, s[16:19], s60 offen lds
    s_add_u32 m0, s55, 4096
    s_add_u32 s60, s57, s62
    buffer_load_dwordx4 v40, s[12:15], s60 offen lds
    s_add_u32 m0, s55, 5120
    s_add_u32 s60, s60, 10240
    buffer_load_dwordx4 v41, s[12:15], s60 offen lds
    s_sub_u32 s61, s61, 1
    s_cmp_eq_u32 s61, 0
    s_cbranch_scc1 K_LOOPX
K_LOOPE:
    s_cmp_ge_u32 s55, 49152
    s_cselect_b32 s60, -2, 1
    s_mul_i32 s3, s60, 24576
    s_add_u32 s55, s55, s3
    s_lshl_b32 s60, s60, 14
    s_add_u32 s56, s56, s60
    s_lshl_b32 s57, s59, 7
    s_add_u32 s57, s57, s53
    s_mul_i32 s58, s59, 245760
    s_add_u32 s58, s58, s54
    s_add_u32 s59, s59, 1
    s_cmp_eq_u32 s59, 10
    s_cselect_b32 s59, 0, s59
    s_add_u32 m0, s56, 0
    s_add_u32 s60, s58, 0
    buffer_load_dwordx4 v42, s[16:19], s60 offen lds
    s_add_u32 m0, s55, 0
    s_max_i32 s60, s57, 0
    buffer_load_dwordx4 v40, s[12:15], s60 offen lds
    s_add_u32 m0, s56, 1024
    s_add_u32 s60, s58, 15360
    buffer_load_dwordx4 v42, s[16:19], s60 offen lds
    s_add_u32 s60, s57, 10240
    s_add_u32 m0, s55, 1024
    s_max_i32 s60, s60, 0
    buffer_load_dwordx4 v41, s[12:15], s60 offen lds
    s_add_u32 m0, s55, 2048
    s_add_u32 s60, s57, 20480
    buffer_load_dwordx4 v40, s[12:15], s60 offen lds
    s_branch K_LOOP
K_LOOPX:
    v_and_b32 v2, 7, v1
    v_lshlrev_b32 v2, 2, v2
    s_waitcnt vmcnt(0)
    s_barrier
    s_cmp_lt_u32 s30, 6
    s_cbranch_scc1 K_NOSMP
    global_load_dword v7, v2, s[8:9] offset:192 sc1
K_NOSMP:
    s_cmp_eq_u32 s34, -1
    s_cbranch_scc1 K_JOIN_S
    s_cmp_lt_u32 s52, 2
    s_cbranch_scc1 K_WOE
    s_cmp_lg_u32 s30, 7
    s_cbranch_scc1 K_JOIN_S
    s_mov_b32 s52, 2
    s_branch K_W7A
K_WOE:
    s_lshl_b32 s57, s52, 2
    s_lshr_b32 s57, 0x7520, s57
    s_and_b32 s57, s57, 7
    s_mul_i32 s57, s57, 51200
    s_mul_i32 s58, s52, 5120
    s_add_u32 s3, s57, 0
    s_add_u32 m0, s58, 0
    s_nop 0
    buffer_load_dwordx4 v17, s[24:27], s3 offen lds
    s_add_u32 s3, s57, 10240
    s_add_u32 m0, s58, 1024
    s_nop 0
    buffer_load_dwordx4 v17, s[24:27], s3 offen lds
    s_add_u32 s3, s57, 20480
    s_add_u32 m0, s58, 2048
    s_nop 0
    buffer_load_dwordx4 v17, s[24:27], s3 offen lds
    s_add_u32 s3, s57, 30720
    s_add_u32 m0, s58, 3072
    s_nop 0
    buffer_load_dwordx4 v17, s[24:27], s3 offen lds
    s_add_u32 s3, s57, 40960
    s_add_u32 m0, s58, 4096
    s_nop 0
    buffer_load_dwordx4 v17, s[24:27], s3 offen lds
    s_add_u32 s3, s57, 409600
    s_add_u32 m0, s58, 20480
    s_nop 0
    buffer_load_dwordx4 v17, s[24:27], s3 offen lds
    s_add_u32 s3, s57, 419840
    s_add_u32 m0, s58, 21504
    s_nop 0
    buffer_load_dwordx4 v17, s[24:27], s3 offen lds
    s_add_u32 s3, s57, 430080
    s_add_u32 m0, s58, 22528
    s_nop 0
    buffer_load_dwordx4 v17, s[24:27], s3 offen lds
    s_add_u32 s3, s57, 440320
    s_add_u32 m0, s58, 23552
    s_nop 0
    buffer_load_dwordx4 v17, s[24:27], s3 offen lds
    s_add_u32 s3, s57, 450560
    s_add_u32 m0, s58, 24576
    s_nop 0
    buffer_load_dwordx4 v17, s[24:27], s3 offen lds
    s_cmp_lg_u32 s30, 7
    s_cbranch_scc1 K_JOIN_S
    s_add_u32 s52, s52, 1
    s_cmp_lt_u32 s52, 4
    s_cbranch_scc1 K_WOE
    s_mov_b32 s52, 0
K_XD:
    s_lshl_b32 s57, s40, 3
    s_lshl1_add_u32 s57, s52, s57
    s_mul_i32 s57, s57, 20480
    s_lshl_b32 s33, s41, 7
    s_add_u32 s57, s57, s33
    s_lshl_b32 s33, s52, 12
    s_add_u32 m0, s33, 140288
    s_add_u32 s3, s57, 0
    buffer_load_dwordx4 v40, s[12:15], s3 offen lds
    s_add_u32 m0, s33, 141312
    s_add_u32 s3, s57, 10240
    buffer_load_dwordx4 v41, s[12:15], s3 offen lds
    s_add_u32 m0, s33, 142336
    s_add_u32 s3, s57, 20480
    buffer_load_dwordx4 v40, s[12:15], s3 offen lds
    s_add_u32 m0, s33, 143360
    s_add_u32 s3, s57, 30720
    buffer_load_dwordx4 v41, s[12:15], s3 offen lds
    s_add_u32 s52, s52, 1
    s_cmp_lt_u32 s52, 4
    s_cbranch_scc1 K_XD
    s_branch K_W7
.p2align 12
K_CONS:
    v_lshrrev_b32 v2, 1, v9
    v_xor_b32 v2, v2, v10
    v_lshlrev_b32 v2, 4, v2
    v_lshl_add_u32 v2, v9, 7, v2
    s_mul_i32 s3, s30, 6144
    v_add_u32 v40, s3, v2
    v_xor_b32 v41, 64, v40
    v_and_b32 v2, 1, v10
    v_lshl_or_b32 v2, v2, 2, v11
    v_lshlrev_b32 v2, 5, v2
    v_lshl_add_u32 v3, v10, 3, v11
    v_lshlrev_b32 v3, 8, v3
    v_add_u32 v3, 73728, v3
    v_lshlrev_b32 v5, 3, v12
    s_movk_i32 s33, 0xff
    s_mov_b32 s3, 0x48209870
    v_lshrrev_b32 v4, v5, s3
    v_add_u32 v4, v4, v2
    v_and_or_b32 v42, v4, s33, v3
    s_mov_b32 s3, 0xf8f0e8c0
    v_lshrrev_b32 v4, v5, s3
    v_add_u32 v4, v4, v2
    v_and_or_b32 v43, v4, s33, v3
    v_add_u32 v2, v2, v5
    v_add_u32 v4, 80, v2
    v_and_or_b32 v44, v4, s33, v3
    v_add_u32 v4, 120, v2
    v_and_or_b32 v45, v4, s33, v3
    v_add_u32 v4, 0, v2
    v_and_or_b32 v46, v4, s33, v3
    v_add_u32 v4, 40, v2
    v_and_or_b32 v47, v4, s33, v3
    v_add_u32 v4, 160, v2
    v_and_or_b32 v48, v4, s33, v3
    v_add_u32 v4, 200, v2
    v_and_or_b32 v49, v4, s33, v3
    s_lshl_b32 s3, s30, 2
    s_add_u32 s3, s3, 158800
    v_mov_b32 v50, s3
    v_mov_b32 v4, 1
    v_mov_b32 v5, 2
    v_mov_b64 v[52:53], 0
    v_mov_b64 v[54:55], 0
    v_mov_b64 v[56:57], 0
    v_mov_b64 v[58:59], 0
    v_mov_b64 v[60:61], 0
    v_mov_b64 v[62:63], 0
    v_mov_b64 v[64:65], 0
    v_mov_b64 v[66:67], 0
    v_mov_b64 v[68:69], 0
    v_mov_b64 v[70:71], 0
    v_mov_b64 v[72:73], 0
    v_mov_b64 v[74:75], 0
    v_mov_b64 v[76:77], 0
    v_mov_b64 v[78:79], 0
    v_mov_b64 v[80:81], 0
    v_mov_b64 v[82:83], 0
    v_mov_b64 v[84:85], 0
    v_mov_b64 v[86:87], 0
    v_mov_b64 v[88:89], 0
    v_mov_b64 v[90:91], 0
    v_mov_b64 v[92:93], 0
    v_mov_b64 v[94:95], 0
    v_mov_b64 v[96:97], 0
    v_mov_b64 v[98:99], 0
    v_mov_b64 v[100:101], 0
    v_mov_b64 v[102:103], 0
    v_mov_b64 v[104:105], 0
    v_mov_b64 v[106:107], 0
    v_mov_b64 v[108:109], 0
    v_mov_b64 v[110:111], 0
    v_mov_b64 v[112:113], 0
    v_mov_b64 v[114:115], 0
    v_mov_b64 v[116:117], 0
    v_mov_b64 v[118:119], 0
    v_mov_b64 v[120:121], 0
    v_mov_b64 v[122:123], 0
    v_mov_b64 v[124:125], 0
    v_mov_b64 v[126:127], 0
    v_mov_b64 v[128:129], 0
    v_mov_b64 v[130:131], 0
    v_mov_b64 v[132:133], 0
    v_mov_b64 v[134:135], 0
    v_mov_b64 v[136:137], 0
    v_mov_b64 v[138:139], 0
    v_mov_b64 v[140:141], 0
    v_mov_b64 v[142:143], 0
    v_mov_b64 v[144:145], 0
    v_mov_b64 v[146:147], 0
    s_mov_b32 s52, 3
    s_cmp_lg_u32 s30, 0
    s_cbranch_scc1 K_WARMM0
    s_call_b64 s[38:39], WP_attd
    s_call_b64 s[38:39], WP_p2g
    s_branch K_WARMMX
K_WARMM0:
    s_cmp_lg_u32 s30, 1
    s_cbranch_scc1 K_WARMM1
    s_call_b64 s[38:39], WP_atts
    s_call_b64 s[38:39], WP_early
    s_branch K_WARMMX
K_WARMM1:
    s_cmp_lg_u32 s30, 2
    s_cbranch_scc1 K_WARMM2
    s_call_b64 s[38:39], WP_help
    s_call_b64 s[38:39], WP_flags
    s_branch K_WARMMX
K_WARMM2:
    s_call_b64 s[38:39], WP_spin
K_WARMMX:
    s_barrier
    ds_read_b128 v[148:151], v40 offset:49152
    ds_read_b64_tr_b16 v[172:173], v42 offset:32768
    ds_read_b64_tr_b16 v[174:175], v42 offset:33792
    ds_read_b128 v[152:155], v40 offset:51200
    ds_read_b128 v[156:159], v40 offset:53248
    ds_read_b64_tr_b16 v[176:177], v43 offset:32768
    ds_read_b64_tr_b16 v[178:179], v43 offset:33792
    ds_read_b64_tr_b16 v[180:181], v44 offset:32768
    ds_read_b64_tr_b16 v[182:183], v44 offset:33792
    ds_read_b64_tr_b16 v[184:185], v45 offset:32768
    ds_read_b64_tr_b16 v[186:187], v45 offset:33792
    ds_read_b64_tr_b16 v[188:189], v46 offset:32768
    ds_read_b64_tr_b16 v[190:191], v46 offset:33792
    ds_read_b64_tr_b16 v[192:193], v47 offset:32768
    ds_read_b64_tr_b16 v[194:195], v47 offset:33792
    ds_read_b64_tr_b16 v[196:197], v48 offset:32768
    ds_read_b64_tr_b16 v[198:199], v48 offset:33792
    ds_read_b64_tr_b16 v[200:201], v49 offset:32768
    ds_read_b64_tr_b16 v[202:203], v49 offset:33792
K_CLOOP:
    s_waitcnt lgkmcnt(0)
    v_mfma_f32_16x16x32_bf16 v[52:55], v[172:175], v[148:151], v[52:55]
    ds_read_b128 v[160:163], v41 offset:49152
    v_mfma_f32_16x16x32_bf16 v[56:59], v[176:179], v[148:151], v[56:59]
    ds_read_b64_tr_b16 v[204:205], v42 offset:40960
    v_mfma_f32_16x16x32_bf16 v[60:63], v[180:183], v[148:151], v[60:63]
    ds_read_b64_tr_b16 v[206:207], v42 offset:41984
    v_mfma_f32_16x16x32_bf16 v[64:67], v[184:187], v[148:151], v[64:67]
    ds_read_b128 v[164:167], v41 offset:51200
    v_mfma_f32_16x16x32_bf16 v[68:71], v[188:191], v[148:151], v[68:71]
    ds_read_b128 v[168:171], v41 offset:53248
    v_mfma_f32_16x16x32_bf16 v[72:75], v[192:195], v[148:151], v[72:75]
    ds_read_b64_tr_b16 v[208:209], v43 offset:40960
    v_mfma_f32_16x16x32_bf16 v[76:79], v[148:151], v[196:199], v[76:79]
    ds_read_b64_tr_b16 v[210:211], v43 offset:41984
    v_mfma_f32_16x16x32_bf16 v[80:83], v[148:151], v[200:203], v[80:83]
    ds_read_b64_tr_b16 v[212:213], v44 offset:40960
    v_mfma_f32_16x16x32_bf16 v[112:115], v[152:155], v[200:203], v[112:115]
    ds_read_b64_tr_b16 v[214:215], v44 offset:41984
    v_mfma_f32_16x16x32_bf16 v[108:111], v[152:155], v[196:199], v[108:111]
    ds_read_b64_tr_b16 v[216:217], v45 offset:40960
    v_mfma_f32_16x16x32_bf16 v[104:107], v[192:195], v[152:155], v[104:107]
    ds_read_b64_tr_b16 v[218:219], v45 offset:41984
    v_mfma_f32_16x16x32_bf16 v[100:103], v[188:191], v[152:155], v[100:103]
    ds_read_b64_tr_b16 v[220:221], v46 offset:40960
    v_mfma_f32_16x16x32_bf16 v[96:99], v[184:187], v[152:155], v[96:99]
    ds_read_b64_tr_b16 v[222:223], v46 offset:41984
    v_mfma_f32_16x16x32_bf16 v[92:95], v[180:183], v[152:155], v[92:95]
    ds_read_b64_tr_b16 v[224:225], v47 offset:40960
    v_mfma_f32_16x16x32_bf16 v[88:91], v[176:179], v[152:155], v[88:91]
    ds_read_b64_tr_b16 v[226:227], v47 offset:41984
    v_mfma_f32_16x16x32_bf16 v[84:87], v[172:175], v[152:155], v[84:87]
    ds_read_b64_tr_b16 v[228:229], v48 offset:40960
    v_mfma_f32_16x16x32_bf16 v[116:119], v[172:175], v[156:159], v[116:119]
    ds_read_b64_tr_b16 v[230:231], v48 offset:41984
    v_mfma_f32_16x16x32_bf16 v[120:123], v[176:179], v[156:159], v[120:123]
    ds_read_b64_tr_b16 v[232:233], v49 offset:40960
    v_mfma_f32_16x16x32_bf16 v[124:127], v[180:183], v[156:159], v[124:127]
    ds_read_b64_tr_b16 v[234:235], v49 offset:41984
    v_mfma_f32_16x16x32_bf16 v[128:131], v[184:187], v[156:159], v[128:131]
    v_mfma_f32_16x16x32_bf16 v[132:135], v[188:191], v[156:159], v[132:135]
    v_mfma_f32_16x16x32_bf16 v[136:139], v[192:195], v[156:159], v[136:139]
    v_mfma_f32_16x16x32_bf16 v[140:143], v[156:159], v[196:199], v[140:143]
    v_mfma_f32_16x16x32_bf16 v[144:147], v[156:159], v[200:203], v[144:147]
    s_waitcnt lgkmcnt(0)
    s_barrier
    v_mfma_f32_16x16x32_bf16 v[52:55], v[204:207], v[160:163], v[52:55]
    ds_read_b128 v[148:151], v40 offset:0
    v_mfma_f32_16x16x32_bf16 v[56:59], v[208:211], v[160:163], v[56:59]
    ds_read_b64_tr_b16 v[172:173], v42 offset:0
    v_mfma_f32_16x16x32_bf16 v[60:63], v[212:215], v[160:163], v[60:63]
    ds_read_b64_tr_b16 v[174:175], v42 offset:1024
    v_mfma_f32_16x16x32_bf16 v[64:67], v[216:219], v[160:163], v[64:67]
    ds_read_b128 v[152:155], v40 offset:2048
    v_mfma_f32_16x16x32_bf16 v[68:71], v[220:223], v[160:163], v[68:71]
    ds_read_b128 v[156:159], v40 offset:4096
    v_mfma_f32_16x16x32_bf16 v[72:75], v[224:227], v[160:163], v[72:75]
    ds_read_b64_tr_b16 v[176:177], v43 offset:0
    v_mfma_f32_16x16x32_bf16 v[76:79], v[160:163], v[228:231], v[76:79]
    ds_read_b64_tr_b16 v[178:179], v43 offset:1024
    v_mfma_f32_16x16x32_bf16 v[80:83], v[160:163], v[232:235], v[80:83]
    ds_read_b64_tr_b16 v[180:181], v44 offset:0
    v_mfma_f32_16x16x32_bf16 v[112:115], v[164:167], v[232:235], v[112:115]
    ds_read_b64_tr_b16 v[182:183], v44 offset:1024
    v_mfma_f32_16x16x32_bf16 v[108:111], v[164:167], v[228:231], v[108:111]
    ds_read_b64_tr_b16 v[184:185], v45 offset:0
    v_mfma_f32_16x16x32_bf16 v[104:107], v[224:227], v[164:167], v[104:107]
    ds_read_b64_tr_b16 v[186:187], v45 offset:1024
    v_mfma_f32_16x16x32_bf16 v[100:103], v[220:223], v[164:167], v[100:103]
    ds_read_b64_tr_b16 v[188:189], v46 offset:0
    v_mfma_f32_16x16x32_bf16 v[96:99], v[216:219], v[164:167], v[96:99]
    ds_read_b64_tr_b16 v[190:191], v46 offset:1024
    v_mfma_f32_16x16x32_bf16 v[92:95], v[212:215], v[164:167], v[92:95]
    ds_read_b64_tr_b16 v[192:193], v47 offset:0
    v_mfma_f32_16x16x32_bf16 v[88:91], v[208:211], v[164:167], v[88:91]
    ds_read_b64_tr_b16 v[194:195], v47 offset:1024
    v_mfma_f32_16x16x32_bf16 v[84:87], v[204:207], v[164:167], v[84:87]
    ds_read_b64_tr_b16 v[196:197], v48 offset:0
    v_mfma_f32_16x16x32_bf16 v[116:119], v[204:207], v[168:171], v[116:119]
    ds_read_b64_tr_b16 v[198:199], v48 offset:1024
    v_mfma_f32_16x16x32_bf16 v[120:123], v[208:211], v[168:171], v[120:123]
    ds_read_b64_tr_b16 v[200:201], v49 offset:0
    v_mfma_f32_16x16x32_bf16 v[124:127], v[212:215], v[168:171], v[124:127]
    ds_read_b64_tr_b16 v[202:203], v49 offset:1024
    v_mfma_f32_16x16x32_bf16 v[128:131], v[216:219], v[168:171], v[128:131]
    v_mfma_f32_16x16x32_bf16 v[132:135], v[220:223], v[168:171], v[132:135]
    v_mfma_f32_16x16x32_bf16 v[136:139], v[224:227], v[168:171], v[136:139]
    v_mfma_f32_16x16x32_bf16 v[140:143], v[168:171], v[228:231], v[140:143]
    v_mfma_f32_16x16x32_bf16 v[144:147], v[168:171], v[232:235], v[144:147]
    s_waitcnt lgkmcnt(0)
    v_mfma_f32_16x16x32_bf16 v[52:55], v[172:175], v[148:151], v[52:55]
    ds_read_b128 v[160:163], v41 offset:0
    v_mfma_f32_16x16x32_bf16 v[56:59], v[176:179], v[148:151], v[56:59]
    ds_read_b64_tr_b16 v[204:205], v42 offset:8192
    v_mfma_f32_16x16x32_bf16 v[60:63], v[180:183], v[148:151], v[60:63]
    ds_read_b64_tr_b16 v[206:207], v42 offset:9216
    v_mfma_f32_16x16x32_bf16 v[64:67], v[184:187], v[148:151], v[64:67]
    ds_read_b128 v[164:167], v41 offset:2048
    v_mfma_f32_16x16x32_bf16 v[68:71], v[188:191], v[148:151], v[68:71]
    ds_read_b128 v[168:171], v41 offset:4096
    v_mfma_f32_16x16x32_bf16 v[72:75], v[192:195], v[148:151], v[72:75]
    ds_read_b64_tr_b16 v[208:209], v43 offset:8192
    v_mfma_f32_16x16x32_bf16 v[76:79], v[148:151], v[196:199], v[76:79]
    ds_read_b64_tr_b16 v[210:211], v43 offset:9216
    v_mfma_f32_16x16x32_bf16 v[80:83], v[148:151], v[200:203], v[80:83]
    ds_read_b64_tr_b16 v[212:213], v44 offset:8192
    v_mfma_f32_16x16x32_bf16 v[112:115], v[152:155], v[200:203], v[112:115]
    ds_read_b64_tr_b16 v[214:215], v44 offset:9216
    v_mfma_f32_16x16x32_bf16 v[108:111], v[152:155], v[196:199], v[108:111]
    ds_read_b64_tr_b16 v[216:217], v45 offset:8192
    v_mfma_f32_16x16x32_bf16 v[104:107], v[192:195], v[152:155], v[104:107]
    ds_read_b64_tr_b16 v[218:219], v45 offset:9216
    v_mfma_f32_16x16x32_bf16 v[100:103], v[188:191], v[152:155], v[100:103]
    ds_read_b64_tr_b16 v[220:221], v46 offset:8192
    v_mfma_f32_16x16x32_bf16 v[96:99], v[184:187], v[152:155], v[96:99]
    ds_read_b64_tr_b16 v[222:223], v46 offset:9216
    v_mfma_f32_16x16x32_bf16 v[92:95], v[180:183], v[152:155], v[92:95]
    ds_read_b64_tr_b16 v[224:225], v47 offset:8192
    v_mfma_f32_16x16x32_bf16 v[88:91], v[176:179], v[152:155], v[88:91]
    ds_read_b64_tr_b16 v[226:227], v47 offset:9216
    v_mfma_f32_16x16x32_bf16 v[84:87], v[172:175], v[152:155], v[84:87]
    ds_read_b64_tr_b16 v[228:229], v48 offset:8192
    v_mfma_f32_16x16x32_bf16 v[116:119], v[172:175], v[156:159], v[116:119]
    ds_read_b64_tr_b16 v[230:231], v48 offset:9216
    v_mfma_f32_16x16x32_bf16 v[120:123], v[176:179], v[156:159], v[120:123]
    ds_read_b64_tr_b16 v[232:233], v49 offset:8192
    v_mfma_f32_16x16x32_bf16 v[124:127], v[180:183], v[156:159], v[124:127]
    ds_read_b64_tr_b16 v[234:235], v49 offset:9216
    v_mfma_f32_16x16x32_bf16 v[128:131], v[184:187], v[156:159], v[128:131]
    v_mfma_f32_16x16x32_bf16 v[132:135], v[188:191], v[156:159], v[132:135]
    v_mfma_f32_16x16x32_bf16 v[136:139], v[192:195], v[156:159], v[136:139]
    v_mfma_f32_16x16x32_bf16 v[140:143], v[156:159], v[196:199], v[140:143]
    v_mfma_f32_16x16x32_bf16 v[144:147], v[156:159], v[200:203], v[144:147]
    s_waitcnt lgkmcnt(0)
    s_barrier
    v_mfma_f32_16x16x32_bf16 v[52:55], v[204:207], v[160:163], v[52:55]
    ds_read_b128 v[148:151], v40 offset:24576
    v_mfma_f32_16x16x32_bf16 v[56:59], v[208:211], v[160:163], v[56:59]
    ds_read_b64_tr_b16 v[172:173], v42 offset:16384
    v_mfma_f32_16x16x32_bf16 v[60:63], v[212:215], v[160:163], v[60:63]
    ds_read_b64_tr_b16 v[174:175], v42 offset:17408
    v_mfma_f32_16x16x32_bf16 v[64:67], v[216:219], v[160:163], v[64:67]
    ds_read_b128 v[152:155], v40 offset:26624
    v_mfma_f32_16x16x32_bf16 v[68:71], v[220:223], v[160:163], v[68:71]
    ds_read_b128 v[156:159], v40 offset:28672
    v_mfma_f32_16x16x32_bf16 v[72:75], v[224:227], v[160:163], v[72:75]
    ds_read_b64_tr_b16 v[176:177], v43 offset:16384
    v_mfma_f32_16x16x32_bf16 v[76:79], v[160:163], v[228:231], v[76:79]
    ds_read_b64_tr_b16 v[178:179], v43 offset:17408
    v_mfma_f32_16x16x32_bf16 v[80:83], v[160:163], v[232:235], v[80:83]
    ds_read_b64_tr_b16 v[180:181], v44 offset:16384
    v_mfma_f32_16x16x32_bf16 v[112:115], v[164:167], v[232:235], v[112:115]
    ds_read_b64_tr_b16 v[182:183], v44 offset:17408
    v_mfma_f32_16x16x32_bf16 v[108:111], v[164:167], v[228:231], v[108:111]
    ds_read_b64_tr_b16 v[184:185], v45 offset:16384
    v_mfma_f32_16x16x32_bf16 v[104:107], v[224:227], v[164:167], v[104:107]
    ds_read_b64_tr_b16 v[186:187], v45 offset:17408
    v_mfma_f32_16x16x32_bf16 v[100:103], v[220:223], v[164:167], v[100:103]
    ds_read_b64_tr_b16 v[188:189], v46 offset:16384
    v_mfma_f32_16x16x32_bf16 v[96:99], v[216:219], v[164:167], v[96:99]
    ds_read_b64_tr_b16 v[190:191], v46 offset:17408
    v_mfma_f32_16x16x32_bf16 v[92:95], v[212:215], v[164:167], v[92:95]
    ds_read_b64_tr_b16 v[192:193], v47 offset:16384
    v_mfma_f32_16x16x32_bf16 v[88:91], v[208:211], v[164:167], v[88:91]
    ds_read_b64_tr_b16 v[194:195], v47 offset:17408
    v_mfma_f32_16x16x32_bf16 v[84:87], v[204:207], v[164:167], v[84:87]
    ds_read_b64_tr_b16 v[196:197], v48 offset:16384
    v_mfma_f32_16x16x32_bf16 v[116:119], v[204:207], v[168:171], v[116:119]
    ds_read_b64_tr_b16 v[198:199], v48 offset:17408
    v_mfma_f32_16x16x32_bf16 v[120:123], v[208:211], v[168:171], v[120:123]
    ds_read_b64_tr_b16 v[200:201], v49 offset:16384
    v_mfma_f32_16x16x32_bf16 v[124:127], v[212:215], v[168:171], v[124:127]
    ds_read_b64_tr_b16 v[202:203], v49 offset:17408
    v_mfma_f32_16x16x32_bf16 v[128:131], v[216:219], v[168:171], v[128:131]
    v_mfma_f32_16x16x32_bf16 v[132:135], v[220:223], v[168:171], v[132:135]
    v_mfma_f32_16x16x32_bf16 v[136:139], v[224:227], v[168:171], v[136:139]
    v_mfma_f32_16x16x32_bf16 v[140:143], v[168:171], v[228:231], v[140:143]
    v_mfma_f32_16x16x32_bf16 v[144:147], v[168:171], v[232:235], v[144:147]
    s_waitcnt lgkmcnt(0)
    v_mfma_f32_16x16x32_bf16 v[52:55], v[172:175], v[148:151], v[52:55]
    ds_read_b128 v[160:163], v41 offset:24576
    v_mfma_f32_16x16x32_bf16 v[56:59], v[176:179], v[148:151], v[56:59]
    ds_read_b64_tr_b16 v[204:205], v42 offset:24576
    v_mfma_f32_16x16x32_bf16 v[60:63], v[180:183], v[148:151], v[60:63]
    ds_read_b64_tr_b16 v[206:207], v42 offset:25600
    v_mfma_f32_16x16x32_bf16 v[64:67], v[184:187], v[148:151], v[64:67]
    ds_read_b128 v[164:167], v41 offset:26624
    v_mfma_f32_16x16x32_bf16 v[68:71], v[188:191], v[148:151], v[68:71]
    ds_read_b128 v[168:171], v41 offset:28672
    v_mfma_f32_16x16x32_bf16 v[72:75], v[192:195], v[148:151], v[72:75]
    ds_read_b64_tr_b16 v[208:209], v43 offset:24576
    v_mfma_f32_16x16x32_bf16 v[76:79], v[148:151], v[196:199], v[76:79]
    ds_read_b64_tr_b16 v[210:211], v43 offset:25600
    v_mfma_f32_16x16x32_bf16 v[80:83], v[148:151], v[200:203], v[80:83]
    ds_read_b64_tr_b16 v[212:213], v44 offset:24576
    v_mfma_f32_16x16x32_bf16 v[112:115], v[152:155], v[200:203], v[112:115]
    ds_read_b64_tr_b16 v[214:215], v44 offset:25600
    v_mfma_f32_16x16x32_bf16 v[108:111], v[152:155], v[196:199], v[108:111]
    ds_read_b64_tr_b16 v[216:217], v45 offset:24576
    v_mfma_f32_16x16x32_bf16 v[104:107], v[192:195], v[152:155], v[104:107]
    ds_read_b64_tr_b16 v[218:219], v45 offset:25600
    v_mfma_f32_16x16x32_bf16 v[100:103], v[188:191], v[152:155], v[100:103]
    ds_read_b64_tr_b16 v[220:221], v46 offset:24576
    v_mfma_f32_16x16x32_bf16 v[96:99], v[184:187], v[152:155], v[96:99]
    ds_read_b64_tr_b16 v[222:223], v46 offset:25600
    v_mfma_f32_16x16x32_bf16 v[92:95], v[180:183], v[152:155], v[92:95]
    ds_read_b64_tr_b16 v[224:225], v47 offset:24576
    v_mfma_f32_16x16x32_bf16 v[88:91], v[176:179], v[152:155], v[88:91]
    ds_read_b64_tr_b16 v[226:227], v47 offset:25600
    v_mfma_f32_16x16x32_bf16 v[84:87], v[172:175], v[152:155], v[84:87]
    ds_read_b64_tr_b16 v[228:229], v48 offset:24576
    v_mfma_f32_16x16x32_bf16 v[116:119], v[172:175], v[156:159], v[116:119]
    ds_read_b64_tr_b16 v[230:231], v48 offset:25600
    v_mfma_f32_16x16x32_bf16 v[120:123], v[176:179], v[156:159], v[120:123]
    ds_read_b64_tr_b16 v[232:233], v49 offset:24576
    v_mfma_f32_16x16x32_bf16 v[124:127], v[180:183], v[156:159], v[124:127]
    ds_read_b64_tr_b16 v[234:235], v49 offset:25600
    v_mfma_f32_16x16x32_bf16 v[128:131], v[184:187], v[156:159], v[128:131]
    v_mfma_f32_16x16x32_bf16 v[132:135], v[188:191], v[156:159], v[132:135]
    v_mfma_f32_16x16x32_bf16 v[136:139], v[192:195], v[156:159], v[136:139]
    v_mfma_f32_16x16x32_bf16 v[140:143], v[156:159], v[196:199], v[140:143]
    v_mfma_f32_16x16x32_bf16 v[144:147], v[156:159], v[200:203], v[144:147]
    s_waitcnt lgkmcnt(0)
    s_barrier
    v_mfma_f32_16x16x32_bf16 v[52:55], v[204:207], v[160:163], v[52:55]
    ds_read_b128 v[148:151], v40 offset:49152
    v_mfma_f32_16x16x32_bf16 v[56:59], v[208:211], v[160:163], v[56:59]
    ds_read_b64_tr_b16 v[172:173], v42 offset:32768
    v_mfma_f32_16x16x32_bf16 v[60:63], v[212:215], v[160:163], v[60:63]
    ds_read_b64_tr_b16 v[174:175], v42 offset:33792
    v_mfma_f32_16x16x32_bf16 v[64:67], v[216:219], v[160:163], v[64:67]
    ds_read_b128 v[152:155], v40 offset:51200
    v_mfma_f32_16x16x32_bf16 v[68:71], v[220:223], v[160:163], v[68:71]
    ds_read_b128 v[156:159], v40 offset:53248
    v_mfma_f32_16x16x32_bf16 v[72:75], v[224:227], v[160:163], v[72:75]
    ds_read_b64_tr_b16 v[176:177], v43 offset:32768
    v_mfma_f32_16x16x32_bf16 v[76:79], v[160:163], v[228:231], v[76:79]
    ds_read_b64_tr_b16 v[178:179], v43 offset:33792
    v_mfma_f32_16x16x32_bf16 v[80:83], v[160:163], v[232:235], v[80:83]
    ds_read_b64_tr_b16 v[180:181], v44 offset:32768
    v_mfma_f32_16x16x32_bf16 v[112:115], v[164:167], v[232:235], v[112:115]
    ds_read_b64_tr_b16 v[182:183], v44 offset:33792
    v_mfma_f32_16x16x32_bf16 v[108:111], v[164:167], v[228:231], v[108:111]
    ds_read_b64_tr_b16 v[184:185], v45 offset:32768
    v_mfma_f32_16x16x32_bf16 v[104:107], v[224:227], v[164:167], v[104:107]
    ds_read_b64_tr_b16 v[186:187], v45 offset:33792
    v_mfma_f32_16x16x32_bf16 v[100:103], v[220:223], v[164:167], v[100:103]
    ds_read_b64_tr_b16 v[188:189], v46 offset:32768
    v_mfma_f32_16x16x32_bf16 v[96:99], v[216:219], v[164:167], v[96:99]
    ds_read_b64_tr_b16 v[190:191], v46 offset:33792
    v_mfma_f32_16x16x32_bf16 v[92:95], v[212:215], v[164:167], v[92:95]
    ds_read_b64_tr_b16 v[192:193], v47 offset:32768
    v_mfma_f32_16x16x32_bf16 v[88:91], v[208:211], v[164:167], v[88:91]
    ds_read_b64_tr_b16 v[194:195], v47 offset:33792
    v_mfma_f32_16x16x32_bf16 v[84:87], v[204:207], v[164:167], v[84:87]
    ds_read_b64_tr_b16 v[196:197], v48 offset:32768
    v_mfma_f32_16x16x32_bf16 v[116:119], v[204:207], v[168:171], v[116:119]
    ds_read_b64_tr_b16 v[198:199], v48 offset:33792
    v_mfma_f32_16x16x32_bf16 v[120:123], v[208:211], v[168:171], v[120:123]
    ds_read_b64_tr_b16 v[200:201], v49 offset:32768
    v_mfma_f32_16x16x32_bf16 v[124:127], v[212:215], v[168:171], v[124:127]
    ds_read_b64_tr_b16 v[202:203], v49 offset:33792
    v_mfma_f32_16x16x32_bf16 v[128:131], v[216:219], v[168:171], v[128:131]
    s_sub_u32 s52, s52, 1
    v_mfma_f32_16x16x32_bf16 v[132:135], v[220:223], v[168:171], v[132:135]
    s_cmp_lg_u32 s52, 0
    v_mfma_f32_16x16x32_bf16 v[136:139], v[224:227], v[168:171], v[136:139]
    v_mfma_f32_16x16x32_bf16 v[140:143], v[168:171], v[228:231], v[140:143]
    v_mfma_f32_16x16x32_bf16 v[144:147], v[168:171], v[232:235], v[144:147]
    s_cbranch_scc1 K_CLOOP
    s_waitcnt lgkmcnt(0)
    v_mfma_f32_16x16x32_bf16 v[52:55], v[172:175], v[148:151], v[52:55]
    ds_read_b128 v[160:163], v41 offset:49152
    ds_read_b64_tr_b16 v[204:205], v42 offset:40960
    v_mfma_f32_16x16x32_bf16 v[116:119], v[172:175], v[156:159], v[116:119]
    ds_read_b64_tr_b16 v[206:207], v42 offset:41984
    ds_read_b128 v[164:167], v41 offset:51200
    v_mfma_f32_16x16x32_bf16 v[84:87], v[172:175], v[152:155], v[84:87]
    ds_read_b128 v[168:171], v41 offset:53248
    ds_read_b64_tr_b16 v[208:209], v43 offset:40960
    v_mfma_f32_16x16x32_bf16 v[56:59], v[176:179], v[148:151], v[56:59]
    ds_read_b64_tr_b16 v[210:211], v43 offset:41984
    ds_read_b64_tr_b16 v[212:213], v44 offset:40960
    v_mfma_f32_16x16x32_bf16 v[120:123], v[176:179], v[156:159], v[120:123]
    ds_read_b64_tr_b16 v[214:215], v44 offset:41984
    ds_read_b64_tr_b16 v[216:217], v45 offset:40960
    v_mfma_f32_16x16x32_bf16 v[88:91], v[176:179], v[152:155], v[88:91]
    ds_read_b64_tr_b16 v[218:219], v45 offset:41984
    ds_read_b64_tr_b16 v[220:221], v46 offset:40960
    v_mfma_f32_16x16x32_bf16 v[60:63], v[180:183], v[148:151], v[60:63]
    ds_read_b64_tr_b16 v[222:223], v46 offset:41984
    ds_read_b64_tr_b16 v[224:225], v47 offset:40960
    v_mfma_f32_16x16x32_bf16 v[124:127], v[180:183], v[156:159], v[124:127]
    ds_read_b64_tr_b16 v[226:227], v47 offset:41984
    ds_read_b64_tr_b16 v[228:229], v48 offset:40960
    v_mfma_f32_16x16x32_bf16 v[92:95], v[180:183], v[152:155], v[92:95]
    ds_read_b64_tr_b16 v[230:231], v48 offset:41984
    ds_read_b64_tr_b16 v[232:233], v49 offset:40960
    v_mfma_f32_16x16x32_bf16 v[64:67], v[184:187], v[148:151], v[64:67]
    ds_read_b64_tr_b16 v[234:235], v49 offset:41984
    v_mfma_f32_16x16x32_bf16 v[128:131], v[184:187], v[156:159], v[128:131]
    s_nop 1
    v_mfma_f32_16x16x32_bf16 v[96:99], v[184:187], v[152:155], v[96:99]
    s_nop 1
    s_waitcnt lgkmcnt(15)
    v_mfma_f32_16x16x32_bf16 v[52:55], v[204:207], v[160:163], v[52:55]
    s_nop 1
    s_waitcnt lgkmcnt(12)
    v_mfma_f32_16x16x32_bf16 v[56:59], v[208:211], v[160:163], v[56:59]
    s_nop 1
    v_mfma_f32_16x16x32_bf16 v[116:119], v[204:207], v[168:171], v[116:119]
    s_nop 1
    v_mfma_f32_16x16x32_bf16 v[120:123], v[208:211], v[168:171], v[120:123]
    s_nop 1
    v_mfma_f32_16x16x32_bf16 v[84:87], v[204:207], v[164:167], v[84:87]
    v_cvt_pk_bf16_f32 v52, v52, v53
    v_cvt_pk_bf16_f32 v53, v54, v55
    v_mfma_f32_16x16x32_bf16 v[88:91], v[208:211], v[164:167], v[88:91]
    v_cvt_pk_bf16_f32 v54, v56, v57
    v_cvt_pk_bf16_f32 v55, v58, v59
    s_waitcnt lgkmcnt(10)
    v_mfma_f32_16x16x32_bf16 v[60:63], v[212:215], v[160:163], v[60:63]
    ds_write_b128 v13, v[52:55] offset:0
    s_waitcnt lgkmcnt(9)
    v_mfma_f32_16x16x32_bf16 v[64:67], v[216:219], v[160:163], v[64:67]
    v_cvt_pk_bf16_f32 v116, v116, v117
    v_cvt_pk_bf16_f32 v117, v118, v119
    v_mfma_f32_16x16x32_bf16 v[124:127], v[212:215], v[168:171], v[124:127]
    v_cvt_pk_bf16_f32 v118, v120, v121
    v_cvt_pk_bf16_f32 v119, v122, v123
    v_mfma_f32_16x16x32_bf16 v[128:131], v[216:219], v[168:171], v[128:131]
    ds_write_b128 v13, v[116:119] offset:2048
    v_mfma_f32_16x16x32_bf16 v[92:95], v[212:215], v[164:167], v[92:95]
    v_cvt_pk_bf16_f32 v84, v84, v85
    v_cvt_pk_bf16_f32 v85, v86, v87
    v_mfma_f32_16x16x32_bf16 v[96:99], v[216:219], v[164:167], v[96:99]
    v_cvt_pk_bf16_f32 v86, v88, v89
    v_cvt_pk_bf16_f32 v87, v90, v91
    v_mfma_f32_16x16x32_bf16 v[68:71], v[188:191], v[148:151], v[68:71]
    ds_write_b128 v13, v[84:87] offset:1024
    v_mfma_f32_16x16x32_bf16 v[72:75], v[192:195], v[148:151], v[72:75]
    v_cvt_pk_bf16_f32 v60, v60, v61
    v_cvt_pk_bf16_f32 v61, v62, v63
    s_waitcnt lgkmcnt(9)
    v_mfma_f32_16x16x32_bf16 v[68:71], v[220:223], v[160:163], v[68:71]
    v_cvt_pk_bf16_f32 v64, v64, v65
    v_cvt_pk_bf16_f32 v65, v66, v67
    s_waitcnt lgkmcnt(7)
    v_mfma_f32_16x16x32_bf16 v[72:75], v[224:227], v[160:163], v[72:75]
    ds_write2st64_b64 v14, v[60:61], v[64:65] offset0:4 offset1:5
    v_mfma_f32_16x16x32_bf16 v[132:135], v[188:191], v[156:159], v[132:135]
    ds_read_b64 v[62:63], v13 offset:0
    ds_read_b64 v[66:67], v13 offset:0
    v_mfma_f32_16x16x32_bf16 v[136:139], v[192:195], v[156:159], v[136:139]
    v_cvt_pk_bf16_f32 v124, v124, v125
    v_cvt_pk_bf16_f32 v125, v126, v127
    v_mfma_f32_16x16x32_bf16 v[132:135], v[220:223], v[168:171], v[132:135]
    v_cvt_pk_bf16_f32 v128, v128, v129
    v_cvt_pk_bf16_f32 v129, v130, v131
    v_mfma_f32_16x16x32_bf16 v[136:139], v[224:227], v[168:171], v[136:139]
    ds_write2st64_b64 v14, v[124:125], v[128:129] offset0:10 offset1:11
    v_mfma_f32_16x16x32_bf16 v[100:103], v[188:191], v[152:155], v[100:103]
    ds_read_b64 v[126:127], v13 offset:2048
    ds_read_b64 v[130:131], v13 offset:2048
    v_mfma_f32_16x16x32_bf16 v[104:107], v[192:195], v[152:155], v[104:107]
    v_cvt_pk_bf16_f32 v92, v92, v93
    v_cvt_pk_bf16_f32 v93, v94, v95
    v_mfma_f32_16x16x32_bf16 v[100:103], v[220:223], v[164:167], v[100:103]
    v_cvt_pk_bf16_f32 v96, v96, v97
    v_cvt_pk_bf16_f32 v97, v98, v99
    v_mfma_f32_16x16x32_bf16 v[104:107], v[224:227], v[164:167], v[104:107]
    ds_read_b64 v[94:95], v13 offset:1024
    ds_read_b64 v[98:99], v13 offset:1024
    v_mfma_f32_16x16x32_bf16 v[76:79], v[148:151], v[196:199], v[76:79]
    v_cvt_pk_bf16_f32 v68, v68, v69
    v_cvt_pk_bf16_f32 v69, v70, v71
    v_mfma_f32_16x16x32_bf16 v[80:83], v[148:151], v[200:203], v[80:83]
    v_cvt_pk_bf16_f32 v72, v72, v73
    v_cvt_pk_bf16_f32 v73, v74, v75
    s_waitcnt lgkmcnt(13)
    v_mfma_f32_16x16x32_bf16 v[76:79], v[160:163], v[228:231], v[76:79]
    ds_write2st64_b64 v14, v[68:69], v[72:73] offset0:8 offset1:9
    s_waitcnt lgkmcnt(12)
    v_mfma_f32_16x16x32_bf16 v[80:83], v[160:163], v[232:235], v[80:83]
    ds_write_b32 v50, v4
    v_cvt_pk_bf16_f32 v132, v132, v133
    v_mfma_f32_16x16x32_bf16 v[140:143], v[156:159], v[196:199], v[140:143]
    v_cvt_pk_bf16_f32 v133, v134, v135
    v_cvt_pk_bf16_f32 v136, v136, v137
    v_mfma_f32_16x16x32_bf16 v[144:147], v[156:159], v[200:203], v[144:147]
    v_cvt_pk_bf16_f32 v137, v138, v139
    ds_read_b64 v[134:135], v18 offset:2048
    v_mfma_f32_16x16x32_bf16 v[140:143], v[168:171], v[228:231], v[140:143]
    ds_read_b64 v[138:139], v19 offset:2048
    v_cvt_pk_bf16_f32 v100, v100, v101
    v_mfma_f32_16x16x32_bf16 v[144:147], v[168:171], v[232:235], v[144:147]
    v_cvt_pk_bf16_f32 v101, v102, v103
    v_cvt_pk_bf16_f32 v104, v104, v105
    v_mfma_f32_16x16x32_bf16 v[108:111], v[152:155], v[196:199], v[108:111]
    v_cvt_pk_bf16_f32 v105, v106, v107
    ds_read_b64 v[102:103], v18 offset:1024
    v_mfma_f32_16x16x32_bf16 v[112:115], v[152:155], v[200:203], v[112:115]
    ds_read_b64 v[106:107], v19 offset:1024
    v_cvt_pk_bf16_f32 v236, v76, v77
    v_mfma_f32_16x16x32_bf16 v[108:111], v[164:167], v[228:231], v[108:111]
    v_cvt_pk_bf16_f32 v237, v78, v79
    v_cvt_pk_bf16_f32 v242, v80, v81
    v_mfma_f32_16x16x32_bf16 v[112:115], v[164:167], v[232:235], v[112:115]
    v_cvt_pk_bf16_f32 v243, v82, v83
    v_cvt_pk_bf16_f32 v240, v140, v141
    s_branch WS_attd
.p2align 12
WP_attd:
    s_setpc_b64 s[38:39]
WS_attd:
    s_waitcnt lgkmcnt(3)
    v_mfma_f32_16x16x32_bf16 v[208:211], v[124:127], v[132:135], v[28:31]
    ds_write2st64_b64 v14, v[236:237], v[242:243] offset0:6 offset1:7
    v_mfma_f32_16x16x32_bf16 v[204:207], v[92:95], v[132:135], v[24:27]
    v_cvt_pk_bf16_f32 v241, v142, v143
    v_cvt_pk_bf16_f32 v246, v144, v145
    s_waitcnt lgkmcnt(3)
    v_mfma_f32_16x16x32_bf16 v[216:219], v[128:131], v[136:139], v[28:31]
    v_cvt_pk_bf16_f32 v247, v146, v147
    ds_read_b64_tr_b16 v[188:189], v20 offset:0
    v_mfma_f32_16x16x32_bf16 v[212:215], v[96:99], v[136:139], v[24:27]
    ds_write2st64_b64 v14, v[240:241], v[246:247] offset0:12 offset1:13
    s_waitcnt lgkmcnt(4)
    v_mfma_f32_16x16x32_bf16 v[176:179], v[92:95], v[100:103], v[28:31]
    ds_write_b32 v50, v5
    v_max3_f32 v72, v204, v205, v208
    v_mfma_f32_16x16x32_bf16 v[172:175], v[60:63], v[100:103], v[32:35]
    v_max3_f32 v73, v206, v207, v210
    v_max_f32 v72, v72, v209
    s_waitcnt lgkmcnt(4)
    v_mfma_f32_16x16x32_bf16 v[184:187], v[96:99], v[104:107], v[28:31]
    v_max_f32 v73, v73, v211
    v_max3_f32 v74, v212, v213, v216
    v_mfma_f32_16x16x32_bf16 v[180:183], v[64:67], v[104:107], v[32:35]
    v_max3_f32 v75, v214, v215, v218
    v_max_f32 v74, v74, v217
    ds_read_b64_tr_b16 v[190:191], v20 offset:1024
    ds_read_b64_tr_b16 v[192:193], v21 offset:0
    ds_read_b64_tr_b16 v[194:195], v21 offset:1024
    ds_read_b64_tr_b16 v[220:221], v22 offset:1024
    ds_read_b64_tr_b16 v[222:223], v22 offset:2048
    ds_read_b64_tr_b16 v[224:225], v23 offset:1024
    ds_read_b64_tr_b16 v[226:227], v23 offset:2048
    v_max_f32 v75, v75, v219
    v_max3_f32 v68, v172, v173, v176
    v_max3_f32 v69, v174, v175, v178
    v_max_f32 v68, v68, v177
    v_max_f32 v69, v69, v179
    v_max3_f32 v70, v180, v181, v184
    v_max3_f32 v71, v182, v183, v186
    v_max_f32 v70, v70, v185
    v_max_f32 v71, v71, v187
    v_permlane16_swap_b32 v72, v74
    v_permlane16_swap_b32 v73, v75
    v_permlane16_swap_b32 v68, v70
    v_permlane16_swap_b32 v69, v71
    v_cvt_pk_bf16_f32 v238, v108, v109
    v_permlane32_swap_b32 v68, v72
    v_permlane32_swap_b32 v70, v74
    v_permlane32_swap_b32 v69, v73
    v_permlane32_swap_b32 v71, v75
    v_max3_f32 v120, v68, v69, v72
    v_max3_f32 v121, v73, v70, v71
    v_max3_f32 v120, v120, v74, v75
    v_max_f32 v120, v120, v121
    v_mul_f32 v120, s46, v120
    v_pk_fma_f32 v[68:69], v[68:69], s[46:47], v[120:121] op_sel_hi:[1,1,0] neg_lo:[0,0,1] neg_hi:[0,0,1]
    v_pk_fma_f32 v[70:71], v[70:71], s[46:47], v[120:121] op_sel_hi:[1,1,0] neg_lo:[0,0,1] neg_hi:[0,0,1]
    v_pk_fma_f32 v[72:73], v[72:73], s[46:47], v[120:121] op_sel_hi:[1,1,0] neg_lo:[0,0,1] neg_hi:[0,0,1]
    v_pk_fma_f32 v[74:75], v[74:75], s[46:47], v[120:121] op_sel_hi:[1,1,0] neg_lo:[0,0,1] neg_hi:[0,0,1]
    v_exp_f32 v68, v68
    v_exp_f32 v69, v69
    v_exp_f32 v70, v70
    v_exp_f32 v71, v71
    v_exp_f32 v72, v72
    v_exp_f32 v73, v73
    v_exp_f32 v74, v74
    v_exp_f32 v75, v75
    v_pk_add_f32 v[56:57], v[68:69], v[70:71]
    v_pk_add_f32 v[58:59], v[72:73], v[74:75]
    v_pk_add_f32 v[56:57], v[56:57], v[58:59]
    v_add_f32 v56, v56, v57
    v_rcp_f32 v56, v56
    s_waitcnt lgkmcnt(0)
    v_pk_mul_f32 v[68:69], v[68:69], v[56:57] op_sel_hi:[1,0]
    v_pk_mul_f32 v[70:71], v[70:71], v[56:57] op_sel_hi:[1,0]
    v_pk_mul_f32 v[72:73], v[72:73], v[56:57] op_sel_hi:[1,0]
    v_pk_mul_f32 v[74:75], v[74:75], v[56:57] op_sel_hi:[1,0]
    v_cvt_pk_bf16_f32 v88, v68, v69
    v_cvt_pk_bf16_f32 v90, v72, v73
    v_cvt_pk_bf16_f32 v89, v70, v71
    v_cvt_pk_bf16_f32 v91, v74, v75
    v_permlane32_swap_b32 v88, v90
    v_cvt_pk_bf16_f32 v239, v110, v111
    v_permlane32_swap_b32 v89, v91
    v_cvt_pk_bf16_f32 v244, v112, v113
    v_cvt_pk_bf16_f32 v245, v114, v115
    v_permlane16_swap_b32 v88, v89
    v_permlane16_swap_b32 v90, v91
    v_perm_b32 v148, v88, v88, v36
    v_perm_b32 v149, v88, v88, v37
    v_perm_b32 v150, v88, v88, v38
    v_perm_b32 v151, v88, v88, v39
    v_perm_b32 v152, v89, v89, v36
    v_perm_b32 v153, v89, v89, v37
    v_mfma_f32_16x16x32_bf16 v[100:103], v[236:239], v[148:151], 0
    v_perm_b32 v154, v89, v89, v38
    v_perm_b32 v155, v89, v89, v39
    v_mfma_f32_16x16x32_bf16 v[156:159], v[188:191], v[148:151], 0
    v_perm_b32 v160, v90, v90, v36
    v_perm_b32 v161, v90, v90, v37
    v_mfma_f32_16x16x32_bf16 v[104:107], v[242:245], v[152:155], 0
    v_perm_b32 v162, v90, v90, v38
    v_perm_b32 v163, v90, v90, v39
    v_mfma_f32_16x16x32_bf16 v[156:159], v[192:195], v[152:155], v[156:159]
    v_perm_b32 v164, v91, v91, v36
    v_perm_b32 v165, v91, v91, v37
    v_mfma_f32_16x16x32_bf16 v[132:135], v[238:241], v[160:163], 0
    v_perm_b32 v166, v91, v91, v38
    v_perm_b32 v167, v91, v91, v39
    v_mfma_f32_16x16x32_bf16 v[156:159], v[220:223], v[160:163], v[156:159]
    v_cvt_pk_bf16_f32 v60, v100, v101
    v_cvt_pk_bf16_f32 v61, v102, v103
    v_mfma_f32_16x16x32_bf16 v[156:159], v[224:227], v[164:167], v[156:159]
    v_cvt_pk_bf16_f32 v62, v104, v105
    v_cvt_pk_bf16_f32 v63, v106, v107
    v_mfma_f32_16x16x32_bf16 v[136:139], v[244:247], v[164:167], 0
    buffer_store_dwordx4 v[60:63], v15, s[20:23], s50 offen sc1
    v_cvt_pk_bf16_f32 v64, v132, v133
    v_cvt_pk_bf16_f32 v65, v134, v135
    s_nop 1
    v_cvt_pk_bf16_f32 v56, v156, v157
    v_cvt_pk_bf16_f32 v57, v158, v159
    v_cvt_pk_bf16_f32 v58, v156, v157
    v_cvt_pk_bf16_f32 v59, v158, v159
    v_cvt_pk_bf16_f32 v66, v136, v137
    v_cvt_pk_bf16_f32 v67, v138, v139
    v_permlane16_swap_b32 v56, v58
    v_permlane16_swap_b32 v57, v59
    buffer_store_dwordx4 v[64:67], v15, s[20:23], s51 offen sc1
    buffer_store_dwordx4 v[56:59], v16, s[20:23], s50 offen sc1
    s_cmp_lg_u32 s34, -1
    s_cbranch_scc1 K_P2_EARLY
K_DRAIN:
    s_waitcnt vmcnt(0)
    s_barrier
    s_branch K_END
K_W7A:
    s_waitcnt vmcnt(0)
    v_and_b32 v4, 7, v1
    v_lshlrev_b32 v4, 2, v4
    s_mov_b32 s3, 131072
K_ZPOLL5:
    v_cmp_eq_u32 vcc, 0, v7
    s_cbranch_vccz K_ZOK5
    s_sub_u32 s3, s3, 1
    s_cbranch_scc1 K_ZOK5
    global_load_dword v7, v4, s[8:9] offset:192 sc1
    s_waitcnt vmcnt(0)
    s_branch K_ZPOLL5
K_ZOK5:
    v_mov_b32 v4, 158720
    v_mov_b32 v3, 1
    s_mov_b64 exec, 1
    s_nop 0
    ds_add_rtn_u32 v2, v4, v3 offset:48
    s_mov_b32 exec_lo, s36
    v_mov_b32 v3, 1
    s_waitcnt lgkmcnt(0)
    v_readfirstlane_b32 s33, v2
    s_nop 3
    s_and_b32 s33, s33, 0xff
    s_cmp_lg_u32 s33, 7
    s_cbranch_scc1 K_ARR7
    global_store_dword v8, v3, s[10:11] sc1
K_ARR7:
    s_mov_b64 exec, -1
    v_mov_b32 v6, 158800
    s_mov_b32 s3, 1048576
K_XG7:
    ds_read_b128 v[2:5], v6
    s_sleep 1
    s_sub_u32 s3, s3, 1
    s_waitcnt lgkmcnt(0)
    v_min3_u32 v2, v2, v4, v5
    v_min_u32 v2, v2, v3
    s_nop 0
    v_readfirstlane_b32 s33, v2
    s_nop 3
    s_cselect_b32 s33, 1, s33
    s_cmp_lt_u32 s33, 1
    s_cbranch_scc1 K_XG7
    v_mov_b32 v4, 158720
    s_branch K_WOE
K_W7:
    v_mov_b32 v3, 0x100
    s_mov_b64 exec, 1
    s_waitcnt vmcnt(0)
    ds_add_u32 v4, v3 offset:48
    s_mov_b64 exec, -1
    s_branch K_P2_HELP
K_FLAG:
    s_waitcnt vmcnt(0)
    v_and_b32 v4, 7, v1
    v_lshlrev_b32 v4, 2, v4
    s_mov_b32 s3, 131072
K_ZPOLL0:
    v_cmp_eq_u32 vcc, 0, v7
    s_cbranch_vccz K_ZOK0
    s_sub_u32 s3, s3, 1
    s_cbranch_scc1 K_ZOK0
    global_load_dword v7, v4, s[8:9] offset:192 sc1
    s_waitcnt vmcnt(0)
    s_branch K_ZPOLL0
K_ZOK0:
    v_mov_b32 v3, 1
    s_mov_b32 exec_lo, s36
    s_mov_b32 exec_hi, 0
    s_setprio 3
    s_barrier
    global_store_dword v8, v3, s[10:11] sc1
    s_mov_b64 exec, -1
    s_branch K_END
WP_atts:
    s_setpc_b64 s[38:39]
K_JOIN_S:
    s_setprio 0
    s_cmp_eq_u32 s30, 7
    s_cbranch_scc1 K_FLAG
    s_lshl_b32 s3, s30, 2
    s_add_u32 s3, s3, 158784
    v_mov_b32 v6, s3
    s_mov_b32 s3, 1048576
K_XG1:
    ds_read2_b32 v[2:3], v6 offset0:0 offset1:1
    s_sleep 1
    s_sub_u32 s3, s3, 1
    s_waitcnt lgkmcnt(0)
    v_min_u32 v2, v2, v3
    s_nop 0
    v_readfirstlane_b32 s33, v2
    s_nop 3
    s_cselect_b32 s33, 1, s33
    s_cmp_lt_u32 s33, 1
    s_cbranch_scc1 K_XG1
    ds_read_b64 v[40:41], v14 offset:4096
    ds_read_b64 v[42:43], v18 offset:1024
    ds_read_b64 v[48:49], v14 offset:0
    ds_read_b64 v[50:51], v13 offset:0
    ds_read_b64 v[52:53], v14 offset:2048
    ds_read_b64 v[54:55], v13 offset:1024
    ds_read_b64 v[44:45], v14 offset:4608
    ds_read_b64 v[46:47], v19 offset:1024
    ds_read_b64 v[56:57], v14 offset:512
    ds_read_b64 v[58:59], v13 offset:0
    ds_read_b64 v[60:61], v14 offset:2560
    ds_read_b64 v[62:63], v13 offset:1024
    s_waitcnt lgkmcnt(8)
    v_mfma_f32_16x16x32_bf16 v[80:83], v[48:51], v[40:43], v[24:27]
    s_waitcnt lgkmcnt(6)
    v_mfma_f32_16x16x32_bf16 v[84:87], v[52:55], v[40:43], v[28:31]
    s_waitcnt lgkmcnt(2)
    v_mfma_f32_16x16x32_bf16 v[88:91], v[56:59], v[44:47], v[24:27]
    s_waitcnt lgkmcnt(0)
    v_mfma_f32_16x16x32_bf16 v[92:95], v[60:63], v[44:47], v[28:31]
    ds_read_b64_tr_b16 v[72:73], v20 offset:0
    ds_read_b64_tr_b16 v[74:75], v20 offset:1024
    ds_read_b64_tr_b16 v[76:77], v21 offset:0
    ds_read_b64_tr_b16 v[78:79], v21 offset:1024
    v_max3_f32 v116, v80, v81, v84
    v_max3_f32 v117, v82, v83, v86
    v_max_f32 v116, v116, v85
    v_max_f32 v117, v117, v87
    v_max3_f32 v118, v88, v89, v92
    v_max3_f32 v119, v90, v91, v94
    v_max_f32 v118, v118, v93
    v_max_f32 v119, v119, v95
    s_nop 0
    v_permlane16_swap_b32 v116, v118
    v_permlane16_swap_b32 v117, v119
    v_max3_f32 v130, v116, v117, v118
    v_max_f32 v130, v130, v119
    v_mov_b32 v131, v130
    s_nop 1
    v_permlane32_swap_b32 v130, v131
    v_max_f32 v130, v130, v131
    v_mul_f32 v130, s46, v130
    v_pk_fma_f32 v[116:117], v[116:117], s[46:47], v[130:131] op_sel_hi:[1,1,0] neg_lo:[0,0,1] neg_hi:[0,0,1]
    v_pk_fma_f32 v[118:119], v[118:119], s[46:47], v[130:131] op_sel_hi:[1,1,0] neg_lo:[0,0,1] neg_hi:[0,0,1]
    v_exp_f32 v116, v116
    v_exp_f32 v117, v117
    v_exp_f32 v118, v118
    v_exp_f32 v119, v119
    s_nop 0
    v_pk_add_f32 v[120:121], v[116:117], v[118:119]
    v_add_f32 v120, v120, v121
    v_mov_b32 v121, v120
    s_nop 1
    v_permlane32_swap_b32 v120, v121
    v_add_f32 v120, v120, v121
    v_rcp_f32 v120, v120
    s_waitcnt lgkmcnt(0)
    v_pk_mul_f32 v[116:117], v[116:117], v[120:121] op_sel_hi:[1,0]
    v_pk_mul_f32 v[118:119], v[118:119], v[120:121] op_sel_hi:[1,0]
    v_cvt_pk_bf16_f32 v128, v116, v117
    v_cvt_pk_bf16_f32 v129, v118, v119
    s_nop 1
    v_permlane16_swap_b32 v128, v129
    s_mov_b32 s3, 1048576
K_XG2:
    ds_read2_b32 v[2:3], v6 offset0:0 offset1:1
    s_sleep 1
    s_sub_u32 s3, s3, 1
    s_waitcnt lgkmcnt(0)
    v_min_u32 v2, v2, v3
    s_nop 0
    v_readfirstlane_b32 s33, v2
    s_nop 3
    s_cselect_b32 s33, 2, s33
    s_cmp_lt_u32 s33, 2
    s_cbranch_scc1 K_XG2
    ds_read_b64 v[64:65], v14 offset:1024
    ds_read_b64 v[66:67], v14 offset:3072
    ds_read_b64 v[68:69], v14 offset:1536
    ds_read_b64 v[70:71], v14 offset:3584
    v_perm_b32 v96, v128, v128, v36
    v_perm_b32 v97, v128, v128, v37
    v_perm_b32 v98, v128, v128, v38
    v_perm_b32 v99, v128, v128, v39
    v_perm_b32 v100, v129, v129, v36
    v_perm_b32 v101, v129, v129, v37
    s_waitcnt lgkmcnt(2)
    v_mfma_f32_16x16x32_bf16 v[104:107], v[64:67], v[96:99], 0
    v_perm_b32 v102, v129, v129, v38
    v_perm_b32 v103, v129, v129, v39
    v_mfma_f32_16x16x32_bf16 v[112:115], v[72:75], v[96:99], 0
    s_nop 0
    v_mfma_f32_16x16x32_bf16 v[112:115], v[76:79], v[100:103], v[112:115]
    s_waitcnt lgkmcnt(0)
    v_mfma_f32_16x16x32_bf16 v[108:111], v[68:71], v[100:103], 0
    s_nop 0
    v_cvt_pk_bf16_f32 v124, v104, v105
    v_cvt_pk_bf16_f32 v125, v106, v107
    s_nop 2
    v_cvt_pk_bf16_f32 v120, v112, v113
    v_cvt_pk_bf16_f32 v121, v114, v115
    v_cvt_pk_bf16_f32 v122, v112, v113
    v_cvt_pk_bf16_f32 v123, v114, v115
    v_cvt_pk_bf16_f32 v126, v108, v109
    v_cvt_pk_bf16_f32 v127, v110, v111
    v_permlane16_swap_b32 v120, v122
    v_permlane16_swap_b32 v121, v123
    buffer_store_dwordx4 v[124:127], v15, s[20:23], s50 offen sc1
    buffer_store_dwordx4 v[120:123], v16, s[20:23], s50 offen sc1
    s_cmp_eq_u32 s34, -1
    s_cbranch_scc1 K_DRAIN
    s_cmp_lg_u32 s30, 6
    s_cbranch_scc1 K_NOFL
    s_waitcnt vmcnt(2)
    v_and_b32 v4, 7, v1
    v_lshlrev_b32 v4, 2, v4
    s_mov_b32 s3, 131072
K_ZPOLL2:
    v_cmp_eq_u32 vcc, 0, v7
    s_cbranch_vccz K_ZOK2
    s_sub_u32 s3, s3, 1
    s_cbranch_scc1 K_ZOK2
    global_load_dword v7, v4, s[8:9] offset:192 sc1
    s_waitcnt vmcnt(0)
    s_branch K_ZPOLL2
K_ZOK2:
    v_and_b32 v2, 1, v1
    v_lshl_add_u32 v2, v2, 2, s42
    global_load_dword v7, v2, s[10:11] offset:128 sc1
K_NOFL:
    v_mov_b32 v4, 158720
    v_mov_b32 v3, 257
    s_mov_b64 exec, 1
    s_waitcnt vmcnt(0)
    ds_add_rtn_u32 v2, v4, v3 offset:48
    s_mov_b32 exec_lo, s36
    v_mov_b32 v3, 1
    s_waitcnt lgkmcnt(0)
    v_readfirstlane_b32 s33, v2
    s_nop 3
    s_and_b32 s33, s33, 0xff
    s_cmp_lg_u32 s33, 7
    s_cbranch_scc1 K_ARRS
    global_store_dword v8, v3, s[10:11] sc1
K_ARRS:
    s_mov_b64 exec, -1
    s_cmp_ge_u32 s30, 6
    s_cbranch_scc1 K_P2_HELP
    s_branch K_LATE
WP_early:
    s_setpc_b64 s[38:39]
K_P2_EARLY:
    s_lshl_b32 s54, s40, 7
    v_lshrrev_b32 v9, 4, v1
    v_mov_b32 v12, 158720
    s_add_u32 s20, s10, 0x100000
    s_addc_u32 s21, s11, 0
    s_mov_b32 s22, 0x280000
    s_mov_b32 s23, 0x20000
    s_add_u32 s16, s10, 0x1000
    s_addc_u32 s17, s11, 0
    s_mov_b32 s18, 0x2000
    s_mov_b32 s19, 0x20000
    s_mov_b32 s48, s6
    s_mov_b32 s49, s7
    s_mov_b32 s50, 0x280000
    s_mov_b32 s51, 0x20000
    s_lshl_b32 s53, s40, 3
    s_lshl1_add_u32 s53, s30, s53
    s_mov_b32 s55, 20480
    v_bfe_u32 v20, v1, 2, 2
    v_and_b32 v21, 3, v1
    s_mul_i32 s3, s53, 20480
    v_lshl_add_u32 v25, v1, 4, s3
    v_add_u32 v26, 20480, v25
    v_add_u32 v35, 16384, v25
    v_add_u32 v36, 16384, v26
    v_and_b32 v2, 15, v1
    s_lshl_b32 s3, s53, 6
    v_lshl_add_u32 v23, v2, 2, s3
    v_lshl_add_u32 v2, v9, 2, v20
    v_bfe_u32 v3, v2, 1, 2
    v_lshlrev_b32 v2, 7, v2
    v_lshl_add_u32 v2, v21, 3, v2
    v_lshl_add_u32 v24, v3, 5, v2
    v_lshrrev_b32 v3, 1, v20
    v_mul_u32_u24 v2, 40, v9
    v_add3_u32 v2, v2, 16, v20
    v_lshlrev_b32 v2, 7, v2
    v_lshl_add_u32 v2, v21, 3, v2
    v_xor_b32 v4, 0, v3
    v_lshl_add_u32 v60, v4, 5, v2
    v_xor_b32 v4, 1, v3
    v_lshl_add_u32 v61, v4, 5, v2
    v_xor_b32 v4, 2, v3
    v_lshl_add_u32 v62, v4, 5, v2
    v_xor_b32 v4, 3, v3
    v_lshl_add_u32 v63, v4, 5, v2
    v_lshrrev_b32 v3, 4, v1
    v_and_b32 v4, 7, v1
    v_lshrrev_b32 v2, 3, v1
    v_xor_b32 v4, v4, v3
    v_mul_u32_u24 v2, 1280, v2
    v_lshl_add_u32 v27, v4, 4, v2
    v_xor_b32 v28, 64, v27
    s_lshl_b32 s71, s40, 3
    s_lshl1_add_u32 s71, s30, s71
    s_mul_i32 s71, s71, 20480
    s_lshl_b32 s33, s41, 7
    s_add_u32 s71, s71, s33
    s_add_u32 s72, s71, 10240
    s_add_u32 s73, s71, 20480
    s_add_u32 s74, s71, 30720
    s_lshl_b32 s3, s30, 12
    s_add_u32 s3, s3, 140288
    v_lshl_add_u32 v33, v1, 4, s3
    v_and_b32 v2, 15, v1
    v_lshrrev_b32 v3, 1, v2
    v_lshrrev_b32 v4, 5, v1
    v_xor_b32 v3, v3, v4
    v_lshlrev_b32 v3, 4, v3
    v_lshl_add_u32 v3, v2, 7, v3
    v_and_b32 v4, 1, v9
    v_lshl_add_u32 v3, v4, 3, v3
    v_add_u32 v29, s3, v3
    v_xor_b32 v30, 32, v29
    v_xor_b32 v31, 64, v29
    v_xor_b32 v32, 96, v29
    s_and_b32 s33, s40, 3
    s_lshl_b32 s33, s33, 3
    s_lshr_b32 s33, 0x7f06037f, s33
    s_and_b32 s33, s33, 0xff
    s_lshl_b32 s3, s30, 1
    s_cmp_ge_u32 s3, s33
    s_cselect_b32 s64, 16, 0
    s_add_u32 s3, s3, 1
    s_cmp_ge_u32 s3, s33
    s_cselect_b32 s65, 16, 0
    s_mov_b32 s63, 0
    s_mov_b32 s66, 0
    s_mov_b32 s67, 16384
    v_mov_b32 v34, 0
    v_mov_b32 v4, 158720
    v_mov_b32 v3, 1
    s_mov_b64 exec, 1
    s_waitcnt vmcnt(0)
    ds_add_rtn_u32 v2, v4, v3 offset:48
    s_mov_b32 exec_lo, s36
    v_mov_b32 v3, 1
    s_waitcnt lgkmcnt(0)
    v_readfirstlane_b32 s33, v2
    s_nop 3
    s_and_b32 s33, s33, 0xff
    s_cmp_lg_u32 s33, 7
    s_cbranch_scc1 K_ARRD
    global_store_dword v8, v3, s[10:11] sc1
K_ARRD:
    s_mov_b64 exec, -1
    s_mov_b32 s3, 1048576
K_P2_GE:
    ds_read_b32 v2, v12 offset:48
    s_sub_u32 s3, s3, 1
    s_waitcnt lgkmcnt(0)
    v_readfirstlane_b32 s33, v2
    s_nop 3
    s_cselect_b32 s33, 1024, s33
    s_cmp_lt_u32 s33, 1024
    s_cbranch_scc1 K_P2_GE
K_P2_GEMM:
    s_setprio 0
    s_mov_b32 s3, 1048576
K_P2_GS:
    ds_read_b32 v2, v12 offset:40
    s_sub_u32 s3, s3, 1
    s_waitcnt lgkmcnt(0)
    v_readfirstlane_b32 s33, v2
    s_nop 3
    s_cselect_b32 s33, 1, s33
    s_cmp_lt_u32 s33, 1
    s_cbranch_scc1 K_P2_GS
    buffer_load_dword v64, v23, s[16:19], 0 offen offset:0 sc1
    buffer_load_dword v66, v23, s[16:19], 0 offen offset:64 sc1
    ds_read_b128 v[16:19], v12
    ds_read_b64 v[40:41], v29 offset:0
    ds_read_b64 v[42:43], v30 offset:0
    ds_read_b64 v[44:45], v31 offset:0
    ds_read_b64 v[46:47], v32 offset:0
    ds_read_b64 v[48:49], v29 offset:2048
    ds_read_b64 v[50:51], v30 offset:2048
    ds_read_b64 v[52:53], v31 offset:2048
    ds_read_b64 v[54:55], v32 offset:2048
    s_waitcnt lgkmcnt(4)
    v_lshlrev_b32 v72, 16, v40
    v_and_b32 v73, 0xffff0000, v40
    v_lshlrev_b32 v74, 16, v41
    v_and_b32 v75, 0xffff0000, v41
    v_lshlrev_b32 v76, 16, v42
    v_and_b32 v77, 0xffff0000, v42
    v_lshlrev_b32 v78, 16, v43
    v_and_b32 v79, 0xffff0000, v43
    v_lshlrev_b32 v80, 16, v44
    v_and_b32 v81, 0xffff0000, v44
    v_lshlrev_b32 v82, 16, v45
    v_and_b32 v83, 0xffff0000, v45
    v_lshlrev_b32 v84, 16, v46
    v_and_b32 v85, 0xffff0000, v46
    v_lshlrev_b32 v86, 16, v47
    v_and_b32 v87, 0xffff0000, v47
    s_waitcnt lgkmcnt(0)
    v_lshlrev_b32 v88, 16, v48
    v_and_b32 v89, 0xffff0000, v48
    v_lshlrev_b32 v90, 16, v49
    v_and_b32 v91, 0xffff0000, v49
    v_lshlrev_b32 v92, 16, v50
    v_and_b32 v93, 0xffff0000, v50
    v_lshlrev_b32 v94, 16, v51
    v_and_b32 v95, 0xffff0000, v51
    v_lshlrev_b32 v96, 16, v52
    v_and_b32 v97, 0xffff0000, v52
    v_lshlrev_b32 v98, 16, v53
    v_and_b32 v99, 0xffff0000, v53
    v_lshlrev_b32 v100, 16, v54
    v_and_b32 v101, 0xffff0000, v54
    v_lshlrev_b32 v102, 16, v55
    v_and_b32 v103, 0xffff0000, v55
    s_cmp_eq_u32 s63, 0
    s_cbranch_scc1 K_SP0
K_SPR0:
    s_ff1_i32_b32 s33, s63
    s_bitset0_b32 s63, s33
    s_lshl_b32 s75, s33, 10
    buffer_load_dwordx4 v[104:107], v25, s[20:23], s75 offen offset:0 sc1
    buffer_load_dwordx4 v[108:111], v26, s[20:23], s75 offen offset:0 sc1
    v_mad_u32_u24 v56, s75, 5, v24
    v_xor_b32 v58, 64, v56
    v_xor_b32 v57, 32, v56
    v_xor_b32 v59, 96, v56
    ds_read_b64_tr_b16 v[184:185], v56 offset:0
    ds_read_b64_tr_b16 v[186:187], v58 offset:2560
    ds_read_b64_tr_b16 v[188:189], v57 offset:0
    ds_read_b64_tr_b16 v[190:191], v59 offset:2560
    ds_read_b64_tr_b16 v[192:193], v58 offset:0
    ds_read_b64_tr_b16 v[194:195], v56 offset:2560
    ds_read_b64_tr_b16 v[196:197], v59 offset:0
    ds_read_b64_tr_b16 v[198:199], v57 offset:2560
    s_cmp_eq_u32 s63, 0
    s_cbranch_scc1 K_SP1
K_SPR1:
    s_ff1_i32_b32 s33, s63
    s_bitset0_b32 s63, s33
    s_lshl_b32 s76, s33, 10
    buffer_load_dwordx4 v[112:115], v25, s[20:23], s76 offen offset:0 sc1
    buffer_load_dwordx4 v[116:119], v26, s[20:23], s76 offen offset:0 sc1
    v_mad_u32_u24 v56, s76, 5, v24
    v_xor_b32 v58, 64, v56
    v_xor_b32 v57, 32, v56
    v_xor_b32 v59, 96, v56
    ds_read_b64_tr_b16 v[200:201], v56 offset:0
    ds_read_b64_tr_b16 v[202:203], v58 offset:2560
    ds_read_b64_tr_b16 v[204:205], v57 offset:0
    ds_read_b64_tr_b16 v[206:207], v59 offset:2560
    ds_read_b64_tr_b16 v[208:209], v58 offset:0
    ds_read_b64_tr_b16 v[210:211], v56 offset:2560
    ds_read_b64_tr_b16 v[212:213], v59 offset:0
    ds_read_b64_tr_b16 v[214:215], v57 offset:2560
    s_waitcnt vmcnt(4)
    s_mov_b64 exec, 1
    ds_add_u32 v12, v34 offset:44
    s_mov_b64 exec, -1
    v_sub_f32 v68, 1.0, v64
    v_cvt_pk_bf16_f32 v68, v68, v68
    v_lshlrev_b32 v68, 16, v68
    v_sub_f32 v70, 1.0, v66
    v_cvt_pk_bf16_f32 v70, v70, v70
    v_lshlrev_b32 v70, 16, v70
    v_pk_mul_f32 v[72:73], v[72:73], v[68:69] op_sel_hi:[1,0]
    v_pk_mul_f32 v[74:75], v[74:75], v[68:69] op_sel_hi:[1,0]
    v_pk_mul_f32 v[76:77], v[76:77], v[68:69] op_sel_hi:[1,0]
    v_pk_mul_f32 v[78:79], v[78:79], v[68:69] op_sel_hi:[1,0]
    v_pk_mul_f32 v[80:81], v[80:81], v[68:69] op_sel_hi:[1,0]
    v_pk_mul_f32 v[82:83], v[82:83], v[68:69] op_sel_hi:[1,0]
    v_pk_mul_f32 v[84:85], v[84:85], v[68:69] op_sel_hi:[1,0]
    v_pk_mul_f32 v[86:87], v[86:87], v[68:69] op_sel_hi:[1,0]
    v_pk_mul_f32 v[88:89], v[88:89], v[70:71] op_sel_hi:[1,0]
    v_pk_mul_f32 v[90:91], v[90:91], v[70:71] op_sel_hi:[1,0]
    v_pk_mul_f32 v[92:93], v[92:93], v[70:71] op_sel_hi:[1,0]
    v_pk_mul_f32 v[94:95], v[94:95], v[70:71] op_sel_hi:[1,0]
    v_pk_mul_f32 v[96:97], v[96:97], v[70:71] op_sel_hi:[1,0]
    v_pk_mul_f32 v[98:99], v[98:99], v[70:71] op_sel_hi:[1,0]
    v_pk_mul_f32 v[100:101], v[100:101], v[70:71] op_sel_hi:[1,0]
    v_pk_mul_f32 v[102:103], v[102:103], v[70:71] op_sel_hi:[1,0]
    s_cmp_eq_u32 s63, 0
    s_cbranch_scc1 K_SP2
K_SPR2:
    s_ff1_i32_b32 s33, s63
    s_bitset0_b32 s63, s33
    s_lshl_b32 s77, s33, 10
    buffer_load_dwordx4 v[120:123], v25, s[20:23], s77 offen offset:0 sc1
    buffer_load_dwordx4 v[124:127], v26, s[20:23], s77 offen offset:0 sc1
    s_cmp_eq_u32 s63, 0
    s_cbranch_scc1 K_SP3
K_SPR3:
    s_ff1_i32_b32 s33, s63
    s_bitset0_b32 s63, s33
    s_lshl_b32 s78, s33, 10
    buffer_load_dwordx4 v[128:131], v25, s[20:23], s78 offen offset:0 sc1
    buffer_load_dwordx4 v[132:135], v26, s[20:23], s78 offen offset:0 sc1
    s_cmp_eq_u32 s63, 0
    s_cbranch_scc1 K_SP4
K_SPR4:
    s_ff1_i32_b32 s33, s63
    s_bitset0_b32 s63, s33
    s_lshl_b32 s75, s33, 10
    buffer_load_dwordx4 v[136:139], v25, s[20:23], s75 offen offset:0 sc1
    buffer_load_dwordx4 v[140:143], v26, s[20:23], s75 offen offset:0 sc1
    s_branch WS_p2g
.p2align 12
WP_p2g:
    s_setpc_b64 s[38:39]
WS_p2g:
    s_waitcnt vmcnt(8) lgkmcnt(9)
    v_mfma_f32_16x16x32_bf16 v[152:155], v[184:187], v[104:107], 0
    v_mad_u32_u24 v56, s77, 5, v24
    v_xor_b32 v58, 64, v56
    v_xor_b32 v57, 32, v56
    v_mfma_f32_16x16x32_bf16 v[168:171], v[184:187], v[108:111], 0
    v_xor_b32 v59, 96, v56
    ds_read_b64_tr_b16 v[216:217], v56 offset:0
    ds_read_b64_tr_b16 v[218:219], v58 offset:2560
    v_mfma_f32_16x16x32_bf16 v[156:159], v[188:191], v[104:107], 0
    ds_read_b64_tr_b16 v[220:221], v57 offset:0
    ds_read_b64_tr_b16 v[222:223], v59 offset:2560
    ds_read_b64_tr_b16 v[224:225], v58 offset:0
    v_mfma_f32_16x16x32_bf16 v[172:175], v[188:191], v[108:111], 0
    ds_read_b64_tr_b16 v[226:227], v56 offset:2560
    ds_read_b64_tr_b16 v[228:229], v59 offset:0
    v_mfma_f32_16x16x32_bf16 v[160:163], v[192:195], v[104:107], 0
    ds_read_b64_tr_b16 v[230:231], v57 offset:2560
    s_cmp_eq_u32 s63, 0
    v_mfma_f32_16x16x32_bf16 v[176:179], v[192:195], v[108:111], 0
    s_cbranch_scc1 K_SP5
K_SPR5:
    s_ff1_i32_b32 s33, s63
    v_mfma_f32_16x16x32_bf16 v[164:167], v[196:199], v[104:107], 0
    s_bitset0_b32 s63, s33
    s_lshl_b32 s76, s33, 10
    v_mfma_f32_16x16x32_bf16 v[180:183], v[196:199], v[108:111], 0
    buffer_load_dwordx4 v[144:147], v25, s[20:23], s76 offen offset:0 sc1
    buffer_load_dwordx4 v[148:151], v26, s[20:23], s76 offen offset:0 sc1
    s_waitcnt vmcnt(8) lgkmcnt(9)
    v_mfma_f32_16x16x32_bf16 v[152:155], v[200:203], v[112:115], v[152:155]
    v_mad_u32_u24 v56, s78, 5, v24
    v_xor_b32 v58, 64, v56
    v_xor_b32 v57, 32, v56
    v_mfma_f32_16x16x32_bf16 v[168:171], v[200:203], v[116:119], v[168:171]
    v_xor_b32 v59, 96, v56
    ds_read_b64_tr_b16 v[184:185], v56 offset:0
    ds_read_b64_tr_b16 v[186:187], v58 offset:2560
    v_mfma_f32_16x16x32_bf16 v[156:159], v[204:207], v[112:115], v[156:159]
    ds_read_b64_tr_b16 v[188:189], v57 offset:0
    ds_read_b64_tr_b16 v[190:191], v59 offset:2560
    ds_read_b64_tr_b16 v[192:193], v58 offset:0
    v_mfma_f32_16x16x32_bf16 v[172:175], v[204:207], v[116:119], v[172:175]
    ds_read_b64_tr_b16 v[194:195], v56 offset:2560
    ds_read_b64_tr_b16 v[196:197], v59 offset:0
    v_mfma_f32_16x16x32_bf16 v[160:163], v[208:211], v[112:115], v[160:163]
    ds_read_b64_tr_b16 v[198:199], v57 offset:2560
    s_cmp_eq_u32 s63, 0
    v_mfma_f32_16x16x32_bf16 v[176:179], v[208:211], v[116:119], v[176:179]
    s_cbranch_scc1 K_SP6
K_SPR6:
    s_ff1_i32_b32 s33, s63
    v_mfma_f32_16x16x32_bf16 v[164:167], v[212:215], v[112:115], v[164:167]
    s_bitset0_b32 s63, s33
    s_lshl_b32 s77, s33, 10
    v_mfma_f32_16x16x32_bf16 v[180:183], v[212:215], v[116:119], v[180:183]
    buffer_load_dwordx4 v[104:107], v25, s[20:23], s77 offen offset:0 sc1
    buffer_load_dwordx4 v[108:111], v26, s[20:23], s77 offen offset:0 sc1
    s_waitcnt vmcnt(8) lgkmcnt(8)
    v_mfma_f32_16x16x32_bf16 v[152:155], v[216:219], v[120:123], v[152:155]
    v_mad_u32_u24 v56, s75, 5, v24
    v_xor_b32 v58, 64, v56
    v_xor_b32 v57, 32, v56
    v_mfma_f32_16x16x32_bf16 v[168:171], v[216:219], v[124:127], v[168:171]
    v_xor_b32 v59, 96, v56
    ds_read_b64_tr_b16 v[200:201], v56 offset:0
    ds_read_b64_tr_b16 v[202:203], v58 offset:2560
    v_mfma_f32_16x16x32_bf16 v[156:159], v[220:223], v[120:123], v[156:159]
    ds_read_b64_tr_b16 v[204:205], v57 offset:0
    ds_read_b64_tr_b16 v[206:207], v59 offset:2560
    ds_read_b64_tr_b16 v[208:209], v58 offset:0
    v_mfma_f32_16x16x32_bf16 v[172:175], v[220:223], v[124:127], v[172:175]
    ds_read_b64_tr_b16 v[210:211], v56 offset:2560
    ds_read_b64_tr_b16 v[212:213], v59 offset:0
    v_mfma_f32_16x16x32_bf16 v[160:163], v[224:227], v[120:123], v[160:163]
    ds_read_b64_tr_b16 v[214:215], v57 offset:2560
    s_andn2_b32 s33, s66, s63
    v_mfma_f32_16x16x32_bf16 v[176:179], v[224:227], v[124:127], v[176:179]
    s_bfe_u32 s33, s33, 0x40000
    s_cmp_eq_u32 s33, 15
    v_mfma_f32_16x16x32_bf16 v[164:167], v[228:231], v[120:123], v[164:167]
    s_cselect_b32 s78, 0, 1024
    s_xor_b32 s69, s78, 1024
    v_mfma_f32_16x16x32_bf16 v[180:183], v[228:231], v[124:127], v[180:183]
    buffer_load_dwordx4 v[112:115], v35, s[20:23], s78 offen offset:0 sc1
    buffer_load_dwordx4 v[116:119], v36, s[20:23], s78 offen offset:0 sc1
    s_waitcnt vmcnt(8) lgkmcnt(8)
    v_mfma_f32_16x16x32_bf16 v[152:155], v[184:187], v[128:131], v[152:155]
    v_mad_u32_u24 v56, s76, 5, v24
    v_xor_b32 v58, 64, v56
    v_xor_b32 v57, 32, v56
    v_mfma_f32_16x16x32_bf16 v[168:171], v[184:187], v[132:135], v[168:171]
    v_xor_b32 v59, 96, v56
    ds_read_b64_tr_b16 v[216:217], v56 offset:0
    ds_read_b64_tr_b16 v[218:219], v58 offset:2560
    v_mfma_f32_16x16x32_bf16 v[156:159], v[188:191], v[128:131], v[156:159]
    ds_read_b64_tr_b16 v[220:221], v57 offset:0
    ds_read_b64_tr_b16 v[222:223], v59 offset:2560
    ds_read_b64_tr_b16 v[224:225], v58 offset:0
    v_mfma_f32_16x16x32_bf16 v[172:175], v[188:191], v[132:135], v[172:175]
    ds_read_b64_tr_b16 v[226:227], v56 offset:2560
    ds_read_b64_tr_b16 v[228:229], v59 offset:0
    v_mfma_f32_16x16x32_bf16 v[160:163], v[192:195], v[128:131], v[160:163]
    ds_read_b64_tr_b16 v[230:231], v57 offset:2560
    s_cmp_eq_u32 s63, 0
    v_mfma_f32_16x16x32_bf16 v[176:179], v[192:195], v[132:135], v[176:179]
    s_cbranch_scc1 K_SP8
K_SPR8:
    s_ff1_i32_b32 s33, s63
    v_mfma_f32_16x16x32_bf16 v[164:167], v[196:199], v[128:131], v[164:167]
    s_bitset0_b32 s63, s33
    s_lshl_b32 s75, s33, 10
    v_mfma_f32_16x16x32_bf16 v[180:183], v[196:199], v[132:135], v[180:183]
    buffer_load_dwordx4 v[120:123], v25, s[20:23], s75 offen offset:0 sc1
    buffer_load_dwordx4 v[124:127], v26, s[20:23], s75 offen offset:0 sc1
    s_waitcnt vmcnt(8) lgkmcnt(8)
    v_mfma_f32_16x16x32_bf16 v[152:155], v[200:203], v[136:139], v[152:155]
    v_mad_u32_u24 v56, s77, 5, v24
    v_xor_b32 v58, 64, v56
    v_mfma_f32_16x16x32_bf16 v[168:171], v[200:203], v[140:143], v[168:171]
    v_xor_b32 v57, 32, v56
    v_xor_b32 v59, 96, v56
    v_mfma_f32_16x16x32_bf16 v[156:159], v[204:207], v[136:139], v[156:159]
    ds_read_b64_tr_b16 v[184:185], v56 offset:0
    ds_read_b64_tr_b16 v[186:187], v58 offset:2560
    v_mfma_f32_16x16x32_bf16 v[172:175], v[204:207], v[140:143], v[172:175]
    ds_read_b64_tr_b16 v[188:189], v57 offset:0
    ds_read_b64_tr_b16 v[190:191], v59 offset:2560
    v_mfma_f32_16x16x32_bf16 v[160:163], v[208:211], v[136:139], v[160:163]
    ds_read_b64_tr_b16 v[192:193], v58 offset:0
    ds_read_b64_tr_b16 v[194:195], v56 offset:2560
    v_mfma_f32_16x16x32_bf16 v[176:179], v[208:211], v[140:143], v[176:179]
    ds_read_b64_tr_b16 v[196:197], v59 offset:0
    ds_read_b64_tr_b16 v[198:199], v57 offset:2560
    v_mfma_f32_16x16x32_bf16 v[164:167], v[212:215], v[136:139], v[164:167]
    buffer_load_dwordx4 v[128:131], v35, s[20:23], s69 offen offset:0 sc1
    buffer_load_dwordx4 v[132:135], v36, s[20:23], s69 offen offset:0 sc1
    v_mfma_f32_16x16x32_bf16 v[180:183], v[212:215], v[140:143], v[180:183]
    s_waitcnt vmcnt(8) lgkmcnt(8)
    v_mfma_f32_16x16x32_bf16 v[152:155], v[216:219], v[144:147], v[152:155]
    v_mad_u32_u24 v56, s78, 20, v60
    v_xor_b32 v58, 64, v56
    v_xor_b32 v57, 32, v56
    v_mfma_f32_16x16x32_bf16 v[168:171], v[216:219], v[148:151], v[168:171]
    v_xor_b32 v59, 96, v56
    ds_read_b64_tr_b16 v[200:201], v56 offset:0
    ds_read_b64_tr_b16 v[202:203], v58 offset:2560
    v_mfma_f32_16x16x32_bf16 v[156:159], v[220:223], v[144:147], v[156:159]
    ds_read_b64_tr_b16 v[204:205], v57 offset:0
    ds_read_b64_tr_b16 v[206:207], v59 offset:2560
    ds_read_b64_tr_b16 v[208:209], v58 offset:0
    v_mfma_f32_16x16x32_bf16 v[172:175], v[220:223], v[148:151], v[172:175]
    ds_read_b64_tr_b16 v[210:211], v56 offset:2560
    ds_read_b64_tr_b16 v[212:213], v59 offset:0
    v_mfma_f32_16x16x32_bf16 v[160:163], v[224:227], v[144:147], v[160:163]
    ds_read_b64_tr_b16 v[214:215], v57 offset:2560
    s_cmp_eq_u32 s63, 0
    v_mfma_f32_16x16x32_bf16 v[176:179], v[224:227], v[148:151], v[176:179]
    s_cbranch_scc1 K_SP10
K_SPR10:
    s_ff1_i32_b32 s33, s63
    v_mfma_f32_16x16x32_bf16 v[164:167], v[228:231], v[144:147], v[164:167]
    s_bitset0_b32 s63, s33
    s_lshl_b32 s77, s33, 10
    v_mfma_f32_16x16x32_bf16 v[180:183], v[228:231], v[148:151], v[180:183]
    buffer_load_dwordx4 v[136:139], v25, s[20:23], s77 offen offset:0 sc1
    buffer_load_dwordx4 v[140:143], v26, s[20:23], s77 offen offset:0 sc1
    s_waitcnt vmcnt(8) lgkmcnt(8)
    v_mfma_f32_16x16x32_bf16 v[152:155], v[184:187], v[104:107], v[152:155]
    v_mad_u32_u24 v56, s75, 5, v24
    v_xor_b32 v58, 64, v56
    v_xor_b32 v57, 32, v56
    v_mfma_f32_16x16x32_bf16 v[168:171], v[184:187], v[108:111], v[168:171]
    v_xor_b32 v59, 96, v56
    ds_read_b64_tr_b16 v[216:217], v56 offset:0
    ds_read_b64_tr_b16 v[218:219], v58 offset:2560
    v_mfma_f32_16x16x32_bf16 v[156:159], v[188:191], v[104:107], v[156:159]
    ds_read_b64_tr_b16 v[220:221], v57 offset:0
    ds_read_b64_tr_b16 v[222:223], v59 offset:2560
    ds_read_b64_tr_b16 v[224:225], v58 offset:0
    v_mfma_f32_16x16x32_bf16 v[172:175], v[188:191], v[108:111], v[172:175]
    ds_read_b64_tr_b16 v[226:227], v56 offset:2560
    ds_read_b64_tr_b16 v[228:229], v59 offset:0
    v_mfma_f32_16x16x32_bf16 v[160:163], v[192:195], v[104:107], v[160:163]
    ds_read_b64_tr_b16 v[230:231], v57 offset:2560
    s_cmp_eq_u32 s63, 0
    v_mfma_f32_16x16x32_bf16 v[176:179], v[192:195], v[108:111], v[176:179]
    s_cbranch_scc1 K_SP11
K_SPR11:
    s_ff1_i32_b32 s33, s63
    v_mfma_f32_16x16x32_bf16 v[164:167], v[196:199], v[104:107], v[164:167]
    s_bitset0_b32 s63, s33
    s_lshl_b32 s78, s33, 10
    v_mfma_f32_16x16x32_bf16 v[180:183], v[196:199], v[108:111], v[180:183]
    buffer_load_dwordx4 v[144:147], v25, s[20:23], s78 offen offset:0 sc1
    buffer_load_dwordx4 v[148:151], v26, s[20:23], s78 offen offset:0 sc1
    s_waitcnt vmcnt(8) lgkmcnt(8)
    v_mfma_f32_16x16x32_bf16 v[152:155], v[200:203], v[112:115], v[152:155]
    v_mad_u32_u24 v56, s69, 20, v60
    v_xor_b32 v58, 64, v56
    v_xor_b32 v57, 32, v56
    v_mfma_f32_16x16x32_bf16 v[168:171], v[200:203], v[116:119], v[168:171]
    v_xor_b32 v59, 96, v56
    ds_read_b64_tr_b16 v[184:185], v56 offset:0
    ds_read_b64_tr_b16 v[186:187], v58 offset:2560
    v_mfma_f32_16x16x32_bf16 v[156:159], v[204:207], v[112:115], v[156:159]
    ds_read_b64_tr_b16 v[188:189], v57 offset:0
    ds_read_b64_tr_b16 v[190:191], v59 offset:2560
    ds_read_b64_tr_b16 v[192:193], v58 offset:0
    v_mfma_f32_16x16x32_bf16 v[172:175], v[204:207], v[116:119], v[172:175]
    ds_read_b64_tr_b16 v[194:195], v56 offset:2560
    ds_read_b64_tr_b16 v[196:197], v59 offset:0
    v_mfma_f32_16x16x32_bf16 v[160:163], v[208:211], v[112:115], v[160:163]
    ds_read_b64_tr_b16 v[198:199], v57 offset:2560
    s_cmp_eq_u32 s63, 0
    v_mfma_f32_16x16x32_bf16 v[176:179], v[208:211], v[116:119], v[176:179]
    s_cbranch_scc1 K_SP12
K_SPR12:
    s_ff1_i32_b32 s33, s63
    v_mfma_f32_16x16x32_bf16 v[164:167], v[212:215], v[112:115], v[164:167]
    s_bitset0_b32 s63, s33
    s_lshl_b32 s75, s33, 10
    v_mfma_f32_16x16x32_bf16 v[180:183], v[212:215], v[116:119], v[180:183]
    buffer_load_dwordx4 v[104:107], v25, s[20:23], s75 offen offset:0 sc1
    buffer_load_dwordx4 v[108:111], v26, s[20:23], s75 offen offset:0 sc1
    s_mov_b32 s3, 1048576
K_P2_GW:
    ds_read_b32 v2, v12 offset:44
    s_sub_u32 s3, s3, 1
    s_waitcnt lgkmcnt(0)
    v_readfirstlane_b32 s33, v2
    s_nop 3
    s_cselect_b32 s33, 4, s33
    s_cmp_lt_u32 s33, 4
    s_cbranch_scc1 K_P2_GW
    v_readfirstlane_b32 s56, v16
    v_readfirstlane_b32 s57, v17
    s_lshl_b32 s58, s53, 4
    s_waitcnt vmcnt(8)
    v_mfma_f32_16x16x32_bf16 v[152:155], v[216:219], v[120:123], v[152:155]
    v_mad_u32_u24 v56, s77, 5, v24
    v_xor_b32 v58, 64, v56
    v_xor_b32 v57, 32, v56
    v_mfma_f32_16x16x32_bf16 v[168:171], v[216:219], v[124:127], v[168:171]
    v_xor_b32 v59, 96, v56
    ds_read_b64_tr_b16 v[200:201], v56 offset:0
    ds_read_b64_tr_b16 v[202:203], v58 offset:2560
    v_mfma_f32_16x16x32_bf16 v[156:159], v[220:223], v[120:123], v[156:159]
    ds_read_b64_tr_b16 v[204:205], v57 offset:0
    ds_read_b64_tr_b16 v[206:207], v59 offset:2560
    ds_read_b64_tr_b16 v[208:209], v58 offset:0
    v_mfma_f32_16x16x32_bf16 v[172:175], v[220:223], v[124:127], v[172:175]
    ds_read_b64_tr_b16 v[210:211], v56 offset:2560
    ds_read_b64_tr_b16 v[212:213], v59 offset:0
    v_mfma_f32_16x16x32_bf16 v[160:163], v[224:227], v[120:123], v[160:163]
    ds_read_b64_tr_b16 v[214:215], v57 offset:2560
    s_cmp_eq_u32 s63, 0
    v_mfma_f32_16x16x32_bf16 v[176:179], v[224:227], v[124:127], v[176:179]
    s_cbranch_scc1 K_SP13
K_SPR13:
    s_ff1_i32_b32 s33, s63
    v_mfma_f32_16x16x32_bf16 v[164:167], v[228:231], v[120:123], v[164:167]
    s_bitset0_b32 s63, s33
    s_lshl_b32 s76, s33, 10
    v_mfma_f32_16x16x32_bf16 v[180:183], v[228:231], v[124:127], v[180:183]
    buffer_load_dwordx4 v[112:115], v25, s[20:23], s76 offen offset:0 sc1
    buffer_load_dwordx4 v[116:119], v26, s[20:23], s76 offen offset:0 sc1
    s_waitcnt vmcnt(8)
    v_mfma_f32_16x16x32_bf16 v[152:155], v[184:187], v[128:131], v[152:155]
    v_mad_u32_u24 v56, s78, 5, v24
    v_xor_b32 v58, 64, v56
    v_xor_b32 v57, 32, v56
    v_mfma_f32_16x16x32_bf16 v[168:171], v[184:187], v[132:135], v[168:171]
    v_xor_b32 v59, 96, v56
    ds_read_b64_tr_b16 v[216:217], v56 offset:0
    ds_read_b64_tr_b16 v[218:219], v58 offset:2560
    v_mfma_f32_16x16x32_bf16 v[156:159], v[188:191], v[128:131], v[156:159]
    ds_read_b64_tr_b16 v[220:221], v57 offset:0
    ds_read_b64_tr_b16 v[222:223], v59 offset:2560
    ds_read_b64_tr_b16 v[224:225], v58 offset:0
    v_mfma_f32_16x16x32_bf16 v[172:175], v[188:191], v[132:135], v[172:175]
    ds_read_b64_tr_b16 v[226:227], v56 offset:2560
    ds_read_b64_tr_b16 v[228:229], v59 offset:0
    v_mfma_f32_16x16x32_bf16 v[160:163], v[192:195], v[128:131], v[160:163]
    ds_read_b64_tr_b16 v[230:231], v57 offset:2560
    s_cmp_eq_u32 s63, 0
    v_mfma_f32_16x16x32_bf16 v[176:179], v[192:195], v[132:135], v[176:179]
    s_cbranch_scc1 K_SP14
K_SPR14:
    s_ff1_i32_b32 s33, s63
    v_mfma_f32_16x16x32_bf16 v[164:167], v[196:199], v[128:131], v[164:167]
    s_bitset0_b32 s63, s33
    s_lshl_b32 s77, s33, 10
    v_mfma_f32_16x16x32_bf16 v[180:183], v[196:199], v[132:135], v[180:183]
    buffer_load_dwordx4 v[120:123], v25, s[20:23], s77 offen offset:0 sc1
    buffer_load_dwordx4 v[124:127], v26, s[20:23], s77 offen offset:0 sc1
    s_waitcnt vmcnt(8) lgkmcnt(8)
    v_mfma_f32_16x16x32_bf16 v[152:155], v[200:203], v[136:139], v[152:155]
    v_mad_u32_u24 v56, s75, 5, v24
    v_xor_b32 v58, 64, v56
    v_xor_b32 v57, 32, v56
    v_mfma_f32_16x16x32_bf16 v[168:171], v[200:203], v[140:143], v[168:171]
    v_xor_b32 v59, 96, v56
    ds_read_b64_tr_b16 v[184:185], v56 offset:0
    ds_read_b64_tr_b16 v[186:187], v58 offset:2560
    v_mfma_f32_16x16x32_bf16 v[156:159], v[204:207], v[136:139], v[156:159]
    ds_read_b64_tr_b16 v[188:189], v57 offset:0
    ds_read_b64_tr_b16 v[190:191], v59 offset:2560
    ds_read_b64_tr_b16 v[192:193], v58 offset:0
    v_mfma_f32_16x16x32_bf16 v[172:175], v[204:207], v[140:143], v[172:175]
    ds_read_b64_tr_b16 v[194:195], v56 offset:2560
    ds_read_b64_tr_b16 v[196:197], v59 offset:0
    v_mfma_f32_16x16x32_bf16 v[160:163], v[208:211], v[136:139], v[160:163]
    ds_read_b64_tr_b16 v[198:199], v57 offset:2560
    s_cmp_eq_u32 s63, 0
    v_mfma_f32_16x16x32_bf16 v[176:179], v[208:211], v[140:143], v[176:179]
    s_cbranch_scc1 K_SP15
K_SPR15:
    s_ff1_i32_b32 s33, s63
    v_mfma_f32_16x16x32_bf16 v[164:167], v[212:215], v[136:139], v[164:167]
    s_bitset0_b32 s63, s33
    s_lshl_b32 s78, s33, 10
    v_mfma_f32_16x16x32_bf16 v[180:183], v[212:215], v[140:143], v[180:183]
    buffer_load_dwordx4 v[128:131], v25, s[20:23], s78 offen offset:0 sc1
    buffer_load_dwordx4 v[132:135], v26, s[20:23], s78 offen offset:0 sc1
    s_waitcnt vmcnt(8) lgkmcnt(8)
    v_mfma_f32_16x16x32_bf16 v[152:155], v[216:219], v[144:147], v[152:155]
    v_mad_u32_u24 v56, s76, 5, v24
    v_xor_b32 v58, 64, v56
    v_xor_b32 v57, 32, v56
    v_mfma_f32_16x16x32_bf16 v[168:171], v[216:219], v[148:151], v[168:171]
    v_xor_b32 v59, 96, v56
    ds_read_b64_tr_b16 v[200:201], v56 offset:0
    ds_read_b64_tr_b16 v[202:203], v58 offset:2560
    v_mfma_f32_16x16x32_bf16 v[156:159], v[220:223], v[144:147], v[156:159]
    ds_read_b64_tr_b16 v[204:205], v57 offset:0
    ds_read_b64_tr_b16 v[206:207], v59 offset:2560
    ds_read_b64_tr_b16 v[208:209], v58 offset:0
    v_mfma_f32_16x16x32_bf16 v[172:175], v[220:223], v[148:151], v[172:175]
    ds_read_b64_tr_b16 v[210:211], v56 offset:2560
    ds_read_b64_tr_b16 v[212:213], v59 offset:0
    v_mfma_f32_16x16x32_bf16 v[160:163], v[224:227], v[144:147], v[160:163]
    ds_read_b64_tr_b16 v[214:215], v57 offset:2560
    s_cmp_eq_u32 s63, 0
    v_mfma_f32_16x16x32_bf16 v[176:179], v[224:227], v[148:151], v[176:179]
    s_cbranch_scc1 K_SP16
K_SPR16:
    s_ff1_i32_b32 s33, s63
    v_mfma_f32_16x16x32_bf16 v[164:167], v[228:231], v[144:147], v[164:167]
    s_bitset0_b32 s63, s33
    s_lshl_b32 s75, s33, 10
    v_mfma_f32_16x16x32_bf16 v[180:183], v[228:231], v[148:151], v[180:183]
    buffer_load_dwordx4 v[136:139], v25, s[20:23], s75 offen offset:0 sc1
    buffer_load_dwordx4 v[140:143], v26, s[20:23], s75 offen offset:0 sc1
    s_waitcnt vmcnt(8) lgkmcnt(8)
    v_mfma_f32_16x16x32_bf16 v[152:155], v[184:187], v[104:107], v[152:155]
    v_mad_u32_u24 v56, s77, 5, v24
    v_xor_b32 v58, 64, v56
    v_xor_b32 v57, 32, v56
    v_mfma_f32_16x16x32_bf16 v[168:171], v[184:187], v[108:111], v[168:171]
    v_xor_b32 v59, 96, v56
    ds_read_b64_tr_b16 v[216:217], v56 offset:0
    ds_read_b64_tr_b16 v[218:219], v58 offset:2560
    v_mfma_f32_16x16x32_bf16 v[156:159], v[188:191], v[104:107], v[156:159]
    ds_read_b64_tr_b16 v[220:221], v57 offset:0
    ds_read_b64_tr_b16 v[222:223], v59 offset:2560
    ds_read_b64_tr_b16 v[224:225], v58 offset:0
    v_mfma_f32_16x16x32_bf16 v[172:175], v[188:191], v[108:111], v[172:175]
    ds_read_b64_tr_b16 v[226:227], v56 offset:2560
    ds_read_b64_tr_b16 v[228:229], v59 offset:0
    v_mfma_f32_16x16x32_bf16 v[160:163], v[192:195], v[104:107], v[160:163]
    ds_read_b64_tr_b16 v[230:231], v57 offset:2560
    s_andn2_b32 s33, s66, s63
    v_mfma_f32_16x16x32_bf16 v[176:179], v[192:195], v[108:111], v[176:179]
    s_bfe_u32 s33, s33, 0x40008
    s_cmp_eq_u32 s33, 15
    v_mfma_f32_16x16x32_bf16 v[164:167], v[196:199], v[104:107], v[164:167]
    s_cselect_b32 s76, 0, 1024
    s_xor_b32 s69, s76, 1024
    v_mfma_f32_16x16x32_bf16 v[180:183], v[196:199], v[108:111], v[180:183]
    buffer_load_dwordx4 v[144:147], v35, s[20:23], s76 offen offset:2048 sc1
    buffer_load_dwordx4 v[148:151], v36, s[20:23], s76 offen offset:2048 sc1
    s_waitcnt vmcnt(8) lgkmcnt(8)
    v_mfma_f32_16x16x32_bf16 v[152:155], v[200:203], v[112:115], v[152:155]
    v_mad_u32_u24 v56, s78, 5, v24
    v_xor_b32 v58, 64, v56
    v_xor_b32 v57, 32, v56
    v_mfma_f32_16x16x32_bf16 v[168:171], v[200:203], v[116:119], v[168:171]
    v_xor_b32 v59, 96, v56
    ds_read_b64_tr_b16 v[184:185], v56 offset:0
    ds_read_b64_tr_b16 v[186:187], v58 offset:2560
    v_mfma_f32_16x16x32_bf16 v[156:159], v[204:207], v[112:115], v[156:159]
    ds_read_b64_tr_b16 v[188:189], v57 offset:0
    ds_read_b64_tr_b16 v[190:191], v59 offset:2560
    ds_read_b64_tr_b16 v[192:193], v58 offset:0
    v_mfma_f32_16x16x32_bf16 v[172:175], v[204:207], v[116:119], v[172:175]
    ds_read_b64_tr_b16 v[194:195], v56 offset:2560
    ds_read_b64_tr_b16 v[196:197], v59 offset:0
    v_mfma_f32_16x16x32_bf16 v[160:163], v[208:211], v[112:115], v[160:163]
    ds_read_b64_tr_b16 v[198:199], v57 offset:2560
    s_cmp_eq_u32 s63, 0
    v_mfma_f32_16x16x32_bf16 v[176:179], v[208:211], v[116:119], v[176:179]
    s_cbranch_scc1 K_SP18
K_SPR18:
    s_ff1_i32_b32 s33, s63
    v_mfma_f32_16x16x32_bf16 v[164:167], v[212:215], v[112:115], v[164:167]
    s_bitset0_b32 s63, s33
    s_lshl_b32 s77, s33, 10
    v_mfma_f32_16x16x32_bf16 v[180:183], v[212:215], v[116:119], v[180:183]
    buffer_load_dwordx4 v[104:107], v25, s[20:23], s77 offen offset:0 sc1
    buffer_load_dwordx4 v[108:111], v26, s[20:23], s77 offen offset:0 sc1
    s_waitcnt vmcnt(8) lgkmcnt(8)
    v_mfma_f32_16x16x32_bf16 v[152:155], v[216:219], v[120:123], v[152:155]
    v_mad_u32_u24 v56, s75, 5, v24
    v_xor_b32 v58, 64, v56
    v_mfma_f32_16x16x32_bf16 v[168:171], v[216:219], v[124:127], v[168:171]
    v_xor_b32 v57, 32, v56
    v_xor_b32 v59, 96, v56
    v_mfma_f32_16x16x32_bf16 v[156:159], v[220:223], v[120:123], v[156:159]
    ds_read_b64_tr_b16 v[200:201], v56 offset:0
    ds_read_b64_tr_b16 v[202:203], v58 offset:2560
    v_mfma_f32_16x16x32_bf16 v[172:175], v[220:223], v[124:127], v[172:175]
    ds_read_b64_tr_b16 v[204:205], v57 offset:0
    ds_read_b64_tr_b16 v[206:207], v59 offset:2560
    v_mfma_f32_16x16x32_bf16 v[160:163], v[224:227], v[120:123], v[160:163]
    ds_read_b64_tr_b16 v[208:209], v58 offset:0
    ds_read_b64_tr_b16 v[210:211], v56 offset:2560
    v_mfma_f32_16x16x32_bf16 v[176:179], v[224:227], v[124:127], v[176:179]
    ds_read_b64_tr_b16 v[212:213], v59 offset:0
    ds_read_b64_tr_b16 v[214:215], v57 offset:2560
    v_mfma_f32_16x16x32_bf16 v[164:167], v[228:231], v[120:123], v[164:167]
    buffer_load_dwordx4 v[112:115], v35, s[20:23], s69 offen offset:2048 sc1
    buffer_load_dwordx4 v[116:119], v36, s[20:23], s69 offen offset:2048 sc1
    v_mfma_f32_16x16x32_bf16 v[180:183], v[228:231], v[124:127], v[180:183]
    s_waitcnt vmcnt(8) lgkmcnt(8)
    v_mfma_f32_16x16x32_bf16 v[152:155], v[184:187], v[128:131], v[152:155]
    v_mad_u32_u24 v56, s76, 20, v60
    v_xor_b32 v58, 64, v56
    v_mfma_f32_16x16x32_bf16 v[168:171], v[184:187], v[132:135], v[168:171]
    v_xor_b32 v57, 32, v56
    v_xor_b32 v59, 96, v56
    v_mfma_f32_16x16x32_bf16 v[156:159], v[188:191], v[128:131], v[156:159]
    ds_read_b64_tr_b16 v[216:217], v56 offset:40960
    ds_read_b64_tr_b16 v[218:219], v58 offset:43520
    v_mfma_f32_16x16x32_bf16 v[172:175], v[188:191], v[132:135], v[172:175]
    ds_read_b64_tr_b16 v[220:221], v57 offset:40960
    ds_read_b64_tr_b16 v[222:223], v59 offset:43520
    v_mfma_f32_16x16x32_bf16 v[160:163], v[192:195], v[128:131], v[160:163]
    ds_read_b64_tr_b16 v[224:225], v58 offset:40960
    ds_read_b64_tr_b16 v[226:227], v56 offset:43520
    v_mfma_f32_16x16x32_bf16 v[176:179], v[192:195], v[132:135], v[176:179]
    ds_read_b64_tr_b16 v[228:229], v59 offset:40960
    ds_read_b64_tr_b16 v[230:231], v57 offset:43520
    v_mfma_f32_16x16x32_bf16 v[164:167], v[196:199], v[128:131], v[164:167]
    v_mfma_f32_16x16x32_bf16 v[180:183], v[196:199], v[132:135], v[180:183]
    s_waitcnt vmcnt(6) lgkmcnt(8)
    v_mfma_f32_16x16x32_bf16 v[152:155], v[200:203], v[136:139], v[152:155]
    v_mad_u32_u24 v56, s77, 5, v24
    v_xor_b32 v58, 64, v56
    v_mfma_f32_16x16x32_bf16 v[168:171], v[200:203], v[140:143], v[168:171]
    v_xor_b32 v57, 32, v56
    v_xor_b32 v59, 96, v56
    v_mfma_f32_16x16x32_bf16 v[156:159], v[204:207], v[136:139], v[156:159]
    ds_read_b64_tr_b16 v[184:185], v56 offset:0
    ds_read_b64_tr_b16 v[186:187], v58 offset:2560
    v_mfma_f32_16x16x32_bf16 v[172:175], v[204:207], v[140:143], v[172:175]
    ds_read_b64_tr_b16 v[188:189], v57 offset:0
    ds_read_b64_tr_b16 v[190:191], v59 offset:2560
    v_mfma_f32_16x16x32_bf16 v[160:163], v[208:211], v[136:139], v[160:163]
    ds_read_b64_tr_b16 v[192:193], v58 offset:0
    ds_read_b64_tr_b16 v[194:195], v56 offset:2560
    v_mfma_f32_16x16x32_bf16 v[176:179], v[208:211], v[140:143], v[176:179]
    ds_read_b64_tr_b16 v[196:197], v59 offset:0
    ds_read_b64_tr_b16 v[198:199], v57 offset:2560
    v_mfma_f32_16x16x32_bf16 v[164:167], v[212:215], v[136:139], v[164:167]
    v_mfma_f32_16x16x32_bf16 v[180:183], v[212:215], v[140:143], v[180:183]
    s_waitcnt vmcnt(4) lgkmcnt(8)
    v_mfma_f32_16x16x32_bf16 v[152:155], v[216:219], v[144:147], v[152:155]
    v_mad_u32_u24 v56, s69, 20, v60
    v_xor_b32 v58, 64, v56
    v_mfma_f32_16x16x32_bf16 v[168:171], v[216:219], v[148:151], v[168:171]
    v_xor_b32 v57, 32, v56
    v_xor_b32 v59, 96, v56
    v_mfma_f32_16x16x32_bf16 v[156:159], v[220:223], v[144:147], v[156:159]
    ds_read_b64_tr_b16 v[200:201], v56 offset:40960
    ds_read_b64_tr_b16 v[202:203], v58 offset:43520
    v_mfma_f32_16x16x32_bf16 v[172:175], v[220:223], v[148:151], v[172:175]
    ds_read_b64_tr_b16 v[204:205], v57 offset:40960
    ds_read_b64_tr_b16 v[206:207], v59 offset:43520
    v_mfma_f32_16x16x32_bf16 v[160:163], v[224:227], v[144:147], v[160:163]
    ds_read_b64_tr_b16 v[208:209], v58 offset:40960
    ds_read_b64_tr_b16 v[210:211], v56 offset:43520
    v_mfma_f32_16x16x32_bf16 v[176:179], v[224:227], v[148:151], v[176:179]
    ds_read_b64_tr_b16 v[212:213], v59 offset:40960
    ds_read_b64_tr_b16 v[214:215], v57 offset:43520
    v_mfma_f32_16x16x32_bf16 v[164:167], v[228:231], v[144:147], v[164:167]
    v_mfma_f32_16x16x32_bf16 v[180:183], v[228:231], v[148:151], v[180:183]
    s_waitcnt vmcnt(2) lgkmcnt(8)
    v_mfma_f32_16x16x32_bf16 v[152:155], v[184:187], v[104:107], v[152:155]
    v_mfma_f32_16x16x32_bf16 v[156:159], v[188:191], v[104:107], v[156:159]
    v_mfma_f32_16x16x32_bf16 v[160:163], v[192:195], v[104:107], v[160:163]
    v_mfma_f32_16x16x32_bf16 v[164:167], v[196:199], v[104:107], v[164:167]
    s_sub_u32 s59, s56, s58
    s_cmp_lt_u32 s59, 32
    s_cbranch_scc1 K_YROW0
K_NOY0:
    s_sub_u32 s59, s57, s58
    s_cmp_lt_u32 s59, 32
    s_cbranch_scc1 K_YROW1
K_NOY1:
    s_waitcnt vmcnt(0) lgkmcnt(0)
    v_mfma_f32_16x16x32_bf16 v[152:155], v[200:203], v[112:115], v[152:155]
    v_mfma_f32_16x16x32_bf16 v[156:159], v[204:207], v[112:115], v[156:159]
    v_mfma_f32_16x16x32_bf16 v[160:163], v[208:211], v[112:115], v[160:163]
    v_mfma_f32_16x16x32_bf16 v[164:167], v[212:215], v[112:115], v[164:167]
    v_mfma_f32_16x16x32_bf16 v[168:171], v[184:187], v[108:111], v[168:171]
    v_mfma_f32_16x16x32_bf16 v[172:175], v[188:191], v[108:111], v[172:175]
    v_mfma_f32_16x16x32_bf16 v[176:179], v[192:195], v[108:111], v[176:179]
    s_nop 1
    v_fma_f32 v152, v152, v64, v72
    v_fma_f32 v153, v153, v64, v73
    v_fma_f32 v154, v154, v64, v74
    v_mfma_f32_16x16x32_bf16 v[180:183], v[196:199], v[108:111], v[180:183]
    v_fma_f32 v155, v155, v64, v75
    v_cvt_pk_bf16_f32 v40, v152, v153
    v_cvt_pk_bf16_f32 v41, v154, v155
    v_mfma_f32_16x16x32_bf16 v[168:171], v[200:203], v[116:119], v[168:171]
    v_fma_f32 v156, v156, v64, v76
    v_fma_f32 v157, v157, v64, v77
    ds_write_b64 v29, v[40:41] offset:0
    v_mfma_f32_16x16x32_bf16 v[172:175], v[204:207], v[116:119], v[172:175]
    v_fma_f32 v158, v158, v64, v78
    v_fma_f32 v159, v159, v64, v79
    v_cvt_pk_bf16_f32 v42, v156, v157
    v_mfma_f32_16x16x32_bf16 v[176:179], v[208:211], v[116:119], v[176:179]
    v_cvt_pk_bf16_f32 v43, v158, v159
    v_fma_f32 v160, v160, v64, v80
    v_fma_f32 v161, v161, v64, v81
    v_mfma_f32_16x16x32_bf16 v[180:183], v[212:215], v[116:119], v[180:183]
    ds_write_b64 v30, v[42:43] offset:0
    v_fma_f32 v162, v162, v64, v82
    v_fma_f32 v163, v163, v64, v83
    v_cvt_pk_bf16_f32 v44, v160, v161
    v_cvt_pk_bf16_f32 v45, v162, v163
    v_pk_fma_f32 v[164:165], v[164:165], v[64:65], v[84:85] op_sel_hi:[1,0,1]
    v_pk_fma_f32 v[166:167], v[166:167], v[64:65], v[86:87] op_sel_hi:[1,0,1]
    ds_write_b64 v31, v[44:45] offset:0
    v_cvt_pk_bf16_f32 v46, v164, v165
    v_cvt_pk_bf16_f32 v47, v166, v167
    ds_write_b64 v32, v[46:47] offset:0
    ds_read_b128 v[72:75], v33 offset:0
    ds_read_b128 v[76:79], v33 offset:1024
    v_pk_fma_f32 v[168:169], v[168:169], v[66:67], v[88:89] op_sel_hi:[1,0,1]
    v_pk_fma_f32 v[170:171], v[170:171], v[66:67], v[90:91] op_sel_hi:[1,0,1]
    v_cvt_pk_bf16_f32 v48, v168, v169
    v_cvt_pk_bf16_f32 v49, v170, v171
    v_pk_fma_f32 v[172:173], v[172:173], v[66:67], v[92:93] op_sel_hi:[1,0,1]
    v_pk_fma_f32 v[174:175], v[174:175], v[66:67], v[94:95] op_sel_hi:[1,0,1]
    v_cvt_pk_bf16_f32 v50, v172, v173
    v_cvt_pk_bf16_f32 v51, v174, v175
    v_pk_fma_f32 v[176:177], v[176:177], v[66:67], v[96:97] op_sel_hi:[1,0,1]
    v_pk_fma_f32 v[178:179], v[178:179], v[66:67], v[98:99] op_sel_hi:[1,0,1]
    v_cvt_pk_bf16_f32 v52, v176, v177
    v_cvt_pk_bf16_f32 v53, v178, v179
    v_pk_fma_f32 v[180:181], v[180:181], v[66:67], v[100:101] op_sel_hi:[1,0,1]
    v_pk_fma_f32 v[182:183], v[182:183], v[66:67], v[102:103] op_sel_hi:[1,0,1]
    v_cvt_pk_bf16_f32 v54, v180, v181
    v_cvt_pk_bf16_f32 v55, v182, v183
    s_waitcnt lgkmcnt(0)
    buffer_store_dwordx4 v[72:75], v27, s[48:51], s71 offen sc1
    buffer_store_dwordx4 v[76:79], v28, s[48:51], s72 offen sc1
    ds_write_b64 v29, v[48:49] offset:2048
    ds_write_b64 v30, v[50:51] offset:2048
    ds_write_b64 v31, v[52:53] offset:2048
    ds_write_b64 v32, v[54:55] offset:2048
    ds_read_b128 v[88:91], v33 offset:2048
    ds_read_b128 v[92:95], v33 offset:3072
    s_waitcnt lgkmcnt(1)
    buffer_store_dwordx4 v[88:91], v27, s[48:51], s73 offen sc1
    s_waitcnt lgkmcnt(0)
    buffer_store_dwordx4 v[92:95], v28, s[48:51], s74 offen sc1
K_END:
K_EXIT:
    s_endpgm
.p2align 12
WP_spin:
    s_setpc_b64 s[38:39]
K_SP0:
    ds_read_b32 v2, v12 offset:32
    s_waitcnt lgkmcnt(0)
    v_readfirstlane_b32 s33, v2
    s_nop 3
    s_lshr_b32 s63, s33, s64
    s_lshr_b32 s33, s33, s65
    s_and_b32 s63, s63, s33
    s_and_b32 s63, s63, 0xff
    s_andn2_b32 s63, s63, s66
    s_cbranch_scc0 K_SP0
    s_or_b32 s66, s66, s63
    s_branch K_SPR0
K_SP1:
    ds_read_b32 v2, v12 offset:32
    s_waitcnt lgkmcnt(0)
    v_readfirstlane_b32 s33, v2
    s_nop 3
    s_lshr_b32 s63, s33, s64
    s_lshr_b32 s33, s33, s65
    s_and_b32 s63, s63, s33
    s_and_b32 s63, s63, 0xff
    s_andn2_b32 s63, s63, s66
    s_cbranch_scc0 K_SP1
    s_or_b32 s66, s66, s63
    s_branch K_SPR1
K_SP2:
    ds_read_b32 v2, v12 offset:32
    s_waitcnt lgkmcnt(0)
    v_readfirstlane_b32 s33, v2
    s_nop 3
    s_lshr_b32 s63, s33, s64
    s_lshr_b32 s33, s33, s65
    s_and_b32 s63, s63, s33
    s_and_b32 s63, s63, 0xff
    s_andn2_b32 s63, s63, s66
    s_cbranch_scc0 K_SP2
    s_or_b32 s66, s66, s63
    s_branch K_SPR2
K_SP3:
    ds_read_b32 v2, v12 offset:32
    s_waitcnt lgkmcnt(0)
    v_readfirstlane_b32 s33, v2
    s_nop 3
    s_lshr_b32 s63, s33, s64
    s_lshr_b32 s33, s33, s65
    s_and_b32 s63, s63, s33
    s_and_b32 s63, s63, 0xff
    s_andn2_b32 s63, s63, s66
    s_cbranch_scc0 K_SP3
    s_or_b32 s66, s66, s63
    s_branch K_SPR3
K_SP4:
    ds_read_b32 v2, v12 offset:32
    s_waitcnt lgkmcnt(0)
    v_readfirstlane_b32 s33, v2
    s_nop 3
    s_lshr_b32 s63, s33, s64
    s_lshr_b32 s33, s33, s65
    s_and_b32 s63, s63, s33
    s_and_b32 s63, s63, 0xff
    s_andn2_b32 s63, s63, s66
    s_cbranch_scc0 K_SP4
    s_or_b32 s66, s66, s63
    s_branch K_SPR4
K_SP5:
    ds_read_b32 v2, v12 offset:32
    s_waitcnt lgkmcnt(0)
    v_readfirstlane_b32 s33, v2
    s_nop 3
    s_lshr_b32 s63, s33, s64
    s_lshr_b32 s33, s33, s65
    s_and_b32 s63, s63, s33
    s_and_b32 s63, s63, 0xff
    s_andn2_b32 s63, s63, s66
    s_cbranch_scc0 K_SP5
    s_or_b32 s66, s66, s63
    s_branch K_SPR5
K_SP6:
    ds_read_b32 v2, v12 offset:32
    s_waitcnt lgkmcnt(0)
    v_readfirstlane_b32 s33, v2
    s_nop 3
    s_lshr_b32 s63, s33, s64
    s_lshr_b32 s33, s33, s65
    s_and_b32 s63, s63, s33
    s_and_b32 s63, s63, 0xff
    s_andn2_b32 s63, s63, s66
    s_cbranch_scc0 K_SP6
    s_or_b32 s66, s66, s63
    s_branch K_SPR6
K_SP8:
    ds_read_b32 v2, v12 offset:32
    s_waitcnt lgkmcnt(0)
    v_readfirstlane_b32 s33, v2
    s_nop 3
    s_lshr_b32 s63, s33, s64
    s_lshr_b32 s33, s33, s65
    s_and_b32 s63, s63, s33
    s_and_b32 s63, s63, 0xff
    s_andn2_b32 s63, s63, s66
    s_cbranch_scc0 K_SP8
    s_or_b32 s66, s66, s63
    s_branch K_SPR8
K_SP10:
    ds_read_b32 v2, v12 offset:32
    s_waitcnt lgkmcnt(0)
    v_readfirstlane_b32 s33, v2
    s_nop 3
    s_lshr_b32 s63, s33, s64
    s_lshr_b32 s33, s33, s65
    s_and_b32 s63, s63, s33
    s_and_b32 s63, s63, 0xff00
    s_andn2_b32 s63, s63, s66
    s_cbranch_scc0 K_SP10
    s_or_b32 s66, s66, s63
    s_branch K_SPR10
K_SP11:
    ds_read_b32 v2, v12 offset:32
    s_waitcnt lgkmcnt(0)
    v_readfirstlane_b32 s33, v2
    s_nop 3
    s_lshr_b32 s63, s33, s64
    s_lshr_b32 s33, s33, s65
    s_and_b32 s63, s63, s33
    s_and_b32 s63, s63, 0xff00
    s_andn2_b32 s63, s63, s66
    s_cbranch_scc0 K_SP11
    s_or_b32 s66, s66, s63
    s_branch K_SPR11
K_SP12:
    ds_read_b32 v2, v12 offset:32
    s_waitcnt lgkmcnt(0)
    v_readfirstlane_b32 s33, v2
    s_nop 3
    s_lshr_b32 s63, s33, s64
    s_lshr_b32 s33, s33, s65
    s_and_b32 s63, s63, s33
    s_and_b32 s63, s63, 0xff00
    s_andn2_b32 s63, s63, s66
    s_cbranch_scc0 K_SP12
    s_or_b32 s66, s66, s63
    s_branch K_SPR12
K_SP13:
    ds_read_b32 v2, v12 offset:32
    s_waitcnt lgkmcnt(0)
    v_readfirstlane_b32 s33, v2
    s_nop 3
    s_lshr_b32 s63, s33, s64
    s_lshr_b32 s33, s33, s65
    s_and_b32 s63, s63, s33
    s_and_b32 s63, s63, 0xff00
    s_andn2_b32 s63, s63, s66
    s_cbranch_scc0 K_SP13
    s_or_b32 s66, s66, s63
    s_branch K_SPR13
K_SP14:
    ds_read_b32 v2, v12 offset:32
    s_waitcnt lgkmcnt(0)
    v_readfirstlane_b32 s33, v2
    s_nop 3
    s_lshr_b32 s63, s33, s64
    s_lshr_b32 s33, s33, s65
    s_and_b32 s63, s63, s33
    s_and_b32 s63, s63, 0xff00
    s_andn2_b32 s63, s63, s66
    s_cbranch_scc0 K_SP14
    s_or_b32 s66, s66, s63
    s_branch K_SPR14
K_SP15:
    ds_read_b32 v2, v12 offset:32
    s_waitcnt lgkmcnt(0)
    v_readfirstlane_b32 s33, v2
    s_nop 3
    s_lshr_b32 s63, s33, s64
    s_lshr_b32 s33, s33, s65
    s_and_b32 s63, s63, s33
    s_and_b32 s63, s63, 0xff00
    s_andn2_b32 s63, s63, s66
    s_cbranch_scc0 K_SP15
    s_or_b32 s66, s66, s63
    s_branch K_SPR15
K_SP16:
    ds_read_b32 v2, v12 offset:32
    s_waitcnt lgkmcnt(0)
    v_readfirstlane_b32 s33, v2
    s_nop 3
    s_lshr_b32 s63, s33, s64
    s_lshr_b32 s33, s33, s65
    s_and_b32 s63, s63, s33
    s_and_b32 s63, s63, 0xff00
    s_andn2_b32 s63, s63, s66
    s_cbranch_scc0 K_SP16
    s_or_b32 s66, s66, s63
    s_branch K_SPR16
K_SP18:
    ds_read_b32 v2, v12 offset:32
    s_waitcnt lgkmcnt(0)
    v_readfirstlane_b32 s33, v2
    s_nop 3
    s_lshr_b32 s63, s33, s64
    s_lshr_b32 s33, s33, s65
    s_and_b32 s63, s63, s33
    s_and_b32 s63, s63, 0xff00
    s_andn2_b32 s63, s63, s66
    s_cbranch_scc0 K_SP18
    s_or_b32 s66, s66, s63
    s_branch K_SPR18
WP_yr0:
    s_setpc_b64 s[38:39]
K_YROW0:
    v_lshlrev_b32 v5, 4, v9
    v_add_u32 v5, 158976, v5
    v_and_b32 v3, 15, v1
    s_and_b32 s33, s59, 15
    v_cmp_eq_u32 vcc, s33, v3
    s_mov_b32 s3, 1048576
K_P2_GY0:
    ds_read_b32 v2, v12 offset:64
    s_sub_u32 s3, s3, 1
    s_waitcnt lgkmcnt(0)
    v_readfirstlane_b32 s33, v2
    s_nop 3
    s_cselect_b32 s33, 1, s33
    s_cmp_lt_u32 s33, 1
    s_cbranch_scc1 K_P2_GY0
    s_mov_b64 exec, vcc
    s_cmp_ge_u32 s59, 16
    s_cbranch_scc1 K_YR1_0
    ds_read_b128 v[72:75], v5 offset:0
    ds_read_b128 v[76:79], v5 offset:64
    ds_read_b128 v[80:83], v5 offset:128
    ds_read_b128 v[84:87], v5 offset:192
    s_mov_b64 exec, -1
    s_branch K_NOY0
K_YR1_0:
    ds_read_b128 v[88:91], v5 offset:0
    ds_read_b128 v[92:95], v5 offset:64
    ds_read_b128 v[96:99], v5 offset:128
    ds_read_b128 v[100:103], v5 offset:192
    s_mov_b64 exec, -1
    s_branch K_NOY0
K_YROW1:
    v_lshlrev_b32 v5, 4, v9
    v_add_u32 v5, 159232, v5
    v_and_b32 v3, 15, v1
    s_and_b32 s33, s59, 15
    v_cmp_eq_u32 vcc, s33, v3
    s_mov_b32 s3, 1048576
K_P2_GY1:
    ds_read_b32 v2, v12 offset:68
    s_sub_u32 s3, s3, 1
    s_waitcnt lgkmcnt(0)
    v_readfirstlane_b32 s33, v2
    s_nop 3
    s_cselect_b32 s33, 1, s33
    s_cmp_lt_u32 s33, 1
    s_cbranch_scc1 K_P2_GY1
    s_mov_b64 exec, vcc
    s_cmp_ge_u32 s59, 16
    s_cbranch_scc1 K_YR1_1
    ds_read_b128 v[72:75], v5 offset:0
    ds_read_b128 v[76:79], v5 offset:64
    ds_read_b128 v[80:83], v5 offset:128
    ds_read_b128 v[84:87], v5 offset:192
    s_mov_b64 exec, -1
    s_branch K_NOY1
K_YR1_1:
    ds_read_b128 v[88:91], v5 offset:0
    ds_read_b128 v[92:95], v5 offset:64
    ds_read_b128 v[96:99], v5 offset:128
    ds_read_b128 v[100:103], v5 offset:192
    s_mov_b64 exec, -1
    s_branch K_NOY1
.p2align 12
WP_gen:
    s_setpc_b64 s[38:39]
K_P2:
    s_cmp_ge_u32 s30, 4
    s_cbranch_scc1 K_P2_HELP
    v_mov_b32 v12, 158720
    s_cmp_lg_u32 s30, 0
    s_cbranch_scc1 K_P2_W13
    v_lshrrev_b32 v3, 4, v1
    v_and_b32 v4, 7, v1
    v_lshrrev_b32 v2, 3, v1
    v_xor_b32 v4, v4, v3
    v_mul_u32_u24 v2, 1280, v2
    v_lshl_add_u32 v27, v4, 4, v2
    v_xor_b32 v28, 64, v27
    s_mov_b32 s58, 0
K_P2_XD:
    s_lshl_b32 s59, s40, 3
    s_lshl1_add_u32 s59, s58, s59
    s_mul_i32 s59, s59, 20480
    s_lshl_b32 s33, s41, 7
    s_add_u32 s59, s59, s33
    s_lshl_b32 s33, s58, 12
    s_add_u32 m0, s33, 140288
    s_add_u32 s3, s59, 0
    buffer_load_dwordx4 v27, s[12:15], s3 offen lds
    s_add_u32 m0, s33, 141312
    s_add_u32 s3, s59, 10240
    buffer_load_dwordx4 v28, s[12:15], s3 offen lds
    s_add_u32 m0, s33, 142336
    s_add_u32 s3, s59, 20480
    buffer_load_dwordx4 v27, s[12:15], s3 offen lds
    s_add_u32 m0, s33, 143360
    s_add_u32 s3, s59, 30720
    buffer_load_dwordx4 v28, s[12:15], s3 offen lds
    s_add_u32 s58, s58, 1
    s_cmp_lt_u32 s58, 4
    s_cbranch_scc1 K_P2_XD
    s_waitcnt vmcnt(0)
    s_branch K_P2_AUXW
K_P2_W13:
    v_lshrrev_b32 v2, 3, v1
    v_mul_u32_u24 v2, 1280, v2
    v_lshrrev_b32 v3, 4, v1
    v_lshlrev_b32 v3, 1, v3
    v_and_b32 v4, 7, v1
    v_xor_b32 v3, v3, v4
    v_lshl_add_u32 v2, v3, 4, v2
    s_lshl_b32 s33, s41, 7
    v_add_u32 v22, s33, v2
    s_mov_b32 s60, 0xfda87520
    s_mov_b32 s61, 0xecb96431
    s_sub_u32 s58, s30, 1
K_P2_WS:
    s_lshl_b32 s3, s58, 2
    s_lshr_b64 s[4:5], s[60:61], s3
    s_and_b32 s4, s4, 15
    s_mul_i32 s4, s4, 51200
    s_mul_i32 s59, s58, 5120
    s_add_u32 s52, s4, 0
    s_add_u32 m0, s59, 0
    s_waitcnt vmcnt(11)
    buffer_load_dwordx4 v22, s[24:27], s52 offen lds
    s_add_u32 s52, s4, 10240
    s_add_u32 m0, s59, 1024
    s_waitcnt vmcnt(11)
    buffer_load_dwordx4 v22, s[24:27], s52 offen lds
    s_add_u32 s52, s4, 20480
    s_add_u32 m0, s59, 2048
    s_waitcnt vmcnt(11)
    buffer_load_dwordx4 v22, s[24:27], s52 offen lds
    s_add_u32 s52, s4, 30720
    s_add_u32 m0, s59, 3072
    s_waitcnt vmcnt(11)
    buffer_load_dwordx4 v22, s[24:27], s52 offen lds
    s_add_u32 s52, s4, 40960
    s_add_u32 m0, s59, 4096
    s_waitcnt vmcnt(11)
    buffer_load_dwordx4 v22, s[24:27], s52 offen lds
    s_cmp_ge_u32 s58, 3
    s_cbranch_scc1 K_P2_WS1
    v_mov_b32 v3, 1
    s_waitcnt vmcnt(5)
    s_mov_b64 exec, 1
    ds_add_u32 v12, v3 offset:52
    s_mov_b64 exec, -1
K_P2_WS1:
    s_add_u32 s58, s58, 3
    s_cmp_lt_u32 s58, 16
    s_cbranch_scc1 K_P2_WS
K_P2_AUXW:
    v_mov_b32 v34, 1
    s_waitcnt vmcnt(10)
    s_mov_b64 exec, 1
    ds_add_u32 v12, v34 offset:72
    s_mov_b64 exec, -1
    s_lshl_b32 s54, s40, 7
    v_lshrrev_b32 v9, 4, v1
    v_mov_b32 v12, 158720
    s_add_u32 s20, s10, 0x100000
    s_addc_u32 s21, s11, 0
    s_mov_b32 s22, 0x280000
    s_mov_b32 s23, 0x20000
    s_add_u32 s16, s10, 0x1000
    s_addc_u32 s17, s11, 0
    s_mov_b32 s18, 0x2000
    s_mov_b32 s19, 0x20000
    s_mov_b32 s48, s6
    s_mov_b32 s49, s7
    s_mov_b32 s50, 0x280000
    s_mov_b32 s51, 0x20000
    s_lshl_b32 s53, s40, 3
    s_lshl1_add_u32 s53, s30, s53
    s_mov_b32 s55, 20480
    v_bfe_u32 v20, v1, 2, 2
    v_and_b32 v21, 3, v1
    s_mul_i32 s3, s53, 20480
    v_lshl_add_u32 v25, v1, 4, s3
    v_add_u32 v26, 20480, v25
    v_add_u32 v35, 16384, v25
    v_add_u32 v36, 16384, v26
    v_and_b32 v2, 15, v1
    s_lshl_b32 s3, s53, 6
    v_lshl_add_u32 v23, v2, 2, s3
    v_lshl_add_u32 v2, v9, 2, v20
    v_bfe_u32 v3, v2, 1, 2
    v_lshlrev_b32 v2, 7, v2
    v_lshl_add_u32 v2, v21, 3, v2
    v_lshl_add_u32 v24, v3, 5, v2
    v_lshrrev_b32 v3, 1, v20
    v_mul_u32_u24 v2, 40, v9
    v_add3_u32 v2, v2, 16, v20
    v_lshlrev_b32 v2, 7, v2
    v_lshl_add_u32 v2, v21, 3, v2
    v_xor_b32 v4, 0, v3
    v_lshl_add_u32 v60, v4, 5, v2
    v_xor_b32 v4, 1, v3
    v_lshl_add_u32 v61, v4, 5, v2
    v_xor_b32 v4, 2, v3
    v_lshl_add_u32 v62, v4, 5, v2
    v_xor_b32 v4, 3, v3
    v_lshl_add_u32 v63, v4, 5, v2
    v_lshrrev_b32 v3, 4, v1
    v_and_b32 v4, 7, v1
    v_lshrrev_b32 v2, 3, v1
    v_xor_b32 v4, v4, v3
    v_mul_u32_u24 v2, 1280, v2
    v_lshl_add_u32 v27, v4, 4, v2
    v_xor_b32 v28, 64, v27
    s_lshl_b32 s71, s40, 3
    s_lshl1_add_u32 s71, s30, s71
    s_mul_i32 s71, s71, 20480
    s_lshl_b32 s33, s41, 7
    s_add_u32 s71, s71, s33
    s_add_u32 s72, s71, 10240
    s_add_u32 s73, s71, 20480
    s_add_u32 s74, s71, 30720
    s_lshl_b32 s3, s30, 12
    s_add_u32 s3, s3, 140288
    v_lshl_add_u32 v33, v1, 4, s3
    v_and_b32 v2, 15, v1
    v_lshrrev_b32 v3, 1, v2
    v_lshrrev_b32 v4, 5, v1
    v_xor_b32 v3, v3, v4
    v_lshlrev_b32 v3, 4, v3
    v_lshl_add_u32 v3, v2, 7, v3
    v_and_b32 v4, 1, v9
    v_lshl_add_u32 v3, v4, 3, v3
    v_add_u32 v29, s3, v3
    v_xor_b32 v30, 32, v29
    v_xor_b32 v31, 64, v29
    v_xor_b32 v32, 96, v29
    s_and_b32 s33, s40, 3
    s_lshl_b32 s33, s33, 3
    s_lshr_b32 s33, 0x7f06037f, s33
    s_and_b32 s33, s33, 0xff
    s_lshl_b32 s3, s30, 1
    s_cmp_ge_u32 s3, s33
    s_cselect_b32 s64, 16, 0
    s_add_u32 s3, s3, 1
    s_cmp_ge_u32 s3, s33
    s_cselect_b32 s65, 16, 0
    s_mov_b32 s63, 0
    s_mov_b32 s66, 0
    s_mov_b32 s67, 16384
    s_mov_b32 s3, 1048576
K_P2_GWA:
    ds_read_b32 v2, v12 offset:72
    s_sub_u32 s3, s3, 1
    s_waitcnt lgkmcnt(0)
    v_readfirstlane_b32 s33, v2
    s_nop 3
    s_cselect_b32 s33, 4, s33
    s_cmp_lt_u32 s33, 4
    s_cbranch_scc1 K_P2_GWA
    s_branch K_P2_GEMM
WP_help:
    s_setpc_b64 s[38:39]
K_LATE:
    v_mov_b32 v6, 158800
    s_mov_b32 s3, 1048576
K_XGL:
    ds_read_b128 v[2:5], v6
    s_sleep 1
    s_sub_u32 s3, s3, 1
    s_waitcnt lgkmcnt(0)
    v_min3_u32 v2, v2, v4, v5
    v_min_u32 v2, v2, v3
    s_nop 0
    v_readfirstlane_b32 s33, v2
    s_nop 3
    s_cselect_b32 s33, 1, s33
    s_cmp_lt_u32 s33, 1
    s_cbranch_scc1 K_XGL
    s_sub_u32 s44, s30, 4
K_WOL:
    s_lshl_b32 s50, s44, 2
    s_lshr_b32 s50, 0x6431, s50
    s_and_b32 s50, s50, 7
    s_mul_i32 s50, s50, 51200
    s_mul_i32 s51, s44, 5120
    s_add_u32 s3, s50, 0
    s_add_u32 m0, s51, 40960
    s_waitcnt vmcnt(13)
    buffer_load_dwordx4 v17, s[24:27], s3 offen lds
    s_add_u32 s3, s50, 10240
    s_add_u32 m0, s51, 41984
    s_waitcnt vmcnt(13)
    buffer_load_dwordx4 v17, s[24:27], s3 offen lds
    s_add_u32 s3, s50, 20480
    s_add_u32 m0, s51, 43008
    s_waitcnt vmcnt(13)
    buffer_load_dwordx4 v17, s[24:27], s3 offen lds
    s_add_u32 s3, s50, 30720
    s_add_u32 m0, s51, 44032
    s_waitcnt vmcnt(13)
    buffer_load_dwordx4 v17, s[24:27], s3 offen lds
    s_add_u32 s3, s50, 40960
    s_add_u32 m0, s51, 45056
    s_waitcnt vmcnt(13)
    buffer_load_dwordx4 v17, s[24:27], s3 offen lds
    s_add_u32 s3, s50, 409600
    s_add_u32 m0, s51, 61440
    s_waitcnt vmcnt(13)
    buffer_load_dwordx4 v17, s[24:27], s3 offen lds
    s_add_u32 s3, s50, 419840
    s_add_u32 m0, s51, 62464
    s_waitcnt vmcnt(13)
    buffer_load_dwordx4 v17, s[24:27], s3 offen lds
    s_add_u32 s3, s50, 430080
    s_add_u32 m0, s51, 63488
    s_waitcnt vmcnt(13)
    buffer_load_dwordx4 v17, s[24:27], s3 offen lds
    s_add_u32 s3, s50, 440320
    s_add_u32 m0, s51, 64512
    s_waitcnt vmcnt(13)
    buffer_load_dwordx4 v17, s[24:27], s3 offen lds
    s_add_u32 s3, s50, 450560
    s_add_u32 m0, s51, 65536
    s_waitcnt vmcnt(13)
    buffer_load_dwordx4 v17, s[24:27], s3 offen lds
    s_add_u32 s44, s44, 2
    s_cmp_lt_u32 s44, 4
    s_cbranch_scc1 K_WOL
    v_mov_b32 v2, 158720
    v_mov_b32 v3, 2
    s_waitcnt vmcnt(0)
    s_mov_b64 exec, 1
    ds_add_u32 v2, v3 offset:44
    s_mov_b64 exec, -1
K_P2_HELP:
    s_setprio 3
    s_add_u32 s59, s40, 1
    s_bitcmp1_b32 s59, 1
    s_cselect_b32 s59, 31, 15
    v_and_b32 v10, s59, v1
    v_lshl_add_u32 v10, v10, 2, s42
    s_cmp_lg_u32 s30, 7
    s_cbranch_scc1 K_P2_N7
    v_and_b32 v4, 7, v1
    v_lshlrev_b32 v4, 2, v4
    s_mov_b32 s3, 131072
K_ZPOLL1:
    v_cmp_eq_u32 vcc, 0, v7
    s_cbranch_vccz K_ZOK1
    s_sub_u32 s3, s3, 1
    s_cbranch_scc1 K_ZOK1
    global_load_dword v7, v4, s[8:9] offset:192 sc1
    s_waitcnt vmcnt(0)
    s_branch K_ZPOLL1
K_ZOK1:
    global_load_dword v7, v10, s[10:11] sc1
K_P2_N7:
    s_lshl_b32 s54, s40, 7
    v_lshrrev_b32 v9, 4, v1
    v_mov_b32 v12, 158720
    s_add_u32 s44, s10, 0x10000
    s_addc_u32 s45, s11, 0
    s_mov_b32 s46, 0x43800
    s_mov_b32 s47, 0x20000
    v_mov_b32 v80, 1
    s_cmp_eq_u32 s30, 7
    s_cbranch_scc1 K_P2_FLAGS
    s_cmp_lg_u32 s30, 6
    s_cbranch_scc1 K_END
    s_mov_b32 s3, 131072
K_P2_DPOLL:
    v_cmp_eq_u32 vcc, 0, v7
    s_cbranch_vccz K_P2_DOK
    s_cmp_eq_u32 s3, 131072
    s_cbranch_scc1 K_P2_DNS
    s_sleep 12
K_P2_DNS:
    v_and_b32 v11, 1, v1
    v_lshl_add_u32 v11, v11, 2, s42
    global_load_dword v7, v11, s[10:11] offset:128 sc1
    s_sub_u32 s3, s3, 1
    s_waitcnt vmcnt(0)
    s_cmp_lg_u32 s3, 0
    s_cbranch_scc1 K_P2_DPOLL
K_P2_DOK:
    v_readlane_b32 s58, v7, 0
    v_readlane_b32 s59, v7, 1
    s_nop 3
    s_and_b32 s3, s58, 0x7ff
    s_sub_u32 s3, 2047, s3
    v_mov_b32 v20, s3
    v_mov_b32 v4, s58
    v_and_b32 v4, 0xffff0000, v4
    v_ashrrev_i32 v5, 31, v4
    v_not_b32 v5, v5
    v_or_b32 v5, 0x80000000, v5
    v_xor_b32 v4, v4, v5
    v_and_b32 v4, 0xffff0000, v4
    v_mul_f32 v5, 0xbfb8aa3b, v4
    v_exp_f32 v5, v5
    s_nop 0
    v_add_f32 v5, 1.0, v5
    v_rcp_f32 v4, v5
    s_nop 0
    v_cvt_pk_bf16_f32 v22, v4, v4
    v_lshlrev_b32 v22, 16, v22
    s_and_b32 s3, s59, 0x7ff
    s_sub_u32 s3, 2047, s3
    v_mov_b32 v21, s3
    v_mov_b32 v4, s59
    v_and_b32 v4, 0xffff0000, v4
    v_ashrrev_i32 v5, 31, v4
    v_not_b32 v5, v5
    v_or_b32 v5, 0x80000000, v5
    v_xor_b32 v4, v4, v5
    v_and_b32 v4, 0xffff0000, v4
    v_mul_f32 v5, 0xbfb8aa3b, v4
    v_exp_f32 v5, v5
    s_nop 0
    v_add_f32 v5, 1.0, v5
    v_rcp_f32 v4, v5
    s_nop 0
    v_cvt_pk_bf16_f32 v23, v4, v4
    v_lshlrev_b32 v23, 16, v23
    ds_write_b128 v12, v[20:23]
    ds_write_b32 v12, v80 offset:40
    s_mov_b32 s53, 0
    v_mov_b32 v16, v20
    v_mov_b32 v17, v21
    v_mov_b32 v18, v22
    v_mov_b32 v19, v23
K_P2_HW:
    s_cmp_eq_u32 s53, 0
    s_cselect_b64 vcc, -1, 0
    s_nop 1
    v_cndmask_b32 v2, v17, v16, vcc
    v_cndmask_b32 v5, v19, v18, vcc
    s_nop 0
    v_readfirstlane_b32 s58, v2
    s_nop 3
    s_sub_u32 s3, s58, s54
    s_cmp_lt_u32 s3, 128
    s_cbranch_scc0 K_P2_YN
    s_call_b64 s[38:39], WP_yr0
    s_mul_i32 s3, s58, 1280
    s_lshl_b32 s33, s41, 7
    s_add_u32 s3, s3, s33
    v_and_b32 v2, 15, v1
    v_lshlrev_b32 v2, 3, v2
    buffer_load_dwordx2 v[84:85], v2, s[12:15], s3 offen
    s_lshl_b32 s3, s58, 2
    s_add_u32 s3, s3, 4096
    v_mov_b32 v2, s3
    global_load_dword v88, v2, s[10:11] sc1
    s_lshl1_add_u32 s3, s41, s53
    s_lshl_b32 s3, s3, 8
    s_add_u32 s3, s3, 568320
    v_min_u32 v3, 53, v1
    v_lshl_add_u32 v3, v3, 2, s3
    s_mov_b32 s3, 131072
K_P2_YPOLL:
    global_load_dword v2, v3, s[10:11] sc1
    s_sub_u32 s3, s3, 1
    s_waitcnt vmcnt(0)
    v_cmp_ne_u32 vcc, 1, v2
    s_cbranch_vccz K_P2_YGO
    s_sleep 16
    s_cmp_lg_u32 s3, 0
    s_cbranch_scc1 K_P2_YPOLL
K_P2_YGO:
    v_and_b32 v2, 15, v1
    v_lshlrev_b32 v2, 4, v2
    v_mul_u32_u24 v4, 5120, v9
    s_mov_b32 s59, s53
    s_mul_i32 s33, s59, 2560
    s_lshl_b32 s3, s41, 8
    s_add_u32 s3, s3, s33
    v_add3_u32 v3, v2, v4, s3
    s_mov_b32 s52, 0
    buffer_load_dwordx4 v[24:27], v3, s[44:47], s52 offen sc1
    s_mov_b32 s52, 20480
    buffer_load_dwordx4 v[28:31], v3, s[44:47], s52 offen sc1
    s_mov_b32 s52, 40960
    buffer_load_dwordx4 v[32:35], v3, s[44:47], s52 offen sc1
    s_mov_b32 s52, 61440
    buffer_load_dwordx4 v[36:39], v3, s[44:47], s52 offen sc1
    s_mov_b32 s52, 81920
    buffer_load_dwordx4 v[40:43], v3, s[44:47], s52 offen sc1
    s_mov_b32 s52, 102400
    buffer_load_dwordx4 v[44:47], v3, s[44:47], s52 offen sc1
    s_mov_b32 s52, 122880
    buffer_load_dwordx4 v[48:51], v3, s[44:47], s52 offen sc1
    s_mov_b32 s52, 143360
    buffer_load_dwordx4 v[52:55], v3, s[44:47], s52 offen sc1
    s_mov_b32 s52, 163840
    buffer_load_dwordx4 v[56:59], v3, s[44:47], s52 offen sc1
    s_mov_b32 s52, 184320
    buffer_load_dwordx4 v[60:63], v3, s[44:47], s52 offen sc1
    s_mov_b32 s52, 204800
    buffer_load_dwordx4 v[64:67], v3, s[44:47], s52 offen sc1
    s_mov_b32 s52, 225280
    buffer_load_dwordx4 v[68:71], v3, s[44:47], s52 offen sc1
    s_mov_b32 s52, 245760
    buffer_load_dwordx4 v[72:75], v3, s[44:47], s52 offen sc1
    s_mov_b32 s52, 266240
    buffer_load_dwordx4 v[76:79], v3, s[44:47], s52 offen sc1
    v_sub_f32 v88, 1.0, v88
    v_cvt_pk_bf16_f32 v88, v88, v88
    v_lshlrev_b32 v88, 16, v88
    v_lshlrev_b32 v86, 16, v85
    v_and_b32 v87, 0xffff0000, v85
    v_and_b32 v85, 0xffff0000, v84
    v_lshlrev_b32 v84, 16, v84
    s_waitcnt vmcnt(12)
    v_add_f32 v20, v24, v28
    v_add_f32 v21, v25, v29
    v_add_f32 v22, v26, v30
    v_add_f32 v23, v27, v31
    s_waitcnt vmcnt(11)
    v_add_f32 v20, v20, v32
    v_add_f32 v21, v21, v33
    v_add_f32 v22, v22, v34
    v_add_f32 v23, v23, v35
    s_waitcnt vmcnt(10)
    v_add_f32 v20, v20, v36
    v_add_f32 v21, v21, v37
    v_add_f32 v22, v22, v38
    v_add_f32 v23, v23, v39
    s_waitcnt vmcnt(9)
    v_add_f32 v20, v20, v40
    v_add_f32 v21, v21, v41
    v_add_f32 v22, v22, v42
    v_add_f32 v23, v23, v43
    s_waitcnt vmcnt(8)
    v_add_f32 v20, v20, v44
    v_add_f32 v21, v21, v45
    v_add_f32 v22, v22, v46
    v_add_f32 v23, v23, v47
    s_waitcnt vmcnt(7)
    v_add_f32 v20, v20, v48
    v_add_f32 v21, v21, v49
    v_add_f32 v22, v22, v50
    v_add_f32 v23, v23, v51
    s_waitcnt vmcnt(6)
    v_add_f32 v20, v20, v52
    v_add_f32 v21, v21, v53
    v_add_f32 v22, v22, v54
    v_add_f32 v23, v23, v55
    s_waitcnt vmcnt(5)
    v_add_f32 v20, v20, v56
    v_add_f32 v21, v21, v57
    v_add_f32 v22, v22, v58
    v_add_f32 v23, v23, v59
    s_waitcnt vmcnt(4)
    v_add_f32 v20, v20, v60
    v_add_f32 v21, v21, v61
    v_add_f32 v22, v22, v62
    v_add_f32 v23, v23, v63
    s_waitcnt vmcnt(3)
    v_add_f32 v20, v20, v64
    v_add_f32 v21, v21, v65
    v_add_f32 v22, v22, v66
    v_add_f32 v23, v23, v67
    s_waitcnt vmcnt(2)
    v_add_f32 v20, v20, v68
    v_add_f32 v21, v21, v69
    v_add_f32 v22, v22, v70
    v_add_f32 v23, v23, v71
    s_waitcnt vmcnt(1)
    v_add_f32 v20, v20, v72
    v_add_f32 v21, v21, v73
    v_add_f32 v22, v22, v74
    v_add_f32 v23, v23, v75
    s_waitcnt vmcnt(0)
    v_add_f32 v20, v20, v76
    v_add_f32 v21, v21, v77
    v_add_f32 v22, v22, v78
    v_add_f32 v23, v23, v79
    v_mov_b32 v24, v20
    v_mov_b32 v25, v21
    v_mov_b32 v26, v22
    v_mov_b32 v27, v23
    s_nop 0
    v_permlane16_swap_b32 v20, v24
    v_permlane16_swap_b32 v21, v25
    v_permlane16_swap_b32 v22, v26
    v_permlane16_swap_b32 v23, v27
    v_add_f32 v20, v20, v24
    v_add_f32 v21, v21, v25
    v_add_f32 v22, v22, v26
    v_add_f32 v23, v23, v27
    v_mov_b32 v24, v20
    v_mov_b32 v25, v21
    v_mov_b32 v26, v22
    v_mov_b32 v27, v23
    s_nop 0
    v_permlane32_swap_b32 v20, v24
    v_permlane32_swap_b32 v21, v25
    v_permlane32_swap_b32 v22, v26
    v_permlane32_swap_b32 v23, v27
    v_add_f32 v20, v20, v24
    v_add_f32 v21, v21, v25
    v_add_f32 v22, v22, v26
    v_add_f32 v23, v23, v27
    v_cvt_pk_bf16_f32 v20, v20, v20
    v_lshlrev_b32 v20, 16, v20
    v_mul_f32 v20, v5, v20
    v_cvt_pk_bf16_f32 v20, v20, v20
    v_lshlrev_b32 v20, 16, v20
    v_add_f32 v20, v20, v84
    v_cvt_pk_bf16_f32 v20, v20, v20
    v_lshlrev_b32 v20, 16, v20
    v_mul_f32 v20, v20, v88
    v_cvt_pk_bf16_f32 v21, v21, v21
    v_lshlrev_b32 v21, 16, v21
    v_mul_f32 v21, v5, v21
    v_cvt_pk_bf16_f32 v21, v21, v21
    v_lshlrev_b32 v21, 16, v21
    v_add_f32 v21, v21, v85
    v_cvt_pk_bf16_f32 v21, v21, v21
    v_lshlrev_b32 v21, 16, v21
    v_mul_f32 v21, v21, v88
    v_cvt_pk_bf16_f32 v22, v22, v22
    v_lshlrev_b32 v22, 16, v22
    v_mul_f32 v22, v5, v22
    v_cvt_pk_bf16_f32 v22, v22, v22
    v_lshlrev_b32 v22, 16, v22
    v_add_f32 v22, v22, v86
    v_cvt_pk_bf16_f32 v22, v22, v22
    v_lshlrev_b32 v22, 16, v22
    v_mul_f32 v22, v22, v88
    v_cvt_pk_bf16_f32 v23, v23, v23
    v_lshlrev_b32 v23, 16, v23
    v_mul_f32 v23, v5, v23
    v_cvt_pk_bf16_f32 v23, v23, v23
    v_lshlrev_b32 v23, 16, v23
    v_add_f32 v23, v23, v87
    v_cvt_pk_bf16_f32 v23, v23, v23
    v_lshlrev_b32 v23, 16, v23
    v_mul_f32 v23, v23, v88
    s_lshl_b32 s3, s59, 8
    s_add_u32 s3, s3, 158976
    v_add_u32 v2, s3, v2
    ds_write_b128 v2, v[20:23]
    s_lshl_b32 s3, s59, 2
    v_add_u32 v2, s3, v12
    ds_write_b32 v2, v80 offset:64
K_P2_YN:
    s_add_u32 s53, s53, 1
    s_cmp_lt_u32 s53, 2
    s_cbranch_scc1 K_P2_HW
    s_branch K_END
WP_flags:
    s_setpc_b64 s[38:39]
K_P2_FLAGS:
    s_mov_b32 exec_hi, 0
    s_waitcnt vmcnt(0)
    s_mov_b32 s3, 131072
K_P2_FCHK:
    v_cmp_eq_u32 vcc, 1, v7
    s_nop 1
    v_mov_b32 v2, vcc_lo
    ds_write_b32 v12, v2 offset:32
    s_cmp_eq_u32 vcc_lo, -1
    s_cbranch_scc1 K_P2_FGO
    s_cmp_lg_u32 vcc_lo, 0
    s_cbranch_scc1 K_P2_FS
    s_sleep 4
K_P2_FS:
    s_sleep 6
    global_load_dword v7, v10, s[10:11] sc1
    s_sub_u32 s3, s3, 1
    s_waitcnt vmcnt(0)
    s_cbranch_scc0 K_P2_FCHK
    v_mov_b32 v2, -1
    ds_write_b32 v12, v2 offset:32
K_P2_FGO:
    s_mov_b64 exec, -1
    s_branch K_END
.p2align 12
K_AUX:
    s_load_dwordx8 s[48:55], s[0:1], 32
    s_load_dwordx2 s[56:57], s[0:1], 64
    s_mul_i32 s44, s28, 7
    s_add_u32 s44, s44, s29
    s_sub_u32 s44, s44, 1
    s_cmp_lt_u32 s44, 54
    s_cselect_b32 s44, s44, 63
    s_cmp_eq_u32 s29, 0
    s_cselect_b32 s44, 63, s44
    s_lshl_b32 s74, s28, 8
    s_lshl_b32 s3, s29, 5
    s_add_u32 s74, s74, s3
    v_mov_b32 v12, 158720
    v_mov_b32 v13, 1
    s_cmp_lt_u32 s30, 4
    s_cbranch_scc1 K_AUX_LO
    s_lshl_b32 s3, s30, 3
    s_add_u32 s3, s3, s74
    s_sub_u32 s3, s3, 32
    v_lshrrev_b32 v9, 3, v1
    v_add_u32 v9, s3, v9
    v_and_b32 v11, 7, v1
    v_lshlrev_b32 v11, 4, v11
    v_mul_u32_u24 v10, 1280, v9
    v_add_u32 v10, v10, v11
    s_waitcnt lgkmcnt(0)
    buffer_load_dwordx4 v[16:19], v10, s[12:15], 0 offen offset:0
    buffer_load_dwordx4 v[20:23], v10, s[12:15], 0 offen offset:128
    buffer_load_dwordx4 v[24:27], v10, s[12:15], 0 offen offset:256
    buffer_load_dwordx4 v[28:31], v10, s[12:15], 0 offen offset:384
    buffer_load_dwordx4 v[32:35], v10, s[12:15], 0 offen offset:512
    buffer_load_dwordx4 v[36:39], v10, s[12:15], 0 offen offset:640
    buffer_load_dwordx4 v[40:43], v10, s[12:15], 0 offen offset:768
    buffer_load_dwordx4 v[44:47], v10, s[12:15], 0 offen offset:896
    buffer_load_dwordx4 v[48:51], v10, s[12:15], 0 offen offset:1024
    buffer_load_dwordx4 v[52:55], v10, s[12:15], 0 offen offset:1152
    s_mov_b32 s16, s48
    s_mov_b32 s17, s49
    s_mov_b32 s18, 0x500
    s_mov_b32 s19, 0x20000
    s_mov_b32 s20, s56
    s_mov_b32 s21, s57
    s_mov_b32 s22, 0x500
    s_mov_b32 s23, 0x20000
    buffer_load_dwordx4 v[56:59], v11, s[16:19], 0 offen offset:0
    buffer_load_dwordx4 v[60:63], v11, s[16:19], 0 offen offset:128
    buffer_load_dwordx4 v[64:67], v11, s[16:19], 0 offen offset:256
    buffer_load_dwordx4 v[68:71], v11, s[16:19], 0 offen offset:384
    buffer_load_dwordx4 v[72:75], v11, s[16:19], 0 offen offset:512
    buffer_load_dwordx4 v[76:79], v11, s[16:19], 0 offen offset:640
    buffer_load_dwordx4 v[80:83], v11, s[16:19], 0 offen offset:768
    buffer_load_dwordx4 v[84:87], v11, s[16:19], 0 offen offset:896
    buffer_load_dwordx4 v[88:91], v11, s[16:19], 0 offen offset:1024
    buffer_load_dwordx4 v[92:95], v11, s[16:19], 0 offen offset:1152
    buffer_load_dwordx4 v[96:99], v11, s[20:23], 0 offen offset:0
    buffer_load_dwordx4 v[100:103], v11, s[20:23], 0 offen offset:128
    buffer_load_dwordx4 v[104:107], v11, s[20:23], 0 offen offset:256
    buffer_load_dwordx4 v[108:111], v11, s[20:23], 0 offen offset:384
    buffer_load_dwordx4 v[112:115], v11, s[20:23], 0 offen offset:512
    buffer_load_dwordx4 v[116:119], v11, s[20:23], 0 offen offset:640
    buffer_load_dwordx4 v[120:123], v11, s[20:23], 0 offen offset:768
    buffer_load_dwordx4 v[124:127], v11, s[20:23], 0 offen offset:896
    buffer_load_dwordx4 v[128:131], v11, s[20:23], 0 offen offset:1024
    buffer_load_dwordx4 v[132:135], v11, s[20:23], 0 offen offset:1152
    s_barrier
    v_mov_b32 v180, 0
    v_mov_b32 v181, 0
    v_mov_b32 v182, 0
    v_mov_b32 v183, 0
    v_and_b32 v10, 31, v9
    v_lshlrev_b32 v10, 2, v10
    v_add_u32 v10, 122880, v10
    v_sub_u32 v4, 0x87ff, v9
    s_setprio 2
    s_waitcnt vmcnt(10)
    v_dot2c_f32_bf16 v180, v16, v56
    v_dot2c_f32_bf16 v181, v17, v57
    v_dot2c_f32_bf16 v180, v18, v58
    v_dot2c_f32_bf16 v181, v19, v59
    v_dot2c_f32_bf16 v180, v20, v60
    v_dot2c_f32_bf16 v181, v21, v61
    v_dot2c_f32_bf16 v180, v22, v62
    v_dot2c_f32_bf16 v181, v23, v63
    v_dot2c_f32_bf16 v180, v24, v64
    v_dot2c_f32_bf16 v181, v25, v65
    v_dot2c_f32_bf16 v180, v26, v66
    v_dot2c_f32_bf16 v181, v27, v67
    v_dot2c_f32_bf16 v180, v28, v68
    v_dot2c_f32_bf16 v181, v29, v69
    v_dot2c_f32_bf16 v180, v30, v70
    v_dot2c_f32_bf16 v181, v31, v71
    v_dot2c_f32_bf16 v180, v32, v72
    v_dot2c_f32_bf16 v181, v33, v73
    v_dot2c_f32_bf16 v180, v34, v74
    v_dot2c_f32_bf16 v181, v35, v75
    v_dot2c_f32_bf16 v180, v36, v76
    v_dot2c_f32_bf16 v181, v37, v77
    v_dot2c_f32_bf16 v180, v38, v78
    v_dot2c_f32_bf16 v181, v39, v79
    v_dot2c_f32_bf16 v180, v40, v80
    v_dot2c_f32_bf16 v181, v41, v81
    v_dot2c_f32_bf16 v180, v42, v82
    v_dot2c_f32_bf16 v181, v43, v83
    v_dot2c_f32_bf16 v180, v44, v84
    v_dot2c_f32_bf16 v181, v45, v85
    v_dot2c_f32_bf16 v180, v46, v86
    v_dot2c_f32_bf16 v181, v47, v87
    v_dot2c_f32_bf16 v180, v48, v88
    v_dot2c_f32_bf16 v181, v49, v89
    v_dot2c_f32_bf16 v180, v50, v90
    v_dot2c_f32_bf16 v181, v51, v91
    v_dot2c_f32_bf16 v180, v52, v92
    v_dot2c_f32_bf16 v181, v53, v93
    v_dot2c_f32_bf16 v180, v54, v94
    v_dot2c_f32_bf16 v181, v55, v95
    s_waitcnt vmcnt(0)
    v_dot2c_f32_bf16 v182, v16, v96
    v_dot2c_f32_bf16 v183, v17, v97
    v_dot2c_f32_bf16 v182, v18, v98
    v_dot2c_f32_bf16 v183, v19, v99
    v_dot2c_f32_bf16 v182, v20, v100
    v_dot2c_f32_bf16 v183, v21, v101
    v_dot2c_f32_bf16 v182, v22, v102
    v_dot2c_f32_bf16 v183, v23, v103
    v_dot2c_f32_bf16 v182, v24, v104
    v_dot2c_f32_bf16 v183, v25, v105
    v_dot2c_f32_bf16 v182, v26, v106
    v_dot2c_f32_bf16 v183, v27, v107
    v_dot2c_f32_bf16 v182, v28, v108
    v_dot2c_f32_bf16 v183, v29, v109
    v_dot2c_f32_bf16 v182, v30, v110
    v_dot2c_f32_bf16 v183, v31, v111
    v_dot2c_f32_bf16 v182, v32, v112
    v_dot2c_f32_bf16 v183, v33, v113
    v_dot2c_f32_bf16 v182, v34, v114
    v_dot2c_f32_bf16 v183, v35, v115
    v_dot2c_f32_bf16 v182, v36, v116
    v_dot2c_f32_bf16 v183, v37, v117
    v_dot2c_f32_bf16 v182, v38, v118
    v_dot2c_f32_bf16 v183, v39, v119
    v_dot2c_f32_bf16 v182, v40, v120
    v_dot2c_f32_bf16 v183, v41, v121
    v_dot2c_f32_bf16 v182, v42, v122
    v_dot2c_f32_bf16 v183, v43, v123
    v_dot2c_f32_bf16 v182, v44, v124
    v_dot2c_f32_bf16 v183, v45, v125
    v_dot2c_f32_bf16 v182, v46, v126
    v_dot2c_f32_bf16 v183, v47, v127
    v_dot2c_f32_bf16 v182, v48, v128
    v_dot2c_f32_bf16 v183, v49, v129
    v_dot2c_f32_bf16 v182, v50, v130
    v_dot2c_f32_bf16 v183, v51, v131
    v_dot2c_f32_bf16 v182, v52, v132
    v_dot2c_f32_bf16 v183, v53, v133
    v_dot2c_f32_bf16 v182, v54, v134
    v_dot2c_f32_bf16 v183, v55, v135
    s_nop 2
    v_add_f32 v180, v180, v181
    v_add_f32 v182, v182, v183
    s_nop 0
    v_add_f32_dpp v180, v180, v180 quad_perm:[1,0,3,2] row_mask:0xf bank_mask:0xf
    v_add_f32_dpp v182, v182, v182 quad_perm:[1,0,3,2] row_mask:0xf bank_mask:0xf
    s_nop 0
    v_add_f32_dpp v180, v180, v180 quad_perm:[2,3,0,1] row_mask:0xf bank_mask:0xf
    v_add_f32_dpp v182, v182, v182 quad_perm:[2,3,0,1] row_mask:0xf bank_mask:0xf
    s_nop 0
    v_add_f32_dpp v180, v180, v180 row_half_mirror row_mask:0xf bank_mask:0xf
    v_add_f32_dpp v182, v182, v182 row_half_mirror row_mask:0xf bank_mask:0xf
    v_cvt_pk_bf16_f32 v2, v180, v180
    v_lshlrev_b32 v2, 16, v2
    v_ashrrev_i32 v3, 31, v2
    v_or_b32 v3, 0x80000000, v3
    v_xor_b32 v2, v2, v3
    v_and_b32 v2, 0xffff0000, v2
    v_or_b32 v2, v2, v4
    ds_write2_b32 v10, v2, v182 offset0:0 offset1:32
    s_mov_b64 exec, 1
    ds_add_u32 v12, v13 offset:36
    s_mov_b64 exec, -1
    s_setprio 0
    s_cmp_lg_u32 s30, 4
    s_cbranch_scc1 K_WARMA0
    s_call_b64 s[38:39], WP_p2g
    s_branch K_WARMAX
K_WARMA0:
    s_cmp_lg_u32 s30, 5
    s_cbranch_scc1 K_WARMA1
    s_call_b64 s[38:39], WP_gen
    s_branch K_WARMAX
K_WARMA1:
    s_cmp_lg_u32 s30, 6
    s_cbranch_scc1 K_WARMA2
    s_call_b64 s[38:39], WP_help
    s_call_b64 s[38:39], WP_flags
    s_branch K_WARMAX
K_WARMA2:
    s_call_b64 s[38:39], WP_spin
K_WARMAX:
    s_cmp_ge_u32 s30, 6
    s_cselect_b32 s44, 63, s44
    s_cmp_lg_u32 s44, 63
    s_cbranch_scc1 K_FFN_C
    s_mov_b32 s3, 1048576
K_FGH:
    ds_read_b32 v2, v12 offset:48
    s_sleep 8
    s_sub_u32 s3, s3, 1
    s_waitcnt lgkmcnt(0)
    v_readfirstlane_b32 s33, v2
    s_nop 3
    s_cselect_b32 s33, 1, s33
    s_cmp_lt_u32 s33, 1
    s_cbranch_scc1 K_FGH
    s_cmp_eq_u32 s30, 6
    s_cbranch_scc1 K_P2_HELP
    v_mov_b32 v7, 1
    s_branch K_P2_HELP
K_AUX_LO:
    s_waitcnt lgkmcnt(0)
    s_cmp_eq_u32 s30, 0
    s_cbranch_scc1 K_AUX_PUB
    s_cmp_eq_u32 s44, 63
    s_cbranch_scc1 K_AUX_NOF
    s_and_b32 s3, s44, 1
    s_cmp_eq_u32 s3, 0
    s_cselect_b64 s[60:61], s[50:51], s[52:53]
    s_cselect_b64 s[64:65], s[52:53], s[50:51]
    s_cselect_b32 s75, 0, 40960
    s_mov_b32 s62, 0x21c000
    s_mov_b32 s63, 0x20000
    s_mov_b32 s66, 0x21c000
    s_mov_b32 s67, 0x20000
    v_lshrrev_b32 v2, 2, v1
    v_mul_u32_u24 v184, 3456, v2
    v_and_b32 v2, 3, v1
    v_lshl_add_u32 v184, v2, 4, v184
    s_lshl_b32 s72, s44, 6
    v_add_u32 v184, s72, v184
    s_sub_u32 s74, s30, 1
K_FSA0:
    s_lshl_b32 s73, s74, 10
    s_mul_i32 s72, s74, 55296
    s_add_u32 m0, s73, s75
    s_waitcnt vmcnt(7)
    buffer_load_dwordx4 v184, s[60:63], s72 offen lds
    s_add_u32 s74, s74, 3
    s_cmp_lt_u32 s74, 24
    s_cbranch_scc1 K_FSA0
    s_barrier
    s_mov_b32 s3, 1048576
K_FGPB:
    ds_read_b32 v2, v12 offset:36
    s_sleep 1
    s_sub_u32 s3, s3, 1
    s_waitcnt lgkmcnt(0)
    v_readfirstlane_b32 s33, v2
    s_nop 3
    s_cselect_b32 s33, 5, s33
    s_cmp_lt_u32 s33, 5
    s_cbranch_scc1 K_FGPB
K_FSA:
    s_lshl_b32 s73, s74, 10
    s_mul_i32 s72, s74, 55296
    s_add_u32 m0, s73, s75
    s_waitcnt vmcnt(7)
    buffer_load_dwordx4 v184, s[60:63], s72 offen lds
    s_add_u32 s74, s74, 3
    s_cmp_lt_u32 s74, 40
    s_cbranch_scc1 K_FSA
    s_sub_u32 s74, s74, 40
    s_xor_b32 s75, s75, 40960
    s_mov_b32 s68, s54
    s_mov_b32 s69, s55
    s_mov_b32 s70, 0x21c000
    s_mov_b32 s71, 0x20000
    s_mul_i32 s3, s44, 40960
    v_lshrrev_b32 v2, 3, v1
    v_mul_u32_u24 v2, 1280, v2
    v_lshrrev_b32 v3, 4, v1
    v_lshlrev_b32 v3, 1, v3
    v_and_b32 v4, 7, v1
    v_xor_b32 v3, v3, v4
    v_lshl_add_u32 v2, v3, 4, v2
    v_add_u32 v185, s3, v2
K_FSB:
    s_lshl_b32 s73, s74, 10
    s_mul_i32 s72, s74, 55296
    s_add_u32 m0, s73, s75
    s_waitcnt vmcnt(7)
    buffer_load_dwordx4 v184, s[64:67], s72 offen lds
    s_add_u32 s74, s74, 3
    s_cmp_lt_u32 s74, 40
    s_cbranch_scc1 K_FSB
    s_sub_u32 s74, s74, 40
    s_mov_b32 s75, 81920
K_FSD0:
    s_lshl_b32 s73, s74, 10
    s_and_b32 s72, s74, 3
    s_mul_i32 s72, s72, 10208
    s_lshl_b32 s3, s74, 5
    s_add_u32 s72, s72, s3
    s_add_u32 m0, s73, s75
    s_waitcnt vmcnt(7)
    buffer_load_dwordx4 v185, s[68:71], s72 offen lds
    s_add_u32 s74, s74, 3
    s_cmp_lt_u32 s74, 24
    s_cbranch_scc1 K_FSD0
    s_waitcnt vmcnt(8)
    s_mov_b64 exec, 1
    ds_add_u32 v12, v13 offset:56
    s_mov_b64 exec, -1
K_FSD:
    s_lshl_b32 s73, s74, 10
    s_and_b32 s72, s74, 3
    s_mul_i32 s72, s72, 10208
    s_lshl_b32 s3, s74, 5
    s_add_u32 s72, s72, s3
    s_add_u32 m0, s73, s75
    s_waitcnt vmcnt(7)
    buffer_load_dwordx4 v185, s[68:71], s72 offen lds
    s_add_u32 s74, s74, 3
    s_cmp_lt_u32 s74, 40
    s_cbranch_scc1 K_FSD
    s_mul_i32 s3, s29, 96
    s_lshl_b32 s72, s30, 5
    s_add_u32 s3, s3, s72
    s_sub_u32 s3, s3, 128
    v_lshrrev_b32 v2, 1, v1
    v_add_u32 v2, s3, v2
    v_mul_u32_u24 v2, 1280, v2
    v_and_b32 v3, 1, v1
    v_lshl_add_u32 v2, v3, 7, v2
    buffer_load_dword v6, v2, s[24:27], 0 offen offset:1024
K_AUX_WR:
    s_mov_b32 s3, 1048576
K_FGR:
    ds_read_b32 v2, v12 offset:60
    s_sleep 2
    s_sub_u32 s3, s3, 1
    s_waitcnt lgkmcnt(0)
    v_readfirstlane_b32 s33, v2
    s_nop 3
    s_cselect_b32 s33, 2, s33
    s_cmp_lt_u32 s33, 2
    s_cbranch_scc1 K_FGR
    s_branch K_P2
K_AUX_NOF:
    s_cmp_lg_u32 s2, 63
    s_cbranch_scc1 K_AUX_NOZ
    s_cmp_lg_u32 s30, 1
    s_cbranch_scc1 K_AUX_NOZ
    s_add_u32 s60, s10, 0x80000
    s_addc_u32 s61, s11, 0
    s_mov_b32 s62, 0xc000
    s_mov_b32 s63, 0x20000
    v_mov_b32 v9, 786432
    global_load_dword v10, v9, s[10:11] sc1
    v_lshlrev_b32 v11, 4, v1
    v_add_u32 v11, 790528, v11
    global_load_dword v6, v11, s[10:11] sc1
    s_barrier
    s_mov_b32 s3, 1048576
K_FGZ:
    ds_read_b32 v2, v12 offset:36
    s_sleep 2
    s_sub_u32 s3, s3, 1
    s_waitcnt lgkmcnt(0)
    v_readfirstlane_b32 s33, v2
    s_nop 3
    s_cselect_b32 s33, 4, s33
    s_cmp_lt_u32 s33, 4
    s_cbranch_scc1 K_FGZ
    v_and_b32 v4, 7, v1
    v_lshlrev_b32 v4, 2, v4
    global_load_dword v7, v4, s[8:9] offset:192 sc1
    s_waitcnt vmcnt(1)
    v_add_u32 v10, 1, v10
    s_mov_b32 s3, 131072
    s_setprio 3
K_AG2_POLL:
    global_load_dwordx4 v[16:19], v11, s[10:11] sc1
    s_waitcnt vmcnt(0)
    v_xor_b32 v2, v10, v17
    v_xor_b32 v3, v10, v19
    v_or_b32 v2, v2, v3
    v_cmp_ne_u32 vcc, 0, v2
    s_cbranch_vccz K_AG2_GOT
    s_sleep 2
    s_sub_u32 s3, s3, 1
    s_cmp_lg_u32 s3, 0
    s_cbranch_scc1 K_AG2_POLL
K_AG2_GOT:
    s_nop 1
    v_max_u32_dpp v3, v16, v16 quad_perm:[1,0,3,2] row_mask:0xf bank_mask:0xf
    s_nop 1
    v_max_u32_dpp v3, v3, v3 quad_perm:[2,3,0,1] row_mask:0xf bank_mask:0xf
    s_nop 1
    v_max_u32_dpp v3, v3, v3 row_half_mirror row_mask:0xf bank_mask:0xf
    s_nop 1
    v_max_u32_dpp v3, v3, v3 row_mirror row_mask:0xf bank_mask:0xf
    s_nop 1
    v_readlane_b32 s74, v3, 0
    v_readlane_b32 s76, v3, 16
    v_readlane_b32 s77, v3, 32
    v_readlane_b32 s78, v3, 48
    s_nop 3
    s_max_u32 s74, s74, s76
    s_max_u32 s77, s77, s78
    s_max_u32 s74, s74, s77
    v_cmp_ne_u32 vcc, s74, v16
    s_nop 1
    v_cndmask_b32 v2, v18, v16, vcc
    s_nop 1
    v_max_u32_dpp v3, v2, v2 quad_perm:[1,0,3,2] row_mask:0xf bank_mask:0xf
    s_nop 1
    v_max_u32_dpp v3, v3, v3 quad_perm:[2,3,0,1] row_mask:0xf bank_mask:0xf
    s_nop 1
    v_max_u32_dpp v3, v3, v3 row_half_mirror row_mask:0xf bank_mask:0xf
    s_nop 1
    v_max_u32_dpp v3, v3, v3 row_mirror row_mask:0xf bank_mask:0xf
    s_nop 1
    v_readlane_b32 s75, v3, 0
    v_readlane_b32 s76, v3, 16
    v_readlane_b32 s77, v3, 32
    v_readlane_b32 s78, v3, 48
    s_nop 3
    s_max_u32 s75, s75, s76
    s_max_u32 s77, s77, s78
    s_max_u32 s75, s75, s77
    v_mov_b32 v176, s74
    v_mov_b32 v177, s75
    v_and_b32 v4, 7, v1
    v_lshlrev_b32 v4, 2, v4
    s_mov_b32 s3, 131072
K_ZPOLL4:
    v_cmp_eq_u32 vcc, 0, v7
    s_cbranch_vccz K_ZOK4
    s_sub_u32 s3, s3, 1
    s_cbranch_scc1 K_ZOK4
    global_load_dword v7, v4, s[8:9] offset:192 sc1
    s_waitcnt vmcnt(0)
    s_branch K_ZPOLL4
K_ZOK4:
    v_and_b32 v2, 7, v1
    v_mul_u32_u24 v2, 20, v2
    v_lshrrev_b32 v3, 3, v1
    v_add_lshl_u32 v2, v2, v3, 8
    buffer_store_dwordx2 v[176:177], v2, s[60:63], 0 offen offset:136 sc1
    s_mov_b64 exec, 1
    global_store_dword v9, v10, s[10:11] sc1
    s_mov_b64 exec, -1
    v_lshlrev_b32 v4, 2, v1
    s_mov_b32 s72, 43008
    s_mov_b32 s3, 131072
K_AGG_POLL:
    s_sleep 8
    buffer_load_dword v2, v4, s[60:63], s72 offen sc1
    s_waitcnt vmcnt(0)
    v_cmp_eq_u32 vcc, 0, v2
    s_cbranch_vccz K_AGG_GOT
    s_sub_u32 s3, s3, 1
    s_cmp_lg_u32 s3, 0
    s_cbranch_scc1 K_AGG_POLL
K_AGG_GOT:
    s_mov_b32 s62, 40960
    v_lshlrev_b32 v3, 8, v1
    s_mov_b32 s3, 0
    buffer_store_dwordx2 v[176:177], v3, s[60:63], s3 offen offset:128 sc1
    s_mov_b32 s3, 16384
    buffer_store_dwordx2 v[176:177], v3, s[60:63], s3 offen offset:128 sc1
    s_mov_b32 s3, 32768
    buffer_store_dwordx2 v[176:177], v3, s[60:63], s3 offen offset:128 sc1
    s_setprio 0
    s_branch K_AUX_NOK
K_AUX_NOZ:
    s_barrier
K_AUX_NOK:
    s_mov_b32 s3, 1048576
K_FGWD:
    ds_read_b32 v2, v12 offset:48
    s_sleep 4
    s_sub_u32 s3, s3, 1
    s_waitcnt lgkmcnt(0)
    v_readfirstlane_b32 s33, v2
    s_nop 3
    s_cselect_b32 s33, 1, s33
    s_cmp_lt_u32 s33, 1
    s_cbranch_scc1 K_FGWD
    s_branch K_P2
K_AUX_PUB:
    s_add_u32 s60, s10, 0x1000
    s_addc_u32 s61, s11, 0
    s_mov_b32 s62, 0x2000
    s_mov_b32 s63, 0x20000
    v_and_b32 v3, 31, v1
    v_lshlrev_b32 v10, 2, v3
    v_add_u32 v11, 122880, v10
    s_lshl_b32 s72, s74, 2
    v_mov_b32 v2, 786432
    global_load_dword v17, v2, s[10:11] sc1
    s_lshl_b32 s3, s2, 2
    s_add_u32 s3, s3, 567296
    v_mov_b32 v9, s3
    s_lshl_b32 s3, s2, 4
    s_add_u32 s3, s3, 790528
    v_lshl_add_u32 v20, v1, 4, s3
    v_and_b32 v5, 7, v1
    v_lshlrev_b32 v5, 2, v5
    s_barrier
    s_setprio 3
    s_waitcnt vmcnt(0)
    v_add_u32 v17, 1, v17
    v_mov_b32 v19, v17
    s_mov_b32 s3, 1048576
K_FGRT:
    ds_read_b32 v2, v12 offset:36
    s_sleep 0
    s_sub_u32 s3, s3, 1
    s_waitcnt lgkmcnt(0)
    v_readfirstlane_b32 s33, v2
    s_nop 3
    s_cselect_b32 s33, 4, s33
    s_cmp_lt_u32 s33, 4
    s_cbranch_scc1 K_FGRT
    ds_read2_b32 v[176:177], v11 offset0:0 offset1:32
    s_waitcnt lgkmcnt(0)
    s_nop 1
    v_max_u32_dpp v3, v176, v176 quad_perm:[1,0,3,2] row_mask:0xf bank_mask:0xf
    s_nop 1
    v_max_u32_dpp v3, v3, v3 quad_perm:[2,3,0,1] row_mask:0xf bank_mask:0xf
    s_nop 1
    v_max_u32_dpp v3, v3, v3 row_half_mirror row_mask:0xf bank_mask:0xf
    s_nop 1
    v_max_u32_dpp v3, v3, v3 row_mirror row_mask:0xf bank_mask:0xf
    s_nop 1
    v_readlane_b32 s74, v3, 0
    v_readlane_b32 s76, v3, 16
    v_readlane_b32 s77, v3, 32
    v_readlane_b32 s78, v3, 48
    s_nop 3
    s_max_u32 s74, s74, s76
    s_max_u32 s77, s77, s78
    s_max_u32 s74, s74, s77
    v_cmp_ne_u32 vcc, s74, v176
    s_nop 1
    v_cndmask_b32 v176, 0, v176, vcc
    s_nop 1
    v_max_u32_dpp v3, v176, v176 quad_perm:[1,0,3,2] row_mask:0xf bank_mask:0xf
    s_nop 1
    v_max_u32_dpp v3, v3, v3 quad_perm:[2,3,0,1] row_mask:0xf bank_mask:0xf
    s_nop 1
    v_max_u32_dpp v3, v3, v3 row_half_mirror row_mask:0xf bank_mask:0xf
    s_nop 1
    v_max_u32_dpp v3, v3, v3 row_mirror row_mask:0xf bank_mask:0xf
    s_nop 1
    v_readlane_b32 s75, v3, 0
    v_readlane_b32 s76, v3, 16
    v_readlane_b32 s77, v3, 32
    v_readlane_b32 s78, v3, 48
    s_nop 3
    s_max_u32 s75, s75, s76
    s_max_u32 s77, s77, s78
    s_max_u32 s75, s75, s77
    v_mov_b32 v16, s74
    v_mov_b32 v18, s75
    s_mov_b64 exec, 1
    global_store_dwordx4 v20, v[16:19], s[10:11] sc1
    s_mov_b64 exec, -1
    s_mov_b64 exec, 1
    ds_add_u32 v12, v13 offset:36
    s_mov_b64 exec, -1
    global_load_dword v7, v5, s[8:9] offset:192 sc1
    v_cvt_pk_bf16_f32 v177, v177, v177
    v_lshlrev_b32 v177, 16, v177
    v_mul_f32 v3, 0xbfb8aa3b, v177
    v_exp_f32 v3, v3
    s_nop 0
    v_add_f32 v3, 1.0, v3
    v_rcp_f32 v177, v3
    s_nop 0
    v_cvt_pk_bf16_f32 v177, v177, v177
    v_lshlrev_b32 v177, 16, v177
    s_mov_b32 exec_hi, 0
    buffer_store_dword v177, v10, s[60:63], s72 offen sc1
    s_mov_b64 exec, -1
    s_waitcnt vmcnt(0)
    v_and_b32 v4, 7, v1
    v_lshlrev_b32 v4, 2, v4
    s_mov_b32 s3, 131072
K_ZPOLL3:
    v_cmp_eq_u32 vcc, 0, v7
    s_cbranch_vccz K_ZOK3
    s_sub_u32 s3, s3, 1
    s_cbranch_scc1 K_ZOK3
    global_load_dword v7, v4, s[8:9] offset:192 sc1
    s_waitcnt vmcnt(0)
    s_branch K_ZPOLL3
K_ZOK3:
    s_mov_b64 exec, 1
    global_store_dword v9, v13, s[10:11] sc1
    s_mov_b64 exec, -1
    v_and_b32 v3, 1, v1
    v_lshl_add_u32 v3, v3, 2, s42
    v_lshlrev_b32 v10, 4, v1
    s_mov_b32 s3, 131072
K_AUX_POLL:
    s_sleep 6
    global_load_dword v2, v3, s[10:11] offset:136 sc1
    s_waitcnt vmcnt(0)
    v_cmp_eq_u32 vcc, 0, v2
    s_cbranch_vccz K_AUX_GOT
    s_sub_u32 s3, s3, 1
    s_cmp_lg_u32 s3, 0
    s_cbranch_scc1 K_AUX_POLL
K_AUX_GOT:
    v_readlane_b32 s74, v2, 0
    v_readlane_b32 s75, v2, 1
    s_nop 3
    s_and_b32 s74, s74, 0x7ff
    s_sub_u32 s74, 2047, s74
    s_mul_i32 s74, s74, 1280
    s_mov_b32 m0, 125184
    s_nop 0
    buffer_load_dwordx4 v10, s[12:15], s74 offen lds
    s_mov_b64 exec, 0xffff
    buffer_load_dwordx4 v10, s[12:15], s74 offen offset:1024 lds
    s_mov_b64 exec, -1
    s_and_b32 s75, s75, 0x7ff
    s_sub_u32 s75, 2047, s75
    s_mul_i32 s75, s75, 1280
    s_mov_b32 m0, 126528
    s_nop 0
    buffer_load_dwordx4 v10, s[12:15], s75 offen lds
    s_mov_b64 exec, 0xffff
    buffer_load_dwordx4 v10, s[12:15], s75 offen offset:1024 lds
    s_mov_b64 exec, -1
    s_waitcnt vmcnt(0)
    ds_write_b32 v12, v13 offset:48
    s_setprio 0
    s_branch K_P2
.p2align 12
K_FFN_C:
    s_add_u32 s64, s10, 0x10000
    s_addc_u32 s65, s11, 0
    s_mov_b32 s66, 0x43800
    s_mov_b32 s67, 0x20000
    s_and_b32 s73, s30, 1
    v_lshrrev_b32 v232, 4, v1
    v_bfe_u32 v4, v1, 2, 2
    v_lshl_add_u32 v2, v232, 3, v4
    v_and_b32 v3, 3, v1
    v_lshlrev_b32 v3, 3, v3
    v_lshl_add_u32 v233, v2, 6, v3
    s_lshl_b32 s72, s73, 5
    v_add_u32 v233, s72, v233
    v_lshl_add_u32 v2, v232, 2, v4
    v_bfe_u32 v4, v2, 1, 2
    v_lshl_add_u32 v3, v2, 7, v3
    v_lshl_add_u32 v3, v4, 5, v3
    s_mul_i32 s3, s73, 20480
    s_add_u32 s3, s3, 81920
    v_add_u32 v238, s3, v3
    v_xor_b32 v239, 32, v238
    v_xor_b32 v240, 64, v238
    v_xor_b32 v241, 96, v238
    v_and_b32 v2, 1, v1
    v_mul_u32_u24 v234, 1344, v2
    v_lshl_add_u32 v234, v232, 4, v234
    v_add_u32 v234, 125184, v234
    v_lshlrev_b32 v236, 4, v1
    v_add_u32 v236, 124160, v236
    s_lshl_b32 s3, s73, 3
    v_add_u32 v235, s3, v236
    v_mul_u32_u24 v2, 2560, v2
    v_lshl_add_u32 v237, v232, 4, v2
    s_mul_i32 s3, s44, 5120
    s_mul_i32 s72, s73, 1280
    s_add_u32 s72, s72, s3
    v_lshlrev_b32 v2, 4, v1
    buffer_store_dwordx4 v[16:19], v2, s[64:67], s72 offen offset:0 sc1
    buffer_store_dwordx4 v[16:19], v2, s[64:67], s72 offen offset:2560 sc1
    s_mov_b64 exec, 0xffff
    buffer_store_dwordx4 v[16:19], v2, s[64:67], s72 offen offset:1024 sc1
    buffer_store_dwordx4 v[16:19], v2, s[64:67], s72 offen offset:3584 sc1
    s_mov_b64 exec, -1
    v_add_u32 v5, 40960, v233
    s_mov_b32 s3, 1048576
K_FGD:
    ds_read_b32 v2, v12 offset:56
    s_sleep 2
    s_sub_u32 s3, s3, 1
    s_waitcnt lgkmcnt(0)
    v_readfirstlane_b32 s33, v2
    s_nop 3
    s_cselect_b32 s33, 3, s33
    s_cmp_lt_u32 s33, 3
    s_cbranch_scc1 K_FGD
    s_setprio 3
    ds_read_b64_tr_b16 v[16:17], v233 offset:0
    ds_read_b64_tr_b16 v[18:19], v233 offset:256
    ds_read_b64_tr_b16 v[20:21], v233 offset:2048
    ds_read_b64_tr_b16 v[22:23], v233 offset:2304
    ds_read_b64_tr_b16 v[24:25], v233 offset:4096
    ds_read_b64_tr_b16 v[26:27], v233 offset:4352
    ds_read_b64_tr_b16 v[28:29], v233 offset:6144
    ds_read_b64_tr_b16 v[30:31], v233 offset:6400
    ds_read_b64_tr_b16 v[32:33], v233 offset:8192
    ds_read_b64_tr_b16 v[34:35], v233 offset:8448
    ds_read_b64_tr_b16 v[36:37], v233 offset:10240
    ds_read_b64_tr_b16 v[38:39], v233 offset:10496
    ds_read_b64_tr_b16 v[40:41], v233 offset:12288
    ds_read_b64_tr_b16 v[42:43], v233 offset:12544
    ds_read_b64_tr_b16 v[44:45], v233 offset:14336
    ds_read_b64_tr_b16 v[46:47], v233 offset:14592
    ds_read_b64_tr_b16 v[48:49], v233 offset:16384
    ds_read_b64_tr_b16 v[50:51], v233 offset:16640
    ds_read_b64_tr_b16 v[52:53], v233 offset:18432
    ds_read_b64_tr_b16 v[54:55], v233 offset:18688
    ds_read_b64_tr_b16 v[56:57], v233 offset:20480
    ds_read_b64_tr_b16 v[58:59], v233 offset:20736
    ds_read_b64_tr_b16 v[60:61], v233 offset:22528
    ds_read_b64_tr_b16 v[62:63], v233 offset:22784
    ds_read_b64_tr_b16 v[64:65], v233 offset:24576
    ds_read_b64_tr_b16 v[66:67], v233 offset:24832
    ds_read_b64_tr_b16 v[68:69], v233 offset:26624
    ds_read_b64_tr_b16 v[70:71], v233 offset:26880
    ds_read_b64_tr_b16 v[72:73], v233 offset:28672
    ds_read_b64_tr_b16 v[74:75], v233 offset:28928
    ds_read_b64_tr_b16 v[76:77], v233 offset:30720
    ds_read_b64_tr_b16 v[78:79], v233 offset:30976
    ds_read_b64_tr_b16 v[80:81], v233 offset:32768
    ds_read_b64_tr_b16 v[82:83], v233 offset:33024
    ds_read_b64_tr_b16 v[84:85], v233 offset:34816
    ds_read_b64_tr_b16 v[86:87], v233 offset:35072
    ds_read_b64_tr_b16 v[88:89], v233 offset:36864
    ds_read_b64_tr_b16 v[90:91], v233 offset:37120
    ds_read_b64_tr_b16 v[92:93], v233 offset:38912
    ds_read_b64_tr_b16 v[94:95], v233 offset:39168
    ds_read_b64_tr_b16 v[96:97], v5 offset:0
    ds_read_b64_tr_b16 v[98:99], v5 offset:256
    ds_read_b64_tr_b16 v[100:101], v5 offset:2048
    ds_read_b64_tr_b16 v[102:103], v5 offset:2304
    ds_read_b64_tr_b16 v[104:105], v5 offset:4096
    ds_read_b64_tr_b16 v[106:107], v5 offset:4352
    ds_read_b64_tr_b16 v[108:109], v5 offset:6144
    ds_read_b64_tr_b16 v[110:111], v5 offset:6400
    ds_read_b64_tr_b16 v[112:113], v5 offset:8192
    ds_read_b64_tr_b16 v[114:115], v5 offset:8448
    ds_read_b64_tr_b16 v[116:117], v5 offset:10240
    ds_read_b64_tr_b16 v[118:119], v5 offset:10496
    ds_read_b64_tr_b16 v[120:121], v5 offset:12288
    ds_read_b64_tr_b16 v[122:123], v5 offset:12544
    ds_read_b64_tr_b16 v[124:125], v5 offset:14336
    ds_read_b64_tr_b16 v[126:127], v5 offset:14592
    ds_read_b64_tr_b16 v[128:129], v5 offset:16384
    ds_read_b64_tr_b16 v[130:131], v5 offset:16640
    ds_read_b64_tr_b16 v[132:133], v5 offset:18432
    ds_read_b64_tr_b16 v[134:135], v5 offset:18688
    ds_read_b64_tr_b16 v[136:137], v5 offset:20480
    ds_read_b64_tr_b16 v[138:139], v5 offset:20736
    ds_read_b64_tr_b16 v[140:141], v5 offset:22528
    ds_read_b64_tr_b16 v[142:143], v5 offset:22784
    ds_read_b64_tr_b16 v[144:145], v5 offset:24576
    ds_read_b64_tr_b16 v[146:147], v5 offset:24832
    ds_read_b64_tr_b16 v[148:149], v5 offset:26624
    ds_read_b64_tr_b16 v[150:151], v5 offset:26880
    ds_read_b64_tr_b16 v[152:153], v5 offset:28672
    ds_read_b64_tr_b16 v[154:155], v5 offset:28928
    ds_read_b64_tr_b16 v[156:157], v5 offset:30720
    ds_read_b64_tr_b16 v[158:159], v5 offset:30976
    ds_read_b64_tr_b16 v[160:161], v5 offset:32768
    ds_read_b64_tr_b16 v[162:163], v5 offset:33024
    ds_read_b64_tr_b16 v[164:165], v5 offset:34816
    ds_read_b64_tr_b16 v[166:167], v5 offset:35072
    ds_read_b64_tr_b16 v[168:169], v5 offset:36864
    ds_read_b64_tr_b16 v[170:171], v5 offset:37120
    ds_read_b64_tr_b16 v[172:173], v5 offset:38912
    ds_read_b64_tr_b16 v[174:175], v5 offset:39168
    s_waitcnt vmcnt(0) lgkmcnt(0)
    s_mov_b64 exec, 1
    ds_add_u32 v12, v13 offset:60
    s_mov_b64 exec, -1
    s_mov_b32 s3, 1048576
K_FGK:
    ds_read_b32 v2, v12 offset:48
    s_sleep 1
    s_sub_u32 s3, s3, 1
    s_waitcnt lgkmcnt(0)
    v_readfirstlane_b32 s33, v2
    s_nop 3
    s_cselect_b32 s33, 1, s33
    s_cmp_lt_u32 s33, 1
    s_cbranch_scc1 K_FGK
    ds_read_b128 v[188:191], v234 offset:0
    ds_read_b128 v[192:195], v234 offset:64
    ds_read_b128 v[196:199], v234 offset:128
    ds_read_b128 v[200:203], v234 offset:192
    ds_read_b128 v[204:207], v234 offset:256
    ds_read_b128 v[208:211], v234 offset:320
    ds_read_b128 v[212:215], v234 offset:384
    ds_read_b128 v[216:219], v234 offset:448
    s_waitcnt lgkmcnt(7)
    v_mfma_f32_16x16x32_bf16 v[220:223], v[16:19], v[188:191], 0
    v_mfma_f32_16x16x32_bf16 v[224:227], v[96:99], v[188:191], 0
    ds_read_b128 v[188:191], v234 offset:512
    s_waitcnt lgkmcnt(7)
    v_mfma_f32_16x16x32_bf16 v[220:223], v[20:23], v[192:195], v[220:223]
    v_mfma_f32_16x16x32_bf16 v[224:227], v[100:103], v[192:195], v[224:227]
    ds_read_b128 v[192:195], v234 offset:576
    s_waitcnt lgkmcnt(7)
    v_mfma_f32_16x16x32_bf16 v[220:223], v[24:27], v[196:199], v[220:223]
    v_mfma_f32_16x16x32_bf16 v[224:227], v[104:107], v[196:199], v[224:227]
    ds_read_b128 v[196:199], v234 offset:640
    s_waitcnt lgkmcnt(7)
    v_mfma_f32_16x16x32_bf16 v[220:223], v[28:31], v[200:203], v[220:223]
    v_mfma_f32_16x16x32_bf16 v[224:227], v[108:111], v[200:203], v[224:227]
    ds_read_b128 v[200:203], v234 offset:704
    s_waitcnt lgkmcnt(7)
    v_mfma_f32_16x16x32_bf16 v[220:223], v[32:35], v[204:207], v[220:223]
    v_mfma_f32_16x16x32_bf16 v[224:227], v[112:115], v[204:207], v[224:227]
    ds_read_b128 v[204:207], v234 offset:768
    s_waitcnt lgkmcnt(7)
    v_mfma_f32_16x16x32_bf16 v[220:223], v[36:39], v[208:211], v[220:223]
    v_mfma_f32_16x16x32_bf16 v[224:227], v[116:119], v[208:211], v[224:227]
    ds_read_b128 v[208:211], v234 offset:832
    s_waitcnt lgkmcnt(7)
    v_mfma_f32_16x16x32_bf16 v[220:223], v[40:43], v[212:215], v[220:223]
    v_mfma_f32_16x16x32_bf16 v[224:227], v[120:123], v[212:215], v[224:227]
    ds_read_b128 v[212:215], v234 offset:896
    s_waitcnt lgkmcnt(7)
    v_mfma_f32_16x16x32_bf16 v[220:223], v[44:47], v[216:219], v[220:223]
    v_mfma_f32_16x16x32_bf16 v[224:227], v[124:127], v[216:219], v[224:227]
    ds_read_b128 v[216:219], v234 offset:960
    s_waitcnt lgkmcnt(7)
    v_mfma_f32_16x16x32_bf16 v[220:223], v[48:51], v[188:191], v[220:223]
    v_mfma_f32_16x16x32_bf16 v[224:227], v[128:131], v[188:191], v[224:227]
    ds_read_b128 v[188:191], v234 offset:1024
    s_waitcnt lgkmcnt(7)
    v_mfma_f32_16x16x32_bf16 v[220:223], v[52:55], v[192:195], v[220:223]
    v_mfma_f32_16x16x32_bf16 v[224:227], v[132:135], v[192:195], v[224:227]
    ds_read_b128 v[192:195], v234 offset:1088
    s_waitcnt lgkmcnt(7)
    v_mfma_f32_16x16x32_bf16 v[220:223], v[56:59], v[196:199], v[220:223]
    v_mfma_f32_16x16x32_bf16 v[224:227], v[136:139], v[196:199], v[224:227]
    ds_read_b128 v[196:199], v234 offset:1152
    s_waitcnt lgkmcnt(7)
    v_mfma_f32_16x16x32_bf16 v[220:223], v[60:63], v[200:203], v[220:223]
    v_mfma_f32_16x16x32_bf16 v[224:227], v[140:143], v[200:203], v[224:227]
    ds_read_b128 v[200:203], v234 offset:1216
    s_waitcnt lgkmcnt(7)
    v_mfma_f32_16x16x32_bf16 v[220:223], v[64:67], v[204:207], v[220:223]
    v_mfma_f32_16x16x32_bf16 v[224:227], v[144:147], v[204:207], v[224:227]
    s_waitcnt lgkmcnt(6)
    v_mfma_f32_16x16x32_bf16 v[220:223], v[68:71], v[208:211], v[220:223]
    v_mfma_f32_16x16x32_bf16 v[224:227], v[148:151], v[208:211], v[224:227]
    s_waitcnt lgkmcnt(5)
    v_mfma_f32_16x16x32_bf16 v[220:223], v[72:75], v[212:215], v[220:223]
    v_mfma_f32_16x16x32_bf16 v[224:227], v[152:155], v[212:215], v[224:227]
    s_waitcnt lgkmcnt(4)
    v_mfma_f32_16x16x32_bf16 v[220:223], v[76:79], v[216:219], v[220:223]
    v_mfma_f32_16x16x32_bf16 v[224:227], v[156:159], v[216:219], v[224:227]
    s_waitcnt lgkmcnt(3)
    v_mfma_f32_16x16x32_bf16 v[220:223], v[80:83], v[188:191], v[220:223]
    v_mfma_f32_16x16x32_bf16 v[224:227], v[160:163], v[188:191], v[224:227]
    s_waitcnt lgkmcnt(2)
    v_mfma_f32_16x16x32_bf16 v[220:223], v[84:87], v[192:195], v[220:223]
    v_mfma_f32_16x16x32_bf16 v[224:227], v[164:167], v[192:195], v[224:227]
    s_waitcnt lgkmcnt(1)
    v_mfma_f32_16x16x32_bf16 v[220:223], v[88:91], v[196:199], v[220:223]
    v_mfma_f32_16x16x32_bf16 v[224:227], v[168:171], v[196:199], v[224:227]
    s_waitcnt lgkmcnt(0)
    v_mfma_f32_16x16x32_bf16 v[220:223], v[92:95], v[200:203], v[220:223]
    v_mfma_f32_16x16x32_bf16 v[224:227], v[172:175], v[200:203], v[224:227]
    s_mov_b32 s3, 1048576
K_FGDN:
    ds_read_b32 v2, v12 offset:52
    s_sleep 1
    s_sub_u32 s3, s3, 1
    s_waitcnt lgkmcnt(0)
    v_readfirstlane_b32 s33, v2
    s_nop 3
    s_cselect_b32 s33, 3, s33
    s_cmp_lt_u32 s33, 3
    s_cbranch_scc1 K_FGDN
    ds_read_b64_tr_b16 v[16:17], v238 offset:0
    ds_read_b64_tr_b16 v[18:19], v238 offset:2048
    ds_read_b64_tr_b16 v[20:21], v239 offset:0
    ds_read_b64_tr_b16 v[22:23], v239 offset:2048
    ds_read_b64_tr_b16 v[24:25], v240 offset:0
    ds_read_b64_tr_b16 v[26:27], v240 offset:2048
    ds_read_b64_tr_b16 v[28:29], v241 offset:0
    ds_read_b64_tr_b16 v[30:31], v241 offset:2048
    ds_read_b64_tr_b16 v[32:33], v238 offset:4096
    ds_read_b64_tr_b16 v[34:35], v238 offset:6144
    ds_read_b64_tr_b16 v[36:37], v239 offset:4096
    ds_read_b64_tr_b16 v[38:39], v239 offset:6144
    ds_read_b64_tr_b16 v[40:41], v240 offset:4096
    ds_read_b64_tr_b16 v[42:43], v240 offset:6144
    v_cvt_pk_bf16_f32 v221, v220, v221
    v_lshlrev_b32 v220, 16, v221
    v_and_b32 v221, 0xffff0000, v221
    v_cvt_pk_bf16_f32 v223, v222, v223
    v_lshlrev_b32 v222, 16, v223
    v_and_b32 v223, 0xffff0000, v223
    v_cvt_pk_bf16_f32 v225, v224, v225
    v_lshlrev_b32 v224, 16, v225
    v_and_b32 v225, 0xffff0000, v225
    v_cvt_pk_bf16_f32 v227, v226, v227
    v_lshlrev_b32 v226, 16, v227
    v_and_b32 v227, 0xffff0000, v227
    v_mul_f32 v188, 0xbfb8aa3b, v220
    v_mul_f32 v189, 0xbfb8aa3b, v221
    v_mul_f32 v190, 0xbfb8aa3b, v222
    v_mul_f32 v191, 0xbfb8aa3b, v223
    v_exp_f32 v188, v188
    v_exp_f32 v189, v189
    v_exp_f32 v190, v190
    v_exp_f32 v191, v191
    v_add_f32 v188, 1.0, v188
    v_add_f32 v189, 1.0, v189
    v_add_f32 v190, 1.0, v190
    v_add_f32 v191, 1.0, v191
    v_rcp_f32 v188, v188
    v_rcp_f32 v189, v189
    v_rcp_f32 v190, v190
    v_rcp_f32 v191, v191
    v_mul_f32 v220, v220, v188
    v_mul_f32 v221, v221, v189
    v_mul_f32 v222, v222, v190
    v_mul_f32 v223, v223, v191
    v_cvt_pk_bf16_f32 v221, v220, v221
    v_lshlrev_b32 v220, 16, v221
    v_and_b32 v221, 0xffff0000, v221
    v_cvt_pk_bf16_f32 v223, v222, v223
    v_lshlrev_b32 v222, 16, v223
    v_and_b32 v223, 0xffff0000, v223
    v_mul_f32 v220, v220, v224
    v_mul_f32 v221, v221, v225
    v_mul_f32 v222, v222, v226
    v_mul_f32 v223, v223, v227
    v_cvt_pk_bf16_f32 v228, v220, v221
    v_cvt_pk_bf16_f32 v229, v222, v223
    ds_write_b64 v235, v[228:229]
    s_mov_b64 exec, 1
    ds_add_u32 v12, v13 offset:52
    s_mov_b64 exec, -1
    ds_read_b64_tr_b16 v[44:45], v241 offset:4096
    ds_read_b64_tr_b16 v[46:47], v241 offset:6144
    ds_read_b64_tr_b16 v[48:49], v238 offset:8192
    ds_read_b64_tr_b16 v[50:51], v238 offset:10240
    ds_read_b64_tr_b16 v[52:53], v239 offset:8192
    ds_read_b64_tr_b16 v[54:55], v239 offset:10240
    ds_read_b64_tr_b16 v[56:57], v240 offset:8192
    ds_read_b64_tr_b16 v[58:59], v240 offset:10240
    ds_read_b64_tr_b16 v[60:61], v241 offset:8192
    ds_read_b64_tr_b16 v[62:63], v241 offset:10240
    ds_read_b64_tr_b16 v[64:65], v238 offset:12288
    ds_read_b64_tr_b16 v[66:67], v238 offset:14336
    ds_read_b64_tr_b16 v[68:69], v239 offset:12288
    ds_read_b64_tr_b16 v[70:71], v239 offset:14336
    ds_read_b64_tr_b16 v[72:73], v240 offset:12288
    ds_read_b64_tr_b16 v[74:75], v240 offset:14336
    ds_read_b64_tr_b16 v[76:77], v241 offset:12288
    ds_read_b64_tr_b16 v[78:79], v241 offset:14336
    ds_read_b64_tr_b16 v[80:81], v238 offset:16384
    ds_read_b64_tr_b16 v[82:83], v238 offset:18432
    ds_read_b64_tr_b16 v[84:85], v239 offset:16384
    ds_read_b64_tr_b16 v[86:87], v239 offset:18432
    ds_read_b64_tr_b16 v[88:89], v240 offset:16384
    ds_read_b64_tr_b16 v[90:91], v240 offset:18432
    ds_read_b64_tr_b16 v[92:93], v241 offset:16384
    ds_read_b64_tr_b16 v[94:95], v241 offset:18432
    s_mov_b32 s3, 1048576
K_FGP:
    ds_read_b32 v2, v12 offset:52
    s_sleep 0
    s_sub_u32 s3, s3, 1
    s_waitcnt lgkmcnt(0)
    v_readfirstlane_b32 s33, v2
    s_nop 3
    s_cselect_b32 s33, 5, s33
    s_cmp_lt_u32 s33, 5
    s_cbranch_scc1 K_FGP
    ds_read_b128 v[228:231], v236
    s_waitcnt lgkmcnt(0)
    v_mfma_f32_16x16x32_bf16 v[96:99], v[16:19], v[228:231], 0
    v_mfma_f32_16x16x32_bf16 v[100:103], v[20:23], v[228:231], 0
    v_mfma_f32_16x16x32_bf16 v[104:107], v[24:27], v[228:231], 0
    v_mfma_f32_16x16x32_bf16 v[108:111], v[28:31], v[228:231], 0
    v_mfma_f32_16x16x32_bf16 v[112:115], v[32:35], v[228:231], 0
    v_mfma_f32_16x16x32_bf16 v[116:119], v[36:39], v[228:231], 0
    v_mfma_f32_16x16x32_bf16 v[120:123], v[40:43], v[228:231], 0
    v_mfma_f32_16x16x32_bf16 v[124:127], v[44:47], v[228:231], 0
    v_mfma_f32_16x16x32_bf16 v[128:131], v[48:51], v[228:231], 0
    v_mfma_f32_16x16x32_bf16 v[132:135], v[52:55], v[228:231], 0
    v_mfma_f32_16x16x32_bf16 v[136:139], v[56:59], v[228:231], 0
    v_mfma_f32_16x16x32_bf16 v[140:143], v[60:63], v[228:231], 0
    v_mfma_f32_16x16x32_bf16 v[144:147], v[64:67], v[228:231], 0
    v_mfma_f32_16x16x32_bf16 v[148:151], v[68:71], v[228:231], 0
    v_mfma_f32_16x16x32_bf16 v[152:155], v[72:75], v[228:231], 0
    v_mfma_f32_16x16x32_bf16 v[156:159], v[76:79], v[228:231], 0
    v_mfma_f32_16x16x32_bf16 v[160:163], v[80:83], v[228:231], 0
    v_mfma_f32_16x16x32_bf16 v[164:167], v[84:87], v[228:231], 0
    v_mfma_f32_16x16x32_bf16 v[168:171], v[88:91], v[228:231], 0
    v_mfma_f32_16x16x32_bf16 v[172:175], v[92:95], v[228:231], 0
    s_mov_b32 exec_lo, 0x00030003
    s_mov_b32 exec_hi, 0x00030003
    buffer_store_dwordx4 v[96:99], v237, s[64:67], s72 offen offset:0 sc1
    buffer_store_dwordx4 v[100:103], v237, s[64:67], s72 offen offset:64 sc1
    buffer_store_dwordx4 v[104:107], v237, s[64:67], s72 offen offset:128 sc1
    buffer_store_dwordx4 v[108:111], v237, s[64:67], s72 offen offset:192 sc1
    buffer_store_dwordx4 v[112:115], v237, s[64:67], s72 offen offset:256 sc1
    buffer_store_dwordx4 v[116:119], v237, s[64:67], s72 offen offset:320 sc1
    buffer_store_dwordx4 v[120:123], v237, s[64:67], s72 offen offset:384 sc1
    buffer_store_dwordx4 v[124:127], v237, s[64:67], s72 offen offset:448 sc1
    buffer_store_dwordx4 v[128:131], v237, s[64:67], s72 offen offset:512 sc1
    buffer_store_dwordx4 v[132:135], v237, s[64:67], s72 offen offset:576 sc1
    buffer_store_dwordx4 v[136:139], v237, s[64:67], s72 offen offset:640 sc1
    buffer_store_dwordx4 v[140:143], v237, s[64:67], s72 offen offset:704 sc1
    buffer_store_dwordx4 v[144:147], v237, s[64:67], s72 offen offset:768 sc1
    buffer_store_dwordx4 v[148:151], v237, s[64:67], s72 offen offset:832 sc1
    buffer_store_dwordx4 v[152:155], v237, s[64:67], s72 offen offset:896 sc1
    buffer_store_dwordx4 v[156:159], v237, s[64:67], s72 offen offset:960 sc1
    buffer_store_dwordx4 v[160:163], v237, s[64:67], s72 offen offset:1024 sc1
    buffer_store_dwordx4 v[164:167], v237, s[64:67], s72 offen offset:1088 sc1
    buffer_store_dwordx4 v[168:171], v237, s[64:67], s72 offen offset:1152 sc1
    buffer_store_dwordx4 v[172:175], v237, s[64:67], s72 offen offset:1216 sc1
    s_mov_b64 exec, -1
    s_mul_i32 s3, s73, 2560
    s_lshl2_add_u32 s3, s44, s3
    s_add_u32 s3, s3, 568320
    v_lshl_add_u32 v2, v1, 8, s3
    s_mov_b64 exec, 0x3ff
    s_waitcnt vmcnt(0)
    global_store_dword v2, v13, s[10:11] sc1
    s_mov_b64 exec, -1
    s_branch K_P2_HELP
K_CODE_END:
.section .rodata,"a"
.p2align 6
.amdhsa_kernel gated_mix__sliding_local_dilated__moe_arch_mod__prompt_kernel
  .amdhsa_next_free_vgpr 248
  .amdhsa_next_free_sgpr 79
  .amdhsa_accum_offset 248
  .amdhsa_group_segment_fixed_size 0
  .amdhsa_kernarg_size 96
  .amdhsa_user_sgpr_count 2
  .amdhsa_user_sgpr_kernarg_segment_ptr 1
  .amdhsa_system_sgpr_workgroup_id_x 1
.end_amdhsa_kernel
```

```asm
; @launch grid=(256,1,1) block=(512,1,1) lds=163840
.amdgcn_target "amdgcn-amd-amdhsa--gfx950"
.text
.p2align 12
.p2align 8
.globl gated_mix__sliding_local_dilated__moe_arch_mod__prompt_kernel
.type gated_mix__sliding_local_dilated__moe_arch_mod__prompt_kernel,@function
gated_mix__sliding_local_dilated__moe_arch_mod__prompt_kernel:
    s_cmp_ge_u32 s2, 256
    s_cbranch_scc1 K_EXIT
    s_load_dwordx2 s[12:13], s[0:1], 0
    s_load_dwordx2 s[16:17], s[0:1], 8
    v_readfirstlane_b32 s30, v0
    s_load_dwordx4 s[8:11], s[0:1], 80
    s_load_dwordx2 s[24:25], s[0:1], 16
    s_load_dwordx2 s[6:7], s[0:1], 72
    s_and_b32 s28, s2, 7
    v_and_b32 v1, 63, v0
    s_mov_b32 s14, 0x280000
    s_mov_b32 s15, 0x20000
    s_lshr_b32 s30, s30, 6
    s_cmp_lt_u32 s2, 64
    s_cbranch_scc1 K_SLOW
    s_cmp_lt_u32 s30, 4
    s_cbranch_scc1 K_FAST
K_SLOW:
    s_getpc_b64 s[38:39]
K_PC:
    s_bfe_u32 s3, s2, 0x30003
    s_mul_i32 s3, s3, ((K_CODE_END-gated_mix__sliding_local_dilated__moe_arch_mod__prompt_kernel+1023)/1024)
    s_sub_u32 s38, s38, K_PC-gated_mix__sliding_local_dilated__moe_arch_mod__prompt_kernel
    s_subb_u32 s39, s39, 0
    v_subrev_u32 v3, 256, v0
    v_add_u32 v2, s3, v3
    v_lshlrev_b32 v2, 7, v2
    v_min_u32 v2, K_CODE_END-gated_mix__sliding_local_dilated__moe_arch_mod__prompt_kernel-4, v2
    v_cmp_gt_u32 vcc, ((K_CODE_END-gated_mix__sliding_local_dilated__moe_arch_mod__prompt_kernel+1023)/1024), v3
    s_and_saveexec_b64 s[4:5], vcc
    s_cbranch_execz K_NOPF
    global_load_dword v6, v2, s[38:39]
K_NOPF:
    s_mov_b64 exec, -1
    v_mov_b64 v[2:3], 0
    v_mov_b64 v[4:5], 0
    v_mov_b32 v7, 158752
    ds_write_b128 v7, v[2:5] offset:0
    ds_write_b128 v7, v[2:5] offset:16
    ds_write_b128 v7, v[2:5] offset:32
    ds_write_b128 v7, v[2:5] offset:48
    s_mov_b32 s43, 1
    s_lshl_b32 s3, s30, 8
    s_add_u32 s3, s3, s2
    s_lshr_b32 s3, s3, 3
    s_cmp_lg_u32 s3, 160
    s_cbranch_scc1 K_COMMON
    s_mul_i32 s3, s2, 6144
    s_add_u32 s3, s3, 527360
    v_lshl_add_u32 v6, v1, 4, s3
    v_mov_b64 v[24:25], 0
    v_mov_b64 v[26:27], 0
    s_waitcnt lgkmcnt(0)
    global_store_dwordx4 v6, v[24:27], s[10:11] offset:-3072 sc1
    global_store_dwordx4 v6, v[24:27], s[10:11] offset:-2048 sc1
    global_store_dwordx4 v6, v[24:27], s[10:11] offset:-1024 sc1
    global_store_dwordx4 v6, v[24:27], s[10:11] offset:0 sc1
    global_store_dwordx4 v6, v[24:27], s[10:11] offset:1024 sc1
    global_store_dwordx4 v6, v[24:27], s[10:11] offset:2048 sc1
    s_lshl_b32 s3, s2, 2
    v_mov_b32 v2, s3
    v_mov_b32 v3, 1
    s_mov_b64 exec, 1
    s_waitcnt vmcnt(0)
    global_store_dword v2, v3, s[8:9] offset:192 sc1
    s_mov_b64 exec, -1
    s_branch K_COMMON
K_FAST:
    s_lshr_b32 s32, s2, 1
    s_and_b32 s32, s32, 28
    v_lshrrev_b32 v3, 4, v1
    s_lshr_b32 s3, s2, 6
    s_mov_b32 s59, 0x59608237
    s_cmp_eq_u32 s3, 2
    s_cselect_b32 s59, 0x26375904, s59
    v_and_b32 v4, 7, v1
    s_cmp_eq_u32 s3, 3
    s_cselect_b32 s59, 0x93042671, s59
    v_lshrrev_b32 v2, 3, v1
    s_lshr_b32 s59, s59, s32
    s_and_b32 s59, s59, 15
    v_xor_b32 v4, v4, v3
    s_lshl_b32 s33, s28, 2
    s_lshr_b32 s33, 0x76543210, s33
    s_and_b32 s33, s33, 15
    s_add_u32 s59, s59, s33
    s_cmp_ge_u32 s59, 10
    v_mul_u32_u24 v2, 1280, v2
    s_cselect_b32 s33, 10, 0
    s_sub_u32 s59, s59, s33
    s_lshr_b32 s53, s28, 1
    v_lshl_add_u32 v40, v4, 4, v2
    s_mul_i32 s53, s53, 655360
    s_lshl2_add_u32 s62, s3, s30
    s_cmp_eq_u32 s62, 15
    s_cselect_b32 s62, 0x800000, 0
    s_add_u32 s62, s62, 40960
    s_mul_i32 s3, s3, 225280
    v_xor_b32 v41, 64, v40
    s_add_u32 s53, s53, s3
    s_mul_i32 s54, s30, 61440
    s_add_u32 s53, s53, s54
    s_sub_u32 s53, s53, 245760
    s_mul_i32 s55, s30, 6144
    s_add_u32 s55, s55, 49152
    s_lshl_b32 s57, s59, 7
    s_add_u32 s57, s57, s53
    s_waitcnt lgkmcnt(0)
    s_add_u32 m0, s55, 0
    s_max_i32 s60, s57, 0
    buffer_load_dwordx4 v40, s[12:15], s60 offen lds
    s_add_u32 s60, s57, 10240
    s_add_u32 m0, s55, 1024
    s_max_i32 s60, s60, 0
    buffer_load_dwordx4 v41, s[12:15], s60 offen lds
    s_add_u32 m0, s55, 2048
    s_add_u32 s60, s57, 20480
    buffer_load_dwordx4 v40, s[12:15], s60 offen lds
    s_add_u32 m0, s55, 3072
    s_add_u32 s60, s57, 30720
    buffer_load_dwordx4 v41, s[12:15], s60 offen lds
    s_add_u32 m0, s55, 4096
    s_add_u32 s60, s57, s62
    buffer_load_dwordx4 v40, s[12:15], s60 offen lds
    s_add_u32 m0, s55, 5120
    s_add_u32 s60, s60, 10240
    buffer_load_dwordx4 v41, s[12:15], s60 offen lds
    v_lshlrev_b32 v2, 1, v3
    s_lshr_b32 s32, 0x64317520, s32
    v_sub_u32 v2, v1, v2
    s_and_b32 s32, s32, 7
    v_and_b32 v2, 15, v2
    s_and_b32 s3, s28, 1
    v_mul_u32_u24 v3, 3840, v3
    s_lshl3_add_u32 s32, s3, s32
    v_mul_u32_u24 v4, 13, v2
    s_mul_i32 s3, s32, 80
    v_lshrrev_b32 v4, 6, v4
    s_add_u32 s54, s54, s3
    v_mul_u32_u24 v4, 1200, v4
    s_lshl_b32 s56, s30, 12
    v_lshl_add_u32 v4, v2, 4, v4
    s_add_u32 s56, s56, 106496
    v_add_u32 v5, 1, v2
    s_mov_b32 s18, 0x258000
    v_and_b32 v5, 16, v5
    s_mov_b32 s19, 0x20000
    v_lshl_add_u32 v4, v5, 24, v4
    v_add_u32 v42, v3, v4
    s_mul_i32 s58, s59, 245760
    s_add_u32 s58, s58, s54
    s_add_u32 s59, s59, 1
    s_cmp_eq_u32 s59, 10
    s_cselect_b32 s59, 0, s59
    s_add_u32 m0, s56, 0
    s_add_u32 s60, s58, 0
    buffer_load_dwordx4 v42, s[16:19], s60 offen lds
    s_add_u32 m0, s56, 1024
    s_add_u32 s60, s58, 15360
    buffer_load_dwordx4 v42, s[16:19], s60 offen lds
    v_xor_b32 v2, 8, v2
    v_mul_u32_u24 v4, 13, v2
    v_lshrrev_b32 v4, 6, v4
    v_mul_u32_u24 v4, 1200, v4
    v_lshl_add_u32 v4, v2, 4, v4
    v_add_u32 v5, 1, v2
    v_and_b32 v5, 16, v5
    v_lshl_add_u32 v4, v5, 24, v4
    v_add_u32 v43, v3, v4
    s_add_u32 m0, s56, 2048
    s_add_u32 s60, s58, 30720
    buffer_load_dwordx4 v43, s[16:19], s60 offen lds
    s_add_u32 m0, s56, 3072
    s_add_u32 s60, s58, 46080
    buffer_load_dwordx4 v43, s[16:19], s60 offen lds
    s_mov_b32 s52, s30
    s_mov_b32 s43, 0
K_COMMON:
    v_mov_b32 v7, 0
    s_lshr_b32 s29, s2, 3
    s_xor_b32 s30, s30, 4
    s_mov_b32 s26, 0xc8000
    s_mov_b32 s27, 0x20000
    s_lshr_b32 s34, s29, 3
    s_lshl_b32 s34, s34, 2
    s_and_b32 s3, s29, 3
    s_add_u32 s34, s34, s3
    s_add_u32 s34, s34, 4
    s_bitcmp1_b32 s29, 2
    s_cselect_b32 s34, -1, s34
    s_cmp_lt_u32 s29, 8
    s_cselect_b32 s34, s29, s34
    s_lshl_b32 s40, s28, 1
    s_cmp_ge_u32 s34, 10
    s_addc_u32 s40, s40, 0
    s_sub_u32 s41, s34, 10
    s_cmp_ge_u32 s34, 10
    s_cselect_b32 s41, s41, s34
    s_mul_i32 s42, s28, 20
    s_add_u32 s42, s42, s34
    s_and_b32 s42, s42, 255
    s_lshl_b32 s42, s42, 8
    s_add_u32 s42, s42, 524288
    s_cmp_lt_u32 s29, 8
    s_cbranch_scc1 K_AUX
    s_lshr_b32 s31, s29, 3
    s_sub_u32 s31, s31, 1
    s_and_b32 s35, s29, 3
    s_and_b32 s3, s29, 4
    s_lshl_b32 s3, s3, 1
    s_add_u32 s35, s35, s3
    s_and_b32 s3, s28, 1
    s_lshl_b32 s3, s3, 2
    s_add_u32 s35, s35, s3
    v_and_b32 v9, 15, v1
    v_lshrrev_b32 v10, 4, v1
    v_bfe_u32 v11, v1, 2, 2
    v_and_b32 v12, 3, v1
    s_waitcnt lgkmcnt(0)
    s_add_u32 s20, s10, 0x100000
    s_addc_u32 s21, s11, 0
    s_mov_b32 s22, 0x280000
    s_mov_b32 s23, 0x20000
    s_and_b32 s3, s30, 3
    s_mul_i32 s3, s3, 3
    s_lshr_b32 s33, s30, 2
    s_lshl1_add_u32 s3, s33, s3
    s_mul_i32 s44, s31, 11
    s_add_u32 s44, s44, s3
    s_cmp_eq_u32 s44, 31
    s_cselect_b32 s51, 4, s30
    s_lshr_b32 s33, s28, 1
    s_lshl_b32 s33, s33, 5
    s_add_u32 s44, s44, s33
    s_lshl_b32 s3, s3, 10
    s_add_u32 s3, s3, 122880
    v_lshl_add_u32 v13, v1, 4, s3
    v_lshl_add_u32 v2, v9, 4, s3
    v_add_u32 v2, 520, v2
    v_add_u32 v3, 512, v13
    v_cmp_eq_u32 vcc, 0, v10
    s_nop 1
    v_cndmask_b32 v18, v2, v3, vcc
    v_cmp_eq_u32 vcc, 1, v10
    s_nop 1
    v_cndmask_b32 v19, v2, v3, vcc
    v_lshl_add_u32 v5, v10, 2, v11
    v_lshl_add_u32 v5, v5, 4, s3
    v_add_u32 v2, 520, v5
    v_add_u32 v3, 8, v5
    v_add_u32 v4, 264, v5
    s_cmp_lt_u32 s30, 4
    s_cselect_b32 s33, 0, 3
    s_sub_u32 s33, s30, s33
    s_mul_i32 s33, s33, 5120
    s_add_u32 s33, s33, 79872
    v_lshl_add_u32 v14, v1, 3, s33
    v_cmp_eq_u32 vcc, 0, v12
    s_nop 1
    v_cndmask_b32 v20, v2, v3, vcc
    v_cmp_eq_u32 vcc, 1, v12
    s_nop 1
    v_cndmask_b32 v21, v2, v4, vcc
    v_cmp_eq_u32 vcc, 2, v12
    s_nop 1
    v_cndmask_b32 v22, v2, v3, vcc
    v_cmp_eq_u32 vcc, 3, v12
    s_nop 1
    v_cndmask_b32 v23, v2, v4, vcc
    s_lshl_b32 s3, s35, 10
    v_lshl_add_u32 v15, v1, 4, s3
    s_lshl_b32 s3, s35, 8
    s_add_u32 s3, s3, 16384
    v_lshl_add_u32 v16, v9, 4, s3
    v_and_b32 v2, 1, v10
    v_lshl_add_u32 v16, v2, 23, v16
    s_cmp_lt_u32 s51, 4
    s_cselect_b32 s3, 0, 0x800000
    s_add_u32 s3, s3, 20480
    v_lshrrev_b32 v2, 1, v10
    v_mad_u32_u24 v16, v2, s3, v16
    s_mul_i32 s50, s44, 20480
    s_add_u32 s51, s50, s3
    v_mov_b32 v17, 0xf149f2ca
    v_lshlrev_b32 v2, 2, v10
    v_sub_u32 v2, v9, v2
    s_cmp_eq_u32 s44, 0
    s_cselect_b32 s3, 0xf149f2ca, 0
    v_subrev_u32 v3, 0, v2
    v_and_b32 v4, 0x80000001, v3
    v_cmp_eq_u32 vcc, 0, v4
    s_nop 1
    v_cndmask_b32 v28, v17, 0, vcc
    v_cmp_eq_u32 vcc, 0x80000000, v4
    s_nop 1
    v_cndmask_b32 v24, v17, 0, vcc
    v_add_f32 v32, s3, v24
    v_subrev_u32 v3, 1, v2
    v_and_b32 v4, 0x80000001, v3
    v_cmp_eq_u32 vcc, 0, v4
    s_nop 1
    v_cndmask_b32 v29, v17, 0, vcc
    v_cmp_eq_u32 vcc, 0x80000000, v4
    s_nop 1
    v_cndmask_b32 v25, v17, 0, vcc
    v_add_f32 v33, s3, v25
    v_subrev_u32 v3, 2, v2
    v_and_b32 v4, 0x80000001, v3
    v_cmp_eq_u32 vcc, 0, v4
    s_nop 1
    v_cndmask_b32 v30, v17, 0, vcc
    v_cmp_eq_u32 vcc, 0x80000000, v4
    s_nop 1
    v_cndmask_b32 v26, v17, 0, vcc
    v_add_f32 v34, s3, v26
    v_subrev_u32 v3, 3, v2
    v_and_b32 v4, 0x80000001, v3
    v_cmp_eq_u32 vcc, 0, v4
    s_nop 1
    v_cndmask_b32 v31, v17, 0, vcc
    v_cmp_eq_u32 vcc, 0x80000000, v4
    s_nop 1
    v_cndmask_b32 v27, v17, 0, vcc
    v_add_f32 v35, s3, v27
    v_mov_b32 v3, 0x0c0c0c0c
    v_mov_b32 v4, 0xc0c0100
    v_cmp_eq_u32 vcc, 0, v24
    v_mov_b32 v5, 0x1000c0c
    s_nop 0
    v_cndmask_b32 v3, v3, v4, vcc
    v_cmp_eq_u32 vcc, 0, v25
    s_nop 1
    v_cndmask_b32 v36, v3, v5, vcc
    v_mov_b32 v3, 0x0c0c0c0c
    v_mov_b32 v4, 0xc0c0302
    v_cmp_eq_u32 vcc, 0, v26
    v_mov_b32 v5, 0x3020c0c
    s_nop 0
    v_cndmask_b32 v3, v3, v4, vcc
    v_cmp_eq_u32 vcc, 0, v27
    s_nop 1
    v_cndmask_b32 v37, v3, v5, vcc
    v_mov_b32 v3, 0x0c0c0c0c
    v_mov_b32 v4, 0xc0c0100
    v_cmp_eq_u32 vcc, 0, v28
    v_mov_b32 v5, 0x1000c0c
    s_nop 0
    v_cndmask_b32 v3, v3, v4, vcc
    v_cmp_eq_u32 vcc, 0, v29
    s_nop 1
    v_cndmask_b32 v38, v3, v5, vcc
    v_mov_b32 v3, 0x0c0c0c0c
    v_mov_b32 v4, 0xc0c0302
    v_cmp_eq_u32 vcc, 0, v30
    v_mov_b32 v5, 0x3020c0c
    s_nop 0
    v_cndmask_b32 v3, v3, v4, vcc
    v_cmp_eq_u32 vcc, 0, v31
    s_nop 1
    v_cndmask_b32 v39, v3, v5, vcc
    s_mov_b32 s46, 0x3ea52b5c
    s_mov_b32 s47, s46
    s_mov_b32 s48, 0x3e64f92e
    s_mov_b32 s49, s48
    s_mov_b32 s36, 0xfffff
    s_cmp_lg_u32 s31, 0
    s_cselect_b32 s33, 64, 0
    v_mov_b32 v2, s33
    v_cmp_gt_u32 vcc, 10, v1
    s_lshr_b32 s3, s28, 1
    s_lshl2_add_u32 s3, s3, s31
    v_cndmask_b32 v2, 0, v2, vcc
    v_lshl_add_u32 v2, v1, 8, v2
    s_mul_i32 s3, s3, 2560
    s_lshl2_add_u32 s3, s35, s3
    s_add_u32 s3, s3, 524288
    v_add_u32 v8, s3, v2
    s_cmp_eq_u32 s43, 1
    s_cbranch_scc1 K_CONS
    v_lshrrev_b32 v2, 3, v1
    v_mul_u32_u24 v2, 1280, v2
    v_lshrrev_b32 v3, 4, v1
    v_lshlrev_b32 v3, 1, v3
    v_and_b32 v4, 7, v1
    v_xor_b32 v3, v3, v4
    v_lshl_add_u32 v2, v3, 4, v2
    s_lshl_b32 s33, s41, 7
    v_add_u32 v17, s33, v2
    s_mov_b32 s61, 9
    s_branch K_LOOPE
K_LOOP:
    s_waitcnt vmcnt(5)
    s_barrier
    s_add_u32 m0, s56, 2048
    s_add_u32 s60, s58, 30720
    buffer_load_dwordx4 v43, s[16:19], s60 offen lds
    s_add_u32 m0, s55, 3072
    s_add_u32 s60, s57, 30720
    buffer_load_dwordx4 v41, s[12:15], s60 offen lds
    s_add_u32 m0, s56, 3072
    s_add_u32 s60, s58, 46080
    buffer_load_dwordx4 v43, s[16:19], s60 offen lds
    s_add_u32 m0, s55, 4096
    s_add_u32 s60, s57, s62
    buffer_load_dwordx4 v40, s[12:15], s60 offen lds
    s_add_u32 m0, s55, 5120
    s_add_u32 s60, s60, 10240
    buffer_load_dwordx4 v41, s[12:15], s60 offen lds
    s_sub_u32 s61, s61, 1
    s_cmp_eq_u32 s61, 0
    s_cbranch_scc1 K_LOOPX
K_LOOPE:
    s_cmp_ge_u32 s55, 49152
    s_cselect_b32 s60, -2, 1
    s_mul_i32 s3, s60, 24576
    s_add_u32 s55, s55, s3
    s_lshl_b32 s60, s60, 14
    s_add_u32 s56, s56, s60
    s_lshl_b32 s57, s59, 7
    s_add_u32 s57, s57, s53
    s_mul_i32 s58, s59, 245760
    s_add_u32 s58, s58, s54
    s_add_u32 s59, s59, 1
    s_cmp_eq_u32 s59, 10
    s_cselect_b32 s59, 0, s59
    s_add_u32 m0, s56, 0
    s_add_u32 s60, s58, 0
    buffer_load_dwordx4 v42, s[16:19], s60 offen lds
    s_add_u32 m0, s55, 0
    s_max_i32 s60, s57, 0
    buffer_load_dwordx4 v40, s[12:15], s60 offen lds
    s_add_u32 m0, s56, 1024
    s_add_u32 s60, s58, 15360
    buffer_load_dwordx4 v42, s[16:19], s60 offen lds
    s_add_u32 s60, s57, 10240
    s_add_u32 m0, s55, 1024
    s_max_i32 s60, s60, 0
    buffer_load_dwordx4 v41, s[12:15], s60 offen lds
    s_add_u32 m0, s55, 2048
    s_add_u32 s60, s57, 20480
    buffer_load_dwordx4 v40, s[12:15], s60 offen lds
    s_branch K_LOOP
K_LOOPX:
    v_and_b32 v2, 7, v1
    v_lshlrev_b32 v2, 2, v2
    s_waitcnt vmcnt(0)
    s_barrier
    s_cmp_lt_u32 s30, 6
    s_cbranch_scc1 K_NOSMP
    global_load_dword v7, v2, s[8:9] offset:192 sc1
K_NOSMP:
    s_cmp_eq_u32 s34, -1
    s_cbranch_scc1 K_JOIN_S
    s_cmp_lt_u32 s52, 2
    s_cbranch_scc1 K_WOE
    s_cmp_lg_u32 s30, 7
    s_cbranch_scc1 K_JOIN_S
    s_mov_b32 s52, 2
    s_branch K_W7A
K_WOE:
    s_lshl_b32 s57, s52, 2
    s_lshr_b32 s57, 0x7520, s57
    s_and_b32 s57, s57, 7
    s_mul_i32 s57, s57, 51200
    s_mul_i32 s58, s52, 5120
    s_add_u32 s3, s57, 0
    s_add_u32 m0, s58, 0
    s_nop 0
    buffer_load_dwordx4 v17, s[24:27], s3 offen lds
    s_add_u32 s3, s57, 10240
    s_add_u32 m0, s58, 1024
    s_nop 0
    buffer_load_dwordx4 v17, s[24:27], s3 offen lds
    s_add_u32 s3, s57, 20480
    s_add_u32 m0, s58, 2048
    s_nop 0
    buffer_load_dwordx4 v17, s[24:27], s3 offen lds
    s_add_u32 s3, s57, 30720
    s_add_u32 m0, s58, 3072
    s_nop 0
    buffer_load_dwordx4 v17, s[24:27], s3 offen lds
    s_add_u32 s3, s57, 40960
    s_add_u32 m0, s58, 4096
    s_nop 0
    buffer_load_dwordx4 v17, s[24:27], s3 offen lds
    s_add_u32 s3, s57, 409600
    s_add_u32 m0, s58, 20480
    s_nop 0
    buffer_load_dwordx4 v17, s[24:27], s3 offen lds
    s_add_u32 s3, s57, 419840
    s_add_u32 m0, s58, 21504
    s_nop 0
    buffer_load_dwordx4 v17, s[24:27], s3 offen lds
    s_add_u32 s3, s57, 430080
    s_add_u32 m0, s58, 22528
    s_nop 0
    buffer_load_dwordx4 v17, s[24:27], s3 offen lds
    s_add_u32 s3, s57, 440320
    s_add_u32 m0, s58, 23552
    s_nop 0
    buffer_load_dwordx4 v17, s[24:27], s3 offen lds
    s_add_u32 s3, s57, 450560
    s_add_u32 m0, s58, 24576
    s_nop 0
    buffer_load_dwordx4 v17, s[24:27], s3 offen lds
    s_cmp_lg_u32 s30, 7
    s_cbranch_scc1 K_JOIN_S
    s_add_u32 s52, s52, 1
    s_cmp_lt_u32 s52, 4
    s_cbranch_scc1 K_WOE
    s_mov_b32 s52, 0
K_XD:
    s_lshl_b32 s57, s40, 3
    s_lshl1_add_u32 s57, s52, s57
    s_mul_i32 s57, s57, 20480
    s_lshl_b32 s33, s41, 7
    s_add_u32 s57, s57, s33
    s_lshl_b32 s33, s52, 12
    s_add_u32 m0, s33, 140288
    s_add_u32 s3, s57, 0
    buffer_load_dwordx4 v40, s[12:15], s3 offen lds
    s_add_u32 m0, s33, 141312
    s_add_u32 s3, s57, 10240
    buffer_load_dwordx4 v41, s[12:15], s3 offen lds
    s_add_u32 m0, s33, 142336
    s_add_u32 s3, s57, 20480
    buffer_load_dwordx4 v40, s[12:15], s3 offen lds
    s_add_u32 m0, s33, 143360
    s_add_u32 s3, s57, 30720
    buffer_load_dwordx4 v41, s[12:15], s3 offen lds
    s_add_u32 s52, s52, 1
    s_cmp_lt_u32 s52, 4
    s_cbranch_scc1 K_XD
    s_branch K_W7
.p2align 12
K_CONS:
    v_lshrrev_b32 v2, 1, v9
    v_xor_b32 v2, v2, v10
    v_lshlrev_b32 v2, 4, v2
    v_lshl_add_u32 v2, v9, 7, v2
    s_mul_i32 s3, s30, 6144
    v_add_u32 v40, s3, v2
    v_xor_b32 v41, 64, v40
    v_and_b32 v2, 1, v10
    v_lshl_or_b32 v2, v2, 2, v11
    v_lshlrev_b32 v2, 5, v2
    v_lshl_add_u32 v3, v10, 3, v11
    v_lshlrev_b32 v3, 8, v3
    v_add_u32 v3, 73728, v3
    v_lshlrev_b32 v5, 3, v12
    s_movk_i32 s33, 0xff
    s_mov_b32 s3, 0x48209870
    v_lshrrev_b32 v4, v5, s3
    v_add_u32 v4, v4, v2
    v_and_or_b32 v42, v4, s33, v3
    s_mov_b32 s3, 0xf8f0e8c0
    v_lshrrev_b32 v4, v5, s3
    v_add_u32 v4, v4, v2
    v_and_or_b32 v43, v4, s33, v3
    v_add_u32 v2, v2, v5
    v_add_u32 v4, 80, v2
    v_and_or_b32 v44, v4, s33, v3
    v_add_u32 v4, 120, v2
    v_and_or_b32 v45, v4, s33, v3
    v_add_u32 v4, 0, v2
    v_and_or_b32 v46, v4, s33, v3
    v_add_u32 v4, 40, v2
    v_and_or_b32 v47, v4, s33, v3
    v_add_u32 v4, 160, v2
    v_and_or_b32 v48, v4, s33, v3
    v_add_u32 v4, 200, v2
    v_and_or_b32 v49, v4, s33, v3
    s_lshl_b32 s3, s30, 2
    s_add_u32 s3, s3, 158800
    v_mov_b32 v50, s3
    v_mov_b32 v4, 1
    v_mov_b32 v5, 2
    v_mov_b64 v[52:53], 0
    v_mov_b64 v[54:55], 0
    v_mov_b64 v[56:57], 0
    v_mov_b64 v[58:59], 0
    v_mov_b64 v[60:61], 0
    v_mov_b64 v[62:63], 0
    v_mov_b64 v[64:65], 0
    v_mov_b64 v[66:67], 0
    v_mov_b64 v[68:69], 0
    v_mov_b64 v[70:71], 0
    v_mov_b64 v[72:73], 0
    v_mov_b64 v[74:75], 0
    v_mov_b64 v[76:77], 0
    v_mov_b64 v[78:79], 0
    v_mov_b64 v[80:81], 0
    v_mov_b64 v[82:83], 0
    v_mov_b64 v[84:85], 0
    v_mov_b64 v[86:87], 0
    v_mov_b64 v[88:89], 0
    v_mov_b64 v[90:91], 0
    v_mov_b64 v[92:93], 0
    v_mov_b64 v[94:95], 0
    v_mov_b64 v[96:97], 0
    v_mov_b64 v[98:99], 0
    v_mov_b64 v[100:101], 0
    v_mov_b64 v[102:103], 0
    v_mov_b64 v[104:105], 0
    v_mov_b64 v[106:107], 0
    v_mov_b64 v[108:109], 0
    v_mov_b64 v[110:111], 0
    v_mov_b64 v[112:113], 0
    v_mov_b64 v[114:115], 0
    v_mov_b64 v[116:117], 0
    v_mov_b64 v[118:119], 0
    v_mov_b64 v[120:121], 0
    v_mov_b64 v[122:123], 0
    v_mov_b64 v[124:125], 0
    v_mov_b64 v[126:127], 0
    v_mov_b64 v[128:129], 0
    v_mov_b64 v[130:131], 0
    v_mov_b64 v[132:133], 0
    v_mov_b64 v[134:135], 0
    v_mov_b64 v[136:137], 0
    v_mov_b64 v[138:139], 0
    v_mov_b64 v[140:141], 0
    v_mov_b64 v[142:143], 0
    v_mov_b64 v[144:145], 0
    v_mov_b64 v[146:147], 0
    s_mov_b32 s52, 3
    s_cmp_lg_u32 s30, 0
    s_cbranch_scc1 K_WARMM0
    s_call_b64 s[38:39], WP_attd
    s_call_b64 s[38:39], WP_p2g
    s_branch K_WARMMX
K_WARMM0:
    s_cmp_lg_u32 s30, 1
    s_cbranch_scc1 K_WARMM1
    s_call_b64 s[38:39], WP_atts
    s_call_b64 s[38:39], WP_early
    s_branch K_WARMMX
K_WARMM1:
    s_cmp_lg_u32 s30, 2
    s_cbranch_scc1 K_WARMM2
    s_call_b64 s[38:39], WP_help
    s_call_b64 s[38:39], WP_flags
    s_branch K_WARMMX
K_WARMM2:
    s_call_b64 s[38:39], WP_spin
K_WARMMX:
    s_barrier
    ds_read_b128 v[148:151], v40 offset:49152
    ds_read_b64_tr_b16 v[172:173], v42 offset:32768
    ds_read_b64_tr_b16 v[174:175], v42 offset:33792
    ds_read_b128 v[152:155], v40 offset:51200
    ds_read_b128 v[156:159], v40 offset:53248
    ds_read_b64_tr_b16 v[176:177], v43 offset:32768
    ds_read_b64_tr_b16 v[178:179], v43 offset:33792
    ds_read_b64_tr_b16 v[180:181], v44 offset:32768
    ds_read_b64_tr_b16 v[182:183], v44 offset:33792
    ds_read_b64_tr_b16 v[184:185], v45 offset:32768
    ds_read_b64_tr_b16 v[186:187], v45 offset:33792
    ds_read_b64_tr_b16 v[188:189], v46 offset:32768
    ds_read_b64_tr_b16 v[190:191], v46 offset:33792
    ds_read_b64_tr_b16 v[192:193], v47 offset:32768
    ds_read_b64_tr_b16 v[194:195], v47 offset:33792
    ds_read_b64_tr_b16 v[196:197], v48 offset:32768
    ds_read_b64_tr_b16 v[198:199], v48 offset:33792
    ds_read_b64_tr_b16 v[200:201], v49 offset:32768
    ds_read_b64_tr_b16 v[202:203], v49 offset:33792
K_CLOOP:
    s_waitcnt lgkmcnt(0)
    v_mfma_f32_16x16x32_bf16 v[52:55], v[172:175], v[148:151], v[52:55]
    ds_read_b128 v[160:163], v41 offset:49152
    v_mfma_f32_16x16x32_bf16 v[56:59], v[176:179], v[148:151], v[56:59]
    ds_read_b64_tr_b16 v[204:205], v42 offset:40960
    v_mfma_f32_16x16x32_bf16 v[60:63], v[180:183], v[148:151], v[60:63]
    ds_read_b64_tr_b16 v[206:207], v42 offset:41984
    v_mfma_f32_16x16x32_bf16 v[64:67], v[184:187], v[148:151], v[64:67]
    ds_read_b128 v[164:167], v41 offset:51200
    v_mfma_f32_16x16x32_bf16 v[68:71], v[188:191], v[148:151], v[68:71]
    ds_read_b128 v[168:171], v41 offset:53248
    v_mfma_f32_16x16x32_bf16 v[72:75], v[192:195], v[148:151], v[72:75]
    ds_read_b64_tr_b16 v[208:209], v43 offset:40960
    v_mfma_f32_16x16x32_bf16 v[76:79], v[148:151], v[196:199], v[76:79]
    ds_read_b64_tr_b16 v[210:211], v43 offset:41984
    v_mfma_f32_16x16x32_bf16 v[80:83], v[148:151], v[200:203], v[80:83]
    ds_read_b64_tr_b16 v[212:213], v44 offset:40960
    v_mfma_f32_16x16x32_bf16 v[112:115], v[152:155], v[200:203], v[112:115]
    ds_read_b64_tr_b16 v[214:215], v44 offset:41984
    v_mfma_f32_16x16x32_bf16 v[108:111], v[152:155], v[196:199], v[108:111]
    ds_read_b64_tr_b16 v[216:217], v45 offset:40960
    v_mfma_f32_16x16x32_bf16 v[104:107], v[192:195], v[152:155], v[104:107]
    ds_read_b64_tr_b16 v[218:219], v45 offset:41984
    v_mfma_f32_16x16x32_bf16 v[100:103], v[188:191], v[152:155], v[100:103]
    ds_read_b64_tr_b16 v[220:221], v46 offset:40960
    v_mfma_f32_16x16x32_bf16 v[96:99], v[184:187], v[152:155], v[96:99]
    ds_read_b64_tr_b16 v[222:223], v46 offset:41984
    v_mfma_f32_16x16x32_bf16 v[92:95], v[180:183], v[152:155], v[92:95]
    ds_read_b64_tr_b16 v[224:225], v47 offset:40960
    v_mfma_f32_16x16x32_bf16 v[88:91], v[176:179], v[152:155], v[88:91]
    ds_read_b64_tr_b16 v[226:227], v47 offset:41984
    v_mfma_f32_16x16x32_bf16 v[84:87], v[172:175], v[152:155], v[84:87]
    ds_read_b64_tr_b16 v[228:229], v48 offset:40960
    v_mfma_f32_16x16x32_bf16 v[116:119], v[172:175], v[156:159], v[116:119]
    ds_read_b64_tr_b16 v[230:231], v48 offset:41984
    v_mfma_f32_16x16x32_bf16 v[120:123], v[176:179], v[156:159], v[120:123]
    ds_read_b64_tr_b16 v[232:233], v49 offset:40960
    v_mfma_f32_16x16x32_bf16 v[124:127], v[180:183], v[156:159], v[124:127]
    ds_read_b64_tr_b16 v[234:235], v49 offset:41984
    v_mfma_f32_16x16x32_bf16 v[128:131], v[184:187], v[156:159], v[128:131]
    v_mfma_f32_16x16x32_bf16 v[132:135], v[188:191], v[156:159], v[132:135]
    v_mfma_f32_16x16x32_bf16 v[136:139], v[192:195], v[156:159], v[136:139]
    v_mfma_f32_16x16x32_bf16 v[140:143], v[156:159], v[196:199], v[140:143]
    v_mfma_f32_16x16x32_bf16 v[144:147], v[156:159], v[200:203], v[144:147]
    s_waitcnt lgkmcnt(0)
    s_barrier
    v_mfma_f32_16x16x32_bf16 v[52:55], v[204:207], v[160:163], v[52:55]
    ds_read_b128 v[148:151], v40 offset:0
    v_mfma_f32_16x16x32_bf16 v[56:59], v[208:211], v[160:163], v[56:59]
    ds_read_b64_tr_b16 v[172:173], v42 offset:0
    v_mfma_f32_16x16x32_bf16 v[60:63], v[212:215], v[160:163], v[60:63]
    ds_read_b64_tr_b16 v[174:175], v42 offset:1024
    v_mfma_f32_16x16x32_bf16 v[64:67], v[216:219], v[160:163], v[64:67]
    ds_read_b128 v[152:155], v40 offset:2048
    v_mfma_f32_16x16x32_bf16 v[68:71], v[220:223], v[160:163], v[68:71]
    ds_read_b128 v[156:159], v40 offset:4096
    v_mfma_f32_16x16x32_bf16 v[72:75], v[224:227], v[160:163], v[72:75]
    ds_read_b64_tr_b16 v[176:177], v43 offset:0
    v_mfma_f32_16x16x32_bf16 v[76:79], v[160:163], v[228:231], v[76:79]
    ds_read_b64_tr_b16 v[178:179], v43 offset:1024
    v_mfma_f32_16x16x32_bf16 v[80:83], v[160:163], v[232:235], v[80:83]
    ds_read_b64_tr_b16 v[180:181], v44 offset:0
    v_mfma_f32_16x16x32_bf16 v[112:115], v[164:167], v[232:235], v[112:115]
    ds_read_b64_tr_b16 v[182:183], v44 offset:1024
    v_mfma_f32_16x16x32_bf16 v[108:111], v[164:167], v[228:231], v[108:111]
    ds_read_b64_tr_b16 v[184:185], v45 offset:0
    v_mfma_f32_16x16x32_bf16 v[104:107], v[224:227], v[164:167], v[104:107]
    ds_read_b64_tr_b16 v[186:187], v45 offset:1024
    v_mfma_f32_16x16x32_bf16 v[100:103], v[220:223], v[164:167], v[100:103]
    ds_read_b64_tr_b16 v[188:189], v46 offset:0
    v_mfma_f32_16x16x32_bf16 v[96:99], v[216:219], v[164:167], v[96:99]
    ds_read_b64_tr_b16 v[190:191], v46 offset:1024
    v_mfma_f32_16x16x32_bf16 v[92:95], v[212:215], v[164:167], v[92:95]
    ds_read_b64_tr_b16 v[192:193], v47 offset:0
    v_mfma_f32_16x16x32_bf16 v[88:91], v[208:211], v[164:167], v[88:91]
    ds_read_b64_tr_b16 v[194:195], v47 offset:1024
    v_mfma_f32_16x16x32_bf16 v[84:87], v[204:207], v[164:167], v[84:87]
    ds_read_b64_tr_b16 v[196:197], v48 offset:0
    v_mfma_f32_16x16x32_bf16 v[116:119], v[204:207], v[168:171], v[116:119]
    ds_read_b64_tr_b16 v[198:199], v48 offset:1024
    v_mfma_f32_16x16x32_bf16 v[120:123], v[208:211], v[168:171], v[120:123]
    ds_read_b64_tr_b16 v[200:201], v49 offset:0
    v_mfma_f32_16x16x32_bf16 v[124:127], v[212:215], v[168:171], v[124:127]
    ds_read_b64_tr_b16 v[202:203], v49 offset:1024
    v_mfma_f32_16x16x32_bf16 v[128:131], v[216:219], v[168:171], v[128:131]
    v_mfma_f32_16x16x32_bf16 v[132:135], v[220:223], v[168:171], v[132:135]
    v_mfma_f32_16x16x32_bf16 v[136:139], v[224:227], v[168:171], v[136:139]
    v_mfma_f32_16x16x32_bf16 v[140:143], v[168:171], v[228:231], v[140:143]
    v_mfma_f32_16x16x32_bf16 v[144:147], v[168:171], v[232:235], v[144:147]
    s_waitcnt lgkmcnt(0)
    v_mfma_f32_16x16x32_bf16 v[52:55], v[172:175], v[148:151], v[52:55]
    ds_read_b128 v[160:163], v41 offset:0
    v_mfma_f32_16x16x32_bf16 v[56:59], v[176:179], v[148:151], v[56:59]
    ds_read_b64_tr_b16 v[204:205], v42 offset:8192
    v_mfma_f32_16x16x32_bf16 v[60:63], v[180:183], v[148:151], v[60:63]
    ds_read_b64_tr_b16 v[206:207], v42 offset:9216
    v_mfma_f32_16x16x32_bf16 v[64:67], v[184:187], v[148:151], v[64:67]
    ds_read_b128 v[164:167], v41 offset:2048
    v_mfma_f32_16x16x32_bf16 v[68:71], v[188:191], v[148:151], v[68:71]
    ds_read_b128 v[168:171], v41 offset:4096
    v_mfma_f32_16x16x32_bf16 v[72:75], v[192:195], v[148:151], v[72:75]
    ds_read_b64_tr_b16 v[208:209], v43 offset:8192
    v_mfma_f32_16x16x32_bf16 v[76:79], v[148:151], v[196:199], v[76:79]
    ds_read_b64_tr_b16 v[210:211], v43 offset:9216
    v_mfma_f32_16x16x32_bf16 v[80:83], v[148:151], v[200:203], v[80:83]
    ds_read_b64_tr_b16 v[212:213], v44 offset:8192
    v_mfma_f32_16x16x32_bf16 v[112:115], v[152:155], v[200:203], v[112:115]
    ds_read_b64_tr_b16 v[214:215], v44 offset:9216
    v_mfma_f32_16x16x32_bf16 v[108:111], v[152:155], v[196:199], v[108:111]
    ds_read_b64_tr_b16 v[216:217], v45 offset:8192
    v_mfma_f32_16x16x32_bf16 v[104:107], v[192:195], v[152:155], v[104:107]
    ds_read_b64_tr_b16 v[218:219], v45 offset:9216
    v_mfma_f32_16x16x32_bf16 v[100:103], v[188:191], v[152:155], v[100:103]
    ds_read_b64_tr_b16 v[220:221], v46 offset:8192
    v_mfma_f32_16x16x32_bf16 v[96:99], v[184:187], v[152:155], v[96:99]
    ds_read_b64_tr_b16 v[222:223], v46 offset:9216
    v_mfma_f32_16x16x32_bf16 v[92:95], v[180:183], v[152:155], v[92:95]
    ds_read_b64_tr_b16 v[224:225], v47 offset:8192
    v_mfma_f32_16x16x32_bf16 v[88:91], v[176:179], v[152:155], v[88:91]
    ds_read_b64_tr_b16 v[226:227], v47 offset:9216
    v_mfma_f32_16x16x32_bf16 v[84:87], v[172:175], v[152:155], v[84:87]
    ds_read_b64_tr_b16 v[228:229], v48 offset:8192
    v_mfma_f32_16x16x32_bf16 v[116:119], v[172:175], v[156:159], v[116:119]
    ds_read_b64_tr_b16 v[230:231], v48 offset:9216
    v_mfma_f32_16x16x32_bf16 v[120:123], v[176:179], v[156:159], v[120:123]
    ds_read_b64_tr_b16 v[232:233], v49 offset:8192
    v_mfma_f32_16x16x32_bf16 v[124:127], v[180:183], v[156:159], v[124:127]
    ds_read_b64_tr_b16 v[234:235], v49 offset:9216
    v_mfma_f32_16x16x32_bf16 v[128:131], v[184:187], v[156:159], v[128:131]
    v_mfma_f32_16x16x32_bf16 v[132:135], v[188:191], v[156:159], v[132:135]
    v_mfma_f32_16x16x32_bf16 v[136:139], v[192:195], v[156:159], v[136:139]
    v_mfma_f32_16x16x32_bf16 v[140:143], v[156:159], v[196:199], v[140:143]
    v_mfma_f32_16x16x32_bf16 v[144:147], v[156:159], v[200:203], v[144:147]
    s_waitcnt lgkmcnt(0)
    s_barrier
    v_mfma_f32_16x16x32_bf16 v[52:55], v[204:207], v[160:163], v[52:55]
    ds_read_b128 v[148:151], v40 offset:24576
    v_mfma_f32_16x16x32_bf16 v[56:59], v[208:211], v[160:163], v[56:59]
    ds_read_b64_tr_b16 v[172:173], v42 offset:16384
    v_mfma_f32_16x16x32_bf16 v[60:63], v[212:215], v[160:163], v[60:63]
    ds_read_b64_tr_b16 v[174:175], v42 offset:17408
    v_mfma_f32_16x16x32_bf16 v[64:67], v[216:219], v[160:163], v[64:67]
    ds_read_b128 v[152:155], v40 offset:26624
    v_mfma_f32_16x16x32_bf16 v[68:71], v[220:223], v[160:163], v[68:71]
    ds_read_b128 v[156:159], v40 offset:28672
    v_mfma_f32_16x16x32_bf16 v[72:75], v[224:227], v[160:163], v[72:75]
    ds_read_b64_tr_b16 v[176:177], v43 offset:16384
    v_mfma_f32_16x16x32_bf16 v[76:79], v[160:163], v[228:231], v[76:79]
    ds_read_b64_tr_b16 v[178:179], v43 offset:17408
    v_mfma_f32_16x16x32_bf16 v[80:83], v[160:163], v[232:235], v[80:83]
    ds_read_b64_tr_b16 v[180:181], v44 offset:16384
    v_mfma_f32_16x16x32_bf16 v[112:115], v[164:167], v[232:235], v[112:115]
    ds_read_b64_tr_b16 v[182:183], v44 offset:17408
    v_mfma_f32_16x16x32_bf16 v[108:111], v[164:167], v[228:231], v[108:111]
    ds_read_b64_tr_b16 v[184:185], v45 offset:16384
    v_mfma_f32_16x16x32_bf16 v[104:107], v[224:227], v[164:167], v[104:107]
    ds_read_b64_tr_b16 v[186:187], v45 offset:17408
    v_mfma_f32_16x16x32_bf16 v[100:103], v[220:223], v[164:167], v[100:103]
    ds_read_b64_tr_b16 v[188:189], v46 offset:16384
    v_mfma_f32_16x16x32_bf16 v[96:99], v[216:219], v[164:167], v[96:99]
    ds_read_b64_tr_b16 v[190:191], v46 offset:17408
    v_mfma_f32_16x16x32_bf16 v[92:95], v[212:215], v[164:167], v[92:95]
    ds_read_b64_tr_b16 v[192:193], v47 offset:16384
    v_mfma_f32_16x16x32_bf16 v[88:91], v[208:211], v[164:167], v[88:91]
    ds_read_b64_tr_b16 v[194:195], v47 offset:17408
    v_mfma_f32_16x16x32_bf16 v[84:87], v[204:207], v[164:167], v[84:87]
    ds_read_b64_tr_b16 v[196:197], v48 offset:16384
    v_mfma_f32_16x16x32_bf16 v[116:119], v[204:207], v[168:171], v[116:119]
    ds_read_b64_tr_b16 v[198:199], v48 offset:17408
    v_mfma_f32_16x16x32_bf16 v[120:123], v[208:211], v[168:171], v[120:123]
    ds_read_b64_tr_b16 v[200:201], v49 offset:16384
    v_mfma_f32_16x16x32_bf16 v[124:127], v[212:215], v[168:171], v[124:127]
    ds_read_b64_tr_b16 v[202:203], v49 offset:17408
    v_mfma_f32_16x16x32_bf16 v[128:131], v[216:219], v[168:171], v[128:131]
    v_mfma_f32_16x16x32_bf16 v[132:135], v[220:223], v[168:171], v[132:135]
    v_mfma_f32_16x16x32_bf16 v[136:139], v[224:227], v[168:171], v[136:139]
    v_mfma_f32_16x16x32_bf16 v[140:143], v[168:171], v[228:231], v[140:143]
    v_mfma_f32_16x16x32_bf16 v[144:147], v[168:171], v[232:235], v[144:147]
    s_waitcnt lgkmcnt(0)
    v_mfma_f32_16x16x32_bf16 v[52:55], v[172:175], v[148:151], v[52:55]
    ds_read_b128 v[160:163], v41 offset:24576
    v_mfma_f32_16x16x32_bf16 v[56:59], v[176:179], v[148:151], v[56:59]
    ds_read_b64_tr_b16 v[204:205], v42 offset:24576
    v_mfma_f32_16x16x32_bf16 v[60:63], v[180:183], v[148:151], v[60:63]
    ds_read_b64_tr_b16 v[206:207], v42 offset:25600
    v_mfma_f32_16x16x32_bf16 v[64:67], v[184:187], v[148:151], v[64:67]
    ds_read_b128 v[164:167], v41 offset:26624
    v_mfma_f32_16x16x32_bf16 v[68:71], v[188:191], v[148:151], v[68:71]
    ds_read_b128 v[168:171], v41 offset:28672
    v_mfma_f32_16x16x32_bf16 v[72:75], v[192:195], v[148:151], v[72:75]
    ds_read_b64_tr_b16 v[208:209], v43 offset:24576
    v_mfma_f32_16x16x32_bf16 v[76:79], v[148:151], v[196:199], v[76:79]
    ds_read_b64_tr_b16 v[210:211], v43 offset:25600
    v_mfma_f32_16x16x32_bf16 v[80:83], v[148:151], v[200:203], v[80:83]
    ds_read_b64_tr_b16 v[212:213], v44 offset:24576
    v_mfma_f32_16x16x32_bf16 v[112:115], v[152:155], v[200:203], v[112:115]
    ds_read_b64_tr_b16 v[214:215], v44 offset:25600
    v_mfma_f32_16x16x32_bf16 v[108:111], v[152:155], v[196:199], v[108:111]
    ds_read_b64_tr_b16 v[216:217], v45 offset:24576
    v_mfma_f32_16x16x32_bf16 v[104:107], v[192:195], v[152:155], v[104:107]
    ds_read_b64_tr_b16 v[218:219], v45 offset:25600
    v_mfma_f32_16x16x32_bf16 v[100:103], v[188:191], v[152:155], v[100:103]
    ds_read_b64_tr_b16 v[220:221], v46 offset:24576
    v_mfma_f32_16x16x32_bf16 v[96:99], v[184:187], v[152:155], v[96:99]
    ds_read_b64_tr_b16 v[222:223], v46 offset:25600
    v_mfma_f32_16x16x32_bf16 v[92:95], v[180:183], v[152:155], v[92:95]
    ds_read_b64_tr_b16 v[224:225], v47 offset:24576
    v_mfma_f32_16x16x32_bf16 v[88:91], v[176:179], v[152:155], v[88:91]
    ds_read_b64_tr_b16 v[226:227], v47 offset:25600
    v_mfma_f32_16x16x32_bf16 v[84:87], v[172:175], v[152:155], v[84:87]
    ds_read_b64_tr_b16 v[228:229], v48 offset:24576
    v_mfma_f32_16x16x32_bf16 v[116:119], v[172:175], v[156:159], v[116:119]
    ds_read_b64_tr_b16 v[230:231], v48 offset:25600
    v_mfma_f32_16x16x32_bf16 v[120:123], v[176:179], v[156:159], v[120:123]
    ds_read_b64_tr_b16 v[232:233], v49 offset:24576
    v_mfma_f32_16x16x32_bf16 v[124:127], v[180:183], v[156:159], v[124:127]
    ds_read_b64_tr_b16 v[234:235], v49 offset:25600
    v_mfma_f32_16x16x32_bf16 v[128:131], v[184:187], v[156:159], v[128:131]
    v_mfma_f32_16x16x32_bf16 v[132:135], v[188:191], v[156:159], v[132:135]
    v_mfma_f32_16x16x32_bf16 v[136:139], v[192:195], v[156:159], v[136:139]
    v_mfma_f32_16x16x32_bf16 v[140:143], v[156:159], v[196:199], v[140:143]
    v_mfma_f32_16x16x32_bf16 v[144:147], v[156:159], v[200:203], v[144:147]
    s_waitcnt lgkmcnt(0)
    s_barrier
    v_mfma_f32_16x16x32_bf16 v[52:55], v[204:207], v[160:163], v[52:55]
    ds_read_b128 v[148:151], v40 offset:49152
    v_mfma_f32_16x16x32_bf16 v[56:59], v[208:211], v[160:163], v[56:59]
    ds_read_b64_tr_b16 v[172:173], v42 offset:32768
    v_mfma_f32_16x16x32_bf16 v[60:63], v[212:215], v[160:163], v[60:63]
    ds_read_b64_tr_b16 v[174:175], v42 offset:33792
    v_mfma_f32_16x16x32_bf16 v[64:67], v[216:219], v[160:163], v[64:67]
    ds_read_b128 v[152:155], v40 offset:51200
    v_mfma_f32_16x16x32_bf16 v[68:71], v[220:223], v[160:163], v[68:71]
    ds_read_b128 v[156:159], v40 offset:53248
    v_mfma_f32_16x16x32_bf16 v[72:75], v[224:227], v[160:163], v[72:75]
    ds_read_b64_tr_b16 v[176:177], v43 offset:32768
    v_mfma_f32_16x16x32_bf16 v[76:79], v[160:163], v[228:231], v[76:79]
    ds_read_b64_tr_b16 v[178:179], v43 offset:33792
    v_mfma_f32_16x16x32_bf16 v[80:83], v[160:163], v[232:235], v[80:83]
    ds_read_b64_tr_b16 v[180:181], v44 offset:32768
    v_mfma_f32_16x16x32_bf16 v[112:115], v[164:167], v[232:235], v[112:115]
    ds_read_b64_tr_b16 v[182:183], v44 offset:33792
    v_mfma_f32_16x16x32_bf16 v[108:111], v[164:167], v[228:231], v[108:111]
    ds_read_b64_tr_b16 v[184:185], v45 offset:32768
    v_mfma_f32_16x16x32_bf16 v[104:107], v[224:227], v[164:167], v[104:107]
    ds_read_b64_tr_b16 v[186:187], v45 offset:33792
    v_mfma_f32_16x16x32_bf16 v[100:103], v[220:223], v[164:167], v[100:103]
    ds_read_b64_tr_b16 v[188:189], v46 offset:32768
    v_mfma_f32_16x16x32_bf16 v[96:99], v[216:219], v[164:167], v[96:99]
    ds_read_b64_tr_b16 v[190:191], v46 offset:33792
    v_mfma_f32_16x16x32_bf16 v[92:95], v[212:215], v[164:167], v[92:95]
    ds_read_b64_tr_b16 v[192:193], v47 offset:32768
    v_mfma_f32_16x16x32_bf16 v[88:91], v[208:211], v[164:167], v[88:91]
    ds_read_b64_tr_b16 v[194:195], v47 offset:33792
    v_mfma_f32_16x16x32_bf16 v[84:87], v[204:207], v[164:167], v[84:87]
    ds_read_b64_tr_b16 v[196:197], v48 offset:32768
    v_mfma_f32_16x16x32_bf16 v[116:119], v[204:207], v[168:171], v[116:119]
    ds_read_b64_tr_b16 v[198:199], v48 offset:33792
    v_mfma_f32_16x16x32_bf16 v[120:123], v[208:211], v[168:171], v[120:123]
    ds_read_b64_tr_b16 v[200:201], v49 offset:32768
    v_mfma_f32_16x16x32_bf16 v[124:127], v[212:215], v[168:171], v[124:127]
    ds_read_b64_tr_b16 v[202:203], v49 offset:33792
    v_mfma_f32_16x16x32_bf16 v[128:131], v[216:219], v[168:171], v[128:131]
    s_sub_u32 s52, s52, 1
    v_mfma_f32_16x16x32_bf16 v[132:135], v[220:223], v[168:171], v[132:135]
    s_cmp_lg_u32 s52, 0
    v_mfma_f32_16x16x32_bf16 v[136:139], v[224:227], v[168:171], v[136:139]
    v_mfma_f32_16x16x32_bf16 v[140:143], v[168:171], v[228:231], v[140:143]
    v_mfma_f32_16x16x32_bf16 v[144:147], v[168:171], v[232:235], v[144:147]
    s_cbranch_scc1 K_CLOOP
    s_waitcnt lgkmcnt(0)
    v_mfma_f32_16x16x32_bf16 v[52:55], v[172:175], v[148:151], v[52:55]
    ds_read_b128 v[160:163], v41 offset:49152
    ds_read_b64_tr_b16 v[204:205], v42 offset:40960
    v_mfma_f32_16x16x32_bf16 v[116:119], v[172:175], v[156:159], v[116:119]
    ds_read_b64_tr_b16 v[206:207], v42 offset:41984
    ds_read_b128 v[164:167], v41 offset:51200
    v_mfma_f32_16x16x32_bf16 v[84:87], v[172:175], v[152:155], v[84:87]
    ds_read_b128 v[168:171], v41 offset:53248
    ds_read_b64_tr_b16 v[208:209], v43 offset:40960
    v_mfma_f32_16x16x32_bf16 v[56:59], v[176:179], v[148:151], v[56:59]
    ds_read_b64_tr_b16 v[210:211], v43 offset:41984
    ds_read_b64_tr_b16 v[212:213], v44 offset:40960
    v_mfma_f32_16x16x32_bf16 v[120:123], v[176:179], v[156:159], v[120:123]
    ds_read_b64_tr_b16 v[214:215], v44 offset:41984
    ds_read_b64_tr_b16 v[216:217], v45 offset:40960
    v_mfma_f32_16x16x32_bf16 v[88:91], v[176:179], v[152:155], v[88:91]
    ds_read_b64_tr_b16 v[218:219], v45 offset:41984
    ds_read_b64_tr_b16 v[220:221], v46 offset:40960
    v_mfma_f32_16x16x32_bf16 v[60:63], v[180:183], v[148:151], v[60:63]
    ds_read_b64_tr_b16 v[222:223], v46 offset:41984
    ds_read_b64_tr_b16 v[224:225], v47 offset:40960
    v_mfma_f32_16x16x32_bf16 v[124:127], v[180:183], v[156:159], v[124:127]
    ds_read_b64_tr_b16 v[226:227], v47 offset:41984
    ds_read_b64_tr_b16 v[228:229], v48 offset:40960
    v_mfma_f32_16x16x32_bf16 v[92:95], v[180:183], v[152:155], v[92:95]
    ds_read_b64_tr_b16 v[230:231], v48 offset:41984
    ds_read_b64_tr_b16 v[232:233], v49 offset:40960
    v_mfma_f32_16x16x32_bf16 v[64:67], v[184:187], v[148:151], v[64:67]
    ds_read_b64_tr_b16 v[234:235], v49 offset:41984
    v_mfma_f32_16x16x32_bf16 v[128:131], v[184:187], v[156:159], v[128:131]
    s_nop 1
    v_mfma_f32_16x16x32_bf16 v[96:99], v[184:187], v[152:155], v[96:99]
    s_nop 1
    s_waitcnt lgkmcnt(15)
    v_mfma_f32_16x16x32_bf16 v[52:55], v[204:207], v[160:163], v[52:55]
    s_nop 1
    s_waitcnt lgkmcnt(12)
    v_mfma_f32_16x16x32_bf16 v[56:59], v[208:211], v[160:163], v[56:59]
    s_nop 1
    v_mfma_f32_16x16x32_bf16 v[116:119], v[204:207], v[168:171], v[116:119]
    s_nop 1
    v_mfma_f32_16x16x32_bf16 v[120:123], v[208:211], v[168:171], v[120:123]
    s_nop 1
    v_mfma_f32_16x16x32_bf16 v[84:87], v[204:207], v[164:167], v[84:87]
    v_cvt_pk_bf16_f32 v52, v52, v53
    v_cvt_pk_bf16_f32 v53, v54, v55
    v_mfma_f32_16x16x32_bf16 v[88:91], v[208:211], v[164:167], v[88:91]
    v_cvt_pk_bf16_f32 v54, v56, v57
    v_cvt_pk_bf16_f32 v55, v58, v59
    s_waitcnt lgkmcnt(10)
    v_mfma_f32_16x16x32_bf16 v[60:63], v[212:215], v[160:163], v[60:63]
    ds_write_b128 v13, v[52:55] offset:0
    s_waitcnt lgkmcnt(9)
    v_mfma_f32_16x16x32_bf16 v[64:67], v[216:219], v[160:163], v[64:67]
    v_cvt_pk_bf16_f32 v116, v116, v117
    v_cvt_pk_bf16_f32 v117, v118, v119
    v_mfma_f32_16x16x32_bf16 v[124:127], v[212:215], v[168:171], v[124:127]
    v_cvt_pk_bf16_f32 v118, v120, v121
    v_cvt_pk_bf16_f32 v119, v122, v123
    v_mfma_f32_16x16x32_bf16 v[128:131], v[216:219], v[168:171], v[128:131]
    ds_write_b128 v13, v[116:119] offset:2048
    v_mfma_f32_16x16x32_bf16 v[92:95], v[212:215], v[164:167], v[92:95]
    v_cvt_pk_bf16_f32 v84, v84, v85
    v_cvt_pk_bf16_f32 v85, v86, v87
    v_mfma_f32_16x16x32_bf16 v[96:99], v[216:219], v[164:167], v[96:99]
    v_cvt_pk_bf16_f32 v86, v88, v89
    v_cvt_pk_bf16_f32 v87, v90, v91
    v_mfma_f32_16x16x32_bf16 v[68:71], v[188:191], v[148:151], v[68:71]
    ds_write_b128 v13, v[84:87] offset:1024
    v_mfma_f32_16x16x32_bf16 v[72:75], v[192:195], v[148:151], v[72:75]
    v_cvt_pk_bf16_f32 v60, v60, v61
    v_cvt_pk_bf16_f32 v61, v62, v63
    s_waitcnt lgkmcnt(9)
    v_mfma_f32_16x16x32_bf16 v[68:71], v[220:223], v[160:163], v[68:71]
    v_cvt_pk_bf16_f32 v64, v64, v65
    v_cvt_pk_bf16_f32 v65, v66, v67
    s_waitcnt lgkmcnt(7)
    v_mfma_f32_16x16x32_bf16 v[72:75], v[224:227], v[160:163], v[72:75]
    ds_write2st64_b64 v14, v[60:61], v[64:65] offset0:4 offset1:5
    v_mfma_f32_16x16x32_bf16 v[132:135], v[188:191], v[156:159], v[132:135]
    ds_read_b64 v[62:63], v13 offset:0
    ds_read_b64 v[66:67], v13 offset:0
    v_mfma_f32_16x16x32_bf16 v[136:139], v[192:195], v[156:159], v[136:139]
    v_cvt_pk_bf16_f32 v124, v124, v125
    v_cvt_pk_bf16_f32 v125, v126, v127
    v_mfma_f32_16x16x32_bf16 v[132:135], v[220:223], v[168:171], v[132:135]
    v_cvt_pk_bf16_f32 v128, v128, v129
    v_cvt_pk_bf16_f32 v129, v130, v131
    v_mfma_f32_16x16x32_bf16 v[136:139], v[224:227], v[168:171], v[136:139]
    ds_write2st64_b64 v14, v[124:125], v[128:129] offset0:10 offset1:11
    v_mfma_f32_16x16x32_bf16 v[100:103], v[188:191], v[152:155], v[100:103]
    ds_read_b64 v[126:127], v13 offset:2048
    ds_read_b64 v[130:131], v13 offset:2048
    v_mfma_f32_16x16x32_bf16 v[104:107], v[192:195], v[152:155], v[104:107]
    v_cvt_pk_bf16_f32 v92, v92, v93
    v_cvt_pk_bf16_f32 v93, v94, v95
    v_mfma_f32_16x16x32_bf16 v[100:103], v[220:223], v[164:167], v[100:103]
    v_cvt_pk_bf16_f32 v96, v96, v97
    v_cvt_pk_bf16_f32 v97, v98, v99
    v_mfma_f32_16x16x32_bf16 v[104:107], v[224:227], v[164:167], v[104:107]
    ds_read_b64 v[94:95], v13 offset:1024
    ds_read_b64 v[98:99], v13 offset:1024
    v_mfma_f32_16x16x32_bf16 v[76:79], v[148:151], v[196:199], v[76:79]
    v_cvt_pk_bf16_f32 v68, v68, v69
    v_cvt_pk_bf16_f32 v69, v70, v71
    v_mfma_f32_16x16x32_bf16 v[80:83], v[148:151], v[200:203], v[80:83]
    v_cvt_pk_bf16_f32 v72, v72, v73
    v_cvt_pk_bf16_f32 v73, v74, v75
    s_waitcnt lgkmcnt(13)
    v_mfma_f32_16x16x32_bf16 v[76:79], v[160:163], v[228:231], v[76:79]
    ds_write2st64_b64 v14, v[68:69], v[72:73] offset0:8 offset1:9
    s_waitcnt lgkmcnt(12)
    v_mfma_f32_16x16x32_bf16 v[80:83], v[160:163], v[232:235], v[80:83]
    ds_write_b32 v50, v4
    v_cvt_pk_bf16_f32 v132, v132, v133
    v_mfma_f32_16x16x32_bf16 v[140:143], v[156:159], v[196:199], v[140:143]
    v_cvt_pk_bf16_f32 v133, v134, v135
    v_cvt_pk_bf16_f32 v136, v136, v137
    v_mfma_f32_16x16x32_bf16 v[144:147], v[156:159], v[200:203], v[144:147]
    v_cvt_pk_bf16_f32 v137, v138, v139
    ds_read_b64 v[134:135], v18 offset:2048
    v_mfma_f32_16x16x32_bf16 v[140:143], v[168:171], v[228:231], v[140:143]
    ds_read_b64 v[138:139], v19 offset:2048
    v_cvt_pk_bf16_f32 v100, v100, v101
    v_mfma_f32_16x16x32_bf16 v[144:147], v[168:171], v[232:235], v[144:147]
    v_cvt_pk_bf16_f32 v101, v102, v103
    v_cvt_pk_bf16_f32 v104, v104, v105
    v_mfma_f32_16x16x32_bf16 v[108:111], v[152:155], v[196:199], v[108:111]
    v_cvt_pk_bf16_f32 v105, v106, v107
    ds_read_b64 v[102:103], v18 offset:1024
    v_mfma_f32_16x16x32_bf16 v[112:115], v[152:155], v[200:203], v[112:115]
    ds_read_b64 v[106:107], v19 offset:1024
    v_cvt_pk_bf16_f32 v236, v76, v77
    v_mfma_f32_16x16x32_bf16 v[108:111], v[164:167], v[228:231], v[108:111]
    v_cvt_pk_bf16_f32 v237, v78, v79
    v_cvt_pk_bf16_f32 v242, v80, v81
    v_mfma_f32_16x16x32_bf16 v[112:115], v[164:167], v[232:235], v[112:115]
    v_cvt_pk_bf16_f32 v243, v82, v83
    v_cvt_pk_bf16_f32 v240, v140, v141
    s_branch WS_attd
.p2align 12
WP_attd:
    s_setpc_b64 s[38:39]
WS_attd:
    s_waitcnt lgkmcnt(3)
    v_mfma_f32_16x16x32_bf16 v[208:211], v[124:127], v[132:135], v[28:31]
    ds_write2st64_b64 v14, v[236:237], v[242:243] offset0:6 offset1:7
    v_mfma_f32_16x16x32_bf16 v[204:207], v[92:95], v[132:135], v[24:27]
    v_cvt_pk_bf16_f32 v241, v142, v143
    v_cvt_pk_bf16_f32 v246, v144, v145
    s_waitcnt lgkmcnt(3)
    v_mfma_f32_16x16x32_bf16 v[216:219], v[128:131], v[136:139], v[28:31]
    v_cvt_pk_bf16_f32 v247, v146, v147
    ds_read_b64_tr_b16 v[188:189], v20 offset:0
    v_mfma_f32_16x16x32_bf16 v[212:215], v[96:99], v[136:139], v[24:27]
    ds_write2st64_b64 v14, v[240:241], v[246:247] offset0:12 offset1:13
    s_waitcnt lgkmcnt(4)
    v_mfma_f32_16x16x32_bf16 v[176:179], v[92:95], v[100:103], v[28:31]
    ds_write_b32 v50, v5
    v_max3_f32 v72, v204, v205, v208
    v_mfma_f32_16x16x32_bf16 v[172:175], v[60:63], v[100:103], v[32:35]
    v_max3_f32 v73, v206, v207, v210
    v_max_f32 v72, v72, v209
    s_waitcnt lgkmcnt(4)
    v_mfma_f32_16x16x32_bf16 v[184:187], v[96:99], v[104:107], v[28:31]
    v_max_f32 v73, v73, v211
    v_max3_f32 v74, v212, v213, v216
    v_mfma_f32_16x16x32_bf16 v[180:183], v[64:67], v[104:107], v[32:35]
    v_max3_f32 v75, v214, v215, v218
    v_max_f32 v74, v74, v217
    ds_read_b64_tr_b16 v[190:191], v20 offset:1024
    ds_read_b64_tr_b16 v[192:193], v21 offset:0
    ds_read_b64_tr_b16 v[194:195], v21 offset:1024
    ds_read_b64_tr_b16 v[220:221], v22 offset:1024
    ds_read_b64_tr_b16 v[222:223], v22 offset:2048
    ds_read_b64_tr_b16 v[224:225], v23 offset:1024
    ds_read_b64_tr_b16 v[226:227], v23 offset:2048
    v_max_f32 v75, v75, v219
    v_max3_f32 v68, v172, v173, v176
    v_max3_f32 v69, v174, v175, v178
    v_max_f32 v68, v68, v177
    v_max_f32 v69, v69, v179
    v_max3_f32 v70, v180, v181, v184
    v_max3_f32 v71, v182, v183, v186
    v_max_f32 v70, v70, v185
    v_max_f32 v71, v71, v187
    v_permlane16_swap_b32 v72, v74
    v_permlane16_swap_b32 v73, v75
    v_permlane16_swap_b32 v68, v70
    v_permlane16_swap_b32 v69, v71
    v_cvt_pk_bf16_f32 v238, v108, v109
    v_permlane32_swap_b32 v68, v72
    v_permlane32_swap_b32 v70, v74
    v_permlane32_swap_b32 v69, v73
    v_permlane32_swap_b32 v71, v75
    v_max3_f32 v120, v68, v69, v72
    v_max3_f32 v121, v73, v70, v71
    v_max3_f32 v120, v120, v74, v75
    v_max_f32 v120, v120, v121
    v_mul_f32 v120, s46, v120
    v_pk_fma_f32 v[68:69], v[68:69], s[46:47], v[120:121] op_sel_hi:[1,1,0] neg_lo:[0,0,1] neg_hi:[0,0,1]
    v_pk_fma_f32 v[70:71], v[70:71], s[46:47], v[120:121] op_sel_hi:[1,1,0] neg_lo:[0,0,1] neg_hi:[0,0,1]
    v_pk_fma_f32 v[72:73], v[72:73], s[46:47], v[120:121] op_sel_hi:[1,1,0] neg_lo:[0,0,1] neg_hi:[0,0,1]
    v_pk_fma_f32 v[74:75], v[74:75], s[46:47], v[120:121] op_sel_hi:[1,1,0] neg_lo:[0,0,1] neg_hi:[0,0,1]
    v_exp_f32 v68, v68
    v_exp_f32 v69, v69
    v_exp_f32 v70, v70
    v_exp_f32 v71, v71
    v_exp_f32 v72, v72
    v_exp_f32 v73, v73
    v_exp_f32 v74, v74
    v_exp_f32 v75, v75
    v_pk_add_f32 v[56:57], v[68:69], v[70:71]
    v_pk_add_f32 v[58:59], v[72:73], v[74:75]
    v_pk_add_f32 v[56:57], v[56:57], v[58:59]
    v_add_f32 v56, v56, v57
    v_rcp_f32 v56, v56
    s_waitcnt lgkmcnt(0)
    v_pk_mul_f32 v[68:69], v[68:69], v[56:57] op_sel_hi:[1,0]
    v_pk_mul_f32 v[70:71], v[70:71], v[56:57] op_sel_hi:[1,0]
    v_pk_mul_f32 v[72:73], v[72:73], v[56:57] op_sel_hi:[1,0]
    v_pk_mul_f32 v[74:75], v[74:75], v[56:57] op_sel_hi:[1,0]
    v_cvt_pk_bf16_f32 v88, v68, v69
    v_cvt_pk_bf16_f32 v90, v72, v73
    v_cvt_pk_bf16_f32 v89, v70, v71
    v_cvt_pk_bf16_f32 v91, v74, v75
    v_permlane32_swap_b32 v88, v90
    v_cvt_pk_bf16_f32 v239, v110, v111
    v_permlane32_swap_b32 v89, v91
    v_cvt_pk_bf16_f32 v244, v112, v113
    v_cvt_pk_bf16_f32 v245, v114, v115
    v_permlane16_swap_b32 v88, v89
    v_permlane16_swap_b32 v90, v91
    v_perm_b32 v148, v88, v88, v36
    v_perm_b32 v149, v88, v88, v37
    v_perm_b32 v150, v88, v88, v38
    v_perm_b32 v151, v88, v88, v39
    v_perm_b32 v152, v89, v89, v36
    v_perm_b32 v153, v89, v89, v37
    v_mfma_f32_16x16x32_bf16 v[100:103], v[236:239], v[148:151], 0
    v_perm_b32 v154, v89, v89, v38
    v_perm_b32 v155, v89, v89, v39
    v_mfma_f32_16x16x32_bf16 v[156:159], v[188:191], v[148:151], 0
    v_perm_b32 v160, v90, v90, v36
    v_perm_b32 v161, v90, v90, v37
    v_mfma_f32_16x16x32_bf16 v[104:107], v[242:245], v[152:155], 0
    v_perm_b32 v162, v90, v90, v38
    v_perm_b32 v163, v90, v90, v39
    v_mfma_f32_16x16x32_bf16 v[156:159], v[192:195], v[152:155], v[156:159]
    v_perm_b32 v164, v91, v91, v36
    v_perm_b32 v165, v91, v91, v37
    v_mfma_f32_16x16x32_bf16 v[132:135], v[238:241], v[160:163], 0
    v_perm_b32 v166, v91, v91, v38
    v_perm_b32 v167, v91, v91, v39
    v_mfma_f32_16x16x32_bf16 v[156:159], v[220:223], v[160:163], v[156:159]
    v_cvt_pk_bf16_f32 v60, v100, v101
    v_cvt_pk_bf16_f32 v61, v102, v103
    v_mfma_f32_16x16x32_bf16 v[156:159], v[224:227], v[164:167], v[156:159]
    v_cvt_pk_bf16_f32 v62, v104, v105
    v_cvt_pk_bf16_f32 v63, v106, v107
    v_mfma_f32_16x16x32_bf16 v[136:139], v[244:247], v[164:167], 0
    buffer_store_dwordx4 v[60:63], v15, s[20:23], s50 offen sc1
    v_cvt_pk_bf16_f32 v64, v132, v133
    v_cvt_pk_bf16_f32 v65, v134, v135
    s_nop 1
    v_cvt_pk_bf16_f32 v56, v156, v157
    v_cvt_pk_bf16_f32 v57, v158, v159
    v_cvt_pk_bf16_f32 v58, v156, v157
    v_cvt_pk_bf16_f32 v59, v158, v159
    v_cvt_pk_bf16_f32 v66, v136, v137
    v_cvt_pk_bf16_f32 v67, v138, v139
    v_permlane16_swap_b32 v56, v58
    v_permlane16_swap_b32 v57, v59
    buffer_store_dwordx4 v[64:67], v15, s[20:23], s51 offen sc1
    buffer_store_dwordx4 v[56:59], v16, s[20:23], s50 offen sc1
    s_cmp_lg_u32 s34, -1
    s_cbranch_scc1 K_P2_EARLY
K_DRAIN:
    s_waitcnt vmcnt(0)
    s_barrier
    s_branch K_END
K_W7A:
    s_waitcnt vmcnt(0)
    v_and_b32 v4, 7, v1
    v_lshlrev_b32 v4, 2, v4
    s_mov_b32 s3, 131072
K_ZPOLL5:
    v_cmp_eq_u32 vcc, 0, v7
    s_cbranch_vccz K_ZOK5
    s_sub_u32 s3, s3, 1
    s_cbranch_scc1 K_ZOK5
    global_load_dword v7, v4, s[8:9] offset:192 sc1
    s_waitcnt vmcnt(0)
    s_branch K_ZPOLL5
K_ZOK5:
    v_mov_b32 v4, 158720
    v_mov_b32 v3, 1
    s_mov_b64 exec, 1
    s_nop 0
    ds_add_rtn_u32 v2, v4, v3 offset:48
    s_mov_b32 exec_lo, s36
    v_mov_b32 v3, 1
    s_waitcnt lgkmcnt(0)
    v_readfirstlane_b32 s33, v2
    s_nop 3
    s_and_b32 s33, s33, 0xff
    s_cmp_lg_u32 s33, 7
    s_cbranch_scc1 K_ARR7
    global_store_dword v8, v3, s[10:11] sc1
K_ARR7:
    s_mov_b64 exec, -1
    v_mov_b32 v6, 158800
    s_mov_b32 s3, 1048576
K_XG7:
    ds_read_b128 v[2:5], v6
    s_sleep 1
    s_sub_u32 s3, s3, 1
    s_waitcnt lgkmcnt(0)
    v_min3_u32 v2, v2, v4, v5
    v_min_u32 v2, v2, v3
    s_nop 0
    v_readfirstlane_b32 s33, v2
    s_nop 3
    s_cselect_b32 s33, 1, s33
    s_cmp_lt_u32 s33, 1
    s_cbranch_scc1 K_XG7
    v_mov_b32 v4, 158720
    s_branch K_WOE
K_W7:
    v_mov_b32 v3, 0x100
    s_mov_b64 exec, 1
    s_waitcnt vmcnt(0)
    ds_add_u32 v4, v3 offset:48
    s_mov_b64 exec, -1
    s_branch K_P2_HELP
K_FLAG:
    s_waitcnt vmcnt(0)
    v_and_b32 v4, 7, v1
    v_lshlrev_b32 v4, 2, v4
    s_mov_b32 s3, 131072
K_ZPOLL0:
    v_cmp_eq_u32 vcc, 0, v7
    s_cbranch_vccz K_ZOK0
    s_sub_u32 s3, s3, 1
    s_cbranch_scc1 K_ZOK0
    global_load_dword v7, v4, s[8:9] offset:192 sc1
    s_waitcnt vmcnt(0)
    s_branch K_ZPOLL0
K_ZOK0:
    v_mov_b32 v3, 1
    s_mov_b32 exec_lo, s36
    s_mov_b32 exec_hi, 0
    s_setprio 3
    s_barrier
    global_store_dword v8, v3, s[10:11] sc1
    s_mov_b64 exec, -1
    s_branch K_END
WP_atts:
    s_setpc_b64 s[38:39]
K_JOIN_S:
    s_setprio 0
    s_cmp_eq_u32 s30, 7
    s_cbranch_scc1 K_FLAG
    s_lshl_b32 s3, s30, 2
    s_add_u32 s3, s3, 158784
    v_mov_b32 v6, s3
    s_mov_b32 s3, 1048576
K_XG1:
    ds_read2_b32 v[2:3], v6 offset0:0 offset1:1
    s_sleep 1
    s_sub_u32 s3, s3, 1
    s_waitcnt lgkmcnt(0)
    v_min_u32 v2, v2, v3
    s_nop 0
    v_readfirstlane_b32 s33, v2
    s_nop 3
    s_cselect_b32 s33, 1, s33
    s_cmp_lt_u32 s33, 1
    s_cbranch_scc1 K_XG1
    ds_read_b64 v[40:41], v14 offset:4096
    ds_read_b64 v[42:43], v18 offset:1024
    ds_read_b64 v[48:49], v14 offset:0
    ds_read_b64 v[50:51], v13 offset:0
    ds_read_b64 v[52:53], v14 offset:2048
    ds_read_b64 v[54:55], v13 offset:1024
    ds_read_b64 v[44:45], v14 offset:4608
    ds_read_b64 v[46:47], v19 offset:1024
    ds_read_b64 v[56:57], v14 offset:512
    ds_read_b64 v[58:59], v13 offset:0
    ds_read_b64 v[60:61], v14 offset:2560
    ds_read_b64 v[62:63], v13 offset:1024
    s_waitcnt lgkmcnt(8)
    v_mfma_f32_16x16x32_bf16 v[80:83], v[48:51], v[40:43], v[24:27]
    s_waitcnt lgkmcnt(6)
    v_mfma_f32_16x16x32_bf16 v[84:87], v[52:55], v[40:43], v[28:31]
    s_waitcnt lgkmcnt(2)
    v_mfma_f32_16x16x32_bf16 v[88:91], v[56:59], v[44:47], v[24:27]
    s_waitcnt lgkmcnt(0)
    v_mfma_f32_16x16x32_bf16 v[92:95], v[60:63], v[44:47], v[28:31]
    ds_read_b64_tr_b16 v[72:73], v20 offset:0
    ds_read_b64_tr_b16 v[74:75], v20 offset:1024
    ds_read_b64_tr_b16 v[76:77], v21 offset:0
    ds_read_b64_tr_b16 v[78:79], v21 offset:1024
    v_max3_f32 v116, v80, v81, v84
    v_max3_f32 v117, v82, v83, v86
    v_max_f32 v116, v116, v85
    v_max_f32 v117, v117, v87
    v_max3_f32 v118, v88, v89, v92
    v_max3_f32 v119, v90, v91, v94
    v_max_f32 v118, v118, v93
    v_max_f32 v119, v119, v95
    s_nop 0
    v_permlane16_swap_b32 v116, v118
    v_permlane16_swap_b32 v117, v119
    v_max3_f32 v130, v116, v117, v118
    v_max_f32 v130, v130, v119
    v_mov_b32 v131, v130
    s_nop 1
    v_permlane32_swap_b32 v130, v131
    v_max_f32 v130, v130, v131
    v_mul_f32 v130, s46, v130
    v_pk_fma_f32 v[116:117], v[116:117], s[46:47], v[130:131] op_sel_hi:[1,1,0] neg_lo:[0,0,1] neg_hi:[0,0,1]
    v_pk_fma_f32 v[118:119], v[118:119], s[46:47], v[130:131] op_sel_hi:[1,1,0] neg_lo:[0,0,1] neg_hi:[0,0,1]
    v_exp_f32 v116, v116
    v_exp_f32 v117, v117
    v_exp_f32 v118, v118
    v_exp_f32 v119, v119
    s_nop 0
    v_pk_add_f32 v[120:121], v[116:117], v[118:119]
    v_add_f32 v120, v120, v121
    v_mov_b32 v121, v120
    s_nop 1
    v_permlane32_swap_b32 v120, v121
    v_add_f32 v120, v120, v121
    v_rcp_f32 v120, v120
    s_waitcnt lgkmcnt(0)
    v_pk_mul_f32 v[116:117], v[116:117], v[120:121] op_sel_hi:[1,0]
    v_pk_mul_f32 v[118:119], v[118:119], v[120:121] op_sel_hi:[1,0]
    v_cvt_pk_bf16_f32 v128, v116, v117
    v_cvt_pk_bf16_f32 v129, v118, v119
    s_nop 1
    v_permlane16_swap_b32 v128, v129
    s_mov_b32 s3, 1048576
K_XG2:
    ds_read2_b32 v[2:3], v6 offset0:0 offset1:1
    s_sleep 1
    s_sub_u32 s3, s3, 1
    s_waitcnt lgkmcnt(0)
    v_min_u32 v2, v2, v3
    s_nop 0
    v_readfirstlane_b32 s33, v2
    s_nop 3
    s_cselect_b32 s33, 2, s33
    s_cmp_lt_u32 s33, 2
    s_cbranch_scc1 K_XG2
    ds_read_b64 v[64:65], v14 offset:1024
    ds_read_b64 v[66:67], v14 offset:3072
    ds_read_b64 v[68:69], v14 offset:1536
    ds_read_b64 v[70:71], v14 offset:3584
    v_perm_b32 v96, v128, v128, v36
    v_perm_b32 v97, v128, v128, v37
    v_perm_b32 v98, v128, v128, v38
    v_perm_b32 v99, v128, v128, v39
    v_perm_b32 v100, v129, v129, v36
    v_perm_b32 v101, v129, v129, v37
    s_waitcnt lgkmcnt(2)
    v_mfma_f32_16x16x32_bf16 v[104:107], v[64:67], v[96:99], 0
    v_perm_b32 v102, v129, v129, v38
    v_perm_b32 v103, v129, v129, v39
    v_mfma_f32_16x16x32_bf16 v[112:115], v[72:75], v[96:99], 0
    s_nop 0
    v_mfma_f32_16x16x32_bf16 v[112:115], v[76:79], v[100:103], v[112:115]
    s_waitcnt lgkmcnt(0)
    v_mfma_f32_16x16x32_bf16 v[108:111], v[68:71], v[100:103], 0
    s_nop 0
    v_cvt_pk_bf16_f32 v124, v104, v105
    v_cvt_pk_bf16_f32 v125, v106, v107
    s_nop 2
    v_cvt_pk_bf16_f32 v120, v112, v113
    v_cvt_pk_bf16_f32 v121, v114, v115
    v_cvt_pk_bf16_f32 v122, v112, v113
    v_cvt_pk_bf16_f32 v123, v114, v115
    v_cvt_pk_bf16_f32 v126, v108, v109
    v_cvt_pk_bf16_f32 v127, v110, v111
    v_permlane16_swap_b32 v120, v122
    v_permlane16_swap_b32 v121, v123
    buffer_store_dwordx4 v[124:127], v15, s[20:23], s50 offen sc1
    buffer_store_dwordx4 v[120:123], v16, s[20:23], s50 offen sc1
    s_cmp_eq_u32 s34, -1
    s_cbranch_scc1 K_DRAIN
    s_cmp_lg_u32 s30, 6
    s_cbranch_scc1 K_NOFL
    s_waitcnt vmcnt(2)
    v_and_b32 v4, 7, v1
    v_lshlrev_b32 v4, 2, v4
    s_mov_b32 s3, 131072
K_ZPOLL2:
    v_cmp_eq_u32 vcc, 0, v7
    s_cbranch_vccz K_ZOK2
    s_sub_u32 s3, s3, 1
    s_cbranch_scc1 K_ZOK2
    global_load_dword v7, v4, s[8:9] offset:192 sc1
    s_waitcnt vmcnt(0)
    s_branch K_ZPOLL2
K_ZOK2:
    v_and_b32 v2, 1, v1
    v_lshl_add_u32 v2, v2, 2, s42
    global_load_dword v7, v2, s[10:11] offset:128 sc1
K_NOFL:
    v_mov_b32 v4, 158720
    v_mov_b32 v3, 257
    s_mov_b64 exec, 1
    s_waitcnt vmcnt(0)
    ds_add_rtn_u32 v2, v4, v3 offset:48
    s_mov_b32 exec_lo, s36
    v_mov_b32 v3, 1
    s_waitcnt lgkmcnt(0)
    v_readfirstlane_b32 s33, v2
    s_nop 3
    s_and_b32 s33, s33, 0xff
    s_cmp_lg_u32 s33, 7
    s_cbranch_scc1 K_ARRS
    global_store_dword v8, v3, s[10:11] sc1
K_ARRS:
    s_mov_b64 exec, -1
    s_cmp_ge_u32 s30, 6
    s_cbranch_scc1 K_P2_HELP
    s_branch K_LATE
WP_early:
    s_setpc_b64 s[38:39]
K_P2_EARLY:
    s_lshl_b32 s54, s40, 7
    v_lshrrev_b32 v9, 4, v1
    v_mov_b32 v12, 158720
    s_add_u32 s20, s10, 0x100000
    s_addc_u32 s21, s11, 0
    s_mov_b32 s22, 0x280000
    s_mov_b32 s23, 0x20000
    s_add_u32 s16, s10, 0x1000
    s_addc_u32 s17, s11, 0
    s_mov_b32 s18, 0x2000
    s_mov_b32 s19, 0x20000
    s_mov_b32 s48, s6
    s_mov_b32 s49, s7
    s_mov_b32 s50, 0x280000
    s_mov_b32 s51, 0x20000
    s_lshl_b32 s53, s40, 3
    s_lshl1_add_u32 s53, s30, s53
    s_mov_b32 s55, 20480
    v_bfe_u32 v20, v1, 2, 2
    v_and_b32 v21, 3, v1
    s_mul_i32 s3, s53, 20480
    v_lshl_add_u32 v25, v1, 4, s3
    v_add_u32 v26, 20480, v25
    v_add_u32 v35, 16384, v25
    v_add_u32 v36, 16384, v26
    v_and_b32 v2, 15, v1
    s_lshl_b32 s3, s53, 6
    v_lshl_add_u32 v23, v2, 2, s3
    v_lshl_add_u32 v2, v9, 2, v20
    v_bfe_u32 v3, v2, 1, 2
    v_lshlrev_b32 v2, 7, v2
    v_lshl_add_u32 v2, v21, 3, v2
    v_lshl_add_u32 v24, v3, 5, v2
    v_lshrrev_b32 v3, 1, v20
    v_mul_u32_u24 v2, 40, v9
    v_add3_u32 v2, v2, 16, v20
    v_lshlrev_b32 v2, 7, v2
    v_lshl_add_u32 v2, v21, 3, v2
    v_xor_b32 v4, 0, v3
    v_lshl_add_u32 v60, v4, 5, v2
    v_xor_b32 v4, 1, v3
    v_lshl_add_u32 v61, v4, 5, v2
    v_xor_b32 v4, 2, v3
    v_lshl_add_u32 v62, v4, 5, v2
    v_xor_b32 v4, 3, v3
    v_lshl_add_u32 v63, v4, 5, v2
    v_lshrrev_b32 v3, 4, v1
    v_and_b32 v4, 7, v1
    v_lshrrev_b32 v2, 3, v1
    v_xor_b32 v4, v4, v3
    v_mul_u32_u24 v2, 1280, v2
    v_lshl_add_u32 v27, v4, 4, v2
    v_xor_b32 v28, 64, v27
    s_lshl_b32 s71, s40, 3
    s_lshl1_add_u32 s71, s30, s71
    s_mul_i32 s71, s71, 20480
    s_lshl_b32 s33, s41, 7
    s_add_u32 s71, s71, s33
    s_add_u32 s72, s71, 10240
    s_add_u32 s73, s71, 20480
    s_add_u32 s74, s71, 30720
    s_lshl_b32 s3, s30, 12
    s_add_u32 s3, s3, 140288
    v_lshl_add_u32 v33, v1, 4, s3
    v_and_b32 v2, 15, v1
    v_lshrrev_b32 v3, 1, v2
    v_lshrrev_b32 v4, 5, v1
    v_xor_b32 v3, v3, v4
    v_lshlrev_b32 v3, 4, v3
    v_lshl_add_u32 v3, v2, 7, v3
    v_and_b32 v4, 1, v9
    v_lshl_add_u32 v3, v4, 3, v3
    v_add_u32 v29, s3, v3
    v_xor_b32 v30, 32, v29
    v_xor_b32 v31, 64, v29
    v_xor_b32 v32, 96, v29
    s_and_b32 s33, s40, 3
    s_lshl_b32 s33, s33, 3
    s_lshr_b32 s33, 0x7f06037f, s33
    s_and_b32 s33, s33, 0xff
    s_lshl_b32 s3, s30, 1
    s_cmp_ge_u32 s3, s33
    s_cselect_b32 s64, 16, 0
    s_add_u32 s3, s3, 1
    s_cmp_ge_u32 s3, s33
    s_cselect_b32 s65, 16, 0
    s_mov_b32 s63, 0
    s_mov_b32 s66, 0
    s_mov_b32 s67, 16384
    v_mov_b32 v34, 0
    v_mov_b32 v4, 158720
    v_mov_b32 v3, 1
    s_mov_b64 exec, 1
    s_waitcnt vmcnt(0)
    ds_add_rtn_u32 v2, v4, v3 offset:48
    s_mov_b32 exec_lo, s36
    v_mov_b32 v3, 1
    s_waitcnt lgkmcnt(0)
    v_readfirstlane_b32 s33, v2
    s_nop 3
    s_and_b32 s33, s33, 0xff
    s_cmp_lg_u32 s33, 7
    s_cbranch_scc1 K_ARRD
    global_store_dword v8, v3, s[10:11] sc1
K_ARRD:
    s_mov_b64 exec, -1
    s_mov_b32 s3, 1048576
K_P2_GE:
    ds_read_b32 v2, v12 offset:48
    s_sub_u32 s3, s3, 1
    s_waitcnt lgkmcnt(0)
    v_readfirstlane_b32 s33, v2
    s_nop 3
    s_cselect_b32 s33, 1024, s33
    s_cmp_lt_u32 s33, 1024
    s_cbranch_scc1 K_P2_GE
K_P2_GEMM:
    s_setprio 0
    s_mov_b32 s3, 1048576
K_P2_GS:
    ds_read_b32 v2, v12 offset:40
    s_sub_u32 s3, s3, 1
    s_waitcnt lgkmcnt(0)
    v_readfirstlane_b32 s33, v2
    s_nop 3
    s_cselect_b32 s33, 1, s33
    s_cmp_lt_u32 s33, 1
    s_cbranch_scc1 K_P2_GS
    buffer_load_dword v64, v23, s[16:19], 0 offen offset:0 sc1
    buffer_load_dword v66, v23, s[16:19], 0 offen offset:64 sc1
    ds_read_b128 v[16:19], v12
    ds_read_b64 v[40:41], v29 offset:0
    ds_read_b64 v[42:43], v30 offset:0
    ds_read_b64 v[44:45], v31 offset:0
    ds_read_b64 v[46:47], v32 offset:0
    ds_read_b64 v[48:49], v29 offset:2048
    ds_read_b64 v[50:51], v30 offset:2048
    ds_read_b64 v[52:53], v31 offset:2048
    ds_read_b64 v[54:55], v32 offset:2048
    s_waitcnt lgkmcnt(4)
    v_lshlrev_b32 v72, 16, v40
    v_and_b32 v73, 0xffff0000, v40
    v_lshlrev_b32 v74, 16, v41
    v_and_b32 v75, 0xffff0000, v41
    v_lshlrev_b32 v76, 16, v42
    v_and_b32 v77, 0xffff0000, v42
    v_lshlrev_b32 v78, 16, v43
    v_and_b32 v79, 0xffff0000, v43
    v_lshlrev_b32 v80, 16, v44
    v_and_b32 v81, 0xffff0000, v44
    v_lshlrev_b32 v82, 16, v45
    v_and_b32 v83, 0xffff0000, v45
    v_lshlrev_b32 v84, 16, v46
    v_and_b32 v85, 0xffff0000, v46
    v_lshlrev_b32 v86, 16, v47
    v_and_b32 v87, 0xffff0000, v47
    s_waitcnt lgkmcnt(0)
    v_lshlrev_b32 v88, 16, v48
    v_and_b32 v89, 0xffff0000, v48
    v_lshlrev_b32 v90, 16, v49
    v_and_b32 v91, 0xffff0000, v49
    v_lshlrev_b32 v92, 16, v50
    v_and_b32 v93, 0xffff0000, v50
    v_lshlrev_b32 v94, 16, v51
    v_and_b32 v95, 0xffff0000, v51
    v_lshlrev_b32 v96, 16, v52
    v_and_b32 v97, 0xffff0000, v52
    v_lshlrev_b32 v98, 16, v53
    v_and_b32 v99, 0xffff0000, v53
    v_lshlrev_b32 v100, 16, v54
    v_and_b32 v101, 0xffff0000, v54
    v_lshlrev_b32 v102, 16, v55
    v_and_b32 v103, 0xffff0000, v55
    s_cmp_eq_u32 s63, 0
    s_cbranch_scc1 K_SP0
K_SPR0:
    s_ff1_i32_b32 s33, s63
    s_bitset0_b32 s63, s33
    s_lshl_b32 s75, s33, 10
    buffer_load_dwordx4 v[104:107], v25, s[20:23], s75 offen offset:0 sc1
    buffer_load_dwordx4 v[108:111], v26, s[20:23], s75 offen offset:0 sc1
    v_mad_u32_u24 v56, s75, 5, v24
    v_xor_b32 v58, 64, v56
    v_xor_b32 v57, 32, v56
    v_xor_b32 v59, 96, v56
    ds_read_b64_tr_b16 v[184:185], v56 offset:0
    ds_read_b64_tr_b16 v[186:187], v58 offset:2560
    ds_read_b64_tr_b16 v[188:189], v57 offset:0
    ds_read_b64_tr_b16 v[190:191], v59 offset:2560
    ds_read_b64_tr_b16 v[192:193], v58 offset:0
    ds_read_b64_tr_b16 v[194:195], v56 offset:2560
    ds_read_b64_tr_b16 v[196:197], v59 offset:0
    ds_read_b64_tr_b16 v[198:199], v57 offset:2560
    s_cmp_eq_u32 s63, 0
    s_cbranch_scc1 K_SP1
K_SPR1:
    s_ff1_i32_b32 s33, s63
    s_bitset0_b32 s63, s33
    s_lshl_b32 s76, s33, 10
    buffer_load_dwordx4 v[112:115], v25, s[20:23], s76 offen offset:0 sc1
    buffer_load_dwordx4 v[116:119], v26, s[20:23], s76 offen offset:0 sc1
    v_mad_u32_u24 v56, s76, 5, v24
    v_xor_b32 v58, 64, v56
    v_xor_b32 v57, 32, v56
    v_xor_b32 v59, 96, v56
    ds_read_b64_tr_b16 v[200:201], v56 offset:0
    ds_read_b64_tr_b16 v[202:203], v58 offset:2560
    ds_read_b64_tr_b16 v[204:205], v57 offset:0
    ds_read_b64_tr_b16 v[206:207], v59 offset:2560
    ds_read_b64_tr_b16 v[208:209], v58 offset:0
    ds_read_b64_tr_b16 v[210:211], v56 offset:2560
    ds_read_b64_tr_b16 v[212:213], v59 offset:0
    ds_read_b64_tr_b16 v[214:215], v57 offset:2560
    s_waitcnt vmcnt(4)
    s_mov_b64 exec, 1
    ds_add_u32 v12, v34 offset:44
    s_mov_b64 exec, -1
    v_sub_f32 v68, 1.0, v64
    v_cvt_pk_bf16_f32 v68, v68, v68
    v_lshlrev_b32 v68, 16, v68
    v_sub_f32 v70, 1.0, v66
    v_cvt_pk_bf16_f32 v70, v70, v70
    v_lshlrev_b32 v70, 16, v70
    v_pk_mul_f32 v[72:73], v[72:73], v[68:69] op_sel_hi:[1,0]
    v_pk_mul_f32 v[74:75], v[74:75], v[68:69] op_sel_hi:[1,0]
    v_pk_mul_f32 v[76:77], v[76:77], v[68:69] op_sel_hi:[1,0]
    v_pk_mul_f32 v[78:79], v[78:79], v[68:69] op_sel_hi:[1,0]
    v_pk_mul_f32 v[80:81], v[80:81], v[68:69] op_sel_hi:[1,0]
    v_pk_mul_f32 v[82:83], v[82:83], v[68:69] op_sel_hi:[1,0]
    v_pk_mul_f32 v[84:85], v[84:85], v[68:69] op_sel_hi:[1,0]
    v_pk_mul_f32 v[86:87], v[86:87], v[68:69] op_sel_hi:[1,0]
    v_pk_mul_f32 v[88:89], v[88:89], v[70:71] op_sel_hi:[1,0]
    v_pk_mul_f32 v[90:91], v[90:91], v[70:71] op_sel_hi:[1,0]
    v_pk_mul_f32 v[92:93], v[92:93], v[70:71] op_sel_hi:[1,0]
    v_pk_mul_f32 v[94:95], v[94:95], v[70:71] op_sel_hi:[1,0]
    v_pk_mul_f32 v[96:97], v[96:97], v[70:71] op_sel_hi:[1,0]
    v_pk_mul_f32 v[98:99], v[98:99], v[70:71] op_sel_hi:[1,0]
    v_pk_mul_f32 v[100:101], v[100:101], v[70:71] op_sel_hi:[1,0]
    v_pk_mul_f32 v[102:103], v[102:103], v[70:71] op_sel_hi:[1,0]
    s_cmp_eq_u32 s63, 0
    s_cbranch_scc1 K_SP2
K_SPR2:
    s_ff1_i32_b32 s33, s63
    s_bitset0_b32 s63, s33
    s_lshl_b32 s77, s33, 10
    buffer_load_dwordx4 v[120:123], v25, s[20:23], s77 offen offset:0 sc1
    buffer_load_dwordx4 v[124:127], v26, s[20:23], s77 offen offset:0 sc1
    s_cmp_eq_u32 s63, 0
    s_cbranch_scc1 K_SP3
K_SPR3:
    s_ff1_i32_b32 s33, s63
    s_bitset0_b32 s63, s33
    s_lshl_b32 s78, s33, 10
    buffer_load_dwordx4 v[128:131], v25, s[20:23], s78 offen offset:0 sc1
    buffer_load_dwordx4 v[132:135], v26, s[20:23], s78 offen offset:0 sc1
    s_cmp_eq_u32 s63, 0
    s_cbranch_scc1 K_SP4
K_SPR4:
    s_ff1_i32_b32 s33, s63
    s_bitset0_b32 s63, s33
    s_lshl_b32 s75, s33, 10
    buffer_load_dwordx4 v[136:139], v25, s[20:23], s75 offen offset:0 sc1
    buffer_load_dwordx4 v[140:143], v26, s[20:23], s75 offen offset:0 sc1
    s_branch WS_p2g
.p2align 12
WP_p2g:
    s_setpc_b64 s[38:39]
WS_p2g:
    s_waitcnt vmcnt(8) lgkmcnt(9)
    v_mfma_f32_16x16x32_bf16 v[152:155], v[184:187], v[104:107], 0
    v_mad_u32_u24 v56, s77, 5, v24
    v_xor_b32 v58, 64, v56
    v_xor_b32 v57, 32, v56
    v_mfma_f32_16x16x32_bf16 v[168:171], v[184:187], v[108:111], 0
    v_xor_b32 v59, 96, v56
    ds_read_b64_tr_b16 v[216:217], v56 offset:0
    ds_read_b64_tr_b16 v[218:219], v58 offset:2560
    v_mfma_f32_16x16x32_bf16 v[156:159], v[188:191], v[104:107], 0
    ds_read_b64_tr_b16 v[220:221], v57 offset:0
    ds_read_b64_tr_b16 v[222:223], v59 offset:2560
    ds_read_b64_tr_b16 v[224:225], v58 offset:0
    v_mfma_f32_16x16x32_bf16 v[172:175], v[188:191], v[108:111], 0
    ds_read_b64_tr_b16 v[226:227], v56 offset:2560
    ds_read_b64_tr_b16 v[228:229], v59 offset:0
    v_mfma_f32_16x16x32_bf16 v[160:163], v[192:195], v[104:107], 0
    ds_read_b64_tr_b16 v[230:231], v57 offset:2560
    s_cmp_eq_u32 s63, 0
    v_mfma_f32_16x16x32_bf16 v[176:179], v[192:195], v[108:111], 0
    s_cbranch_scc1 K_SP5
K_SPR5:
    s_ff1_i32_b32 s33, s63
    v_mfma_f32_16x16x32_bf16 v[164:167], v[196:199], v[104:107], 0
    s_bitset0_b32 s63, s33
    s_lshl_b32 s76, s33, 10
    v_mfma_f32_16x16x32_bf16 v[180:183], v[196:199], v[108:111], 0
    buffer_load_dwordx4 v[144:147], v25, s[20:23], s76 offen offset:0 sc1
    buffer_load_dwordx4 v[148:151], v26, s[20:23], s76 offen offset:0 sc1
    s_waitcnt vmcnt(8) lgkmcnt(9)
    v_mfma_f32_16x16x32_bf16 v[152:155], v[200:203], v[112:115], v[152:155]
    v_mad_u32_u24 v56, s78, 5, v24
    v_xor_b32 v58, 64, v56
    v_xor_b32 v57, 32, v56
    v_mfma_f32_16x16x32_bf16 v[168:171], v[200:203], v[116:119], v[168:171]
    v_xor_b32 v59, 96, v56
    ds_read_b64_tr_b16 v[184:185], v56 offset:0
    ds_read_b64_tr_b16 v[186:187], v58 offset:2560
    v_mfma_f32_16x16x32_bf16 v[156:159], v[204:207], v[112:115], v[156:159]
    ds_read_b64_tr_b16 v[188:189], v57 offset:0
    ds_read_b64_tr_b16 v[190:191], v59 offset:2560
    ds_read_b64_tr_b16 v[192:193], v58 offset:0
    v_mfma_f32_16x16x32_bf16 v[172:175], v[204:207], v[116:119], v[172:175]
    ds_read_b64_tr_b16 v[194:195], v56 offset:2560
    ds_read_b64_tr_b16 v[196:197], v59 offset:0
    v_mfma_f32_16x16x32_bf16 v[160:163], v[208:211], v[112:115], v[160:163]
    ds_read_b64_tr_b16 v[198:199], v57 offset:2560
    s_cmp_eq_u32 s63, 0
    v_mfma_f32_16x16x32_bf16 v[176:179], v[208:211], v[116:119], v[176:179]
    s_cbranch_scc1 K_SP6
K_SPR6:
    s_ff1_i32_b32 s33, s63
    v_mfma_f32_16x16x32_bf16 v[164:167], v[212:215], v[112:115], v[164:167]
    s_bitset0_b32 s63, s33
    s_lshl_b32 s77, s33, 10
    v_mfma_f32_16x16x32_bf16 v[180:183], v[212:215], v[116:119], v[180:183]
    buffer_load_dwordx4 v[104:107], v25, s[20:23], s77 offen offset:0 sc1
    buffer_load_dwordx4 v[108:111], v26, s[20:23], s77 offen offset:0 sc1
    s_waitcnt vmcnt(8) lgkmcnt(8)
    v_mfma_f32_16x16x32_bf16 v[152:155], v[216:219], v[120:123], v[152:155]
    v_mad_u32_u24 v56, s75, 5, v24
    v_xor_b32 v58, 64, v56
    v_xor_b32 v57, 32, v56
    v_mfma_f32_16x16x32_bf16 v[168:171], v[216:219], v[124:127], v[168:171]
    v_xor_b32 v59, 96, v56
    ds_read_b64_tr_b16 v[200:201], v56 offset:0
    ds_read_b64_tr_b16 v[202:203], v58 offset:2560
    v_mfma_f32_16x16x32_bf16 v[156:159], v[220:223], v[120:123], v[156:159]
    ds_read_b64_tr_b16 v[204:205], v57 offset:0
    ds_read_b64_tr_b16 v[206:207], v59 offset:2560
    ds_read_b64_tr_b16 v[208:209], v58 offset:0
    v_mfma_f32_16x16x32_bf16 v[172:175], v[220:223], v[124:127], v[172:175]
    ds_read_b64_tr_b16 v[210:211], v56 offset:2560
    ds_read_b64_tr_b16 v[212:213], v59 offset:0
    v_mfma_f32_16x16x32_bf16 v[160:163], v[224:227], v[120:123], v[160:163]
    ds_read_b64_tr_b16 v[214:215], v57 offset:2560
    s_andn2_b32 s33, s66, s63
    v_mfma_f32_16x16x32_bf16 v[176:179], v[224:227], v[124:127], v[176:179]
    s_bfe_u32 s33, s33, 0x40000
    s_cmp_eq_u32 s33, 15
    v_mfma_f32_16x16x32_bf16 v[164:167], v[228:231], v[120:123], v[164:167]
    s_cselect_b32 s78, 0, 1024
    s_xor_b32 s69, s78, 1024
    v_mfma_f32_16x16x32_bf16 v[180:183], v[228:231], v[124:127], v[180:183]
    buffer_load_dwordx4 v[112:115], v35, s[20:23], s78 offen offset:0 sc1
    buffer_load_dwordx4 v[116:119], v36, s[20:23], s78 offen offset:0 sc1
    s_waitcnt vmcnt(8) lgkmcnt(8)
    v_mfma_f32_16x16x32_bf16 v[152:155], v[184:187], v[128:131], v[152:155]
    v_mad_u32_u24 v56, s76, 5, v24
    v_xor_b32 v58, 64, v56
    v_xor_b32 v57, 32, v56
    v_mfma_f32_16x16x32_bf16 v[168:171], v[184:187], v[132:135], v[168:171]
    v_xor_b32 v59, 96, v56
    ds_read_b64_tr_b16 v[216:217], v56 offset:0
    ds_read_b64_tr_b16 v[218:219], v58 offset:2560
    v_mfma_f32_16x16x32_bf16 v[156:159], v[188:191], v[128:131], v[156:159]
    ds_read_b64_tr_b16 v[220:221], v57 offset:0
    ds_read_b64_tr_b16 v[222:223], v59 offset:2560
    ds_read_b64_tr_b16 v[224:225], v58 offset:0
    v_mfma_f32_16x16x32_bf16 v[172:175], v[188:191], v[132:135], v[172:175]
    ds_read_b64_tr_b16 v[226:227], v56 offset:2560
    ds_read_b64_tr_b16 v[228:229], v59 offset:0
    v_mfma_f32_16x16x32_bf16 v[160:163], v[192:195], v[128:131], v[160:163]
    ds_read_b64_tr_b16 v[230:231], v57 offset:2560
    s_cmp_eq_u32 s63, 0
    v_mfma_f32_16x16x32_bf16 v[176:179], v[192:195], v[132:135], v[176:179]
    s_cbranch_scc1 K_SP8
K_SPR8:
    s_ff1_i32_b32 s33, s63
    v_mfma_f32_16x16x32_bf16 v[164:167], v[196:199], v[128:131], v[164:167]
    s_bitset0_b32 s63, s33
    s_lshl_b32 s75, s33, 10
    v_mfma_f32_16x16x32_bf16 v[180:183], v[196:199], v[132:135], v[180:183]
    buffer_load_dwordx4 v[120:123], v25, s[20:23], s75 offen offset:0 sc1
    buffer_load_dwordx4 v[124:127], v26, s[20:23], s75 offen offset:0 sc1
    s_waitcnt vmcnt(8) lgkmcnt(8)
    v_mfma_f32_16x16x32_bf16 v[152:155], v[200:203], v[136:139], v[152:155]
    v_mad_u32_u24 v56, s77, 5, v24
    v_xor_b32 v58, 64, v56
    v_mfma_f32_16x16x32_bf16 v[168:171], v[200:203], v[140:143], v[168:171]
    v_xor_b32 v57, 32, v56
    v_xor_b32 v59, 96, v56
    v_mfma_f32_16x16x32_bf16 v[156:159], v[204:207], v[136:139], v[156:159]
    ds_read_b64_tr_b16 v[184:185], v56 offset:0
    ds_read_b64_tr_b16 v[186:187], v58 offset:2560
    v_mfma_f32_16x16x32_bf16 v[172:175], v[204:207], v[140:143], v[172:175]
    ds_read_b64_tr_b16 v[188:189], v57 offset:0
    ds_read_b64_tr_b16 v[190:191], v59 offset:2560
    v_mfma_f32_16x16x32_bf16 v[160:163], v[208:211], v[136:139], v[160:163]
    ds_read_b64_tr_b16 v[192:193], v58 offset:0
    ds_read_b64_tr_b16 v[194:195], v56 offset:2560
    v_mfma_f32_16x16x32_bf16 v[176:179], v[208:211], v[140:143], v[176:179]
    ds_read_b64_tr_b16 v[196:197], v59 offset:0
    ds_read_b64_tr_b16 v[198:199], v57 offset:2560
    v_mfma_f32_16x16x32_bf16 v[164:167], v[212:215], v[136:139], v[164:167]
    buffer_load_dwordx4 v[128:131], v35, s[20:23], s69 offen offset:0 sc1
    buffer_load_dwordx4 v[132:135], v36, s[20:23], s69 offen offset:0 sc1
    v_mfma_f32_16x16x32_bf16 v[180:183], v[212:215], v[140:143], v[180:183]
    s_waitcnt vmcnt(8) lgkmcnt(8)
    v_mfma_f32_16x16x32_bf16 v[152:155], v[216:219], v[144:147], v[152:155]
    v_mad_u32_u24 v56, s78, 20, v60
    v_xor_b32 v58, 64, v56
    v_xor_b32 v57, 32, v56
    v_mfma_f32_16x16x32_bf16 v[168:171], v[216:219], v[148:151], v[168:171]
    v_xor_b32 v59, 96, v56
    ds_read_b64_tr_b16 v[200:201], v56 offset:0
    ds_read_b64_tr_b16 v[202:203], v58 offset:2560
    v_mfma_f32_16x16x32_bf16 v[156:159], v[220:223], v[144:147], v[156:159]
    ds_read_b64_tr_b16 v[204:205], v57 offset:0
    ds_read_b64_tr_b16 v[206:207], v59 offset:2560
    ds_read_b64_tr_b16 v[208:209], v58 offset:0
    v_mfma_f32_16x16x32_bf16 v[172:175], v[220:223], v[148:151], v[172:175]
    ds_read_b64_tr_b16 v[210:211], v56 offset:2560
    ds_read_b64_tr_b16 v[212:213], v59 offset:0
    v_mfma_f32_16x16x32_bf16 v[160:163], v[224:227], v[144:147], v[160:163]
    ds_read_b64_tr_b16 v[214:215], v57 offset:2560
    s_cmp_eq_u32 s63, 0
    v_mfma_f32_16x16x32_bf16 v[176:179], v[224:227], v[148:151], v[176:179]
    s_cbranch_scc1 K_SP10
K_SPR10:
    s_ff1_i32_b32 s33, s63
    v_mfma_f32_16x16x32_bf16 v[164:167], v[228:231], v[144:147], v[164:167]
    s_bitset0_b32 s63, s33
    s_lshl_b32 s77, s33, 10
    v_mfma_f32_16x16x32_bf16 v[180:183], v[228:231], v[148:151], v[180:183]
    buffer_load_dwordx4 v[136:139], v25, s[20:23], s77 offen offset:0 sc1
    buffer_load_dwordx4 v[140:143], v26, s[20:23], s77 offen offset:0 sc1
    s_waitcnt vmcnt(8) lgkmcnt(8)
    v_mfma_f32_16x16x32_bf16 v[152:155], v[184:187], v[104:107], v[152:155]
    v_mad_u32_u24 v56, s75, 5, v24
    v_xor_b32 v58, 64, v56
    v_xor_b32 v57, 32, v56
    v_mfma_f32_16x16x32_bf16 v[168:171], v[184:187], v[108:111], v[168:171]
    v_xor_b32 v59, 96, v56
    ds_read_b64_tr_b16 v[216:217], v56 offset:0
    ds_read_b64_tr_b16 v[218:219], v58 offset:2560
    v_mfma_f32_16x16x32_bf16 v[156:159], v[188:191], v[104:107], v[156:159]
    ds_read_b64_tr_b16 v[220:221], v57 offset:0
    ds_read_b64_tr_b16 v[222:223], v59 offset:2560
    ds_read_b64_tr_b16 v[224:225], v58 offset:0
    v_mfma_f32_16x16x32_bf16 v[172:175], v[188:191], v[108:111], v[172:175]
    ds_read_b64_tr_b16 v[226:227], v56 offset:2560
    ds_read_b64_tr_b16 v[228:229], v59 offset:0
    v_mfma_f32_16x16x32_bf16 v[160:163], v[192:195], v[104:107], v[160:163]
    ds_read_b64_tr_b16 v[230:231], v57 offset:2560
    s_cmp_eq_u32 s63, 0
    v_mfma_f32_16x16x32_bf16 v[176:179], v[192:195], v[108:111], v[176:179]
    s_cbranch_scc1 K_SP11
K_SPR11:
    s_ff1_i32_b32 s33, s63
    v_mfma_f32_16x16x32_bf16 v[164:167], v[196:199], v[104:107], v[164:167]
    s_bitset0_b32 s63, s33
    s_lshl_b32 s78, s33, 10
    v_mfma_f32_16x16x32_bf16 v[180:183], v[196:199], v[108:111], v[180:183]
    buffer_load_dwordx4 v[144:147], v25, s[20:23], s78 offen offset:0 sc1
    buffer_load_dwordx4 v[148:151], v26, s[20:23], s78 offen offset:0 sc1
    s_waitcnt vmcnt(8) lgkmcnt(8)
    v_mfma_f32_16x16x32_bf16 v[152:155], v[200:203], v[112:115], v[152:155]
    v_mad_u32_u24 v56, s69, 20, v60
    v_xor_b32 v58, 64, v56
    v_xor_b32 v57, 32, v56
    v_mfma_f32_16x16x32_bf16 v[168:171], v[200:203], v[116:119], v[168:171]
    v_xor_b32 v59, 96, v56
    ds_read_b64_tr_b16 v[184:185], v56 offset:0
    ds_read_b64_tr_b16 v[186:187], v58 offset:2560
    v_mfma_f32_16x16x32_bf16 v[156:159], v[204:207], v[112:115], v[156:159]
    ds_read_b64_tr_b16 v[188:189], v57 offset:0
    ds_read_b64_tr_b16 v[190:191], v59 offset:2560
    ds_read_b64_tr_b16 v[192:193], v58 offset:0
    v_mfma_f32_16x16x32_bf16 v[172:175], v[204:207], v[116:119], v[172:175]
    ds_read_b64_tr_b16 v[194:195], v56 offset:2560
    ds_read_b64_tr_b16 v[196:197], v59 offset:0
    v_mfma_f32_16x16x32_bf16 v[160:163], v[208:211], v[112:115], v[160:163]
    ds_read_b64_tr_b16 v[198:199], v57 offset:2560
    s_cmp_eq_u32 s63, 0
    v_mfma_f32_16x16x32_bf16 v[176:179], v[208:211], v[116:119], v[176:179]
    s_cbranch_scc1 K_SP12
K_SPR12:
    s_ff1_i32_b32 s33, s63
    v_mfma_f32_16x16x32_bf16 v[164:167], v[212:215], v[112:115], v[164:167]
    s_bitset0_b32 s63, s33
    s_lshl_b32 s75, s33, 10
    v_mfma_f32_16x16x32_bf16 v[180:183], v[212:215], v[116:119], v[180:183]
    buffer_load_dwordx4 v[104:107], v25, s[20:23], s75 offen offset:0 sc1
    buffer_load_dwordx4 v[108:111], v26, s[20:23], s75 offen offset:0 sc1
    s_mov_b32 s3, 1048576
K_P2_GW:
    ds_read_b32 v2, v12 offset:44
    s_sub_u32 s3, s3, 1
    s_waitcnt lgkmcnt(0)
    v_readfirstlane_b32 s33, v2
    s_nop 3
    s_cselect_b32 s33, 4, s33
    s_cmp_lt_u32 s33, 4
    s_cbranch_scc1 K_P2_GW
    v_readfirstlane_b32 s56, v16
    v_readfirstlane_b32 s57, v17
    s_lshl_b32 s58, s53, 4
    s_waitcnt vmcnt(8)
    v_mfma_f32_16x16x32_bf16 v[152:155], v[216:219], v[120:123], v[152:155]
    v_mad_u32_u24 v56, s77, 5, v24
    v_xor_b32 v58, 64, v56
    v_xor_b32 v57, 32, v56
    v_mfma_f32_16x16x32_bf16 v[168:171], v[216:219], v[124:127], v[168:171]
    v_xor_b32 v59, 96, v56
    ds_read_b64_tr_b16 v[200:201], v56 offset:0
    ds_read_b64_tr_b16 v[202:203], v58 offset:2560
    v_mfma_f32_16x16x32_bf16 v[156:159], v[220:223], v[120:123], v[156:159]
    ds_read_b64_tr_b16 v[204:205], v57 offset:0
    ds_read_b64_tr_b16 v[206:207], v59 offset:2560
    ds_read_b64_tr_b16 v[208:209], v58 offset:0
    v_mfma_f32_16x16x32_bf16 v[172:175], v[220:223], v[124:127], v[172:175]
    ds_read_b64_tr_b16 v[210:211], v56 offset:2560
    ds_read_b64_tr_b16 v[212:213], v59 offset:0
    v_mfma_f32_16x16x32_bf16 v[160:163], v[224:227], v[120:123], v[160:163]
    ds_read_b64_tr_b16 v[214:215], v57 offset:2560
    s_cmp_eq_u32 s63, 0
    v_mfma_f32_16x16x32_bf16 v[176:179], v[224:227], v[124:127], v[176:179]
    s_cbranch_scc1 K_SP13
K_SPR13:
    s_ff1_i32_b32 s33, s63
    v_mfma_f32_16x16x32_bf16 v[164:167], v[228:231], v[120:123], v[164:167]
    s_bitset0_b32 s63, s33
    s_lshl_b32 s76, s33, 10
    v_mfma_f32_16x16x32_bf16 v[180:183], v[228:231], v[124:127], v[180:183]
    buffer_load_dwordx4 v[112:115], v25, s[20:23], s76 offen offset:0 sc1
    buffer_load_dwordx4 v[116:119], v26, s[20:23], s76 offen offset:0 sc1
    s_waitcnt vmcnt(8)
    v_mfma_f32_16x16x32_bf16 v[152:155], v[184:187], v[128:131], v[152:155]
    v_mad_u32_u24 v56, s78, 5, v24
    v_xor_b32 v58, 64, v56
    v_xor_b32 v57, 32, v56
    v_mfma_f32_16x16x32_bf16 v[168:171], v[184:187], v[132:135], v[168:171]
    v_xor_b32 v59, 96, v56
    ds_read_b64_tr_b16 v[216:217], v56 offset:0
    ds_read_b64_tr_b16 v[218:219], v58 offset:2560
    v_mfma_f32_16x16x32_bf16 v[156:159], v[188:191], v[128:131], v[156:159]
    ds_read_b64_tr_b16 v[220:221], v57 offset:0
    ds_read_b64_tr_b16 v[222:223], v59 offset:2560
    ds_read_b64_tr_b16 v[224:225], v58 offset:0
    v_mfma_f32_16x16x32_bf16 v[172:175], v[188:191], v[132:135], v[172:175]
    ds_read_b64_tr_b16 v[226:227], v56 offset:2560
    ds_read_b64_tr_b16 v[228:229], v59 offset:0
    v_mfma_f32_16x16x32_bf16 v[160:163], v[192:195], v[128:131], v[160:163]
    ds_read_b64_tr_b16 v[230:231], v57 offset:2560
    s_cmp_eq_u32 s63, 0
    v_mfma_f32_16x16x32_bf16 v[176:179], v[192:195], v[132:135], v[176:179]
    s_cbranch_scc1 K_SP14
K_SPR14:
    s_ff1_i32_b32 s33, s63
    v_mfma_f32_16x16x32_bf16 v[164:167], v[196:199], v[128:131], v[164:167]
    s_bitset0_b32 s63, s33
    s_lshl_b32 s77, s33, 10
    v_mfma_f32_16x16x32_bf16 v[180:183], v[196:199], v[132:135], v[180:183]
    buffer_load_dwordx4 v[120:123], v25, s[20:23], s77 offen offset:0 sc1
    buffer_load_dwordx4 v[124:127], v26, s[20:23], s77 offen offset:0 sc1
    s_waitcnt vmcnt(8) lgkmcnt(8)
    v_mfma_f32_16x16x32_bf16 v[152:155], v[200:203], v[136:139], v[152:155]
    v_mad_u32_u24 v56, s75, 5, v24
    v_xor_b32 v58, 64, v56
    v_xor_b32 v57, 32, v56
    v_mfma_f32_16x16x32_bf16 v[168:171], v[200:203], v[140:143], v[168:171]
    v_xor_b32 v59, 96, v56
    ds_read_b64_tr_b16 v[184:185], v56 offset:0
    ds_read_b64_tr_b16 v[186:187], v58 offset:2560
    v_mfma_f32_16x16x32_bf16 v[156:159], v[204:207], v[136:139], v[156:159]
    ds_read_b64_tr_b16 v[188:189], v57 offset:0
    ds_read_b64_tr_b16 v[190:191], v59 offset:2560
    ds_read_b64_tr_b16 v[192:193], v58 offset:0
    v_mfma_f32_16x16x32_bf16 v[172:175], v[204:207], v[140:143], v[172:175]
    ds_read_b64_tr_b16 v[194:195], v56 offset:2560
    ds_read_b64_tr_b16 v[196:197], v59 offset:0
    v_mfma_f32_16x16x32_bf16 v[160:163], v[208:211], v[136:139], v[160:163]
    ds_read_b64_tr_b16 v[198:199], v57 offset:2560
    s_cmp_eq_u32 s63, 0
    v_mfma_f32_16x16x32_bf16 v[176:179], v[208:211], v[140:143], v[176:179]
    s_cbranch_scc1 K_SP15
K_SPR15:
    s_ff1_i32_b32 s33, s63
    v_mfma_f32_16x16x32_bf16 v[164:167], v[212:215], v[136:139], v[164:167]
    s_bitset0_b32 s63, s33
    s_lshl_b32 s78, s33, 10
    v_mfma_f32_16x16x32_bf16 v[180:183], v[212:215], v[140:143], v[180:183]
    buffer_load_dwordx4 v[128:131], v25, s[20:23], s78 offen offset:0 sc1
    buffer_load_dwordx4 v[132:135], v26, s[20:23], s78 offen offset:0 sc1
    s_waitcnt vmcnt(8) lgkmcnt(8)
    v_mfma_f32_16x16x32_bf16 v[152:155], v[216:219], v[144:147], v[152:155]
    v_mad_u32_u24 v56, s76, 5, v24
    v_xor_b32 v58, 64, v56
    v_xor_b32 v57, 32, v56
    v_mfma_f32_16x16x32_bf16 v[168:171], v[216:219], v[148:151], v[168:171]
    v_xor_b32 v59, 96, v56
    ds_read_b64_tr_b16 v[200:201], v56 offset:0
    ds_read_b64_tr_b16 v[202:203], v58 offset:2560
    v_mfma_f32_16x16x32_bf16 v[156:159], v[220:223], v[144:147], v[156:159]
    ds_read_b64_tr_b16 v[204:205], v57 offset:0
    ds_read_b64_tr_b16 v[206:207], v59 offset:2560
    ds_read_b64_tr_b16 v[208:209], v58 offset:0
    v_mfma_f32_16x16x32_bf16 v[172:175], v[220:223], v[148:151], v[172:175]
    ds_read_b64_tr_b16 v[210:211], v56 offset:2560
    ds_read_b64_tr_b16 v[212:213], v59 offset:0
    v_mfma_f32_16x16x32_bf16 v[160:163], v[224:227], v[144:147], v[160:163]
    ds_read_b64_tr_b16 v[214:215], v57 offset:2560
    s_cmp_eq_u32 s63, 0
    v_mfma_f32_16x16x32_bf16 v[176:179], v[224:227], v[148:151], v[176:179]
    s_cbranch_scc1 K_SP16
K_SPR16:
    s_ff1_i32_b32 s33, s63
    v_mfma_f32_16x16x32_bf16 v[164:167], v[228:231], v[144:147], v[164:167]
    s_bitset0_b32 s63, s33
    s_lshl_b32 s75, s33, 10
    v_mfma_f32_16x16x32_bf16 v[180:183], v[228:231], v[148:151], v[180:183]
    buffer_load_dwordx4 v[136:139], v25, s[20:23], s75 offen offset:0 sc1
    buffer_load_dwordx4 v[140:143], v26, s[20:23], s75 offen offset:0 sc1
    s_waitcnt vmcnt(8) lgkmcnt(8)
    v_mfma_f32_16x16x32_bf16 v[152:155], v[184:187], v[104:107], v[152:155]
    v_mad_u32_u24 v56, s77, 5, v24
    v_xor_b32 v58, 64, v56
    v_xor_b32 v57, 32, v56
    v_mfma_f32_16x16x32_bf16 v[168:171], v[184:187], v[108:111], v[168:171]
    v_xor_b32 v59, 96, v56
    ds_read_b64_tr_b16 v[216:217], v56 offset:0
    ds_read_b64_tr_b16 v[218:219], v58 offset:2560
    v_mfma_f32_16x16x32_bf16 v[156:159], v[188:191], v[104:107], v[156:159]
    ds_read_b64_tr_b16 v[220:221], v57 offset:0
    ds_read_b64_tr_b16 v[222:223], v59 offset:2560
    ds_read_b64_tr_b16 v[224:225], v58 offset:0
    v_mfma_f32_16x16x32_bf16 v[172:175], v[188:191], v[108:111], v[172:175]
    ds_read_b64_tr_b16 v[226:227], v56 offset:2560
    ds_read_b64_tr_b16 v[228:229], v59 offset:0
    v_mfma_f32_16x16x32_bf16 v[160:163], v[192:195], v[104:107], v[160:163]
    ds_read_b64_tr_b16 v[230:231], v57 offset:2560
    s_andn2_b32 s33, s66, s63
    v_mfma_f32_16x16x32_bf16 v[176:179], v[192:195], v[108:111], v[176:179]
    s_bfe_u32 s33, s33, 0x40008
    s_cmp_eq_u32 s33, 15
    v_mfma_f32_16x16x32_bf16 v[164:167], v[196:199], v[104:107], v[164:167]
    s_cselect_b32 s76, 0, 1024
    s_xor_b32 s69, s76, 1024
    v_mfma_f32_16x16x32_bf16 v[180:183], v[196:199], v[108:111], v[180:183]
    buffer_load_dwordx4 v[144:147], v35, s[20:23], s76 offen offset:2048 sc1
    buffer_load_dwordx4 v[148:151], v36, s[20:23], s76 offen offset:2048 sc1
    s_waitcnt vmcnt(8) lgkmcnt(8)
    v_mfma_f32_16x16x32_bf16 v[152:155], v[200:203], v[112:115], v[152:155]
    v_mad_u32_u24 v56, s78, 5, v24
    v_xor_b32 v58, 64, v56
    v_xor_b32 v57, 32, v56
    v_mfma_f32_16x16x32_bf16 v[168:171], v[200:203], v[116:119], v[168:171]
    v_xor_b32 v59, 96, v56
    ds_read_b64_tr_b16 v[184:185], v56 offset:0
    ds_read_b64_tr_b16 v[186:187], v58 offset:2560
    v_mfma_f32_16x16x32_bf16 v[156:159], v[204:207], v[112:115], v[156:159]
    ds_read_b64_tr_b16 v[188:189], v57 offset:0
    ds_read_b64_tr_b16 v[190:191], v59 offset:2560
    ds_read_b64_tr_b16 v[192:193], v58 offset:0
    v_mfma_f32_16x16x32_bf16 v[172:175], v[204:207], v[116:119], v[172:175]
    ds_read_b64_tr_b16 v[194:195], v56 offset:2560
    ds_read_b64_tr_b16 v[196:197], v59 offset:0
    v_mfma_f32_16x16x32_bf16 v[160:163], v[208:211], v[112:115], v[160:163]
    ds_read_b64_tr_b16 v[198:199], v57 offset:2560
    s_cmp_eq_u32 s63, 0
    v_mfma_f32_16x16x32_bf16 v[176:179], v[208:211], v[116:119], v[176:179]
    s_cbranch_scc1 K_SP18
K_SPR18:
    s_ff1_i32_b32 s33, s63
    v_mfma_f32_16x16x32_bf16 v[164:167], v[212:215], v[112:115], v[164:167]
    s_bitset0_b32 s63, s33
    s_lshl_b32 s77, s33, 10
    v_mfma_f32_16x16x32_bf16 v[180:183], v[212:215], v[116:119], v[180:183]
    buffer_load_dwordx4 v[104:107], v25, s[20:23], s77 offen offset:0 sc1
    buffer_load_dwordx4 v[108:111], v26, s[20:23], s77 offen offset:0 sc1
    s_waitcnt vmcnt(8) lgkmcnt(8)
    v_mfma_f32_16x16x32_bf16 v[152:155], v[216:219], v[120:123], v[152:155]
    v_mad_u32_u24 v56, s75, 5, v24
    v_xor_b32 v58, 64, v56
    v_mfma_f32_16x16x32_bf16 v[168:171], v[216:219], v[124:127], v[168:171]
    v_xor_b32 v57, 32, v56
    v_xor_b32 v59, 96, v56
    v_mfma_f32_16x16x32_bf16 v[156:159], v[220:223], v[120:123], v[156:159]
    ds_read_b64_tr_b16 v[200:201], v56 offset:0
    ds_read_b64_tr_b16 v[202:203], v58 offset:2560
    v_mfma_f32_16x16x32_bf16 v[172:175], v[220:223], v[124:127], v[172:175]
    ds_read_b64_tr_b16 v[204:205], v57 offset:0
    ds_read_b64_tr_b16 v[206:207], v59 offset:2560
    v_mfma_f32_16x16x32_bf16 v[160:163], v[224:227], v[120:123], v[160:163]
    ds_read_b64_tr_b16 v[208:209], v58 offset:0
    ds_read_b64_tr_b16 v[210:211], v56 offset:2560
    v_mfma_f32_16x16x32_bf16 v[176:179], v[224:227], v[124:127], v[176:179]
    ds_read_b64_tr_b16 v[212:213], v59 offset:0
    ds_read_b64_tr_b16 v[214:215], v57 offset:2560
    v_mfma_f32_16x16x32_bf16 v[164:167], v[228:231], v[120:123], v[164:167]
    buffer_load_dwordx4 v[112:115], v35, s[20:23], s69 offen offset:2048 sc1
    buffer_load_dwordx4 v[116:119], v36, s[20:23], s69 offen offset:2048 sc1
    v_mfma_f32_16x16x32_bf16 v[180:183], v[228:231], v[124:127], v[180:183]
    s_waitcnt vmcnt(8) lgkmcnt(8)
    v_mfma_f32_16x16x32_bf16 v[152:155], v[184:187], v[128:131], v[152:155]
    v_mad_u32_u24 v56, s76, 20, v60
    v_xor_b32 v58, 64, v56
    v_mfma_f32_16x16x32_bf16 v[168:171], v[184:187], v[132:135], v[168:171]
    v_xor_b32 v57, 32, v56
    v_xor_b32 v59, 96, v56
    v_mfma_f32_16x16x32_bf16 v[156:159], v[188:191], v[128:131], v[156:159]
    ds_read_b64_tr_b16 v[216:217], v56 offset:40960
    ds_read_b64_tr_b16 v[218:219], v58 offset:43520
    v_mfma_f32_16x16x32_bf16 v[172:175], v[188:191], v[132:135], v[172:175]
    ds_read_b64_tr_b16 v[220:221], v57 offset:40960
    ds_read_b64_tr_b16 v[222:223], v59 offset:43520
    v_mfma_f32_16x16x32_bf16 v[160:163], v[192:195], v[128:131], v[160:163]
    ds_read_b64_tr_b16 v[224:225], v58 offset:40960
    ds_read_b64_tr_b16 v[226:227], v56 offset:43520
    v_mfma_f32_16x16x32_bf16 v[176:179], v[192:195], v[132:135], v[176:179]
    ds_read_b64_tr_b16 v[228:229], v59 offset:40960
    ds_read_b64_tr_b16 v[230:231], v57 offset:43520
    v_mfma_f32_16x16x32_bf16 v[164:167], v[196:199], v[128:131], v[164:167]
    v_mfma_f32_16x16x32_bf16 v[180:183], v[196:199], v[132:135], v[180:183]
    s_waitcnt vmcnt(6) lgkmcnt(8)
    v_mfma_f32_16x16x32_bf16 v[152:155], v[200:203], v[136:139], v[152:155]
    v_mad_u32_u24 v56, s77, 5, v24
    v_xor_b32 v58, 64, v56
    v_mfma_f32_16x16x32_bf16 v[168:171], v[200:203], v[140:143], v[168:171]
    v_xor_b32 v57, 32, v56
    v_xor_b32 v59, 96, v56
    v_mfma_f32_16x16x32_bf16 v[156:159], v[204:207], v[136:139], v[156:159]
    ds_read_b64_tr_b16 v[184:185], v56 offset:0
    ds_read_b64_tr_b16 v[186:187], v58 offset:2560
    v_mfma_f32_16x16x32_bf16 v[172:175], v[204:207], v[140:143], v[172:175]
    ds_read_b64_tr_b16 v[188:189], v57 offset:0
    ds_read_b64_tr_b16 v[190:191], v59 offset:2560
    v_mfma_f32_16x16x32_bf16 v[160:163], v[208:211], v[136:139], v[160:163]
    ds_read_b64_tr_b16 v[192:193], v58 offset:0
    ds_read_b64_tr_b16 v[194:195], v56 offset:2560
    v_mfma_f32_16x16x32_bf16 v[176:179], v[208:211], v[140:143], v[176:179]
    ds_read_b64_tr_b16 v[196:197], v59 offset:0
    ds_read_b64_tr_b16 v[198:199], v57 offset:2560
    v_mfma_f32_16x16x32_bf16 v[164:167], v[212:215], v[136:139], v[164:167]
    v_mfma_f32_16x16x32_bf16 v[180:183], v[212:215], v[140:143], v[180:183]
    s_waitcnt vmcnt(4) lgkmcnt(8)
    v_mfma_f32_16x16x32_bf16 v[152:155], v[216:219], v[144:147], v[152:155]
    v_mad_u32_u24 v56, s69, 20, v60
    v_xor_b32 v58, 64, v56
    v_mfma_f32_16x16x32_bf16 v[168:171], v[216:219], v[148:151], v[168:171]
    v_xor_b32 v57, 32, v56
    v_xor_b32 v59, 96, v56
    v_mfma_f32_16x16x32_bf16 v[156:159], v[220:223], v[144:147], v[156:159]
    ds_read_b64_tr_b16 v[200:201], v56 offset:40960
    ds_read_b64_tr_b16 v[202:203], v58 offset:43520
    v_mfma_f32_16x16x32_bf16 v[172:175], v[220:223], v[148:151], v[172:175]
    ds_read_b64_tr_b16 v[204:205], v57 offset:40960
    ds_read_b64_tr_b16 v[206:207], v59 offset:43520
    v_mfma_f32_16x16x32_bf16 v[160:163], v[224:227], v[144:147], v[160:163]
    ds_read_b64_tr_b16 v[208:209], v58 offset:40960
    ds_read_b64_tr_b16 v[210:211], v56 offset:43520
    v_mfma_f32_16x16x32_bf16 v[176:179], v[224:227], v[148:151], v[176:179]
    ds_read_b64_tr_b16 v[212:213], v59 offset:40960
    ds_read_b64_tr_b16 v[214:215], v57 offset:43520
    v_mfma_f32_16x16x32_bf16 v[164:167], v[228:231], v[144:147], v[164:167]
    v_mfma_f32_16x16x32_bf16 v[180:183], v[228:231], v[148:151], v[180:183]
    s_waitcnt vmcnt(2) lgkmcnt(8)
    v_mfma_f32_16x16x32_bf16 v[152:155], v[184:187], v[104:107], v[152:155]
    v_mfma_f32_16x16x32_bf16 v[156:159], v[188:191], v[104:107], v[156:159]
    v_mfma_f32_16x16x32_bf16 v[160:163], v[192:195], v[104:107], v[160:163]
    v_mfma_f32_16x16x32_bf16 v[164:167], v[196:199], v[104:107], v[164:167]
    s_sub_u32 s59, s56, s58
    s_cmp_lt_u32 s59, 32
    s_cbranch_scc1 K_YROW0
K_NOY0:
    s_sub_u32 s59, s57, s58
    s_cmp_lt_u32 s59, 32
    s_cbranch_scc1 K_YROW1
K_NOY1:
    s_waitcnt vmcnt(0) lgkmcnt(0)
    v_mfma_f32_16x16x32_bf16 v[152:155], v[200:203], v[112:115], v[152:155]
    v_mfma_f32_16x16x32_bf16 v[156:159], v[204:207], v[112:115], v[156:159]
    v_mfma_f32_16x16x32_bf16 v[160:163], v[208:211], v[112:115], v[160:163]
    v_mfma_f32_16x16x32_bf16 v[164:167], v[212:215], v[112:115], v[164:167]
    v_mfma_f32_16x16x32_bf16 v[168:171], v[184:187], v[108:111], v[168:171]
    v_mfma_f32_16x16x32_bf16 v[172:175], v[188:191], v[108:111], v[172:175]
    v_mfma_f32_16x16x32_bf16 v[176:179], v[192:195], v[108:111], v[176:179]
    s_nop 1
    v_fma_f32 v152, v152, v64, v72
    v_fma_f32 v153, v153, v64, v73
    v_fma_f32 v154, v154, v64, v74
    v_mfma_f32_16x16x32_bf16 v[180:183], v[196:199], v[108:111], v[180:183]
    v_fma_f32 v155, v155, v64, v75
    v_cvt_pk_bf16_f32 v40, v152, v153
    v_cvt_pk_bf16_f32 v41, v154, v155
    v_mfma_f32_16x16x32_bf16 v[168:171], v[200:203], v[116:119], v[168:171]
    v_fma_f32 v156, v156, v64, v76
    v_fma_f32 v157, v157, v64, v77
    ds_write_b64 v29, v[40:41] offset:0
    v_mfma_f32_16x16x32_bf16 v[172:175], v[204:207], v[116:119], v[172:175]
    v_fma_f32 v158, v158, v64, v78
    v_fma_f32 v159, v159, v64, v79
    v_cvt_pk_bf16_f32 v42, v156, v157
    v_mfma_f32_16x16x32_bf16 v[176:179], v[208:211], v[116:119], v[176:179]
    v_cvt_pk_bf16_f32 v43, v158, v159
    v_fma_f32 v160, v160, v64, v80
    v_fma_f32 v161, v161, v64, v81
    v_mfma_f32_16x16x32_bf16 v[180:183], v[212:215], v[116:119], v[180:183]
    ds_write_b64 v30, v[42:43] offset:0
    v_fma_f32 v162, v162, v64, v82
    v_fma_f32 v163, v163, v64, v83
    v_cvt_pk_bf16_f32 v44, v160, v161
    v_cvt_pk_bf16_f32 v45, v162, v163
    v_pk_fma_f32 v[164:165], v[164:165], v[64:65], v[84:85] op_sel_hi:[1,0,1]
    v_pk_fma_f32 v[166:167], v[166:167], v[64:65], v[86:87] op_sel_hi:[1,0,1]
    ds_write_b64 v31, v[44:45] offset:0
    v_cvt_pk_bf16_f32 v46, v164, v165
    v_cvt_pk_bf16_f32 v47, v166, v167
    ds_write_b64 v32, v[46:47] offset:0
    ds_read_b128 v[72:75], v33 offset:0
    ds_read_b128 v[76:79], v33 offset:1024
    v_pk_fma_f32 v[168:169], v[168:169], v[66:67], v[88:89] op_sel_hi:[1,0,1]
    v_pk_fma_f32 v[170:171], v[170:171], v[66:67], v[90:91] op_sel_hi:[1,0,1]
    v_cvt_pk_bf16_f32 v48, v168, v169
    v_cvt_pk_bf16_f32 v49, v170, v171
    v_pk_fma_f32 v[172:173], v[172:173], v[66:67], v[92:93] op_sel_hi:[1,0,1]
    v_pk_fma_f32 v[174:175], v[174:175], v[66:67], v[94:95] op_sel_hi:[1,0,1]
    v_cvt_pk_bf16_f32 v50, v172, v173
    v_cvt_pk_bf16_f32 v51, v174, v175
    v_pk_fma_f32 v[176:177], v[176:177], v[66:67], v[96:97] op_sel_hi:[1,0,1]
    v_pk_fma_f32 v[178:179], v[178:179], v[66:67], v[98:99] op_sel_hi:[1,0,1]
    v_cvt_pk_bf16_f32 v52, v176, v177
    v_cvt_pk_bf16_f32 v53, v178, v179
    v_pk_fma_f32 v[180:181], v[180:181], v[66:67], v[100:101] op_sel_hi:[1,0,1]
    v_pk_fma_f32 v[182:183], v[182:183], v[66:67], v[102:103] op_sel_hi:[1,0,1]
    v_cvt_pk_bf16_f32 v54, v180, v181
    v_cvt_pk_bf16_f32 v55, v182, v183
    s_waitcnt lgkmcnt(0)
    buffer_store_dwordx4 v[72:75], v27, s[48:51], s71 offen sc1
    buffer_store_dwordx4 v[76:79], v28, s[48:51], s72 offen sc1
    ds_write_b64 v29, v[48:49] offset:2048
    ds_write_b64 v30, v[50:51] offset:2048
    ds_write_b64 v31, v[52:53] offset:2048
    ds_write_b64 v32, v[54:55] offset:2048
    ds_read_b128 v[88:91], v33 offset:2048
    ds_read_b128 v[92:95], v33 offset:3072
    s_waitcnt lgkmcnt(1)
    buffer_store_dwordx4 v[88:91], v27, s[48:51], s73 offen sc1
    s_waitcnt lgkmcnt(0)
    buffer_store_dwordx4 v[92:95], v28, s[48:51], s74 offen sc1
K_END:
K_EXIT:
    s_endpgm
.p2align 12
WP_spin:
    s_setpc_b64 s[38:39]
K_SP0:
    ds_read_b32 v2, v12 offset:32
    s_waitcnt lgkmcnt(0)
    v_readfirstlane_b32 s33, v2
    s_nop 3
    s_lshr_b32 s63, s33, s64
    s_lshr_b32 s33, s33, s65
    s_and_b32 s63, s63, s33
    s_and_b32 s63, s63, 0xff
    s_andn2_b32 s63, s63, s66
    s_cbranch_scc0 K_SP0
    s_or_b32 s66, s66, s63
    s_branch K_SPR0
K_SP1:
    ds_read_b32 v2, v12 offset:32
    s_waitcnt lgkmcnt(0)
    v_readfirstlane_b32 s33, v2
    s_nop 3
    s_lshr_b32 s63, s33, s64
    s_lshr_b32 s33, s33, s65
    s_and_b32 s63, s63, s33
    s_and_b32 s63, s63, 0xff
    s_andn2_b32 s63, s63, s66
    s_cbranch_scc0 K_SP1
    s_or_b32 s66, s66, s63
    s_branch K_SPR1
K_SP2:
    ds_read_b32 v2, v12 offset:32
    s_waitcnt lgkmcnt(0)
    v_readfirstlane_b32 s33, v2
    s_nop 3
    s_lshr_b32 s63, s33, s64
    s_lshr_b32 s33, s33, s65
    s_and_b32 s63, s63, s33
    s_and_b32 s63, s63, 0xff
    s_andn2_b32 s63, s63, s66
    s_cbranch_scc0 K_SP2
    s_or_b32 s66, s66, s63
    s_branch K_SPR2
K_SP3:
    ds_read_b32 v2, v12 offset:32
    s_waitcnt lgkmcnt(0)
    v_readfirstlane_b32 s33, v2
    s_nop 3
    s_lshr_b32 s63, s33, s64
    s_lshr_b32 s33, s33, s65
    s_and_b32 s63, s63, s33
    s_and_b32 s63, s63, 0xff
    s_andn2_b32 s63, s63, s66
    s_cbranch_scc0 K_SP3
    s_or_b32 s66, s66, s63
    s_branch K_SPR3
K_SP4:
    ds_read_b32 v2, v12 offset:32
    s_waitcnt lgkmcnt(0)
    v_readfirstlane_b32 s33, v2
    s_nop 3
    s_lshr_b32 s63, s33, s64
    s_lshr_b32 s33, s33, s65
    s_and_b32 s63, s63, s33
    s_and_b32 s63, s63, 0xff
    s_andn2_b32 s63, s63, s66
    s_cbranch_scc0 K_SP4
    s_or_b32 s66, s66, s63
    s_branch K_SPR4
K_SP5:
    ds_read_b32 v2, v12 offset:32
    s_waitcnt lgkmcnt(0)
    v_readfirstlane_b32 s33, v2
    s_nop 3
    s_lshr_b32 s63, s33, s64
    s_lshr_b32 s33, s33, s65
    s_and_b32 s63, s63, s33
    s_and_b32 s63, s63, 0xff
    s_andn2_b32 s63, s63, s66
    s_cbranch_scc0 K_SP5
    s_or_b32 s66, s66, s63
    s_branch K_SPR5
K_SP6:
    ds_read_b32 v2, v12 offset:32
    s_waitcnt lgkmcnt(0)
    v_readfirstlane_b32 s33, v2
    s_nop 3
    s_lshr_b32 s63, s33, s64
    s_lshr_b32 s33, s33, s65
    s_and_b32 s63, s63, s33
    s_and_b32 s63, s63, 0xff
    s_andn2_b32 s63, s63, s66
    s_cbranch_scc0 K_SP6
    s_or_b32 s66, s66, s63
    s_branch K_SPR6
K_SP8:
    ds_read_b32 v2, v12 offset:32
    s_waitcnt lgkmcnt(0)
    v_readfirstlane_b32 s33, v2
    s_nop 3
    s_lshr_b32 s63, s33, s64
    s_lshr_b32 s33, s33, s65
    s_and_b32 s63, s63, s33
    s_and_b32 s63, s63, 0xff
    s_andn2_b32 s63, s63, s66
    s_cbranch_scc0 K_SP8
    s_or_b32 s66, s66, s63
    s_branch K_SPR8
K_SP10:
    ds_read_b32 v2, v12 offset:32
    s_waitcnt lgkmcnt(0)
    v_readfirstlane_b32 s33, v2
    s_nop 3
    s_lshr_b32 s63, s33, s64
    s_lshr_b32 s33, s33, s65
    s_and_b32 s63, s63, s33
    s_and_b32 s63, s63, 0xff00
    s_andn2_b32 s63, s63, s66
    s_cbranch_scc0 K_SP10
    s_or_b32 s66, s66, s63
    s_branch K_SPR10
K_SP11:
    ds_read_b32 v2, v12 offset:32
    s_waitcnt lgkmcnt(0)
    v_readfirstlane_b32 s33, v2
    s_nop 3
    s_lshr_b32 s63, s33, s64
    s_lshr_b32 s33, s33, s65
    s_and_b32 s63, s63, s33
    s_and_b32 s63, s63, 0xff00
    s_andn2_b32 s63, s63, s66
    s_cbranch_scc0 K_SP11
    s_or_b32 s66, s66, s63
    s_branch K_SPR11
K_SP12:
    ds_read_b32 v2, v12 offset:32
    s_waitcnt lgkmcnt(0)
    v_readfirstlane_b32 s33, v2
    s_nop 3
    s_lshr_b32 s63, s33, s64
    s_lshr_b32 s33, s33, s65
    s_and_b32 s63, s63, s33
    s_and_b32 s63, s63, 0xff00
    s_andn2_b32 s63, s63, s66
    s_cbranch_scc0 K_SP12
    s_or_b32 s66, s66, s63
    s_branch K_SPR12
K_SP13:
    ds_read_b32 v2, v12 offset:32
    s_waitcnt lgkmcnt(0)
    v_readfirstlane_b32 s33, v2
    s_nop 3
    s_lshr_b32 s63, s33, s64
    s_lshr_b32 s33, s33, s65
    s_and_b32 s63, s63, s33
    s_and_b32 s63, s63, 0xff00
    s_andn2_b32 s63, s63, s66
    s_cbranch_scc0 K_SP13
    s_or_b32 s66, s66, s63
    s_branch K_SPR13
K_SP14:
    ds_read_b32 v2, v12 offset:32
    s_waitcnt lgkmcnt(0)
    v_readfirstlane_b32 s33, v2
    s_nop 3
    s_lshr_b32 s63, s33, s64
    s_lshr_b32 s33, s33, s65
    s_and_b32 s63, s63, s33
    s_and_b32 s63, s63, 0xff00
    s_andn2_b32 s63, s63, s66
    s_cbranch_scc0 K_SP14
    s_or_b32 s66, s66, s63
    s_branch K_SPR14
K_SP15:
    ds_read_b32 v2, v12 offset:32
    s_waitcnt lgkmcnt(0)
    v_readfirstlane_b32 s33, v2
    s_nop 3
    s_lshr_b32 s63, s33, s64
    s_lshr_b32 s33, s33, s65
    s_and_b32 s63, s63, s33
    s_and_b32 s63, s63, 0xff00
    s_andn2_b32 s63, s63, s66
    s_cbranch_scc0 K_SP15
    s_or_b32 s66, s66, s63
    s_branch K_SPR15
K_SP16:
    ds_read_b32 v2, v12 offset:32
    s_waitcnt lgkmcnt(0)
    v_readfirstlane_b32 s33, v2
    s_nop 3
    s_lshr_b32 s63, s33, s64
    s_lshr_b32 s33, s33, s65
    s_and_b32 s63, s63, s33
    s_and_b32 s63, s63, 0xff00
    s_andn2_b32 s63, s63, s66
    s_cbranch_scc0 K_SP16
    s_or_b32 s66, s66, s63
    s_branch K_SPR16
K_SP18:
    ds_read_b32 v2, v12 offset:32
    s_waitcnt lgkmcnt(0)
    v_readfirstlane_b32 s33, v2
    s_nop 3
    s_lshr_b32 s63, s33, s64
    s_lshr_b32 s33, s33, s65
    s_and_b32 s63, s63, s33
    s_and_b32 s63, s63, 0xff00
    s_andn2_b32 s63, s63, s66
    s_cbranch_scc0 K_SP18
    s_or_b32 s66, s66, s63
    s_branch K_SPR18
WP_yr0:
    s_setpc_b64 s[38:39]
K_YROW0:
    v_lshlrev_b32 v5, 4, v9
    v_add_u32 v5, 158976, v5
    v_and_b32 v3, 15, v1
    s_and_b32 s33, s59, 15
    v_cmp_eq_u32 vcc, s33, v3
    s_mov_b32 s3, 1048576
K_P2_GY0:
    ds_read_b32 v2, v12 offset:64
    s_sub_u32 s3, s3, 1
    s_waitcnt lgkmcnt(0)
    v_readfirstlane_b32 s33, v2
    s_nop 3
    s_cselect_b32 s33, 1, s33
    s_cmp_lt_u32 s33, 1
    s_cbranch_scc1 K_P2_GY0
    s_mov_b64 exec, vcc
    s_cmp_ge_u32 s59, 16
    s_cbranch_scc1 K_YR1_0
    ds_read_b128 v[72:75], v5 offset:0
    ds_read_b128 v[76:79], v5 offset:64
    ds_read_b128 v[80:83], v5 offset:128
    ds_read_b128 v[84:87], v5 offset:192
    s_mov_b64 exec, -1
    s_branch K_NOY0
K_YR1_0:
    ds_read_b128 v[88:91], v5 offset:0
    ds_read_b128 v[92:95], v5 offset:64
    ds_read_b128 v[96:99], v5 offset:128
    ds_read_b128 v[100:103], v5 offset:192
    s_mov_b64 exec, -1
    s_branch K_NOY0
K_YROW1:
    v_lshlrev_b32 v5, 4, v9
    v_add_u32 v5, 159232, v5
    v_and_b32 v3, 15, v1
    s_and_b32 s33, s59, 15
    v_cmp_eq_u32 vcc, s33, v3
    s_mov_b32 s3, 1048576
K_P2_GY1:
    ds_read_b32 v2, v12 offset:68
    s_sub_u32 s3, s3, 1
    s_waitcnt lgkmcnt(0)
    v_readfirstlane_b32 s33, v2
    s_nop 3
    s_cselect_b32 s33, 1, s33
    s_cmp_lt_u32 s33, 1
    s_cbranch_scc1 K_P2_GY1
    s_mov_b64 exec, vcc
    s_cmp_ge_u32 s59, 16
    s_cbranch_scc1 K_YR1_1
    ds_read_b128 v[72:75], v5 offset:0
    ds_read_b128 v[76:79], v5 offset:64
    ds_read_b128 v[80:83], v5 offset:128
    ds_read_b128 v[84:87], v5 offset:192
    s_mov_b64 exec, -1
    s_branch K_NOY1
K_YR1_1:
    ds_read_b128 v[88:91], v5 offset:0
    ds_read_b128 v[92:95], v5 offset:64
    ds_read_b128 v[96:99], v5 offset:128
    ds_read_b128 v[100:103], v5 offset:192
    s_mov_b64 exec, -1
    s_branch K_NOY1
.p2align 12
WP_gen:
    s_setpc_b64 s[38:39]
K_P2:
    s_cmp_ge_u32 s30, 4
    s_cbranch_scc1 K_P2_HELP
    v_mov_b32 v12, 158720
    s_cmp_lg_u32 s30, 0
    s_cbranch_scc1 K_P2_W13
    v_lshrrev_b32 v3, 4, v1
    v_and_b32 v4, 7, v1
    v_lshrrev_b32 v2, 3, v1
    v_xor_b32 v4, v4, v3
    v_mul_u32_u24 v2, 1280, v2
    v_lshl_add_u32 v27, v4, 4, v2
    v_xor_b32 v28, 64, v27
    s_mov_b32 s58, 0
K_P2_XD:
    s_lshl_b32 s59, s40, 3
    s_lshl1_add_u32 s59, s58, s59
    s_mul_i32 s59, s59, 20480
    s_lshl_b32 s33, s41, 7
    s_add_u32 s59, s59, s33
    s_lshl_b32 s33, s58, 12
    s_add_u32 m0, s33, 140288
    s_add_u32 s3, s59, 0
    buffer_load_dwordx4 v27, s[12:15], s3 offen lds
    s_add_u32 m0, s33, 141312
    s_add_u32 s3, s59, 10240
    buffer_load_dwordx4 v28, s[12:15], s3 offen lds
    s_add_u32 m0, s33, 142336
    s_add_u32 s3, s59, 20480
    buffer_load_dwordx4 v27, s[12:15], s3 offen lds
    s_add_u32 m0, s33, 143360
    s_add_u32 s3, s59, 30720
    buffer_load_dwordx4 v28, s[12:15], s3 offen lds
    s_add_u32 s58, s58, 1
    s_cmp_lt_u32 s58, 4
    s_cbranch_scc1 K_P2_XD
    s_waitcnt vmcnt(0)
    s_branch K_P2_AUXW
K_P2_W13:
    v_lshrrev_b32 v2, 3, v1
    v_mul_u32_u24 v2, 1280, v2
    v_lshrrev_b32 v3, 4, v1
    v_lshlrev_b32 v3, 1, v3
    v_and_b32 v4, 7, v1
    v_xor_b32 v3, v3, v4
    v_lshl_add_u32 v2, v3, 4, v2
    s_lshl_b32 s33, s41, 7
    v_add_u32 v22, s33, v2
    s_mov_b32 s60, 0xfda87520
    s_mov_b32 s61, 0xecb96431
    s_sub_u32 s58, s30, 1
K_P2_WS:
    s_lshl_b32 s3, s58, 2
    s_lshr_b64 s[4:5], s[60:61], s3
    s_and_b32 s4, s4, 15
    s_mul_i32 s4, s4, 51200
    s_mul_i32 s59, s58, 5120
    s_add_u32 s52, s4, 0
    s_add_u32 m0, s59, 0
    s_waitcnt vmcnt(11)
    buffer_load_dwordx4 v22, s[24:27], s52 offen lds
    s_add_u32 s52, s4, 10240
    s_add_u32 m0, s59, 1024
    s_waitcnt vmcnt(11)
    buffer_load_dwordx4 v22, s[24:27], s52 offen lds
    s_add_u32 s52, s4, 20480
    s_add_u32 m0, s59, 2048
    s_waitcnt vmcnt(11)
    buffer_load_dwordx4 v22, s[24:27], s52 offen lds
    s_add_u32 s52, s4, 30720
    s_add_u32 m0, s59, 3072
    s_waitcnt vmcnt(11)
    buffer_load_dwordx4 v22, s[24:27], s52 offen lds
    s_add_u32 s52, s4, 40960
    s_add_u32 m0, s59, 4096
    s_waitcnt vmcnt(11)
    buffer_load_dwordx4 v22, s[24:27], s52 offen lds
    s_cmp_ge_u32 s58, 3
    s_cbranch_scc1 K_P2_WS1
    v_mov_b32 v3, 1
    s_waitcnt vmcnt(5)
    s_mov_b64 exec, 1
    ds_add_u32 v12, v3 offset:52
    s_mov_b64 exec, -1
K_P2_WS1:
    s_add_u32 s58, s58, 3
    s_cmp_lt_u32 s58, 16
    s_cbranch_scc1 K_P2_WS
K_P2_AUXW:
    v_mov_b32 v34, 1
    s_waitcnt vmcnt(10)
    s_mov_b64 exec, 1
    ds_add_u32 v12, v34 offset:72
    s_mov_b64 exec, -1
    s_lshl_b32 s54, s40, 7
    v_lshrrev_b32 v9, 4, v1
    v_mov_b32 v12, 158720
    s_add_u32 s20, s10, 0x100000
    s_addc_u32 s21, s11, 0
    s_mov_b32 s22, 0x280000
    s_mov_b32 s23, 0x20000
    s_add_u32 s16, s10, 0x1000
    s_addc_u32 s17, s11, 0
    s_mov_b32 s18, 0x2000
    s_mov_b32 s19, 0x20000
    s_mov_b32 s48, s6
    s_mov_b32 s49, s7
    s_mov_b32 s50, 0x280000
    s_mov_b32 s51, 0x20000
    s_lshl_b32 s53, s40, 3
    s_lshl1_add_u32 s53, s30, s53
    s_mov_b32 s55, 20480
    v_bfe_u32 v20, v1, 2, 2
    v_and_b32 v21, 3, v1
    s_mul_i32 s3, s53, 20480
    v_lshl_add_u32 v25, v1, 4, s3
    v_add_u32 v26, 20480, v25
    v_add_u32 v35, 16384, v25
    v_add_u32 v36, 16384, v26
    v_and_b32 v2, 15, v1
    s_lshl_b32 s3, s53, 6
    v_lshl_add_u32 v23, v2, 2, s3
    v_lshl_add_u32 v2, v9, 2, v20
    v_bfe_u32 v3, v2, 1, 2
    v_lshlrev_b32 v2, 7, v2
    v_lshl_add_u32 v2, v21, 3, v2
    v_lshl_add_u32 v24, v3, 5, v2
    v_lshrrev_b32 v3, 1, v20
    v_mul_u32_u24 v2, 40, v9
    v_add3_u32 v2, v2, 16, v20
    v_lshlrev_b32 v2, 7, v2
    v_lshl_add_u32 v2, v21, 3, v2
    v_xor_b32 v4, 0, v3
    v_lshl_add_u32 v60, v4, 5, v2
    v_xor_b32 v4, 1, v3
    v_lshl_add_u32 v61, v4, 5, v2
    v_xor_b32 v4, 2, v3
    v_lshl_add_u32 v62, v4, 5, v2
    v_xor_b32 v4, 3, v3
    v_lshl_add_u32 v63, v4, 5, v2
    v_lshrrev_b32 v3, 4, v1
    v_and_b32 v4, 7, v1
    v_lshrrev_b32 v2, 3, v1
    v_xor_b32 v4, v4, v3
    v_mul_u32_u24 v2, 1280, v2
    v_lshl_add_u32 v27, v4, 4, v2
    v_xor_b32 v28, 64, v27
    s_lshl_b32 s71, s40, 3
    s_lshl1_add_u32 s71, s30, s71
    s_mul_i32 s71, s71, 20480
    s_lshl_b32 s33, s41, 7
    s_add_u32 s71, s71, s33
    s_add_u32 s72, s71, 10240
    s_add_u32 s73, s71, 20480
    s_add_u32 s74, s71, 30720
    s_lshl_b32 s3, s30, 12
    s_add_u32 s3, s3, 140288
    v_lshl_add_u32 v33, v1, 4, s3
    v_and_b32 v2, 15, v1
    v_lshrrev_b32 v3, 1, v2
    v_lshrrev_b32 v4, 5, v1
    v_xor_b32 v3, v3, v4
    v_lshlrev_b32 v3, 4, v3
    v_lshl_add_u32 v3, v2, 7, v3
    v_and_b32 v4, 1, v9
    v_lshl_add_u32 v3, v4, 3, v3
    v_add_u32 v29, s3, v3
    v_xor_b32 v30, 32, v29
    v_xor_b32 v31, 64, v29
    v_xor_b32 v32, 96, v29
    s_and_b32 s33, s40, 3
    s_lshl_b32 s33, s33, 3
    s_lshr_b32 s33, 0x7f06037f, s33
    s_and_b32 s33, s33, 0xff
    s_lshl_b32 s3, s30, 1
    s_cmp_ge_u32 s3, s33
    s_cselect_b32 s64, 16, 0
    s_add_u32 s3, s3, 1
    s_cmp_ge_u32 s3, s33
    s_cselect_b32 s65, 16, 0
    s_mov_b32 s63, 0
    s_mov_b32 s66, 0
    s_mov_b32 s67, 16384
    s_mov_b32 s3, 1048576
K_P2_GWA:
    ds_read_b32 v2, v12 offset:72
    s_sub_u32 s3, s3, 1
    s_waitcnt lgkmcnt(0)
    v_readfirstlane_b32 s33, v2
    s_nop 3
    s_cselect_b32 s33, 4, s33
    s_cmp_lt_u32 s33, 4
    s_cbranch_scc1 K_P2_GWA
    s_branch K_P2_GEMM
WP_help:
    s_setpc_b64 s[38:39]
K_LATE:
    v_mov_b32 v6, 158800
    s_mov_b32 s3, 1048576
K_XGL:
    ds_read_b128 v[2:5], v6
    s_sleep 1
    s_sub_u32 s3, s3, 1
    s_waitcnt lgkmcnt(0)
    v_min3_u32 v2, v2, v4, v5
    v_min_u32 v2, v2, v3
    s_nop 0
    v_readfirstlane_b32 s33, v2
    s_nop 3
    s_cselect_b32 s33, 1, s33
    s_cmp_lt_u32 s33, 1
    s_cbranch_scc1 K_XGL
    s_sub_u32 s44, s30, 4
K_WOL:
    s_lshl_b32 s50, s44, 2
    s_lshr_b32 s50, 0x6431, s50
    s_and_b32 s50, s50, 7
    s_mul_i32 s50, s50, 51200
    s_mul_i32 s51, s44, 5120
    s_add_u32 s3, s50, 0
    s_add_u32 m0, s51, 40960
    s_waitcnt vmcnt(13)
    buffer_load_dwordx4 v17, s[24:27], s3 offen lds
    s_add_u32 s3, s50, 10240
    s_add_u32 m0, s51, 41984
    s_waitcnt vmcnt(13)
    buffer_load_dwordx4 v17, s[24:27], s3 offen lds
    s_add_u32 s3, s50, 20480
    s_add_u32 m0, s51, 43008
    s_waitcnt vmcnt(13)
    buffer_load_dwordx4 v17, s[24:27], s3 offen lds
    s_add_u32 s3, s50, 30720
    s_add_u32 m0, s51, 44032
    s_waitcnt vmcnt(13)
    buffer_load_dwordx4 v17, s[24:27], s3 offen lds
    s_add_u32 s3, s50, 40960
    s_add_u32 m0, s51, 45056
    s_waitcnt vmcnt(13)
    buffer_load_dwordx4 v17, s[24:27], s3 offen lds
    s_add_u32 s3, s50, 409600
    s_add_u32 m0, s51, 61440
    s_waitcnt vmcnt(13)
    buffer_load_dwordx4 v17, s[24:27], s3 offen lds
    s_add_u32 s3, s50, 419840
    s_add_u32 m0, s51, 62464
    s_waitcnt vmcnt(13)
    buffer_load_dwordx4 v17, s[24:27], s3 offen lds
    s_add_u32 s3, s50, 430080
    s_add_u32 m0, s51, 63488
    s_waitcnt vmcnt(13)
    buffer_load_dwordx4 v17, s[24:27], s3 offen lds
    s_add_u32 s3, s50, 440320
    s_add_u32 m0, s51, 64512
    s_waitcnt vmcnt(13)
    buffer_load_dwordx4 v17, s[24:27], s3 offen lds
    s_add_u32 s3, s50, 450560
    s_add_u32 m0, s51, 65536
    s_waitcnt vmcnt(13)
    buffer_load_dwordx4 v17, s[24:27], s3 offen lds
    s_add_u32 s44, s44, 2
    s_cmp_lt_u32 s44, 4
    s_cbranch_scc1 K_WOL
    v_mov_b32 v2, 158720
    v_mov_b32 v3, 2
    s_waitcnt vmcnt(0)
    s_mov_b64 exec, 1
    ds_add_u32 v2, v3 offset:44
    s_mov_b64 exec, -1
K_P2_HELP:
    s_setprio 3
    s_add_u32 s59, s40, 1
    s_bitcmp1_b32 s59, 1
    s_cselect_b32 s59, 31, 15
    v_and_b32 v10, s59, v1
    v_lshl_add_u32 v10, v10, 2, s42
    s_cmp_lg_u32 s30, 7
    s_cbranch_scc1 K_P2_N7
    v_and_b32 v4, 7, v1
    v_lshlrev_b32 v4, 2, v4
    s_mov_b32 s3, 131072
K_ZPOLL1:
    v_cmp_eq_u32 vcc, 0, v7
    s_cbranch_vccz K_ZOK1
    s_sub_u32 s3, s3, 1
    s_cbranch_scc1 K_ZOK1
    global_load_dword v7, v4, s[8:9] offset:192 sc1
    s_waitcnt vmcnt(0)
    s_branch K_ZPOLL1
K_ZOK1:
    global_load_dword v7, v10, s[10:11] sc1
K_P2_N7:
    s_lshl_b32 s54, s40, 7
    v_lshrrev_b32 v9, 4, v1
    v_mov_b32 v12, 158720
    s_add_u32 s44, s10, 0x10000
    s_addc_u32 s45, s11, 0
    s_mov_b32 s46, 0x43800
    s_mov_b32 s47, 0x20000
    v_mov_b32 v80, 1
    s_cmp_eq_u32 s30, 7
    s_cbranch_scc1 K_P2_FLAGS
    s_cmp_lg_u32 s30, 6
    s_cbranch_scc1 K_END
    s_mov_b32 s3, 131072
K_P2_DPOLL:
    v_cmp_eq_u32 vcc, 0, v7
    s_cbranch_vccz K_P2_DOK
    s_cmp_eq_u32 s3, 131072
    s_cbranch_scc1 K_P2_DNS
    s_sleep 12
K_P2_DNS:
    v_and_b32 v11, 1, v1
    v_lshl_add_u32 v11, v11, 2, s42
    global_load_dword v7, v11, s[10:11] offset:128 sc1
    s_sub_u32 s3, s3, 1
    s_waitcnt vmcnt(0)
    s_cmp_lg_u32 s3, 0
    s_cbranch_scc1 K_P2_DPOLL
K_P2_DOK:
    v_readlane_b32 s58, v7, 0
    v_readlane_b32 s59, v7, 1
    s_nop 3
    s_and_b32 s3, s58, 0x7ff
    s_sub_u32 s3, 2047, s3
    v_mov_b32 v20, s3
    v_mov_b32 v4, s58
    v_and_b32 v4, 0xffff0000, v4
    v_ashrrev_i32 v5, 31, v4
    v_not_b32 v5, v5
    v_or_b32 v5, 0x80000000, v5
    v_xor_b32 v4, v4, v5
    v_and_b32 v4, 0xffff0000, v4
    v_mul_f32 v5, 0xbfb8aa3b, v4
    v_exp_f32 v5, v5
    s_nop 0
    v_add_f32 v5, 1.0, v5
    v_rcp_f32 v4, v5
    s_nop 0
    v_cvt_pk_bf16_f32 v22, v4, v4
    v_lshlrev_b32 v22, 16, v22
    s_and_b32 s3, s59, 0x7ff
    s_sub_u32 s3, 2047, s3
    v_mov_b32 v21, s3
    v_mov_b32 v4, s59
    v_and_b32 v4, 0xffff0000, v4
    v_ashrrev_i32 v5, 31, v4
    v_not_b32 v5, v5
    v_or_b32 v5, 0x80000000, v5
    v_xor_b32 v4, v4, v5
    v_and_b32 v4, 0xffff0000, v4
    v_mul_f32 v5, 0xbfb8aa3b, v4
    v_exp_f32 v5, v5
    s_nop 0
    v_add_f32 v5, 1.0, v5
    v_rcp_f32 v4, v5
    s_nop 0
    v_cvt_pk_bf16_f32 v23, v4, v4
    v_lshlrev_b32 v23, 16, v23
    ds_write_b128 v12, v[20:23]
    ds_write_b32 v12, v80 offset:40
    s_mov_b32 s53, 0
    v_mov_b32 v16, v20
    v_mov_b32 v17, v21
    v_mov_b32 v18, v22
    v_mov_b32 v19, v23
K_P2_HW:
    s_cmp_eq_u32 s53, 0
    s_cselect_b64 vcc, -1, 0
    s_nop 1
    v_cndmask_b32 v2, v17, v16, vcc
    v_cndmask_b32 v5, v19, v18, vcc
    s_nop 0
    v_readfirstlane_b32 s58, v2
    s_nop 3
    s_sub_u32 s3, s58, s54
    s_cmp_lt_u32 s3, 128
    s_cbranch_scc0 K_P2_YN
    s_call_b64 s[38:39], WP_yr0
    s_mul_i32 s3, s58, 1280
    s_lshl_b32 s33, s41, 7
    s_add_u32 s3, s3, s33
    v_and_b32 v2, 15, v1
    v_lshlrev_b32 v2, 3, v2
    buffer_load_dwordx2 v[84:85], v2, s[12:15], s3 offen
    s_lshl_b32 s3, s58, 2
    s_add_u32 s3, s3, 4096
    v_mov_b32 v2, s3
    global_load_dword v88, v2, s[10:11] sc1
    s_lshl1_add_u32 s3, s41, s53
    s_lshl_b32 s3, s3, 8
    s_add_u32 s3, s3, 568320
    v_min_u32 v3, 53, v1
    v_lshl_add_u32 v3, v3, 2, s3
    s_mov_b32 s3, 131072
K_P2_YPOLL:
    global_load_dword v2, v3, s[10:11] sc1
    s_sub_u32 s3, s3, 1
    s_waitcnt vmcnt(0)
    v_cmp_ne_u32 vcc, 1, v2
    s_cbranch_vccz K_P2_YGO
    s_bcnt1_i32_b64 s33, vcc
    s_cmp_le_u32 s33, 24
    s_cbranch_scc1 K_P2_YS
    s_sleep 16
K_P2_YS:
    s_sleep 2
    s_cmp_lg_u32 s3, 0
    s_cbranch_scc1 K_P2_YPOLL
K_P2_YGO:
    v_and_b32 v2, 15, v1
    v_lshlrev_b32 v2, 4, v2
    v_mul_u32_u24 v4, 5120, v9
    s_mov_b32 s59, s53
    s_mul_i32 s33, s59, 2560
    s_lshl_b32 s3, s41, 8
    s_add_u32 s3, s3, s33
    v_add3_u32 v3, v2, v4, s3
    s_mov_b32 s52, 0
    buffer_load_dwordx4 v[24:27], v3, s[44:47], s52 offen sc1
    s_mov_b32 s52, 20480
    buffer_load_dwordx4 v[28:31], v3, s[44:47], s52 offen sc1
    s_mov_b32 s52, 40960
    buffer_load_dwordx4 v[32:35], v3, s[44:47], s52 offen sc1
    s_mov_b32 s52, 61440
    buffer_load_dwordx4 v[36:39], v3, s[44:47], s52 offen sc1
    s_mov_b32 s52, 81920
    buffer_load_dwordx4 v[40:43], v3, s[44:47], s52 offen sc1
    s_mov_b32 s52, 102400
    buffer_load_dwordx4 v[44:47], v3, s[44:47], s52 offen sc1
    s_mov_b32 s52, 122880
    buffer_load_dwordx4 v[48:51], v3, s[44:47], s52 offen sc1
    s_mov_b32 s52, 143360
    buffer_load_dwordx4 v[52:55], v3, s[44:47], s52 offen sc1
    s_mov_b32 s52, 163840
    buffer_load_dwordx4 v[56:59], v3, s[44:47], s52 offen sc1
    s_mov_b32 s52, 184320
    buffer_load_dwordx4 v[60:63], v3, s[44:47], s52 offen sc1
    s_mov_b32 s52, 204800
    buffer_load_dwordx4 v[64:67], v3, s[44:47], s52 offen sc1
    s_mov_b32 s52, 225280
    buffer_load_dwordx4 v[68:71], v3, s[44:47], s52 offen sc1
    s_mov_b32 s52, 245760
    buffer_load_dwordx4 v[72:75], v3, s[44:47], s52 offen sc1
    s_mov_b32 s52, 266240
    buffer_load_dwordx4 v[76:79], v3, s[44:47], s52 offen sc1
    v_sub_f32 v88, 1.0, v88
    v_cvt_pk_bf16_f32 v88, v88, v88
    v_lshlrev_b32 v88, 16, v88
    v_lshlrev_b32 v86, 16, v85
    v_and_b32 v87, 0xffff0000, v85
    v_and_b32 v85, 0xffff0000, v84
    v_lshlrev_b32 v84, 16, v84
    s_waitcnt vmcnt(12)
    v_pk_add_f32 v[20:21], v[24:25], v[28:29]
    v_pk_add_f32 v[22:23], v[26:27], v[30:31]
    s_waitcnt vmcnt(11)
    v_pk_add_f32 v[20:21], v[20:21], v[32:33]
    v_pk_add_f32 v[22:23], v[22:23], v[34:35]
    s_waitcnt vmcnt(10)
    v_pk_add_f32 v[20:21], v[20:21], v[36:37]
    v_pk_add_f32 v[22:23], v[22:23], v[38:39]
    s_waitcnt vmcnt(9)
    v_pk_add_f32 v[20:21], v[20:21], v[40:41]
    v_pk_add_f32 v[22:23], v[22:23], v[42:43]
    s_waitcnt vmcnt(8)
    v_pk_add_f32 v[20:21], v[20:21], v[44:45]
    v_pk_add_f32 v[22:23], v[22:23], v[46:47]
    s_waitcnt vmcnt(7)
    v_pk_add_f32 v[20:21], v[20:21], v[48:49]
    v_pk_add_f32 v[22:23], v[22:23], v[50:51]
    s_waitcnt vmcnt(6)
    v_pk_add_f32 v[20:21], v[20:21], v[52:53]
    v_pk_add_f32 v[22:23], v[22:23], v[54:55]
    s_waitcnt vmcnt(5)
    v_pk_add_f32 v[20:21], v[20:21], v[56:57]
    v_pk_add_f32 v[22:23], v[22:23], v[58:59]
    s_waitcnt vmcnt(4)
    v_pk_add_f32 v[20:21], v[20:21], v[60:61]
    v_pk_add_f32 v[22:23], v[22:23], v[62:63]
    s_waitcnt vmcnt(3)
    v_pk_add_f32 v[20:21], v[20:21], v[64:65]
    v_pk_add_f32 v[22:23], v[22:23], v[66:67]
    s_waitcnt vmcnt(2)
    v_pk_add_f32 v[20:21], v[20:21], v[68:69]
    v_pk_add_f32 v[22:23], v[22:23], v[70:71]
    s_waitcnt vmcnt(1)
    v_pk_add_f32 v[20:21], v[20:21], v[72:73]
    v_pk_add_f32 v[22:23], v[22:23], v[74:75]
    s_waitcnt vmcnt(0)
    v_pk_add_f32 v[20:21], v[20:21], v[76:77]
    v_pk_add_f32 v[22:23], v[22:23], v[78:79]
    v_mov_b32 v24, v20
    v_mov_b32 v25, v21
    v_mov_b32 v26, v22
    v_mov_b32 v27, v23
    s_nop 0
    v_permlane16_swap_b32 v20, v24
    v_permlane16_swap_b32 v21, v25
    v_permlane16_swap_b32 v22, v26
    v_permlane16_swap_b32 v23, v27
    v_add_f32 v20, v20, v24
    v_add_f32 v21, v21, v25
    v_add_f32 v22, v22, v26
    v_add_f32 v23, v23, v27
    v_mov_b32 v24, v20
    v_mov_b32 v25, v21
    v_mov_b32 v26, v22
    v_mov_b32 v27, v23
    s_nop 0
    v_permlane32_swap_b32 v20, v24
    v_permlane32_swap_b32 v21, v25
    v_permlane32_swap_b32 v22, v26
    v_permlane32_swap_b32 v23, v27
    v_add_f32 v20, v20, v24
    v_add_f32 v21, v21, v25
    v_add_f32 v22, v22, v26
    v_add_f32 v23, v23, v27
    v_cvt_pk_bf16_f32 v20, v20, v20
    v_lshlrev_b32 v20, 16, v20
    v_mul_f32 v20, v5, v20
    v_cvt_pk_bf16_f32 v20, v20, v20
    v_lshlrev_b32 v20, 16, v20
    v_add_f32 v20, v20, v84
    v_cvt_pk_bf16_f32 v20, v20, v20
    v_lshlrev_b32 v20, 16, v20
    v_mul_f32 v20, v20, v88
    v_cvt_pk_bf16_f32 v21, v21, v21
    v_lshlrev_b32 v21, 16, v21
    v_mul_f32 v21, v5, v21
    v_cvt_pk_bf16_f32 v21, v21, v21
    v_lshlrev_b32 v21, 16, v21
    v_add_f32 v21, v21, v85
    v_cvt_pk_bf16_f32 v21, v21, v21
    v_lshlrev_b32 v21, 16, v21
    v_mul_f32 v21, v21, v88
    v_cvt_pk_bf16_f32 v22, v22, v22
    v_lshlrev_b32 v22, 16, v22
    v_mul_f32 v22, v5, v22
    v_cvt_pk_bf16_f32 v22, v22, v22
    v_lshlrev_b32 v22, 16, v22
    v_add_f32 v22, v22, v86
    v_cvt_pk_bf16_f32 v22, v22, v22
    v_lshlrev_b32 v22, 16, v22
    v_mul_f32 v22, v22, v88
    v_cvt_pk_bf16_f32 v23, v23, v23
    v_lshlrev_b32 v23, 16, v23
    v_mul_f32 v23, v5, v23
    v_cvt_pk_bf16_f32 v23, v23, v23
    v_lshlrev_b32 v23, 16, v23
    v_add_f32 v23, v23, v87
    v_cvt_pk_bf16_f32 v23, v23, v23
    v_lshlrev_b32 v23, 16, v23
    v_mul_f32 v23, v23, v88
    s_lshl_b32 s3, s59, 8
    s_add_u32 s3, s3, 158976
    v_add_u32 v2, s3, v2
    ds_write_b128 v2, v[20:23]
    s_lshl_b32 s3, s59, 2
    v_add_u32 v2, s3, v12
    ds_write_b32 v2, v80 offset:64
K_P2_YN:
    s_add_u32 s53, s53, 1
    s_cmp_lt_u32 s53, 2
    s_cbranch_scc1 K_P2_HW
    s_branch K_END
WP_flags:
    s_setpc_b64 s[38:39]
K_P2_FLAGS:
    s_mov_b32 exec_hi, 0
    s_waitcnt vmcnt(0)
    s_mov_b32 s3, 131072
K_P2_FCHK:
    v_cmp_eq_u32 vcc, 1, v7
    s_nop 1
    v_mov_b32 v2, vcc_lo
    ds_write_b32 v12, v2 offset:32
    s_cmp_eq_u32 vcc_lo, -1
    s_cbranch_scc1 K_P2_FGO
    s_cmp_lg_u32 vcc_lo, 0
    s_cbranch_scc1 K_P2_FS
    s_sleep 4
K_P2_FS:
    s_sleep 6
    global_load_dword v7, v10, s[10:11] sc1
    s_sub_u32 s3, s3, 1
    s_waitcnt vmcnt(0)
    s_cbranch_scc0 K_P2_FCHK
    v_mov_b32 v2, -1
    ds_write_b32 v12, v2 offset:32
K_P2_FGO:
    s_mov_b64 exec, -1
    s_branch K_END
.p2align 12
K_AUX:
    s_load_dwordx8 s[48:55], s[0:1], 32
    s_load_dwordx2 s[56:57], s[0:1], 64
    s_mul_i32 s44, s28, 7
    s_add_u32 s44, s44, s29
    s_sub_u32 s44, s44, 1
    s_cmp_lt_u32 s44, 54
    s_cselect_b32 s44, s44, 63
    s_cmp_eq_u32 s29, 0
    s_cselect_b32 s44, 63, s44
    s_lshl_b32 s74, s28, 8
    s_lshl_b32 s3, s29, 5
    s_add_u32 s74, s74, s3
    v_mov_b32 v12, 158720
    v_mov_b32 v13, 1
    s_cmp_lt_u32 s30, 4
    s_cbranch_scc1 K_AUX_LO
    s_lshl_b32 s3, s30, 3
    s_add_u32 s3, s3, s74
    s_sub_u32 s3, s3, 32
    v_lshrrev_b32 v9, 3, v1
    v_add_u32 v9, s3, v9
    v_and_b32 v11, 7, v1
    v_lshlrev_b32 v11, 4, v11
    v_mul_u32_u24 v10, 1280, v9
    v_add_u32 v10, v10, v11
    s_waitcnt lgkmcnt(0)
    buffer_load_dwordx4 v[16:19], v10, s[12:15], 0 offen offset:0
    buffer_load_dwordx4 v[20:23], v10, s[12:15], 0 offen offset:128
    buffer_load_dwordx4 v[24:27], v10, s[12:15], 0 offen offset:256
    buffer_load_dwordx4 v[28:31], v10, s[12:15], 0 offen offset:384
    buffer_load_dwordx4 v[32:35], v10, s[12:15], 0 offen offset:512
    buffer_load_dwordx4 v[36:39], v10, s[12:15], 0 offen offset:640
    buffer_load_dwordx4 v[40:43], v10, s[12:15], 0 offen offset:768
    buffer_load_dwordx4 v[44:47], v10, s[12:15], 0 offen offset:896
    buffer_load_dwordx4 v[48:51], v10, s[12:15], 0 offen offset:1024
    buffer_load_dwordx4 v[52:55], v10, s[12:15], 0 offen offset:1152
    s_mov_b32 s16, s48
    s_mov_b32 s17, s49
    s_mov_b32 s18, 0x500
    s_mov_b32 s19, 0x20000
    s_mov_b32 s20, s56
    s_mov_b32 s21, s57
    s_mov_b32 s22, 0x500
    s_mov_b32 s23, 0x20000
    buffer_load_dwordx4 v[56:59], v11, s[16:19], 0 offen offset:0
    buffer_load_dwordx4 v[60:63], v11, s[16:19], 0 offen offset:128
    buffer_load_dwordx4 v[64:67], v11, s[16:19], 0 offen offset:256
    buffer_load_dwordx4 v[68:71], v11, s[16:19], 0 offen offset:384
    buffer_load_dwordx4 v[72:75], v11, s[16:19], 0 offen offset:512
    buffer_load_dwordx4 v[76:79], v11, s[16:19], 0 offen offset:640
    buffer_load_dwordx4 v[80:83], v11, s[16:19], 0 offen offset:768
    buffer_load_dwordx4 v[84:87], v11, s[16:19], 0 offen offset:896
    buffer_load_dwordx4 v[88:91], v11, s[16:19], 0 offen offset:1024
    buffer_load_dwordx4 v[92:95], v11, s[16:19], 0 offen offset:1152
    buffer_load_dwordx4 v[96:99], v11, s[20:23], 0 offen offset:0
    buffer_load_dwordx4 v[100:103], v11, s[20:23], 0 offen offset:128
    buffer_load_dwordx4 v[104:107], v11, s[20:23], 0 offen offset:256
    buffer_load_dwordx4 v[108:111], v11, s[20:23], 0 offen offset:384
    buffer_load_dwordx4 v[112:115], v11, s[20:23], 0 offen offset:512
    buffer_load_dwordx4 v[116:119], v11, s[20:23], 0 offen offset:640
    buffer_load_dwordx4 v[120:123], v11, s[20:23], 0 offen offset:768
    buffer_load_dwordx4 v[124:127], v11, s[20:23], 0 offen offset:896
    buffer_load_dwordx4 v[128:131], v11, s[20:23], 0 offen offset:1024
    buffer_load_dwordx4 v[132:135], v11, s[20:23], 0 offen offset:1152
    s_barrier
    v_mov_b32 v180, 0
    v_mov_b32 v181, 0
    v_mov_b32 v182, 0
    v_mov_b32 v183, 0
    v_and_b32 v10, 31, v9
    v_lshlrev_b32 v10, 2, v10
    v_add_u32 v10, 122880, v10
    v_sub_u32 v4, 0x87ff, v9
    s_setprio 2
    s_waitcnt vmcnt(10)
    v_dot2c_f32_bf16 v180, v16, v56
    v_dot2c_f32_bf16 v181, v17, v57
    v_dot2c_f32_bf16 v180, v18, v58
    v_dot2c_f32_bf16 v181, v19, v59
    v_dot2c_f32_bf16 v180, v20, v60
    v_dot2c_f32_bf16 v181, v21, v61
    v_dot2c_f32_bf16 v180, v22, v62
    v_dot2c_f32_bf16 v181, v23, v63
    v_dot2c_f32_bf16 v180, v24, v64
    v_dot2c_f32_bf16 v181, v25, v65
    v_dot2c_f32_bf16 v180, v26, v66
    v_dot2c_f32_bf16 v181, v27, v67
    v_dot2c_f32_bf16 v180, v28, v68
    v_dot2c_f32_bf16 v181, v29, v69
    v_dot2c_f32_bf16 v180, v30, v70
    v_dot2c_f32_bf16 v181, v31, v71
    v_dot2c_f32_bf16 v180, v32, v72
    v_dot2c_f32_bf16 v181, v33, v73
    v_dot2c_f32_bf16 v180, v34, v74
    v_dot2c_f32_bf16 v181, v35, v75
    v_dot2c_f32_bf16 v180, v36, v76
    v_dot2c_f32_bf16 v181, v37, v77
    v_dot2c_f32_bf16 v180, v38, v78
    v_dot2c_f32_bf16 v181, v39, v79
    v_dot2c_f32_bf16 v180, v40, v80
    v_dot2c_f32_bf16 v181, v41, v81
    v_dot2c_f32_bf16 v180, v42, v82
    v_dot2c_f32_bf16 v181, v43, v83
    v_dot2c_f32_bf16 v180, v44, v84
    v_dot2c_f32_bf16 v181, v45, v85
    v_dot2c_f32_bf16 v180, v46, v86
    v_dot2c_f32_bf16 v181, v47, v87
    v_dot2c_f32_bf16 v180, v48, v88
    v_dot2c_f32_bf16 v181, v49, v89
    v_dot2c_f32_bf16 v180, v50, v90
    v_dot2c_f32_bf16 v181, v51, v91
    v_dot2c_f32_bf16 v180, v52, v92
    v_dot2c_f32_bf16 v181, v53, v93
    v_dot2c_f32_bf16 v180, v54, v94
    v_dot2c_f32_bf16 v181, v55, v95
    s_waitcnt vmcnt(0)
    v_dot2c_f32_bf16 v182, v16, v96
    v_dot2c_f32_bf16 v183, v17, v97
    v_dot2c_f32_bf16 v182, v18, v98
    v_dot2c_f32_bf16 v183, v19, v99
    v_dot2c_f32_bf16 v182, v20, v100
    v_dot2c_f32_bf16 v183, v21, v101
    v_dot2c_f32_bf16 v182, v22, v102
    v_dot2c_f32_bf16 v183, v23, v103
    v_dot2c_f32_bf16 v182, v24, v104
    v_dot2c_f32_bf16 v183, v25, v105
    v_dot2c_f32_bf16 v182, v26, v106
    v_dot2c_f32_bf16 v183, v27, v107
    v_dot2c_f32_bf16 v182, v28, v108
    v_dot2c_f32_bf16 v183, v29, v109
    v_dot2c_f32_bf16 v182, v30, v110
    v_dot2c_f32_bf16 v183, v31, v111
    v_dot2c_f32_bf16 v182, v32, v112
    v_dot2c_f32_bf16 v183, v33, v113
    v_dot2c_f32_bf16 v182, v34, v114
    v_dot2c_f32_bf16 v183, v35, v115
    v_dot2c_f32_bf16 v182, v36, v116
    v_dot2c_f32_bf16 v183, v37, v117
    v_dot2c_f32_bf16 v182, v38, v118
    v_dot2c_f32_bf16 v183, v39, v119
    v_dot2c_f32_bf16 v182, v40, v120
    v_dot2c_f32_bf16 v183, v41, v121
    v_dot2c_f32_bf16 v182, v42, v122
    v_dot2c_f32_bf16 v183, v43, v123
    v_dot2c_f32_bf16 v182, v44, v124
    v_dot2c_f32_bf16 v183, v45, v125
    v_dot2c_f32_bf16 v182, v46, v126
    v_dot2c_f32_bf16 v183, v47, v127
    v_dot2c_f32_bf16 v182, v48, v128
    v_dot2c_f32_bf16 v183, v49, v129
    v_dot2c_f32_bf16 v182, v50, v130
    v_dot2c_f32_bf16 v183, v51, v131
    v_dot2c_f32_bf16 v182, v52, v132
    v_dot2c_f32_bf16 v183, v53, v133
    v_dot2c_f32_bf16 v182, v54, v134
    v_dot2c_f32_bf16 v183, v55, v135
    s_nop 2
    v_add_f32 v180, v180, v181
    v_add_f32 v182, v182, v183
    s_nop 0
    v_add_f32_dpp v180, v180, v180 quad_perm:[1,0,3,2] row_mask:0xf bank_mask:0xf
    v_add_f32_dpp v182, v182, v182 quad_perm:[1,0,3,2] row_mask:0xf bank_mask:0xf
    s_nop 0
    v_add_f32_dpp v180, v180, v180 quad_perm:[2,3,0,1] row_mask:0xf bank_mask:0xf
    v_add_f32_dpp v182, v182, v182 quad_perm:[2,3,0,1] row_mask:0xf bank_mask:0xf
    s_nop 0
    v_add_f32_dpp v180, v180, v180 row_half_mirror row_mask:0xf bank_mask:0xf
    v_add_f32_dpp v182, v182, v182 row_half_mirror row_mask:0xf bank_mask:0xf
    v_cvt_pk_bf16_f32 v2, v180, v180
    v_lshlrev_b32 v2, 16, v2
    v_ashrrev_i32 v3, 31, v2
    v_or_b32 v3, 0x80000000, v3
    v_xor_b32 v2, v2, v3
    v_and_b32 v2, 0xffff0000, v2
    v_or_b32 v2, v2, v4
    ds_write2_b32 v10, v2, v182 offset0:0 offset1:32
    s_mov_b64 exec, 1
    ds_add_u32 v12, v13 offset:36
    s_mov_b64 exec, -1
    s_setprio 0
    s_cmp_lg_u32 s30, 4
    s_cbranch_scc1 K_WARMA0
    s_call_b64 s[38:39], WP_p2g
    s_branch K_WARMAX
K_WARMA0:
    s_cmp_lg_u32 s30, 5
    s_cbranch_scc1 K_WARMA1
    s_call_b64 s[38:39], WP_gen
    s_branch K_WARMAX
K_WARMA1:
    s_cmp_lg_u32 s30, 6
    s_cbranch_scc1 K_WARMA2
    s_call_b64 s[38:39], WP_help
    s_call_b64 s[38:39], WP_flags
    s_branch K_WARMAX
K_WARMA2:
    s_call_b64 s[38:39], WP_spin
K_WARMAX:
    s_cmp_ge_u32 s30, 6
    s_cselect_b32 s44, 63, s44
    s_cmp_lg_u32 s44, 63
    s_cbranch_scc1 K_FFN_C
    s_mov_b32 s3, 1048576
K_FGH:
    ds_read_b32 v2, v12 offset:48
    s_sleep 8
    s_sub_u32 s3, s3, 1
    s_waitcnt lgkmcnt(0)
    v_readfirstlane_b32 s33, v2
    s_nop 3
    s_cselect_b32 s33, 1, s33
    s_cmp_lt_u32 s33, 1
    s_cbranch_scc1 K_FGH
    s_cmp_eq_u32 s30, 6
    s_cbranch_scc1 K_P2_HELP
    v_mov_b32 v7, 1
    s_branch K_P2_HELP
K_AUX_LO:
    s_waitcnt lgkmcnt(0)
    s_cmp_eq_u32 s30, 0
    s_cbranch_scc1 K_AUX_PUB
    s_cmp_eq_u32 s44, 63
    s_cbranch_scc1 K_AUX_NOF
    s_and_b32 s3, s44, 1
    s_cmp_eq_u32 s3, 0
    s_cselect_b64 s[60:61], s[50:51], s[52:53]
    s_cselect_b64 s[64:65], s[52:53], s[50:51]
    s_cselect_b32 s75, 0, 40960
    s_mov_b32 s62, 0x21c000
    s_mov_b32 s63, 0x20000
    s_mov_b32 s66, 0x21c000
    s_mov_b32 s67, 0x20000
    v_lshrrev_b32 v2, 2, v1
    v_mul_u32_u24 v184, 3456, v2
    v_and_b32 v2, 3, v1
    v_lshl_add_u32 v184, v2, 4, v184
    s_lshl_b32 s72, s44, 6
    v_add_u32 v184, s72, v184
    s_sub_u32 s74, s30, 1
K_FSA0:
    s_lshl_b32 s73, s74, 10
    s_mul_i32 s72, s74, 55296
    s_add_u32 m0, s73, s75
    s_waitcnt vmcnt(7)
    buffer_load_dwordx4 v184, s[60:63], s72 offen lds
    s_add_u32 s74, s74, 3
    s_cmp_lt_u32 s74, 24
    s_cbranch_scc1 K_FSA0
    s_barrier
    s_mov_b32 s3, 1048576
K_FGPB:
    ds_read_b32 v2, v12 offset:36
    s_sleep 1
    s_sub_u32 s3, s3, 1
    s_waitcnt lgkmcnt(0)
    v_readfirstlane_b32 s33, v2
    s_nop 3
    s_cselect_b32 s33, 5, s33
    s_cmp_lt_u32 s33, 5
    s_cbranch_scc1 K_FGPB
K_FSA:
    s_lshl_b32 s73, s74, 10
    s_mul_i32 s72, s74, 55296
    s_add_u32 m0, s73, s75
    s_waitcnt vmcnt(7)
    buffer_load_dwordx4 v184, s[60:63], s72 offen lds
    s_add_u32 s74, s74, 3
    s_cmp_lt_u32 s74, 40
    s_cbranch_scc1 K_FSA
    s_sub_u32 s74, s74, 40
    s_xor_b32 s75, s75, 40960
    s_mov_b32 s68, s54
    s_mov_b32 s69, s55
    s_mov_b32 s70, 0x21c000
    s_mov_b32 s71, 0x20000
    s_mul_i32 s3, s44, 40960
    v_lshrrev_b32 v2, 3, v1
    v_mul_u32_u24 v2, 1280, v2
    v_lshrrev_b32 v3, 4, v1
    v_lshlrev_b32 v3, 1, v3
    v_and_b32 v4, 7, v1
    v_xor_b32 v3, v3, v4
    v_lshl_add_u32 v2, v3, 4, v2
    v_add_u32 v185, s3, v2
K_FSB:
    s_lshl_b32 s73, s74, 10
    s_mul_i32 s72, s74, 55296
    s_add_u32 m0, s73, s75
    s_waitcnt vmcnt(7)
    buffer_load_dwordx4 v184, s[64:67], s72 offen lds
    s_add_u32 s74, s74, 3
    s_cmp_lt_u32 s74, 40
    s_cbranch_scc1 K_FSB
    s_sub_u32 s74, s74, 40
    s_mov_b32 s75, 81920
K_FSD0:
    s_lshl_b32 s73, s74, 10
    s_and_b32 s72, s74, 3
    s_mul_i32 s72, s72, 10208
    s_lshl_b32 s3, s74, 5
    s_add_u32 s72, s72, s3
    s_add_u32 m0, s73, s75
    s_waitcnt vmcnt(7)
    buffer_load_dwordx4 v185, s[68:71], s72 offen lds
    s_add_u32 s74, s74, 3
    s_cmp_lt_u32 s74, 24
    s_cbranch_scc1 K_FSD0
    s_waitcnt vmcnt(8)
    s_mov_b64 exec, 1
    ds_add_u32 v12, v13 offset:56
    s_mov_b64 exec, -1
K_FSD:
    s_lshl_b32 s73, s74, 10
    s_and_b32 s72, s74, 3
    s_mul_i32 s72, s72, 10208
    s_lshl_b32 s3, s74, 5
    s_add_u32 s72, s72, s3
    s_add_u32 m0, s73, s75
    s_waitcnt vmcnt(7)
    buffer_load_dwordx4 v185, s[68:71], s72 offen lds
    s_add_u32 s74, s74, 3
    s_cmp_lt_u32 s74, 40
    s_cbranch_scc1 K_FSD
    s_mul_i32 s3, s29, 96
    s_lshl_b32 s72, s30, 5
    s_add_u32 s3, s3, s72
    s_sub_u32 s3, s3, 128
    v_lshrrev_b32 v2, 1, v1
    v_add_u32 v2, s3, v2
    v_mul_u32_u24 v2, 1280, v2
    v_and_b32 v3, 1, v1
    v_lshl_add_u32 v2, v3, 7, v2
    buffer_load_dword v6, v2, s[24:27], 0 offen offset:1024
K_AUX_WR:
    s_mov_b32 s3, 1048576
K_FGR:
    ds_read_b32 v2, v12 offset:60
    s_sleep 2
    s_sub_u32 s3, s3, 1
    s_waitcnt lgkmcnt(0)
    v_readfirstlane_b32 s33, v2
    s_nop 3
    s_cselect_b32 s33, 2, s33
    s_cmp_lt_u32 s33, 2
    s_cbranch_scc1 K_FGR
    s_branch K_P2
K_AUX_NOF:
    s_cmp_lg_u32 s2, 63
    s_cbranch_scc1 K_AUX_NOZ
    s_cmp_lg_u32 s30, 1
    s_cbranch_scc1 K_AUX_NOZ
    s_add_u32 s60, s10, 0x80000
    s_addc_u32 s61, s11, 0
    s_mov_b32 s62, 0xc000
    s_mov_b32 s63, 0x20000
    v_mov_b32 v9, 786432
    global_load_dword v10, v9, s[10:11] sc1
    v_lshlrev_b32 v11, 4, v1
    v_add_u32 v11, 790528, v11
    global_load_dword v6, v11, s[10:11] sc1
    s_barrier
    s_mov_b32 s3, 1048576
K_FGZ:
    ds_read_b32 v2, v12 offset:36
    s_sleep 2
    s_sub_u32 s3, s3, 1
    s_waitcnt lgkmcnt(0)
    v_readfirstlane_b32 s33, v2
    s_nop 3
    s_cselect_b32 s33, 4, s33
    s_cmp_lt_u32 s33, 4
    s_cbranch_scc1 K_FGZ
    v_and_b32 v4, 7, v1
    v_lshlrev_b32 v4, 2, v4
    global_load_dword v7, v4, s[8:9] offset:192 sc1
    s_waitcnt vmcnt(1)
    v_add_u32 v10, 1, v10
    s_mov_b32 s3, 131072
    s_setprio 3
K_AG2_POLL:
    global_load_dwordx4 v[16:19], v11, s[10:11] sc1
    s_waitcnt vmcnt(0)
    v_xor_b32 v2, v10, v17
    v_xor_b32 v3, v10, v19
    v_or_b32 v2, v2, v3
    v_cmp_ne_u32 vcc, 0, v2
    s_cbranch_vccz K_AG2_GOT
    s_sleep 2
    s_sub_u32 s3, s3, 1
    s_cmp_lg_u32 s3, 0
    s_cbranch_scc1 K_AG2_POLL
K_AG2_GOT:
    s_nop 1
    v_max_u32_dpp v3, v16, v16 quad_perm:[1,0,3,2] row_mask:0xf bank_mask:0xf
    s_nop 1
    v_max_u32_dpp v3, v3, v3 quad_perm:[2,3,0,1] row_mask:0xf bank_mask:0xf
    s_nop 1
    v_max_u32_dpp v3, v3, v3 row_half_mirror row_mask:0xf bank_mask:0xf
    s_nop 1
    v_max_u32_dpp v3, v3, v3 row_mirror row_mask:0xf bank_mask:0xf
    s_nop 1
    v_readlane_b32 s74, v3, 0
    v_readlane_b32 s76, v3, 16
    v_readlane_b32 s77, v3, 32
    v_readlane_b32 s78, v3, 48
    s_nop 3
    s_max_u32 s74, s74, s76
    s_max_u32 s77, s77, s78
    s_max_u32 s74, s74, s77
    v_cmp_ne_u32 vcc, s74, v16
    s_nop 1
    v_cndmask_b32 v2, v18, v16, vcc
    s_nop 1
    v_max_u32_dpp v3, v2, v2 quad_perm:[1,0,3,2] row_mask:0xf bank_mask:0xf
    s_nop 1
    v_max_u32_dpp v3, v3, v3 quad_perm:[2,3,0,1] row_mask:0xf bank_mask:0xf
    s_nop 1
    v_max_u32_dpp v3, v3, v3 row_half_mirror row_mask:0xf bank_mask:0xf
    s_nop 1
    v_max_u32_dpp v3, v3, v3 row_mirror row_mask:0xf bank_mask:0xf
    s_nop 1
    v_readlane_b32 s75, v3, 0
    v_readlane_b32 s76, v3, 16
    v_readlane_b32 s77, v3, 32
    v_readlane_b32 s78, v3, 48
    s_nop 3
    s_max_u32 s75, s75, s76
    s_max_u32 s77, s77, s78
    s_max_u32 s75, s75, s77
    v_mov_b32 v176, s74
    v_mov_b32 v177, s75
    v_and_b32 v4, 7, v1
    v_lshlrev_b32 v4, 2, v4
    s_mov_b32 s3, 131072
K_ZPOLL4:
    v_cmp_eq_u32 vcc, 0, v7
    s_cbranch_vccz K_ZOK4
    s_sub_u32 s3, s3, 1
    s_cbranch_scc1 K_ZOK4
    global_load_dword v7, v4, s[8:9] offset:192 sc1
    s_waitcnt vmcnt(0)
    s_branch K_ZPOLL4
K_ZOK4:
    v_and_b32 v2, 7, v1
    v_mul_u32_u24 v2, 20, v2
    v_lshrrev_b32 v3, 3, v1
    v_add_lshl_u32 v2, v2, v3, 8
    buffer_store_dwordx2 v[176:177], v2, s[60:63], 0 offen offset:136 sc1
    s_mov_b64 exec, 1
    global_store_dword v9, v10, s[10:11] sc1
    s_mov_b64 exec, -1
    v_lshlrev_b32 v4, 2, v1
    s_mov_b32 s72, 43008
    s_mov_b32 s3, 131072
K_AGG_POLL:
    s_sleep 8
    buffer_load_dword v2, v4, s[60:63], s72 offen sc1
    s_waitcnt vmcnt(0)
    v_cmp_eq_u32 vcc, 0, v2
    s_cbranch_vccz K_AGG_GOT
    s_sub_u32 s3, s3, 1
    s_cmp_lg_u32 s3, 0
    s_cbranch_scc1 K_AGG_POLL
K_AGG_GOT:
    s_mov_b32 s62, 40960
    v_lshlrev_b32 v3, 8, v1
    s_mov_b32 s3, 0
    buffer_store_dwordx2 v[176:177], v3, s[60:63], s3 offen offset:128 sc1
    s_mov_b32 s3, 16384
    buffer_store_dwordx2 v[176:177], v3, s[60:63], s3 offen offset:128 sc1
    s_mov_b32 s3, 32768
    buffer_store_dwordx2 v[176:177], v3, s[60:63], s3 offen offset:128 sc1
    s_setprio 0
    s_branch K_AUX_NOK
K_AUX_NOZ:
    s_barrier
K_AUX_NOK:
    s_mov_b32 s3, 1048576
K_FGWD:
    ds_read_b32 v2, v12 offset:48
    s_sleep 4
    s_sub_u32 s3, s3, 1
    s_waitcnt lgkmcnt(0)
    v_readfirstlane_b32 s33, v2
    s_nop 3
    s_cselect_b32 s33, 1, s33
    s_cmp_lt_u32 s33, 1
    s_cbranch_scc1 K_FGWD
    s_branch K_P2
K_AUX_PUB:
    s_add_u32 s60, s10, 0x1000
    s_addc_u32 s61, s11, 0
    s_mov_b32 s62, 0x2000
    s_mov_b32 s63, 0x20000
    v_and_b32 v3, 31, v1
    v_lshlrev_b32 v10, 2, v3
    v_add_u32 v11, 122880, v10
    s_lshl_b32 s72, s74, 2
    v_mov_b32 v2, 786432
    global_load_dword v17, v2, s[10:11] sc1
    s_lshl_b32 s3, s2, 2
    s_add_u32 s3, s3, 567296
    v_mov_b32 v9, s3
    s_lshl_b32 s3, s2, 4
    s_add_u32 s3, s3, 790528
    v_lshl_add_u32 v20, v1, 4, s3
    v_and_b32 v5, 7, v1
    v_lshlrev_b32 v5, 2, v5
    s_barrier
    s_setprio 3
    s_waitcnt vmcnt(0)
    v_add_u32 v17, 1, v17
    v_mov_b32 v19, v17
    s_mov_b32 s3, 1048576
K_FGRT:
    ds_read_b32 v2, v12 offset:36
    s_sleep 0
    s_sub_u32 s3, s3, 1
    s_waitcnt lgkmcnt(0)
    v_readfirstlane_b32 s33, v2
    s_nop 3
    s_cselect_b32 s33, 4, s33
    s_cmp_lt_u32 s33, 4
    s_cbranch_scc1 K_FGRT
    ds_read2_b32 v[176:177], v11 offset0:0 offset1:32
    s_waitcnt lgkmcnt(0)
    s_nop 1
    v_max_u32_dpp v3, v176, v176 quad_perm:[1,0,3,2] row_mask:0xf bank_mask:0xf
    s_nop 1
    v_max_u32_dpp v3, v3, v3 quad_perm:[2,3,0,1] row_mask:0xf bank_mask:0xf
    s_nop 1
    v_max_u32_dpp v3, v3, v3 row_half_mirror row_mask:0xf bank_mask:0xf
    s_nop 1
    v_max_u32_dpp v3, v3, v3 row_mirror row_mask:0xf bank_mask:0xf
    s_nop 1
    v_readlane_b32 s74, v3, 0
    v_readlane_b32 s76, v3, 16
    v_readlane_b32 s77, v3, 32
    v_readlane_b32 s78, v3, 48
    s_nop 3
    s_max_u32 s74, s74, s76
    s_max_u32 s77, s77, s78
    s_max_u32 s74, s74, s77
    v_cmp_ne_u32 vcc, s74, v176
    s_nop 1
    v_cndmask_b32 v176, 0, v176, vcc
    s_nop 1
    v_max_u32_dpp v3, v176, v176 quad_perm:[1,0,3,2] row_mask:0xf bank_mask:0xf
    s_nop 1
    v_max_u32_dpp v3, v3, v3 quad_perm:[2,3,0,1] row_mask:0xf bank_mask:0xf
    s_nop 1
    v_max_u32_dpp v3, v3, v3 row_half_mirror row_mask:0xf bank_mask:0xf
    s_nop 1
    v_max_u32_dpp v3, v3, v3 row_mirror row_mask:0xf bank_mask:0xf
    s_nop 1
    v_readlane_b32 s75, v3, 0
    v_readlane_b32 s76, v3, 16
    v_readlane_b32 s77, v3, 32
    v_readlane_b32 s78, v3, 48
    s_nop 3
    s_max_u32 s75, s75, s76
    s_max_u32 s77, s77, s78
    s_max_u32 s75, s75, s77
    v_mov_b32 v16, s74
    v_mov_b32 v18, s75
    s_mov_b64 exec, 1
    global_store_dwordx4 v20, v[16:19], s[10:11] sc1
    s_mov_b64 exec, -1
    s_mov_b64 exec, 1
    ds_add_u32 v12, v13 offset:36
    s_mov_b64 exec, -1
    global_load_dword v7, v5, s[8:9] offset:192 sc1
    v_cvt_pk_bf16_f32 v177, v177, v177
    v_lshlrev_b32 v177, 16, v177
    v_mul_f32 v3, 0xbfb8aa3b, v177
    v_exp_f32 v3, v3
    s_nop 0
    v_add_f32 v3, 1.0, v3
    v_rcp_f32 v177, v3
    s_nop 0
    v_cvt_pk_bf16_f32 v177, v177, v177
    v_lshlrev_b32 v177, 16, v177
    s_mov_b32 exec_hi, 0
    buffer_store_dword v177, v10, s[60:63], s72 offen sc1
    s_mov_b64 exec, -1
    s_waitcnt vmcnt(0)
    v_and_b32 v4, 7, v1
    v_lshlrev_b32 v4, 2, v4
    s_mov_b32 s3, 131072
K_ZPOLL3:
    v_cmp_eq_u32 vcc, 0, v7
    s_cbranch_vccz K_ZOK3
    s_sub_u32 s3, s3, 1
    s_cbranch_scc1 K_ZOK3
    global_load_dword v7, v4, s[8:9] offset:192 sc1
    s_waitcnt vmcnt(0)
    s_branch K_ZPOLL3
K_ZOK3:
    s_mov_b64 exec, 1
    global_store_dword v9, v13, s[10:11] sc1
    s_mov_b64 exec, -1
    v_and_b32 v3, 1, v1
    v_lshl_add_u32 v3, v3, 2, s42
    v_lshlrev_b32 v10, 4, v1
    s_mov_b32 s3, 131072
K_AUX_POLL:
    s_sleep 6
    global_load_dword v2, v3, s[10:11] offset:136 sc1
    s_waitcnt vmcnt(0)
    v_cmp_eq_u32 vcc, 0, v2
    s_cbranch_vccz K_AUX_GOT
    s_sub_u32 s3, s3, 1
    s_cmp_lg_u32 s3, 0
    s_cbranch_scc1 K_AUX_POLL
K_AUX_GOT:
    v_readlane_b32 s74, v2, 0
    v_readlane_b32 s75, v2, 1
    s_nop 3
    s_and_b32 s74, s74, 0x7ff
    s_sub_u32 s74, 2047, s74
    s_mul_i32 s74, s74, 1280
    s_mov_b32 m0, 125184
    s_nop 0
    buffer_load_dwordx4 v10, s[12:15], s74 offen lds
    s_mov_b64 exec, 0xffff
    buffer_load_dwordx4 v10, s[12:15], s74 offen offset:1024 lds
    s_mov_b64 exec, -1
    s_and_b32 s75, s75, 0x7ff
    s_sub_u32 s75, 2047, s75
    s_mul_i32 s75, s75, 1280
    s_mov_b32 m0, 126528
    s_nop 0
    buffer_load_dwordx4 v10, s[12:15], s75 offen lds
    s_mov_b64 exec, 0xffff
    buffer_load_dwordx4 v10, s[12:15], s75 offen offset:1024 lds
    s_mov_b64 exec, -1
    s_waitcnt vmcnt(0)
    ds_write_b32 v12, v13 offset:48
    s_setprio 0
    s_branch K_P2
.p2align 12
K_FFN_C:
    s_add_u32 s64, s10, 0x10000
    s_addc_u32 s65, s11, 0
    s_mov_b32 s66, 0x43800
    s_mov_b32 s67, 0x20000
    s_and_b32 s73, s30, 1
    v_lshrrev_b32 v232, 4, v1
    v_bfe_u32 v4, v1, 2, 2
    v_lshl_add_u32 v2, v232, 3, v4
    v_and_b32 v3, 3, v1
    v_lshlrev_b32 v3, 3, v3
    v_lshl_add_u32 v233, v2, 6, v3
    s_lshl_b32 s72, s73, 5
    v_add_u32 v233, s72, v233
    v_lshl_add_u32 v2, v232, 2, v4
    v_bfe_u32 v4, v2, 1, 2
    v_lshl_add_u32 v3, v2, 7, v3
    v_lshl_add_u32 v3, v4, 5, v3
    s_mul_i32 s3, s73, 20480
    s_add_u32 s3, s3, 81920
    v_add_u32 v238, s3, v3
    v_xor_b32 v239, 32, v238
    v_xor_b32 v240, 64, v238
    v_xor_b32 v241, 96, v238
    v_and_b32 v2, 1, v1
    v_mul_u32_u24 v234, 1344, v2
    v_lshl_add_u32 v234, v232, 4, v234
    v_add_u32 v234, 125184, v234
    v_lshlrev_b32 v236, 4, v1
    v_add_u32 v236, 124160, v236
    s_lshl_b32 s3, s73, 3
    v_add_u32 v235, s3, v236
    v_lshlrev_b32 v237, 2, v1
    s_mul_i32 s3, s44, 5120
    s_mul_i32 s72, s73, 1280
    s_add_u32 s72, s72, s3
    v_lshlrev_b32 v2, 4, v1
    buffer_store_dwordx4 v[16:19], v2, s[64:67], s72 offen offset:0 sc1
    buffer_store_dwordx4 v[16:19], v2, s[64:67], s72 offen offset:2560 sc1
    s_mov_b64 exec, 0xffff
    buffer_store_dwordx4 v[16:19], v2, s[64:67], s72 offen offset:1024 sc1
    buffer_store_dwordx4 v[16:19], v2, s[64:67], s72 offen offset:3584 sc1
    s_mov_b64 exec, -1
    v_add_u32 v5, 40960, v233
    s_mov_b32 s3, 1048576
K_FGD:
    ds_read_b32 v2, v12 offset:56
    s_sleep 2
    s_sub_u32 s3, s3, 1
    s_waitcnt lgkmcnt(0)
    v_readfirstlane_b32 s33, v2
    s_nop 3
    s_cselect_b32 s33, 3, s33
    s_cmp_lt_u32 s33, 3
    s_cbranch_scc1 K_FGD
    s_setprio 3
    ds_read_b64_tr_b16 v[16:17], v233 offset:0
    ds_read_b64_tr_b16 v[18:19], v233 offset:256
    ds_read_b64_tr_b16 v[20:21], v233 offset:2048
    ds_read_b64_tr_b16 v[22:23], v233 offset:2304
    ds_read_b64_tr_b16 v[24:25], v233 offset:4096
    ds_read_b64_tr_b16 v[26:27], v233 offset:4352
    ds_read_b64_tr_b16 v[28:29], v233 offset:6144
    ds_read_b64_tr_b16 v[30:31], v233 offset:6400
    ds_read_b64_tr_b16 v[32:33], v233 offset:8192
    ds_read_b64_tr_b16 v[34:35], v233 offset:8448
    ds_read_b64_tr_b16 v[36:37], v233 offset:10240
    ds_read_b64_tr_b16 v[38:39], v233 offset:10496
    ds_read_b64_tr_b16 v[40:41], v233 offset:12288
    ds_read_b64_tr_b16 v[42:43], v233 offset:12544
    ds_read_b64_tr_b16 v[44:45], v233 offset:14336
    ds_read_b64_tr_b16 v[46:47], v233 offset:14592
    ds_read_b64_tr_b16 v[48:49], v233 offset:16384
    ds_read_b64_tr_b16 v[50:51], v233 offset:16640
    ds_read_b64_tr_b16 v[52:53], v233 offset:18432
    ds_read_b64_tr_b16 v[54:55], v233 offset:18688
    ds_read_b64_tr_b16 v[56:57], v233 offset:20480
    ds_read_b64_tr_b16 v[58:59], v233 offset:20736
    ds_read_b64_tr_b16 v[60:61], v233 offset:22528
    ds_read_b64_tr_b16 v[62:63], v233 offset:22784
    ds_read_b64_tr_b16 v[64:65], v233 offset:24576
    ds_read_b64_tr_b16 v[66:67], v233 offset:24832
    ds_read_b64_tr_b16 v[68:69], v233 offset:26624
    ds_read_b64_tr_b16 v[70:71], v233 offset:26880
    ds_read_b64_tr_b16 v[72:73], v233 offset:28672
    ds_read_b64_tr_b16 v[74:75], v233 offset:28928
    ds_read_b64_tr_b16 v[76:77], v233 offset:30720
    ds_read_b64_tr_b16 v[78:79], v233 offset:30976
    ds_read_b64_tr_b16 v[80:81], v233 offset:32768
    ds_read_b64_tr_b16 v[82:83], v233 offset:33024
    ds_read_b64_tr_b16 v[84:85], v233 offset:34816
    ds_read_b64_tr_b16 v[86:87], v233 offset:35072
    ds_read_b64_tr_b16 v[88:89], v233 offset:36864
    ds_read_b64_tr_b16 v[90:91], v233 offset:37120
    ds_read_b64_tr_b16 v[92:93], v233 offset:38912
    ds_read_b64_tr_b16 v[94:95], v233 offset:39168
    ds_read_b64_tr_b16 v[96:97], v5 offset:0
    ds_read_b64_tr_b16 v[98:99], v5 offset:256
    ds_read_b64_tr_b16 v[100:101], v5 offset:2048
    ds_read_b64_tr_b16 v[102:103], v5 offset:2304
    ds_read_b64_tr_b16 v[104:105], v5 offset:4096
    ds_read_b64_tr_b16 v[106:107], v5 offset:4352
    ds_read_b64_tr_b16 v[108:109], v5 offset:6144
    ds_read_b64_tr_b16 v[110:111], v5 offset:6400
    ds_read_b64_tr_b16 v[112:113], v5 offset:8192
    ds_read_b64_tr_b16 v[114:115], v5 offset:8448
    ds_read_b64_tr_b16 v[116:117], v5 offset:10240
    ds_read_b64_tr_b16 v[118:119], v5 offset:10496
    ds_read_b64_tr_b16 v[120:121], v5 offset:12288
    ds_read_b64_tr_b16 v[122:123], v5 offset:12544
    ds_read_b64_tr_b16 v[124:125], v5 offset:14336
    ds_read_b64_tr_b16 v[126:127], v5 offset:14592
    ds_read_b64_tr_b16 v[128:129], v5 offset:16384
    ds_read_b64_tr_b16 v[130:131], v5 offset:16640
    ds_read_b64_tr_b16 v[132:133], v5 offset:18432
    ds_read_b64_tr_b16 v[134:135], v5 offset:18688
    ds_read_b64_tr_b16 v[136:137], v5 offset:20480
    ds_read_b64_tr_b16 v[138:139], v5 offset:20736
    ds_read_b64_tr_b16 v[140:141], v5 offset:22528
    ds_read_b64_tr_b16 v[142:143], v5 offset:22784
    ds_read_b64_tr_b16 v[144:145], v5 offset:24576
    ds_read_b64_tr_b16 v[146:147], v5 offset:24832
    ds_read_b64_tr_b16 v[148:149], v5 offset:26624
    ds_read_b64_tr_b16 v[150:151], v5 offset:26880
    ds_read_b64_tr_b16 v[152:153], v5 offset:28672
    ds_read_b64_tr_b16 v[154:155], v5 offset:28928
    ds_read_b64_tr_b16 v[156:157], v5 offset:30720
    ds_read_b64_tr_b16 v[158:159], v5 offset:30976
    ds_read_b64_tr_b16 v[160:161], v5 offset:32768
    ds_read_b64_tr_b16 v[162:163], v5 offset:33024
    ds_read_b64_tr_b16 v[164:165], v5 offset:34816
    ds_read_b64_tr_b16 v[166:167], v5 offset:35072
    ds_read_b64_tr_b16 v[168:169], v5 offset:36864
    ds_read_b64_tr_b16 v[170:171], v5 offset:37120
    ds_read_b64_tr_b16 v[172:173], v5 offset:38912
    ds_read_b64_tr_b16 v[174:175], v5 offset:39168
    s_waitcnt vmcnt(0) lgkmcnt(0)
    s_mov_b64 exec, 1
    ds_add_u32 v12, v13 offset:60
    s_mov_b64 exec, -1
    s_mov_b32 s3, 1048576
K_FGK:
    ds_read_b32 v2, v12 offset:48
    s_sleep 1
    s_sub_u32 s3, s3, 1
    s_waitcnt lgkmcnt(0)
    v_readfirstlane_b32 s33, v2
    s_nop 3
    s_cselect_b32 s33, 1, s33
    s_cmp_lt_u32 s33, 1
    s_cbranch_scc1 K_FGK
    ds_read_b128 v[188:191], v234 offset:0
    ds_read_b128 v[192:195], v234 offset:64
    ds_read_b128 v[196:199], v234 offset:128
    ds_read_b128 v[200:203], v234 offset:192
    ds_read_b128 v[204:207], v234 offset:256
    ds_read_b128 v[208:211], v234 offset:320
    ds_read_b128 v[212:215], v234 offset:384
    ds_read_b128 v[216:219], v234 offset:448
    s_waitcnt lgkmcnt(7)
    v_mfma_f32_16x16x32_bf16 v[220:223], v[16:19], v[188:191], 0
    v_mfma_f32_16x16x32_bf16 v[224:227], v[96:99], v[188:191], 0
    ds_read_b128 v[188:191], v234 offset:512
    s_waitcnt lgkmcnt(7)
    v_mfma_f32_16x16x32_bf16 v[220:223], v[20:23], v[192:195], v[220:223]
    v_mfma_f32_16x16x32_bf16 v[224:227], v[100:103], v[192:195], v[224:227]
    ds_read_b128 v[192:195], v234 offset:576
    s_waitcnt lgkmcnt(7)
    v_mfma_f32_16x16x32_bf16 v[220:223], v[24:27], v[196:199], v[220:223]
    v_mfma_f32_16x16x32_bf16 v[224:227], v[104:107], v[196:199], v[224:227]
    ds_read_b128 v[196:199], v234 offset:640
    s_waitcnt lgkmcnt(7)
    v_mfma_f32_16x16x32_bf16 v[220:223], v[28:31], v[200:203], v[220:223]
    v_mfma_f32_16x16x32_bf16 v[224:227], v[108:111], v[200:203], v[224:227]
    ds_read_b128 v[200:203], v234 offset:704
    s_waitcnt lgkmcnt(7)
    v_mfma_f32_16x16x32_bf16 v[220:223], v[32:35], v[204:207], v[220:223]
    v_mfma_f32_16x16x32_bf16 v[224:227], v[112:115], v[204:207], v[224:227]
    ds_read_b128 v[204:207], v234 offset:768
    s_waitcnt lgkmcnt(7)
    v_mfma_f32_16x16x32_bf16 v[220:223], v[36:39], v[208:211], v[220:223]
    v_mfma_f32_16x16x32_bf16 v[224:227], v[116:119], v[208:211], v[224:227]
    ds_read_b128 v[208:211], v234 offset:832
    s_waitcnt lgkmcnt(7)
    v_mfma_f32_16x16x32_bf16 v[220:223], v[40:43], v[212:215], v[220:223]
    v_mfma_f32_16x16x32_bf16 v[224:227], v[120:123], v[212:215], v[224:227]
    ds_read_b128 v[212:215], v234 offset:896
    s_waitcnt lgkmcnt(7)
    v_mfma_f32_16x16x32_bf16 v[220:223], v[44:47], v[216:219], v[220:223]
    v_mfma_f32_16x16x32_bf16 v[224:227], v[124:127], v[216:219], v[224:227]
    ds_read_b128 v[216:219], v234 offset:960
    s_waitcnt lgkmcnt(7)
    v_mfma_f32_16x16x32_bf16 v[220:223], v[48:51], v[188:191], v[220:223]
    v_mfma_f32_16x16x32_bf16 v[224:227], v[128:131], v[188:191], v[224:227]
    ds_read_b128 v[188:191], v234 offset:1024
    s_waitcnt lgkmcnt(7)
    v_mfma_f32_16x16x32_bf16 v[220:223], v[52:55], v[192:195], v[220:223]
    v_mfma_f32_16x16x32_bf16 v[224:227], v[132:135], v[192:195], v[224:227]
    ds_read_b128 v[192:195], v234 offset:1088
    s_waitcnt lgkmcnt(7)
    v_mfma_f32_16x16x32_bf16 v[220:223], v[56:59], v[196:199], v[220:223]
    v_mfma_f32_16x16x32_bf16 v[224:227], v[136:139], v[196:199], v[224:227]
    ds_read_b128 v[196:199], v234 offset:1152
    s_waitcnt lgkmcnt(7)
    v_mfma_f32_16x16x32_bf16 v[220:223], v[60:63], v[200:203], v[220:223]
    v_mfma_f32_16x16x32_bf16 v[224:227], v[140:143], v[200:203], v[224:227]
    ds_read_b128 v[200:203], v234 offset:1216
    s_waitcnt lgkmcnt(7)
    v_mfma_f32_16x16x32_bf16 v[220:223], v[64:67], v[204:207], v[220:223]
    v_mfma_f32_16x16x32_bf16 v[224:227], v[144:147], v[204:207], v[224:227]
    s_waitcnt lgkmcnt(6)
    v_mfma_f32_16x16x32_bf16 v[220:223], v[68:71], v[208:211], v[220:223]
    v_mfma_f32_16x16x32_bf16 v[224:227], v[148:151], v[208:211], v[224:227]
    s_waitcnt lgkmcnt(5)
    v_mfma_f32_16x16x32_bf16 v[220:223], v[72:75], v[212:215], v[220:223]
    v_mfma_f32_16x16x32_bf16 v[224:227], v[152:155], v[212:215], v[224:227]
    s_waitcnt lgkmcnt(4)
    v_mfma_f32_16x16x32_bf16 v[220:223], v[76:79], v[216:219], v[220:223]
    v_mfma_f32_16x16x32_bf16 v[224:227], v[156:159], v[216:219], v[224:227]
    s_waitcnt lgkmcnt(3)
    v_mfma_f32_16x16x32_bf16 v[220:223], v[80:83], v[188:191], v[220:223]
    v_mfma_f32_16x16x32_bf16 v[224:227], v[160:163], v[188:191], v[224:227]
    s_waitcnt lgkmcnt(2)
    v_mfma_f32_16x16x32_bf16 v[220:223], v[84:87], v[192:195], v[220:223]
    v_mfma_f32_16x16x32_bf16 v[224:227], v[164:167], v[192:195], v[224:227]
    s_waitcnt lgkmcnt(1)
    v_mfma_f32_16x16x32_bf16 v[220:223], v[88:91], v[196:199], v[220:223]
    v_mfma_f32_16x16x32_bf16 v[224:227], v[168:171], v[196:199], v[224:227]
    s_waitcnt lgkmcnt(0)
    v_mfma_f32_16x16x32_bf16 v[220:223], v[92:95], v[200:203], v[220:223]
    v_mfma_f32_16x16x32_bf16 v[224:227], v[172:175], v[200:203], v[224:227]
    v_mov_b64 v[204:205], 0
    v_mov_b64 v[206:207], 0
    v_mov_b64 v[208:209], 0
    v_mov_b64 v[210:211], 0
    v_mov_b64 v[212:213], 0
    v_mov_b64 v[214:215], 0
    v_mov_b64 v[216:217], 0
    v_mov_b64 v[218:219], 0
    v_mov_b32 v5, 0x100
    v_cvt_pk_bf16_f32 v221, v220, v221
    v_lshlrev_b32 v220, 16, v221
    v_and_b32 v221, 0xffff0000, v221
    v_cvt_pk_bf16_f32 v223, v222, v223
    v_lshlrev_b32 v222, 16, v223
    v_and_b32 v223, 0xffff0000, v223
    v_cvt_pk_bf16_f32 v225, v224, v225
    v_lshlrev_b32 v224, 16, v225
    v_and_b32 v225, 0xffff0000, v225
    v_cvt_pk_bf16_f32 v227, v226, v227
    v_lshlrev_b32 v226, 16, v227
    v_and_b32 v227, 0xffff0000, v227
    v_mul_f32 v188, 0xbfb8aa3b, v220
    v_mul_f32 v189, 0xbfb8aa3b, v221
    v_mul_f32 v190, 0xbfb8aa3b, v222
    v_mul_f32 v191, 0xbfb8aa3b, v223
    v_exp_f32 v188, v188
    v_exp_f32 v189, v189
    v_exp_f32 v190, v190
    v_exp_f32 v191, v191
    v_add_f32 v188, 1.0, v188
    v_add_f32 v189, 1.0, v189
    v_add_f32 v190, 1.0, v190
    v_add_f32 v191, 1.0, v191
    v_rcp_f32 v188, v188
    v_rcp_f32 v189, v189
    v_rcp_f32 v190, v190
    v_rcp_f32 v191, v191
    v_mul_f32 v220, v220, v188
    v_mul_f32 v221, v221, v189
    v_mul_f32 v222, v222, v190
    v_mul_f32 v223, v223, v191
    v_cvt_pk_bf16_f32 v221, v220, v221
    v_lshlrev_b32 v220, 16, v221
    v_and_b32 v221, 0xffff0000, v221
    v_cvt_pk_bf16_f32 v223, v222, v223
    v_lshlrev_b32 v222, 16, v223
    v_and_b32 v223, 0xffff0000, v223
    v_mul_f32 v220, v220, v224
    v_mul_f32 v221, v221, v225
    v_mul_f32 v222, v222, v226
    v_mul_f32 v223, v223, v227
    v_cvt_pk_bf16_f32 v228, v220, v221
    v_cvt_pk_bf16_f32 v229, v222, v223
    ds_write_b64 v235, v[228:229]
    s_mov_b64 exec, 1
    ds_add_u32 v12, v5 offset:52
    s_mov_b64 exec, -1
    s_mov_b32 s3, 1048576
K_FGP:
    ds_read_b32 v2, v12 offset:52
    s_sleep 0
    s_sub_u32 s3, s3, 1
    s_waitcnt lgkmcnt(0)
    v_readfirstlane_b32 s33, v2
    s_nop 3
    s_cselect_b32 s33, 515, s33
    s_cmp_lt_u32 s33, 515
    s_cbranch_scc1 K_FGP
    s_mov_b32 exec_lo, 0xf000f
    s_mov_b32 exec_hi, 0xf000f
    ds_read_b128 v[204:207], v236
    s_mov_b32 exec_lo, 0xf000f0
    s_mov_b32 exec_hi, 0xf000f0
    ds_read_b128 v[208:211], v236
    s_mov_b32 exec_lo, 0xf000f00
    s_mov_b32 exec_hi, 0xf000f00
    ds_read_b128 v[212:215], v236
    s_mov_b32 exec_lo, 0xf000f000
    s_mov_b32 exec_hi, 0xf000f000
    ds_read_b128 v[216:219], v236
    s_mov_b64 exec, -1
    ds_read_b64_tr_b16 v[16:17], v238 offset:0
    ds_read_b64_tr_b16 v[18:19], v238 offset:2048
    ds_read_b64_tr_b16 v[20:21], v239 offset:0
    ds_read_b64_tr_b16 v[22:23], v239 offset:2048
    ds_read_b64_tr_b16 v[24:25], v240 offset:0
    ds_read_b64_tr_b16 v[26:27], v240 offset:2048
    ds_read_b64_tr_b16 v[28:29], v241 offset:0
    ds_read_b64_tr_b16 v[30:31], v241 offset:2048
    ds_read_b64_tr_b16 v[32:33], v238 offset:4096
    ds_read_b64_tr_b16 v[34:35], v238 offset:6144
    s_waitcnt lgkmcnt(8)
    v_mfma_f32_16x16x32_bf16 v[96:99], v[204:207], v[16:19], 0
    ds_read_b64_tr_b16 v[36:37], v239 offset:4096
    ds_read_b64_tr_b16 v[38:39], v239 offset:6144
    s_waitcnt lgkmcnt(8)
    v_mfma_f32_16x16x32_bf16 v[96:99], v[208:211], v[20:23], v[96:99]
    ds_read_b64_tr_b16 v[40:41], v240 offset:4096
    ds_read_b64_tr_b16 v[42:43], v240 offset:6144
    s_waitcnt lgkmcnt(8)
    v_mfma_f32_16x16x32_bf16 v[96:99], v[212:215], v[24:27], v[96:99]
    ds_read_b64_tr_b16 v[44:45], v241 offset:4096
    ds_read_b64_tr_b16 v[46:47], v241 offset:6144
    s_waitcnt lgkmcnt(8)
    v_mfma_f32_16x16x32_bf16 v[96:99], v[216:219], v[28:31], v[96:99]
    ds_read_b64_tr_b16 v[48:49], v238 offset:8192
    ds_read_b64_tr_b16 v[50:51], v238 offset:10240
    s_waitcnt lgkmcnt(8)
    v_mfma_f32_16x16x32_bf16 v[100:103], v[204:207], v[32:35], 0
    ds_read_b64_tr_b16 v[52:53], v239 offset:8192
    ds_read_b64_tr_b16 v[54:55], v239 offset:10240
    s_waitcnt lgkmcnt(8)
    v_mfma_f32_16x16x32_bf16 v[100:103], v[208:211], v[36:39], v[100:103]
    ds_read_b64_tr_b16 v[56:57], v240 offset:8192
    ds_read_b64_tr_b16 v[58:59], v240 offset:10240
    s_waitcnt lgkmcnt(8)
    v_mfma_f32_16x16x32_bf16 v[100:103], v[212:215], v[40:43], v[100:103]
    ds_read_b64_tr_b16 v[60:61], v241 offset:8192
    ds_read_b64_tr_b16 v[62:63], v241 offset:10240
    s_waitcnt lgkmcnt(8)
    v_mfma_f32_16x16x32_bf16 v[100:103], v[216:219], v[44:47], v[100:103]
    ds_read_b64_tr_b16 v[64:65], v238 offset:12288
    ds_read_b64_tr_b16 v[66:67], v238 offset:14336
    buffer_store_dword v96, v237, s[64:67], s72 offen offset:0 sc1
    buffer_store_dword v97, v237, s[64:67], s72 offen offset:2560 sc1
    s_waitcnt lgkmcnt(8)
    v_mfma_f32_16x16x32_bf16 v[104:107], v[204:207], v[48:51], 0
    ds_read_b64_tr_b16 v[68:69], v239 offset:12288
    ds_read_b64_tr_b16 v[70:71], v239 offset:14336
    s_waitcnt lgkmcnt(8)
    v_mfma_f32_16x16x32_bf16 v[104:107], v[208:211], v[52:55], v[104:107]
    ds_read_b64_tr_b16 v[72:73], v240 offset:12288
    ds_read_b64_tr_b16 v[74:75], v240 offset:14336
    s_waitcnt lgkmcnt(8)
    v_mfma_f32_16x16x32_bf16 v[104:107], v[212:215], v[56:59], v[104:107]
    ds_read_b64_tr_b16 v[76:77], v241 offset:12288
    ds_read_b64_tr_b16 v[78:79], v241 offset:14336
    s_waitcnt lgkmcnt(8)
    v_mfma_f32_16x16x32_bf16 v[104:107], v[216:219], v[60:63], v[104:107]
    ds_read_b64_tr_b16 v[80:81], v238 offset:16384
    ds_read_b64_tr_b16 v[82:83], v238 offset:18432
    buffer_store_dword v100, v237, s[64:67], s72 offen offset:256 sc1
    buffer_store_dword v101, v237, s[64:67], s72 offen offset:2816 sc1
    s_waitcnt lgkmcnt(8)
    v_mfma_f32_16x16x32_bf16 v[108:111], v[204:207], v[64:67], 0
    ds_read_b64_tr_b16 v[84:85], v239 offset:16384
    ds_read_b64_tr_b16 v[86:87], v239 offset:18432
    s_waitcnt lgkmcnt(8)
    v_mfma_f32_16x16x32_bf16 v[108:111], v[208:211], v[68:71], v[108:111]
    ds_read_b64_tr_b16 v[88:89], v240 offset:16384
    ds_read_b64_tr_b16 v[90:91], v240 offset:18432
    s_waitcnt lgkmcnt(8)
    v_mfma_f32_16x16x32_bf16 v[108:111], v[212:215], v[72:75], v[108:111]
    ds_read_b64_tr_b16 v[92:93], v241 offset:16384
    ds_read_b64_tr_b16 v[94:95], v241 offset:18432
    s_waitcnt lgkmcnt(8)
    v_mfma_f32_16x16x32_bf16 v[108:111], v[216:219], v[76:79], v[108:111]
    buffer_store_dword v104, v237, s[64:67], s72 offen offset:512 sc1
    buffer_store_dword v105, v237, s[64:67], s72 offen offset:3072 sc1
    s_waitcnt lgkmcnt(6)
    v_mfma_f32_16x16x32_bf16 v[112:115], v[204:207], v[80:83], 0
    s_waitcnt lgkmcnt(4)
    v_mfma_f32_16x16x32_bf16 v[112:115], v[208:211], v[84:87], v[112:115]
    s_waitcnt lgkmcnt(2)
    v_mfma_f32_16x16x32_bf16 v[112:115], v[212:215], v[88:91], v[112:115]
    s_waitcnt lgkmcnt(0)
    v_mfma_f32_16x16x32_bf16 v[112:115], v[216:219], v[92:95], v[112:115]
    buffer_store_dword v108, v237, s[64:67], s72 offen offset:768 sc1
    buffer_store_dword v109, v237, s[64:67], s72 offen offset:3328 sc1
    s_nop 5
    buffer_store_dword v112, v237, s[64:67], s72 offen offset:1024 sc1
    buffer_store_dword v113, v237, s[64:67], s72 offen offset:3584 sc1
    s_mul_i32 s3, s73, 2560
    s_lshl2_add_u32 s3, s44, s3
    s_add_u32 s3, s3, 568320
    v_lshl_add_u32 v2, v1, 8, s3
    s_mov_b64 exec, 0x3ff
    s_waitcnt vmcnt(0)
    global_store_dword v2, v13, s[10:11] sc1
    s_mov_b64 exec, -1
    s_branch K_P2_HELP
K_CODE_END:
.section .rodata,"a"
.p2align 6
.amdhsa_kernel gated_mix__sliding_local_dilated__moe_arch_mod__prompt_kernel
  .amdhsa_next_free_vgpr 248
  .amdhsa_next_free_sgpr 79
  .amdhsa_accum_offset 248
  .amdhsa_group_segment_fixed_size 0
  .amdhsa_kernarg_size 96
  .amdhsa_user_sgpr_count 2
  .amdhsa_user_sgpr_kernarg_segment_ptr 1
  .amdhsa_system_sgpr_workgroup_id_x 1
.end_amdhsa_kernel
```

```asm
; @launch grid=(256,1,1) block=(512,1,1) lds=163840
.amdgcn_target "amdgcn-amd-amdhsa--gfx950"
.text
.p2align 12
.p2align 8
.globl gated_mix__sliding_local_dilated__moe_arch_mod__prompt_kernel
.type gated_mix__sliding_local_dilated__moe_arch_mod__prompt_kernel,@function
gated_mix__sliding_local_dilated__moe_arch_mod__prompt_kernel:
    s_cmp_ge_u32 s2, 256
    s_cbranch_scc1 K_EXIT
    s_load_dwordx2 s[12:13], s[0:1], 0
    s_load_dwordx2 s[16:17], s[0:1], 8
    v_readfirstlane_b32 s30, v0
    s_load_dwordx4 s[8:11], s[0:1], 80
    s_load_dwordx2 s[24:25], s[0:1], 16
    s_load_dwordx2 s[6:7], s[0:1], 72
    s_and_b32 s28, s2, 7
    v_and_b32 v1, 63, v0
    s_mov_b32 s14, 0x280000
    s_mov_b32 s15, 0x20000
    s_lshr_b32 s30, s30, 6
    s_cmp_lt_u32 s2, 64
    s_cbranch_scc1 K_SLOW
    s_cmp_lt_u32 s30, 4
    s_cbranch_scc1 K_FAST
K_SLOW:
    s_getpc_b64 s[38:39]
K_PC:
    s_bfe_u32 s3, s2, 0x30003
    s_mul_i32 s3, s3, ((K_CODE_END-gated_mix__sliding_local_dilated__moe_arch_mod__prompt_kernel+1023)/1024)
    s_sub_u32 s38, s38, K_PC-gated_mix__sliding_local_dilated__moe_arch_mod__prompt_kernel
    s_subb_u32 s39, s39, 0
    v_subrev_u32 v3, 256, v0
    v_add_u32 v2, s3, v3
    v_lshlrev_b32 v2, 7, v2
    v_min_u32 v2, K_CODE_END-gated_mix__sliding_local_dilated__moe_arch_mod__prompt_kernel-4, v2
    v_cmp_gt_u32 vcc, ((K_CODE_END-gated_mix__sliding_local_dilated__moe_arch_mod__prompt_kernel+1023)/1024), v3
    s_and_saveexec_b64 s[4:5], vcc
    s_cbranch_execz K_NOPF
    global_load_dword v6, v2, s[38:39]
K_NOPF:
    s_mov_b64 exec, -1
    v_mov_b64 v[2:3], 0
    v_mov_b64 v[4:5], 0
    v_mov_b32 v7, 158752
    ds_write_b128 v7, v[2:5] offset:0
    ds_write_b128 v7, v[2:5] offset:16
    ds_write_b128 v7, v[2:5] offset:32
    ds_write_b128 v7, v[2:5] offset:48
    s_mov_b32 s43, 1
    s_lshl_b32 s3, s30, 8
    s_add_u32 s3, s3, s2
    s_lshr_b32 s3, s3, 3
    s_cmp_lg_u32 s3, 160
    s_cbranch_scc1 K_COMMON
    s_mul_i32 s3, s2, 6144
    s_add_u32 s3, s3, 527360
    v_lshl_add_u32 v6, v1, 4, s3
    v_mov_b64 v[24:25], 0
    v_mov_b64 v[26:27], 0
    s_waitcnt lgkmcnt(0)
    global_store_dwordx4 v6, v[24:27], s[10:11] offset:-3072 sc1
    global_store_dwordx4 v6, v[24:27], s[10:11] offset:-2048 sc1
    global_store_dwordx4 v6, v[24:27], s[10:11] offset:-1024 sc1
    global_store_dwordx4 v6, v[24:27], s[10:11] offset:0 sc1
    global_store_dwordx4 v6, v[24:27], s[10:11] offset:1024 sc1
    global_store_dwordx4 v6, v[24:27], s[10:11] offset:2048 sc1
    s_lshl_b32 s3, s2, 2
    v_mov_b32 v2, s3
    v_mov_b32 v3, 1
    s_mov_b64 exec, 1
    s_waitcnt vmcnt(0)
    global_store_dword v2, v3, s[8:9] offset:192 sc1
    s_mov_b64 exec, -1
    s_branch K_COMMON
K_FAST:
    s_lshr_b32 s32, s2, 1
    s_and_b32 s32, s32, 28
    v_lshrrev_b32 v3, 4, v1
    s_lshr_b32 s3, s2, 6
    s_mov_b32 s59, 0x59608237
    s_cmp_eq_u32 s3, 2
    s_cselect_b32 s59, 0x26375904, s59
    v_and_b32 v4, 7, v1
    s_cmp_eq_u32 s3, 3
    s_cselect_b32 s59, 0x93042671, s59
    v_lshrrev_b32 v2, 3, v1
    s_lshr_b32 s59, s59, s32
    s_and_b32 s59, s59, 15
    v_xor_b32 v4, v4, v3
    s_lshl_b32 s33, s28, 2
    s_lshr_b32 s33, 0x76543210, s33
    s_and_b32 s33, s33, 15
    s_add_u32 s59, s59, s33
    s_cmp_ge_u32 s59, 10
    v_mul_u32_u24 v2, 1280, v2
    s_cselect_b32 s33, 10, 0
    s_sub_u32 s59, s59, s33
    s_lshr_b32 s53, s28, 1
    v_lshl_add_u32 v40, v4, 4, v2
    s_mul_i32 s53, s53, 655360
    s_lshl2_add_u32 s62, s3, s30
    s_cmp_eq_u32 s62, 15
    s_cselect_b32 s62, 0x800000, 0
    s_add_u32 s62, s62, 40960
    s_mul_i32 s3, s3, 225280
    v_xor_b32 v41, 64, v40
    s_add_u32 s53, s53, s3
    s_mul_i32 s54, s30, 61440
    s_add_u32 s53, s53, s54
    s_sub_u32 s53, s53, 245760
    s_mul_i32 s55, s30, 6144
    s_add_u32 s55, s55, 49152
    s_lshl_b32 s57, s59, 7
    s_add_u32 s57, s57, s53
    s_waitcnt lgkmcnt(0)
    s_add_u32 m0, s55, 0
    s_max_i32 s60, s57, 0
    buffer_load_dwordx4 v40, s[12:15], s60 offen lds
    s_add_u32 s60, s57, 10240
    s_add_u32 m0, s55, 1024
    s_max_i32 s60, s60, 0
    buffer_load_dwordx4 v41, s[12:15], s60 offen lds
    s_add_u32 m0, s55, 2048
    s_add_u32 s60, s57, 20480
    buffer_load_dwordx4 v40, s[12:15], s60 offen lds
    s_add_u32 m0, s55, 3072
    s_add_u32 s60, s57, 30720
    buffer_load_dwordx4 v41, s[12:15], s60 offen lds
    s_add_u32 m0, s55, 4096
    s_add_u32 s60, s57, s62
    buffer_load_dwordx4 v40, s[12:15], s60 offen lds
    s_add_u32 m0, s55, 5120
    s_add_u32 s60, s60, 10240
    buffer_load_dwordx4 v41, s[12:15], s60 offen lds
    v_lshlrev_b32 v2, 1, v3
    s_lshr_b32 s32, 0x64317520, s32
    v_sub_u32 v2, v1, v2
    s_and_b32 s32, s32, 7
    v_and_b32 v2, 15, v2
    s_and_b32 s3, s28, 1
    v_mul_u32_u24 v3, 3840, v3
    s_lshl3_add_u32 s32, s3, s32
    v_mul_u32_u24 v4, 13, v2
    s_mul_i32 s3, s32, 80
    v_lshrrev_b32 v4, 6, v4
    s_add_u32 s54, s54, s3
    v_mul_u32_u24 v4, 1200, v4
    s_lshl_b32 s56, s30, 12
    v_lshl_add_u32 v4, v2, 4, v4
    s_add_u32 s56, s56, 106496
    v_add_u32 v5, 1, v2
    s_mov_b32 s18, 0x258000
    v_and_b32 v5, 16, v5
    s_mov_b32 s19, 0x20000
    v_lshl_add_u32 v4, v5, 24, v4
    v_add_u32 v42, v3, v4
    s_mul_i32 s58, s59, 245760
    s_add_u32 s58, s58, s54
    s_add_u32 s59, s59, 1
    s_cmp_eq_u32 s59, 10
    s_cselect_b32 s59, 0, s59
    s_add_u32 m0, s56, 0
    s_add_u32 s60, s58, 0
    buffer_load_dwordx4 v42, s[16:19], s60 offen lds
    s_add_u32 m0, s56, 1024
    s_add_u32 s60, s58, 15360
    buffer_load_dwordx4 v42, s[16:19], s60 offen lds
    v_xor_b32 v2, 8, v2
    v_mul_u32_u24 v4, 13, v2
    v_lshrrev_b32 v4, 6, v4
    v_mul_u32_u24 v4, 1200, v4
    v_lshl_add_u32 v4, v2, 4, v4
    v_add_u32 v5, 1, v2
    v_and_b32 v5, 16, v5
    v_lshl_add_u32 v4, v5, 24, v4
    v_add_u32 v43, v3, v4
    s_add_u32 m0, s56, 2048
    s_add_u32 s60, s58, 30720
    buffer_load_dwordx4 v43, s[16:19], s60 offen lds
    s_add_u32 m0, s56, 3072
    s_add_u32 s60, s58, 46080
    buffer_load_dwordx4 v43, s[16:19], s60 offen lds
    s_mov_b32 s52, s30
    s_mov_b32 s43, 0
K_COMMON:
    v_mov_b32 v7, 0
    s_lshr_b32 s29, s2, 3
    s_xor_b32 s30, s30, 4
    s_mov_b32 s26, 0xc8000
    s_mov_b32 s27, 0x20000
    s_lshr_b32 s34, s29, 3
    s_lshl_b32 s34, s34, 2
    s_and_b32 s3, s29, 3
    s_add_u32 s34, s34, s3
    s_add_u32 s34, s34, 4
    s_bitcmp1_b32 s29, 2
    s_cselect_b32 s34, -1, s34
    s_cmp_lt_u32 s29, 8
    s_cselect_b32 s34, s29, s34
    s_lshl_b32 s40, s28, 1
    s_cmp_ge_u32 s34, 10
    s_addc_u32 s40, s40, 0
    s_sub_u32 s41, s34, 10
    s_cmp_ge_u32 s34, 10
    s_cselect_b32 s41, s41, s34
    s_mul_i32 s42, s28, 20
    s_add_u32 s42, s42, s34
    s_and_b32 s42, s42, 255
    s_lshl_b32 s42, s42, 8
    s_add_u32 s42, s42, 524288
    s_cmp_lt_u32 s29, 8
    s_cbranch_scc1 K_AUX
    s_lshr_b32 s31, s29, 3
    s_sub_u32 s31, s31, 1
    s_and_b32 s35, s29, 3
    s_and_b32 s3, s29, 4
    s_lshl_b32 s3, s3, 1
    s_add_u32 s35, s35, s3
    s_and_b32 s3, s28, 1
    s_lshl_b32 s3, s3, 2
    s_add_u32 s35, s35, s3
    v_and_b32 v9, 15, v1
    v_lshrrev_b32 v10, 4, v1
    v_bfe_u32 v11, v1, 2, 2
    v_and_b32 v12, 3, v1
    s_waitcnt lgkmcnt(0)
    s_add_u32 s20, s10, 0x100000
    s_addc_u32 s21, s11, 0
    s_mov_b32 s22, 0x280000
    s_mov_b32 s23, 0x20000
    s_and_b32 s3, s30, 3
    s_mul_i32 s3, s3, 3
    s_lshr_b32 s33, s30, 2
    s_lshl1_add_u32 s3, s33, s3
    s_mul_i32 s44, s31, 11
    s_add_u32 s44, s44, s3
    s_cmp_eq_u32 s44, 31
    s_cselect_b32 s51, 4, s30
    s_lshr_b32 s33, s28, 1
    s_lshl_b32 s33, s33, 5
    s_add_u32 s44, s44, s33
    s_lshl_b32 s3, s3, 10
    s_add_u32 s3, s3, 122880
    v_lshl_add_u32 v13, v1, 4, s3
    v_lshl_add_u32 v2, v9, 4, s3
    v_add_u32 v2, 520, v2
    v_add_u32 v3, 512, v13
    v_cmp_eq_u32 vcc, 0, v10
    s_nop 1
    v_cndmask_b32 v18, v2, v3, vcc
    v_cmp_eq_u32 vcc, 1, v10
    s_nop 1
    v_cndmask_b32 v19, v2, v3, vcc
    v_lshl_add_u32 v5, v10, 2, v11
    v_lshl_add_u32 v5, v5, 4, s3
    v_add_u32 v2, 520, v5
    v_add_u32 v3, 8, v5
    v_add_u32 v4, 264, v5
    s_cmp_lt_u32 s30, 4
    s_cselect_b32 s33, 0, 3
    s_sub_u32 s33, s30, s33
    s_mul_i32 s33, s33, 5120
    s_add_u32 s33, s33, 79872
    v_lshl_add_u32 v14, v1, 3, s33
    v_cmp_eq_u32 vcc, 0, v12
    s_nop 1
    v_cndmask_b32 v20, v2, v3, vcc
    v_cmp_eq_u32 vcc, 1, v12
    s_nop 1
    v_cndmask_b32 v21, v2, v4, vcc
    v_cmp_eq_u32 vcc, 2, v12
    s_nop 1
    v_cndmask_b32 v22, v2, v3, vcc
    v_cmp_eq_u32 vcc, 3, v12
    s_nop 1
    v_cndmask_b32 v23, v2, v4, vcc
    s_lshl_b32 s3, s35, 10
    v_lshl_add_u32 v15, v1, 4, s3
    s_lshl_b32 s3, s35, 8
    s_add_u32 s3, s3, 16384
    v_lshl_add_u32 v16, v9, 4, s3
    v_and_b32 v2, 1, v10
    v_lshl_add_u32 v16, v2, 23, v16
    s_cmp_lt_u32 s51, 4
    s_cselect_b32 s3, 0, 0x800000
    s_add_u32 s3, s3, 20480
    v_lshrrev_b32 v2, 1, v10
    v_mad_u32_u24 v16, v2, s3, v16
    s_mul_i32 s50, s44, 20480
    s_add_u32 s51, s50, s3
    v_mov_b32 v17, 0xf149f2ca
    v_lshlrev_b32 v2, 2, v10
    v_sub_u32 v2, v9, v2
    s_cmp_eq_u32 s44, 0
    s_cselect_b32 s3, 0xf149f2ca, 0
    v_subrev_u32 v3, 0, v2
    v_and_b32 v4, 0x80000001, v3
    v_cmp_eq_u32 vcc, 0, v4
    s_nop 1
    v_cndmask_b32 v28, v17, 0, vcc
    v_cmp_eq_u32 vcc, 0x80000000, v4
    s_nop 1
    v_cndmask_b32 v24, v17, 0, vcc
    v_add_f32 v32, s3, v24
    v_subrev_u32 v3, 1, v2
    v_and_b32 v4, 0x80000001, v3
    v_cmp_eq_u32 vcc, 0, v4
    s_nop 1
    v_cndmask_b32 v29, v17, 0, vcc
    v_cmp_eq_u32 vcc, 0x80000000, v4
    s_nop 1
    v_cndmask_b32 v25, v17, 0, vcc
    v_add_f32 v33, s3, v25
    v_subrev_u32 v3, 2, v2
    v_and_b32 v4, 0x80000001, v3
    v_cmp_eq_u32 vcc, 0, v4
    s_nop 1
    v_cndmask_b32 v30, v17, 0, vcc
    v_cmp_eq_u32 vcc, 0x80000000, v4
    s_nop 1
    v_cndmask_b32 v26, v17, 0, vcc
    v_add_f32 v34, s3, v26
    v_subrev_u32 v3, 3, v2
    v_and_b32 v4, 0x80000001, v3
    v_cmp_eq_u32 vcc, 0, v4
    s_nop 1
    v_cndmask_b32 v31, v17, 0, vcc
    v_cmp_eq_u32 vcc, 0x80000000, v4
    s_nop 1
    v_cndmask_b32 v27, v17, 0, vcc
    v_add_f32 v35, s3, v27
    v_mov_b32 v3, 0x0c0c0c0c
    v_mov_b32 v4, 0xc0c0100
    v_cmp_eq_u32 vcc, 0, v24
    v_mov_b32 v5, 0x1000c0c
    s_nop 0
    v_cndmask_b32 v3, v3, v4, vcc
    v_cmp_eq_u32 vcc, 0, v25
    s_nop 1
    v_cndmask_b32 v36, v3, v5, vcc
    v_mov_b32 v3, 0x0c0c0c0c
    v_mov_b32 v4, 0xc0c0302
    v_cmp_eq_u32 vcc, 0, v26
    v_mov_b32 v5, 0x3020c0c
    s_nop 0
    v_cndmask_b32 v3, v3, v4, vcc
    v_cmp_eq_u32 vcc, 0, v27
    s_nop 1
    v_cndmask_b32 v37, v3, v5, vcc
    v_mov_b32 v3, 0x0c0c0c0c
    v_mov_b32 v4, 0xc0c0100
    v_cmp_eq_u32 vcc, 0, v28
    v_mov_b32 v5, 0x1000c0c
    s_nop 0
    v_cndmask_b32 v3, v3, v4, vcc
    v_cmp_eq_u32 vcc, 0, v29
    s_nop 1
    v_cndmask_b32 v38, v3, v5, vcc
    v_mov_b32 v3, 0x0c0c0c0c
    v_mov_b32 v4, 0xc0c0302
    v_cmp_eq_u32 vcc, 0, v30
    v_mov_b32 v5, 0x3020c0c
    s_nop 0
    v_cndmask_b32 v3, v3, v4, vcc
    v_cmp_eq_u32 vcc, 0, v31
    s_nop 1
    v_cndmask_b32 v39, v3, v5, vcc
    s_mov_b32 s46, 0x3ea52b5c
    s_mov_b32 s47, s46
    s_mov_b32 s48, 0x3e64f92e
    s_mov_b32 s49, s48
    s_mov_b32 s36, 0xfffff
    s_cmp_lg_u32 s31, 0
    s_cselect_b32 s33, 64, 0
    v_mov_b32 v2, s33
    v_cmp_gt_u32 vcc, 10, v1
    s_lshr_b32 s3, s28, 1
    s_lshl2_add_u32 s3, s3, s31
    v_cndmask_b32 v2, 0, v2, vcc
    v_lshl_add_u32 v2, v1, 8, v2
    s_mul_i32 s3, s3, 2560
    s_lshl2_add_u32 s3, s35, s3
    s_add_u32 s3, s3, 524288
    v_add_u32 v8, s3, v2
    s_cmp_eq_u32 s43, 1
    s_cbranch_scc1 K_CONS
    v_lshrrev_b32 v2, 3, v1
    v_mul_u32_u24 v2, 1280, v2
    v_lshrrev_b32 v3, 4, v1
    v_lshlrev_b32 v3, 1, v3
    v_and_b32 v4, 7, v1
    v_xor_b32 v3, v3, v4
    v_lshl_add_u32 v2, v3, 4, v2
    s_lshl_b32 s33, s41, 7
    v_add_u32 v17, s33, v2
    s_mov_b32 s61, 9
    s_branch K_LOOPE
K_LOOP:
    s_waitcnt vmcnt(5)
    s_barrier
    s_add_u32 m0, s56, 2048
    s_add_u32 s60, s58, 30720
    buffer_load_dwordx4 v43, s[16:19], s60 offen lds
    s_add_u32 m0, s55, 3072
    s_add_u32 s60, s57, 30720
    buffer_load_dwordx4 v41, s[12:15], s60 offen lds
    s_add_u32 m0, s56, 3072
    s_add_u32 s60, s58, 46080
    buffer_load_dwordx4 v43, s[16:19], s60 offen lds
    s_add_u32 m0, s55, 4096
    s_add_u32 s60, s57, s62
    buffer_load_dwordx4 v40, s[12:15], s60 offen lds
    s_add_u32 m0, s55, 5120
    s_add_u32 s60, s60, 10240
    buffer_load_dwordx4 v41, s[12:15], s60 offen lds
    s_sub_u32 s61, s61, 1
    s_cmp_eq_u32 s61, 0
    s_cbranch_scc1 K_LOOPX
K_LOOPE:
    s_cmp_ge_u32 s55, 49152
    s_cselect_b32 s60, -2, 1
    s_mul_i32 s3, s60, 24576
    s_add_u32 s55, s55, s3
    s_lshl_b32 s60, s60, 14
    s_add_u32 s56, s56, s60
    s_lshl_b32 s57, s59, 7
    s_add_u32 s57, s57, s53
    s_mul_i32 s58, s59, 245760
    s_add_u32 s58, s58, s54
    s_add_u32 s59, s59, 1
    s_cmp_eq_u32 s59, 10
    s_cselect_b32 s59, 0, s59
    s_add_u32 m0, s56, 0
    s_add_u32 s60, s58, 0
    buffer_load_dwordx4 v42, s[16:19], s60 offen lds
    s_add_u32 m0, s55, 0
    s_max_i32 s60, s57, 0
    buffer_load_dwordx4 v40, s[12:15], s60 offen lds
    s_add_u32 m0, s56, 1024
    s_add_u32 s60, s58, 15360
    buffer_load_dwordx4 v42, s[16:19], s60 offen lds
    s_add_u32 s60, s57, 10240
    s_add_u32 m0, s55, 1024
    s_max_i32 s60, s60, 0
    buffer_load_dwordx4 v41, s[12:15], s60 offen lds
    s_add_u32 m0, s55, 2048
    s_add_u32 s60, s57, 20480
    buffer_load_dwordx4 v40, s[12:15], s60 offen lds
    s_branch K_LOOP
K_LOOPX:
    v_and_b32 v2, 7, v1
    v_lshlrev_b32 v2, 2, v2
    s_waitcnt vmcnt(0)
    s_barrier
    s_cmp_lt_u32 s30, 6
    s_cbranch_scc1 K_NOSMP
    global_load_dword v7, v2, s[8:9] offset:192 sc1
K_NOSMP:
    s_cmp_eq_u32 s34, -1
    s_cbranch_scc1 K_JOIN_S
    s_cmp_lt_u32 s52, 2
    s_cbranch_scc1 K_WOE
    s_cmp_lg_u32 s30, 7
    s_cbranch_scc1 K_JOIN_S
    s_mov_b32 s52, 2
    s_branch K_W7A
K_WOE:
    s_lshl_b32 s57, s52, 2
    s_lshr_b32 s57, 0x7520, s57
    s_and_b32 s57, s57, 7
    s_mul_i32 s57, s57, 51200
    s_mul_i32 s58, s52, 5120
    s_add_u32 s3, s57, 0
    s_add_u32 m0, s58, 0
    s_nop 0
    buffer_load_dwordx4 v17, s[24:27], s3 offen lds
    s_add_u32 s3, s57, 10240
    s_add_u32 m0, s58, 1024
    s_nop 0
    buffer_load_dwordx4 v17, s[24:27], s3 offen lds
    s_add_u32 s3, s57, 20480
    s_add_u32 m0, s58, 2048
    s_nop 0
    buffer_load_dwordx4 v17, s[24:27], s3 offen lds
    s_add_u32 s3, s57, 30720
    s_add_u32 m0, s58, 3072
    s_nop 0
    buffer_load_dwordx4 v17, s[24:27], s3 offen lds
    s_add_u32 s3, s57, 40960
    s_add_u32 m0, s58, 4096
    s_nop 0
    buffer_load_dwordx4 v17, s[24:27], s3 offen lds
    s_add_u32 s3, s57, 409600
    s_add_u32 m0, s58, 20480
    s_nop 0
    buffer_load_dwordx4 v17, s[24:27], s3 offen lds
    s_add_u32 s3, s57, 419840
    s_add_u32 m0, s58, 21504
    s_nop 0
    buffer_load_dwordx4 v17, s[24:27], s3 offen lds
    s_add_u32 s3, s57, 430080
    s_add_u32 m0, s58, 22528
    s_nop 0
    buffer_load_dwordx4 v17, s[24:27], s3 offen lds
    s_add_u32 s3, s57, 440320
    s_add_u32 m0, s58, 23552
    s_nop 0
    buffer_load_dwordx4 v17, s[24:27], s3 offen lds
    s_add_u32 s3, s57, 450560
    s_add_u32 m0, s58, 24576
    s_nop 0
    buffer_load_dwordx4 v17, s[24:27], s3 offen lds
    s_cmp_lg_u32 s30, 7
    s_cbranch_scc1 K_JOIN_S
    s_add_u32 s52, s52, 1
    s_cmp_lt_u32 s52, 4
    s_cbranch_scc1 K_WOE
    s_mov_b32 s52, 0
K_XD:
    s_lshl_b32 s57, s40, 3
    s_lshl1_add_u32 s57, s52, s57
    s_mul_i32 s57, s57, 20480
    s_lshl_b32 s33, s41, 7
    s_add_u32 s57, s57, s33
    s_lshl_b32 s33, s52, 12
    s_add_u32 m0, s33, 140288
    s_add_u32 s3, s57, 0
    buffer_load_dwordx4 v40, s[12:15], s3 offen lds
    s_add_u32 m0, s33, 141312
    s_add_u32 s3, s57, 10240
    buffer_load_dwordx4 v41, s[12:15], s3 offen lds
    s_add_u32 m0, s33, 142336
    s_add_u32 s3, s57, 20480
    buffer_load_dwordx4 v40, s[12:15], s3 offen lds
    s_add_u32 m0, s33, 143360
    s_add_u32 s3, s57, 30720
    buffer_load_dwordx4 v41, s[12:15], s3 offen lds
    s_add_u32 s52, s52, 1
    s_cmp_lt_u32 s52, 4
    s_cbranch_scc1 K_XD
    s_branch K_W7
.p2align 12
K_CONS:
    v_lshrrev_b32 v2, 1, v9
    v_xor_b32 v2, v2, v10
    v_lshlrev_b32 v2, 4, v2
    v_lshl_add_u32 v2, v9, 7, v2
    s_mul_i32 s3, s30, 6144
    v_add_u32 v40, s3, v2
    v_xor_b32 v41, 64, v40
    v_and_b32 v2, 1, v10
    v_lshl_or_b32 v2, v2, 2, v11
    v_lshlrev_b32 v2, 5, v2
    v_lshl_add_u32 v3, v10, 3, v11
    v_lshlrev_b32 v3, 8, v3
    v_add_u32 v3, 73728, v3
    v_lshlrev_b32 v5, 3, v12
    s_movk_i32 s33, 0xff
    s_mov_b32 s3, 0x48209870
    v_lshrrev_b32 v4, v5, s3
    v_add_u32 v4, v4, v2
    v_and_or_b32 v42, v4, s33, v3
    s_mov_b32 s3, 0xf8f0e8c0
    v_lshrrev_b32 v4, v5, s3
    v_add_u32 v4, v4, v2
    v_and_or_b32 v43, v4, s33, v3
    v_add_u32 v2, v2, v5
    v_add_u32 v4, 80, v2
    v_and_or_b32 v44, v4, s33, v3
    v_add_u32 v4, 120, v2
    v_and_or_b32 v45, v4, s33, v3
    v_add_u32 v4, 0, v2
    v_and_or_b32 v46, v4, s33, v3
    v_add_u32 v4, 40, v2
    v_and_or_b32 v47, v4, s33, v3
    v_add_u32 v4, 160, v2
    v_and_or_b32 v48, v4, s33, v3
    v_add_u32 v4, 200, v2
    v_and_or_b32 v49, v4, s33, v3
    s_lshl_b32 s3, s30, 2
    s_add_u32 s3, s3, 158800
    v_mov_b32 v50, s3
    v_mov_b32 v4, 1
    v_mov_b32 v5, 2
    v_mov_b64 v[52:53], 0
    v_mov_b64 v[54:55], 0
    v_mov_b64 v[56:57], 0
    v_mov_b64 v[58:59], 0
    v_mov_b64 v[60:61], 0
    v_mov_b64 v[62:63], 0
    v_mov_b64 v[64:65], 0
    v_mov_b64 v[66:67], 0
    v_mov_b64 v[68:69], 0
    v_mov_b64 v[70:71], 0
    v_mov_b64 v[72:73], 0
    v_mov_b64 v[74:75], 0
    v_mov_b64 v[76:77], 0
    v_mov_b64 v[78:79], 0
    v_mov_b64 v[80:81], 0
    v_mov_b64 v[82:83], 0
    v_mov_b64 v[84:85], 0
    v_mov_b64 v[86:87], 0
    v_mov_b64 v[88:89], 0
    v_mov_b64 v[90:91], 0
    v_mov_b64 v[92:93], 0
    v_mov_b64 v[94:95], 0
    v_mov_b64 v[96:97], 0
    v_mov_b64 v[98:99], 0
    v_mov_b64 v[100:101], 0
    v_mov_b64 v[102:103], 0
    v_mov_b64 v[104:105], 0
    v_mov_b64 v[106:107], 0
    v_mov_b64 v[108:109], 0
    v_mov_b64 v[110:111], 0
    v_mov_b64 v[112:113], 0
    v_mov_b64 v[114:115], 0
    v_mov_b64 v[116:117], 0
    v_mov_b64 v[118:119], 0
    v_mov_b64 v[120:121], 0
    v_mov_b64 v[122:123], 0
    v_mov_b64 v[124:125], 0
    v_mov_b64 v[126:127], 0
    v_mov_b64 v[128:129], 0
    v_mov_b64 v[130:131], 0
    v_mov_b64 v[132:133], 0
    v_mov_b64 v[134:135], 0
    v_mov_b64 v[136:137], 0
    v_mov_b64 v[138:139], 0
    v_mov_b64 v[140:141], 0
    v_mov_b64 v[142:143], 0
    v_mov_b64 v[144:145], 0
    v_mov_b64 v[146:147], 0
    s_mov_b32 s52, 3
    s_cmp_lg_u32 s30, 0
    s_cbranch_scc1 K_WARMM0
    s_call_b64 s[38:39], WP_attd
    s_call_b64 s[38:39], WP_p2g
    s_branch K_WARMMX
K_WARMM0:
    s_cmp_lg_u32 s30, 1
    s_cbranch_scc1 K_WARMM1
    s_call_b64 s[38:39], WP_atts
    s_call_b64 s[38:39], WP_early
    s_branch K_WARMMX
K_WARMM1:
    s_cmp_lg_u32 s30, 2
    s_cbranch_scc1 K_WARMM2
    s_call_b64 s[38:39], WP_help
    s_call_b64 s[38:39], WP_flags
    s_branch K_WARMMX
K_WARMM2:
    s_call_b64 s[38:39], WP_spin
K_WARMMX:
    s_barrier
    ds_read_b128 v[148:151], v40 offset:49152
    ds_read_b64_tr_b16 v[172:173], v42 offset:32768
    ds_read_b64_tr_b16 v[174:175], v42 offset:33792
    ds_read_b128 v[152:155], v40 offset:51200
    ds_read_b128 v[156:159], v40 offset:53248
    ds_read_b64_tr_b16 v[176:177], v43 offset:32768
    ds_read_b64_tr_b16 v[178:179], v43 offset:33792
    ds_read_b64_tr_b16 v[180:181], v44 offset:32768
    ds_read_b64_tr_b16 v[182:183], v44 offset:33792
    ds_read_b64_tr_b16 v[184:185], v45 offset:32768
    ds_read_b64_tr_b16 v[186:187], v45 offset:33792
    ds_read_b64_tr_b16 v[188:189], v46 offset:32768
    ds_read_b64_tr_b16 v[190:191], v46 offset:33792
    ds_read_b64_tr_b16 v[192:193], v47 offset:32768
    ds_read_b64_tr_b16 v[194:195], v47 offset:33792
    ds_read_b64_tr_b16 v[196:197], v48 offset:32768
    ds_read_b64_tr_b16 v[198:199], v48 offset:33792
    ds_read_b64_tr_b16 v[200:201], v49 offset:32768
    ds_read_b64_tr_b16 v[202:203], v49 offset:33792
K_CLOOP:
    s_waitcnt lgkmcnt(0)
    v_mfma_f32_16x16x32_bf16 v[52:55], v[172:175], v[148:151], v[52:55]
    ds_read_b128 v[160:163], v41 offset:49152
    v_mfma_f32_16x16x32_bf16 v[56:59], v[176:179], v[148:151], v[56:59]
    ds_read_b64_tr_b16 v[204:205], v42 offset:40960
    v_mfma_f32_16x16x32_bf16 v[60:63], v[180:183], v[148:151], v[60:63]
    ds_read_b64_tr_b16 v[206:207], v42 offset:41984
    v_mfma_f32_16x16x32_bf16 v[64:67], v[184:187], v[148:151], v[64:67]
    ds_read_b128 v[164:167], v41 offset:51200
    v_mfma_f32_16x16x32_bf16 v[68:71], v[188:191], v[148:151], v[68:71]
    ds_read_b128 v[168:171], v41 offset:53248
    v_mfma_f32_16x16x32_bf16 v[72:75], v[192:195], v[148:151], v[72:75]
    ds_read_b64_tr_b16 v[208:209], v43 offset:40960
    v_mfma_f32_16x16x32_bf16 v[76:79], v[148:151], v[196:199], v[76:79]
    ds_read_b64_tr_b16 v[210:211], v43 offset:41984
    v_mfma_f32_16x16x32_bf16 v[80:83], v[148:151], v[200:203], v[80:83]
    ds_read_b64_tr_b16 v[212:213], v44 offset:40960
    v_mfma_f32_16x16x32_bf16 v[112:115], v[152:155], v[200:203], v[112:115]
    ds_read_b64_tr_b16 v[214:215], v44 offset:41984
    v_mfma_f32_16x16x32_bf16 v[108:111], v[152:155], v[196:199], v[108:111]
    ds_read_b64_tr_b16 v[216:217], v45 offset:40960
    v_mfma_f32_16x16x32_bf16 v[104:107], v[192:195], v[152:155], v[104:107]
    ds_read_b64_tr_b16 v[218:219], v45 offset:41984
    v_mfma_f32_16x16x32_bf16 v[100:103], v[188:191], v[152:155], v[100:103]
    ds_read_b64_tr_b16 v[220:221], v46 offset:40960
    v_mfma_f32_16x16x32_bf16 v[96:99], v[184:187], v[152:155], v[96:99]
    ds_read_b64_tr_b16 v[222:223], v46 offset:41984
    v_mfma_f32_16x16x32_bf16 v[92:95], v[180:183], v[152:155], v[92:95]
    ds_read_b64_tr_b16 v[224:225], v47 offset:40960
    v_mfma_f32_16x16x32_bf16 v[88:91], v[176:179], v[152:155], v[88:91]
    ds_read_b64_tr_b16 v[226:227], v47 offset:41984
    v_mfma_f32_16x16x32_bf16 v[84:87], v[172:175], v[152:155], v[84:87]
    ds_read_b64_tr_b16 v[228:229], v48 offset:40960
    v_mfma_f32_16x16x32_bf16 v[116:119], v[172:175], v[156:159], v[116:119]
    ds_read_b64_tr_b16 v[230:231], v48 offset:41984
    v_mfma_f32_16x16x32_bf16 v[120:123], v[176:179], v[156:159], v[120:123]
    ds_read_b64_tr_b16 v[232:233], v49 offset:40960
    v_mfma_f32_16x16x32_bf16 v[124:127], v[180:183], v[156:159], v[124:127]
    ds_read_b64_tr_b16 v[234:235], v49 offset:41984
    v_mfma_f32_16x16x32_bf16 v[128:131], v[184:187], v[156:159], v[128:131]
    v_mfma_f32_16x16x32_bf16 v[132:135], v[188:191], v[156:159], v[132:135]
    v_mfma_f32_16x16x32_bf16 v[136:139], v[192:195], v[156:159], v[136:139]
    v_mfma_f32_16x16x32_bf16 v[140:143], v[156:159], v[196:199], v[140:143]
    v_mfma_f32_16x16x32_bf16 v[144:147], v[156:159], v[200:203], v[144:147]
    s_waitcnt lgkmcnt(0)
    s_barrier
    v_mfma_f32_16x16x32_bf16 v[52:55], v[204:207], v[160:163], v[52:55]
    ds_read_b128 v[148:151], v40 offset:0
    v_mfma_f32_16x16x32_bf16 v[56:59], v[208:211], v[160:163], v[56:59]
    ds_read_b64_tr_b16 v[172:173], v42 offset:0
    v_mfma_f32_16x16x32_bf16 v[60:63], v[212:215], v[160:163], v[60:63]
    ds_read_b64_tr_b16 v[174:175], v42 offset:1024
    v_mfma_f32_16x16x32_bf16 v[64:67], v[216:219], v[160:163], v[64:67]
    ds_read_b128 v[152:155], v40 offset:2048
    v_mfma_f32_16x16x32_bf16 v[68:71], v[220:223], v[160:163], v[68:71]
    ds_read_b128 v[156:159], v40 offset:4096
    v_mfma_f32_16x16x32_bf16 v[72:75], v[224:227], v[160:163], v[72:75]
    ds_read_b64_tr_b16 v[176:177], v43 offset:0
    v_mfma_f32_16x16x32_bf16 v[76:79], v[160:163], v[228:231], v[76:79]
    ds_read_b64_tr_b16 v[178:179], v43 offset:1024
    v_mfma_f32_16x16x32_bf16 v[80:83], v[160:163], v[232:235], v[80:83]
    ds_read_b64_tr_b16 v[180:181], v44 offset:0
    v_mfma_f32_16x16x32_bf16 v[112:115], v[164:167], v[232:235], v[112:115]
    ds_read_b64_tr_b16 v[182:183], v44 offset:1024
    v_mfma_f32_16x16x32_bf16 v[108:111], v[164:167], v[228:231], v[108:111]
    ds_read_b64_tr_b16 v[184:185], v45 offset:0
    v_mfma_f32_16x16x32_bf16 v[104:107], v[224:227], v[164:167], v[104:107]
    ds_read_b64_tr_b16 v[186:187], v45 offset:1024
    v_mfma_f32_16x16x32_bf16 v[100:103], v[220:223], v[164:167], v[100:103]
    ds_read_b64_tr_b16 v[188:189], v46 offset:0
    v_mfma_f32_16x16x32_bf16 v[96:99], v[216:219], v[164:167], v[96:99]
    ds_read_b64_tr_b16 v[190:191], v46 offset:1024
    v_mfma_f32_16x16x32_bf16 v[92:95], v[212:215], v[164:167], v[92:95]
    ds_read_b64_tr_b16 v[192:193], v47 offset:0
    v_mfma_f32_16x16x32_bf16 v[88:91], v[208:211], v[164:167], v[88:91]
    ds_read_b64_tr_b16 v[194:195], v47 offset:1024
    v_mfma_f32_16x16x32_bf16 v[84:87], v[204:207], v[164:167], v[84:87]
    ds_read_b64_tr_b16 v[196:197], v48 offset:0
    v_mfma_f32_16x16x32_bf16 v[116:119], v[204:207], v[168:171], v[116:119]
    ds_read_b64_tr_b16 v[198:199], v48 offset:1024
    v_mfma_f32_16x16x32_bf16 v[120:123], v[208:211], v[168:171], v[120:123]
    ds_read_b64_tr_b16 v[200:201], v49 offset:0
    v_mfma_f32_16x16x32_bf16 v[124:127], v[212:215], v[168:171], v[124:127]
    ds_read_b64_tr_b16 v[202:203], v49 offset:1024
    v_mfma_f32_16x16x32_bf16 v[128:131], v[216:219], v[168:171], v[128:131]
    v_mfma_f32_16x16x32_bf16 v[132:135], v[220:223], v[168:171], v[132:135]
    v_mfma_f32_16x16x32_bf16 v[136:139], v[224:227], v[168:171], v[136:139]
    v_mfma_f32_16x16x32_bf16 v[140:143], v[168:171], v[228:231], v[140:143]
    v_mfma_f32_16x16x32_bf16 v[144:147], v[168:171], v[232:235], v[144:147]
    s_waitcnt lgkmcnt(0)
    v_mfma_f32_16x16x32_bf16 v[52:55], v[172:175], v[148:151], v[52:55]
    ds_read_b128 v[160:163], v41 offset:0
    v_mfma_f32_16x16x32_bf16 v[56:59], v[176:179], v[148:151], v[56:59]
    ds_read_b64_tr_b16 v[204:205], v42 offset:8192
    v_mfma_f32_16x16x32_bf16 v[60:63], v[180:183], v[148:151], v[60:63]
    ds_read_b64_tr_b16 v[206:207], v42 offset:9216
    v_mfma_f32_16x16x32_bf16 v[64:67], v[184:187], v[148:151], v[64:67]
    ds_read_b128 v[164:167], v41 offset:2048
    v_mfma_f32_16x16x32_bf16 v[68:71], v[188:191], v[148:151], v[68:71]
    ds_read_b128 v[168:171], v41 offset:4096
    v_mfma_f32_16x16x32_bf16 v[72:75], v[192:195], v[148:151], v[72:75]
    ds_read_b64_tr_b16 v[208:209], v43 offset:8192
    v_mfma_f32_16x16x32_bf16 v[76:79], v[148:151], v[196:199], v[76:79]
    ds_read_b64_tr_b16 v[210:211], v43 offset:9216
    v_mfma_f32_16x16x32_bf16 v[80:83], v[148:151], v[200:203], v[80:83]
    ds_read_b64_tr_b16 v[212:213], v44 offset:8192
    v_mfma_f32_16x16x32_bf16 v[112:115], v[152:155], v[200:203], v[112:115]
    ds_read_b64_tr_b16 v[214:215], v44 offset:9216
    v_mfma_f32_16x16x32_bf16 v[108:111], v[152:155], v[196:199], v[108:111]
    ds_read_b64_tr_b16 v[216:217], v45 offset:8192
    v_mfma_f32_16x16x32_bf16 v[104:107], v[192:195], v[152:155], v[104:107]
    ds_read_b64_tr_b16 v[218:219], v45 offset:9216
    v_mfma_f32_16x16x32_bf16 v[100:103], v[188:191], v[152:155], v[100:103]
    ds_read_b64_tr_b16 v[220:221], v46 offset:8192
    v_mfma_f32_16x16x32_bf16 v[96:99], v[184:187], v[152:155], v[96:99]
    ds_read_b64_tr_b16 v[222:223], v46 offset:9216
    v_mfma_f32_16x16x32_bf16 v[92:95], v[180:183], v[152:155], v[92:95]
    ds_read_b64_tr_b16 v[224:225], v47 offset:8192
    v_mfma_f32_16x16x32_bf16 v[88:91], v[176:179], v[152:155], v[88:91]
    ds_read_b64_tr_b16 v[226:227], v47 offset:9216
    v_mfma_f32_16x16x32_bf16 v[84:87], v[172:175], v[152:155], v[84:87]
    ds_read_b64_tr_b16 v[228:229], v48 offset:8192
    v_mfma_f32_16x16x32_bf16 v[116:119], v[172:175], v[156:159], v[116:119]
    ds_read_b64_tr_b16 v[230:231], v48 offset:9216
    v_mfma_f32_16x16x32_bf16 v[120:123], v[176:179], v[156:159], v[120:123]
    ds_read_b64_tr_b16 v[232:233], v49 offset:8192
    v_mfma_f32_16x16x32_bf16 v[124:127], v[180:183], v[156:159], v[124:127]
    ds_read_b64_tr_b16 v[234:235], v49 offset:9216
    v_mfma_f32_16x16x32_bf16 v[128:131], v[184:187], v[156:159], v[128:131]
    v_mfma_f32_16x16x32_bf16 v[132:135], v[188:191], v[156:159], v[132:135]
    v_mfma_f32_16x16x32_bf16 v[136:139], v[192:195], v[156:159], v[136:139]
    v_mfma_f32_16x16x32_bf16 v[140:143], v[156:159], v[196:199], v[140:143]
    v_mfma_f32_16x16x32_bf16 v[144:147], v[156:159], v[200:203], v[144:147]
    s_waitcnt lgkmcnt(0)
    s_barrier
    v_mfma_f32_16x16x32_bf16 v[52:55], v[204:207], v[160:163], v[52:55]
    ds_read_b128 v[148:151], v40 offset:24576
    v_mfma_f32_16x16x32_bf16 v[56:59], v[208:211], v[160:163], v[56:59]
    ds_read_b64_tr_b16 v[172:173], v42 offset:16384
    v_mfma_f32_16x16x32_bf16 v[60:63], v[212:215], v[160:163], v[60:63]
    ds_read_b64_tr_b16 v[174:175], v42 offset:17408
    v_mfma_f32_16x16x32_bf16 v[64:67], v[216:219], v[160:163], v[64:67]
    ds_read_b128 v[152:155], v40 offset:26624
    v_mfma_f32_16x16x32_bf16 v[68:71], v[220:223], v[160:163], v[68:71]
    ds_read_b128 v[156:159], v40 offset:28672
    v_mfma_f32_16x16x32_bf16 v[72:75], v[224:227], v[160:163], v[72:75]
    ds_read_b64_tr_b16 v[176:177], v43 offset:16384
    v_mfma_f32_16x16x32_bf16 v[76:79], v[160:163], v[228:231], v[76:79]
    ds_read_b64_tr_b16 v[178:179], v43 offset:17408
    v_mfma_f32_16x16x32_bf16 v[80:83], v[160:163], v[232:235], v[80:83]
    ds_read_b64_tr_b16 v[180:181], v44 offset:16384
    v_mfma_f32_16x16x32_bf16 v[112:115], v[164:167], v[232:235], v[112:115]
    ds_read_b64_tr_b16 v[182:183], v44 offset:17408
    v_mfma_f32_16x16x32_bf16 v[108:111], v[164:167], v[228:231], v[108:111]
    ds_read_b64_tr_b16 v[184:185], v45 offset:16384
    v_mfma_f32_16x16x32_bf16 v[104:107], v[224:227], v[164:167], v[104:107]
    ds_read_b64_tr_b16 v[186:187], v45 offset:17408
    v_mfma_f32_16x16x32_bf16 v[100:103], v[220:223], v[164:167], v[100:103]
    ds_read_b64_tr_b16 v[188:189], v46 offset:16384
    v_mfma_f32_16x16x32_bf16 v[96:99], v[216:219], v[164:167], v[96:99]
    ds_read_b64_tr_b16 v[190:191], v46 offset:17408
    v_mfma_f32_16x16x32_bf16 v[92:95], v[212:215], v[164:167], v[92:95]
    ds_read_b64_tr_b16 v[192:193], v47 offset:16384
    v_mfma_f32_16x16x32_bf16 v[88:91], v[208:211], v[164:167], v[88:91]
    ds_read_b64_tr_b16 v[194:195], v47 offset:17408
    v_mfma_f32_16x16x32_bf16 v[84:87], v[204:207], v[164:167], v[84:87]
    ds_read_b64_tr_b16 v[196:197], v48 offset:16384
    v_mfma_f32_16x16x32_bf16 v[116:119], v[204:207], v[168:171], v[116:119]
    ds_read_b64_tr_b16 v[198:199], v48 offset:17408
    v_mfma_f32_16x16x32_bf16 v[120:123], v[208:211], v[168:171], v[120:123]
    ds_read_b64_tr_b16 v[200:201], v49 offset:16384
    v_mfma_f32_16x16x32_bf16 v[124:127], v[212:215], v[168:171], v[124:127]
    ds_read_b64_tr_b16 v[202:203], v49 offset:17408
    v_mfma_f32_16x16x32_bf16 v[128:131], v[216:219], v[168:171], v[128:131]
    v_mfma_f32_16x16x32_bf16 v[132:135], v[220:223], v[168:171], v[132:135]
    v_mfma_f32_16x16x32_bf16 v[136:139], v[224:227], v[168:171], v[136:139]
    v_mfma_f32_16x16x32_bf16 v[140:143], v[168:171], v[228:231], v[140:143]
    v_mfma_f32_16x16x32_bf16 v[144:147], v[168:171], v[232:235], v[144:147]
    s_waitcnt lgkmcnt(0)
    v_mfma_f32_16x16x32_bf16 v[52:55], v[172:175], v[148:151], v[52:55]
    ds_read_b128 v[160:163], v41 offset:24576
    v_mfma_f32_16x16x32_bf16 v[56:59], v[176:179], v[148:151], v[56:59]
    ds_read_b64_tr_b16 v[204:205], v42 offset:24576
    v_mfma_f32_16x16x32_bf16 v[60:63], v[180:183], v[148:151], v[60:63]
    ds_read_b64_tr_b16 v[206:207], v42 offset:25600
    v_mfma_f32_16x16x32_bf16 v[64:67], v[184:187], v[148:151], v[64:67]
    ds_read_b128 v[164:167], v41 offset:26624
    v_mfma_f32_16x16x32_bf16 v[68:71], v[188:191], v[148:151], v[68:71]
    ds_read_b128 v[168:171], v41 offset:28672
    v_mfma_f32_16x16x32_bf16 v[72:75], v[192:195], v[148:151], v[72:75]
    ds_read_b64_tr_b16 v[208:209], v43 offset:24576
    v_mfma_f32_16x16x32_bf16 v[76:79], v[148:151], v[196:199], v[76:79]
    ds_read_b64_tr_b16 v[210:211], v43 offset:25600
    v_mfma_f32_16x16x32_bf16 v[80:83], v[148:151], v[200:203], v[80:83]
    ds_read_b64_tr_b16 v[212:213], v44 offset:24576
    v_mfma_f32_16x16x32_bf16 v[112:115], v[152:155], v[200:203], v[112:115]
    ds_read_b64_tr_b16 v[214:215], v44 offset:25600
    v_mfma_f32_16x16x32_bf16 v[108:111], v[152:155], v[196:199], v[108:111]
    ds_read_b64_tr_b16 v[216:217], v45 offset:24576
    v_mfma_f32_16x16x32_bf16 v[104:107], v[192:195], v[152:155], v[104:107]
    ds_read_b64_tr_b16 v[218:219], v45 offset:25600
    v_mfma_f32_16x16x32_bf16 v[100:103], v[188:191], v[152:155], v[100:103]
    ds_read_b64_tr_b16 v[220:221], v46 offset:24576
    v_mfma_f32_16x16x32_bf16 v[96:99], v[184:187], v[152:155], v[96:99]
    ds_read_b64_tr_b16 v[222:223], v46 offset:25600
    v_mfma_f32_16x16x32_bf16 v[92:95], v[180:183], v[152:155], v[92:95]
    ds_read_b64_tr_b16 v[224:225], v47 offset:24576
    v_mfma_f32_16x16x32_bf16 v[88:91], v[176:179], v[152:155], v[88:91]
    ds_read_b64_tr_b16 v[226:227], v47 offset:25600
    v_mfma_f32_16x16x32_bf16 v[84:87], v[172:175], v[152:155], v[84:87]
    ds_read_b64_tr_b16 v[228:229], v48 offset:24576
    v_mfma_f32_16x16x32_bf16 v[116:119], v[172:175], v[156:159], v[116:119]
    ds_read_b64_tr_b16 v[230:231], v48 offset:25600
    v_mfma_f32_16x16x32_bf16 v[120:123], v[176:179], v[156:159], v[120:123]
    ds_read_b64_tr_b16 v[232:233], v49 offset:24576
    v_mfma_f32_16x16x32_bf16 v[124:127], v[180:183], v[156:159], v[124:127]
    ds_read_b64_tr_b16 v[234:235], v49 offset:25600
    v_mfma_f32_16x16x32_bf16 v[128:131], v[184:187], v[156:159], v[128:131]
    v_mfma_f32_16x16x32_bf16 v[132:135], v[188:191], v[156:159], v[132:135]
    v_mfma_f32_16x16x32_bf16 v[136:139], v[192:195], v[156:159], v[136:139]
    v_mfma_f32_16x16x32_bf16 v[140:143], v[156:159], v[196:199], v[140:143]
    v_mfma_f32_16x16x32_bf16 v[144:147], v[156:159], v[200:203], v[144:147]
    s_waitcnt lgkmcnt(0)
    s_barrier
    v_mfma_f32_16x16x32_bf16 v[52:55], v[204:207], v[160:163], v[52:55]
    ds_read_b128 v[148:151], v40 offset:49152
    v_mfma_f32_16x16x32_bf16 v[56:59], v[208:211], v[160:163], v[56:59]
    ds_read_b64_tr_b16 v[172:173], v42 offset:32768
    v_mfma_f32_16x16x32_bf16 v[60:63], v[212:215], v[160:163], v[60:63]
    ds_read_b64_tr_b16 v[174:175], v42 offset:33792
    v_mfma_f32_16x16x32_bf16 v[64:67], v[216:219], v[160:163], v[64:67]
    ds_read_b128 v[152:155], v40 offset:51200
    v_mfma_f32_16x16x32_bf16 v[68:71], v[220:223], v[160:163], v[68:71]
    ds_read_b128 v[156:159], v40 offset:53248
    v_mfma_f32_16x16x32_bf16 v[72:75], v[224:227], v[160:163], v[72:75]
    ds_read_b64_tr_b16 v[176:177], v43 offset:32768
    v_mfma_f32_16x16x32_bf16 v[76:79], v[160:163], v[228:231], v[76:79]
    ds_read_b64_tr_b16 v[178:179], v43 offset:33792
    v_mfma_f32_16x16x32_bf16 v[80:83], v[160:163], v[232:235], v[80:83]
    ds_read_b64_tr_b16 v[180:181], v44 offset:32768
    v_mfma_f32_16x16x32_bf16 v[112:115], v[164:167], v[232:235], v[112:115]
    ds_read_b64_tr_b16 v[182:183], v44 offset:33792
    v_mfma_f32_16x16x32_bf16 v[108:111], v[164:167], v[228:231], v[108:111]
    ds_read_b64_tr_b16 v[184:185], v45 offset:32768
    v_mfma_f32_16x16x32_bf16 v[104:107], v[224:227], v[164:167], v[104:107]
    ds_read_b64_tr_b16 v[186:187], v45 offset:33792
    v_mfma_f32_16x16x32_bf16 v[100:103], v[220:223], v[164:167], v[100:103]
    ds_read_b64_tr_b16 v[188:189], v46 offset:32768
    v_mfma_f32_16x16x32_bf16 v[96:99], v[216:219], v[164:167], v[96:99]
    ds_read_b64_tr_b16 v[190:191], v46 offset:33792
    v_mfma_f32_16x16x32_bf16 v[92:95], v[212:215], v[164:167], v[92:95]
    ds_read_b64_tr_b16 v[192:193], v47 offset:32768
    v_mfma_f32_16x16x32_bf16 v[88:91], v[208:211], v[164:167], v[88:91]
    ds_read_b64_tr_b16 v[194:195], v47 offset:33792
    v_mfma_f32_16x16x32_bf16 v[84:87], v[204:207], v[164:167], v[84:87]
    ds_read_b64_tr_b16 v[196:197], v48 offset:32768
    v_mfma_f32_16x16x32_bf16 v[116:119], v[204:207], v[168:171], v[116:119]
    ds_read_b64_tr_b16 v[198:199], v48 offset:33792
    v_mfma_f32_16x16x32_bf16 v[120:123], v[208:211], v[168:171], v[120:123]
    ds_read_b64_tr_b16 v[200:201], v49 offset:32768
    v_mfma_f32_16x16x32_bf16 v[124:127], v[212:215], v[168:171], v[124:127]
    ds_read_b64_tr_b16 v[202:203], v49 offset:33792
    v_mfma_f32_16x16x32_bf16 v[128:131], v[216:219], v[168:171], v[128:131]
    s_sub_u32 s52, s52, 1
    v_mfma_f32_16x16x32_bf16 v[132:135], v[220:223], v[168:171], v[132:135]
    s_cmp_lg_u32 s52, 0
    v_mfma_f32_16x16x32_bf16 v[136:139], v[224:227], v[168:171], v[136:139]
    v_mfma_f32_16x16x32_bf16 v[140:143], v[168:171], v[228:231], v[140:143]
    v_mfma_f32_16x16x32_bf16 v[144:147], v[168:171], v[232:235], v[144:147]
    s_cbranch_scc1 K_CLOOP
    s_waitcnt lgkmcnt(0)
    v_mfma_f32_16x16x32_bf16 v[52:55], v[172:175], v[148:151], v[52:55]
    ds_read_b128 v[160:163], v41 offset:49152
    ds_read_b64_tr_b16 v[204:205], v42 offset:40960
    v_mfma_f32_16x16x32_bf16 v[116:119], v[172:175], v[156:159], v[116:119]
    ds_read_b64_tr_b16 v[206:207], v42 offset:41984
    ds_read_b128 v[164:167], v41 offset:51200
    v_mfma_f32_16x16x32_bf16 v[84:87], v[172:175], v[152:155], v[84:87]
    ds_read_b128 v[168:171], v41 offset:53248
    ds_read_b64_tr_b16 v[208:209], v43 offset:40960
    v_mfma_f32_16x16x32_bf16 v[56:59], v[176:179], v[148:151], v[56:59]
    ds_read_b64_tr_b16 v[210:211], v43 offset:41984
    ds_read_b64_tr_b16 v[212:213], v44 offset:40960
    v_mfma_f32_16x16x32_bf16 v[120:123], v[176:179], v[156:159], v[120:123]
    ds_read_b64_tr_b16 v[214:215], v44 offset:41984
    ds_read_b64_tr_b16 v[216:217], v45 offset:40960
    v_mfma_f32_16x16x32_bf16 v[88:91], v[176:179], v[152:155], v[88:91]
    ds_read_b64_tr_b16 v[218:219], v45 offset:41984
    ds_read_b64_tr_b16 v[220:221], v46 offset:40960
    v_mfma_f32_16x16x32_bf16 v[60:63], v[180:183], v[148:151], v[60:63]
    ds_read_b64_tr_b16 v[222:223], v46 offset:41984
    ds_read_b64_tr_b16 v[224:225], v47 offset:40960
    v_mfma_f32_16x16x32_bf16 v[124:127], v[180:183], v[156:159], v[124:127]
    ds_read_b64_tr_b16 v[226:227], v47 offset:41984
    ds_read_b64_tr_b16 v[228:229], v48 offset:40960
    v_mfma_f32_16x16x32_bf16 v[92:95], v[180:183], v[152:155], v[92:95]
    ds_read_b64_tr_b16 v[230:231], v48 offset:41984
    ds_read_b64_tr_b16 v[232:233], v49 offset:40960
    v_mfma_f32_16x16x32_bf16 v[64:67], v[184:187], v[148:151], v[64:67]
    ds_read_b64_tr_b16 v[234:235], v49 offset:41984
    v_mfma_f32_16x16x32_bf16 v[128:131], v[184:187], v[156:159], v[128:131]
    s_nop 1
    v_mfma_f32_16x16x32_bf16 v[96:99], v[184:187], v[152:155], v[96:99]
    s_nop 1
    s_waitcnt lgkmcnt(15)
    v_mfma_f32_16x16x32_bf16 v[52:55], v[204:207], v[160:163], v[52:55]
    s_nop 1
    s_waitcnt lgkmcnt(12)
    v_mfma_f32_16x16x32_bf16 v[56:59], v[208:211], v[160:163], v[56:59]
    s_nop 1
    v_mfma_f32_16x16x32_bf16 v[116:119], v[204:207], v[168:171], v[116:119]
    s_nop 1
    v_mfma_f32_16x16x32_bf16 v[120:123], v[208:211], v[168:171], v[120:123]
    s_nop 1
    v_mfma_f32_16x16x32_bf16 v[84:87], v[204:207], v[164:167], v[84:87]
    v_cvt_pk_bf16_f32 v52, v52, v53
    v_cvt_pk_bf16_f32 v53, v54, v55
    v_mfma_f32_16x16x32_bf16 v[88:91], v[208:211], v[164:167], v[88:91]
    v_cvt_pk_bf16_f32 v54, v56, v57
    v_cvt_pk_bf16_f32 v55, v58, v59
    s_waitcnt lgkmcnt(10)
    v_mfma_f32_16x16x32_bf16 v[60:63], v[212:215], v[160:163], v[60:63]
    ds_write_b128 v13, v[52:55] offset:0
    s_waitcnt lgkmcnt(9)
    v_mfma_f32_16x16x32_bf16 v[64:67], v[216:219], v[160:163], v[64:67]
    v_cvt_pk_bf16_f32 v116, v116, v117
    v_cvt_pk_bf16_f32 v117, v118, v119
    v_mfma_f32_16x16x32_bf16 v[124:127], v[212:215], v[168:171], v[124:127]
    v_cvt_pk_bf16_f32 v118, v120, v121
    v_cvt_pk_bf16_f32 v119, v122, v123
    v_mfma_f32_16x16x32_bf16 v[128:131], v[216:219], v[168:171], v[128:131]
    ds_write_b128 v13, v[116:119] offset:2048
    v_mfma_f32_16x16x32_bf16 v[92:95], v[212:215], v[164:167], v[92:95]
    v_cvt_pk_bf16_f32 v84, v84, v85
    v_cvt_pk_bf16_f32 v85, v86, v87
    v_mfma_f32_16x16x32_bf16 v[96:99], v[216:219], v[164:167], v[96:99]
    v_cvt_pk_bf16_f32 v86, v88, v89
    v_cvt_pk_bf16_f32 v87, v90, v91
    v_mfma_f32_16x16x32_bf16 v[68:71], v[188:191], v[148:151], v[68:71]
    ds_write_b128 v13, v[84:87] offset:1024
    v_mfma_f32_16x16x32_bf16 v[72:75], v[192:195], v[148:151], v[72:75]
    v_cvt_pk_bf16_f32 v60, v60, v61
    v_cvt_pk_bf16_f32 v61, v62, v63
    s_waitcnt lgkmcnt(9)
    v_mfma_f32_16x16x32_bf16 v[68:71], v[220:223], v[160:163], v[68:71]
    v_cvt_pk_bf16_f32 v64, v64, v65
    v_cvt_pk_bf16_f32 v65, v66, v67
    s_waitcnt lgkmcnt(7)
    v_mfma_f32_16x16x32_bf16 v[72:75], v[224:227], v[160:163], v[72:75]
    ds_write2st64_b64 v14, v[60:61], v[64:65] offset0:4 offset1:5
    v_mfma_f32_16x16x32_bf16 v[132:135], v[188:191], v[156:159], v[132:135]
    ds_read_b64 v[62:63], v13 offset:0
    ds_read_b64 v[66:67], v13 offset:0
    v_mfma_f32_16x16x32_bf16 v[136:139], v[192:195], v[156:159], v[136:139]
    v_cvt_pk_bf16_f32 v124, v124, v125
    v_cvt_pk_bf16_f32 v125, v126, v127
    v_mfma_f32_16x16x32_bf16 v[132:135], v[220:223], v[168:171], v[132:135]
    v_cvt_pk_bf16_f32 v128, v128, v129
    v_cvt_pk_bf16_f32 v129, v130, v131
    v_mfma_f32_16x16x32_bf16 v[136:139], v[224:227], v[168:171], v[136:139]
    ds_write2st64_b64 v14, v[124:125], v[128:129] offset0:10 offset1:11
    v_mfma_f32_16x16x32_bf16 v[100:103], v[188:191], v[152:155], v[100:103]
    ds_read_b64 v[126:127], v13 offset:2048
    ds_read_b64 v[130:131], v13 offset:2048
    v_mfma_f32_16x16x32_bf16 v[104:107], v[192:195], v[152:155], v[104:107]
    v_cvt_pk_bf16_f32 v92, v92, v93
    v_cvt_pk_bf16_f32 v93, v94, v95
    v_mfma_f32_16x16x32_bf16 v[100:103], v[220:223], v[164:167], v[100:103]
    v_cvt_pk_bf16_f32 v96, v96, v97
    v_cvt_pk_bf16_f32 v97, v98, v99
    v_mfma_f32_16x16x32_bf16 v[104:107], v[224:227], v[164:167], v[104:107]
    ds_read_b64 v[94:95], v13 offset:1024
    ds_read_b64 v[98:99], v13 offset:1024
    v_mfma_f32_16x16x32_bf16 v[76:79], v[148:151], v[196:199], v[76:79]
    v_cvt_pk_bf16_f32 v68, v68, v69
    v_cvt_pk_bf16_f32 v69, v70, v71
    v_mfma_f32_16x16x32_bf16 v[80:83], v[148:151], v[200:203], v[80:83]
    v_cvt_pk_bf16_f32 v72, v72, v73
    v_cvt_pk_bf16_f32 v73, v74, v75
    s_waitcnt lgkmcnt(13)
    v_mfma_f32_16x16x32_bf16 v[76:79], v[160:163], v[228:231], v[76:79]
    ds_write2st64_b64 v14, v[68:69], v[72:73] offset0:8 offset1:9
    s_waitcnt lgkmcnt(12)
    v_mfma_f32_16x16x32_bf16 v[80:83], v[160:163], v[232:235], v[80:83]
    ds_write_b32 v50, v4
    v_cvt_pk_bf16_f32 v132, v132, v133
    v_mfma_f32_16x16x32_bf16 v[140:143], v[156:159], v[196:199], v[140:143]
    v_cvt_pk_bf16_f32 v133, v134, v135
    v_cvt_pk_bf16_f32 v136, v136, v137
    v_mfma_f32_16x16x32_bf16 v[144:147], v[156:159], v[200:203], v[144:147]
    v_cvt_pk_bf16_f32 v137, v138, v139
    ds_read_b64 v[134:135], v18 offset:2048
    v_mfma_f32_16x16x32_bf16 v[140:143], v[168:171], v[228:231], v[140:143]
    ds_read_b64 v[138:139], v19 offset:2048
    v_cvt_pk_bf16_f32 v100, v100, v101
    v_mfma_f32_16x16x32_bf16 v[144:147], v[168:171], v[232:235], v[144:147]
    v_cvt_pk_bf16_f32 v101, v102, v103
    v_cvt_pk_bf16_f32 v104, v104, v105
    v_mfma_f32_16x16x32_bf16 v[108:111], v[152:155], v[196:199], v[108:111]
    v_cvt_pk_bf16_f32 v105, v106, v107
    ds_read_b64 v[102:103], v18 offset:1024
    v_mfma_f32_16x16x32_bf16 v[112:115], v[152:155], v[200:203], v[112:115]
    ds_read_b64 v[106:107], v19 offset:1024
    v_cvt_pk_bf16_f32 v236, v76, v77
    v_mfma_f32_16x16x32_bf16 v[108:111], v[164:167], v[228:231], v[108:111]
    v_cvt_pk_bf16_f32 v237, v78, v79
    v_cvt_pk_bf16_f32 v242, v80, v81
    v_mfma_f32_16x16x32_bf16 v[112:115], v[164:167], v[232:235], v[112:115]
    v_cvt_pk_bf16_f32 v243, v82, v83
    v_cvt_pk_bf16_f32 v240, v140, v141
    s_branch WS_attd
.p2align 12
WP_attd:
    s_setpc_b64 s[38:39]
WS_attd:
    s_waitcnt lgkmcnt(3)
    v_mfma_f32_16x16x32_bf16 v[208:211], v[124:127], v[132:135], v[28:31]
    ds_write2st64_b64 v14, v[236:237], v[242:243] offset0:6 offset1:7
    v_mfma_f32_16x16x32_bf16 v[204:207], v[92:95], v[132:135], v[24:27]
    v_cvt_pk_bf16_f32 v241, v142, v143
    v_cvt_pk_bf16_f32 v246, v144, v145
    s_waitcnt lgkmcnt(3)
    v_mfma_f32_16x16x32_bf16 v[216:219], v[128:131], v[136:139], v[28:31]
    v_cvt_pk_bf16_f32 v247, v146, v147
    ds_read_b64_tr_b16 v[188:189], v20 offset:0
    v_mfma_f32_16x16x32_bf16 v[212:215], v[96:99], v[136:139], v[24:27]
    ds_write2st64_b64 v14, v[240:241], v[246:247] offset0:12 offset1:13
    s_waitcnt lgkmcnt(4)
    v_mfma_f32_16x16x32_bf16 v[176:179], v[92:95], v[100:103], v[28:31]
    ds_write_b32 v50, v5
    v_max3_f32 v72, v204, v205, v208
    v_mfma_f32_16x16x32_bf16 v[172:175], v[60:63], v[100:103], v[32:35]
    v_max3_f32 v73, v206, v207, v210
    v_max_f32 v72, v72, v209
    s_waitcnt lgkmcnt(4)
    v_mfma_f32_16x16x32_bf16 v[184:187], v[96:99], v[104:107], v[28:31]
    v_max_f32 v73, v73, v211
    v_max3_f32 v74, v212, v213, v216
    v_mfma_f32_16x16x32_bf16 v[180:183], v[64:67], v[104:107], v[32:35]
    v_max3_f32 v75, v214, v215, v218
    v_max_f32 v74, v74, v217
    ds_read_b64_tr_b16 v[190:191], v20 offset:1024
    ds_read_b64_tr_b16 v[192:193], v21 offset:0
    ds_read_b64_tr_b16 v[194:195], v21 offset:1024
    ds_read_b64_tr_b16 v[220:221], v22 offset:1024
    ds_read_b64_tr_b16 v[222:223], v22 offset:2048
    ds_read_b64_tr_b16 v[224:225], v23 offset:1024
    ds_read_b64_tr_b16 v[226:227], v23 offset:2048
    v_max_f32 v75, v75, v219
    v_max3_f32 v68, v172, v173, v176
    v_max3_f32 v69, v174, v175, v178
    v_max_f32 v68, v68, v177
    v_max_f32 v69, v69, v179
    v_max3_f32 v70, v180, v181, v184
    v_max3_f32 v71, v182, v183, v186
    v_max_f32 v70, v70, v185
    v_max_f32 v71, v71, v187
    v_permlane16_swap_b32 v72, v74
    v_permlane16_swap_b32 v73, v75
    v_permlane16_swap_b32 v68, v70
    v_permlane16_swap_b32 v69, v71
    v_cvt_pk_bf16_f32 v238, v108, v109
    v_permlane32_swap_b32 v68, v72
    v_permlane32_swap_b32 v70, v74
    v_permlane32_swap_b32 v69, v73
    v_permlane32_swap_b32 v71, v75
    v_max3_f32 v120, v68, v69, v72
    v_max3_f32 v121, v73, v70, v71
    v_max3_f32 v120, v120, v74, v75
    v_max_f32 v120, v120, v121
    v_mul_f32 v120, s46, v120
    v_pk_fma_f32 v[68:69], v[68:69], s[46:47], v[120:121] op_sel_hi:[1,1,0] neg_lo:[0,0,1] neg_hi:[0,0,1]
    v_pk_fma_f32 v[70:71], v[70:71], s[46:47], v[120:121] op_sel_hi:[1,1,0] neg_lo:[0,0,1] neg_hi:[0,0,1]
    v_pk_fma_f32 v[72:73], v[72:73], s[46:47], v[120:121] op_sel_hi:[1,1,0] neg_lo:[0,0,1] neg_hi:[0,0,1]
    v_pk_fma_f32 v[74:75], v[74:75], s[46:47], v[120:121] op_sel_hi:[1,1,0] neg_lo:[0,0,1] neg_hi:[0,0,1]
    v_exp_f32 v68, v68
    v_exp_f32 v69, v69
    v_exp_f32 v70, v70
    v_exp_f32 v71, v71
    v_exp_f32 v72, v72
    v_exp_f32 v73, v73
    v_exp_f32 v74, v74
    v_exp_f32 v75, v75
    v_pk_add_f32 v[56:57], v[68:69], v[70:71]
    v_pk_add_f32 v[58:59], v[72:73], v[74:75]
    v_pk_add_f32 v[56:57], v[56:57], v[58:59]
    v_add_f32 v56, v56, v57
    v_rcp_f32 v56, v56
    s_waitcnt lgkmcnt(0)
    v_pk_mul_f32 v[68:69], v[68:69], v[56:57] op_sel_hi:[1,0]
    v_pk_mul_f32 v[70:71], v[70:71], v[56:57] op_sel_hi:[1,0]
    v_pk_mul_f32 v[72:73], v[72:73], v[56:57] op_sel_hi:[1,0]
    v_pk_mul_f32 v[74:75], v[74:75], v[56:57] op_sel_hi:[1,0]
    v_cvt_pk_bf16_f32 v88, v68, v69
    v_cvt_pk_bf16_f32 v90, v72, v73
    v_cvt_pk_bf16_f32 v89, v70, v71
    v_cvt_pk_bf16_f32 v91, v74, v75
    v_permlane32_swap_b32 v88, v90
    v_cvt_pk_bf16_f32 v239, v110, v111
    v_permlane32_swap_b32 v89, v91
    v_cvt_pk_bf16_f32 v244, v112, v113
    v_cvt_pk_bf16_f32 v245, v114, v115
    v_permlane16_swap_b32 v88, v89
    v_permlane16_swap_b32 v90, v91
    v_perm_b32 v148, v88, v88, v36
    v_perm_b32 v149, v88, v88, v37
    v_perm_b32 v150, v88, v88, v38
    v_perm_b32 v151, v88, v88, v39
    v_perm_b32 v152, v89, v89, v36
    v_perm_b32 v153, v89, v89, v37
    v_mfma_f32_16x16x32_bf16 v[100:103], v[236:239], v[148:151], 0
    v_perm_b32 v154, v89, v89, v38
    v_perm_b32 v155, v89, v89, v39
    v_mfma_f32_16x16x32_bf16 v[156:159], v[188:191], v[148:151], 0
    v_perm_b32 v160, v90, v90, v36
    v_perm_b32 v161, v90, v90, v37
    v_mfma_f32_16x16x32_bf16 v[104:107], v[242:245], v[152:155], 0
    v_perm_b32 v162, v90, v90, v38
    v_perm_b32 v163, v90, v90, v39
    v_mfma_f32_16x16x32_bf16 v[156:159], v[192:195], v[152:155], v[156:159]
    v_perm_b32 v164, v91, v91, v36
    v_perm_b32 v165, v91, v91, v37
    v_mfma_f32_16x16x32_bf16 v[132:135], v[238:241], v[160:163], 0
    v_perm_b32 v166, v91, v91, v38
    v_perm_b32 v167, v91, v91, v39
    v_mfma_f32_16x16x32_bf16 v[156:159], v[220:223], v[160:163], v[156:159]
    v_cvt_pk_bf16_f32 v60, v100, v101
    v_cvt_pk_bf16_f32 v61, v102, v103
    v_mfma_f32_16x16x32_bf16 v[156:159], v[224:227], v[164:167], v[156:159]
    v_cvt_pk_bf16_f32 v62, v104, v105
    v_cvt_pk_bf16_f32 v63, v106, v107
    v_mfma_f32_16x16x32_bf16 v[136:139], v[244:247], v[164:167], 0
    buffer_store_dwordx4 v[60:63], v15, s[20:23], s50 offen sc1
    v_cvt_pk_bf16_f32 v64, v132, v133
    v_cvt_pk_bf16_f32 v65, v134, v135
    s_nop 1
    v_cvt_pk_bf16_f32 v56, v156, v157
    v_cvt_pk_bf16_f32 v57, v158, v159
    v_cvt_pk_bf16_f32 v58, v156, v157
    v_cvt_pk_bf16_f32 v59, v158, v159
    v_cvt_pk_bf16_f32 v66, v136, v137
    v_cvt_pk_bf16_f32 v67, v138, v139
    v_permlane16_swap_b32 v56, v58
    v_permlane16_swap_b32 v57, v59
    buffer_store_dwordx4 v[64:67], v15, s[20:23], s51 offen sc1
    buffer_store_dwordx4 v[56:59], v16, s[20:23], s50 offen sc1
    s_cmp_lg_u32 s34, -1
    s_cbranch_scc1 K_P2_EARLY
K_DRAIN:
    s_waitcnt vmcnt(0)
    s_barrier
    s_branch K_END
K_W7A:
    s_waitcnt vmcnt(0)
    v_and_b32 v4, 7, v1
    v_lshlrev_b32 v4, 2, v4
    s_mov_b32 s3, 131072
K_ZPOLL5:
    v_cmp_eq_u32 vcc, 0, v7
    s_cbranch_vccz K_ZOK5
    s_sub_u32 s3, s3, 1
    s_cbranch_scc1 K_ZOK5
    global_load_dword v7, v4, s[8:9] offset:192 sc1
    s_waitcnt vmcnt(0)
    s_branch K_ZPOLL5
K_ZOK5:
    v_mov_b32 v4, 158720
    v_mov_b32 v3, 1
    s_mov_b64 exec, 1
    s_nop 0
    ds_add_rtn_u32 v2, v4, v3 offset:48
    s_mov_b32 exec_lo, s36
    v_mov_b32 v3, 1
    s_waitcnt lgkmcnt(0)
    v_readfirstlane_b32 s33, v2
    s_nop 3
    s_and_b32 s33, s33, 0xff
    s_cmp_lg_u32 s33, 7
    s_cbranch_scc1 K_ARR7
    global_store_dword v8, v3, s[10:11] sc1
K_ARR7:
    s_mov_b64 exec, -1
    v_mov_b32 v6, 158800
    s_mov_b32 s3, 1048576
K_XG7:
    ds_read_b128 v[2:5], v6
    s_sleep 1
    s_sub_u32 s3, s3, 1
    s_waitcnt lgkmcnt(0)
    v_min3_u32 v2, v2, v4, v5
    v_min_u32 v2, v2, v3
    s_nop 0
    v_readfirstlane_b32 s33, v2
    s_nop 3
    s_cselect_b32 s33, 1, s33
    s_cmp_lt_u32 s33, 1
    s_cbranch_scc1 K_XG7
    v_mov_b32 v4, 158720
    s_branch K_WOE
K_W7:
    v_mov_b32 v3, 0x100
    s_mov_b64 exec, 1
    s_waitcnt vmcnt(0)
    ds_add_u32 v4, v3 offset:48
    s_mov_b64 exec, -1
    s_branch K_P2_HELP
K_FLAG:
    s_waitcnt vmcnt(0)
    v_and_b32 v4, 7, v1
    v_lshlrev_b32 v4, 2, v4
    s_mov_b32 s3, 131072
K_ZPOLL0:
    v_cmp_eq_u32 vcc, 0, v7
    s_cbranch_vccz K_ZOK0
    s_sub_u32 s3, s3, 1
    s_cbranch_scc1 K_ZOK0
    global_load_dword v7, v4, s[8:9] offset:192 sc1
    s_waitcnt vmcnt(0)
    s_branch K_ZPOLL0
K_ZOK0:
    v_mov_b32 v3, 1
    s_mov_b32 exec_lo, s36
    s_mov_b32 exec_hi, 0
    s_setprio 3
    s_barrier
    global_store_dword v8, v3, s[10:11] sc1
    s_mov_b64 exec, -1
    s_branch K_END
WP_atts:
    s_setpc_b64 s[38:39]
K_JOIN_S:
    s_setprio 0
    s_cmp_eq_u32 s30, 7
    s_cbranch_scc1 K_FLAG
    s_lshl_b32 s3, s30, 2
    s_add_u32 s3, s3, 158784
    v_mov_b32 v6, s3
    s_mov_b32 s3, 1048576
K_XG1:
    ds_read2_b32 v[2:3], v6 offset0:0 offset1:1
    s_sleep 1
    s_sub_u32 s3, s3, 1
    s_waitcnt lgkmcnt(0)
    v_min_u32 v2, v2, v3
    s_nop 0
    v_readfirstlane_b32 s33, v2
    s_nop 3
    s_cselect_b32 s33, 1, s33
    s_cmp_lt_u32 s33, 1
    s_cbranch_scc1 K_XG1
    ds_read_b64 v[40:41], v14 offset:4096
    ds_read_b64 v[42:43], v18 offset:1024
    ds_read_b64 v[48:49], v14 offset:0
    ds_read_b64 v[50:51], v13 offset:0
    ds_read_b64 v[52:53], v14 offset:2048
    ds_read_b64 v[54:55], v13 offset:1024
    ds_read_b64 v[44:45], v14 offset:4608
    ds_read_b64 v[46:47], v19 offset:1024
    ds_read_b64 v[56:57], v14 offset:512
    ds_read_b64 v[58:59], v13 offset:0
    ds_read_b64 v[60:61], v14 offset:2560
    ds_read_b64 v[62:63], v13 offset:1024
    s_waitcnt lgkmcnt(8)
    v_mfma_f32_16x16x32_bf16 v[80:83], v[48:51], v[40:43], v[24:27]
    s_waitcnt lgkmcnt(6)
    v_mfma_f32_16x16x32_bf16 v[84:87], v[52:55], v[40:43], v[28:31]
    s_waitcnt lgkmcnt(2)
    v_mfma_f32_16x16x32_bf16 v[88:91], v[56:59], v[44:47], v[24:27]
    s_waitcnt lgkmcnt(0)
    v_mfma_f32_16x16x32_bf16 v[92:95], v[60:63], v[44:47], v[28:31]
    ds_read_b64_tr_b16 v[72:73], v20 offset:0
    ds_read_b64_tr_b16 v[74:75], v20 offset:1024
    ds_read_b64_tr_b16 v[76:77], v21 offset:0
    ds_read_b64_tr_b16 v[78:79], v21 offset:1024
    v_max3_f32 v116, v80, v81, v84
    v_max3_f32 v117, v82, v83, v86
    v_max_f32 v116, v116, v85
    v_max_f32 v117, v117, v87
    v_max3_f32 v118, v88, v89, v92
    v_max3_f32 v119, v90, v91, v94
    v_max_f32 v118, v118, v93
    v_max_f32 v119, v119, v95
    s_nop 0
    v_permlane16_swap_b32 v116, v118
    v_permlane16_swap_b32 v117, v119
    v_max3_f32 v130, v116, v117, v118
    v_max_f32 v130, v130, v119
    v_mov_b32 v131, v130
    s_nop 1
    v_permlane32_swap_b32 v130, v131
    v_max_f32 v130, v130, v131
    v_mul_f32 v130, s46, v130
    v_pk_fma_f32 v[116:117], v[116:117], s[46:47], v[130:131] op_sel_hi:[1,1,0] neg_lo:[0,0,1] neg_hi:[0,0,1]
    v_pk_fma_f32 v[118:119], v[118:119], s[46:47], v[130:131] op_sel_hi:[1,1,0] neg_lo:[0,0,1] neg_hi:[0,0,1]
    v_exp_f32 v116, v116
    v_exp_f32 v117, v117
    v_exp_f32 v118, v118
    v_exp_f32 v119, v119
    s_nop 0
    v_pk_add_f32 v[120:121], v[116:117], v[118:119]
    v_add_f32 v120, v120, v121
    v_mov_b32 v121, v120
    s_nop 1
    v_permlane32_swap_b32 v120, v121
    v_add_f32 v120, v120, v121
    v_rcp_f32 v120, v120
    s_waitcnt lgkmcnt(0)
    v_pk_mul_f32 v[116:117], v[116:117], v[120:121] op_sel_hi:[1,0]
    v_pk_mul_f32 v[118:119], v[118:119], v[120:121] op_sel_hi:[1,0]
    v_cvt_pk_bf16_f32 v128, v116, v117
    v_cvt_pk_bf16_f32 v129, v118, v119
    s_nop 1
    v_permlane16_swap_b32 v128, v129
    s_mov_b32 s3, 1048576
K_XG2:
    ds_read2_b32 v[2:3], v6 offset0:0 offset1:1
    s_sleep 1
    s_sub_u32 s3, s3, 1
    s_waitcnt lgkmcnt(0)
    v_min_u32 v2, v2, v3
    s_nop 0
    v_readfirstlane_b32 s33, v2
    s_nop 3
    s_cselect_b32 s33, 2, s33
    s_cmp_lt_u32 s33, 2
    s_cbranch_scc1 K_XG2
    ds_read_b64 v[64:65], v14 offset:1024
    ds_read_b64 v[66:67], v14 offset:3072
    ds_read_b64 v[68:69], v14 offset:1536
    ds_read_b64 v[70:71], v14 offset:3584
    v_perm_b32 v96, v128, v128, v36
    v_perm_b32 v97, v128, v128, v37
    v_perm_b32 v98, v128, v128, v38
    v_perm_b32 v99, v128, v128, v39
    v_perm_b32 v100, v129, v129, v36
    v_perm_b32 v101, v129, v129, v37
    s_waitcnt lgkmcnt(2)
    v_mfma_f32_16x16x32_bf16 v[104:107], v[64:67], v[96:99], 0
    v_perm_b32 v102, v129, v129, v38
    v_perm_b32 v103, v129, v129, v39
    v_mfma_f32_16x16x32_bf16 v[112:115], v[72:75], v[96:99], 0
    s_nop 0
    v_mfma_f32_16x16x32_bf16 v[112:115], v[76:79], v[100:103], v[112:115]
    s_waitcnt lgkmcnt(0)
    v_mfma_f32_16x16x32_bf16 v[108:111], v[68:71], v[100:103], 0
    s_nop 0
    v_cvt_pk_bf16_f32 v124, v104, v105
    v_cvt_pk_bf16_f32 v125, v106, v107
    s_nop 2
    v_cvt_pk_bf16_f32 v120, v112, v113
    v_cvt_pk_bf16_f32 v121, v114, v115
    v_cvt_pk_bf16_f32 v122, v112, v113
    v_cvt_pk_bf16_f32 v123, v114, v115
    v_cvt_pk_bf16_f32 v126, v108, v109
    v_cvt_pk_bf16_f32 v127, v110, v111
    v_permlane16_swap_b32 v120, v122
    v_permlane16_swap_b32 v121, v123
    buffer_store_dwordx4 v[124:127], v15, s[20:23], s50 offen sc1
    buffer_store_dwordx4 v[120:123], v16, s[20:23], s50 offen sc1
    s_cmp_eq_u32 s34, -1
    s_cbranch_scc1 K_DRAIN
    s_cmp_lg_u32 s30, 6
    s_cbranch_scc1 K_NOFL
    s_waitcnt vmcnt(2)
    v_and_b32 v4, 7, v1
    v_lshlrev_b32 v4, 2, v4
    s_mov_b32 s3, 131072
K_ZPOLL2:
    v_cmp_eq_u32 vcc, 0, v7
    s_cbranch_vccz K_ZOK2
    s_sub_u32 s3, s3, 1
    s_cbranch_scc1 K_ZOK2
    global_load_dword v7, v4, s[8:9] offset:192 sc1
    s_waitcnt vmcnt(0)
    s_branch K_ZPOLL2
K_ZOK2:
    v_and_b32 v2, 1, v1
    v_lshl_add_u32 v2, v2, 2, s42
    global_load_dword v7, v2, s[10:11] offset:128 sc1
K_NOFL:
    v_mov_b32 v4, 158720
    v_mov_b32 v3, 257
    s_mov_b64 exec, 1
    s_waitcnt vmcnt(0)
    ds_add_rtn_u32 v2, v4, v3 offset:48
    s_mov_b32 exec_lo, s36
    v_mov_b32 v3, 1
    s_waitcnt lgkmcnt(0)
    v_readfirstlane_b32 s33, v2
    s_nop 3
    s_and_b32 s33, s33, 0xff
    s_cmp_lg_u32 s33, 7
    s_cbranch_scc1 K_ARRS
    global_store_dword v8, v3, s[10:11] sc1
K_ARRS:
    s_mov_b64 exec, -1
    s_cmp_ge_u32 s30, 6
    s_cbranch_scc1 K_P2_HELP
    s_branch K_LATE
WP_early:
    s_setpc_b64 s[38:39]
K_P2_EARLY:
    s_lshl_b32 s54, s40, 7
    v_lshrrev_b32 v9, 4, v1
    v_mov_b32 v12, 158720
    s_add_u32 s20, s10, 0x100000
    s_addc_u32 s21, s11, 0
    s_mov_b32 s22, 0x280000
    s_mov_b32 s23, 0x20000
    s_add_u32 s16, s10, 0x1000
    s_addc_u32 s17, s11, 0
    s_mov_b32 s18, 0x2000
    s_mov_b32 s19, 0x20000
    s_mov_b32 s48, s6
    s_mov_b32 s49, s7
    s_mov_b32 s50, 0x280000
    s_mov_b32 s51, 0x20000
    s_lshl_b32 s53, s40, 3
    s_lshl1_add_u32 s53, s30, s53
    s_mov_b32 s55, 20480
    v_bfe_u32 v20, v1, 2, 2
    v_and_b32 v21, 3, v1
    s_mul_i32 s3, s53, 20480
    v_lshl_add_u32 v25, v1, 4, s3
    v_add_u32 v26, 20480, v25
    v_add_u32 v35, 16384, v25
    v_add_u32 v36, 16384, v26
    v_and_b32 v2, 15, v1
    s_lshl_b32 s3, s53, 6
    v_lshl_add_u32 v23, v2, 2, s3
    v_lshl_add_u32 v2, v9, 2, v20
    v_bfe_u32 v3, v2, 1, 2
    v_lshlrev_b32 v2, 7, v2
    v_lshl_add_u32 v2, v21, 3, v2
    v_lshl_add_u32 v24, v3, 5, v2
    v_lshrrev_b32 v3, 1, v20
    v_mul_u32_u24 v2, 40, v9
    v_add3_u32 v2, v2, 16, v20
    v_lshlrev_b32 v2, 7, v2
    v_lshl_add_u32 v2, v21, 3, v2
    v_xor_b32 v4, 0, v3
    v_lshl_add_u32 v60, v4, 5, v2
    v_xor_b32 v4, 1, v3
    v_lshl_add_u32 v61, v4, 5, v2
    v_xor_b32 v4, 2, v3
    v_lshl_add_u32 v62, v4, 5, v2
    v_xor_b32 v4, 3, v3
    v_lshl_add_u32 v63, v4, 5, v2
    v_lshrrev_b32 v3, 4, v1
    v_and_b32 v4, 7, v1
    v_lshrrev_b32 v2, 3, v1
    v_xor_b32 v4, v4, v3
    v_mul_u32_u24 v2, 1280, v2
    v_lshl_add_u32 v27, v4, 4, v2
    v_xor_b32 v28, 64, v27
    s_lshl_b32 s71, s40, 3
    s_lshl1_add_u32 s71, s30, s71
    s_mul_i32 s71, s71, 20480
    s_lshl_b32 s33, s41, 7
    s_add_u32 s71, s71, s33
    s_add_u32 s72, s71, 10240
    s_add_u32 s73, s71, 20480
    s_add_u32 s74, s71, 30720
    s_lshl_b32 s3, s30, 12
    s_add_u32 s3, s3, 140288
    v_lshl_add_u32 v33, v1, 4, s3
    v_and_b32 v2, 15, v1
    v_lshrrev_b32 v3, 1, v2
    v_lshrrev_b32 v4, 5, v1
    v_xor_b32 v3, v3, v4
    v_lshlrev_b32 v3, 4, v3
    v_lshl_add_u32 v3, v2, 7, v3
    v_and_b32 v4, 1, v9
    v_lshl_add_u32 v3, v4, 3, v3
    v_add_u32 v29, s3, v3
    v_xor_b32 v30, 32, v29
    v_xor_b32 v31, 64, v29
    v_xor_b32 v32, 96, v29
    s_and_b32 s33, s40, 3
    s_lshl_b32 s33, s33, 3
    s_lshr_b32 s33, 0x7f06037f, s33
    s_and_b32 s33, s33, 0xff
    s_lshl_b32 s3, s30, 1
    s_cmp_ge_u32 s3, s33
    s_cselect_b32 s64, 16, 0
    s_add_u32 s3, s3, 1
    s_cmp_ge_u32 s3, s33
    s_cselect_b32 s65, 16, 0
    s_mov_b32 s63, 0
    s_mov_b32 s66, 0
    s_mov_b32 s67, 16384
    v_mov_b32 v34, 0
    v_mov_b32 v4, 158720
    v_mov_b32 v3, 1
    s_mov_b64 exec, 1
    s_waitcnt vmcnt(0)
    ds_add_rtn_u32 v2, v4, v3 offset:48
    s_mov_b32 exec_lo, s36
    v_mov_b32 v3, 1
    s_waitcnt lgkmcnt(0)
    v_readfirstlane_b32 s33, v2
    s_nop 3
    s_and_b32 s33, s33, 0xff
    s_cmp_lg_u32 s33, 7
    s_cbranch_scc1 K_ARRD
    global_store_dword v8, v3, s[10:11] sc1
K_ARRD:
    s_mov_b64 exec, -1
    s_mov_b32 s3, 1048576
K_P2_GE:
    ds_read_b32 v2, v12 offset:48
    s_sub_u32 s3, s3, 1
    s_waitcnt lgkmcnt(0)
    v_readfirstlane_b32 s33, v2
    s_nop 3
    s_cselect_b32 s33, 1024, s33
    s_cmp_lt_u32 s33, 1024
    s_cbranch_scc1 K_P2_GE
K_P2_GEMM:
    s_setprio 0
    s_mov_b32 s3, 1048576
K_P2_GS:
    ds_read_b32 v2, v12 offset:40
    s_sub_u32 s3, s3, 1
    s_waitcnt lgkmcnt(0)
    v_readfirstlane_b32 s33, v2
    s_nop 3
    s_cselect_b32 s33, 1, s33
    s_cmp_lt_u32 s33, 1
    s_cbranch_scc1 K_P2_GS
    buffer_load_dword v64, v23, s[16:19], 0 offen offset:0 sc1
    buffer_load_dword v66, v23, s[16:19], 0 offen offset:64 sc1
    ds_read_b128 v[16:19], v12
    ds_read_b64 v[40:41], v29 offset:0
    ds_read_b64 v[42:43], v30 offset:0
    ds_read_b64 v[44:45], v31 offset:0
    ds_read_b64 v[46:47], v32 offset:0
    ds_read_b64 v[48:49], v29 offset:2048
    ds_read_b64 v[50:51], v30 offset:2048
    ds_read_b64 v[52:53], v31 offset:2048
    ds_read_b64 v[54:55], v32 offset:2048
    s_waitcnt lgkmcnt(4)
    v_lshlrev_b32 v72, 16, v40
    v_and_b32 v73, 0xffff0000, v40
    v_lshlrev_b32 v74, 16, v41
    v_and_b32 v75, 0xffff0000, v41
    v_lshlrev_b32 v76, 16, v42
    v_and_b32 v77, 0xffff0000, v42
    v_lshlrev_b32 v78, 16, v43
    v_and_b32 v79, 0xffff0000, v43
    v_lshlrev_b32 v80, 16, v44
    v_and_b32 v81, 0xffff0000, v44
    v_lshlrev_b32 v82, 16, v45
    v_and_b32 v83, 0xffff0000, v45
    v_lshlrev_b32 v84, 16, v46
    v_and_b32 v85, 0xffff0000, v46
    v_lshlrev_b32 v86, 16, v47
    v_and_b32 v87, 0xffff0000, v47
    s_waitcnt lgkmcnt(0)
    v_lshlrev_b32 v88, 16, v48
    v_and_b32 v89, 0xffff0000, v48
    v_lshlrev_b32 v90, 16, v49
    v_and_b32 v91, 0xffff0000, v49
    v_lshlrev_b32 v92, 16, v50
    v_and_b32 v93, 0xffff0000, v50
    v_lshlrev_b32 v94, 16, v51
    v_and_b32 v95, 0xffff0000, v51
    v_lshlrev_b32 v96, 16, v52
    v_and_b32 v97, 0xffff0000, v52
    v_lshlrev_b32 v98, 16, v53
    v_and_b32 v99, 0xffff0000, v53
    v_lshlrev_b32 v100, 16, v54
    v_and_b32 v101, 0xffff0000, v54
    v_lshlrev_b32 v102, 16, v55
    v_and_b32 v103, 0xffff0000, v55
    s_cmp_eq_u32 s63, 0
    s_cbranch_scc1 K_SP0
K_SPR0:
    s_ff1_i32_b32 s33, s63
    s_bitset0_b32 s63, s33
    s_lshl_b32 s75, s33, 10
    buffer_load_dwordx4 v[104:107], v25, s[20:23], s75 offen offset:0 sc1
    buffer_load_dwordx4 v[108:111], v26, s[20:23], s75 offen offset:0 sc1
    v_mad_u32_u24 v56, s75, 5, v24
    v_xor_b32 v58, 64, v56
    v_xor_b32 v57, 32, v56
    v_xor_b32 v59, 96, v56
    ds_read_b64_tr_b16 v[184:185], v56 offset:0
    ds_read_b64_tr_b16 v[186:187], v58 offset:2560
    ds_read_b64_tr_b16 v[188:189], v57 offset:0
    ds_read_b64_tr_b16 v[190:191], v59 offset:2560
    ds_read_b64_tr_b16 v[192:193], v58 offset:0
    ds_read_b64_tr_b16 v[194:195], v56 offset:2560
    ds_read_b64_tr_b16 v[196:197], v59 offset:0
    ds_read_b64_tr_b16 v[198:199], v57 offset:2560
    s_cmp_eq_u32 s63, 0
    s_cbranch_scc1 K_SP1
K_SPR1:
    s_ff1_i32_b32 s33, s63
    s_bitset0_b32 s63, s33
    s_lshl_b32 s76, s33, 10
    buffer_load_dwordx4 v[112:115], v25, s[20:23], s76 offen offset:0 sc1
    buffer_load_dwordx4 v[116:119], v26, s[20:23], s76 offen offset:0 sc1
    v_mad_u32_u24 v56, s76, 5, v24
    v_xor_b32 v58, 64, v56
    v_xor_b32 v57, 32, v56
    v_xor_b32 v59, 96, v56
    ds_read_b64_tr_b16 v[200:201], v56 offset:0
    ds_read_b64_tr_b16 v[202:203], v58 offset:2560
    ds_read_b64_tr_b16 v[204:205], v57 offset:0
    ds_read_b64_tr_b16 v[206:207], v59 offset:2560
    ds_read_b64_tr_b16 v[208:209], v58 offset:0
    ds_read_b64_tr_b16 v[210:211], v56 offset:2560
    ds_read_b64_tr_b16 v[212:213], v59 offset:0
    ds_read_b64_tr_b16 v[214:215], v57 offset:2560
    s_waitcnt vmcnt(4)
    s_mov_b64 exec, 1
    ds_add_u32 v12, v34 offset:44
    s_mov_b64 exec, -1
    v_sub_f32 v68, 1.0, v64
    v_cvt_pk_bf16_f32 v68, v68, v68
    v_lshlrev_b32 v68, 16, v68
    v_sub_f32 v70, 1.0, v66
    v_cvt_pk_bf16_f32 v70, v70, v70
    v_lshlrev_b32 v70, 16, v70
    v_pk_mul_f32 v[72:73], v[72:73], v[68:69] op_sel_hi:[1,0]
    v_pk_mul_f32 v[74:75], v[74:75], v[68:69] op_sel_hi:[1,0]
    v_pk_mul_f32 v[76:77], v[76:77], v[68:69] op_sel_hi:[1,0]
    v_pk_mul_f32 v[78:79], v[78:79], v[68:69] op_sel_hi:[1,0]
    v_pk_mul_f32 v[80:81], v[80:81], v[68:69] op_sel_hi:[1,0]
    v_pk_mul_f32 v[82:83], v[82:83], v[68:69] op_sel_hi:[1,0]
    v_pk_mul_f32 v[84:85], v[84:85], v[68:69] op_sel_hi:[1,0]
    v_pk_mul_f32 v[86:87], v[86:87], v[68:69] op_sel_hi:[1,0]
    v_pk_mul_f32 v[88:89], v[88:89], v[70:71] op_sel_hi:[1,0]
    v_pk_mul_f32 v[90:91], v[90:91], v[70:71] op_sel_hi:[1,0]
    v_pk_mul_f32 v[92:93], v[92:93], v[70:71] op_sel_hi:[1,0]
    v_pk_mul_f32 v[94:95], v[94:95], v[70:71] op_sel_hi:[1,0]
    v_pk_mul_f32 v[96:97], v[96:97], v[70:71] op_sel_hi:[1,0]
    v_pk_mul_f32 v[98:99], v[98:99], v[70:71] op_sel_hi:[1,0]
    v_pk_mul_f32 v[100:101], v[100:101], v[70:71] op_sel_hi:[1,0]
    v_pk_mul_f32 v[102:103], v[102:103], v[70:71] op_sel_hi:[1,0]
    s_cmp_eq_u32 s63, 0
    s_cbranch_scc1 K_SP2
K_SPR2:
    s_ff1_i32_b32 s33, s63
    s_bitset0_b32 s63, s33
    s_lshl_b32 s77, s33, 10
    buffer_load_dwordx4 v[120:123], v25, s[20:23], s77 offen offset:0 sc1
    buffer_load_dwordx4 v[124:127], v26, s[20:23], s77 offen offset:0 sc1
    s_cmp_eq_u32 s63, 0
    s_cbranch_scc1 K_SP3
K_SPR3:
    s_ff1_i32_b32 s33, s63
    s_bitset0_b32 s63, s33
    s_lshl_b32 s78, s33, 10
    buffer_load_dwordx4 v[128:131], v25, s[20:23], s78 offen offset:0 sc1
    buffer_load_dwordx4 v[132:135], v26, s[20:23], s78 offen offset:0 sc1
    s_cmp_eq_u32 s63, 0
    s_cbranch_scc1 K_SP4
K_SPR4:
    s_ff1_i32_b32 s33, s63
    s_bitset0_b32 s63, s33
    s_lshl_b32 s75, s33, 10
    buffer_load_dwordx4 v[136:139], v25, s[20:23], s75 offen offset:0 sc1
    buffer_load_dwordx4 v[140:143], v26, s[20:23], s75 offen offset:0 sc1
    s_branch WS_p2g
.p2align 12
WP_p2g:
    s_setpc_b64 s[38:39]
WS_p2g:
    s_waitcnt vmcnt(8) lgkmcnt(9)
    v_mfma_f32_16x16x32_bf16 v[152:155], v[184:187], v[104:107], 0
    v_mad_u32_u24 v56, s77, 5, v24
    v_xor_b32 v58, 64, v56
    v_xor_b32 v57, 32, v56
    v_mfma_f32_16x16x32_bf16 v[168:171], v[184:187], v[108:111], 0
    v_xor_b32 v59, 96, v56
    ds_read_b64_tr_b16 v[216:217], v56 offset:0
    ds_read_b64_tr_b16 v[218:219], v58 offset:2560
    v_mfma_f32_16x16x32_bf16 v[156:159], v[188:191], v[104:107], 0
    ds_read_b64_tr_b16 v[220:221], v57 offset:0
    ds_read_b64_tr_b16 v[222:223], v59 offset:2560
    ds_read_b64_tr_b16 v[224:225], v58 offset:0
    v_mfma_f32_16x16x32_bf16 v[172:175], v[188:191], v[108:111], 0
    ds_read_b64_tr_b16 v[226:227], v56 offset:2560
    ds_read_b64_tr_b16 v[228:229], v59 offset:0
    v_mfma_f32_16x16x32_bf16 v[160:163], v[192:195], v[104:107], 0
    ds_read_b64_tr_b16 v[230:231], v57 offset:2560
    s_cmp_eq_u32 s63, 0
    v_mfma_f32_16x16x32_bf16 v[176:179], v[192:195], v[108:111], 0
    s_cbranch_scc1 K_SP5
K_SPR5:
    s_ff1_i32_b32 s33, s63
    v_mfma_f32_16x16x32_bf16 v[164:167], v[196:199], v[104:107], 0
    s_bitset0_b32 s63, s33
    s_lshl_b32 s76, s33, 10
    v_mfma_f32_16x16x32_bf16 v[180:183], v[196:199], v[108:111], 0
    buffer_load_dwordx4 v[144:147], v25, s[20:23], s76 offen offset:0 sc1
    buffer_load_dwordx4 v[148:151], v26, s[20:23], s76 offen offset:0 sc1
    s_waitcnt vmcnt(8) lgkmcnt(9)
    v_mfma_f32_16x16x32_bf16 v[152:155], v[200:203], v[112:115], v[152:155]
    v_mad_u32_u24 v56, s78, 5, v24
    v_xor_b32 v58, 64, v56
    v_xor_b32 v57, 32, v56
    v_mfma_f32_16x16x32_bf16 v[168:171], v[200:203], v[116:119], v[168:171]
    v_xor_b32 v59, 96, v56
    ds_read_b64_tr_b16 v[184:185], v56 offset:0
    ds_read_b64_tr_b16 v[186:187], v58 offset:2560
    v_mfma_f32_16x16x32_bf16 v[156:159], v[204:207], v[112:115], v[156:159]
    ds_read_b64_tr_b16 v[188:189], v57 offset:0
    ds_read_b64_tr_b16 v[190:191], v59 offset:2560
    ds_read_b64_tr_b16 v[192:193], v58 offset:0
    v_mfma_f32_16x16x32_bf16 v[172:175], v[204:207], v[116:119], v[172:175]
    ds_read_b64_tr_b16 v[194:195], v56 offset:2560
    ds_read_b64_tr_b16 v[196:197], v59 offset:0
    v_mfma_f32_16x16x32_bf16 v[160:163], v[208:211], v[112:115], v[160:163]
    ds_read_b64_tr_b16 v[198:199], v57 offset:2560
    s_cmp_eq_u32 s63, 0
    v_mfma_f32_16x16x32_bf16 v[176:179], v[208:211], v[116:119], v[176:179]
    s_cbranch_scc1 K_SP6
K_SPR6:
    s_ff1_i32_b32 s33, s63
    v_mfma_f32_16x16x32_bf16 v[164:167], v[212:215], v[112:115], v[164:167]
    s_bitset0_b32 s63, s33
    s_lshl_b32 s77, s33, 10
    v_mfma_f32_16x16x32_bf16 v[180:183], v[212:215], v[116:119], v[180:183]
    buffer_load_dwordx4 v[104:107], v25, s[20:23], s77 offen offset:0 sc1
    buffer_load_dwordx4 v[108:111], v26, s[20:23], s77 offen offset:0 sc1
    s_waitcnt vmcnt(8) lgkmcnt(8)
    v_mfma_f32_16x16x32_bf16 v[152:155], v[216:219], v[120:123], v[152:155]
    v_mad_u32_u24 v56, s75, 5, v24
    v_xor_b32 v58, 64, v56
    v_xor_b32 v57, 32, v56
    v_mfma_f32_16x16x32_bf16 v[168:171], v[216:219], v[124:127], v[168:171]
    v_xor_b32 v59, 96, v56
    ds_read_b64_tr_b16 v[200:201], v56 offset:0
    ds_read_b64_tr_b16 v[202:203], v58 offset:2560
    v_mfma_f32_16x16x32_bf16 v[156:159], v[220:223], v[120:123], v[156:159]
    ds_read_b64_tr_b16 v[204:205], v57 offset:0
    ds_read_b64_tr_b16 v[206:207], v59 offset:2560
    ds_read_b64_tr_b16 v[208:209], v58 offset:0
    v_mfma_f32_16x16x32_bf16 v[172:175], v[220:223], v[124:127], v[172:175]
    ds_read_b64_tr_b16 v[210:211], v56 offset:2560
    ds_read_b64_tr_b16 v[212:213], v59 offset:0
    v_mfma_f32_16x16x32_bf16 v[160:163], v[224:227], v[120:123], v[160:163]
    ds_read_b64_tr_b16 v[214:215], v57 offset:2560
    s_andn2_b32 s33, s66, s63
    v_mfma_f32_16x16x32_bf16 v[176:179], v[224:227], v[124:127], v[176:179]
    s_bfe_u32 s33, s33, 0x40000
    s_cmp_eq_u32 s33, 15
    v_mfma_f32_16x16x32_bf16 v[164:167], v[228:231], v[120:123], v[164:167]
    s_cselect_b32 s78, 0, 1024
    s_xor_b32 s69, s78, 1024
    v_mfma_f32_16x16x32_bf16 v[180:183], v[228:231], v[124:127], v[180:183]
    buffer_load_dwordx4 v[112:115], v35, s[20:23], s78 offen offset:0 sc1
    buffer_load_dwordx4 v[116:119], v36, s[20:23], s78 offen offset:0 sc1
    s_waitcnt vmcnt(8) lgkmcnt(8)
    v_mfma_f32_16x16x32_bf16 v[152:155], v[184:187], v[128:131], v[152:155]
    v_mad_u32_u24 v56, s76, 5, v24
    v_xor_b32 v58, 64, v56
    v_xor_b32 v57, 32, v56
    v_mfma_f32_16x16x32_bf16 v[168:171], v[184:187], v[132:135], v[168:171]
    v_xor_b32 v59, 96, v56
    ds_read_b64_tr_b16 v[216:217], v56 offset:0
    ds_read_b64_tr_b16 v[218:219], v58 offset:2560
    v_mfma_f32_16x16x32_bf16 v[156:159], v[188:191], v[128:131], v[156:159]
    ds_read_b64_tr_b16 v[220:221], v57 offset:0
    ds_read_b64_tr_b16 v[222:223], v59 offset:2560
    ds_read_b64_tr_b16 v[224:225], v58 offset:0
    v_mfma_f32_16x16x32_bf16 v[172:175], v[188:191], v[132:135], v[172:175]
    ds_read_b64_tr_b16 v[226:227], v56 offset:2560
    ds_read_b64_tr_b16 v[228:229], v59 offset:0
    v_mfma_f32_16x16x32_bf16 v[160:163], v[192:195], v[128:131], v[160:163]
    ds_read_b64_tr_b16 v[230:231], v57 offset:2560
    s_cmp_eq_u32 s63, 0
    v_mfma_f32_16x16x32_bf16 v[176:179], v[192:195], v[132:135], v[176:179]
    s_cbranch_scc1 K_SP8
K_SPR8:
    s_ff1_i32_b32 s33, s63
    v_mfma_f32_16x16x32_bf16 v[164:167], v[196:199], v[128:131], v[164:167]
    s_bitset0_b32 s63, s33
    s_lshl_b32 s75, s33, 10
    v_mfma_f32_16x16x32_bf16 v[180:183], v[196:199], v[132:135], v[180:183]
    buffer_load_dwordx4 v[120:123], v25, s[20:23], s75 offen offset:0 sc1
    buffer_load_dwordx4 v[124:127], v26, s[20:23], s75 offen offset:0 sc1
    s_waitcnt vmcnt(8) lgkmcnt(8)
    v_mfma_f32_16x16x32_bf16 v[152:155], v[200:203], v[136:139], v[152:155]
    v_mad_u32_u24 v56, s77, 5, v24
    v_xor_b32 v58, 64, v56
    v_mfma_f32_16x16x32_bf16 v[168:171], v[200:203], v[140:143], v[168:171]
    v_xor_b32 v57, 32, v56
    v_xor_b32 v59, 96, v56
    v_mfma_f32_16x16x32_bf16 v[156:159], v[204:207], v[136:139], v[156:159]
    ds_read_b64_tr_b16 v[184:185], v56 offset:0
    ds_read_b64_tr_b16 v[186:187], v58 offset:2560
    v_mfma_f32_16x16x32_bf16 v[172:175], v[204:207], v[140:143], v[172:175]
    ds_read_b64_tr_b16 v[188:189], v57 offset:0
    ds_read_b64_tr_b16 v[190:191], v59 offset:2560
    v_mfma_f32_16x16x32_bf16 v[160:163], v[208:211], v[136:139], v[160:163]
    ds_read_b64_tr_b16 v[192:193], v58 offset:0
    ds_read_b64_tr_b16 v[194:195], v56 offset:2560
    v_mfma_f32_16x16x32_bf16 v[176:179], v[208:211], v[140:143], v[176:179]
    ds_read_b64_tr_b16 v[196:197], v59 offset:0
    ds_read_b64_tr_b16 v[198:199], v57 offset:2560
    v_mfma_f32_16x16x32_bf16 v[164:167], v[212:215], v[136:139], v[164:167]
    buffer_load_dwordx4 v[128:131], v35, s[20:23], s69 offen offset:0 sc1
    buffer_load_dwordx4 v[132:135], v36, s[20:23], s69 offen offset:0 sc1
    v_mfma_f32_16x16x32_bf16 v[180:183], v[212:215], v[140:143], v[180:183]
    s_waitcnt vmcnt(8) lgkmcnt(8)
    v_mfma_f32_16x16x32_bf16 v[152:155], v[216:219], v[144:147], v[152:155]
    v_mad_u32_u24 v56, s78, 20, v60
    v_xor_b32 v58, 64, v56
    v_xor_b32 v57, 32, v56
    v_mfma_f32_16x16x32_bf16 v[168:171], v[216:219], v[148:151], v[168:171]
    v_xor_b32 v59, 96, v56
    ds_read_b64_tr_b16 v[200:201], v56 offset:0
    ds_read_b64_tr_b16 v[202:203], v58 offset:2560
    v_mfma_f32_16x16x32_bf16 v[156:159], v[220:223], v[144:147], v[156:159]
    ds_read_b64_tr_b16 v[204:205], v57 offset:0
    ds_read_b64_tr_b16 v[206:207], v59 offset:2560
    ds_read_b64_tr_b16 v[208:209], v58 offset:0
    v_mfma_f32_16x16x32_bf16 v[172:175], v[220:223], v[148:151], v[172:175]
    ds_read_b64_tr_b16 v[210:211], v56 offset:2560
    ds_read_b64_tr_b16 v[212:213], v59 offset:0
    v_mfma_f32_16x16x32_bf16 v[160:163], v[224:227], v[144:147], v[160:163]
    ds_read_b64_tr_b16 v[214:215], v57 offset:2560
    s_cmp_eq_u32 s63, 0
    v_mfma_f32_16x16x32_bf16 v[176:179], v[224:227], v[148:151], v[176:179]
    s_cbranch_scc1 K_SP10
K_SPR10:
    s_ff1_i32_b32 s33, s63
    v_mfma_f32_16x16x32_bf16 v[164:167], v[228:231], v[144:147], v[164:167]
    s_bitset0_b32 s63, s33
    s_lshl_b32 s77, s33, 10
    v_mfma_f32_16x16x32_bf16 v[180:183], v[228:231], v[148:151], v[180:183]
    buffer_load_dwordx4 v[136:139], v25, s[20:23], s77 offen offset:0 sc1
    buffer_load_dwordx4 v[140:143], v26, s[20:23], s77 offen offset:0 sc1
    s_waitcnt vmcnt(8) lgkmcnt(8)
    v_mfma_f32_16x16x32_bf16 v[152:155], v[184:187], v[104:107], v[152:155]
    v_mad_u32_u24 v56, s75, 5, v24
    v_xor_b32 v58, 64, v56
    v_xor_b32 v57, 32, v56
    v_mfma_f32_16x16x32_bf16 v[168:171], v[184:187], v[108:111], v[168:171]
    v_xor_b32 v59, 96, v56
    ds_read_b64_tr_b16 v[216:217], v56 offset:0
    ds_read_b64_tr_b16 v[218:219], v58 offset:2560
    v_mfma_f32_16x16x32_bf16 v[156:159], v[188:191], v[104:107], v[156:159]
    ds_read_b64_tr_b16 v[220:221], v57 offset:0
    ds_read_b64_tr_b16 v[222:223], v59 offset:2560
    ds_read_b64_tr_b16 v[224:225], v58 offset:0
    v_mfma_f32_16x16x32_bf16 v[172:175], v[188:191], v[108:111], v[172:175]
    ds_read_b64_tr_b16 v[226:227], v56 offset:2560
    ds_read_b64_tr_b16 v[228:229], v59 offset:0
    v_mfma_f32_16x16x32_bf16 v[160:163], v[192:195], v[104:107], v[160:163]
    ds_read_b64_tr_b16 v[230:231], v57 offset:2560
    s_cmp_eq_u32 s63, 0
    v_mfma_f32_16x16x32_bf16 v[176:179], v[192:195], v[108:111], v[176:179]
    s_cbranch_scc1 K_SP11
K_SPR11:
    s_ff1_i32_b32 s33, s63
    v_mfma_f32_16x16x32_bf16 v[164:167], v[196:199], v[104:107], v[164:167]
    s_bitset0_b32 s63, s33
    s_lshl_b32 s78, s33, 10
    v_mfma_f32_16x16x32_bf16 v[180:183], v[196:199], v[108:111], v[180:183]
    buffer_load_dwordx4 v[144:147], v25, s[20:23], s78 offen offset:0 sc1
    buffer_load_dwordx4 v[148:151], v26, s[20:23], s78 offen offset:0 sc1
    s_waitcnt vmcnt(8) lgkmcnt(8)
    v_mfma_f32_16x16x32_bf16 v[152:155], v[200:203], v[112:115], v[152:155]
    v_mad_u32_u24 v56, s69, 20, v60
    v_xor_b32 v58, 64, v56
    v_xor_b32 v57, 32, v56
    v_mfma_f32_16x16x32_bf16 v[168:171], v[200:203], v[116:119], v[168:171]
    v_xor_b32 v59, 96, v56
    ds_read_b64_tr_b16 v[184:185], v56 offset:0
    ds_read_b64_tr_b16 v[186:187], v58 offset:2560
    v_mfma_f32_16x16x32_bf16 v[156:159], v[204:207], v[112:115], v[156:159]
    ds_read_b64_tr_b16 v[188:189], v57 offset:0
    ds_read_b64_tr_b16 v[190:191], v59 offset:2560
    ds_read_b64_tr_b16 v[192:193], v58 offset:0
    v_mfma_f32_16x16x32_bf16 v[172:175], v[204:207], v[116:119], v[172:175]
    ds_read_b64_tr_b16 v[194:195], v56 offset:2560
    ds_read_b64_tr_b16 v[196:197], v59 offset:0
    v_mfma_f32_16x16x32_bf16 v[160:163], v[208:211], v[112:115], v[160:163]
    ds_read_b64_tr_b16 v[198:199], v57 offset:2560
    s_cmp_eq_u32 s63, 0
    v_mfma_f32_16x16x32_bf16 v[176:179], v[208:211], v[116:119], v[176:179]
    s_cbranch_scc1 K_SP12
K_SPR12:
    s_ff1_i32_b32 s33, s63
    v_mfma_f32_16x16x32_bf16 v[164:167], v[212:215], v[112:115], v[164:167]
    s_bitset0_b32 s63, s33
    s_lshl_b32 s75, s33, 10
    v_mfma_f32_16x16x32_bf16 v[180:183], v[212:215], v[116:119], v[180:183]
    buffer_load_dwordx4 v[104:107], v25, s[20:23], s75 offen offset:0 sc1
    buffer_load_dwordx4 v[108:111], v26, s[20:23], s75 offen offset:0 sc1
    s_mov_b32 s3, 1048576
K_P2_GW:
    ds_read_b32 v2, v12 offset:44
    s_sub_u32 s3, s3, 1
    s_waitcnt lgkmcnt(0)
    v_readfirstlane_b32 s33, v2
    s_nop 3
    s_cselect_b32 s33, 4, s33
    s_cmp_lt_u32 s33, 4
    s_cbranch_scc1 K_P2_GW
    v_readfirstlane_b32 s56, v16
    v_readfirstlane_b32 s57, v17
    s_lshl_b32 s58, s53, 4
    s_waitcnt vmcnt(8)
    v_mfma_f32_16x16x32_bf16 v[152:155], v[216:219], v[120:123], v[152:155]
    v_mad_u32_u24 v56, s77, 5, v24
    v_xor_b32 v58, 64, v56
    v_xor_b32 v57, 32, v56
    v_mfma_f32_16x16x32_bf16 v[168:171], v[216:219], v[124:127], v[168:171]
    v_xor_b32 v59, 96, v56
    ds_read_b64_tr_b16 v[200:201], v56 offset:0
    ds_read_b64_tr_b16 v[202:203], v58 offset:2560
    v_mfma_f32_16x16x32_bf16 v[156:159], v[220:223], v[120:123], v[156:159]
    ds_read_b64_tr_b16 v[204:205], v57 offset:0
    ds_read_b64_tr_b16 v[206:207], v59 offset:2560
    ds_read_b64_tr_b16 v[208:209], v58 offset:0
    v_mfma_f32_16x16x32_bf16 v[172:175], v[220:223], v[124:127], v[172:175]
    ds_read_b64_tr_b16 v[210:211], v56 offset:2560
    ds_read_b64_tr_b16 v[212:213], v59 offset:0
    v_mfma_f32_16x16x32_bf16 v[160:163], v[224:227], v[120:123], v[160:163]
    ds_read_b64_tr_b16 v[214:215], v57 offset:2560
    s_cmp_eq_u32 s63, 0
    v_mfma_f32_16x16x32_bf16 v[176:179], v[224:227], v[124:127], v[176:179]
    s_cbranch_scc1 K_SP13
K_SPR13:
    s_ff1_i32_b32 s33, s63
    v_mfma_f32_16x16x32_bf16 v[164:167], v[228:231], v[120:123], v[164:167]
    s_bitset0_b32 s63, s33
    s_lshl_b32 s76, s33, 10
    v_mfma_f32_16x16x32_bf16 v[180:183], v[228:231], v[124:127], v[180:183]
    buffer_load_dwordx4 v[112:115], v25, s[20:23], s76 offen offset:0 sc1
    buffer_load_dwordx4 v[116:119], v26, s[20:23], s76 offen offset:0 sc1
    s_waitcnt vmcnt(8)
    v_mfma_f32_16x16x32_bf16 v[152:155], v[184:187], v[128:131], v[152:155]
    v_mad_u32_u24 v56, s78, 5, v24
    v_xor_b32 v58, 64, v56
    v_xor_b32 v57, 32, v56
    v_mfma_f32_16x16x32_bf16 v[168:171], v[184:187], v[132:135], v[168:171]
    v_xor_b32 v59, 96, v56
    ds_read_b64_tr_b16 v[216:217], v56 offset:0
    ds_read_b64_tr_b16 v[218:219], v58 offset:2560
    v_mfma_f32_16x16x32_bf16 v[156:159], v[188:191], v[128:131], v[156:159]
    ds_read_b64_tr_b16 v[220:221], v57 offset:0
    ds_read_b64_tr_b16 v[222:223], v59 offset:2560
    ds_read_b64_tr_b16 v[224:225], v58 offset:0
    v_mfma_f32_16x16x32_bf16 v[172:175], v[188:191], v[132:135], v[172:175]
    ds_read_b64_tr_b16 v[226:227], v56 offset:2560
    ds_read_b64_tr_b16 v[228:229], v59 offset:0
    v_mfma_f32_16x16x32_bf16 v[160:163], v[192:195], v[128:131], v[160:163]
    ds_read_b64_tr_b16 v[230:231], v57 offset:2560
    s_cmp_eq_u32 s63, 0
    v_mfma_f32_16x16x32_bf16 v[176:179], v[192:195], v[132:135], v[176:179]
    s_cbranch_scc1 K_SP14
K_SPR14:
    s_ff1_i32_b32 s33, s63
    v_mfma_f32_16x16x32_bf16 v[164:167], v[196:199], v[128:131], v[164:167]
    s_bitset0_b32 s63, s33
    s_lshl_b32 s77, s33, 10
    v_mfma_f32_16x16x32_bf16 v[180:183], v[196:199], v[132:135], v[180:183]
    buffer_load_dwordx4 v[120:123], v25, s[20:23], s77 offen offset:0 sc1
    buffer_load_dwordx4 v[124:127], v26, s[20:23], s77 offen offset:0 sc1
    s_waitcnt vmcnt(8) lgkmcnt(8)
    v_mfma_f32_16x16x32_bf16 v[152:155], v[200:203], v[136:139], v[152:155]
    v_mad_u32_u24 v56, s75, 5, v24
    v_xor_b32 v58, 64, v56
    v_xor_b32 v57, 32, v56
    v_mfma_f32_16x16x32_bf16 v[168:171], v[200:203], v[140:143], v[168:171]
    v_xor_b32 v59, 96, v56
    ds_read_b64_tr_b16 v[184:185], v56 offset:0
    ds_read_b64_tr_b16 v[186:187], v58 offset:2560
    v_mfma_f32_16x16x32_bf16 v[156:159], v[204:207], v[136:139], v[156:159]
    ds_read_b64_tr_b16 v[188:189], v57 offset:0
    ds_read_b64_tr_b16 v[190:191], v59 offset:2560
    ds_read_b64_tr_b16 v[192:193], v58 offset:0
    v_mfma_f32_16x16x32_bf16 v[172:175], v[204:207], v[140:143], v[172:175]
    ds_read_b64_tr_b16 v[194:195], v56 offset:2560
    ds_read_b64_tr_b16 v[196:197], v59 offset:0
    v_mfma_f32_16x16x32_bf16 v[160:163], v[208:211], v[136:139], v[160:163]
    ds_read_b64_tr_b16 v[198:199], v57 offset:2560
    s_cmp_eq_u32 s63, 0
    v_mfma_f32_16x16x32_bf16 v[176:179], v[208:211], v[140:143], v[176:179]
    s_cbranch_scc1 K_SP15
K_SPR15:
    s_ff1_i32_b32 s33, s63
    v_mfma_f32_16x16x32_bf16 v[164:167], v[212:215], v[136:139], v[164:167]
    s_bitset0_b32 s63, s33
    s_lshl_b32 s78, s33, 10
    v_mfma_f32_16x16x32_bf16 v[180:183], v[212:215], v[140:143], v[180:183]
    buffer_load_dwordx4 v[128:131], v25, s[20:23], s78 offen offset:0 sc1
    buffer_load_dwordx4 v[132:135], v26, s[20:23], s78 offen offset:0 sc1
    s_waitcnt vmcnt(8) lgkmcnt(8)
    v_mfma_f32_16x16x32_bf16 v[152:155], v[216:219], v[144:147], v[152:155]
    v_mad_u32_u24 v56, s76, 5, v24
    v_xor_b32 v58, 64, v56
    v_xor_b32 v57, 32, v56
    v_mfma_f32_16x16x32_bf16 v[168:171], v[216:219], v[148:151], v[168:171]
    v_xor_b32 v59, 96, v56
    ds_read_b64_tr_b16 v[200:201], v56 offset:0
    ds_read_b64_tr_b16 v[202:203], v58 offset:2560
    v_mfma_f32_16x16x32_bf16 v[156:159], v[220:223], v[144:147], v[156:159]
    ds_read_b64_tr_b16 v[204:205], v57 offset:0
    ds_read_b64_tr_b16 v[206:207], v59 offset:2560
    ds_read_b64_tr_b16 v[208:209], v58 offset:0
    v_mfma_f32_16x16x32_bf16 v[172:175], v[220:223], v[148:151], v[172:175]
    ds_read_b64_tr_b16 v[210:211], v56 offset:2560
    ds_read_b64_tr_b16 v[212:213], v59 offset:0
    v_mfma_f32_16x16x32_bf16 v[160:163], v[224:227], v[144:147], v[160:163]
    ds_read_b64_tr_b16 v[214:215], v57 offset:2560
    s_cmp_eq_u32 s63, 0
    v_mfma_f32_16x16x32_bf16 v[176:179], v[224:227], v[148:151], v[176:179]
    s_cbranch_scc1 K_SP16
K_SPR16:
    s_ff1_i32_b32 s33, s63
    v_mfma_f32_16x16x32_bf16 v[164:167], v[228:231], v[144:147], v[164:167]
    s_bitset0_b32 s63, s33
    s_lshl_b32 s75, s33, 10
    v_mfma_f32_16x16x32_bf16 v[180:183], v[228:231], v[148:151], v[180:183]
    buffer_load_dwordx4 v[136:139], v25, s[20:23], s75 offen offset:0 sc1
    buffer_load_dwordx4 v[140:143], v26, s[20:23], s75 offen offset:0 sc1
    s_waitcnt vmcnt(8) lgkmcnt(8)
    v_mfma_f32_16x16x32_bf16 v[152:155], v[184:187], v[104:107], v[152:155]
    v_mad_u32_u24 v56, s77, 5, v24
    v_xor_b32 v58, 64, v56
    v_xor_b32 v57, 32, v56
    v_mfma_f32_16x16x32_bf16 v[168:171], v[184:187], v[108:111], v[168:171]
    v_xor_b32 v59, 96, v56
    ds_read_b64_tr_b16 v[216:217], v56 offset:0
    ds_read_b64_tr_b16 v[218:219], v58 offset:2560
    v_mfma_f32_16x16x32_bf16 v[156:159], v[188:191], v[104:107], v[156:159]
    ds_read_b64_tr_b16 v[220:221], v57 offset:0
    ds_read_b64_tr_b16 v[222:223], v59 offset:2560
    ds_read_b64_tr_b16 v[224:225], v58 offset:0
    v_mfma_f32_16x16x32_bf16 v[172:175], v[188:191], v[108:111], v[172:175]
    ds_read_b64_tr_b16 v[226:227], v56 offset:2560
    ds_read_b64_tr_b16 v[228:229], v59 offset:0
    v_mfma_f32_16x16x32_bf16 v[160:163], v[192:195], v[104:107], v[160:163]
    ds_read_b64_tr_b16 v[230:231], v57 offset:2560
    s_andn2_b32 s33, s66, s63
    v_mfma_f32_16x16x32_bf16 v[176:179], v[192:195], v[108:111], v[176:179]
    s_bfe_u32 s33, s33, 0x40008
    s_cmp_eq_u32 s33, 15
    v_mfma_f32_16x16x32_bf16 v[164:167], v[196:199], v[104:107], v[164:167]
    s_cselect_b32 s76, 0, 1024
    s_xor_b32 s69, s76, 1024
    v_mfma_f32_16x16x32_bf16 v[180:183], v[196:199], v[108:111], v[180:183]
    buffer_load_dwordx4 v[144:147], v35, s[20:23], s76 offen offset:2048 sc1
    buffer_load_dwordx4 v[148:151], v36, s[20:23], s76 offen offset:2048 sc1
    s_waitcnt vmcnt(8) lgkmcnt(8)
    v_mfma_f32_16x16x32_bf16 v[152:155], v[200:203], v[112:115], v[152:155]
    v_mad_u32_u24 v56, s78, 5, v24
    v_xor_b32 v58, 64, v56
    v_xor_b32 v57, 32, v56
    v_mfma_f32_16x16x32_bf16 v[168:171], v[200:203], v[116:119], v[168:171]
    v_xor_b32 v59, 96, v56
    ds_read_b64_tr_b16 v[184:185], v56 offset:0
    ds_read_b64_tr_b16 v[186:187], v58 offset:2560
    v_mfma_f32_16x16x32_bf16 v[156:159], v[204:207], v[112:115], v[156:159]
    ds_read_b64_tr_b16 v[188:189], v57 offset:0
    ds_read_b64_tr_b16 v[190:191], v59 offset:2560
    ds_read_b64_tr_b16 v[192:193], v58 offset:0
    v_mfma_f32_16x16x32_bf16 v[172:175], v[204:207], v[116:119], v[172:175]
    ds_read_b64_tr_b16 v[194:195], v56 offset:2560
    ds_read_b64_tr_b16 v[196:197], v59 offset:0
    v_mfma_f32_16x16x32_bf16 v[160:163], v[208:211], v[112:115], v[160:163]
    ds_read_b64_tr_b16 v[198:199], v57 offset:2560
    s_cmp_eq_u32 s63, 0
    v_mfma_f32_16x16x32_bf16 v[176:179], v[208:211], v[116:119], v[176:179]
    s_cbranch_scc1 K_SP18
K_SPR18:
    s_ff1_i32_b32 s33, s63
    v_mfma_f32_16x16x32_bf16 v[164:167], v[212:215], v[112:115], v[164:167]
    s_bitset0_b32 s63, s33
    s_lshl_b32 s77, s33, 10
    v_mfma_f32_16x16x32_bf16 v[180:183], v[212:215], v[116:119], v[180:183]
    buffer_load_dwordx4 v[104:107], v25, s[20:23], s77 offen offset:0 sc1
    buffer_load_dwordx4 v[108:111], v26, s[20:23], s77 offen offset:0 sc1
    s_waitcnt vmcnt(8) lgkmcnt(8)
    v_mfma_f32_16x16x32_bf16 v[152:155], v[216:219], v[120:123], v[152:155]
    v_mad_u32_u24 v56, s75, 5, v24
    v_xor_b32 v58, 64, v56
    v_mfma_f32_16x16x32_bf16 v[168:171], v[216:219], v[124:127], v[168:171]
    v_xor_b32 v57, 32, v56
    v_xor_b32 v59, 96, v56
    v_mfma_f32_16x16x32_bf16 v[156:159], v[220:223], v[120:123], v[156:159]
    ds_read_b64_tr_b16 v[200:201], v56 offset:0
    ds_read_b64_tr_b16 v[202:203], v58 offset:2560
    v_mfma_f32_16x16x32_bf16 v[172:175], v[220:223], v[124:127], v[172:175]
    ds_read_b64_tr_b16 v[204:205], v57 offset:0
    ds_read_b64_tr_b16 v[206:207], v59 offset:2560
    v_mfma_f32_16x16x32_bf16 v[160:163], v[224:227], v[120:123], v[160:163]
    ds_read_b64_tr_b16 v[208:209], v58 offset:0
    ds_read_b64_tr_b16 v[210:211], v56 offset:2560
    v_mfma_f32_16x16x32_bf16 v[176:179], v[224:227], v[124:127], v[176:179]
    ds_read_b64_tr_b16 v[212:213], v59 offset:0
    ds_read_b64_tr_b16 v[214:215], v57 offset:2560
    v_mfma_f32_16x16x32_bf16 v[164:167], v[228:231], v[120:123], v[164:167]
    buffer_load_dwordx4 v[112:115], v35, s[20:23], s69 offen offset:2048 sc1
    buffer_load_dwordx4 v[116:119], v36, s[20:23], s69 offen offset:2048 sc1
    v_mfma_f32_16x16x32_bf16 v[180:183], v[228:231], v[124:127], v[180:183]
    s_waitcnt vmcnt(8) lgkmcnt(8)
    v_mfma_f32_16x16x32_bf16 v[152:155], v[184:187], v[128:131], v[152:155]
    v_mad_u32_u24 v56, s76, 20, v60
    v_xor_b32 v58, 64, v56
    v_mfma_f32_16x16x32_bf16 v[168:171], v[184:187], v[132:135], v[168:171]
    v_xor_b32 v57, 32, v56
    v_xor_b32 v59, 96, v56
    v_mfma_f32_16x16x32_bf16 v[156:159], v[188:191], v[128:131], v[156:159]
    ds_read_b64_tr_b16 v[216:217], v56 offset:40960
    ds_read_b64_tr_b16 v[218:219], v58 offset:43520
    v_mfma_f32_16x16x32_bf16 v[172:175], v[188:191], v[132:135], v[172:175]
    ds_read_b64_tr_b16 v[220:221], v57 offset:40960
    ds_read_b64_tr_b16 v[222:223], v59 offset:43520
    v_mfma_f32_16x16x32_bf16 v[160:163], v[192:195], v[128:131], v[160:163]
    ds_read_b64_tr_b16 v[224:225], v58 offset:40960
    ds_read_b64_tr_b16 v[226:227], v56 offset:43520
    v_mfma_f32_16x16x32_bf16 v[176:179], v[192:195], v[132:135], v[176:179]
    ds_read_b64_tr_b16 v[228:229], v59 offset:40960
    ds_read_b64_tr_b16 v[230:231], v57 offset:43520
    v_mfma_f32_16x16x32_bf16 v[164:167], v[196:199], v[128:131], v[164:167]
    v_mfma_f32_16x16x32_bf16 v[180:183], v[196:199], v[132:135], v[180:183]
    s_waitcnt vmcnt(6) lgkmcnt(8)
    v_mfma_f32_16x16x32_bf16 v[152:155], v[200:203], v[136:139], v[152:155]
    v_mad_u32_u24 v56, s77, 5, v24
    v_xor_b32 v58, 64, v56
    v_mfma_f32_16x16x32_bf16 v[168:171], v[200:203], v[140:143], v[168:171]
    v_xor_b32 v57, 32, v56
    v_xor_b32 v59, 96, v56
    v_mfma_f32_16x16x32_bf16 v[156:159], v[204:207], v[136:139], v[156:159]
    ds_read_b64_tr_b16 v[184:185], v56 offset:0
    ds_read_b64_tr_b16 v[186:187], v58 offset:2560
    v_mfma_f32_16x16x32_bf16 v[172:175], v[204:207], v[140:143], v[172:175]
    ds_read_b64_tr_b16 v[188:189], v57 offset:0
    ds_read_b64_tr_b16 v[190:191], v59 offset:2560
    v_mfma_f32_16x16x32_bf16 v[160:163], v[208:211], v[136:139], v[160:163]
    ds_read_b64_tr_b16 v[192:193], v58 offset:0
    ds_read_b64_tr_b16 v[194:195], v56 offset:2560
    v_mfma_f32_16x16x32_bf16 v[176:179], v[208:211], v[140:143], v[176:179]
    ds_read_b64_tr_b16 v[196:197], v59 offset:0
    ds_read_b64_tr_b16 v[198:199], v57 offset:2560
    v_mfma_f32_16x16x32_bf16 v[164:167], v[212:215], v[136:139], v[164:167]
    v_mfma_f32_16x16x32_bf16 v[180:183], v[212:215], v[140:143], v[180:183]
    s_waitcnt vmcnt(4) lgkmcnt(8)
    v_mfma_f32_16x16x32_bf16 v[152:155], v[216:219], v[144:147], v[152:155]
    v_mad_u32_u24 v56, s69, 20, v60
    v_xor_b32 v58, 64, v56
    v_mfma_f32_16x16x32_bf16 v[168:171], v[216:219], v[148:151], v[168:171]
    v_xor_b32 v57, 32, v56
    v_xor_b32 v59, 96, v56
    v_mfma_f32_16x16x32_bf16 v[156:159], v[220:223], v[144:147], v[156:159]
    ds_read_b64_tr_b16 v[200:201], v56 offset:40960
    ds_read_b64_tr_b16 v[202:203], v58 offset:43520
    v_mfma_f32_16x16x32_bf16 v[172:175], v[220:223], v[148:151], v[172:175]
    ds_read_b64_tr_b16 v[204:205], v57 offset:40960
    ds_read_b64_tr_b16 v[206:207], v59 offset:43520
    v_mfma_f32_16x16x32_bf16 v[160:163], v[224:227], v[144:147], v[160:163]
    ds_read_b64_tr_b16 v[208:209], v58 offset:40960
    ds_read_b64_tr_b16 v[210:211], v56 offset:43520
    v_mfma_f32_16x16x32_bf16 v[176:179], v[224:227], v[148:151], v[176:179]
    ds_read_b64_tr_b16 v[212:213], v59 offset:40960
    ds_read_b64_tr_b16 v[214:215], v57 offset:43520
    v_mfma_f32_16x16x32_bf16 v[164:167], v[228:231], v[144:147], v[164:167]
    v_mfma_f32_16x16x32_bf16 v[180:183], v[228:231], v[148:151], v[180:183]
    s_waitcnt vmcnt(2) lgkmcnt(8)
    v_mfma_f32_16x16x32_bf16 v[152:155], v[184:187], v[104:107], v[152:155]
    v_mfma_f32_16x16x32_bf16 v[156:159], v[188:191], v[104:107], v[156:159]
    v_mfma_f32_16x16x32_bf16 v[160:163], v[192:195], v[104:107], v[160:163]
    v_mfma_f32_16x16x32_bf16 v[164:167], v[196:199], v[104:107], v[164:167]
    s_sub_u32 s59, s56, s58
    s_cmp_lt_u32 s59, 32
    s_cbranch_scc1 K_YROW0
K_NOY0:
    s_sub_u32 s59, s57, s58
    s_cmp_lt_u32 s59, 32
    s_cbranch_scc1 K_YROW1
K_NOY1:
    s_waitcnt vmcnt(0) lgkmcnt(0)
    v_mfma_f32_16x16x32_bf16 v[152:155], v[200:203], v[112:115], v[152:155]
    v_mfma_f32_16x16x32_bf16 v[156:159], v[204:207], v[112:115], v[156:159]
    v_mfma_f32_16x16x32_bf16 v[160:163], v[208:211], v[112:115], v[160:163]
    v_mfma_f32_16x16x32_bf16 v[164:167], v[212:215], v[112:115], v[164:167]
    v_mfma_f32_16x16x32_bf16 v[168:171], v[184:187], v[108:111], v[168:171]
    v_mfma_f32_16x16x32_bf16 v[172:175], v[188:191], v[108:111], v[172:175]
    v_mfma_f32_16x16x32_bf16 v[176:179], v[192:195], v[108:111], v[176:179]
    s_nop 1
    v_fma_f32 v152, v152, v64, v72
    v_fma_f32 v153, v153, v64, v73
    v_fma_f32 v154, v154, v64, v74
    v_mfma_f32_16x16x32_bf16 v[180:183], v[196:199], v[108:111], v[180:183]
    v_fma_f32 v155, v155, v64, v75
    v_cvt_pk_bf16_f32 v40, v152, v153
    v_cvt_pk_bf16_f32 v41, v154, v155
    v_mfma_f32_16x16x32_bf16 v[168:171], v[200:203], v[116:119], v[168:171]
    v_fma_f32 v156, v156, v64, v76
    v_fma_f32 v157, v157, v64, v77
    ds_write_b64 v29, v[40:41] offset:0
    v_mfma_f32_16x16x32_bf16 v[172:175], v[204:207], v[116:119], v[172:175]
    v_fma_f32 v158, v158, v64, v78
    v_fma_f32 v159, v159, v64, v79
    v_cvt_pk_bf16_f32 v42, v156, v157
    v_mfma_f32_16x16x32_bf16 v[176:179], v[208:211], v[116:119], v[176:179]
    v_cvt_pk_bf16_f32 v43, v158, v159
    v_fma_f32 v160, v160, v64, v80
    v_fma_f32 v161, v161, v64, v81
    v_mfma_f32_16x16x32_bf16 v[180:183], v[212:215], v[116:119], v[180:183]
    ds_write_b64 v30, v[42:43] offset:0
    v_fma_f32 v162, v162, v64, v82
    v_fma_f32 v163, v163, v64, v83
    v_cvt_pk_bf16_f32 v44, v160, v161
    v_cvt_pk_bf16_f32 v45, v162, v163
    v_pk_fma_f32 v[164:165], v[164:165], v[64:65], v[84:85] op_sel_hi:[1,0,1]
    v_pk_fma_f32 v[166:167], v[166:167], v[64:65], v[86:87] op_sel_hi:[1,0,1]
    ds_write_b64 v31, v[44:45] offset:0
    v_cvt_pk_bf16_f32 v46, v164, v165
    v_cvt_pk_bf16_f32 v47, v166, v167
    ds_write_b64 v32, v[46:47] offset:0
    ds_read_b128 v[72:75], v33 offset:0
    ds_read_b128 v[76:79], v33 offset:1024
    v_pk_fma_f32 v[168:169], v[168:169], v[66:67], v[88:89] op_sel_hi:[1,0,1]
    v_pk_fma_f32 v[170:171], v[170:171], v[66:67], v[90:91] op_sel_hi:[1,0,1]
    v_cvt_pk_bf16_f32 v48, v168, v169
    v_cvt_pk_bf16_f32 v49, v170, v171
    v_pk_fma_f32 v[172:173], v[172:173], v[66:67], v[92:93] op_sel_hi:[1,0,1]
    v_pk_fma_f32 v[174:175], v[174:175], v[66:67], v[94:95] op_sel_hi:[1,0,1]
    v_cvt_pk_bf16_f32 v50, v172, v173
    v_cvt_pk_bf16_f32 v51, v174, v175
    v_pk_fma_f32 v[176:177], v[176:177], v[66:67], v[96:97] op_sel_hi:[1,0,1]
    v_pk_fma_f32 v[178:179], v[178:179], v[66:67], v[98:99] op_sel_hi:[1,0,1]
    v_cvt_pk_bf16_f32 v52, v176, v177
    v_cvt_pk_bf16_f32 v53, v178, v179
    v_pk_fma_f32 v[180:181], v[180:181], v[66:67], v[100:101] op_sel_hi:[1,0,1]
    v_pk_fma_f32 v[182:183], v[182:183], v[66:67], v[102:103] op_sel_hi:[1,0,1]
    v_cvt_pk_bf16_f32 v54, v180, v181
    v_cvt_pk_bf16_f32 v55, v182, v183
    s_waitcnt lgkmcnt(0)
    buffer_store_dwordx4 v[72:75], v27, s[48:51], s71 offen sc1
    buffer_store_dwordx4 v[76:79], v28, s[48:51], s72 offen sc1
    ds_write_b64 v29, v[48:49] offset:2048
    ds_write_b64 v30, v[50:51] offset:2048
    ds_write_b64 v31, v[52:53] offset:2048
    ds_write_b64 v32, v[54:55] offset:2048
    ds_read_b128 v[88:91], v33 offset:2048
    ds_read_b128 v[92:95], v33 offset:3072
    s_waitcnt lgkmcnt(1)
    buffer_store_dwordx4 v[88:91], v27, s[48:51], s73 offen sc1
    s_waitcnt lgkmcnt(0)
    buffer_store_dwordx4 v[92:95], v28, s[48:51], s74 offen sc1
K_END:
K_EXIT:
    s_endpgm
.p2align 12
WP_spin:
    s_setpc_b64 s[38:39]
K_SP0:
    ds_read_b32 v2, v12 offset:32
    s_waitcnt lgkmcnt(0)
    v_readfirstlane_b32 s33, v2
    s_nop 3
    s_lshr_b32 s63, s33, s64
    s_lshr_b32 s33, s33, s65
    s_and_b32 s63, s63, s33
    s_and_b32 s63, s63, 0xff
    s_andn2_b32 s63, s63, s66
    s_cbranch_scc0 K_SP0
    s_or_b32 s66, s66, s63
    s_branch K_SPR0
K_SP1:
    ds_read_b32 v2, v12 offset:32
    s_waitcnt lgkmcnt(0)
    v_readfirstlane_b32 s33, v2
    s_nop 3
    s_lshr_b32 s63, s33, s64
    s_lshr_b32 s33, s33, s65
    s_and_b32 s63, s63, s33
    s_and_b32 s63, s63, 0xff
    s_andn2_b32 s63, s63, s66
    s_cbranch_scc0 K_SP1
    s_or_b32 s66, s66, s63
    s_branch K_SPR1
K_SP2:
    ds_read_b32 v2, v12 offset:32
    s_waitcnt lgkmcnt(0)
    v_readfirstlane_b32 s33, v2
    s_nop 3
    s_lshr_b32 s63, s33, s64
    s_lshr_b32 s33, s33, s65
    s_and_b32 s63, s63, s33
    s_and_b32 s63, s63, 0xff
    s_andn2_b32 s63, s63, s66
    s_cbranch_scc0 K_SP2
    s_or_b32 s66, s66, s63
    s_branch K_SPR2
K_SP3:
    ds_read_b32 v2, v12 offset:32
    s_waitcnt lgkmcnt(0)
    v_readfirstlane_b32 s33, v2
    s_nop 3
    s_lshr_b32 s63, s33, s64
    s_lshr_b32 s33, s33, s65
    s_and_b32 s63, s63, s33
    s_and_b32 s63, s63, 0xff
    s_andn2_b32 s63, s63, s66
    s_cbranch_scc0 K_SP3
    s_or_b32 s66, s66, s63
    s_branch K_SPR3
K_SP4:
    ds_read_b32 v2, v12 offset:32
    s_waitcnt lgkmcnt(0)
    v_readfirstlane_b32 s33, v2
    s_nop 3
    s_lshr_b32 s63, s33, s64
    s_lshr_b32 s33, s33, s65
    s_and_b32 s63, s63, s33
    s_and_b32 s63, s63, 0xff
    s_andn2_b32 s63, s63, s66
    s_cbranch_scc0 K_SP4
    s_or_b32 s66, s66, s63
    s_branch K_SPR4
K_SP5:
    ds_read_b32 v2, v12 offset:32
    s_waitcnt lgkmcnt(0)
    v_readfirstlane_b32 s33, v2
    s_nop 3
    s_lshr_b32 s63, s33, s64
    s_lshr_b32 s33, s33, s65
    s_and_b32 s63, s63, s33
    s_and_b32 s63, s63, 0xff
    s_andn2_b32 s63, s63, s66
    s_cbranch_scc0 K_SP5
    s_or_b32 s66, s66, s63
    s_branch K_SPR5
K_SP6:
    ds_read_b32 v2, v12 offset:32
    s_waitcnt lgkmcnt(0)
    v_readfirstlane_b32 s33, v2
    s_nop 3
    s_lshr_b32 s63, s33, s64
    s_lshr_b32 s33, s33, s65
    s_and_b32 s63, s63, s33
    s_and_b32 s63, s63, 0xff
    s_andn2_b32 s63, s63, s66
    s_cbranch_scc0 K_SP6
    s_or_b32 s66, s66, s63
    s_branch K_SPR6
K_SP8:
    ds_read_b32 v2, v12 offset:32
    s_waitcnt lgkmcnt(0)
    v_readfirstlane_b32 s33, v2
    s_nop 3
    s_lshr_b32 s63, s33, s64
    s_lshr_b32 s33, s33, s65
    s_and_b32 s63, s63, s33
    s_and_b32 s63, s63, 0xff
    s_andn2_b32 s63, s63, s66
    s_cbranch_scc0 K_SP8
    s_or_b32 s66, s66, s63
    s_branch K_SPR8
K_SP10:
    ds_read_b32 v2, v12 offset:32
    s_waitcnt lgkmcnt(0)
    v_readfirstlane_b32 s33, v2
    s_nop 3
    s_lshr_b32 s63, s33, s64
    s_lshr_b32 s33, s33, s65
    s_and_b32 s63, s63, s33
    s_and_b32 s63, s63, 0xff00
    s_andn2_b32 s63, s63, s66
    s_cbranch_scc0 K_SP10
    s_or_b32 s66, s66, s63
    s_branch K_SPR10
K_SP11:
    ds_read_b32 v2, v12 offset:32
    s_waitcnt lgkmcnt(0)
    v_readfirstlane_b32 s33, v2
    s_nop 3
    s_lshr_b32 s63, s33, s64
    s_lshr_b32 s33, s33, s65
    s_and_b32 s63, s63, s33
    s_and_b32 s63, s63, 0xff00
    s_andn2_b32 s63, s63, s66
    s_cbranch_scc0 K_SP11
    s_or_b32 s66, s66, s63
    s_branch K_SPR11
K_SP12:
    ds_read_b32 v2, v12 offset:32
    s_waitcnt lgkmcnt(0)
    v_readfirstlane_b32 s33, v2
    s_nop 3
    s_lshr_b32 s63, s33, s64
    s_lshr_b32 s33, s33, s65
    s_and_b32 s63, s63, s33
    s_and_b32 s63, s63, 0xff00
    s_andn2_b32 s63, s63, s66
    s_cbranch_scc0 K_SP12
    s_or_b32 s66, s66, s63
    s_branch K_SPR12
K_SP13:
    ds_read_b32 v2, v12 offset:32
    s_waitcnt lgkmcnt(0)
    v_readfirstlane_b32 s33, v2
    s_nop 3
    s_lshr_b32 s63, s33, s64
    s_lshr_b32 s33, s33, s65
    s_and_b32 s63, s63, s33
    s_and_b32 s63, s63, 0xff00
    s_andn2_b32 s63, s63, s66
    s_cbranch_scc0 K_SP13
    s_or_b32 s66, s66, s63
    s_branch K_SPR13
K_SP14:
    ds_read_b32 v2, v12 offset:32
    s_waitcnt lgkmcnt(0)
    v_readfirstlane_b32 s33, v2
    s_nop 3
    s_lshr_b32 s63, s33, s64
    s_lshr_b32 s33, s33, s65
    s_and_b32 s63, s63, s33
    s_and_b32 s63, s63, 0xff00
    s_andn2_b32 s63, s63, s66
    s_cbranch_scc0 K_SP14
    s_or_b32 s66, s66, s63
    s_branch K_SPR14
K_SP15:
    ds_read_b32 v2, v12 offset:32
    s_waitcnt lgkmcnt(0)
    v_readfirstlane_b32 s33, v2
    s_nop 3
    s_lshr_b32 s63, s33, s64
    s_lshr_b32 s33, s33, s65
    s_and_b32 s63, s63, s33
    s_and_b32 s63, s63, 0xff00
    s_andn2_b32 s63, s63, s66
    s_cbranch_scc0 K_SP15
    s_or_b32 s66, s66, s63
    s_branch K_SPR15
K_SP16:
    ds_read_b32 v2, v12 offset:32
    s_waitcnt lgkmcnt(0)
    v_readfirstlane_b32 s33, v2
    s_nop 3
    s_lshr_b32 s63, s33, s64
    s_lshr_b32 s33, s33, s65
    s_and_b32 s63, s63, s33
    s_and_b32 s63, s63, 0xff00
    s_andn2_b32 s63, s63, s66
    s_cbranch_scc0 K_SP16
    s_or_b32 s66, s66, s63
    s_branch K_SPR16
K_SP18:
    ds_read_b32 v2, v12 offset:32
    s_waitcnt lgkmcnt(0)
    v_readfirstlane_b32 s33, v2
    s_nop 3
    s_lshr_b32 s63, s33, s64
    s_lshr_b32 s33, s33, s65
    s_and_b32 s63, s63, s33
    s_and_b32 s63, s63, 0xff00
    s_andn2_b32 s63, s63, s66
    s_cbranch_scc0 K_SP18
    s_or_b32 s66, s66, s63
    s_branch K_SPR18
WP_yr0:
    s_setpc_b64 s[38:39]
K_YROW0:
    v_lshlrev_b32 v5, 4, v9
    v_add_u32 v5, 158976, v5
    v_and_b32 v3, 15, v1
    s_and_b32 s33, s59, 15
    v_cmp_eq_u32 vcc, s33, v3
    s_mov_b32 s3, 1048576
K_P2_GY0:
    ds_read_b32 v2, v12 offset:64
    s_sub_u32 s3, s3, 1
    s_waitcnt lgkmcnt(0)
    v_readfirstlane_b32 s33, v2
    s_nop 3
    s_cselect_b32 s33, 1, s33
    s_cmp_lt_u32 s33, 1
    s_cbranch_scc1 K_P2_GY0
    s_mov_b64 exec, vcc
    s_cmp_ge_u32 s59, 16
    s_cbranch_scc1 K_YR1_0
    ds_read_b128 v[72:75], v5 offset:0
    ds_read_b128 v[76:79], v5 offset:64
    ds_read_b128 v[80:83], v5 offset:128
    ds_read_b128 v[84:87], v5 offset:192
    s_mov_b64 exec, -1
    s_branch K_NOY0
K_YR1_0:
    ds_read_b128 v[88:91], v5 offset:0
    ds_read_b128 v[92:95], v5 offset:64
    ds_read_b128 v[96:99], v5 offset:128
    ds_read_b128 v[100:103], v5 offset:192
    s_mov_b64 exec, -1
    s_branch K_NOY0
K_YROW1:
    v_lshlrev_b32 v5, 4, v9
    v_add_u32 v5, 159232, v5
    v_and_b32 v3, 15, v1
    s_and_b32 s33, s59, 15
    v_cmp_eq_u32 vcc, s33, v3
    s_mov_b32 s3, 1048576
K_P2_GY1:
    ds_read_b32 v2, v12 offset:68
    s_sub_u32 s3, s3, 1
    s_waitcnt lgkmcnt(0)
    v_readfirstlane_b32 s33, v2
    s_nop 3
    s_cselect_b32 s33, 1, s33
    s_cmp_lt_u32 s33, 1
    s_cbranch_scc1 K_P2_GY1
    s_mov_b64 exec, vcc
    s_cmp_ge_u32 s59, 16
    s_cbranch_scc1 K_YR1_1
    ds_read_b128 v[72:75], v5 offset:0
    ds_read_b128 v[76:79], v5 offset:64
    ds_read_b128 v[80:83], v5 offset:128
    ds_read_b128 v[84:87], v5 offset:192
    s_mov_b64 exec, -1
    s_branch K_NOY1
K_YR1_1:
    ds_read_b128 v[88:91], v5 offset:0
    ds_read_b128 v[92:95], v5 offset:64
    ds_read_b128 v[96:99], v5 offset:128
    ds_read_b128 v[100:103], v5 offset:192
    s_mov_b64 exec, -1
    s_branch K_NOY1
.p2align 12
WP_gen:
    s_setpc_b64 s[38:39]
K_P2:
    s_cmp_ge_u32 s30, 4
    s_cbranch_scc1 K_P2_HELP
    v_mov_b32 v12, 158720
    s_cmp_lg_u32 s30, 0
    s_cbranch_scc1 K_P2_W13
    v_lshrrev_b32 v3, 4, v1
    v_and_b32 v4, 7, v1
    v_lshrrev_b32 v2, 3, v1
    v_xor_b32 v4, v4, v3
    v_mul_u32_u24 v2, 1280, v2
    v_lshl_add_u32 v27, v4, 4, v2
    v_xor_b32 v28, 64, v27
    s_mov_b32 s58, 0
K_P2_XD:
    s_lshl_b32 s59, s40, 3
    s_lshl1_add_u32 s59, s58, s59
    s_mul_i32 s59, s59, 20480
    s_lshl_b32 s33, s41, 7
    s_add_u32 s59, s59, s33
    s_lshl_b32 s33, s58, 12
    s_add_u32 m0, s33, 140288
    s_add_u32 s3, s59, 0
    buffer_load_dwordx4 v27, s[12:15], s3 offen lds
    s_add_u32 m0, s33, 141312
    s_add_u32 s3, s59, 10240
    buffer_load_dwordx4 v28, s[12:15], s3 offen lds
    s_add_u32 m0, s33, 142336
    s_add_u32 s3, s59, 20480
    buffer_load_dwordx4 v27, s[12:15], s3 offen lds
    s_add_u32 m0, s33, 143360
    s_add_u32 s3, s59, 30720
    buffer_load_dwordx4 v28, s[12:15], s3 offen lds
    s_add_u32 s58, s58, 1
    s_cmp_lt_u32 s58, 4
    s_cbranch_scc1 K_P2_XD
    s_waitcnt vmcnt(0)
    s_branch K_P2_AUXW
K_P2_W13:
    v_lshrrev_b32 v2, 3, v1
    v_mul_u32_u24 v2, 1280, v2
    v_lshrrev_b32 v3, 4, v1
    v_lshlrev_b32 v3, 1, v3
    v_and_b32 v4, 7, v1
    v_xor_b32 v3, v3, v4
    v_lshl_add_u32 v2, v3, 4, v2
    s_lshl_b32 s33, s41, 7
    v_add_u32 v22, s33, v2
    s_mov_b32 s60, 0xfda87520
    s_mov_b32 s61, 0xecb96431
    s_sub_u32 s58, s30, 1
K_P2_WS:
    s_lshl_b32 s3, s58, 2
    s_lshr_b64 s[4:5], s[60:61], s3
    s_and_b32 s4, s4, 15
    s_mul_i32 s4, s4, 51200
    s_mul_i32 s59, s58, 5120
    s_add_u32 s52, s4, 0
    s_add_u32 m0, s59, 0
    s_waitcnt vmcnt(11)
    buffer_load_dwordx4 v22, s[24:27], s52 offen lds
    s_add_u32 s52, s4, 10240
    s_add_u32 m0, s59, 1024
    s_waitcnt vmcnt(11)
    buffer_load_dwordx4 v22, s[24:27], s52 offen lds
    s_add_u32 s52, s4, 20480
    s_add_u32 m0, s59, 2048
    s_waitcnt vmcnt(11)
    buffer_load_dwordx4 v22, s[24:27], s52 offen lds
    s_add_u32 s52, s4, 30720
    s_add_u32 m0, s59, 3072
    s_waitcnt vmcnt(11)
    buffer_load_dwordx4 v22, s[24:27], s52 offen lds
    s_add_u32 s52, s4, 40960
    s_add_u32 m0, s59, 4096
    s_waitcnt vmcnt(11)
    buffer_load_dwordx4 v22, s[24:27], s52 offen lds
    s_cmp_ge_u32 s58, 3
    s_cbranch_scc1 K_P2_WS1
    v_mov_b32 v3, 1
    s_waitcnt vmcnt(5)
    s_mov_b64 exec, 1
    ds_add_u32 v12, v3 offset:52
    s_mov_b64 exec, -1
K_P2_WS1:
    s_add_u32 s58, s58, 3
    s_cmp_lt_u32 s58, 16
    s_cbranch_scc1 K_P2_WS
K_P2_AUXW:
    v_mov_b32 v34, 1
    s_waitcnt vmcnt(10)
    s_mov_b64 exec, 1
    ds_add_u32 v12, v34 offset:72
    s_mov_b64 exec, -1
    s_lshl_b32 s54, s40, 7
    v_lshrrev_b32 v9, 4, v1
    v_mov_b32 v12, 158720
    s_add_u32 s20, s10, 0x100000
    s_addc_u32 s21, s11, 0
    s_mov_b32 s22, 0x280000
    s_mov_b32 s23, 0x20000
    s_add_u32 s16, s10, 0x1000
    s_addc_u32 s17, s11, 0
    s_mov_b32 s18, 0x2000
    s_mov_b32 s19, 0x20000
    s_mov_b32 s48, s6
    s_mov_b32 s49, s7
    s_mov_b32 s50, 0x280000
    s_mov_b32 s51, 0x20000
    s_lshl_b32 s53, s40, 3
    s_lshl1_add_u32 s53, s30, s53
    s_mov_b32 s55, 20480
    v_bfe_u32 v20, v1, 2, 2
    v_and_b32 v21, 3, v1
    s_mul_i32 s3, s53, 20480
    v_lshl_add_u32 v25, v1, 4, s3
    v_add_u32 v26, 20480, v25
    v_add_u32 v35, 16384, v25
    v_add_u32 v36, 16384, v26
    v_and_b32 v2, 15, v1
    s_lshl_b32 s3, s53, 6
    v_lshl_add_u32 v23, v2, 2, s3
    v_lshl_add_u32 v2, v9, 2, v20
    v_bfe_u32 v3, v2, 1, 2
    v_lshlrev_b32 v2, 7, v2
    v_lshl_add_u32 v2, v21, 3, v2
    v_lshl_add_u32 v24, v3, 5, v2
    v_lshrrev_b32 v3, 1, v20
    v_mul_u32_u24 v2, 40, v9
    v_add3_u32 v2, v2, 16, v20
    v_lshlrev_b32 v2, 7, v2
    v_lshl_add_u32 v2, v21, 3, v2
    v_xor_b32 v4, 0, v3
    v_lshl_add_u32 v60, v4, 5, v2
    v_xor_b32 v4, 1, v3
    v_lshl_add_u32 v61, v4, 5, v2
    v_xor_b32 v4, 2, v3
    v_lshl_add_u32 v62, v4, 5, v2
    v_xor_b32 v4, 3, v3
    v_lshl_add_u32 v63, v4, 5, v2
    v_lshrrev_b32 v3, 4, v1
    v_and_b32 v4, 7, v1
    v_lshrrev_b32 v2, 3, v1
    v_xor_b32 v4, v4, v3
    v_mul_u32_u24 v2, 1280, v2
    v_lshl_add_u32 v27, v4, 4, v2
    v_xor_b32 v28, 64, v27
    s_lshl_b32 s71, s40, 3
    s_lshl1_add_u32 s71, s30, s71
    s_mul_i32 s71, s71, 20480
    s_lshl_b32 s33, s41, 7
    s_add_u32 s71, s71, s33
    s_add_u32 s72, s71, 10240
    s_add_u32 s73, s71, 20480
    s_add_u32 s74, s71, 30720
    s_lshl_b32 s3, s30, 12
    s_add_u32 s3, s3, 140288
    v_lshl_add_u32 v33, v1, 4, s3
    v_and_b32 v2, 15, v1
    v_lshrrev_b32 v3, 1, v2
    v_lshrrev_b32 v4, 5, v1
    v_xor_b32 v3, v3, v4
    v_lshlrev_b32 v3, 4, v3
    v_lshl_add_u32 v3, v2, 7, v3
    v_and_b32 v4, 1, v9
    v_lshl_add_u32 v3, v4, 3, v3
    v_add_u32 v29, s3, v3
    v_xor_b32 v30, 32, v29
    v_xor_b32 v31, 64, v29
    v_xor_b32 v32, 96, v29
    s_and_b32 s33, s40, 3
    s_lshl_b32 s33, s33, 3
    s_lshr_b32 s33, 0x7f06037f, s33
    s_and_b32 s33, s33, 0xff
    s_lshl_b32 s3, s30, 1
    s_cmp_ge_u32 s3, s33
    s_cselect_b32 s64, 16, 0
    s_add_u32 s3, s3, 1
    s_cmp_ge_u32 s3, s33
    s_cselect_b32 s65, 16, 0
    s_mov_b32 s63, 0
    s_mov_b32 s66, 0
    s_mov_b32 s67, 16384
    s_mov_b32 s3, 1048576
K_P2_GWA:
    ds_read_b32 v2, v12 offset:72
    s_sub_u32 s3, s3, 1
    s_waitcnt lgkmcnt(0)
    v_readfirstlane_b32 s33, v2
    s_nop 3
    s_cselect_b32 s33, 4, s33
    s_cmp_lt_u32 s33, 4
    s_cbranch_scc1 K_P2_GWA
    s_branch K_P2_GEMM
WP_help:
    s_setpc_b64 s[38:39]
K_LATE:
    v_mov_b32 v6, 158800
    s_mov_b32 s3, 1048576
K_XGL:
    ds_read_b128 v[2:5], v6
    s_sleep 1
    s_sub_u32 s3, s3, 1
    s_waitcnt lgkmcnt(0)
    v_min3_u32 v2, v2, v4, v5
    v_min_u32 v2, v2, v3
    s_nop 0
    v_readfirstlane_b32 s33, v2
    s_nop 3
    s_cselect_b32 s33, 1, s33
    s_cmp_lt_u32 s33, 1
    s_cbranch_scc1 K_XGL
    s_sub_u32 s44, s30, 4
K_WOL:
    s_lshl_b32 s50, s44, 2
    s_lshr_b32 s50, 0x6431, s50
    s_and_b32 s50, s50, 7
    s_mul_i32 s50, s50, 51200
    s_mul_i32 s51, s44, 5120
    s_add_u32 s3, s50, 0
    s_add_u32 m0, s51, 40960
    s_waitcnt vmcnt(13)
    buffer_load_dwordx4 v17, s[24:27], s3 offen lds
    s_add_u32 s3, s50, 10240
    s_add_u32 m0, s51, 41984
    s_waitcnt vmcnt(13)
    buffer_load_dwordx4 v17, s[24:27], s3 offen lds
    s_add_u32 s3, s50, 20480
    s_add_u32 m0, s51, 43008
    s_waitcnt vmcnt(13)
    buffer_load_dwordx4 v17, s[24:27], s3 offen lds
    s_add_u32 s3, s50, 30720
    s_add_u32 m0, s51, 44032
    s_waitcnt vmcnt(13)
    buffer_load_dwordx4 v17, s[24:27], s3 offen lds
    s_add_u32 s3, s50, 40960
    s_add_u32 m0, s51, 45056
    s_waitcnt vmcnt(13)
    buffer_load_dwordx4 v17, s[24:27], s3 offen lds
    s_add_u32 s3, s50, 409600
    s_add_u32 m0, s51, 61440
    s_waitcnt vmcnt(13)
    buffer_load_dwordx4 v17, s[24:27], s3 offen lds
    s_add_u32 s3, s50, 419840
    s_add_u32 m0, s51, 62464
    s_waitcnt vmcnt(13)
    buffer_load_dwordx4 v17, s[24:27], s3 offen lds
    s_add_u32 s3, s50, 430080
    s_add_u32 m0, s51, 63488
    s_waitcnt vmcnt(13)
    buffer_load_dwordx4 v17, s[24:27], s3 offen lds
    s_add_u32 s3, s50, 440320
    s_add_u32 m0, s51, 64512
    s_waitcnt vmcnt(13)
    buffer_load_dwordx4 v17, s[24:27], s3 offen lds
    s_add_u32 s3, s50, 450560
    s_add_u32 m0, s51, 65536
    s_waitcnt vmcnt(13)
    buffer_load_dwordx4 v17, s[24:27], s3 offen lds
    s_add_u32 s44, s44, 2
    s_cmp_lt_u32 s44, 4
    s_cbranch_scc1 K_WOL
    v_mov_b32 v2, 158720
    v_mov_b32 v3, 2
    s_waitcnt vmcnt(0)
    s_mov_b64 exec, 1
    ds_add_u32 v2, v3 offset:44
    s_mov_b64 exec, -1
K_P2_HELP:
    s_setprio 3
    s_add_u32 s59, s40, 1
    s_bitcmp1_b32 s59, 1
    s_cselect_b32 s59, 31, 15
    v_and_b32 v10, s59, v1
    v_lshl_add_u32 v10, v10, 2, s42
    s_cmp_lg_u32 s30, 7
    s_cbranch_scc1 K_P2_N7
    v_and_b32 v4, 7, v1
    v_lshlrev_b32 v4, 2, v4
    s_mov_b32 s3, 131072
K_ZPOLL1:
    v_cmp_eq_u32 vcc, 0, v7
    s_cbranch_vccz K_ZOK1
    s_sub_u32 s3, s3, 1
    s_cbranch_scc1 K_ZOK1
    global_load_dword v7, v4, s[8:9] offset:192 sc1
    s_waitcnt vmcnt(0)
    s_branch K_ZPOLL1
K_ZOK1:
    global_load_dword v7, v10, s[10:11] sc1
K_P2_N7:
    s_lshl_b32 s54, s40, 7
    v_lshrrev_b32 v9, 4, v1
    v_mov_b32 v12, 158720
    s_add_u32 s44, s10, 0x10000
    s_addc_u32 s45, s11, 0
    s_mov_b32 s46, 0x43800
    s_mov_b32 s47, 0x20000
    v_mov_b32 v80, 1
    s_cmp_eq_u32 s30, 7
    s_cbranch_scc1 K_P2_FLAGS
    s_cmp_lg_u32 s30, 6
    s_cbranch_scc1 K_END
    s_mov_b32 s3, 131072
K_P2_DPOLL:
    v_cmp_eq_u32 vcc, 0, v7
    s_cbranch_vccz K_P2_DOK
    s_cmp_eq_u32 s3, 131072
    s_cbranch_scc1 K_P2_DNS
    s_sleep 12
K_P2_DNS:
    v_and_b32 v11, 1, v1
    v_lshl_add_u32 v11, v11, 2, s42
    global_load_dword v7, v11, s[10:11] offset:128 sc1
    s_sub_u32 s3, s3, 1
    s_waitcnt vmcnt(0)
    s_cmp_lg_u32 s3, 0
    s_cbranch_scc1 K_P2_DPOLL
K_P2_DOK:
    v_readlane_b32 s58, v7, 0
    v_readlane_b32 s59, v7, 1
    s_nop 3
    s_and_b32 s3, s58, 0x7ff
    s_sub_u32 s3, 2047, s3
    v_mov_b32 v20, s3
    v_mov_b32 v4, s58
    v_and_b32 v4, 0xffff0000, v4
    v_ashrrev_i32 v5, 31, v4
    v_not_b32 v5, v5
    v_or_b32 v5, 0x80000000, v5
    v_xor_b32 v4, v4, v5
    v_and_b32 v4, 0xffff0000, v4
    v_mul_f32 v5, 0xbfb8aa3b, v4
    v_exp_f32 v5, v5
    s_nop 0
    v_add_f32 v5, 1.0, v5
    v_rcp_f32 v4, v5
    s_nop 0
    v_cvt_pk_bf16_f32 v22, v4, v4
    v_lshlrev_b32 v22, 16, v22
    s_and_b32 s3, s59, 0x7ff
    s_sub_u32 s3, 2047, s3
    v_mov_b32 v21, s3
    v_mov_b32 v4, s59
    v_and_b32 v4, 0xffff0000, v4
    v_ashrrev_i32 v5, 31, v4
    v_not_b32 v5, v5
    v_or_b32 v5, 0x80000000, v5
    v_xor_b32 v4, v4, v5
    v_and_b32 v4, 0xffff0000, v4
    v_mul_f32 v5, 0xbfb8aa3b, v4
    v_exp_f32 v5, v5
    s_nop 0
    v_add_f32 v5, 1.0, v5
    v_rcp_f32 v4, v5
    s_nop 0
    v_cvt_pk_bf16_f32 v23, v4, v4
    v_lshlrev_b32 v23, 16, v23
    ds_write_b128 v12, v[20:23]
    ds_write_b32 v12, v80 offset:40
    s_mov_b32 s53, 0
    v_mov_b32 v16, v20
    v_mov_b32 v17, v21
    v_mov_b32 v18, v22
    v_mov_b32 v19, v23
K_P2_HW:
    s_cmp_eq_u32 s53, 0
    s_cselect_b64 vcc, -1, 0
    s_nop 1
    v_cndmask_b32 v2, v17, v16, vcc
    v_cndmask_b32 v5, v19, v18, vcc
    s_nop 0
    v_readfirstlane_b32 s58, v2
    s_nop 3
    s_sub_u32 s3, s58, s54
    s_cmp_lt_u32 s3, 128
    s_cbranch_scc0 K_P2_YN
    s_call_b64 s[38:39], WP_yr0
    s_mul_i32 s3, s58, 1280
    s_lshl_b32 s33, s41, 7
    s_add_u32 s3, s3, s33
    v_and_b32 v2, 15, v1
    v_lshlrev_b32 v2, 3, v2
    buffer_load_dwordx2 v[84:85], v2, s[12:15], s3 offen
    s_lshl_b32 s3, s58, 2
    s_add_u32 s3, s3, 4096
    v_mov_b32 v2, s3
    global_load_dword v88, v2, s[10:11] sc1
    s_lshl1_add_u32 s3, s41, s53
    s_lshl_b32 s3, s3, 8
    s_add_u32 s3, s3, 568320
    v_min_u32 v3, 53, v1
    v_lshl_add_u32 v3, v3, 2, s3
    s_mov_b32 s3, 131072
K_P2_YPOLL:
    global_load_dword v2, v3, s[10:11] sc1
    s_sub_u32 s3, s3, 1
    s_waitcnt vmcnt(0)
    v_cmp_ne_u32 vcc, 1, v2
    s_cbranch_vccz K_P2_YGO
    s_bcnt1_i32_b64 s33, vcc
    s_cmp_le_u32 s33, 24
    s_cbranch_scc1 K_P2_YS
    s_sleep 16
K_P2_YS:
    s_sleep 2
    s_cmp_lg_u32 s3, 0
    s_cbranch_scc1 K_P2_YPOLL
K_P2_YGO:
    v_and_b32 v2, 15, v1
    v_lshlrev_b32 v2, 4, v2
    v_mul_u32_u24 v4, 5120, v9
    s_mov_b32 s59, s53
    s_mul_i32 s33, s59, 2560
    s_lshl_b32 s3, s41, 8
    s_add_u32 s3, s3, s33
    v_add3_u32 v3, v2, v4, s3
    s_mov_b32 s52, 0
    buffer_load_dwordx4 v[24:27], v3, s[44:47], s52 offen sc1
    s_mov_b32 s52, 20480
    buffer_load_dwordx4 v[28:31], v3, s[44:47], s52 offen sc1
    s_mov_b32 s52, 40960
    buffer_load_dwordx4 v[32:35], v3, s[44:47], s52 offen sc1
    s_mov_b32 s52, 61440
    buffer_load_dwordx4 v[36:39], v3, s[44:47], s52 offen sc1
    s_mov_b32 s52, 81920
    buffer_load_dwordx4 v[40:43], v3, s[44:47], s52 offen sc1
    s_mov_b32 s52, 102400
    buffer_load_dwordx4 v[44:47], v3, s[44:47], s52 offen sc1
    s_mov_b32 s52, 122880
    buffer_load_dwordx4 v[48:51], v3, s[44:47], s52 offen sc1
    s_mov_b32 s52, 143360
    buffer_load_dwordx4 v[52:55], v3, s[44:47], s52 offen sc1
    s_mov_b32 s52, 163840
    buffer_load_dwordx4 v[56:59], v3, s[44:47], s52 offen sc1
    s_mov_b32 s52, 184320
    buffer_load_dwordx4 v[60:63], v3, s[44:47], s52 offen sc1
    s_mov_b32 s52, 204800
    buffer_load_dwordx4 v[64:67], v3, s[44:47], s52 offen sc1
    s_mov_b32 s52, 225280
    buffer_load_dwordx4 v[68:71], v3, s[44:47], s52 offen sc1
    s_mov_b32 s52, 245760
    buffer_load_dwordx4 v[72:75], v3, s[44:47], s52 offen sc1
    s_mov_b32 s52, 266240
    buffer_load_dwordx4 v[76:79], v3, s[44:47], s52 offen sc1
    v_sub_f32 v88, 1.0, v88
    v_cvt_pk_bf16_f32 v88, v88, v88
    v_lshlrev_b32 v88, 16, v88
    v_lshlrev_b32 v86, 16, v85
    v_and_b32 v87, 0xffff0000, v85
    v_and_b32 v85, 0xffff0000, v84
    v_lshlrev_b32 v84, 16, v84
    s_waitcnt vmcnt(12)
    v_pk_add_f32 v[20:21], v[24:25], v[28:29]
    v_pk_add_f32 v[22:23], v[26:27], v[30:31]
    s_waitcnt vmcnt(11)
    v_pk_add_f32 v[20:21], v[20:21], v[32:33]
    v_pk_add_f32 v[22:23], v[22:23], v[34:35]
    s_waitcnt vmcnt(10)
    v_pk_add_f32 v[20:21], v[20:21], v[36:37]
    v_pk_add_f32 v[22:23], v[22:23], v[38:39]
    s_waitcnt vmcnt(9)
    v_pk_add_f32 v[20:21], v[20:21], v[40:41]
    v_pk_add_f32 v[22:23], v[22:23], v[42:43]
    s_waitcnt vmcnt(8)
    v_pk_add_f32 v[20:21], v[20:21], v[44:45]
    v_pk_add_f32 v[22:23], v[22:23], v[46:47]
    s_waitcnt vmcnt(7)
    v_pk_add_f32 v[20:21], v[20:21], v[48:49]
    v_pk_add_f32 v[22:23], v[22:23], v[50:51]
    s_waitcnt vmcnt(6)
    v_pk_add_f32 v[20:21], v[20:21], v[52:53]
    v_pk_add_f32 v[22:23], v[22:23], v[54:55]
    s_waitcnt vmcnt(5)
    v_pk_add_f32 v[20:21], v[20:21], v[56:57]
    v_pk_add_f32 v[22:23], v[22:23], v[58:59]
    s_waitcnt vmcnt(4)
    v_pk_add_f32 v[20:21], v[20:21], v[60:61]
    v_pk_add_f32 v[22:23], v[22:23], v[62:63]
    s_waitcnt vmcnt(3)
    v_pk_add_f32 v[20:21], v[20:21], v[64:65]
    v_pk_add_f32 v[22:23], v[22:23], v[66:67]
    s_waitcnt vmcnt(2)
    v_pk_add_f32 v[20:21], v[20:21], v[68:69]
    v_pk_add_f32 v[22:23], v[22:23], v[70:71]
    s_waitcnt vmcnt(1)
    v_pk_add_f32 v[20:21], v[20:21], v[72:73]
    v_pk_add_f32 v[22:23], v[22:23], v[74:75]
    s_waitcnt vmcnt(0)
    v_pk_add_f32 v[20:21], v[20:21], v[76:77]
    v_pk_add_f32 v[22:23], v[22:23], v[78:79]
    v_mov_b32 v24, v20
    v_mov_b32 v25, v21
    v_mov_b32 v26, v22
    v_mov_b32 v27, v23
    s_nop 0
    v_permlane16_swap_b32 v20, v24
    v_permlane16_swap_b32 v21, v25
    v_permlane16_swap_b32 v22, v26
    v_permlane16_swap_b32 v23, v27
    v_add_f32 v20, v20, v24
    v_add_f32 v21, v21, v25
    v_add_f32 v22, v22, v26
    v_add_f32 v23, v23, v27
    v_mov_b32 v24, v20
    v_mov_b32 v25, v21
    v_mov_b32 v26, v22
    v_mov_b32 v27, v23
    s_nop 0
    v_permlane32_swap_b32 v20, v24
    v_permlane32_swap_b32 v21, v25
    v_permlane32_swap_b32 v22, v26
    v_permlane32_swap_b32 v23, v27
    v_add_f32 v20, v20, v24
    v_add_f32 v21, v21, v25
    v_add_f32 v22, v22, v26
    v_add_f32 v23, v23, v27
    v_cvt_pk_bf16_f32 v20, v20, v20
    v_lshlrev_b32 v20, 16, v20
    v_mul_f32 v20, v5, v20
    v_cvt_pk_bf16_f32 v20, v20, v20
    v_lshlrev_b32 v20, 16, v20
    v_add_f32 v20, v20, v84
    v_cvt_pk_bf16_f32 v20, v20, v20
    v_lshlrev_b32 v20, 16, v20
    v_mul_f32 v20, v20, v88
    v_cvt_pk_bf16_f32 v21, v21, v21
    v_lshlrev_b32 v21, 16, v21
    v_mul_f32 v21, v5, v21
    v_cvt_pk_bf16_f32 v21, v21, v21
    v_lshlrev_b32 v21, 16, v21
    v_add_f32 v21, v21, v85
    v_cvt_pk_bf16_f32 v21, v21, v21
    v_lshlrev_b32 v21, 16, v21
    v_mul_f32 v21, v21, v88
    v_cvt_pk_bf16_f32 v22, v22, v22
    v_lshlrev_b32 v22, 16, v22
    v_mul_f32 v22, v5, v22
    v_cvt_pk_bf16_f32 v22, v22, v22
    v_lshlrev_b32 v22, 16, v22
    v_add_f32 v22, v22, v86
    v_cvt_pk_bf16_f32 v22, v22, v22
    v_lshlrev_b32 v22, 16, v22
    v_mul_f32 v22, v22, v88
    v_cvt_pk_bf16_f32 v23, v23, v23
    v_lshlrev_b32 v23, 16, v23
    v_mul_f32 v23, v5, v23
    v_cvt_pk_bf16_f32 v23, v23, v23
    v_lshlrev_b32 v23, 16, v23
    v_add_f32 v23, v23, v87
    v_cvt_pk_bf16_f32 v23, v23, v23
    v_lshlrev_b32 v23, 16, v23
    v_mul_f32 v23, v23, v88
    s_lshl_b32 s3, s59, 8
    s_add_u32 s3, s3, 158976
    v_add_u32 v2, s3, v2
    ds_write_b128 v2, v[20:23]
    s_lshl_b32 s3, s59, 2
    v_add_u32 v2, s3, v12
    ds_write_b32 v2, v80 offset:64
K_P2_YN:
    s_add_u32 s53, s53, 1
    s_cmp_lt_u32 s53, 2
    s_cbranch_scc1 K_P2_HW
    s_branch K_END
WP_flags:
    s_setpc_b64 s[38:39]
K_P2_FLAGS:
    s_mov_b32 exec_hi, 0
    s_waitcnt vmcnt(0)
    s_mov_b32 s3, 131072
K_P2_FCHK:
    v_cmp_eq_u32 vcc, 1, v7
    s_nop 1
    v_mov_b32 v2, vcc_lo
    ds_write_b32 v12, v2 offset:32
    s_cmp_eq_u32 vcc_lo, -1
    s_cbranch_scc1 K_P2_FGO
    s_cmp_lg_u32 vcc_lo, 0
    s_cbranch_scc1 K_P2_FS
    s_sleep 4
K_P2_FS:
    s_sleep 6
    global_load_dword v7, v10, s[10:11] sc1
    s_sub_u32 s3, s3, 1
    s_waitcnt vmcnt(0)
    s_cbranch_scc0 K_P2_FCHK
    v_mov_b32 v2, -1
    ds_write_b32 v12, v2 offset:32
K_P2_FGO:
    s_mov_b64 exec, -1
    s_branch K_END
.p2align 12
K_AUX:
    s_load_dwordx8 s[48:55], s[0:1], 32
    s_load_dwordx2 s[56:57], s[0:1], 64
    s_mul_i32 s44, s28, 7
    s_add_u32 s44, s44, s29
    s_sub_u32 s44, s44, 1
    s_cmp_lt_u32 s44, 54
    s_cselect_b32 s44, s44, 63
    s_cmp_eq_u32 s29, 0
    s_cselect_b32 s44, 63, s44
    s_lshl_b32 s74, s28, 8
    s_lshl_b32 s3, s29, 5
    s_add_u32 s74, s74, s3
    v_mov_b32 v12, 158720
    v_mov_b32 v13, 1
    s_cmp_lt_u32 s30, 4
    s_cbranch_scc1 K_AUX_LO
    s_lshl_b32 s3, s30, 3
    s_add_u32 s3, s3, s74
    s_sub_u32 s3, s3, 32
    v_lshrrev_b32 v9, 3, v1
    v_add_u32 v9, s3, v9
    v_and_b32 v11, 7, v1
    v_lshlrev_b32 v11, 4, v11
    v_mul_u32_u24 v10, 1280, v9
    v_add_u32 v10, v10, v11
    s_waitcnt lgkmcnt(0)
    buffer_load_dwordx4 v[16:19], v10, s[12:15], 0 offen offset:0
    buffer_load_dwordx4 v[20:23], v10, s[12:15], 0 offen offset:128
    buffer_load_dwordx4 v[24:27], v10, s[12:15], 0 offen offset:256
    buffer_load_dwordx4 v[28:31], v10, s[12:15], 0 offen offset:384
    buffer_load_dwordx4 v[32:35], v10, s[12:15], 0 offen offset:512
    buffer_load_dwordx4 v[36:39], v10, s[12:15], 0 offen offset:640
    buffer_load_dwordx4 v[40:43], v10, s[12:15], 0 offen offset:768
    buffer_load_dwordx4 v[44:47], v10, s[12:15], 0 offen offset:896
    buffer_load_dwordx4 v[48:51], v10, s[12:15], 0 offen offset:1024
    buffer_load_dwordx4 v[52:55], v10, s[12:15], 0 offen offset:1152
    v_add_u32 v11, 127872, v11
    s_barrier
    v_mov_b32 v180, 0
    v_mov_b32 v181, 0
    v_mov_b32 v182, 0
    v_mov_b32 v183, 0
    v_and_b32 v10, 31, v9
    v_lshlrev_b32 v10, 2, v10
    v_add_u32 v10, 122880, v10
    v_sub_u32 v4, 0x87ff, v9
    s_setprio 2
    s_mov_b32 s3, 1048576
K_FGWV:
    ds_read_b32 v2, v12 offset:76
    s_sleep 1
    s_sub_u32 s3, s3, 1
    s_waitcnt lgkmcnt(0)
    v_readfirstlane_b32 s33, v2
    s_nop 3
    s_cselect_b32 s33, 1, s33
    s_cmp_lt_u32 s33, 1
    s_cbranch_scc1 K_FGWV
    ds_read_b128 v[56:59], v11 offset:0
    ds_read_b128 v[60:63], v11 offset:128
    ds_read_b128 v[64:67], v11 offset:256
    ds_read_b128 v[68:71], v11 offset:384
    ds_read_b128 v[72:75], v11 offset:512
    ds_read_b128 v[76:79], v11 offset:640
    ds_read_b128 v[80:83], v11 offset:768
    ds_read_b128 v[84:87], v11 offset:896
    ds_read_b128 v[88:91], v11 offset:1024
    ds_read_b128 v[92:95], v11 offset:1152
    ds_read_b128 v[96:99], v11 offset:2048
    ds_read_b128 v[100:103], v11 offset:2176
    ds_read_b128 v[104:107], v11 offset:2304
    ds_read_b128 v[108:111], v11 offset:2432
    ds_read_b128 v[112:115], v11 offset:2560
    ds_read_b128 v[116:119], v11 offset:2688
    ds_read_b128 v[120:123], v11 offset:2816
    ds_read_b128 v[124:127], v11 offset:2944
    ds_read_b128 v[128:131], v11 offset:3072
    ds_read_b128 v[132:135], v11 offset:3200
    s_waitcnt lgkmcnt(0)
    s_waitcnt vmcnt(9)
    v_dot2c_f32_bf16 v180, v16, v56
    v_dot2c_f32_bf16 v182, v16, v96
    v_dot2c_f32_bf16 v181, v17, v57
    v_dot2c_f32_bf16 v183, v17, v97
    v_dot2c_f32_bf16 v180, v18, v58
    v_dot2c_f32_bf16 v182, v18, v98
    v_dot2c_f32_bf16 v181, v19, v59
    v_dot2c_f32_bf16 v183, v19, v99
    s_waitcnt vmcnt(8)
    v_dot2c_f32_bf16 v180, v20, v60
    v_dot2c_f32_bf16 v182, v20, v100
    v_dot2c_f32_bf16 v181, v21, v61
    v_dot2c_f32_bf16 v183, v21, v101
    v_dot2c_f32_bf16 v180, v22, v62
    v_dot2c_f32_bf16 v182, v22, v102
    v_dot2c_f32_bf16 v181, v23, v63
    v_dot2c_f32_bf16 v183, v23, v103
    s_waitcnt vmcnt(7)
    v_dot2c_f32_bf16 v180, v24, v64
    v_dot2c_f32_bf16 v182, v24, v104
    v_dot2c_f32_bf16 v181, v25, v65
    v_dot2c_f32_bf16 v183, v25, v105
    v_dot2c_f32_bf16 v180, v26, v66
    v_dot2c_f32_bf16 v182, v26, v106
    v_dot2c_f32_bf16 v181, v27, v67
    v_dot2c_f32_bf16 v183, v27, v107
    s_waitcnt vmcnt(6)
    v_dot2c_f32_bf16 v180, v28, v68
    v_dot2c_f32_bf16 v182, v28, v108
    v_dot2c_f32_bf16 v181, v29, v69
    v_dot2c_f32_bf16 v183, v29, v109
    v_dot2c_f32_bf16 v180, v30, v70
    v_dot2c_f32_bf16 v182, v30, v110
    v_dot2c_f32_bf16 v181, v31, v71
    v_dot2c_f32_bf16 v183, v31, v111
    s_waitcnt vmcnt(5)
    v_dot2c_f32_bf16 v180, v32, v72
    v_dot2c_f32_bf16 v182, v32, v112
    v_dot2c_f32_bf16 v181, v33, v73
    v_dot2c_f32_bf16 v183, v33, v113
    v_dot2c_f32_bf16 v180, v34, v74
    v_dot2c_f32_bf16 v182, v34, v114
    v_dot2c_f32_bf16 v181, v35, v75
    v_dot2c_f32_bf16 v183, v35, v115
    s_waitcnt vmcnt(4)
    v_dot2c_f32_bf16 v180, v36, v76
    v_dot2c_f32_bf16 v182, v36, v116
    v_dot2c_f32_bf16 v181, v37, v77
    v_dot2c_f32_bf16 v183, v37, v117
    v_dot2c_f32_bf16 v180, v38, v78
    v_dot2c_f32_bf16 v182, v38, v118
    v_dot2c_f32_bf16 v181, v39, v79
    v_dot2c_f32_bf16 v183, v39, v119
    s_waitcnt vmcnt(3)
    v_dot2c_f32_bf16 v180, v40, v80
    v_dot2c_f32_bf16 v182, v40, v120
    v_dot2c_f32_bf16 v181, v41, v81
    v_dot2c_f32_bf16 v183, v41, v121
    v_dot2c_f32_bf16 v180, v42, v82
    v_dot2c_f32_bf16 v182, v42, v122
    v_dot2c_f32_bf16 v181, v43, v83
    v_dot2c_f32_bf16 v183, v43, v123
    s_waitcnt vmcnt(2)
    v_dot2c_f32_bf16 v180, v44, v84
    v_dot2c_f32_bf16 v182, v44, v124
    v_dot2c_f32_bf16 v181, v45, v85
    v_dot2c_f32_bf16 v183, v45, v125
    v_dot2c_f32_bf16 v180, v46, v86
    v_dot2c_f32_bf16 v182, v46, v126
    v_dot2c_f32_bf16 v181, v47, v87
    v_dot2c_f32_bf16 v183, v47, v127
    s_waitcnt vmcnt(1)
    v_dot2c_f32_bf16 v180, v48, v88
    v_dot2c_f32_bf16 v182, v48, v128
    v_dot2c_f32_bf16 v181, v49, v89
    v_dot2c_f32_bf16 v183, v49, v129
    v_dot2c_f32_bf16 v180, v50, v90
    v_dot2c_f32_bf16 v182, v50, v130
    v_dot2c_f32_bf16 v181, v51, v91
    v_dot2c_f32_bf16 v183, v51, v131
    s_waitcnt vmcnt(0)
    v_dot2c_f32_bf16 v180, v52, v92
    v_dot2c_f32_bf16 v182, v52, v132
    v_dot2c_f32_bf16 v181, v53, v93
    v_dot2c_f32_bf16 v183, v53, v133
    v_dot2c_f32_bf16 v180, v54, v94
    v_dot2c_f32_bf16 v182, v54, v134
    v_dot2c_f32_bf16 v181, v55, v95
    v_dot2c_f32_bf16 v183, v55, v135
    s_nop 2
    v_add_f32 v180, v180, v181
    v_add_f32 v182, v182, v183
    s_nop 0
    v_add_f32_dpp v180, v180, v180 quad_perm:[1,0,3,2] row_mask:0xf bank_mask:0xf
    v_add_f32_dpp v182, v182, v182 quad_perm:[1,0,3,2] row_mask:0xf bank_mask:0xf
    s_nop 0
    v_add_f32_dpp v180, v180, v180 quad_perm:[2,3,0,1] row_mask:0xf bank_mask:0xf
    v_add_f32_dpp v182, v182, v182 quad_perm:[2,3,0,1] row_mask:0xf bank_mask:0xf
    s_nop 0
    v_add_f32_dpp v180, v180, v180 row_half_mirror row_mask:0xf bank_mask:0xf
    v_add_f32_dpp v182, v182, v182 row_half_mirror row_mask:0xf bank_mask:0xf
    v_cvt_pk_bf16_f32 v2, v180, v180
    v_lshlrev_b32 v2, 16, v2
    v_ashrrev_i32 v3, 31, v2
    v_or_b32 v3, 0x80000000, v3
    v_xor_b32 v2, v2, v3
    v_and_b32 v2, 0xffff0000, v2
    v_or_b32 v2, v2, v4
    ds_write2_b32 v10, v2, v182 offset0:0 offset1:32
    s_mov_b64 exec, 1
    ds_add_u32 v12, v13 offset:36
    s_mov_b64 exec, -1
    s_setprio 0
    s_cmp_lg_u32 s30, 4
    s_cbranch_scc1 K_WARMA0
    s_call_b64 s[38:39], WP_p2g
    s_branch K_WARMAX
K_WARMA0:
    s_cmp_lg_u32 s30, 5
    s_cbranch_scc1 K_WARMA1
    s_call_b64 s[38:39], WP_gen
    s_branch K_WARMAX
K_WARMA1:
    s_cmp_lg_u32 s30, 6
    s_cbranch_scc1 K_WARMA2
    s_call_b64 s[38:39], WP_help
    s_call_b64 s[38:39], WP_flags
    s_branch K_WARMAX
K_WARMA2:
    s_call_b64 s[38:39], WP_spin
K_WARMAX:
    s_cmp_ge_u32 s30, 6
    s_cselect_b32 s44, 63, s44
    s_cmp_lg_u32 s44, 63
    s_cbranch_scc1 K_FFN_C
    s_mov_b32 s3, 1048576
K_FGH:
    ds_read_b32 v2, v12 offset:48
    s_sleep 8
    s_sub_u32 s3, s3, 1
    s_waitcnt lgkmcnt(0)
    v_readfirstlane_b32 s33, v2
    s_nop 3
    s_cselect_b32 s33, 1, s33
    s_cmp_lt_u32 s33, 1
    s_cbranch_scc1 K_FGH
    s_cmp_eq_u32 s30, 6
    s_cbranch_scc1 K_P2_HELP
    v_mov_b32 v7, 1
    s_branch K_P2_HELP
K_AUX_LO:
    s_waitcnt lgkmcnt(0)
    s_cmp_eq_u32 s30, 0
    s_cbranch_scc1 K_AUX_PUB
    s_cmp_eq_u32 s44, 63
    s_cbranch_scc1 K_AUX_NOF
    s_and_b32 s3, s44, 1
    s_cmp_eq_u32 s3, 0
    s_cselect_b64 s[60:61], s[50:51], s[52:53]
    s_cselect_b64 s[64:65], s[52:53], s[50:51]
    s_cselect_b32 s75, 0, 40960
    s_mov_b32 s62, 0x21c000
    s_mov_b32 s63, 0x20000
    s_mov_b32 s66, 0x21c000
    s_mov_b32 s67, 0x20000
    v_lshrrev_b32 v2, 2, v1
    v_mul_u32_u24 v184, 3456, v2
    v_and_b32 v2, 3, v1
    v_lshl_add_u32 v184, v2, 4, v184
    s_lshl_b32 s72, s44, 6
    v_add_u32 v184, s72, v184
    s_sub_u32 s74, s30, 1
    s_barrier
K_FSA0:
    s_lshl_b32 s73, s74, 10
    s_mul_i32 s72, s74, 55296
    s_add_u32 m0, s73, s75
    s_waitcnt vmcnt(7)
    buffer_load_dwordx4 v184, s[60:63], s72 offen lds
    s_add_u32 s74, s74, 3
    s_cmp_lt_u32 s74, 24
    s_cbranch_scc1 K_FSA0
    s_mov_b32 s3, 1048576
K_FGPB:
    ds_read_b32 v2, v12 offset:36
    s_sleep 1
    s_sub_u32 s3, s3, 1
    s_waitcnt lgkmcnt(0)
    v_readfirstlane_b32 s33, v2
    s_nop 3
    s_cselect_b32 s33, 5, s33
    s_cmp_lt_u32 s33, 5
    s_cbranch_scc1 K_FGPB
K_FSA:
    s_lshl_b32 s73, s74, 10
    s_mul_i32 s72, s74, 55296
    s_add_u32 m0, s73, s75
    s_waitcnt vmcnt(7)
    buffer_load_dwordx4 v184, s[60:63], s72 offen lds
    s_add_u32 s74, s74, 3
    s_cmp_lt_u32 s74, 40
    s_cbranch_scc1 K_FSA
    s_sub_u32 s74, s74, 40
    s_xor_b32 s75, s75, 40960
    s_mov_b32 s68, s54
    s_mov_b32 s69, s55
    s_mov_b32 s70, 0x21c000
    s_mov_b32 s71, 0x20000
    s_mul_i32 s3, s44, 40960
    v_lshrrev_b32 v2, 3, v1
    v_mul_u32_u24 v2, 1280, v2
    v_lshrrev_b32 v3, 4, v1
    v_lshlrev_b32 v3, 1, v3
    v_and_b32 v4, 7, v1
    v_xor_b32 v3, v3, v4
    v_lshl_add_u32 v2, v3, 4, v2
    v_add_u32 v185, s3, v2
K_FSB:
    s_lshl_b32 s73, s74, 10
    s_mul_i32 s72, s74, 55296
    s_add_u32 m0, s73, s75
    s_waitcnt vmcnt(7)
    buffer_load_dwordx4 v184, s[64:67], s72 offen lds
    s_add_u32 s74, s74, 3
    s_cmp_lt_u32 s74, 40
    s_cbranch_scc1 K_FSB
    s_sub_u32 s74, s74, 40
    s_mov_b32 s75, 81920
K_FSD0:
    s_lshl_b32 s73, s74, 10
    s_and_b32 s72, s74, 3
    s_mul_i32 s72, s72, 10208
    s_lshl_b32 s3, s74, 5
    s_add_u32 s72, s72, s3
    s_add_u32 m0, s73, s75
    s_waitcnt vmcnt(7)
    buffer_load_dwordx4 v185, s[68:71], s72 offen lds
    s_add_u32 s74, s74, 3
    s_cmp_lt_u32 s74, 24
    s_cbranch_scc1 K_FSD0
    s_waitcnt vmcnt(8)
    s_mov_b64 exec, 1
    ds_add_u32 v12, v13 offset:56
    s_mov_b64 exec, -1
K_FSD:
    s_lshl_b32 s73, s74, 10
    s_and_b32 s72, s74, 3
    s_mul_i32 s72, s72, 10208
    s_lshl_b32 s3, s74, 5
    s_add_u32 s72, s72, s3
    s_add_u32 m0, s73, s75
    s_waitcnt vmcnt(7)
    buffer_load_dwordx4 v185, s[68:71], s72 offen lds
    s_add_u32 s74, s74, 3
    s_cmp_lt_u32 s74, 40
    s_cbranch_scc1 K_FSD
    s_mul_i32 s3, s29, 96
    s_lshl_b32 s72, s30, 5
    s_add_u32 s3, s3, s72
    s_sub_u32 s3, s3, 128
    v_lshrrev_b32 v2, 1, v1
    v_add_u32 v2, s3, v2
    v_mul_u32_u24 v2, 1280, v2
    v_and_b32 v3, 1, v1
    v_lshl_add_u32 v2, v3, 7, v2
    buffer_load_dword v6, v2, s[24:27], 0 offen offset:1024
K_AUX_WR:
    s_mov_b32 s3, 1048576
K_FGR:
    ds_read_b32 v2, v12 offset:60
    s_sleep 2
    s_sub_u32 s3, s3, 1
    s_waitcnt lgkmcnt(0)
    v_readfirstlane_b32 s33, v2
    s_nop 3
    s_cselect_b32 s33, 2, s33
    s_cmp_lt_u32 s33, 2
    s_cbranch_scc1 K_FGR
    s_branch K_P2
K_AUX_NOF:
    s_cmp_lg_u32 s2, 63
    s_cbranch_scc1 K_AUX_NOZ
    s_cmp_lg_u32 s30, 1
    s_cbranch_scc1 K_AUX_NOZ
    s_add_u32 s60, s10, 0x80000
    s_addc_u32 s61, s11, 0
    s_mov_b32 s62, 0xc000
    s_mov_b32 s63, 0x20000
    v_mov_b32 v9, 786432
    global_load_dword v10, v9, s[10:11] sc1
    v_lshlrev_b32 v11, 4, v1
    v_add_u32 v11, 790528, v11
    global_load_dword v6, v11, s[10:11] sc1
    s_barrier
    s_mov_b32 s3, 1048576
K_FGZ:
    ds_read_b32 v2, v12 offset:36
    s_sleep 2
    s_sub_u32 s3, s3, 1
    s_waitcnt lgkmcnt(0)
    v_readfirstlane_b32 s33, v2
    s_nop 3
    s_cselect_b32 s33, 4, s33
    s_cmp_lt_u32 s33, 4
    s_cbranch_scc1 K_FGZ
    v_and_b32 v4, 7, v1
    v_lshlrev_b32 v4, 2, v4
    global_load_dword v7, v4, s[8:9] offset:192 sc1
    s_waitcnt vmcnt(1)
    v_add_u32 v10, 1, v10
    s_mov_b32 s3, 131072
    s_setprio 3
K_AG2_POLL:
    global_load_dwordx4 v[16:19], v11, s[10:11] sc1
    s_waitcnt vmcnt(0)
    v_xor_b32 v2, v10, v17
    v_xor_b32 v3, v10, v19
    v_or_b32 v2, v2, v3
    v_cmp_ne_u32 vcc, 0, v2
    s_cbranch_vccz K_AG2_GOT
    s_sleep 2
    s_sub_u32 s3, s3, 1
    s_cmp_lg_u32 s3, 0
    s_cbranch_scc1 K_AG2_POLL
K_AG2_GOT:
    s_nop 1
    v_max_u32_dpp v3, v16, v16 quad_perm:[1,0,3,2] row_mask:0xf bank_mask:0xf
    s_nop 1
    v_max_u32_dpp v3, v3, v3 quad_perm:[2,3,0,1] row_mask:0xf bank_mask:0xf
    s_nop 1
    v_max_u32_dpp v3, v3, v3 row_half_mirror row_mask:0xf bank_mask:0xf
    s_nop 1
    v_max_u32_dpp v3, v3, v3 row_mirror row_mask:0xf bank_mask:0xf
    s_nop 1
    v_readlane_b32 s74, v3, 0
    v_readlane_b32 s76, v3, 16
    v_readlane_b32 s77, v3, 32
    v_readlane_b32 s78, v3, 48
    s_nop 3
    s_max_u32 s74, s74, s76
    s_max_u32 s77, s77, s78
    s_max_u32 s74, s74, s77
    v_cmp_ne_u32 vcc, s74, v16
    s_nop 1
    v_cndmask_b32 v2, v18, v16, vcc
    s_nop 1
    v_max_u32_dpp v3, v2, v2 quad_perm:[1,0,3,2] row_mask:0xf bank_mask:0xf
    s_nop 1
    v_max_u32_dpp v3, v3, v3 quad_perm:[2,3,0,1] row_mask:0xf bank_mask:0xf
    s_nop 1
    v_max_u32_dpp v3, v3, v3 row_half_mirror row_mask:0xf bank_mask:0xf
    s_nop 1
    v_max_u32_dpp v3, v3, v3 row_mirror row_mask:0xf bank_mask:0xf
    s_nop 1
    v_readlane_b32 s75, v3, 0
    v_readlane_b32 s76, v3, 16
    v_readlane_b32 s77, v3, 32
    v_readlane_b32 s78, v3, 48
    s_nop 3
    s_max_u32 s75, s75, s76
    s_max_u32 s77, s77, s78
    s_max_u32 s75, s75, s77
    v_mov_b32 v176, s74
    v_mov_b32 v177, s75
    v_and_b32 v4, 7, v1
    v_lshlrev_b32 v4, 2, v4
    s_mov_b32 s3, 131072
K_ZPOLL4:
    v_cmp_eq_u32 vcc, 0, v7
    s_cbranch_vccz K_ZOK4
    s_sub_u32 s3, s3, 1
    s_cbranch_scc1 K_ZOK4
    global_load_dword v7, v4, s[8:9] offset:192 sc1
    s_waitcnt vmcnt(0)
    s_branch K_ZPOLL4
K_ZOK4:
    v_and_b32 v2, 7, v1
    v_mul_u32_u24 v2, 20, v2
    v_lshrrev_b32 v3, 3, v1
    v_add_lshl_u32 v2, v2, v3, 8
    buffer_store_dwordx2 v[176:177], v2, s[60:63], 0 offen offset:136 sc1
    s_mov_b64 exec, 1
    global_store_dword v9, v10, s[10:11] sc1
    s_mov_b64 exec, -1
    v_lshlrev_b32 v4, 2, v1
    s_mov_b32 s72, 43008
    s_mov_b32 s3, 131072
K_AGG_POLL:
    s_sleep 8
    buffer_load_dword v2, v4, s[60:63], s72 offen sc1
    s_waitcnt vmcnt(0)
    v_cmp_eq_u32 vcc, 0, v2
    s_cbranch_vccz K_AGG_GOT
    s_sub_u32 s3, s3, 1
    s_cmp_lg_u32 s3, 0
    s_cbranch_scc1 K_AGG_POLL
K_AGG_GOT:
    s_mov_b32 s62, 40960
    v_lshlrev_b32 v3, 8, v1
    s_mov_b32 s3, 0
    buffer_store_dwordx2 v[176:177], v3, s[60:63], s3 offen offset:128 sc1
    s_mov_b32 s3, 16384
    buffer_store_dwordx2 v[176:177], v3, s[60:63], s3 offen offset:128 sc1
    s_mov_b32 s3, 32768
    buffer_store_dwordx2 v[176:177], v3, s[60:63], s3 offen offset:128 sc1
    s_setprio 0
    s_branch K_AUX_NOK
K_AUX_NOZ:
    s_barrier
K_AUX_NOK:
    s_mov_b32 s3, 1048576
K_FGWD:
    ds_read_b32 v2, v12 offset:48
    s_sleep 4
    s_sub_u32 s3, s3, 1
    s_waitcnt lgkmcnt(0)
    v_readfirstlane_b32 s33, v2
    s_nop 3
    s_cselect_b32 s33, 1, s33
    s_cmp_lt_u32 s33, 1
    s_cbranch_scc1 K_FGWD
    s_branch K_P2
K_AUX_PUB:
    s_mov_b32 s16, s48
    s_mov_b32 s17, s49
    s_mov_b32 s18, 0x500
    s_mov_b32 s19, 0x20000
    s_mov_b32 s20, s56
    s_mov_b32 s21, s57
    s_mov_b32 s22, 0x500
    s_mov_b32 s23, 0x20000
    v_lshlrev_b32 v2, 4, v1
    s_mov_b32 m0, 127872
    s_nop 0
    buffer_load_dwordx4 v2, s[16:19], 0 offen lds
    buffer_load_dwordx4 v2, s[16:19], 0 offen offset:1024 lds
    s_mov_b32 m0, 129920
    s_nop 0
    buffer_load_dwordx4 v2, s[20:23], 0 offen lds
    buffer_load_dwordx4 v2, s[20:23], 0 offen offset:1024 lds
    s_add_u32 s60, s10, 0x1000
    s_addc_u32 s61, s11, 0
    s_mov_b32 s62, 0x2000
    s_mov_b32 s63, 0x20000
    v_and_b32 v3, 31, v1
    v_lshlrev_b32 v10, 2, v3
    v_add_u32 v11, 122880, v10
    s_lshl_b32 s72, s74, 2
    v_mov_b32 v2, 786432
    global_load_dword v17, v2, s[10:11] sc1
    s_lshl_b32 s3, s2, 2
    s_add_u32 s3, s3, 567296
    v_mov_b32 v9, s3
    s_lshl_b32 s3, s2, 4
    s_add_u32 s3, s3, 790528
    v_lshl_add_u32 v20, v1, 4, s3
    v_and_b32 v5, 7, v1
    v_lshlrev_b32 v5, 2, v5
    s_barrier
    s_setprio 3
    s_waitcnt vmcnt(1)
    ds_write_b32 v12, v13 offset:76
    s_waitcnt vmcnt(0)
    v_add_u32 v17, 1, v17
    v_mov_b32 v19, v17
    s_mov_b32 s3, 1048576
K_FGRT:
    ds_read_b32 v2, v12 offset:36
    s_sleep 0
    s_sub_u32 s3, s3, 1
    s_waitcnt lgkmcnt(0)
    v_readfirstlane_b32 s33, v2
    s_nop 3
    s_cselect_b32 s33, 4, s33
    s_cmp_lt_u32 s33, 4
    s_cbranch_scc1 K_FGRT
    ds_read2_b32 v[176:177], v11 offset0:0 offset1:32
    s_waitcnt lgkmcnt(0)
    s_nop 1
    v_max_u32_dpp v3, v176, v176 quad_perm:[1,0,3,2] row_mask:0xf bank_mask:0xf
    s_nop 1
    v_max_u32_dpp v3, v3, v3 quad_perm:[2,3,0,1] row_mask:0xf bank_mask:0xf
    s_nop 1
    v_max_u32_dpp v3, v3, v3 row_half_mirror row_mask:0xf bank_mask:0xf
    s_nop 1
    v_max_u32_dpp v3, v3, v3 row_mirror row_mask:0xf bank_mask:0xf
    s_nop 1
    v_readlane_b32 s74, v3, 0
    v_readlane_b32 s76, v3, 16
    v_readlane_b32 s77, v3, 32
    v_readlane_b32 s78, v3, 48
    s_nop 3
    s_max_u32 s74, s74, s76
    s_max_u32 s77, s77, s78
    s_max_u32 s74, s74, s77
    v_cmp_ne_u32 vcc, s74, v176
    s_nop 1
    v_cndmask_b32 v176, 0, v176, vcc
    s_nop 1
    v_max_u32_dpp v3, v176, v176 quad_perm:[1,0,3,2] row_mask:0xf bank_mask:0xf
    s_nop 1
    v_max_u32_dpp v3, v3, v3 quad_perm:[2,3,0,1] row_mask:0xf bank_mask:0xf
    s_nop 1
    v_max_u32_dpp v3, v3, v3 row_half_mirror row_mask:0xf bank_mask:0xf
    s_nop 1
    v_max_u32_dpp v3, v3, v3 row_mirror row_mask:0xf bank_mask:0xf
    s_nop 1
    v_readlane_b32 s75, v3, 0
    v_readlane_b32 s76, v3, 16
    v_readlane_b32 s77, v3, 32
    v_readlane_b32 s78, v3, 48
    s_nop 3
    s_max_u32 s75, s75, s76
    s_max_u32 s77, s77, s78
    s_max_u32 s75, s75, s77
    v_mov_b32 v16, s74
    v_mov_b32 v18, s75
    s_mov_b64 exec, 1
    global_store_dwordx4 v20, v[16:19], s[10:11] sc1
    s_mov_b64 exec, -1
    s_mov_b64 exec, 1
    ds_add_u32 v12, v13 offset:36
    s_mov_b64 exec, -1
    global_load_dword v7, v5, s[8:9] offset:192 sc1
    v_cvt_pk_bf16_f32 v177, v177, v177
    v_lshlrev_b32 v177, 16, v177
    v_mul_f32 v3, 0xbfb8aa3b, v177
    v_exp_f32 v3, v3
    s_nop 0
    v_add_f32 v3, 1.0, v3
    v_rcp_f32 v177, v3
    s_nop 0
    v_cvt_pk_bf16_f32 v177, v177, v177
    v_lshlrev_b32 v177, 16, v177
    s_mov_b32 exec_hi, 0
    buffer_store_dword v177, v10, s[60:63], s72 offen sc1
    s_mov_b64 exec, -1
    s_waitcnt vmcnt(0)
    v_and_b32 v4, 7, v1
    v_lshlrev_b32 v4, 2, v4
    s_mov_b32 s3, 131072
K_ZPOLL3:
    v_cmp_eq_u32 vcc, 0, v7
    s_cbranch_vccz K_ZOK3
    s_sub_u32 s3, s3, 1
    s_cbranch_scc1 K_ZOK3
    global_load_dword v7, v4, s[8:9] offset:192 sc1
    s_waitcnt vmcnt(0)
    s_branch K_ZPOLL3
K_ZOK3:
    s_mov_b64 exec, 1
    global_store_dword v9, v13, s[10:11] sc1
    s_mov_b64 exec, -1
    v_and_b32 v3, 1, v1
    v_lshl_add_u32 v3, v3, 2, s42
    v_lshlrev_b32 v10, 4, v1
    s_mov_b32 s3, 131072
K_AUX_POLL:
    s_sleep 6
    global_load_dword v2, v3, s[10:11] offset:136 sc1
    s_waitcnt vmcnt(0)
    v_cmp_eq_u32 vcc, 0, v2
    s_cbranch_vccz K_AUX_GOT
    s_sub_u32 s3, s3, 1
    s_cmp_lg_u32 s3, 0
    s_cbranch_scc1 K_AUX_POLL
K_AUX_GOT:
    v_readlane_b32 s74, v2, 0
    v_readlane_b32 s75, v2, 1
    s_nop 3
    s_and_b32 s74, s74, 0x7ff
    s_sub_u32 s74, 2047, s74
    s_mul_i32 s74, s74, 1280
    s_mov_b32 m0, 125184
    s_nop 0
    buffer_load_dwordx4 v10, s[12:15], s74 offen lds
    s_mov_b64 exec, 0xffff
    buffer_load_dwordx4 v10, s[12:15], s74 offen offset:1024 lds
    s_mov_b64 exec, -1
    s_and_b32 s75, s75, 0x7ff
    s_sub_u32 s75, 2047, s75
    s_mul_i32 s75, s75, 1280
    s_mov_b32 m0, 126528
    s_nop 0
    buffer_load_dwordx4 v10, s[12:15], s75 offen lds
    s_mov_b64 exec, 0xffff
    buffer_load_dwordx4 v10, s[12:15], s75 offen offset:1024 lds
    s_mov_b64 exec, -1
    s_waitcnt vmcnt(0)
    ds_write_b32 v12, v13 offset:48
    s_setprio 0
    s_branch K_P2
.p2align 12
K_FFN_C:
    s_add_u32 s64, s10, 0x10000
    s_addc_u32 s65, s11, 0
    s_mov_b32 s66, 0x43800
    s_mov_b32 s67, 0x20000
    s_and_b32 s73, s30, 1
    v_lshrrev_b32 v232, 4, v1
    v_bfe_u32 v4, v1, 2, 2
    v_lshl_add_u32 v2, v232, 3, v4
    v_and_b32 v3, 3, v1
    v_lshlrev_b32 v3, 3, v3
    v_lshl_add_u32 v233, v2, 6, v3
    s_lshl_b32 s72, s73, 5
    v_add_u32 v233, s72, v233
    v_lshl_add_u32 v2, v232, 2, v4
    v_bfe_u32 v4, v2, 1, 2
    v_lshl_add_u32 v3, v2, 7, v3
    v_lshl_add_u32 v3, v4, 5, v3
    s_mul_i32 s3, s73, 20480
    s_add_u32 s3, s3, 81920
    v_add_u32 v238, s3, v3
    v_xor_b32 v239, 32, v238
    v_xor_b32 v240, 64, v238
    v_xor_b32 v241, 96, v238
    v_and_b32 v2, 1, v1
    v_mul_u32_u24 v234, 1344, v2
    v_lshl_add_u32 v234, v232, 4, v234
    v_add_u32 v234, 125184, v234
    v_lshlrev_b32 v236, 4, v1
    v_add_u32 v236, 124160, v236
    s_lshl_b32 s3, s73, 3
    v_add_u32 v235, s3, v236
    v_lshlrev_b32 v237, 2, v1
    s_mul_i32 s3, s44, 5120
    s_mul_i32 s72, s73, 1280
    s_add_u32 s72, s72, s3
    v_lshlrev_b32 v2, 4, v1
    buffer_store_dwordx4 v[16:19], v2, s[64:67], s72 offen offset:0 sc1
    buffer_store_dwordx4 v[16:19], v2, s[64:67], s72 offen offset:2560 sc1
    s_mov_b64 exec, 0xffff
    buffer_store_dwordx4 v[16:19], v2, s[64:67], s72 offen offset:1024 sc1
    buffer_store_dwordx4 v[16:19], v2, s[64:67], s72 offen offset:3584 sc1
    s_mov_b64 exec, -1
    v_add_u32 v5, 40960, v233
    s_mov_b32 s3, 1048576
K_FGD:
    ds_read_b32 v2, v12 offset:56
    s_sleep 2
    s_sub_u32 s3, s3, 1
    s_waitcnt lgkmcnt(0)
    v_readfirstlane_b32 s33, v2
    s_nop 3
    s_cselect_b32 s33, 3, s33
    s_cmp_lt_u32 s33, 3
    s_cbranch_scc1 K_FGD
    s_setprio 3
    ds_read_b64_tr_b16 v[16:17], v233 offset:0
    ds_read_b64_tr_b16 v[18:19], v233 offset:256
    ds_read_b64_tr_b16 v[20:21], v233 offset:2048
    ds_read_b64_tr_b16 v[22:23], v233 offset:2304
    ds_read_b64_tr_b16 v[24:25], v233 offset:4096
    ds_read_b64_tr_b16 v[26:27], v233 offset:4352
    ds_read_b64_tr_b16 v[28:29], v233 offset:6144
    ds_read_b64_tr_b16 v[30:31], v233 offset:6400
    ds_read_b64_tr_b16 v[32:33], v233 offset:8192
    ds_read_b64_tr_b16 v[34:35], v233 offset:8448
    ds_read_b64_tr_b16 v[36:37], v233 offset:10240
    ds_read_b64_tr_b16 v[38:39], v233 offset:10496
    ds_read_b64_tr_b16 v[40:41], v233 offset:12288
    ds_read_b64_tr_b16 v[42:43], v233 offset:12544
    ds_read_b64_tr_b16 v[44:45], v233 offset:14336
    ds_read_b64_tr_b16 v[46:47], v233 offset:14592
    ds_read_b64_tr_b16 v[48:49], v233 offset:16384
    ds_read_b64_tr_b16 v[50:51], v233 offset:16640
    ds_read_b64_tr_b16 v[52:53], v233 offset:18432
    ds_read_b64_tr_b16 v[54:55], v233 offset:18688
    ds_read_b64_tr_b16 v[56:57], v233 offset:20480
    ds_read_b64_tr_b16 v[58:59], v233 offset:20736
    ds_read_b64_tr_b16 v[60:61], v233 offset:22528
    ds_read_b64_tr_b16 v[62:63], v233 offset:22784
    ds_read_b64_tr_b16 v[64:65], v233 offset:24576
    ds_read_b64_tr_b16 v[66:67], v233 offset:24832
    ds_read_b64_tr_b16 v[68:69], v233 offset:26624
    ds_read_b64_tr_b16 v[70:71], v233 offset:26880
    ds_read_b64_tr_b16 v[72:73], v233 offset:28672
    ds_read_b64_tr_b16 v[74:75], v233 offset:28928
    ds_read_b64_tr_b16 v[76:77], v233 offset:30720
    ds_read_b64_tr_b16 v[78:79], v233 offset:30976
    ds_read_b64_tr_b16 v[80:81], v233 offset:32768
    ds_read_b64_tr_b16 v[82:83], v233 offset:33024
    ds_read_b64_tr_b16 v[84:85], v233 offset:34816
    ds_read_b64_tr_b16 v[86:87], v233 offset:35072
    ds_read_b64_tr_b16 v[88:89], v233 offset:36864
    ds_read_b64_tr_b16 v[90:91], v233 offset:37120
    ds_read_b64_tr_b16 v[92:93], v233 offset:38912
    ds_read_b64_tr_b16 v[94:95], v233 offset:39168
    ds_read_b64_tr_b16 v[96:97], v5 offset:0
    ds_read_b64_tr_b16 v[98:99], v5 offset:256
    ds_read_b64_tr_b16 v[100:101], v5 offset:2048
    ds_read_b64_tr_b16 v[102:103], v5 offset:2304
    ds_read_b64_tr_b16 v[104:105], v5 offset:4096
    ds_read_b64_tr_b16 v[106:107], v5 offset:4352
    ds_read_b64_tr_b16 v[108:109], v5 offset:6144
    ds_read_b64_tr_b16 v[110:111], v5 offset:6400
    ds_read_b64_tr_b16 v[112:113], v5 offset:8192
    ds_read_b64_tr_b16 v[114:115], v5 offset:8448
    ds_read_b64_tr_b16 v[116:117], v5 offset:10240
    ds_read_b64_tr_b16 v[118:119], v5 offset:10496
    ds_read_b64_tr_b16 v[120:121], v5 offset:12288
    ds_read_b64_tr_b16 v[122:123], v5 offset:12544
    ds_read_b64_tr_b16 v[124:125], v5 offset:14336
    ds_read_b64_tr_b16 v[126:127], v5 offset:14592
    ds_read_b64_tr_b16 v[128:129], v5 offset:16384
    ds_read_b64_tr_b16 v[130:131], v5 offset:16640
    ds_read_b64_tr_b16 v[132:133], v5 offset:18432
    ds_read_b64_tr_b16 v[134:135], v5 offset:18688
    ds_read_b64_tr_b16 v[136:137], v5 offset:20480
    ds_read_b64_tr_b16 v[138:139], v5 offset:20736
    ds_read_b64_tr_b16 v[140:141], v5 offset:22528
    ds_read_b64_tr_b16 v[142:143], v5 offset:22784
    ds_read_b64_tr_b16 v[144:145], v5 offset:24576
    ds_read_b64_tr_b16 v[146:147], v5 offset:24832
    ds_read_b64_tr_b16 v[148:149], v5 offset:26624
    ds_read_b64_tr_b16 v[150:151], v5 offset:26880
    ds_read_b64_tr_b16 v[152:153], v5 offset:28672
    ds_read_b64_tr_b16 v[154:155], v5 offset:28928
    ds_read_b64_tr_b16 v[156:157], v5 offset:30720
    ds_read_b64_tr_b16 v[158:159], v5 offset:30976
    ds_read_b64_tr_b16 v[160:161], v5 offset:32768
    ds_read_b64_tr_b16 v[162:163], v5 offset:33024
    ds_read_b64_tr_b16 v[164:165], v5 offset:34816
    ds_read_b64_tr_b16 v[166:167], v5 offset:35072
    ds_read_b64_tr_b16 v[168:169], v5 offset:36864
    ds_read_b64_tr_b16 v[170:171], v5 offset:37120
    ds_read_b64_tr_b16 v[172:173], v5 offset:38912
    ds_read_b64_tr_b16 v[174:175], v5 offset:39168
    s_waitcnt vmcnt(0) lgkmcnt(0)
    s_mov_b64 exec, 1
    ds_add_u32 v12, v13 offset:60
    s_mov_b64 exec, -1
    s_mov_b32 s3, 1048576
K_FGK:
    ds_read_b32 v2, v12 offset:48
    s_sleep 1
    s_sub_u32 s3, s3, 1
    s_waitcnt lgkmcnt(0)
    v_readfirstlane_b32 s33, v2
    s_nop 3
    s_cselect_b32 s33, 1, s33
    s_cmp_lt_u32 s33, 1
    s_cbranch_scc1 K_FGK
    ds_read_b128 v[188:191], v234 offset:0
    ds_read_b128 v[192:195], v234 offset:64
    ds_read_b128 v[196:199], v234 offset:128
    ds_read_b128 v[200:203], v234 offset:192
    ds_read_b128 v[204:207], v234 offset:256
    ds_read_b128 v[208:211], v234 offset:320
    ds_read_b128 v[212:215], v234 offset:384
    ds_read_b128 v[216:219], v234 offset:448
    s_waitcnt lgkmcnt(7)
    v_mfma_f32_16x16x32_bf16 v[220:223], v[16:19], v[188:191], 0
    v_mfma_f32_16x16x32_bf16 v[224:227], v[96:99], v[188:191], 0
    ds_read_b128 v[188:191], v234 offset:512
    s_waitcnt lgkmcnt(7)
    v_mfma_f32_16x16x32_bf16 v[220:223], v[20:23], v[192:195], v[220:223]
    v_mfma_f32_16x16x32_bf16 v[224:227], v[100:103], v[192:195], v[224:227]
    ds_read_b128 v[192:195], v234 offset:576
    s_waitcnt lgkmcnt(7)
    v_mfma_f32_16x16x32_bf16 v[220:223], v[24:27], v[196:199], v[220:223]
    v_mfma_f32_16x16x32_bf16 v[224:227], v[104:107], v[196:199], v[224:227]
    ds_read_b128 v[196:199], v234 offset:640
    s_waitcnt lgkmcnt(7)
    v_mfma_f32_16x16x32_bf16 v[220:223], v[28:31], v[200:203], v[220:223]
    v_mfma_f32_16x16x32_bf16 v[224:227], v[108:111], v[200:203], v[224:227]
    ds_read_b128 v[200:203], v234 offset:704
    s_waitcnt lgkmcnt(7)
    v_mfma_f32_16x16x32_bf16 v[220:223], v[32:35], v[204:207], v[220:223]
    v_mfma_f32_16x16x32_bf16 v[224:227], v[112:115], v[204:207], v[224:227]
    ds_read_b128 v[204:207], v234 offset:768
    s_waitcnt lgkmcnt(7)
    v_mfma_f32_16x16x32_bf16 v[220:223], v[36:39], v[208:211], v[220:223]
    v_mfma_f32_16x16x32_bf16 v[224:227], v[116:119], v[208:211], v[224:227]
    ds_read_b128 v[208:211], v234 offset:832
    s_waitcnt lgkmcnt(7)
    v_mfma_f32_16x16x32_bf16 v[220:223], v[40:43], v[212:215], v[220:223]
    v_mfma_f32_16x16x32_bf16 v[224:227], v[120:123], v[212:215], v[224:227]
    ds_read_b128 v[212:215], v234 offset:896
    s_waitcnt lgkmcnt(7)
    v_mfma_f32_16x16x32_bf16 v[220:223], v[44:47], v[216:219], v[220:223]
    v_mfma_f32_16x16x32_bf16 v[224:227], v[124:127], v[216:219], v[224:227]
    ds_read_b128 v[216:219], v234 offset:960
    s_waitcnt lgkmcnt(7)
    v_mfma_f32_16x16x32_bf16 v[220:223], v[48:51], v[188:191], v[220:223]
    v_mfma_f32_16x16x32_bf16 v[224:227], v[128:131], v[188:191], v[224:227]
    ds_read_b128 v[188:191], v234 offset:1024
    s_waitcnt lgkmcnt(7)
    v_mfma_f32_16x16x32_bf16 v[220:223], v[52:55], v[192:195], v[220:223]
    v_mfma_f32_16x16x32_bf16 v[224:227], v[132:135], v[192:195], v[224:227]
    ds_read_b128 v[192:195], v234 offset:1088
    s_waitcnt lgkmcnt(7)
    v_mfma_f32_16x16x32_bf16 v[220:223], v[56:59], v[196:199], v[220:223]
    v_mfma_f32_16x16x32_bf16 v[224:227], v[136:139], v[196:199], v[224:227]
    ds_read_b128 v[196:199], v234 offset:1152
    s_waitcnt lgkmcnt(7)
    v_mfma_f32_16x16x32_bf16 v[220:223], v[60:63], v[200:203], v[220:223]
    v_mfma_f32_16x16x32_bf16 v[224:227], v[140:143], v[200:203], v[224:227]
    ds_read_b128 v[200:203], v234 offset:1216
    s_waitcnt lgkmcnt(7)
    v_mfma_f32_16x16x32_bf16 v[220:223], v[64:67], v[204:207], v[220:223]
    v_mfma_f32_16x16x32_bf16 v[224:227], v[144:147], v[204:207], v[224:227]
    s_waitcnt lgkmcnt(6)
    v_mfma_f32_16x16x32_bf16 v[220:223], v[68:71], v[208:211], v[220:223]
    v_mfma_f32_16x16x32_bf16 v[224:227], v[148:151], v[208:211], v[224:227]
    s_waitcnt lgkmcnt(5)
    v_mfma_f32_16x16x32_bf16 v[220:223], v[72:75], v[212:215], v[220:223]
    v_mfma_f32_16x16x32_bf16 v[224:227], v[152:155], v[212:215], v[224:227]
    s_waitcnt lgkmcnt(4)
    v_mfma_f32_16x16x32_bf16 v[220:223], v[76:79], v[216:219], v[220:223]
    v_mfma_f32_16x16x32_bf16 v[224:227], v[156:159], v[216:219], v[224:227]
    s_waitcnt lgkmcnt(3)
    v_mfma_f32_16x16x32_bf16 v[220:223], v[80:83], v[188:191], v[220:223]
    v_mfma_f32_16x16x32_bf16 v[224:227], v[160:163], v[188:191], v[224:227]
    s_waitcnt lgkmcnt(2)
    v_mfma_f32_16x16x32_bf16 v[220:223], v[84:87], v[192:195], v[220:223]
    v_mfma_f32_16x16x32_bf16 v[224:227], v[164:167], v[192:195], v[224:227]
    s_waitcnt lgkmcnt(1)
    v_mfma_f32_16x16x32_bf16 v[220:223], v[88:91], v[196:199], v[220:223]
    v_mfma_f32_16x16x32_bf16 v[224:227], v[168:171], v[196:199], v[224:227]
    s_waitcnt lgkmcnt(0)
    v_mfma_f32_16x16x32_bf16 v[220:223], v[92:95], v[200:203], v[220:223]
    v_mfma_f32_16x16x32_bf16 v[224:227], v[172:175], v[200:203], v[224:227]
    v_mov_b64 v[204:205], 0
    v_mov_b64 v[206:207], 0
    v_mov_b64 v[208:209], 0
    v_mov_b64 v[210:211], 0
    v_mov_b64 v[212:213], 0
    v_mov_b64 v[214:215], 0
    v_mov_b64 v[216:217], 0
    v_mov_b64 v[218:219], 0
    v_mov_b32 v5, 0x100
    v_cvt_pk_bf16_f32 v221, v220, v221
    v_lshlrev_b32 v220, 16, v221
    v_and_b32 v221, 0xffff0000, v221
    v_cvt_pk_bf16_f32 v223, v222, v223
    v_lshlrev_b32 v222, 16, v223
    v_and_b32 v223, 0xffff0000, v223
    v_cvt_pk_bf16_f32 v225, v224, v225
    v_lshlrev_b32 v224, 16, v225
    v_and_b32 v225, 0xffff0000, v225
    v_cvt_pk_bf16_f32 v227, v226, v227
    v_lshlrev_b32 v226, 16, v227
    v_and_b32 v227, 0xffff0000, v227
    v_mul_f32 v188, 0xbfb8aa3b, v220
    v_mul_f32 v189, 0xbfb8aa3b, v221
    v_mul_f32 v190, 0xbfb8aa3b, v222
    v_mul_f32 v191, 0xbfb8aa3b, v223
    v_exp_f32 v188, v188
    v_exp_f32 v189, v189
    v_exp_f32 v190, v190
    v_exp_f32 v191, v191
    v_add_f32 v188, 1.0, v188
    v_add_f32 v189, 1.0, v189
    v_add_f32 v190, 1.0, v190
    v_add_f32 v191, 1.0, v191
    v_rcp_f32 v188, v188
    v_rcp_f32 v189, v189
    v_rcp_f32 v190, v190
    v_rcp_f32 v191, v191
    v_mul_f32 v220, v220, v188
    v_mul_f32 v221, v221, v189
    v_mul_f32 v222, v222, v190
    v_mul_f32 v223, v223, v191
    v_cvt_pk_bf16_f32 v221, v220, v221
    v_lshlrev_b32 v220, 16, v221
    v_and_b32 v221, 0xffff0000, v221
    v_cvt_pk_bf16_f32 v223, v222, v223
    v_lshlrev_b32 v222, 16, v223
    v_and_b32 v223, 0xffff0000, v223
    v_mul_f32 v220, v220, v224
    v_mul_f32 v221, v221, v225
    v_mul_f32 v222, v222, v226
    v_mul_f32 v223, v223, v227
    v_cvt_pk_bf16_f32 v228, v220, v221
    v_cvt_pk_bf16_f32 v229, v222, v223
    ds_write_b64 v235, v[228:229]
    s_mov_b64 exec, 1
    ds_add_u32 v12, v5 offset:52
    s_mov_b64 exec, -1
    s_mov_b32 s3, 1048576
K_FGP:
    ds_read_b32 v2, v12 offset:52
    s_sleep 0
    s_sub_u32 s3, s3, 1
    s_waitcnt lgkmcnt(0)
    v_readfirstlane_b32 s33, v2
    s_nop 3
    s_cselect_b32 s33, 515, s33
    s_cmp_lt_u32 s33, 515
    s_cbranch_scc1 K_FGP
    s_mov_b32 exec_lo, 0xf000f
    s_mov_b32 exec_hi, 0xf000f
    ds_read_b128 v[204:207], v236
    s_mov_b32 exec_lo, 0xf000f0
    s_mov_b32 exec_hi, 0xf000f0
    ds_read_b128 v[208:211], v236
    s_mov_b32 exec_lo, 0xf000f00
    s_mov_b32 exec_hi, 0xf000f00
    ds_read_b128 v[212:215], v236
    s_mov_b32 exec_lo, 0xf000f000
    s_mov_b32 exec_hi, 0xf000f000
    ds_read_b128 v[216:219], v236
    s_mov_b64 exec, -1
    ds_read_b64_tr_b16 v[16:17], v238 offset:0
    ds_read_b64_tr_b16 v[18:19], v238 offset:2048
    ds_read_b64_tr_b16 v[20:21], v239 offset:0
    ds_read_b64_tr_b16 v[22:23], v239 offset:2048
    ds_read_b64_tr_b16 v[24:25], v240 offset:0
    ds_read_b64_tr_b16 v[26:27], v240 offset:2048
    ds_read_b64_tr_b16 v[28:29], v241 offset:0
    ds_read_b64_tr_b16 v[30:31], v241 offset:2048
    ds_read_b64_tr_b16 v[32:33], v238 offset:4096
    ds_read_b64_tr_b16 v[34:35], v238 offset:6144
    s_waitcnt lgkmcnt(8)
    v_mfma_f32_16x16x32_bf16 v[96:99], v[204:207], v[16:19], 0
    ds_read_b64_tr_b16 v[36:37], v239 offset:4096
    ds_read_b64_tr_b16 v[38:39], v239 offset:6144
    s_waitcnt lgkmcnt(8)
    v_mfma_f32_16x16x32_bf16 v[96:99], v[208:211], v[20:23], v[96:99]
    ds_read_b64_tr_b16 v[40:41], v240 offset:4096
    ds_read_b64_tr_b16 v[42:43], v240 offset:6144
    s_waitcnt lgkmcnt(8)
    v_mfma_f32_16x16x32_bf16 v[96:99], v[212:215], v[24:27], v[96:99]
    ds_read_b64_tr_b16 v[44:45], v241 offset:4096
    ds_read_b64_tr_b16 v[46:47], v241 offset:6144
    s_waitcnt lgkmcnt(8)
    v_mfma_f32_16x16x32_bf16 v[96:99], v[216:219], v[28:31], v[96:99]
    ds_read_b64_tr_b16 v[48:49], v238 offset:8192
    ds_read_b64_tr_b16 v[50:51], v238 offset:10240
    s_waitcnt lgkmcnt(8)
    v_mfma_f32_16x16x32_bf16 v[100:103], v[204:207], v[32:35], 0
    ds_read_b64_tr_b16 v[52:53], v239 offset:8192
    ds_read_b64_tr_b16 v[54:55], v239 offset:10240
    s_waitcnt lgkmcnt(8)
    v_mfma_f32_16x16x32_bf16 v[100:103], v[208:211], v[36:39], v[100:103]
    ds_read_b64_tr_b16 v[56:57], v240 offset:8192
    ds_read_b64_tr_b16 v[58:59], v240 offset:10240
    s_waitcnt lgkmcnt(8)
    v_mfma_f32_16x16x32_bf16 v[100:103], v[212:215], v[40:43], v[100:103]
    ds_read_b64_tr_b16 v[60:61], v241 offset:8192
    ds_read_b64_tr_b16 v[62:63], v241 offset:10240
    s_waitcnt lgkmcnt(8)
    v_mfma_f32_16x16x32_bf16 v[100:103], v[216:219], v[44:47], v[100:103]
    ds_read_b64_tr_b16 v[64:65], v238 offset:12288
    ds_read_b64_tr_b16 v[66:67], v238 offset:14336
    buffer_store_dword v96, v237, s[64:67], s72 offen offset:0 sc1
    buffer_store_dword v97, v237, s[64:67], s72 offen offset:2560 sc1
    s_waitcnt lgkmcnt(8)
    v_mfma_f32_16x16x32_bf16 v[104:107], v[204:207], v[48:51], 0
    ds_read_b64_tr_b16 v[68:69], v239 offset:12288
    ds_read_b64_tr_b16 v[70:71], v239 offset:14336
    s_waitcnt lgkmcnt(8)
    v_mfma_f32_16x16x32_bf16 v[104:107], v[208:211], v[52:55], v[104:107]
    ds_read_b64_tr_b16 v[72:73], v240 offset:12288
    ds_read_b64_tr_b16 v[74:75], v240 offset:14336
    s_waitcnt lgkmcnt(8)
    v_mfma_f32_16x16x32_bf16 v[104:107], v[212:215], v[56:59], v[104:107]
    ds_read_b64_tr_b16 v[76:77], v241 offset:12288
    ds_read_b64_tr_b16 v[78:79], v241 offset:14336
    s_waitcnt lgkmcnt(8)
    v_mfma_f32_16x16x32_bf16 v[104:107], v[216:219], v[60:63], v[104:107]
    ds_read_b64_tr_b16 v[80:81], v238 offset:16384
    ds_read_b64_tr_b16 v[82:83], v238 offset:18432
    buffer_store_dword v100, v237, s[64:67], s72 offen offset:256 sc1
    buffer_store_dword v101, v237, s[64:67], s72 offen offset:2816 sc1
    s_waitcnt lgkmcnt(8)
    v_mfma_f32_16x16x32_bf16 v[108:111], v[204:207], v[64:67], 0
    ds_read_b64_tr_b16 v[84:85], v239 offset:16384
    ds_read_b64_tr_b16 v[86:87], v239 offset:18432
    s_waitcnt lgkmcnt(8)
    v_mfma_f32_16x16x32_bf16 v[108:111], v[208:211], v[68:71], v[108:111]
    ds_read_b64_tr_b16 v[88:89], v240 offset:16384
    ds_read_b64_tr_b16 v[90:91], v240 offset:18432
    s_waitcnt lgkmcnt(8)
    v_mfma_f32_16x16x32_bf16 v[108:111], v[212:215], v[72:75], v[108:111]
    ds_read_b64_tr_b16 v[92:93], v241 offset:16384
    ds_read_b64_tr_b16 v[94:95], v241 offset:18432
    s_waitcnt lgkmcnt(8)
    v_mfma_f32_16x16x32_bf16 v[108:111], v[216:219], v[76:79], v[108:111]
    buffer_store_dword v104, v237, s[64:67], s72 offen offset:512 sc1
    buffer_store_dword v105, v237, s[64:67], s72 offen offset:3072 sc1
    s_waitcnt lgkmcnt(6)
    v_mfma_f32_16x16x32_bf16 v[112:115], v[204:207], v[80:83], 0
    s_waitcnt lgkmcnt(4)
    v_mfma_f32_16x16x32_bf16 v[112:115], v[208:211], v[84:87], v[112:115]
    s_waitcnt lgkmcnt(2)
    v_mfma_f32_16x16x32_bf16 v[112:115], v[212:215], v[88:91], v[112:115]
    s_waitcnt lgkmcnt(0)
    v_mfma_f32_16x16x32_bf16 v[112:115], v[216:219], v[92:95], v[112:115]
    buffer_store_dword v108, v237, s[64:67], s72 offen offset:768 sc1
    buffer_store_dword v109, v237, s[64:67], s72 offen offset:3328 sc1
    s_nop 5
    buffer_store_dword v112, v237, s[64:67], s72 offen offset:1024 sc1
    buffer_store_dword v113, v237, s[64:67], s72 offen offset:3584 sc1
    s_mul_i32 s3, s73, 2560
    s_lshl2_add_u32 s3, s44, s3
    s_add_u32 s3, s3, 568320
    v_lshl_add_u32 v2, v1, 8, s3
    s_mov_b64 exec, 0x3ff
    s_waitcnt vmcnt(0)
    global_store_dword v2, v13, s[10:11] sc1
    s_mov_b64 exec, -1
    s_branch K_P2_HELP
K_CODE_END:
.section .rodata,"a"
.p2align 6
.amdhsa_kernel gated_mix__sliding_local_dilated__moe_arch_mod__prompt_kernel
  .amdhsa_next_free_vgpr 248
  .amdhsa_next_free_sgpr 79
  .amdhsa_accum_offset 248
  .amdhsa_group_segment_fixed_size 0
  .amdhsa_kernarg_size 96
  .amdhsa_user_sgpr_count 2
  .amdhsa_user_sgpr_kernarg_segment_ptr 1
  .amdhsa_system_sgpr_workgroup_id_x 1
.end_amdhsa_kernel
```

```asm
; @launch grid=(256,1,1) block=(512,1,1) lds=163840
.amdgcn_target "amdgcn-amd-amdhsa--gfx950"
.text
.p2align 12
.p2align 8
.globl gated_mix__sliding_local_dilated__moe_arch_mod__prompt_kernel
.type gated_mix__sliding_local_dilated__moe_arch_mod__prompt_kernel,@function
gated_mix__sliding_local_dilated__moe_arch_mod__prompt_kernel:
    s_cmp_ge_u32 s2, 256
    s_cbranch_scc1 K_EXIT
    s_load_dwordx2 s[12:13], s[0:1], 0
    s_load_dwordx2 s[16:17], s[0:1], 8
    v_readfirstlane_b32 s30, v0
    s_load_dwordx4 s[8:11], s[0:1], 80
    s_load_dwordx2 s[24:25], s[0:1], 16
    s_load_dwordx2 s[6:7], s[0:1], 72
    s_and_b32 s28, s2, 7
    v_and_b32 v1, 63, v0
    s_mov_b32 s14, 0x280000
    s_mov_b32 s15, 0x20000
    s_lshr_b32 s30, s30, 6
    s_cmp_lt_u32 s2, 64
    s_cbranch_scc1 K_SLOW
    s_cmp_lt_u32 s30, 4
    s_cbranch_scc1 K_FAST
K_SLOW:
    s_getpc_b64 s[38:39]
K_PC:
    s_bfe_u32 s3, s2, 0x30003
    s_mul_i32 s3, s3, ((K_CODE_END-gated_mix__sliding_local_dilated__moe_arch_mod__prompt_kernel+1023)/1024)
    s_sub_u32 s38, s38, K_PC-gated_mix__sliding_local_dilated__moe_arch_mod__prompt_kernel
    s_subb_u32 s39, s39, 0
    v_subrev_u32 v3, 256, v0
    v_add_u32 v2, s3, v3
    v_lshlrev_b32 v2, 7, v2
    v_min_u32 v2, K_CODE_END-gated_mix__sliding_local_dilated__moe_arch_mod__prompt_kernel-4, v2
    v_cmp_gt_u32 vcc, ((K_CODE_END-gated_mix__sliding_local_dilated__moe_arch_mod__prompt_kernel+1023)/1024), v3
    s_and_saveexec_b64 s[4:5], vcc
    s_cbranch_execz K_NOPF
    global_load_dword v6, v2, s[38:39]
K_NOPF:
    s_mov_b64 exec, -1
    v_mov_b64 v[2:3], 0
    v_mov_b64 v[4:5], 0
    v_mov_b32 v7, 158752
    ds_write_b128 v7, v[2:5] offset:0
    ds_write_b128 v7, v[2:5] offset:16
    ds_write_b128 v7, v[2:5] offset:32
    ds_write_b128 v7, v[2:5] offset:48
    s_mov_b32 s43, 1
    s_lshl_b32 s3, s30, 8
    s_add_u32 s3, s3, s2
    s_lshr_b32 s3, s3, 3
    s_cmp_lg_u32 s3, 160
    s_cbranch_scc1 K_COMMON
    s_mul_i32 s3, s2, 6144
    s_add_u32 s3, s3, 527360
    v_lshl_add_u32 v6, v1, 4, s3
    v_mov_b64 v[24:25], 0
    v_mov_b64 v[26:27], 0
    s_waitcnt lgkmcnt(0)
    global_store_dwordx4 v6, v[24:27], s[10:11] offset:-3072 sc1
    global_store_dwordx4 v6, v[24:27], s[10:11] offset:-2048 sc1
    global_store_dwordx4 v6, v[24:27], s[10:11] offset:-1024 sc1
    global_store_dwordx4 v6, v[24:27], s[10:11] offset:0 sc1
    global_store_dwordx4 v6, v[24:27], s[10:11] offset:1024 sc1
    global_store_dwordx4 v6, v[24:27], s[10:11] offset:2048 sc1
    s_lshl_b32 s3, s2, 2
    v_mov_b32 v2, s3
    v_mov_b32 v3, 1
    s_mov_b64 exec, 1
    s_waitcnt vmcnt(0)
    global_store_dword v2, v3, s[8:9] offset:192 sc1
    s_mov_b64 exec, -1
    s_branch K_COMMON
K_FAST:
    s_lshr_b32 s32, s2, 1
    s_and_b32 s32, s32, 28
    v_lshrrev_b32 v3, 4, v1
    s_lshr_b32 s3, s2, 6
    s_mov_b32 s59, 0x59608237
    s_cmp_eq_u32 s3, 2
    s_cselect_b32 s59, 0x26375904, s59
    v_and_b32 v4, 7, v1
    s_cmp_eq_u32 s3, 3
    s_cselect_b32 s59, 0x93042671, s59
    v_lshrrev_b32 v2, 3, v1
    s_lshr_b32 s59, s59, s32
    s_and_b32 s59, s59, 15
    v_xor_b32 v4, v4, v3
    s_lshl_b32 s33, s28, 2
    s_lshr_b32 s33, 0x76543210, s33
    s_and_b32 s33, s33, 15
    s_add_u32 s59, s59, s33
    s_cmp_ge_u32 s59, 10
    v_mul_u32_u24 v2, 1280, v2
    s_cselect_b32 s33, 10, 0
    s_sub_u32 s59, s59, s33
    s_lshr_b32 s53, s28, 1
    v_lshl_add_u32 v40, v4, 4, v2
    s_mul_i32 s53, s53, 655360
    s_lshl2_add_u32 s62, s3, s30
    s_cmp_eq_u32 s62, 15
    s_cselect_b32 s62, 0x800000, 0
    s_add_u32 s62, s62, 40960
    s_mul_i32 s3, s3, 225280
    v_xor_b32 v41, 64, v40
    s_add_u32 s53, s53, s3
    s_mul_i32 s54, s30, 61440
    s_add_u32 s53, s53, s54
    s_sub_u32 s53, s53, 245760
    s_mul_i32 s55, s30, 6144
    s_add_u32 s55, s55, 49152
    s_lshl_b32 s57, s59, 7
    s_add_u32 s57, s57, s53
    s_waitcnt lgkmcnt(0)
    s_add_u32 m0, s55, 0
    s_max_i32 s60, s57, 0
    buffer_load_dwordx4 v40, s[12:15], s60 offen lds
    s_add_u32 s60, s57, 10240
    s_add_u32 m0, s55, 1024
    s_max_i32 s60, s60, 0
    buffer_load_dwordx4 v41, s[12:15], s60 offen lds
    s_add_u32 m0, s55, 2048
    s_add_u32 s60, s57, 20480
    buffer_load_dwordx4 v40, s[12:15], s60 offen lds
    s_add_u32 m0, s55, 3072
    s_add_u32 s60, s57, 30720
    buffer_load_dwordx4 v41, s[12:15], s60 offen lds
    s_add_u32 m0, s55, 4096
    s_add_u32 s60, s57, s62
    buffer_load_dwordx4 v40, s[12:15], s60 offen lds
    s_add_u32 m0, s55, 5120
    s_add_u32 s60, s60, 10240
    buffer_load_dwordx4 v41, s[12:15], s60 offen lds
    v_lshlrev_b32 v2, 1, v3
    s_lshr_b32 s32, 0x64317520, s32
    v_sub_u32 v2, v1, v2
    s_and_b32 s32, s32, 7
    v_and_b32 v2, 15, v2
    s_and_b32 s3, s28, 1
    v_mul_u32_u24 v3, 3840, v3
    s_lshl3_add_u32 s32, s3, s32
    v_mul_u32_u24 v4, 13, v2
    s_mul_i32 s3, s32, 80
    v_lshrrev_b32 v4, 6, v4
    s_add_u32 s54, s54, s3
    v_mul_u32_u24 v4, 1200, v4
    s_lshl_b32 s56, s30, 12
    v_lshl_add_u32 v4, v2, 4, v4
    s_add_u32 s56, s56, 106496
    v_add_u32 v5, 1, v2
    s_mov_b32 s18, 0x258000
    v_and_b32 v5, 16, v5
    s_mov_b32 s19, 0x20000
    v_lshl_add_u32 v4, v5, 24, v4
    v_add_u32 v42, v3, v4
    s_mul_i32 s58, s59, 245760
    s_add_u32 s58, s58, s54
    s_add_u32 s59, s59, 1
    s_cmp_eq_u32 s59, 10
    s_cselect_b32 s59, 0, s59
    s_add_u32 m0, s56, 0
    s_add_u32 s60, s58, 0
    buffer_load_dwordx4 v42, s[16:19], s60 offen lds
    s_add_u32 m0, s56, 1024
    s_add_u32 s60, s58, 15360
    buffer_load_dwordx4 v42, s[16:19], s60 offen lds
    v_xor_b32 v2, 8, v2
    v_mul_u32_u24 v4, 13, v2
    v_lshrrev_b32 v4, 6, v4
    v_mul_u32_u24 v4, 1200, v4
    v_lshl_add_u32 v4, v2, 4, v4
    v_add_u32 v5, 1, v2
    v_and_b32 v5, 16, v5
    v_lshl_add_u32 v4, v5, 24, v4
    v_add_u32 v43, v3, v4
    s_add_u32 m0, s56, 2048
    s_add_u32 s60, s58, 30720
    buffer_load_dwordx4 v43, s[16:19], s60 offen lds
    s_add_u32 m0, s56, 3072
    s_add_u32 s60, s58, 46080
    buffer_load_dwordx4 v43, s[16:19], s60 offen lds
    s_mov_b32 s52, s30
    s_mov_b32 s43, 0
K_COMMON:
    v_mov_b32 v7, 0
    s_lshr_b32 s29, s2, 3
    s_xor_b32 s30, s30, 4
    s_mov_b32 s26, 0xc8000
    s_mov_b32 s27, 0x20000
    s_lshr_b32 s34, s29, 3
    s_lshl_b32 s34, s34, 2
    s_and_b32 s3, s29, 3
    s_add_u32 s34, s34, s3
    s_add_u32 s34, s34, 4
    s_bitcmp1_b32 s29, 2
    s_cselect_b32 s34, -1, s34
    s_cmp_lt_u32 s29, 8
    s_cselect_b32 s34, s29, s34
    s_lshl_b32 s40, s28, 1
    s_cmp_ge_u32 s34, 10
    s_addc_u32 s40, s40, 0
    s_sub_u32 s41, s34, 10
    s_cmp_ge_u32 s34, 10
    s_cselect_b32 s41, s41, s34
    s_mul_i32 s42, s28, 20
    s_add_u32 s42, s42, s34
    s_and_b32 s42, s42, 255
    s_lshl_b32 s42, s42, 8
    s_add_u32 s42, s42, 524288
    s_cmp_lt_u32 s29, 8
    s_cbranch_scc1 K_AUX
    s_lshr_b32 s31, s29, 3
    s_sub_u32 s31, s31, 1
    s_and_b32 s35, s29, 3
    s_and_b32 s3, s29, 4
    s_lshl_b32 s3, s3, 1
    s_add_u32 s35, s35, s3
    s_and_b32 s3, s28, 1
    s_lshl_b32 s3, s3, 2
    s_add_u32 s35, s35, s3
    v_and_b32 v9, 15, v1
    v_lshrrev_b32 v10, 4, v1
    v_bfe_u32 v11, v1, 2, 2
    v_and_b32 v12, 3, v1
    s_waitcnt lgkmcnt(0)
    s_add_u32 s20, s10, 0x100000
    s_addc_u32 s21, s11, 0
    s_mov_b32 s22, 0x280000
    s_mov_b32 s23, 0x20000
    s_and_b32 s3, s30, 3
    s_mul_i32 s3, s3, 3
    s_lshr_b32 s33, s30, 2
    s_lshl1_add_u32 s3, s33, s3
    s_mul_i32 s44, s31, 11
    s_add_u32 s44, s44, s3
    s_cmp_eq_u32 s44, 31
    s_cselect_b32 s51, 4, s30
    s_lshr_b32 s33, s28, 1
    s_lshl_b32 s33, s33, 5
    s_add_u32 s44, s44, s33
    s_lshl_b32 s3, s3, 10
    s_add_u32 s3, s3, 122880
    v_lshl_add_u32 v13, v1, 4, s3
    v_lshl_add_u32 v2, v9, 4, s3
    v_add_u32 v2, 520, v2
    v_add_u32 v3, 512, v13
    v_cmp_eq_u32 vcc, 0, v10
    s_nop 1
    v_cndmask_b32 v18, v2, v3, vcc
    v_cmp_eq_u32 vcc, 1, v10
    s_nop 1
    v_cndmask_b32 v19, v2, v3, vcc
    v_lshl_add_u32 v5, v10, 2, v11
    v_lshl_add_u32 v5, v5, 4, s3
    v_add_u32 v2, 520, v5
    v_add_u32 v3, 8, v5
    v_add_u32 v4, 264, v5
    s_cmp_lt_u32 s30, 4
    s_cselect_b32 s33, 0, 3
    s_sub_u32 s33, s30, s33
    s_mul_i32 s33, s33, 5120
    s_add_u32 s33, s33, 79872
    v_lshl_add_u32 v14, v1, 3, s33
    v_cmp_eq_u32 vcc, 0, v12
    s_nop 1
    v_cndmask_b32 v20, v2, v3, vcc
    v_cmp_eq_u32 vcc, 1, v12
    s_nop 1
    v_cndmask_b32 v21, v2, v4, vcc
    v_cmp_eq_u32 vcc, 2, v12
    s_nop 1
    v_cndmask_b32 v22, v2, v3, vcc
    v_cmp_eq_u32 vcc, 3, v12
    s_nop 1
    v_cndmask_b32 v23, v2, v4, vcc
    s_lshl_b32 s3, s35, 10
    v_lshl_add_u32 v15, v1, 4, s3
    s_lshl_b32 s3, s35, 8
    s_add_u32 s3, s3, 16384
    v_lshl_add_u32 v16, v9, 4, s3
    v_and_b32 v2, 1, v10
    v_lshl_add_u32 v16, v2, 23, v16
    s_cmp_lt_u32 s51, 4
    s_cselect_b32 s3, 0, 0x800000
    s_add_u32 s3, s3, 20480
    v_lshrrev_b32 v2, 1, v10
    v_mad_u32_u24 v16, v2, s3, v16
    s_mul_i32 s50, s44, 20480
    s_add_u32 s51, s50, s3
    v_mov_b32 v17, 0xf149f2ca
    v_lshlrev_b32 v2, 2, v10
    v_sub_u32 v2, v9, v2
    s_cmp_eq_u32 s44, 0
    s_cselect_b32 s3, 0xf149f2ca, 0
    v_subrev_u32 v3, 0, v2
    v_and_b32 v4, 0x80000001, v3
    v_cmp_eq_u32 vcc, 0, v4
    s_nop 1
    v_cndmask_b32 v28, v17, 0, vcc
    v_cmp_eq_u32 vcc, 0x80000000, v4
    s_nop 1
    v_cndmask_b32 v24, v17, 0, vcc
    v_add_f32 v32, s3, v24
    v_subrev_u32 v3, 1, v2
    v_and_b32 v4, 0x80000001, v3
    v_cmp_eq_u32 vcc, 0, v4
    s_nop 1
    v_cndmask_b32 v29, v17, 0, vcc
    v_cmp_eq_u32 vcc, 0x80000000, v4
    s_nop 1
    v_cndmask_b32 v25, v17, 0, vcc
    v_add_f32 v33, s3, v25
    v_subrev_u32 v3, 2, v2
    v_and_b32 v4, 0x80000001, v3
    v_cmp_eq_u32 vcc, 0, v4
    s_nop 1
    v_cndmask_b32 v30, v17, 0, vcc
    v_cmp_eq_u32 vcc, 0x80000000, v4
    s_nop 1
    v_cndmask_b32 v26, v17, 0, vcc
    v_add_f32 v34, s3, v26
    v_subrev_u32 v3, 3, v2
    v_and_b32 v4, 0x80000001, v3
    v_cmp_eq_u32 vcc, 0, v4
    s_nop 1
    v_cndmask_b32 v31, v17, 0, vcc
    v_cmp_eq_u32 vcc, 0x80000000, v4
    s_nop 1
    v_cndmask_b32 v27, v17, 0, vcc
    v_add_f32 v35, s3, v27
    v_mov_b32 v3, 0x0c0c0c0c
    v_mov_b32 v4, 0xc0c0100
    v_cmp_eq_u32 vcc, 0, v24
    v_mov_b32 v5, 0x1000c0c
    s_nop 0
    v_cndmask_b32 v3, v3, v4, vcc
    v_cmp_eq_u32 vcc, 0, v25
    s_nop 1
    v_cndmask_b32 v36, v3, v5, vcc
    v_mov_b32 v3, 0x0c0c0c0c
    v_mov_b32 v4, 0xc0c0302
    v_cmp_eq_u32 vcc, 0, v26
    v_mov_b32 v5, 0x3020c0c
    s_nop 0
    v_cndmask_b32 v3, v3, v4, vcc
    v_cmp_eq_u32 vcc, 0, v27
    s_nop 1
    v_cndmask_b32 v37, v3, v5, vcc
    v_mov_b32 v3, 0x0c0c0c0c
    v_mov_b32 v4, 0xc0c0100
    v_cmp_eq_u32 vcc, 0, v28
    v_mov_b32 v5, 0x1000c0c
    s_nop 0
    v_cndmask_b32 v3, v3, v4, vcc
    v_cmp_eq_u32 vcc, 0, v29
    s_nop 1
    v_cndmask_b32 v38, v3, v5, vcc
    v_mov_b32 v3, 0x0c0c0c0c
    v_mov_b32 v4, 0xc0c0302
    v_cmp_eq_u32 vcc, 0, v30
    v_mov_b32 v5, 0x3020c0c
    s_nop 0
    v_cndmask_b32 v3, v3, v4, vcc
    v_cmp_eq_u32 vcc, 0, v31
    s_nop 1
    v_cndmask_b32 v39, v3, v5, vcc
    s_mov_b32 s46, 0x3ea52b5c
    s_mov_b32 s47, s46
    s_mov_b32 s48, 0x3e64f92e
    s_mov_b32 s49, s48
    s_mov_b32 s36, 0xfffff
    s_cmp_lg_u32 s31, 0
    s_cselect_b32 s33, 64, 0
    v_mov_b32 v2, s33
    v_cmp_gt_u32 vcc, 10, v1
    s_lshr_b32 s3, s28, 1
    s_lshl2_add_u32 s3, s3, s31
    v_cndmask_b32 v2, 0, v2, vcc
    v_lshl_add_u32 v2, v1, 8, v2
    s_mul_i32 s3, s3, 2560
    s_lshl2_add_u32 s3, s35, s3
    s_add_u32 s3, s3, 524288
    v_add_u32 v8, s3, v2
    s_cmp_eq_u32 s43, 1
    s_cbranch_scc1 K_CONS
    v_lshrrev_b32 v2, 3, v1
    v_mul_u32_u24 v2, 1280, v2
    v_lshrrev_b32 v3, 4, v1
    v_lshlrev_b32 v3, 1, v3
    v_and_b32 v4, 7, v1
    v_xor_b32 v3, v3, v4
    v_lshl_add_u32 v2, v3, 4, v2
    s_lshl_b32 s33, s41, 7
    v_add_u32 v17, s33, v2
    s_mov_b32 s61, 9
    s_branch K_LOOPE
K_LOOP:
    s_waitcnt vmcnt(5)
    s_barrier
    s_add_u32 m0, s56, 2048
    s_add_u32 s60, s58, 30720
    buffer_load_dwordx4 v43, s[16:19], s60 offen lds
    s_add_u32 m0, s55, 3072
    s_add_u32 s60, s57, 30720
    buffer_load_dwordx4 v41, s[12:15], s60 offen lds
    s_add_u32 m0, s56, 3072
    s_add_u32 s60, s58, 46080
    buffer_load_dwordx4 v43, s[16:19], s60 offen lds
    s_add_u32 m0, s55, 4096
    s_add_u32 s60, s57, s62
    buffer_load_dwordx4 v40, s[12:15], s60 offen lds
    s_add_u32 m0, s55, 5120
    s_add_u32 s60, s60, 10240
    buffer_load_dwordx4 v41, s[12:15], s60 offen lds
    s_sub_u32 s61, s61, 1
    s_cmp_eq_u32 s61, 0
    s_cbranch_scc1 K_LOOPX
K_LOOPE:
    s_cmp_ge_u32 s55, 49152
    s_cselect_b32 s60, -2, 1
    s_mul_i32 s3, s60, 24576
    s_add_u32 s55, s55, s3
    s_lshl_b32 s60, s60, 14
    s_add_u32 s56, s56, s60
    s_lshl_b32 s57, s59, 7
    s_add_u32 s57, s57, s53
    s_mul_i32 s58, s59, 245760
    s_add_u32 s58, s58, s54
    s_add_u32 s59, s59, 1
    s_cmp_eq_u32 s59, 10
    s_cselect_b32 s59, 0, s59
    s_add_u32 m0, s56, 0
    s_add_u32 s60, s58, 0
    buffer_load_dwordx4 v42, s[16:19], s60 offen lds
    s_add_u32 m0, s55, 0
    s_max_i32 s60, s57, 0
    buffer_load_dwordx4 v40, s[12:15], s60 offen lds
    s_add_u32 m0, s56, 1024
    s_add_u32 s60, s58, 15360
    buffer_load_dwordx4 v42, s[16:19], s60 offen lds
    s_add_u32 s60, s57, 10240
    s_add_u32 m0, s55, 1024
    s_max_i32 s60, s60, 0
    buffer_load_dwordx4 v41, s[12:15], s60 offen lds
    s_add_u32 m0, s55, 2048
    s_add_u32 s60, s57, 20480
    buffer_load_dwordx4 v40, s[12:15], s60 offen lds
    s_branch K_LOOP
K_LOOPX:
    v_and_b32 v2, 7, v1
    v_lshlrev_b32 v2, 2, v2
    s_waitcnt vmcnt(0)
    s_barrier
    s_cmp_lt_u32 s30, 6
    s_cbranch_scc1 K_NOSMP
    global_load_dword v7, v2, s[8:9] offset:192 sc1
K_NOSMP:
    s_cmp_eq_u32 s34, -1
    s_cbranch_scc1 K_JOIN_S
    s_cmp_lt_u32 s52, 2
    s_cbranch_scc1 K_WOE
    s_cmp_lg_u32 s30, 7
    s_cbranch_scc1 K_JOIN_S
    s_mov_b32 s52, 2
    s_branch K_W7A
K_WOE:
    s_lshl_b32 s57, s52, 2
    s_lshr_b32 s57, 0x7520, s57
    s_and_b32 s57, s57, 7
    s_mul_i32 s57, s57, 51200
    s_mul_i32 s58, s52, 5120
    s_add_u32 s3, s57, 0
    s_add_u32 m0, s58, 0
    s_nop 0
    buffer_load_dwordx4 v17, s[24:27], s3 offen lds
    s_add_u32 s3, s57, 10240
    s_add_u32 m0, s58, 1024
    s_nop 0
    buffer_load_dwordx4 v17, s[24:27], s3 offen lds
    s_add_u32 s3, s57, 20480
    s_add_u32 m0, s58, 2048
    s_nop 0
    buffer_load_dwordx4 v17, s[24:27], s3 offen lds
    s_add_u32 s3, s57, 30720
    s_add_u32 m0, s58, 3072
    s_nop 0
    buffer_load_dwordx4 v17, s[24:27], s3 offen lds
    s_add_u32 s3, s57, 40960
    s_add_u32 m0, s58, 4096
    s_nop 0
    buffer_load_dwordx4 v17, s[24:27], s3 offen lds
    s_add_u32 s3, s57, 409600
    s_add_u32 m0, s58, 20480
    s_nop 0
    buffer_load_dwordx4 v17, s[24:27], s3 offen lds
    s_add_u32 s3, s57, 419840
    s_add_u32 m0, s58, 21504
    s_nop 0
    buffer_load_dwordx4 v17, s[24:27], s3 offen lds
    s_add_u32 s3, s57, 430080
    s_add_u32 m0, s58, 22528
    s_nop 0
    buffer_load_dwordx4 v17, s[24:27], s3 offen lds
    s_add_u32 s3, s57, 440320
    s_add_u32 m0, s58, 23552
    s_nop 0
    buffer_load_dwordx4 v17, s[24:27], s3 offen lds
    s_add_u32 s3, s57, 450560
    s_add_u32 m0, s58, 24576
    s_nop 0
    buffer_load_dwordx4 v17, s[24:27], s3 offen lds
    s_cmp_lg_u32 s30, 7
    s_cbranch_scc1 K_JOIN_S
    s_add_u32 s52, s52, 1
    s_cmp_lt_u32 s52, 4
    s_cbranch_scc1 K_WOE
    s_mov_b32 s52, 0
K_XD:
    s_lshl_b32 s57, s40, 3
    s_lshl1_add_u32 s57, s52, s57
    s_mul_i32 s57, s57, 20480
    s_lshl_b32 s33, s41, 7
    s_add_u32 s57, s57, s33
    s_lshl_b32 s33, s52, 12
    s_add_u32 m0, s33, 140288
    s_add_u32 s3, s57, 0
    buffer_load_dwordx4 v40, s[12:15], s3 offen lds
    s_add_u32 m0, s33, 141312
    s_add_u32 s3, s57, 10240
    buffer_load_dwordx4 v41, s[12:15], s3 offen lds
    s_add_u32 m0, s33, 142336
    s_add_u32 s3, s57, 20480
    buffer_load_dwordx4 v40, s[12:15], s3 offen lds
    s_add_u32 m0, s33, 143360
    s_add_u32 s3, s57, 30720
    buffer_load_dwordx4 v41, s[12:15], s3 offen lds
    s_add_u32 s52, s52, 1
    s_cmp_lt_u32 s52, 4
    s_cbranch_scc1 K_XD
    s_branch K_W7
.p2align 12
K_CONS:
    v_lshrrev_b32 v2, 1, v9
    v_xor_b32 v2, v2, v10
    v_lshlrev_b32 v2, 4, v2
    v_lshl_add_u32 v2, v9, 7, v2
    s_mul_i32 s3, s30, 6144
    v_add_u32 v40, s3, v2
    v_xor_b32 v41, 64, v40
    v_and_b32 v2, 1, v10
    v_lshl_or_b32 v2, v2, 2, v11
    v_lshlrev_b32 v2, 5, v2
    v_lshl_add_u32 v3, v10, 3, v11
    v_lshlrev_b32 v3, 8, v3
    v_add_u32 v3, 73728, v3
    v_lshlrev_b32 v5, 3, v12
    s_movk_i32 s33, 0xff
    s_mov_b32 s3, 0x48209870
    v_lshrrev_b32 v4, v5, s3
    v_add_u32 v4, v4, v2
    v_and_or_b32 v42, v4, s33, v3
    s_mov_b32 s3, 0xf8f0e8c0
    v_lshrrev_b32 v4, v5, s3
    v_add_u32 v4, v4, v2
    v_and_or_b32 v43, v4, s33, v3
    v_add_u32 v2, v2, v5
    v_add_u32 v4, 80, v2
    v_and_or_b32 v44, v4, s33, v3
    v_add_u32 v4, 120, v2
    v_and_or_b32 v45, v4, s33, v3
    v_add_u32 v4, 0, v2
    v_and_or_b32 v46, v4, s33, v3
    v_add_u32 v4, 40, v2
    v_and_or_b32 v47, v4, s33, v3
    v_add_u32 v4, 160, v2
    v_and_or_b32 v48, v4, s33, v3
    v_add_u32 v4, 200, v2
    v_and_or_b32 v49, v4, s33, v3
    s_lshl_b32 s3, s30, 2
    s_add_u32 s3, s3, 158800
    v_mov_b32 v50, s3
    v_mov_b32 v4, 1
    v_mov_b32 v5, 2
    v_mov_b64 v[52:53], 0
    v_mov_b64 v[54:55], 0
    v_mov_b64 v[56:57], 0
    v_mov_b64 v[58:59], 0
    v_mov_b64 v[60:61], 0
    v_mov_b64 v[62:63], 0
    v_mov_b64 v[64:65], 0
    v_mov_b64 v[66:67], 0
    v_mov_b64 v[68:69], 0
    v_mov_b64 v[70:71], 0
    v_mov_b64 v[72:73], 0
    v_mov_b64 v[74:75], 0
    v_mov_b64 v[76:77], 0
    v_mov_b64 v[78:79], 0
    v_mov_b64 v[80:81], 0
    v_mov_b64 v[82:83], 0
    v_mov_b64 v[84:85], 0
    v_mov_b64 v[86:87], 0
    v_mov_b64 v[88:89], 0
    v_mov_b64 v[90:91], 0
    v_mov_b64 v[92:93], 0
    v_mov_b64 v[94:95], 0
    v_mov_b64 v[96:97], 0
    v_mov_b64 v[98:99], 0
    v_mov_b64 v[100:101], 0
    v_mov_b64 v[102:103], 0
    v_mov_b64 v[104:105], 0
    v_mov_b64 v[106:107], 0
    v_mov_b64 v[108:109], 0
    v_mov_b64 v[110:111], 0
    v_mov_b64 v[112:113], 0
    v_mov_b64 v[114:115], 0
    v_mov_b64 v[116:117], 0
    v_mov_b64 v[118:119], 0
    v_mov_b64 v[120:121], 0
    v_mov_b64 v[122:123], 0
    v_mov_b64 v[124:125], 0
    v_mov_b64 v[126:127], 0
    v_mov_b64 v[128:129], 0
    v_mov_b64 v[130:131], 0
    v_mov_b64 v[132:133], 0
    v_mov_b64 v[134:135], 0
    v_mov_b64 v[136:137], 0
    v_mov_b64 v[138:139], 0
    v_mov_b64 v[140:141], 0
    v_mov_b64 v[142:143], 0
    v_mov_b64 v[144:145], 0
    v_mov_b64 v[146:147], 0
    s_mov_b32 s52, 3
    s_cmp_lg_u32 s30, 0
    s_cbranch_scc1 K_WARMM0
    s_call_b64 s[38:39], WP_attd
    s_call_b64 s[38:39], WP_p2g
    s_branch K_WARMMX
K_WARMM0:
    s_cmp_lg_u32 s30, 1
    s_cbranch_scc1 K_WARMM1
    s_call_b64 s[38:39], WP_atts
    s_call_b64 s[38:39], WP_early
    s_branch K_WARMMX
K_WARMM1:
    s_cmp_lg_u32 s30, 2
    s_cbranch_scc1 K_WARMM2
    s_call_b64 s[38:39], WP_help
    s_call_b64 s[38:39], WP_flags
    s_branch K_WARMMX
K_WARMM2:
    s_call_b64 s[38:39], WP_spin
K_WARMMX:
    s_barrier
    ds_read_b128 v[148:151], v40 offset:49152
    ds_read_b64_tr_b16 v[172:173], v42 offset:32768
    ds_read_b64_tr_b16 v[174:175], v42 offset:33792
    ds_read_b128 v[152:155], v40 offset:51200
    ds_read_b128 v[156:159], v40 offset:53248
    ds_read_b64_tr_b16 v[176:177], v43 offset:32768
    ds_read_b64_tr_b16 v[178:179], v43 offset:33792
    ds_read_b64_tr_b16 v[180:181], v44 offset:32768
    ds_read_b64_tr_b16 v[182:183], v44 offset:33792
    ds_read_b64_tr_b16 v[184:185], v45 offset:32768
    ds_read_b64_tr_b16 v[186:187], v45 offset:33792
    ds_read_b64_tr_b16 v[188:189], v46 offset:32768
    ds_read_b64_tr_b16 v[190:191], v46 offset:33792
    ds_read_b64_tr_b16 v[192:193], v47 offset:32768
    ds_read_b64_tr_b16 v[194:195], v47 offset:33792
    ds_read_b64_tr_b16 v[196:197], v48 offset:32768
    ds_read_b64_tr_b16 v[198:199], v48 offset:33792
    ds_read_b64_tr_b16 v[200:201], v49 offset:32768
    ds_read_b64_tr_b16 v[202:203], v49 offset:33792
K_CLOOP:
    s_waitcnt lgkmcnt(0)
    v_mfma_f32_16x16x32_bf16 v[52:55], v[172:175], v[148:151], v[52:55]
    ds_read_b128 v[160:163], v41 offset:49152
    v_mfma_f32_16x16x32_bf16 v[56:59], v[176:179], v[148:151], v[56:59]
    ds_read_b64_tr_b16 v[204:205], v42 offset:40960
    v_mfma_f32_16x16x32_bf16 v[60:63], v[180:183], v[148:151], v[60:63]
    ds_read_b64_tr_b16 v[206:207], v42 offset:41984
    v_mfma_f32_16x16x32_bf16 v[64:67], v[184:187], v[148:151], v[64:67]
    ds_read_b128 v[164:167], v41 offset:51200
    v_mfma_f32_16x16x32_bf16 v[68:71], v[188:191], v[148:151], v[68:71]
    ds_read_b128 v[168:171], v41 offset:53248
    v_mfma_f32_16x16x32_bf16 v[72:75], v[192:195], v[148:151], v[72:75]
    ds_read_b64_tr_b16 v[208:209], v43 offset:40960
    v_mfma_f32_16x16x32_bf16 v[76:79], v[148:151], v[196:199], v[76:79]
    ds_read_b64_tr_b16 v[210:211], v43 offset:41984
    v_mfma_f32_16x16x32_bf16 v[80:83], v[148:151], v[200:203], v[80:83]
    ds_read_b64_tr_b16 v[212:213], v44 offset:40960
    v_mfma_f32_16x16x32_bf16 v[112:115], v[152:155], v[200:203], v[112:115]
    ds_read_b64_tr_b16 v[214:215], v44 offset:41984
    v_mfma_f32_16x16x32_bf16 v[108:111], v[152:155], v[196:199], v[108:111]
    ds_read_b64_tr_b16 v[216:217], v45 offset:40960
    v_mfma_f32_16x16x32_bf16 v[104:107], v[192:195], v[152:155], v[104:107]
    ds_read_b64_tr_b16 v[218:219], v45 offset:41984
    v_mfma_f32_16x16x32_bf16 v[100:103], v[188:191], v[152:155], v[100:103]
    ds_read_b64_tr_b16 v[220:221], v46 offset:40960
    v_mfma_f32_16x16x32_bf16 v[96:99], v[184:187], v[152:155], v[96:99]
    ds_read_b64_tr_b16 v[222:223], v46 offset:41984
    v_mfma_f32_16x16x32_bf16 v[92:95], v[180:183], v[152:155], v[92:95]
    ds_read_b64_tr_b16 v[224:225], v47 offset:40960
    v_mfma_f32_16x16x32_bf16 v[88:91], v[176:179], v[152:155], v[88:91]
    ds_read_b64_tr_b16 v[226:227], v47 offset:41984
    v_mfma_f32_16x16x32_bf16 v[84:87], v[172:175], v[152:155], v[84:87]
    ds_read_b64_tr_b16 v[228:229], v48 offset:40960
    v_mfma_f32_16x16x32_bf16 v[116:119], v[172:175], v[156:159], v[116:119]
    ds_read_b64_tr_b16 v[230:231], v48 offset:41984
    v_mfma_f32_16x16x32_bf16 v[120:123], v[176:179], v[156:159], v[120:123]
    ds_read_b64_tr_b16 v[232:233], v49 offset:40960
    v_mfma_f32_16x16x32_bf16 v[124:127], v[180:183], v[156:159], v[124:127]
    ds_read_b64_tr_b16 v[234:235], v49 offset:41984
    v_mfma_f32_16x16x32_bf16 v[128:131], v[184:187], v[156:159], v[128:131]
    v_mfma_f32_16x16x32_bf16 v[132:135], v[188:191], v[156:159], v[132:135]
    v_mfma_f32_16x16x32_bf16 v[136:139], v[192:195], v[156:159], v[136:139]
    v_mfma_f32_16x16x32_bf16 v[140:143], v[156:159], v[196:199], v[140:143]
    v_mfma_f32_16x16x32_bf16 v[144:147], v[156:159], v[200:203], v[144:147]
    s_waitcnt lgkmcnt(0)
    s_barrier
    v_mfma_f32_16x16x32_bf16 v[52:55], v[204:207], v[160:163], v[52:55]
    ds_read_b128 v[148:151], v40 offset:0
    v_mfma_f32_16x16x32_bf16 v[56:59], v[208:211], v[160:163], v[56:59]
    ds_read_b64_tr_b16 v[172:173], v42 offset:0
    v_mfma_f32_16x16x32_bf16 v[60:63], v[212:215], v[160:163], v[60:63]
    ds_read_b64_tr_b16 v[174:175], v42 offset:1024
    v_mfma_f32_16x16x32_bf16 v[64:67], v[216:219], v[160:163], v[64:67]
    ds_read_b128 v[152:155], v40 offset:2048
    v_mfma_f32_16x16x32_bf16 v[68:71], v[220:223], v[160:163], v[68:71]
    ds_read_b128 v[156:159], v40 offset:4096
    v_mfma_f32_16x16x32_bf16 v[72:75], v[224:227], v[160:163], v[72:75]
    ds_read_b64_tr_b16 v[176:177], v43 offset:0
    v_mfma_f32_16x16x32_bf16 v[76:79], v[160:163], v[228:231], v[76:79]
    ds_read_b64_tr_b16 v[178:179], v43 offset:1024
    v_mfma_f32_16x16x32_bf16 v[80:83], v[160:163], v[232:235], v[80:83]
    ds_read_b64_tr_b16 v[180:181], v44 offset:0
    v_mfma_f32_16x16x32_bf16 v[112:115], v[164:167], v[232:235], v[112:115]
    ds_read_b64_tr_b16 v[182:183], v44 offset:1024
    v_mfma_f32_16x16x32_bf16 v[108:111], v[164:167], v[228:231], v[108:111]
    ds_read_b64_tr_b16 v[184:185], v45 offset:0
    v_mfma_f32_16x16x32_bf16 v[104:107], v[224:227], v[164:167], v[104:107]
    ds_read_b64_tr_b16 v[186:187], v45 offset:1024
    v_mfma_f32_16x16x32_bf16 v[100:103], v[220:223], v[164:167], v[100:103]
    ds_read_b64_tr_b16 v[188:189], v46 offset:0
    v_mfma_f32_16x16x32_bf16 v[96:99], v[216:219], v[164:167], v[96:99]
    ds_read_b64_tr_b16 v[190:191], v46 offset:1024
    v_mfma_f32_16x16x32_bf16 v[92:95], v[212:215], v[164:167], v[92:95]
    ds_read_b64_tr_b16 v[192:193], v47 offset:0
    v_mfma_f32_16x16x32_bf16 v[88:91], v[208:211], v[164:167], v[88:91]
    ds_read_b64_tr_b16 v[194:195], v47 offset:1024
    v_mfma_f32_16x16x32_bf16 v[84:87], v[204:207], v[164:167], v[84:87]
    ds_read_b64_tr_b16 v[196:197], v48 offset:0
    v_mfma_f32_16x16x32_bf16 v[116:119], v[204:207], v[168:171], v[116:119]
    ds_read_b64_tr_b16 v[198:199], v48 offset:1024
    v_mfma_f32_16x16x32_bf16 v[120:123], v[208:211], v[168:171], v[120:123]
    ds_read_b64_tr_b16 v[200:201], v49 offset:0
    v_mfma_f32_16x16x32_bf16 v[124:127], v[212:215], v[168:171], v[124:127]
    ds_read_b64_tr_b16 v[202:203], v49 offset:1024
    v_mfma_f32_16x16x32_bf16 v[128:131], v[216:219], v[168:171], v[128:131]
    v_mfma_f32_16x16x32_bf16 v[132:135], v[220:223], v[168:171], v[132:135]
    v_mfma_f32_16x16x32_bf16 v[136:139], v[224:227], v[168:171], v[136:139]
    v_mfma_f32_16x16x32_bf16 v[140:143], v[168:171], v[228:231], v[140:143]
    v_mfma_f32_16x16x32_bf16 v[144:147], v[168:171], v[232:235], v[144:147]
    s_waitcnt lgkmcnt(0)
    v_mfma_f32_16x16x32_bf16 v[52:55], v[172:175], v[148:151], v[52:55]
    ds_read_b128 v[160:163], v41 offset:0
    v_mfma_f32_16x16x32_bf16 v[56:59], v[176:179], v[148:151], v[56:59]
    ds_read_b64_tr_b16 v[204:205], v42 offset:8192
    v_mfma_f32_16x16x32_bf16 v[60:63], v[180:183], v[148:151], v[60:63]
    ds_read_b64_tr_b16 v[206:207], v42 offset:9216
    v_mfma_f32_16x16x32_bf16 v[64:67], v[184:187], v[148:151], v[64:67]
    ds_read_b128 v[164:167], v41 offset:2048
    v_mfma_f32_16x16x32_bf16 v[68:71], v[188:191], v[148:151], v[68:71]
    ds_read_b128 v[168:171], v41 offset:4096
    v_mfma_f32_16x16x32_bf16 v[72:75], v[192:195], v[148:151], v[72:75]
    ds_read_b64_tr_b16 v[208:209], v43 offset:8192
    v_mfma_f32_16x16x32_bf16 v[76:79], v[148:151], v[196:199], v[76:79]
    ds_read_b64_tr_b16 v[210:211], v43 offset:9216
    v_mfma_f32_16x16x32_bf16 v[80:83], v[148:151], v[200:203], v[80:83]
    ds_read_b64_tr_b16 v[212:213], v44 offset:8192
    v_mfma_f32_16x16x32_bf16 v[112:115], v[152:155], v[200:203], v[112:115]
    ds_read_b64_tr_b16 v[214:215], v44 offset:9216
    v_mfma_f32_16x16x32_bf16 v[108:111], v[152:155], v[196:199], v[108:111]
    ds_read_b64_tr_b16 v[216:217], v45 offset:8192
    v_mfma_f32_16x16x32_bf16 v[104:107], v[192:195], v[152:155], v[104:107]
    ds_read_b64_tr_b16 v[218:219], v45 offset:9216
    v_mfma_f32_16x16x32_bf16 v[100:103], v[188:191], v[152:155], v[100:103]
    ds_read_b64_tr_b16 v[220:221], v46 offset:8192
    v_mfma_f32_16x16x32_bf16 v[96:99], v[184:187], v[152:155], v[96:99]
    ds_read_b64_tr_b16 v[222:223], v46 offset:9216
    v_mfma_f32_16x16x32_bf16 v[92:95], v[180:183], v[152:155], v[92:95]
    ds_read_b64_tr_b16 v[224:225], v47 offset:8192
    v_mfma_f32_16x16x32_bf16 v[88:91], v[176:179], v[152:155], v[88:91]
    ds_read_b64_tr_b16 v[226:227], v47 offset:9216
    v_mfma_f32_16x16x32_bf16 v[84:87], v[172:175], v[152:155], v[84:87]
    ds_read_b64_tr_b16 v[228:229], v48 offset:8192
    v_mfma_f32_16x16x32_bf16 v[116:119], v[172:175], v[156:159], v[116:119]
    ds_read_b64_tr_b16 v[230:231], v48 offset:9216
    v_mfma_f32_16x16x32_bf16 v[120:123], v[176:179], v[156:159], v[120:123]
    ds_read_b64_tr_b16 v[232:233], v49 offset:8192
    v_mfma_f32_16x16x32_bf16 v[124:127], v[180:183], v[156:159], v[124:127]
    ds_read_b64_tr_b16 v[234:235], v49 offset:9216
    v_mfma_f32_16x16x32_bf16 v[128:131], v[184:187], v[156:159], v[128:131]
    v_mfma_f32_16x16x32_bf16 v[132:135], v[188:191], v[156:159], v[132:135]
    v_mfma_f32_16x16x32_bf16 v[136:139], v[192:195], v[156:159], v[136:139]
    v_mfma_f32_16x16x32_bf16 v[140:143], v[156:159], v[196:199], v[140:143]
    v_mfma_f32_16x16x32_bf16 v[144:147], v[156:159], v[200:203], v[144:147]
    s_waitcnt lgkmcnt(0)
    s_barrier
    v_mfma_f32_16x16x32_bf16 v[52:55], v[204:207], v[160:163], v[52:55]
    ds_read_b128 v[148:151], v40 offset:24576
    v_mfma_f32_16x16x32_bf16 v[56:59], v[208:211], v[160:163], v[56:59]
    ds_read_b64_tr_b16 v[172:173], v42 offset:16384
    v_mfma_f32_16x16x32_bf16 v[60:63], v[212:215], v[160:163], v[60:63]
    ds_read_b64_tr_b16 v[174:175], v42 offset:17408
    v_mfma_f32_16x16x32_bf16 v[64:67], v[216:219], v[160:163], v[64:67]
    ds_read_b128 v[152:155], v40 offset:26624
    v_mfma_f32_16x16x32_bf16 v[68:71], v[220:223], v[160:163], v[68:71]
    ds_read_b128 v[156:159], v40 offset:28672
    v_mfma_f32_16x16x32_bf16 v[72:75], v[224:227], v[160:163], v[72:75]
    ds_read_b64_tr_b16 v[176:177], v43 offset:16384
    v_mfma_f32_16x16x32_bf16 v[76:79], v[160:163], v[228:231], v[76:79]
    ds_read_b64_tr_b16 v[178:179], v43 offset:17408
    v_mfma_f32_16x16x32_bf16 v[80:83], v[160:163], v[232:235], v[80:83]
    ds_read_b64_tr_b16 v[180:181], v44 offset:16384
    v_mfma_f32_16x16x32_bf16 v[112:115], v[164:167], v[232:235], v[112:115]
    ds_read_b64_tr_b16 v[182:183], v44 offset:17408
    v_mfma_f32_16x16x32_bf16 v[108:111], v[164:167], v[228:231], v[108:111]
    ds_read_b64_tr_b16 v[184:185], v45 offset:16384
    v_mfma_f32_16x16x32_bf16 v[104:107], v[224:227], v[164:167], v[104:107]
    ds_read_b64_tr_b16 v[186:187], v45 offset:17408
    v_mfma_f32_16x16x32_bf16 v[100:103], v[220:223], v[164:167], v[100:103]
    ds_read_b64_tr_b16 v[188:189], v46 offset:16384
    v_mfma_f32_16x16x32_bf16 v[96:99], v[216:219], v[164:167], v[96:99]
    ds_read_b64_tr_b16 v[190:191], v46 offset:17408
    v_mfma_f32_16x16x32_bf16 v[92:95], v[212:215], v[164:167], v[92:95]
    ds_read_b64_tr_b16 v[192:193], v47 offset:16384
    v_mfma_f32_16x16x32_bf16 v[88:91], v[208:211], v[164:167], v[88:91]
    ds_read_b64_tr_b16 v[194:195], v47 offset:17408
    v_mfma_f32_16x16x32_bf16 v[84:87], v[204:207], v[164:167], v[84:87]
    ds_read_b64_tr_b16 v[196:197], v48 offset:16384
    v_mfma_f32_16x16x32_bf16 v[116:119], v[204:207], v[168:171], v[116:119]
    ds_read_b64_tr_b16 v[198:199], v48 offset:17408
    v_mfma_f32_16x16x32_bf16 v[120:123], v[208:211], v[168:171], v[120:123]
    ds_read_b64_tr_b16 v[200:201], v49 offset:16384
    v_mfma_f32_16x16x32_bf16 v[124:127], v[212:215], v[168:171], v[124:127]
    ds_read_b64_tr_b16 v[202:203], v49 offset:17408
    v_mfma_f32_16x16x32_bf16 v[128:131], v[216:219], v[168:171], v[128:131]
    v_mfma_f32_16x16x32_bf16 v[132:135], v[220:223], v[168:171], v[132:135]
    v_mfma_f32_16x16x32_bf16 v[136:139], v[224:227], v[168:171], v[136:139]
    v_mfma_f32_16x16x32_bf16 v[140:143], v[168:171], v[228:231], v[140:143]
    v_mfma_f32_16x16x32_bf16 v[144:147], v[168:171], v[232:235], v[144:147]
    s_waitcnt lgkmcnt(0)
    v_mfma_f32_16x16x32_bf16 v[52:55], v[172:175], v[148:151], v[52:55]
    ds_read_b128 v[160:163], v41 offset:24576
    v_mfma_f32_16x16x32_bf16 v[56:59], v[176:179], v[148:151], v[56:59]
    ds_read_b64_tr_b16 v[204:205], v42 offset:24576
    v_mfma_f32_16x16x32_bf16 v[60:63], v[180:183], v[148:151], v[60:63]
    ds_read_b64_tr_b16 v[206:207], v42 offset:25600
    v_mfma_f32_16x16x32_bf16 v[64:67], v[184:187], v[148:151], v[64:67]
    ds_read_b128 v[164:167], v41 offset:26624
    v_mfma_f32_16x16x32_bf16 v[68:71], v[188:191], v[148:151], v[68:71]
    ds_read_b128 v[168:171], v41 offset:28672
    v_mfma_f32_16x16x32_bf16 v[72:75], v[192:195], v[148:151], v[72:75]
    ds_read_b64_tr_b16 v[208:209], v43 offset:24576
    v_mfma_f32_16x16x32_bf16 v[76:79], v[148:151], v[196:199], v[76:79]
    ds_read_b64_tr_b16 v[210:211], v43 offset:25600
    v_mfma_f32_16x16x32_bf16 v[80:83], v[148:151], v[200:203], v[80:83]
    ds_read_b64_tr_b16 v[212:213], v44 offset:24576
    v_mfma_f32_16x16x32_bf16 v[112:115], v[152:155], v[200:203], v[112:115]
    ds_read_b64_tr_b16 v[214:215], v44 offset:25600
    v_mfma_f32_16x16x32_bf16 v[108:111], v[152:155], v[196:199], v[108:111]
    ds_read_b64_tr_b16 v[216:217], v45 offset:24576
    v_mfma_f32_16x16x32_bf16 v[104:107], v[192:195], v[152:155], v[104:107]
    ds_read_b64_tr_b16 v[218:219], v45 offset:25600
    v_mfma_f32_16x16x32_bf16 v[100:103], v[188:191], v[152:155], v[100:103]
    ds_read_b64_tr_b16 v[220:221], v46 offset:24576
    v_mfma_f32_16x16x32_bf16 v[96:99], v[184:187], v[152:155], v[96:99]
    ds_read_b64_tr_b16 v[222:223], v46 offset:25600
    v_mfma_f32_16x16x32_bf16 v[92:95], v[180:183], v[152:155], v[92:95]
    ds_read_b64_tr_b16 v[224:225], v47 offset:24576
    v_mfma_f32_16x16x32_bf16 v[88:91], v[176:179], v[152:155], v[88:91]
    ds_read_b64_tr_b16 v[226:227], v47 offset:25600
    v_mfma_f32_16x16x32_bf16 v[84:87], v[172:175], v[152:155], v[84:87]
    ds_read_b64_tr_b16 v[228:229], v48 offset:24576
    v_mfma_f32_16x16x32_bf16 v[116:119], v[172:175], v[156:159], v[116:119]
    ds_read_b64_tr_b16 v[230:231], v48 offset:25600
    v_mfma_f32_16x16x32_bf16 v[120:123], v[176:179], v[156:159], v[120:123]
    ds_read_b64_tr_b16 v[232:233], v49 offset:24576
    v_mfma_f32_16x16x32_bf16 v[124:127], v[180:183], v[156:159], v[124:127]
    ds_read_b64_tr_b16 v[234:235], v49 offset:25600
    v_mfma_f32_16x16x32_bf16 v[128:131], v[184:187], v[156:159], v[128:131]
    v_mfma_f32_16x16x32_bf16 v[132:135], v[188:191], v[156:159], v[132:135]
    v_mfma_f32_16x16x32_bf16 v[136:139], v[192:195], v[156:159], v[136:139]
    v_mfma_f32_16x16x32_bf16 v[140:143], v[156:159], v[196:199], v[140:143]
    v_mfma_f32_16x16x32_bf16 v[144:147], v[156:159], v[200:203], v[144:147]
    s_waitcnt lgkmcnt(0)
    s_barrier
    v_mfma_f32_16x16x32_bf16 v[52:55], v[204:207], v[160:163], v[52:55]
    ds_read_b128 v[148:151], v40 offset:49152
    v_mfma_f32_16x16x32_bf16 v[56:59], v[208:211], v[160:163], v[56:59]
    ds_read_b64_tr_b16 v[172:173], v42 offset:32768
    v_mfma_f32_16x16x32_bf16 v[60:63], v[212:215], v[160:163], v[60:63]
    ds_read_b64_tr_b16 v[174:175], v42 offset:33792
    v_mfma_f32_16x16x32_bf16 v[64:67], v[216:219], v[160:163], v[64:67]
    ds_read_b128 v[152:155], v40 offset:51200
    v_mfma_f32_16x16x32_bf16 v[68:71], v[220:223], v[160:163], v[68:71]
    ds_read_b128 v[156:159], v40 offset:53248
    v_mfma_f32_16x16x32_bf16 v[72:75], v[224:227], v[160:163], v[72:75]
    ds_read_b64_tr_b16 v[176:177], v43 offset:32768
    v_mfma_f32_16x16x32_bf16 v[76:79], v[160:163], v[228:231], v[76:79]
    ds_read_b64_tr_b16 v[178:179], v43 offset:33792
    v_mfma_f32_16x16x32_bf16 v[80:83], v[160:163], v[232:235], v[80:83]
    ds_read_b64_tr_b16 v[180:181], v44 offset:32768
    v_mfma_f32_16x16x32_bf16 v[112:115], v[164:167], v[232:235], v[112:115]
    ds_read_b64_tr_b16 v[182:183], v44 offset:33792
    v_mfma_f32_16x16x32_bf16 v[108:111], v[164:167], v[228:231], v[108:111]
    ds_read_b64_tr_b16 v[184:185], v45 offset:32768
    v_mfma_f32_16x16x32_bf16 v[104:107], v[224:227], v[164:167], v[104:107]
    ds_read_b64_tr_b16 v[186:187], v45 offset:33792
    v_mfma_f32_16x16x32_bf16 v[100:103], v[220:223], v[164:167], v[100:103]
    ds_read_b64_tr_b16 v[188:189], v46 offset:32768
    v_mfma_f32_16x16x32_bf16 v[96:99], v[216:219], v[164:167], v[96:99]
    ds_read_b64_tr_b16 v[190:191], v46 offset:33792
    v_mfma_f32_16x16x32_bf16 v[92:95], v[212:215], v[164:167], v[92:95]
    ds_read_b64_tr_b16 v[192:193], v47 offset:32768
    v_mfma_f32_16x16x32_bf16 v[88:91], v[208:211], v[164:167], v[88:91]
    ds_read_b64_tr_b16 v[194:195], v47 offset:33792
    v_mfma_f32_16x16x32_bf16 v[84:87], v[204:207], v[164:167], v[84:87]
    ds_read_b64_tr_b16 v[196:197], v48 offset:32768
    v_mfma_f32_16x16x32_bf16 v[116:119], v[204:207], v[168:171], v[116:119]
    ds_read_b64_tr_b16 v[198:199], v48 offset:33792
    v_mfma_f32_16x16x32_bf16 v[120:123], v[208:211], v[168:171], v[120:123]
    ds_read_b64_tr_b16 v[200:201], v49 offset:32768
    v_mfma_f32_16x16x32_bf16 v[124:127], v[212:215], v[168:171], v[124:127]
    ds_read_b64_tr_b16 v[202:203], v49 offset:33792
    v_mfma_f32_16x16x32_bf16 v[128:131], v[216:219], v[168:171], v[128:131]
    s_sub_u32 s52, s52, 1
    v_mfma_f32_16x16x32_bf16 v[132:135], v[220:223], v[168:171], v[132:135]
    s_cmp_lg_u32 s52, 0
    v_mfma_f32_16x16x32_bf16 v[136:139], v[224:227], v[168:171], v[136:139]
    v_mfma_f32_16x16x32_bf16 v[140:143], v[168:171], v[228:231], v[140:143]
    v_mfma_f32_16x16x32_bf16 v[144:147], v[168:171], v[232:235], v[144:147]
    s_cbranch_scc1 K_CLOOP
    s_waitcnt lgkmcnt(0)
    v_mfma_f32_16x16x32_bf16 v[52:55], v[172:175], v[148:151], v[52:55]
    ds_read_b128 v[160:163], v41 offset:49152
    ds_read_b64_tr_b16 v[204:205], v42 offset:40960
    v_mfma_f32_16x16x32_bf16 v[116:119], v[172:175], v[156:159], v[116:119]
    ds_read_b64_tr_b16 v[206:207], v42 offset:41984
    ds_read_b128 v[164:167], v41 offset:51200
    v_mfma_f32_16x16x32_bf16 v[84:87], v[172:175], v[152:155], v[84:87]
    ds_read_b128 v[168:171], v41 offset:53248
    ds_read_b64_tr_b16 v[208:209], v43 offset:40960
    v_mfma_f32_16x16x32_bf16 v[56:59], v[176:179], v[148:151], v[56:59]
    ds_read_b64_tr_b16 v[210:211], v43 offset:41984
    ds_read_b64_tr_b16 v[212:213], v44 offset:40960
    v_mfma_f32_16x16x32_bf16 v[120:123], v[176:179], v[156:159], v[120:123]
    ds_read_b64_tr_b16 v[214:215], v44 offset:41984
    ds_read_b64_tr_b16 v[216:217], v45 offset:40960
    v_mfma_f32_16x16x32_bf16 v[88:91], v[176:179], v[152:155], v[88:91]
    ds_read_b64_tr_b16 v[218:219], v45 offset:41984
    ds_read_b64_tr_b16 v[220:221], v46 offset:40960
    v_mfma_f32_16x16x32_bf16 v[60:63], v[180:183], v[148:151], v[60:63]
    ds_read_b64_tr_b16 v[222:223], v46 offset:41984
    ds_read_b64_tr_b16 v[224:225], v47 offset:40960
    v_mfma_f32_16x16x32_bf16 v[124:127], v[180:183], v[156:159], v[124:127]
    ds_read_b64_tr_b16 v[226:227], v47 offset:41984
    ds_read_b64_tr_b16 v[228:229], v48 offset:40960
    v_mfma_f32_16x16x32_bf16 v[92:95], v[180:183], v[152:155], v[92:95]
    ds_read_b64_tr_b16 v[230:231], v48 offset:41984
    ds_read_b64_tr_b16 v[232:233], v49 offset:40960
    v_mfma_f32_16x16x32_bf16 v[64:67], v[184:187], v[148:151], v[64:67]
    ds_read_b64_tr_b16 v[234:235], v49 offset:41984
    v_mfma_f32_16x16x32_bf16 v[128:131], v[184:187], v[156:159], v[128:131]
    s_nop 1
    v_mfma_f32_16x16x32_bf16 v[96:99], v[184:187], v[152:155], v[96:99]
    s_nop 1
    s_waitcnt lgkmcnt(15)
    v_mfma_f32_16x16x32_bf16 v[52:55], v[204:207], v[160:163], v[52:55]
    s_nop 1
    s_waitcnt lgkmcnt(12)
    v_mfma_f32_16x16x32_bf16 v[56:59], v[208:211], v[160:163], v[56:59]
    s_nop 1
    v_mfma_f32_16x16x32_bf16 v[116:119], v[204:207], v[168:171], v[116:119]
    s_nop 1
    v_mfma_f32_16x16x32_bf16 v[120:123], v[208:211], v[168:171], v[120:123]
    s_nop 1
    v_mfma_f32_16x16x32_bf16 v[84:87], v[204:207], v[164:167], v[84:87]
    v_cvt_pk_bf16_f32 v52, v52, v53
    v_cvt_pk_bf16_f32 v53, v54, v55
    v_mfma_f32_16x16x32_bf16 v[88:91], v[208:211], v[164:167], v[88:91]
    v_cvt_pk_bf16_f32 v54, v56, v57
    v_cvt_pk_bf16_f32 v55, v58, v59
    s_waitcnt lgkmcnt(10)
    v_mfma_f32_16x16x32_bf16 v[60:63], v[212:215], v[160:163], v[60:63]
    ds_write_b128 v13, v[52:55] offset:0
    s_waitcnt lgkmcnt(9)
    v_mfma_f32_16x16x32_bf16 v[64:67], v[216:219], v[160:163], v[64:67]
    v_cvt_pk_bf16_f32 v116, v116, v117
    v_cvt_pk_bf16_f32 v117, v118, v119
    v_mfma_f32_16x16x32_bf16 v[124:127], v[212:215], v[168:171], v[124:127]
    v_cvt_pk_bf16_f32 v118, v120, v121
    v_cvt_pk_bf16_f32 v119, v122, v123
    v_mfma_f32_16x16x32_bf16 v[128:131], v[216:219], v[168:171], v[128:131]
    ds_write_b128 v13, v[116:119] offset:2048
    v_mfma_f32_16x16x32_bf16 v[92:95], v[212:215], v[164:167], v[92:95]
    v_cvt_pk_bf16_f32 v84, v84, v85
    v_cvt_pk_bf16_f32 v85, v86, v87
    v_mfma_f32_16x16x32_bf16 v[96:99], v[216:219], v[164:167], v[96:99]
    v_cvt_pk_bf16_f32 v86, v88, v89
    v_cvt_pk_bf16_f32 v87, v90, v91
    v_mfma_f32_16x16x32_bf16 v[68:71], v[188:191], v[148:151], v[68:71]
    ds_write_b128 v13, v[84:87] offset:1024
    v_mfma_f32_16x16x32_bf16 v[72:75], v[192:195], v[148:151], v[72:75]
    v_cvt_pk_bf16_f32 v60, v60, v61
    v_cvt_pk_bf16_f32 v61, v62, v63
    s_waitcnt lgkmcnt(9)
    v_mfma_f32_16x16x32_bf16 v[68:71], v[220:223], v[160:163], v[68:71]
    v_cvt_pk_bf16_f32 v64, v64, v65
    v_cvt_pk_bf16_f32 v65, v66, v67
    s_waitcnt lgkmcnt(7)
    v_mfma_f32_16x16x32_bf16 v[72:75], v[224:227], v[160:163], v[72:75]
    ds_write2st64_b64 v14, v[60:61], v[64:65] offset0:4 offset1:5
    v_mfma_f32_16x16x32_bf16 v[132:135], v[188:191], v[156:159], v[132:135]
    ds_read_b64 v[62:63], v13 offset:0
    ds_read_b64 v[66:67], v13 offset:0
    v_mfma_f32_16x16x32_bf16 v[136:139], v[192:195], v[156:159], v[136:139]
    v_cvt_pk_bf16_f32 v124, v124, v125
    v_cvt_pk_bf16_f32 v125, v126, v127
    v_mfma_f32_16x16x32_bf16 v[132:135], v[220:223], v[168:171], v[132:135]
    v_cvt_pk_bf16_f32 v128, v128, v129
    v_cvt_pk_bf16_f32 v129, v130, v131
    v_mfma_f32_16x16x32_bf16 v[136:139], v[224:227], v[168:171], v[136:139]
    ds_write2st64_b64 v14, v[124:125], v[128:129] offset0:10 offset1:11
    v_mfma_f32_16x16x32_bf16 v[100:103], v[188:191], v[152:155], v[100:103]
    ds_read_b64 v[126:127], v13 offset:2048
    ds_read_b64 v[130:131], v13 offset:2048
    v_mfma_f32_16x16x32_bf16 v[104:107], v[192:195], v[152:155], v[104:107]
    v_cvt_pk_bf16_f32 v92, v92, v93
    v_cvt_pk_bf16_f32 v93, v94, v95
    v_mfma_f32_16x16x32_bf16 v[100:103], v[220:223], v[164:167], v[100:103]
    v_cvt_pk_bf16_f32 v96, v96, v97
    v_cvt_pk_bf16_f32 v97, v98, v99
    v_mfma_f32_16x16x32_bf16 v[104:107], v[224:227], v[164:167], v[104:107]
    ds_read_b64 v[94:95], v13 offset:1024
    ds_read_b64 v[98:99], v13 offset:1024
    v_mfma_f32_16x16x32_bf16 v[76:79], v[148:151], v[196:199], v[76:79]
    v_cvt_pk_bf16_f32 v68, v68, v69
    v_cvt_pk_bf16_f32 v69, v70, v71
    v_mfma_f32_16x16x32_bf16 v[80:83], v[148:151], v[200:203], v[80:83]
    v_cvt_pk_bf16_f32 v72, v72, v73
    v_cvt_pk_bf16_f32 v73, v74, v75
    s_waitcnt lgkmcnt(13)
    v_mfma_f32_16x16x32_bf16 v[76:79], v[160:163], v[228:231], v[76:79]
    ds_write2st64_b64 v14, v[68:69], v[72:73] offset0:8 offset1:9
    s_waitcnt lgkmcnt(12)
    v_mfma_f32_16x16x32_bf16 v[80:83], v[160:163], v[232:235], v[80:83]
    ds_write_b32 v50, v4
    v_cvt_pk_bf16_f32 v132, v132, v133
    v_mfma_f32_16x16x32_bf16 v[140:143], v[156:159], v[196:199], v[140:143]
    v_cvt_pk_bf16_f32 v133, v134, v135
    v_cvt_pk_bf16_f32 v136, v136, v137
    v_mfma_f32_16x16x32_bf16 v[144:147], v[156:159], v[200:203], v[144:147]
    v_cvt_pk_bf16_f32 v137, v138, v139
    ds_read_b64 v[134:135], v18 offset:2048
    v_mfma_f32_16x16x32_bf16 v[140:143], v[168:171], v[228:231], v[140:143]
    ds_read_b64 v[138:139], v19 offset:2048
    v_cvt_pk_bf16_f32 v100, v100, v101
    v_mfma_f32_16x16x32_bf16 v[144:147], v[168:171], v[232:235], v[144:147]
    v_cvt_pk_bf16_f32 v101, v102, v103
    v_cvt_pk_bf16_f32 v104, v104, v105
    v_mfma_f32_16x16x32_bf16 v[108:111], v[152:155], v[196:199], v[108:111]
    v_cvt_pk_bf16_f32 v105, v106, v107
    ds_read_b64 v[102:103], v18 offset:1024
    v_mfma_f32_16x16x32_bf16 v[112:115], v[152:155], v[200:203], v[112:115]
    ds_read_b64 v[106:107], v19 offset:1024
    v_cvt_pk_bf16_f32 v236, v76, v77
    v_mfma_f32_16x16x32_bf16 v[108:111], v[164:167], v[228:231], v[108:111]
    v_cvt_pk_bf16_f32 v237, v78, v79
    v_cvt_pk_bf16_f32 v242, v80, v81
    v_mfma_f32_16x16x32_bf16 v[112:115], v[164:167], v[232:235], v[112:115]
    v_cvt_pk_bf16_f32 v243, v82, v83
    v_cvt_pk_bf16_f32 v240, v140, v141
    s_branch WS_attd
.p2align 12
WP_attd:
    s_setpc_b64 s[38:39]
WS_attd:
    s_waitcnt lgkmcnt(3)
    v_mfma_f32_16x16x32_bf16 v[208:211], v[124:127], v[132:135], v[28:31]
    ds_write2st64_b64 v14, v[236:237], v[242:243] offset0:6 offset1:7
    v_mfma_f32_16x16x32_bf16 v[204:207], v[92:95], v[132:135], v[24:27]
    v_cvt_pk_bf16_f32 v241, v142, v143
    v_cvt_pk_bf16_f32 v246, v144, v145
    s_waitcnt lgkmcnt(3)
    v_mfma_f32_16x16x32_bf16 v[216:219], v[128:131], v[136:139], v[28:31]
    v_cvt_pk_bf16_f32 v247, v146, v147
    ds_read_b64_tr_b16 v[188:189], v20 offset:0
    v_mfma_f32_16x16x32_bf16 v[212:215], v[96:99], v[136:139], v[24:27]
    ds_write2st64_b64 v14, v[240:241], v[246:247] offset0:12 offset1:13
    s_waitcnt lgkmcnt(4)
    v_mfma_f32_16x16x32_bf16 v[176:179], v[92:95], v[100:103], v[28:31]
    ds_write_b32 v50, v5
    v_max3_f32 v72, v204, v205, v208
    v_mfma_f32_16x16x32_bf16 v[172:175], v[60:63], v[100:103], v[32:35]
    v_max3_f32 v73, v206, v207, v210
    v_max_f32 v72, v72, v209
    s_waitcnt lgkmcnt(4)
    v_mfma_f32_16x16x32_bf16 v[184:187], v[96:99], v[104:107], v[28:31]
    v_max_f32 v73, v73, v211
    v_max3_f32 v74, v212, v213, v216
    v_mfma_f32_16x16x32_bf16 v[180:183], v[64:67], v[104:107], v[32:35]
    v_max3_f32 v75, v214, v215, v218
    v_max_f32 v74, v74, v217
    ds_read_b64_tr_b16 v[190:191], v20 offset:1024
    ds_read_b64_tr_b16 v[192:193], v21 offset:0
    ds_read_b64_tr_b16 v[194:195], v21 offset:1024
    ds_read_b64_tr_b16 v[220:221], v22 offset:1024
    ds_read_b64_tr_b16 v[222:223], v22 offset:2048
    ds_read_b64_tr_b16 v[224:225], v23 offset:1024
    ds_read_b64_tr_b16 v[226:227], v23 offset:2048
    v_max_f32 v75, v75, v219
    v_max3_f32 v68, v172, v173, v176
    v_max3_f32 v69, v174, v175, v178
    v_max_f32 v68, v68, v177
    v_max_f32 v69, v69, v179
    v_max3_f32 v70, v180, v181, v184
    v_max3_f32 v71, v182, v183, v186
    v_max_f32 v70, v70, v185
    v_max_f32 v71, v71, v187
    v_permlane16_swap_b32 v72, v74
    v_permlane16_swap_b32 v73, v75
    v_permlane16_swap_b32 v68, v70
    v_permlane16_swap_b32 v69, v71
    v_cvt_pk_bf16_f32 v238, v108, v109
    v_permlane32_swap_b32 v68, v72
    v_permlane32_swap_b32 v70, v74
    v_permlane32_swap_b32 v69, v73
    v_permlane32_swap_b32 v71, v75
    v_max3_f32 v120, v68, v69, v72
    v_max3_f32 v121, v73, v70, v71
    v_max3_f32 v120, v120, v74, v75
    v_max_f32 v120, v120, v121
    v_mul_f32 v120, s46, v120
    v_pk_fma_f32 v[68:69], v[68:69], s[46:47], v[120:121] op_sel_hi:[1,1,0] neg_lo:[0,0,1] neg_hi:[0,0,1]
    v_pk_fma_f32 v[70:71], v[70:71], s[46:47], v[120:121] op_sel_hi:[1,1,0] neg_lo:[0,0,1] neg_hi:[0,0,1]
    v_pk_fma_f32 v[72:73], v[72:73], s[46:47], v[120:121] op_sel_hi:[1,1,0] neg_lo:[0,0,1] neg_hi:[0,0,1]
    v_pk_fma_f32 v[74:75], v[74:75], s[46:47], v[120:121] op_sel_hi:[1,1,0] neg_lo:[0,0,1] neg_hi:[0,0,1]
    v_exp_f32 v68, v68
    v_exp_f32 v69, v69
    v_exp_f32 v70, v70
    v_exp_f32 v71, v71
    v_exp_f32 v72, v72
    v_exp_f32 v73, v73
    v_exp_f32 v74, v74
    v_exp_f32 v75, v75
    v_pk_add_f32 v[56:57], v[68:69], v[70:71]
    v_pk_add_f32 v[58:59], v[72:73], v[74:75]
    v_pk_add_f32 v[56:57], v[56:57], v[58:59]
    v_add_f32 v56, v56, v57
    v_rcp_f32 v56, v56
    s_waitcnt lgkmcnt(0)
    v_pk_mul_f32 v[68:69], v[68:69], v[56:57] op_sel_hi:[1,0]
    v_pk_mul_f32 v[70:71], v[70:71], v[56:57] op_sel_hi:[1,0]
    v_pk_mul_f32 v[72:73], v[72:73], v[56:57] op_sel_hi:[1,0]
    v_pk_mul_f32 v[74:75], v[74:75], v[56:57] op_sel_hi:[1,0]
    v_cvt_pk_bf16_f32 v88, v68, v69
    v_cvt_pk_bf16_f32 v90, v72, v73
    v_cvt_pk_bf16_f32 v89, v70, v71
    v_cvt_pk_bf16_f32 v91, v74, v75
    v_permlane32_swap_b32 v88, v90
    v_cvt_pk_bf16_f32 v239, v110, v111
    v_permlane32_swap_b32 v89, v91
    v_cvt_pk_bf16_f32 v244, v112, v113
    v_cvt_pk_bf16_f32 v245, v114, v115
    v_permlane16_swap_b32 v88, v89
    v_permlane16_swap_b32 v90, v91
    v_perm_b32 v148, v88, v88, v36
    v_perm_b32 v149, v88, v88, v37
    v_perm_b32 v150, v88, v88, v38
    v_perm_b32 v151, v88, v88, v39
    v_perm_b32 v152, v89, v89, v36
    v_perm_b32 v153, v89, v89, v37
    v_mfma_f32_16x16x32_bf16 v[100:103], v[236:239], v[148:151], 0
    v_perm_b32 v154, v89, v89, v38
    v_perm_b32 v155, v89, v89, v39
    v_mfma_f32_16x16x32_bf16 v[156:159], v[188:191], v[148:151], 0
    v_perm_b32 v160, v90, v90, v36
    v_perm_b32 v161, v90, v90, v37
    v_mfma_f32_16x16x32_bf16 v[104:107], v[242:245], v[152:155], 0
    v_perm_b32 v162, v90, v90, v38
    v_perm_b32 v163, v90, v90, v39
    v_mfma_f32_16x16x32_bf16 v[156:159], v[192:195], v[152:155], v[156:159]
    v_perm_b32 v164, v91, v91, v36
    v_perm_b32 v165, v91, v91, v37
    v_mfma_f32_16x16x32_bf16 v[132:135], v[238:241], v[160:163], 0
    v_perm_b32 v166, v91, v91, v38
    v_perm_b32 v167, v91, v91, v39
    v_mfma_f32_16x16x32_bf16 v[156:159], v[220:223], v[160:163], v[156:159]
    v_cvt_pk_bf16_f32 v60, v100, v101
    v_cvt_pk_bf16_f32 v61, v102, v103
    v_mfma_f32_16x16x32_bf16 v[156:159], v[224:227], v[164:167], v[156:159]
    v_cvt_pk_bf16_f32 v62, v104, v105
    v_cvt_pk_bf16_f32 v63, v106, v107
    v_mfma_f32_16x16x32_bf16 v[136:139], v[244:247], v[164:167], 0
    buffer_store_dwordx4 v[60:63], v15, s[20:23], s50 offen sc1
    v_cvt_pk_bf16_f32 v64, v132, v133
    v_cvt_pk_bf16_f32 v65, v134, v135
    s_nop 1
    v_cvt_pk_bf16_f32 v56, v156, v157
    v_cvt_pk_bf16_f32 v57, v158, v159
    v_cvt_pk_bf16_f32 v58, v156, v157
    v_cvt_pk_bf16_f32 v59, v158, v159
    v_cvt_pk_bf16_f32 v66, v136, v137
    v_cvt_pk_bf16_f32 v67, v138, v139
    v_permlane16_swap_b32 v56, v58
    v_permlane16_swap_b32 v57, v59
    buffer_store_dwordx4 v[64:67], v15, s[20:23], s51 offen sc1
    buffer_store_dwordx4 v[56:59], v16, s[20:23], s50 offen sc1
    s_cmp_lg_u32 s34, -1
    s_cbranch_scc1 K_P2_EARLY
K_DRAIN:
    s_waitcnt vmcnt(0)
    s_barrier
    s_branch K_END
K_W7A:
    s_waitcnt vmcnt(0)
    v_and_b32 v4, 7, v1
    v_lshlrev_b32 v4, 2, v4
    s_mov_b32 s3, 131072
K_ZPOLL5:
    v_cmp_eq_u32 vcc, 0, v7
    s_cbranch_vccz K_ZOK5
    s_sub_u32 s3, s3, 1
    s_cbranch_scc1 K_ZOK5
    global_load_dword v7, v4, s[8:9] offset:192 sc1
    s_waitcnt vmcnt(0)
    s_branch K_ZPOLL5
K_ZOK5:
    v_mov_b32 v4, 158720
    v_mov_b32 v3, 1
    s_mov_b64 exec, 1
    s_nop 0
    ds_add_rtn_u32 v2, v4, v3 offset:48
    s_mov_b32 exec_lo, s36
    v_mov_b32 v3, 1
    s_waitcnt lgkmcnt(0)
    v_readfirstlane_b32 s33, v2
    s_nop 3
    s_and_b32 s33, s33, 0xff
    s_cmp_lg_u32 s33, 7
    s_cbranch_scc1 K_ARR7
    global_store_dword v8, v3, s[10:11] sc1
K_ARR7:
    s_mov_b64 exec, -1
    v_mov_b32 v6, 158800
    s_mov_b32 s3, 1048576
K_XG7:
    ds_read_b128 v[2:5], v6
    s_sleep 1
    s_sub_u32 s3, s3, 1
    s_waitcnt lgkmcnt(0)
    v_min3_u32 v2, v2, v4, v5
    v_min_u32 v2, v2, v3
    s_nop 0
    v_readfirstlane_b32 s33, v2
    s_nop 3
    s_cselect_b32 s33, 1, s33
    s_cmp_lt_u32 s33, 1
    s_cbranch_scc1 K_XG7
    v_mov_b32 v4, 158720
    s_branch K_WOE
K_W7:
    v_mov_b32 v3, 0x100
    s_mov_b64 exec, 1
    s_waitcnt vmcnt(0)
    ds_add_u32 v4, v3 offset:48
    s_mov_b64 exec, -1
    s_branch K_P2_HELP
K_FLAG:
    s_waitcnt vmcnt(0)
    v_and_b32 v4, 7, v1
    v_lshlrev_b32 v4, 2, v4
    s_mov_b32 s3, 131072
K_ZPOLL0:
    v_cmp_eq_u32 vcc, 0, v7
    s_cbranch_vccz K_ZOK0
    s_sub_u32 s3, s3, 1
    s_cbranch_scc1 K_ZOK0
    global_load_dword v7, v4, s[8:9] offset:192 sc1
    s_waitcnt vmcnt(0)
    s_branch K_ZPOLL0
K_ZOK0:
    v_mov_b32 v3, 1
    s_mov_b32 exec_lo, s36
    s_mov_b32 exec_hi, 0
    s_setprio 3
    s_barrier
    global_store_dword v8, v3, s[10:11] sc1
    s_mov_b64 exec, -1
    s_branch K_END
WP_atts:
    s_setpc_b64 s[38:39]
K_JOIN_S:
    s_setprio 0
    s_cmp_eq_u32 s30, 7
    s_cbranch_scc1 K_FLAG
    s_lshl_b32 s3, s30, 2
    s_add_u32 s3, s3, 158784
    v_mov_b32 v6, s3
    s_mov_b32 s3, 1048576
K_XG1:
    ds_read2_b32 v[2:3], v6 offset0:0 offset1:1
    s_sleep 1
    s_sub_u32 s3, s3, 1
    s_waitcnt lgkmcnt(0)
    v_min_u32 v2, v2, v3
    s_nop 0
    v_readfirstlane_b32 s33, v2
    s_nop 3
    s_cselect_b32 s33, 1, s33
    s_cmp_lt_u32 s33, 1
    s_cbranch_scc1 K_XG1
    ds_read_b64 v[40:41], v14 offset:4096
    ds_read_b64 v[42:43], v18 offset:1024
    ds_read_b64 v[48:49], v14 offset:0
    ds_read_b64 v[50:51], v13 offset:0
    ds_read_b64 v[52:53], v14 offset:2048
    ds_read_b64 v[54:55], v13 offset:1024
    ds_read_b64 v[44:45], v14 offset:4608
    ds_read_b64 v[46:47], v19 offset:1024
    ds_read_b64 v[56:57], v14 offset:512
    ds_read_b64 v[58:59], v13 offset:0
    ds_read_b64 v[60:61], v14 offset:2560
    ds_read_b64 v[62:63], v13 offset:1024
    s_waitcnt lgkmcnt(8)
    v_mfma_f32_16x16x32_bf16 v[80:83], v[48:51], v[40:43], v[24:27]
    s_waitcnt lgkmcnt(6)
    v_mfma_f32_16x16x32_bf16 v[84:87], v[52:55], v[40:43], v[28:31]
    s_waitcnt lgkmcnt(2)
    v_mfma_f32_16x16x32_bf16 v[88:91], v[56:59], v[44:47], v[24:27]
    s_waitcnt lgkmcnt(0)
    v_mfma_f32_16x16x32_bf16 v[92:95], v[60:63], v[44:47], v[28:31]
    ds_read_b64_tr_b16 v[72:73], v20 offset:0
    ds_read_b64_tr_b16 v[74:75], v20 offset:1024
    ds_read_b64_tr_b16 v[76:77], v21 offset:0
    ds_read_b64_tr_b16 v[78:79], v21 offset:1024
    v_max3_f32 v116, v80, v81, v84
    v_max3_f32 v117, v82, v83, v86
    v_max_f32 v116, v116, v85
    v_max_f32 v117, v117, v87
    v_max3_f32 v118, v88, v89, v92
    v_max3_f32 v119, v90, v91, v94
    v_max_f32 v118, v118, v93
    v_max_f32 v119, v119, v95
    s_nop 0
    v_permlane16_swap_b32 v116, v118
    v_permlane16_swap_b32 v117, v119
    v_max3_f32 v130, v116, v117, v118
    v_max_f32 v130, v130, v119
    v_mov_b32 v131, v130
    s_nop 1
    v_permlane32_swap_b32 v130, v131
    v_max_f32 v130, v130, v131
    v_mul_f32 v130, s46, v130
    v_pk_fma_f32 v[116:117], v[116:117], s[46:47], v[130:131] op_sel_hi:[1,1,0] neg_lo:[0,0,1] neg_hi:[0,0,1]
    v_pk_fma_f32 v[118:119], v[118:119], s[46:47], v[130:131] op_sel_hi:[1,1,0] neg_lo:[0,0,1] neg_hi:[0,0,1]
    v_exp_f32 v116, v116
    v_exp_f32 v117, v117
    v_exp_f32 v118, v118
    v_exp_f32 v119, v119
    s_nop 0
    v_pk_add_f32 v[120:121], v[116:117], v[118:119]
    v_add_f32 v120, v120, v121
    v_mov_b32 v121, v120
    s_nop 1
    v_permlane32_swap_b32 v120, v121
    v_add_f32 v120, v120, v121
    v_rcp_f32 v120, v120
    s_waitcnt lgkmcnt(0)
    v_pk_mul_f32 v[116:117], v[116:117], v[120:121] op_sel_hi:[1,0]
    v_pk_mul_f32 v[118:119], v[118:119], v[120:121] op_sel_hi:[1,0]
    v_cvt_pk_bf16_f32 v128, v116, v117
    v_cvt_pk_bf16_f32 v129, v118, v119
    s_nop 1
    v_permlane16_swap_b32 v128, v129
    s_mov_b32 s3, 1048576
K_XG2:
    ds_read2_b32 v[2:3], v6 offset0:0 offset1:1
    s_sleep 1
    s_sub_u32 s3, s3, 1
    s_waitcnt lgkmcnt(0)
    v_min_u32 v2, v2, v3
    s_nop 0
    v_readfirstlane_b32 s33, v2
    s_nop 3
    s_cselect_b32 s33, 2, s33
    s_cmp_lt_u32 s33, 2
    s_cbranch_scc1 K_XG2
    ds_read_b64 v[64:65], v14 offset:1024
    ds_read_b64 v[66:67], v14 offset:3072
    ds_read_b64 v[68:69], v14 offset:1536
    ds_read_b64 v[70:71], v14 offset:3584
    v_perm_b32 v96, v128, v128, v36
    v_perm_b32 v97, v128, v128, v37
    v_perm_b32 v98, v128, v128, v38
    v_perm_b32 v99, v128, v128, v39
    v_perm_b32 v100, v129, v129, v36
    v_perm_b32 v101, v129, v129, v37
    s_waitcnt lgkmcnt(2)
    v_mfma_f32_16x16x32_bf16 v[104:107], v[64:67], v[96:99], 0
    v_perm_b32 v102, v129, v129, v38
    v_perm_b32 v103, v129, v129, v39
    v_mfma_f32_16x16x32_bf16 v[112:115], v[72:75], v[96:99], 0
    s_nop 0
    v_mfma_f32_16x16x32_bf16 v[112:115], v[76:79], v[100:103], v[112:115]
    s_waitcnt lgkmcnt(0)
    v_mfma_f32_16x16x32_bf16 v[108:111], v[68:71], v[100:103], 0
    s_nop 0
    v_cvt_pk_bf16_f32 v124, v104, v105
    v_cvt_pk_bf16_f32 v125, v106, v107
    s_nop 2
    v_cvt_pk_bf16_f32 v120, v112, v113
    v_cvt_pk_bf16_f32 v121, v114, v115
    v_cvt_pk_bf16_f32 v122, v112, v113
    v_cvt_pk_bf16_f32 v123, v114, v115
    v_cvt_pk_bf16_f32 v126, v108, v109
    v_cvt_pk_bf16_f32 v127, v110, v111
    v_permlane16_swap_b32 v120, v122
    v_permlane16_swap_b32 v121, v123
    buffer_store_dwordx4 v[124:127], v15, s[20:23], s50 offen sc1
    buffer_store_dwordx4 v[120:123], v16, s[20:23], s50 offen sc1
    s_cmp_eq_u32 s34, -1
    s_cbranch_scc1 K_DRAIN
    s_cmp_lg_u32 s30, 6
    s_cbranch_scc1 K_NOFL
    s_waitcnt vmcnt(2)
    v_and_b32 v4, 7, v1
    v_lshlrev_b32 v4, 2, v4
    s_mov_b32 s3, 131072
K_ZPOLL2:
    v_cmp_eq_u32 vcc, 0, v7
    s_cbranch_vccz K_ZOK2
    s_sub_u32 s3, s3, 1
    s_cbranch_scc1 K_ZOK2
    global_load_dword v7, v4, s[8:9] offset:192 sc1
    s_waitcnt vmcnt(0)
    s_branch K_ZPOLL2
K_ZOK2:
    v_and_b32 v2, 1, v1
    v_lshl_add_u32 v2, v2, 2, s42
    global_load_dword v7, v2, s[10:11] offset:128 sc1
K_NOFL:
    v_mov_b32 v4, 158720
    v_mov_b32 v3, 257
    s_mov_b64 exec, 1
    s_waitcnt vmcnt(0)
    ds_add_rtn_u32 v2, v4, v3 offset:48
    s_mov_b32 exec_lo, s36
    v_mov_b32 v3, 1
    s_waitcnt lgkmcnt(0)
    v_readfirstlane_b32 s33, v2
    s_nop 3
    s_and_b32 s33, s33, 0xff
    s_cmp_lg_u32 s33, 7
    s_cbranch_scc1 K_ARRS
    global_store_dword v8, v3, s[10:11] sc1
K_ARRS:
    s_mov_b64 exec, -1
    s_cmp_ge_u32 s30, 6
    s_cbranch_scc1 K_P2_HELP
    s_branch K_LATE
WP_early:
    s_setpc_b64 s[38:39]
K_P2_EARLY:
    s_lshl_b32 s54, s40, 7
    v_lshrrev_b32 v9, 4, v1
    v_mov_b32 v12, 158720
    s_add_u32 s20, s10, 0x100000
    s_addc_u32 s21, s11, 0
    s_mov_b32 s22, 0x280000
    s_mov_b32 s23, 0x20000
    s_add_u32 s16, s10, 0x1000
    s_addc_u32 s17, s11, 0
    s_mov_b32 s18, 0x2000
    s_mov_b32 s19, 0x20000
    s_mov_b32 s48, s6
    s_mov_b32 s49, s7
    s_mov_b32 s50, 0x280000
    s_mov_b32 s51, 0x20000
    s_lshl_b32 s53, s40, 3
    s_lshl1_add_u32 s53, s30, s53
    s_mov_b32 s55, 20480
    v_bfe_u32 v20, v1, 2, 2
    v_and_b32 v21, 3, v1
    s_mul_i32 s3, s53, 20480
    v_lshl_add_u32 v25, v1, 4, s3
    v_add_u32 v26, 20480, v25
    v_add_u32 v35, 16384, v25
    v_add_u32 v36, 16384, v26
    v_and_b32 v2, 15, v1
    s_lshl_b32 s3, s53, 6
    v_lshl_add_u32 v23, v2, 2, s3
    v_lshl_add_u32 v2, v9, 2, v20
    v_bfe_u32 v3, v2, 1, 2
    v_lshlrev_b32 v2, 7, v2
    v_lshl_add_u32 v2, v21, 3, v2
    v_lshl_add_u32 v24, v3, 5, v2
    v_lshrrev_b32 v3, 1, v20
    v_mul_u32_u24 v2, 40, v9
    v_add3_u32 v2, v2, 16, v20
    v_lshlrev_b32 v2, 7, v2
    v_lshl_add_u32 v2, v21, 3, v2
    v_xor_b32 v4, 0, v3
    v_lshl_add_u32 v60, v4, 5, v2
    v_xor_b32 v4, 1, v3
    v_lshl_add_u32 v61, v4, 5, v2
    v_xor_b32 v4, 2, v3
    v_lshl_add_u32 v62, v4, 5, v2
    v_xor_b32 v4, 3, v3
    v_lshl_add_u32 v63, v4, 5, v2
    v_lshrrev_b32 v3, 4, v1
    v_and_b32 v4, 7, v1
    v_lshrrev_b32 v2, 3, v1
    v_xor_b32 v4, v4, v3
    v_mul_u32_u24 v2, 1280, v2
    v_lshl_add_u32 v27, v4, 4, v2
    v_xor_b32 v28, 64, v27
    s_lshl_b32 s71, s40, 3
    s_lshl1_add_u32 s71, s30, s71
    s_mul_i32 s71, s71, 20480
    s_lshl_b32 s33, s41, 7
    s_add_u32 s71, s71, s33
    s_add_u32 s72, s71, 10240
    s_add_u32 s73, s71, 20480
    s_add_u32 s74, s71, 30720
    s_lshl_b32 s3, s30, 12
    s_add_u32 s3, s3, 140288
    v_lshl_add_u32 v33, v1, 4, s3
    v_and_b32 v2, 15, v1
    v_lshrrev_b32 v3, 1, v2
    v_lshrrev_b32 v4, 5, v1
    v_xor_b32 v3, v3, v4
    v_lshlrev_b32 v3, 4, v3
    v_lshl_add_u32 v3, v2, 7, v3
    v_and_b32 v4, 1, v9
    v_lshl_add_u32 v3, v4, 3, v3
    v_add_u32 v29, s3, v3
    v_xor_b32 v30, 32, v29
    v_xor_b32 v31, 64, v29
    v_xor_b32 v32, 96, v29
    s_and_b32 s33, s40, 3
    s_lshl_b32 s33, s33, 3
    s_lshr_b32 s33, 0x7f06037f, s33
    s_and_b32 s33, s33, 0xff
    s_lshl_b32 s3, s30, 1
    s_cmp_ge_u32 s3, s33
    s_cselect_b32 s64, 16, 0
    s_add_u32 s3, s3, 1
    s_cmp_ge_u32 s3, s33
    s_cselect_b32 s65, 16, 0
    s_mov_b32 s63, 0
    s_mov_b32 s66, 0
    s_mov_b32 s67, 16384
    v_mov_b32 v34, 0
    v_mov_b32 v4, 158720
    v_mov_b32 v3, 1
    s_mov_b64 exec, 1
    s_waitcnt vmcnt(0)
    ds_add_rtn_u32 v2, v4, v3 offset:48
    s_mov_b32 exec_lo, s36
    v_mov_b32 v3, 1
    s_waitcnt lgkmcnt(0)
    v_readfirstlane_b32 s33, v2
    s_nop 3
    s_and_b32 s33, s33, 0xff
    s_cmp_lg_u32 s33, 7
    s_cbranch_scc1 K_ARRD
    global_store_dword v8, v3, s[10:11] sc1
K_ARRD:
    s_mov_b64 exec, -1
    s_mov_b32 s3, 1048576
K_P2_GE:
    ds_read_b32 v2, v12 offset:48
    s_sub_u32 s3, s3, 1
    s_waitcnt lgkmcnt(0)
    v_readfirstlane_b32 s33, v2
    s_nop 3
    s_cselect_b32 s33, 1024, s33
    s_cmp_lt_u32 s33, 1024
    s_cbranch_scc1 K_P2_GE
K_P2_GEMM:
    s_setprio 0
    s_mov_b32 s3, 1048576
K_P2_GS:
    ds_read_b32 v2, v12 offset:40
    s_sub_u32 s3, s3, 1
    s_waitcnt lgkmcnt(0)
    v_readfirstlane_b32 s33, v2
    s_nop 3
    s_cselect_b32 s33, 1, s33
    s_cmp_lt_u32 s33, 1
    s_cbranch_scc1 K_P2_GS
    buffer_load_dword v64, v23, s[16:19], 0 offen offset:0 sc1
    buffer_load_dword v66, v23, s[16:19], 0 offen offset:64 sc1
    ds_read_b128 v[16:19], v12
    ds_read_b64 v[40:41], v29 offset:0
    ds_read_b64 v[42:43], v30 offset:0
    ds_read_b64 v[44:45], v31 offset:0
    ds_read_b64 v[46:47], v32 offset:0
    ds_read_b64 v[48:49], v29 offset:2048
    ds_read_b64 v[50:51], v30 offset:2048
    ds_read_b64 v[52:53], v31 offset:2048
    ds_read_b64 v[54:55], v32 offset:2048
    s_waitcnt lgkmcnt(4)
    v_lshlrev_b32 v72, 16, v40
    v_and_b32 v73, 0xffff0000, v40
    v_lshlrev_b32 v74, 16, v41
    v_and_b32 v75, 0xffff0000, v41
    v_lshlrev_b32 v76, 16, v42
    v_and_b32 v77, 0xffff0000, v42
    v_lshlrev_b32 v78, 16, v43
    v_and_b32 v79, 0xffff0000, v43
    v_lshlrev_b32 v80, 16, v44
    v_and_b32 v81, 0xffff0000, v44
    v_lshlrev_b32 v82, 16, v45
    v_and_b32 v83, 0xffff0000, v45
    v_lshlrev_b32 v84, 16, v46
    v_and_b32 v85, 0xffff0000, v46
    v_lshlrev_b32 v86, 16, v47
    v_and_b32 v87, 0xffff0000, v47
    s_waitcnt lgkmcnt(0)
    v_lshlrev_b32 v88, 16, v48
    v_and_b32 v89, 0xffff0000, v48
    v_lshlrev_b32 v90, 16, v49
    v_and_b32 v91, 0xffff0000, v49
    v_lshlrev_b32 v92, 16, v50
    v_and_b32 v93, 0xffff0000, v50
    v_lshlrev_b32 v94, 16, v51
    v_and_b32 v95, 0xffff0000, v51
    v_lshlrev_b32 v96, 16, v52
    v_and_b32 v97, 0xffff0000, v52
    v_lshlrev_b32 v98, 16, v53
    v_and_b32 v99, 0xffff0000, v53
    v_lshlrev_b32 v100, 16, v54
    v_and_b32 v101, 0xffff0000, v54
    v_lshlrev_b32 v102, 16, v55
    v_and_b32 v103, 0xffff0000, v55
    s_cmp_eq_u32 s63, 0
    s_cbranch_scc1 K_SP0
K_SPR0:
    s_ff1_i32_b32 s33, s63
    s_bitset0_b32 s63, s33
    s_lshl_b32 s75, s33, 10
    buffer_load_dwordx4 v[104:107], v25, s[20:23], s75 offen offset:0 sc1
    buffer_load_dwordx4 v[108:111], v26, s[20:23], s75 offen offset:0 sc1
    v_mad_u32_u24 v56, s75, 5, v24
    v_xor_b32 v58, 64, v56
    v_xor_b32 v57, 32, v56
    v_xor_b32 v59, 96, v56
    ds_read_b64_tr_b16 v[184:185], v56 offset:0
    ds_read_b64_tr_b16 v[186:187], v58 offset:2560
    ds_read_b64_tr_b16 v[188:189], v57 offset:0
    ds_read_b64_tr_b16 v[190:191], v59 offset:2560
    ds_read_b64_tr_b16 v[192:193], v58 offset:0
    ds_read_b64_tr_b16 v[194:195], v56 offset:2560
    ds_read_b64_tr_b16 v[196:197], v59 offset:0
    ds_read_b64_tr_b16 v[198:199], v57 offset:2560
    s_cmp_eq_u32 s63, 0
    s_cbranch_scc1 K_SP1
K_SPR1:
    s_ff1_i32_b32 s33, s63
    s_bitset0_b32 s63, s33
    s_lshl_b32 s76, s33, 10
    buffer_load_dwordx4 v[112:115], v25, s[20:23], s76 offen offset:0 sc1
    buffer_load_dwordx4 v[116:119], v26, s[20:23], s76 offen offset:0 sc1
    v_mad_u32_u24 v56, s76, 5, v24
    v_xor_b32 v58, 64, v56
    v_xor_b32 v57, 32, v56
    v_xor_b32 v59, 96, v56
    ds_read_b64_tr_b16 v[200:201], v56 offset:0
    ds_read_b64_tr_b16 v[202:203], v58 offset:2560
    ds_read_b64_tr_b16 v[204:205], v57 offset:0
    ds_read_b64_tr_b16 v[206:207], v59 offset:2560
    ds_read_b64_tr_b16 v[208:209], v58 offset:0
    ds_read_b64_tr_b16 v[210:211], v56 offset:2560
    ds_read_b64_tr_b16 v[212:213], v59 offset:0
    ds_read_b64_tr_b16 v[214:215], v57 offset:2560
    s_waitcnt vmcnt(4)
    s_mov_b64 exec, 1
    ds_add_u32 v12, v34 offset:44
    s_mov_b64 exec, -1
    v_sub_f32 v68, 1.0, v64
    v_cvt_pk_bf16_f32 v68, v68, v68
    v_lshlrev_b32 v68, 16, v68
    v_sub_f32 v70, 1.0, v66
    v_cvt_pk_bf16_f32 v70, v70, v70
    v_lshlrev_b32 v70, 16, v70
    v_pk_mul_f32 v[72:73], v[72:73], v[68:69] op_sel_hi:[1,0]
    v_pk_mul_f32 v[74:75], v[74:75], v[68:69] op_sel_hi:[1,0]
    v_pk_mul_f32 v[76:77], v[76:77], v[68:69] op_sel_hi:[1,0]
    v_pk_mul_f32 v[78:79], v[78:79], v[68:69] op_sel_hi:[1,0]
    v_pk_mul_f32 v[80:81], v[80:81], v[68:69] op_sel_hi:[1,0]
    v_pk_mul_f32 v[82:83], v[82:83], v[68:69] op_sel_hi:[1,0]
    v_pk_mul_f32 v[84:85], v[84:85], v[68:69] op_sel_hi:[1,0]
    v_pk_mul_f32 v[86:87], v[86:87], v[68:69] op_sel_hi:[1,0]
    v_pk_mul_f32 v[88:89], v[88:89], v[70:71] op_sel_hi:[1,0]
    v_pk_mul_f32 v[90:91], v[90:91], v[70:71] op_sel_hi:[1,0]
    v_pk_mul_f32 v[92:93], v[92:93], v[70:71] op_sel_hi:[1,0]
    v_pk_mul_f32 v[94:95], v[94:95], v[70:71] op_sel_hi:[1,0]
    v_pk_mul_f32 v[96:97], v[96:97], v[70:71] op_sel_hi:[1,0]
    v_pk_mul_f32 v[98:99], v[98:99], v[70:71] op_sel_hi:[1,0]
    v_pk_mul_f32 v[100:101], v[100:101], v[70:71] op_sel_hi:[1,0]
    v_pk_mul_f32 v[102:103], v[102:103], v[70:71] op_sel_hi:[1,0]
    s_cmp_eq_u32 s63, 0
    s_cbranch_scc1 K_SP2
K_SPR2:
    s_ff1_i32_b32 s33, s63
    s_bitset0_b32 s63, s33
    s_lshl_b32 s77, s33, 10
    buffer_load_dwordx4 v[120:123], v25, s[20:23], s77 offen offset:0 sc1
    buffer_load_dwordx4 v[124:127], v26, s[20:23], s77 offen offset:0 sc1
    s_cmp_eq_u32 s63, 0
    s_cbranch_scc1 K_SP3
K_SPR3:
    s_ff1_i32_b32 s33, s63
    s_bitset0_b32 s63, s33
    s_lshl_b32 s78, s33, 10
    buffer_load_dwordx4 v[128:131], v25, s[20:23], s78 offen offset:0 sc1
    buffer_load_dwordx4 v[132:135], v26, s[20:23], s78 offen offset:0 sc1
    s_cmp_eq_u32 s63, 0
    s_cbranch_scc1 K_SP4
K_SPR4:
    s_ff1_i32_b32 s33, s63
    s_bitset0_b32 s63, s33
    s_lshl_b32 s75, s33, 10
    buffer_load_dwordx4 v[136:139], v25, s[20:23], s75 offen offset:0 sc1
    buffer_load_dwordx4 v[140:143], v26, s[20:23], s75 offen offset:0 sc1
    s_branch WS_p2g
.p2align 12
WP_p2g:
    s_setpc_b64 s[38:39]
WS_p2g:
    s_waitcnt vmcnt(8) lgkmcnt(9)
    v_mfma_f32_16x16x32_bf16 v[152:155], v[184:187], v[104:107], 0
    v_mad_u32_u24 v56, s77, 5, v24
    v_xor_b32 v58, 64, v56
    v_xor_b32 v57, 32, v56
    v_mfma_f32_16x16x32_bf16 v[168:171], v[184:187], v[108:111], 0
    v_xor_b32 v59, 96, v56
    ds_read_b64_tr_b16 v[216:217], v56 offset:0
    ds_read_b64_tr_b16 v[218:219], v58 offset:2560
    v_mfma_f32_16x16x32_bf16 v[156:159], v[188:191], v[104:107], 0
    ds_read_b64_tr_b16 v[220:221], v57 offset:0
    ds_read_b64_tr_b16 v[222:223], v59 offset:2560
    ds_read_b64_tr_b16 v[224:225], v58 offset:0
    v_mfma_f32_16x16x32_bf16 v[172:175], v[188:191], v[108:111], 0
    ds_read_b64_tr_b16 v[226:227], v56 offset:2560
    ds_read_b64_tr_b16 v[228:229], v59 offset:0
    v_mfma_f32_16x16x32_bf16 v[160:163], v[192:195], v[104:107], 0
    ds_read_b64_tr_b16 v[230:231], v57 offset:2560
    s_cmp_eq_u32 s63, 0
    v_mfma_f32_16x16x32_bf16 v[176:179], v[192:195], v[108:111], 0
    s_cbranch_scc1 K_SP5
K_SPR5:
    s_ff1_i32_b32 s33, s63
    v_mfma_f32_16x16x32_bf16 v[164:167], v[196:199], v[104:107], 0
    s_bitset0_b32 s63, s33
    s_lshl_b32 s76, s33, 10
    v_mfma_f32_16x16x32_bf16 v[180:183], v[196:199], v[108:111], 0
    buffer_load_dwordx4 v[144:147], v25, s[20:23], s76 offen offset:0 sc1
    buffer_load_dwordx4 v[148:151], v26, s[20:23], s76 offen offset:0 sc1
    s_waitcnt vmcnt(8) lgkmcnt(9)
    v_mfma_f32_16x16x32_bf16 v[152:155], v[200:203], v[112:115], v[152:155]
    v_mad_u32_u24 v56, s78, 5, v24
    v_xor_b32 v58, 64, v56
    v_xor_b32 v57, 32, v56
    v_mfma_f32_16x16x32_bf16 v[168:171], v[200:203], v[116:119], v[168:171]
    v_xor_b32 v59, 96, v56
    ds_read_b64_tr_b16 v[184:185], v56 offset:0
    ds_read_b64_tr_b16 v[186:187], v58 offset:2560
    v_mfma_f32_16x16x32_bf16 v[156:159], v[204:207], v[112:115], v[156:159]
    ds_read_b64_tr_b16 v[188:189], v57 offset:0
    ds_read_b64_tr_b16 v[190:191], v59 offset:2560
    ds_read_b64_tr_b16 v[192:193], v58 offset:0
    v_mfma_f32_16x16x32_bf16 v[172:175], v[204:207], v[116:119], v[172:175]
    ds_read_b64_tr_b16 v[194:195], v56 offset:2560
    ds_read_b64_tr_b16 v[196:197], v59 offset:0
    v_mfma_f32_16x16x32_bf16 v[160:163], v[208:211], v[112:115], v[160:163]
    ds_read_b64_tr_b16 v[198:199], v57 offset:2560
    s_cmp_eq_u32 s63, 0
    v_mfma_f32_16x16x32_bf16 v[176:179], v[208:211], v[116:119], v[176:179]
    s_cbranch_scc1 K_SP6
K_SPR6:
    s_ff1_i32_b32 s33, s63
    v_mfma_f32_16x16x32_bf16 v[164:167], v[212:215], v[112:115], v[164:167]
    s_bitset0_b32 s63, s33
    s_lshl_b32 s77, s33, 10
    v_mfma_f32_16x16x32_bf16 v[180:183], v[212:215], v[116:119], v[180:183]
    buffer_load_dwordx4 v[104:107], v25, s[20:23], s77 offen offset:0 sc1
    buffer_load_dwordx4 v[108:111], v26, s[20:23], s77 offen offset:0 sc1
    s_waitcnt vmcnt(8) lgkmcnt(8)
    v_mfma_f32_16x16x32_bf16 v[152:155], v[216:219], v[120:123], v[152:155]
    v_mad_u32_u24 v56, s75, 5, v24
    v_xor_b32 v58, 64, v56
    v_xor_b32 v57, 32, v56
    v_mfma_f32_16x16x32_bf16 v[168:171], v[216:219], v[124:127], v[168:171]
    v_xor_b32 v59, 96, v56
    ds_read_b64_tr_b16 v[200:201], v56 offset:0
    ds_read_b64_tr_b16 v[202:203], v58 offset:2560
    v_mfma_f32_16x16x32_bf16 v[156:159], v[220:223], v[120:123], v[156:159]
    ds_read_b64_tr_b16 v[204:205], v57 offset:0
    ds_read_b64_tr_b16 v[206:207], v59 offset:2560
    ds_read_b64_tr_b16 v[208:209], v58 offset:0
    v_mfma_f32_16x16x32_bf16 v[172:175], v[220:223], v[124:127], v[172:175]
    ds_read_b64_tr_b16 v[210:211], v56 offset:2560
    ds_read_b64_tr_b16 v[212:213], v59 offset:0
    v_mfma_f32_16x16x32_bf16 v[160:163], v[224:227], v[120:123], v[160:163]
    ds_read_b64_tr_b16 v[214:215], v57 offset:2560
    s_andn2_b32 s33, s66, s63
    v_mfma_f32_16x16x32_bf16 v[176:179], v[224:227], v[124:127], v[176:179]
    s_bfe_u32 s33, s33, 0x40000
    s_cmp_eq_u32 s33, 15
    v_mfma_f32_16x16x32_bf16 v[164:167], v[228:231], v[120:123], v[164:167]
    s_cselect_b32 s78, 0, 1024
    s_xor_b32 s69, s78, 1024
    v_mfma_f32_16x16x32_bf16 v[180:183], v[228:231], v[124:127], v[180:183]
    buffer_load_dwordx4 v[112:115], v35, s[20:23], s78 offen offset:0 sc1
    buffer_load_dwordx4 v[116:119], v36, s[20:23], s78 offen offset:0 sc1
    s_waitcnt vmcnt(8) lgkmcnt(8)
    v_mfma_f32_16x16x32_bf16 v[152:155], v[184:187], v[128:131], v[152:155]
    v_mad_u32_u24 v56, s76, 5, v24
    v_xor_b32 v58, 64, v56
    v_xor_b32 v57, 32, v56
    v_mfma_f32_16x16x32_bf16 v[168:171], v[184:187], v[132:135], v[168:171]
    v_xor_b32 v59, 96, v56
    ds_read_b64_tr_b16 v[216:217], v56 offset:0
    ds_read_b64_tr_b16 v[218:219], v58 offset:2560
    v_mfma_f32_16x16x32_bf16 v[156:159], v[188:191], v[128:131], v[156:159]
    ds_read_b64_tr_b16 v[220:221], v57 offset:0
    ds_read_b64_tr_b16 v[222:223], v59 offset:2560
    ds_read_b64_tr_b16 v[224:225], v58 offset:0
    v_mfma_f32_16x16x32_bf16 v[172:175], v[188:191], v[132:135], v[172:175]
    ds_read_b64_tr_b16 v[226:227], v56 offset:2560
    ds_read_b64_tr_b16 v[228:229], v59 offset:0
    v_mfma_f32_16x16x32_bf16 v[160:163], v[192:195], v[128:131], v[160:163]
    ds_read_b64_tr_b16 v[230:231], v57 offset:2560
    s_cmp_eq_u32 s63, 0
    v_mfma_f32_16x16x32_bf16 v[176:179], v[192:195], v[132:135], v[176:179]
    s_cbranch_scc1 K_SP8
K_SPR8:
    s_ff1_i32_b32 s33, s63
    v_mfma_f32_16x16x32_bf16 v[164:167], v[196:199], v[128:131], v[164:167]
    s_bitset0_b32 s63, s33
    s_lshl_b32 s75, s33, 10
    v_mfma_f32_16x16x32_bf16 v[180:183], v[196:199], v[132:135], v[180:183]
    buffer_load_dwordx4 v[120:123], v25, s[20:23], s75 offen offset:0 sc1
    buffer_load_dwordx4 v[124:127], v26, s[20:23], s75 offen offset:0 sc1
    s_waitcnt vmcnt(8) lgkmcnt(8)
    v_mfma_f32_16x16x32_bf16 v[152:155], v[200:203], v[136:139], v[152:155]
    v_mad_u32_u24 v56, s77, 5, v24
    v_xor_b32 v58, 64, v56
    v_mfma_f32_16x16x32_bf16 v[168:171], v[200:203], v[140:143], v[168:171]
    v_xor_b32 v57, 32, v56
    v_xor_b32 v59, 96, v56
    v_mfma_f32_16x16x32_bf16 v[156:159], v[204:207], v[136:139], v[156:159]
    ds_read_b64_tr_b16 v[184:185], v56 offset:0
    ds_read_b64_tr_b16 v[186:187], v58 offset:2560
    v_mfma_f32_16x16x32_bf16 v[172:175], v[204:207], v[140:143], v[172:175]
    ds_read_b64_tr_b16 v[188:189], v57 offset:0
    ds_read_b64_tr_b16 v[190:191], v59 offset:2560
    v_mfma_f32_16x16x32_bf16 v[160:163], v[208:211], v[136:139], v[160:163]
    ds_read_b64_tr_b16 v[192:193], v58 offset:0
    ds_read_b64_tr_b16 v[194:195], v56 offset:2560
    v_mfma_f32_16x16x32_bf16 v[176:179], v[208:211], v[140:143], v[176:179]
    ds_read_b64_tr_b16 v[196:197], v59 offset:0
    ds_read_b64_tr_b16 v[198:199], v57 offset:2560
    v_mfma_f32_16x16x32_bf16 v[164:167], v[212:215], v[136:139], v[164:167]
    buffer_load_dwordx4 v[128:131], v35, s[20:23], s69 offen offset:0 sc1
    buffer_load_dwordx4 v[132:135], v36, s[20:23], s69 offen offset:0 sc1
    v_mfma_f32_16x16x32_bf16 v[180:183], v[212:215], v[140:143], v[180:183]
    s_waitcnt vmcnt(8) lgkmcnt(8)
    v_mfma_f32_16x16x32_bf16 v[152:155], v[216:219], v[144:147], v[152:155]
    v_mad_u32_u24 v56, s78, 20, v60
    v_xor_b32 v58, 64, v56
    v_xor_b32 v57, 32, v56
    v_mfma_f32_16x16x32_bf16 v[168:171], v[216:219], v[148:151], v[168:171]
    v_xor_b32 v59, 96, v56
    ds_read_b64_tr_b16 v[200:201], v56 offset:0
    ds_read_b64_tr_b16 v[202:203], v58 offset:2560
    v_mfma_f32_16x16x32_bf16 v[156:159], v[220:223], v[144:147], v[156:159]
    ds_read_b64_tr_b16 v[204:205], v57 offset:0
    ds_read_b64_tr_b16 v[206:207], v59 offset:2560
    ds_read_b64_tr_b16 v[208:209], v58 offset:0
    v_mfma_f32_16x16x32_bf16 v[172:175], v[220:223], v[148:151], v[172:175]
    ds_read_b64_tr_b16 v[210:211], v56 offset:2560
    ds_read_b64_tr_b16 v[212:213], v59 offset:0
    v_mfma_f32_16x16x32_bf16 v[160:163], v[224:227], v[144:147], v[160:163]
    ds_read_b64_tr_b16 v[214:215], v57 offset:2560
    s_cmp_eq_u32 s63, 0
    v_mfma_f32_16x16x32_bf16 v[176:179], v[224:227], v[148:151], v[176:179]
    s_cbranch_scc1 K_SP10
K_SPR10:
    s_ff1_i32_b32 s33, s63
    v_mfma_f32_16x16x32_bf16 v[164:167], v[228:231], v[144:147], v[164:167]
    s_bitset0_b32 s63, s33
    s_lshl_b32 s77, s33, 10
    v_mfma_f32_16x16x32_bf16 v[180:183], v[228:231], v[148:151], v[180:183]
    buffer_load_dwordx4 v[136:139], v25, s[20:23], s77 offen offset:0 sc1
    buffer_load_dwordx4 v[140:143], v26, s[20:23], s77 offen offset:0 sc1
    s_waitcnt vmcnt(8) lgkmcnt(8)
    v_mfma_f32_16x16x32_bf16 v[152:155], v[184:187], v[104:107], v[152:155]
    v_mad_u32_u24 v56, s75, 5, v24
    v_xor_b32 v58, 64, v56
    v_xor_b32 v57, 32, v56
    v_mfma_f32_16x16x32_bf16 v[168:171], v[184:187], v[108:111], v[168:171]
    v_xor_b32 v59, 96, v56
    ds_read_b64_tr_b16 v[216:217], v56 offset:0
    ds_read_b64_tr_b16 v[218:219], v58 offset:2560
    v_mfma_f32_16x16x32_bf16 v[156:159], v[188:191], v[104:107], v[156:159]
    ds_read_b64_tr_b16 v[220:221], v57 offset:0
    ds_read_b64_tr_b16 v[222:223], v59 offset:2560
    ds_read_b64_tr_b16 v[224:225], v58 offset:0
    v_mfma_f32_16x16x32_bf16 v[172:175], v[188:191], v[108:111], v[172:175]
    ds_read_b64_tr_b16 v[226:227], v56 offset:2560
    ds_read_b64_tr_b16 v[228:229], v59 offset:0
    v_mfma_f32_16x16x32_bf16 v[160:163], v[192:195], v[104:107], v[160:163]
    ds_read_b64_tr_b16 v[230:231], v57 offset:2560
    s_cmp_eq_u32 s63, 0
    v_mfma_f32_16x16x32_bf16 v[176:179], v[192:195], v[108:111], v[176:179]
    s_cbranch_scc1 K_SP11
K_SPR11:
    s_ff1_i32_b32 s33, s63
    v_mfma_f32_16x16x32_bf16 v[164:167], v[196:199], v[104:107], v[164:167]
    s_bitset0_b32 s63, s33
    s_lshl_b32 s78, s33, 10
    v_mfma_f32_16x16x32_bf16 v[180:183], v[196:199], v[108:111], v[180:183]
    buffer_load_dwordx4 v[144:147], v25, s[20:23], s78 offen offset:0 sc1
    buffer_load_dwordx4 v[148:151], v26, s[20:23], s78 offen offset:0 sc1
    s_waitcnt vmcnt(8) lgkmcnt(8)
    v_mfma_f32_16x16x32_bf16 v[152:155], v[200:203], v[112:115], v[152:155]
    v_mad_u32_u24 v56, s69, 20, v60
    v_xor_b32 v58, 64, v56
    v_xor_b32 v57, 32, v56
    v_mfma_f32_16x16x32_bf16 v[168:171], v[200:203], v[116:119], v[168:171]
    v_xor_b32 v59, 96, v56
    ds_read_b64_tr_b16 v[184:185], v56 offset:0
    ds_read_b64_tr_b16 v[186:187], v58 offset:2560
    v_mfma_f32_16x16x32_bf16 v[156:159], v[204:207], v[112:115], v[156:159]
    ds_read_b64_tr_b16 v[188:189], v57 offset:0
    ds_read_b64_tr_b16 v[190:191], v59 offset:2560
    ds_read_b64_tr_b16 v[192:193], v58 offset:0
    v_mfma_f32_16x16x32_bf16 v[172:175], v[204:207], v[116:119], v[172:175]
    ds_read_b64_tr_b16 v[194:195], v56 offset:2560
    ds_read_b64_tr_b16 v[196:197], v59 offset:0
    v_mfma_f32_16x16x32_bf16 v[160:163], v[208:211], v[112:115], v[160:163]
    ds_read_b64_tr_b16 v[198:199], v57 offset:2560
    s_cmp_eq_u32 s63, 0
    v_mfma_f32_16x16x32_bf16 v[176:179], v[208:211], v[116:119], v[176:179]
    s_cbranch_scc1 K_SP12
K_SPR12:
    s_ff1_i32_b32 s33, s63
    v_mfma_f32_16x16x32_bf16 v[164:167], v[212:215], v[112:115], v[164:167]
    s_bitset0_b32 s63, s33
    s_lshl_b32 s75, s33, 10
    v_mfma_f32_16x16x32_bf16 v[180:183], v[212:215], v[116:119], v[180:183]
    buffer_load_dwordx4 v[104:107], v25, s[20:23], s75 offen offset:0 sc1
    buffer_load_dwordx4 v[108:111], v26, s[20:23], s75 offen offset:0 sc1
    s_mov_b32 s3, 1048576
K_P2_GW:
    ds_read_b32 v2, v12 offset:44
    s_sub_u32 s3, s3, 1
    s_waitcnt lgkmcnt(0)
    v_readfirstlane_b32 s33, v2
    s_nop 3
    s_cselect_b32 s33, 4, s33
    s_cmp_lt_u32 s33, 4
    s_cbranch_scc1 K_P2_GW
    v_readfirstlane_b32 s56, v16
    v_readfirstlane_b32 s57, v17
    s_lshl_b32 s58, s53, 4
    s_waitcnt vmcnt(8)
    v_mfma_f32_16x16x32_bf16 v[152:155], v[216:219], v[120:123], v[152:155]
    v_mad_u32_u24 v56, s77, 5, v24
    v_xor_b32 v58, 64, v56
    v_xor_b32 v57, 32, v56
    v_mfma_f32_16x16x32_bf16 v[168:171], v[216:219], v[124:127], v[168:171]
    v_xor_b32 v59, 96, v56
    ds_read_b64_tr_b16 v[200:201], v56 offset:0
    ds_read_b64_tr_b16 v[202:203], v58 offset:2560
    v_mfma_f32_16x16x32_bf16 v[156:159], v[220:223], v[120:123], v[156:159]
    ds_read_b64_tr_b16 v[204:205], v57 offset:0
    ds_read_b64_tr_b16 v[206:207], v59 offset:2560
    ds_read_b64_tr_b16 v[208:209], v58 offset:0
    v_mfma_f32_16x16x32_bf16 v[172:175], v[220:223], v[124:127], v[172:175]
    ds_read_b64_tr_b16 v[210:211], v56 offset:2560
    ds_read_b64_tr_b16 v[212:213], v59 offset:0
    v_mfma_f32_16x16x32_bf16 v[160:163], v[224:227], v[120:123], v[160:163]
    ds_read_b64_tr_b16 v[214:215], v57 offset:2560
    s_cmp_eq_u32 s63, 0
    v_mfma_f32_16x16x32_bf16 v[176:179], v[224:227], v[124:127], v[176:179]
    s_cbranch_scc1 K_SP13
K_SPR13:
    s_ff1_i32_b32 s33, s63
    v_mfma_f32_16x16x32_bf16 v[164:167], v[228:231], v[120:123], v[164:167]
    s_bitset0_b32 s63, s33
    s_lshl_b32 s76, s33, 10
    v_mfma_f32_16x16x32_bf16 v[180:183], v[228:231], v[124:127], v[180:183]
    buffer_load_dwordx4 v[112:115], v25, s[20:23], s76 offen offset:0 sc1
    buffer_load_dwordx4 v[116:119], v26, s[20:23], s76 offen offset:0 sc1
    s_waitcnt vmcnt(8)
    v_mfma_f32_16x16x32_bf16 v[152:155], v[184:187], v[128:131], v[152:155]
    v_mad_u32_u24 v56, s78, 5, v24
    v_xor_b32 v58, 64, v56
    v_xor_b32 v57, 32, v56
    v_mfma_f32_16x16x32_bf16 v[168:171], v[184:187], v[132:135], v[168:171]
    v_xor_b32 v59, 96, v56
    ds_read_b64_tr_b16 v[216:217], v56 offset:0
    ds_read_b64_tr_b16 v[218:219], v58 offset:2560
    v_mfma_f32_16x16x32_bf16 v[156:159], v[188:191], v[128:131], v[156:159]
    ds_read_b64_tr_b16 v[220:221], v57 offset:0
    ds_read_b64_tr_b16 v[222:223], v59 offset:2560
    ds_read_b64_tr_b16 v[224:225], v58 offset:0
    v_mfma_f32_16x16x32_bf16 v[172:175], v[188:191], v[132:135], v[172:175]
    ds_read_b64_tr_b16 v[226:227], v56 offset:2560
    ds_read_b64_tr_b16 v[228:229], v59 offset:0
    v_mfma_f32_16x16x32_bf16 v[160:163], v[192:195], v[128:131], v[160:163]
    ds_read_b64_tr_b16 v[230:231], v57 offset:2560
    s_cmp_eq_u32 s63, 0
    v_mfma_f32_16x16x32_bf16 v[176:179], v[192:195], v[132:135], v[176:179]
    s_cbranch_scc1 K_SP14
K_SPR14:
    s_ff1_i32_b32 s33, s63
    v_mfma_f32_16x16x32_bf16 v[164:167], v[196:199], v[128:131], v[164:167]
    s_bitset0_b32 s63, s33
    s_lshl_b32 s77, s33, 10
    v_mfma_f32_16x16x32_bf16 v[180:183], v[196:199], v[132:135], v[180:183]
    buffer_load_dwordx4 v[120:123], v25, s[20:23], s77 offen offset:0 sc1
    buffer_load_dwordx4 v[124:127], v26, s[20:23], s77 offen offset:0 sc1
    s_waitcnt vmcnt(8) lgkmcnt(8)
    v_mfma_f32_16x16x32_bf16 v[152:155], v[200:203], v[136:139], v[152:155]
    v_mad_u32_u24 v56, s75, 5, v24
    v_xor_b32 v58, 64, v56
    v_xor_b32 v57, 32, v56
    v_mfma_f32_16x16x32_bf16 v[168:171], v[200:203], v[140:143], v[168:171]
    v_xor_b32 v59, 96, v56
    ds_read_b64_tr_b16 v[184:185], v56 offset:0
    ds_read_b64_tr_b16 v[186:187], v58 offset:2560
    v_mfma_f32_16x16x32_bf16 v[156:159], v[204:207], v[136:139], v[156:159]
    ds_read_b64_tr_b16 v[188:189], v57 offset:0
    ds_read_b64_tr_b16 v[190:191], v59 offset:2560
    ds_read_b64_tr_b16 v[192:193], v58 offset:0
    v_mfma_f32_16x16x32_bf16 v[172:175], v[204:207], v[140:143], v[172:175]
    ds_read_b64_tr_b16 v[194:195], v56 offset:2560
    ds_read_b64_tr_b16 v[196:197], v59 offset:0
    v_mfma_f32_16x16x32_bf16 v[160:163], v[208:211], v[136:139], v[160:163]
    ds_read_b64_tr_b16 v[198:199], v57 offset:2560
    s_cmp_eq_u32 s63, 0
    v_mfma_f32_16x16x32_bf16 v[176:179], v[208:211], v[140:143], v[176:179]
    s_cbranch_scc1 K_SP15
K_SPR15:
    s_ff1_i32_b32 s33, s63
    v_mfma_f32_16x16x32_bf16 v[164:167], v[212:215], v[136:139], v[164:167]
    s_bitset0_b32 s63, s33
    s_lshl_b32 s78, s33, 10
    v_mfma_f32_16x16x32_bf16 v[180:183], v[212:215], v[140:143], v[180:183]
    buffer_load_dwordx4 v[128:131], v25, s[20:23], s78 offen offset:0 sc1
    buffer_load_dwordx4 v[132:135], v26, s[20:23], s78 offen offset:0 sc1
    s_waitcnt vmcnt(8) lgkmcnt(8)
    v_mfma_f32_16x16x32_bf16 v[152:155], v[216:219], v[144:147], v[152:155]
    v_mad_u32_u24 v56, s76, 5, v24
    v_xor_b32 v58, 64, v56
    v_xor_b32 v57, 32, v56
    v_mfma_f32_16x16x32_bf16 v[168:171], v[216:219], v[148:151], v[168:171]
    v_xor_b32 v59, 96, v56
    ds_read_b64_tr_b16 v[200:201], v56 offset:0
    ds_read_b64_tr_b16 v[202:203], v58 offset:2560
    v_mfma_f32_16x16x32_bf16 v[156:159], v[220:223], v[144:147], v[156:159]
    ds_read_b64_tr_b16 v[204:205], v57 offset:0
    ds_read_b64_tr_b16 v[206:207], v59 offset:2560
    ds_read_b64_tr_b16 v[208:209], v58 offset:0
    v_mfma_f32_16x16x32_bf16 v[172:175], v[220:223], v[148:151], v[172:175]
    ds_read_b64_tr_b16 v[210:211], v56 offset:2560
    ds_read_b64_tr_b16 v[212:213], v59 offset:0
    v_mfma_f32_16x16x32_bf16 v[160:163], v[224:227], v[144:147], v[160:163]
    ds_read_b64_tr_b16 v[214:215], v57 offset:2560
    s_cmp_eq_u32 s63, 0
    v_mfma_f32_16x16x32_bf16 v[176:179], v[224:227], v[148:151], v[176:179]
    s_cbranch_scc1 K_SP16
K_SPR16:
    s_ff1_i32_b32 s33, s63
    v_mfma_f32_16x16x32_bf16 v[164:167], v[228:231], v[144:147], v[164:167]
    s_bitset0_b32 s63, s33
    s_lshl_b32 s75, s33, 10
    v_mfma_f32_16x16x32_bf16 v[180:183], v[228:231], v[148:151], v[180:183]
    buffer_load_dwordx4 v[136:139], v25, s[20:23], s75 offen offset:0 sc1
    buffer_load_dwordx4 v[140:143], v26, s[20:23], s75 offen offset:0 sc1
    s_waitcnt vmcnt(8) lgkmcnt(8)
    v_mfma_f32_16x16x32_bf16 v[152:155], v[184:187], v[104:107], v[152:155]
    v_mad_u32_u24 v56, s77, 5, v24
    v_xor_b32 v58, 64, v56
    v_xor_b32 v57, 32, v56
    v_mfma_f32_16x16x32_bf16 v[168:171], v[184:187], v[108:111], v[168:171]
    v_xor_b32 v59, 96, v56
    ds_read_b64_tr_b16 v[216:217], v56 offset:0
    ds_read_b64_tr_b16 v[218:219], v58 offset:2560
    v_mfma_f32_16x16x32_bf16 v[156:159], v[188:191], v[104:107], v[156:159]
    ds_read_b64_tr_b16 v[220:221], v57 offset:0
    ds_read_b64_tr_b16 v[222:223], v59 offset:2560
    ds_read_b64_tr_b16 v[224:225], v58 offset:0
    v_mfma_f32_16x16x32_bf16 v[172:175], v[188:191], v[108:111], v[172:175]
    ds_read_b64_tr_b16 v[226:227], v56 offset:2560
    ds_read_b64_tr_b16 v[228:229], v59 offset:0
    v_mfma_f32_16x16x32_bf16 v[160:163], v[192:195], v[104:107], v[160:163]
    ds_read_b64_tr_b16 v[230:231], v57 offset:2560
    s_andn2_b32 s33, s66, s63
    v_mfma_f32_16x16x32_bf16 v[176:179], v[192:195], v[108:111], v[176:179]
    s_bfe_u32 s33, s33, 0x40008
    s_cmp_eq_u32 s33, 15
    v_mfma_f32_16x16x32_bf16 v[164:167], v[196:199], v[104:107], v[164:167]
    s_cselect_b32 s76, 0, 1024
    s_xor_b32 s69, s76, 1024
    v_mfma_f32_16x16x32_bf16 v[180:183], v[196:199], v[108:111], v[180:183]
    buffer_load_dwordx4 v[144:147], v35, s[20:23], s76 offen offset:2048 sc1
    buffer_load_dwordx4 v[148:151], v36, s[20:23], s76 offen offset:2048 sc1
    s_waitcnt vmcnt(8) lgkmcnt(8)
    v_mfma_f32_16x16x32_bf16 v[152:155], v[200:203], v[112:115], v[152:155]
    v_mad_u32_u24 v56, s78, 5, v24
    v_xor_b32 v58, 64, v56
    v_xor_b32 v57, 32, v56
    v_mfma_f32_16x16x32_bf16 v[168:171], v[200:203], v[116:119], v[168:171]
    v_xor_b32 v59, 96, v56
    ds_read_b64_tr_b16 v[184:185], v56 offset:0
    ds_read_b64_tr_b16 v[186:187], v58 offset:2560
    v_mfma_f32_16x16x32_bf16 v[156:159], v[204:207], v[112:115], v[156:159]
    ds_read_b64_tr_b16 v[188:189], v57 offset:0
    ds_read_b64_tr_b16 v[190:191], v59 offset:2560
    ds_read_b64_tr_b16 v[192:193], v58 offset:0
    v_mfma_f32_16x16x32_bf16 v[172:175], v[204:207], v[116:119], v[172:175]
    ds_read_b64_tr_b16 v[194:195], v56 offset:2560
    ds_read_b64_tr_b16 v[196:197], v59 offset:0
    v_mfma_f32_16x16x32_bf16 v[160:163], v[208:211], v[112:115], v[160:163]
    ds_read_b64_tr_b16 v[198:199], v57 offset:2560
    s_cmp_eq_u32 s63, 0
    v_mfma_f32_16x16x32_bf16 v[176:179], v[208:211], v[116:119], v[176:179]
    s_cbranch_scc1 K_SP18
K_SPR18:
    s_ff1_i32_b32 s33, s63
    v_mfma_f32_16x16x32_bf16 v[164:167], v[212:215], v[112:115], v[164:167]
    s_bitset0_b32 s63, s33
    s_lshl_b32 s77, s33, 10
    v_mfma_f32_16x16x32_bf16 v[180:183], v[212:215], v[116:119], v[180:183]
    buffer_load_dwordx4 v[104:107], v25, s[20:23], s77 offen offset:0 sc1
    buffer_load_dwordx4 v[108:111], v26, s[20:23], s77 offen offset:0 sc1
    s_waitcnt vmcnt(8) lgkmcnt(8)
    v_mfma_f32_16x16x32_bf16 v[152:155], v[216:219], v[120:123], v[152:155]
    v_mad_u32_u24 v56, s75, 5, v24
    v_xor_b32 v58, 64, v56
    v_mfma_f32_16x16x32_bf16 v[168:171], v[216:219], v[124:127], v[168:171]
    v_xor_b32 v57, 32, v56
    v_xor_b32 v59, 96, v56
    v_mfma_f32_16x16x32_bf16 v[156:159], v[220:223], v[120:123], v[156:159]
    ds_read_b64_tr_b16 v[200:201], v56 offset:0
    ds_read_b64_tr_b16 v[202:203], v58 offset:2560
    v_mfma_f32_16x16x32_bf16 v[172:175], v[220:223], v[124:127], v[172:175]
    ds_read_b64_tr_b16 v[204:205], v57 offset:0
    ds_read_b64_tr_b16 v[206:207], v59 offset:2560
    v_mfma_f32_16x16x32_bf16 v[160:163], v[224:227], v[120:123], v[160:163]
    ds_read_b64_tr_b16 v[208:209], v58 offset:0
    ds_read_b64_tr_b16 v[210:211], v56 offset:2560
    v_mfma_f32_16x16x32_bf16 v[176:179], v[224:227], v[124:127], v[176:179]
    ds_read_b64_tr_b16 v[212:213], v59 offset:0
    ds_read_b64_tr_b16 v[214:215], v57 offset:2560
    v_mfma_f32_16x16x32_bf16 v[164:167], v[228:231], v[120:123], v[164:167]
    buffer_load_dwordx4 v[112:115], v35, s[20:23], s69 offen offset:2048 sc1
    buffer_load_dwordx4 v[116:119], v36, s[20:23], s69 offen offset:2048 sc1
    v_mfma_f32_16x16x32_bf16 v[180:183], v[228:231], v[124:127], v[180:183]
    s_waitcnt vmcnt(8) lgkmcnt(8)
    v_mfma_f32_16x16x32_bf16 v[152:155], v[184:187], v[128:131], v[152:155]
    v_mad_u32_u24 v56, s76, 20, v60
    v_xor_b32 v58, 64, v56
    v_mfma_f32_16x16x32_bf16 v[168:171], v[184:187], v[132:135], v[168:171]
    v_xor_b32 v57, 32, v56
    v_xor_b32 v59, 96, v56
    v_mfma_f32_16x16x32_bf16 v[156:159], v[188:191], v[128:131], v[156:159]
    ds_read_b64_tr_b16 v[216:217], v56 offset:40960
    ds_read_b64_tr_b16 v[218:219], v58 offset:43520
    v_mfma_f32_16x16x32_bf16 v[172:175], v[188:191], v[132:135], v[172:175]
    ds_read_b64_tr_b16 v[220:221], v57 offset:40960
    ds_read_b64_tr_b16 v[222:223], v59 offset:43520
    v_mfma_f32_16x16x32_bf16 v[160:163], v[192:195], v[128:131], v[160:163]
    ds_read_b64_tr_b16 v[224:225], v58 offset:40960
    ds_read_b64_tr_b16 v[226:227], v56 offset:43520
    v_mfma_f32_16x16x32_bf16 v[176:179], v[192:195], v[132:135], v[176:179]
    ds_read_b64_tr_b16 v[228:229], v59 offset:40960
    ds_read_b64_tr_b16 v[230:231], v57 offset:43520
    v_mfma_f32_16x16x32_bf16 v[164:167], v[196:199], v[128:131], v[164:167]
    v_mfma_f32_16x16x32_bf16 v[180:183], v[196:199], v[132:135], v[180:183]
    s_waitcnt vmcnt(6) lgkmcnt(8)
    v_mfma_f32_16x16x32_bf16 v[152:155], v[200:203], v[136:139], v[152:155]
    v_mad_u32_u24 v56, s77, 5, v24
    v_xor_b32 v58, 64, v56
    v_mfma_f32_16x16x32_bf16 v[168:171], v[200:203], v[140:143], v[168:171]
    v_xor_b32 v57, 32, v56
    v_xor_b32 v59, 96, v56
    v_mfma_f32_16x16x32_bf16 v[156:159], v[204:207], v[136:139], v[156:159]
    ds_read_b64_tr_b16 v[184:185], v56 offset:0
    ds_read_b64_tr_b16 v[186:187], v58 offset:2560
    v_mfma_f32_16x16x32_bf16 v[172:175], v[204:207], v[140:143], v[172:175]
    ds_read_b64_tr_b16 v[188:189], v57 offset:0
    ds_read_b64_tr_b16 v[190:191], v59 offset:2560
    v_mfma_f32_16x16x32_bf16 v[160:163], v[208:211], v[136:139], v[160:163]
    ds_read_b64_tr_b16 v[192:193], v58 offset:0
    ds_read_b64_tr_b16 v[194:195], v56 offset:2560
    v_mfma_f32_16x16x32_bf16 v[176:179], v[208:211], v[140:143], v[176:179]
    ds_read_b64_tr_b16 v[196:197], v59 offset:0
    ds_read_b64_tr_b16 v[198:199], v57 offset:2560
    v_mfma_f32_16x16x32_bf16 v[164:167], v[212:215], v[136:139], v[164:167]
    v_mfma_f32_16x16x32_bf16 v[180:183], v[212:215], v[140:143], v[180:183]
    s_waitcnt vmcnt(4) lgkmcnt(8)
    v_mfma_f32_16x16x32_bf16 v[152:155], v[216:219], v[144:147], v[152:155]
    v_mad_u32_u24 v56, s69, 20, v60
    v_xor_b32 v58, 64, v56
    v_mfma_f32_16x16x32_bf16 v[168:171], v[216:219], v[148:151], v[168:171]
    v_xor_b32 v57, 32, v56
    v_xor_b32 v59, 96, v56
    v_mfma_f32_16x16x32_bf16 v[156:159], v[220:223], v[144:147], v[156:159]
    ds_read_b64_tr_b16 v[200:201], v56 offset:40960
    ds_read_b64_tr_b16 v[202:203], v58 offset:43520
    v_mfma_f32_16x16x32_bf16 v[172:175], v[220:223], v[148:151], v[172:175]
    ds_read_b64_tr_b16 v[204:205], v57 offset:40960
    ds_read_b64_tr_b16 v[206:207], v59 offset:43520
    v_mfma_f32_16x16x32_bf16 v[160:163], v[224:227], v[144:147], v[160:163]
    ds_read_b64_tr_b16 v[208:209], v58 offset:40960
    ds_read_b64_tr_b16 v[210:211], v56 offset:43520
    v_mfma_f32_16x16x32_bf16 v[176:179], v[224:227], v[148:151], v[176:179]
    ds_read_b64_tr_b16 v[212:213], v59 offset:40960
    ds_read_b64_tr_b16 v[214:215], v57 offset:43520
    v_mfma_f32_16x16x32_bf16 v[164:167], v[228:231], v[144:147], v[164:167]
    v_mfma_f32_16x16x32_bf16 v[180:183], v[228:231], v[148:151], v[180:183]
    s_waitcnt vmcnt(2) lgkmcnt(8)
    v_mfma_f32_16x16x32_bf16 v[152:155], v[184:187], v[104:107], v[152:155]
    v_mfma_f32_16x16x32_bf16 v[156:159], v[188:191], v[104:107], v[156:159]
    v_mfma_f32_16x16x32_bf16 v[160:163], v[192:195], v[104:107], v[160:163]
    v_mfma_f32_16x16x32_bf16 v[164:167], v[196:199], v[104:107], v[164:167]
    s_sub_u32 s59, s56, s58
    s_cmp_lt_u32 s59, 32
    s_cbranch_scc1 K_YROW0
K_NOY0:
    s_sub_u32 s59, s57, s58
    s_cmp_lt_u32 s59, 32
    s_cbranch_scc1 K_YROW1
K_NOY1:
    s_waitcnt vmcnt(0) lgkmcnt(0)
    v_mfma_f32_16x16x32_bf16 v[152:155], v[200:203], v[112:115], v[152:155]
    v_mfma_f32_16x16x32_bf16 v[156:159], v[204:207], v[112:115], v[156:159]
    v_mfma_f32_16x16x32_bf16 v[160:163], v[208:211], v[112:115], v[160:163]
    v_mfma_f32_16x16x32_bf16 v[164:167], v[212:215], v[112:115], v[164:167]
    v_mfma_f32_16x16x32_bf16 v[168:171], v[184:187], v[108:111], v[168:171]
    v_mfma_f32_16x16x32_bf16 v[172:175], v[188:191], v[108:111], v[172:175]
    v_mfma_f32_16x16x32_bf16 v[176:179], v[192:195], v[108:111], v[176:179]
    s_nop 1
    v_fma_f32 v152, v152, v64, v72
    v_fma_f32 v153, v153, v64, v73
    v_fma_f32 v154, v154, v64, v74
    v_mfma_f32_16x16x32_bf16 v[180:183], v[196:199], v[108:111], v[180:183]
    v_fma_f32 v155, v155, v64, v75
    v_cvt_pk_bf16_f32 v40, v152, v153
    v_cvt_pk_bf16_f32 v41, v154, v155
    v_mfma_f32_16x16x32_bf16 v[168:171], v[200:203], v[116:119], v[168:171]
    v_fma_f32 v156, v156, v64, v76
    v_fma_f32 v157, v157, v64, v77
    ds_write_b64 v29, v[40:41] offset:0
    v_mfma_f32_16x16x32_bf16 v[172:175], v[204:207], v[116:119], v[172:175]
    v_fma_f32 v158, v158, v64, v78
    v_fma_f32 v159, v159, v64, v79
    v_cvt_pk_bf16_f32 v42, v156, v157
    v_mfma_f32_16x16x32_bf16 v[176:179], v[208:211], v[116:119], v[176:179]
    v_cvt_pk_bf16_f32 v43, v158, v159
    v_fma_f32 v160, v160, v64, v80
    v_fma_f32 v161, v161, v64, v81
    v_mfma_f32_16x16x32_bf16 v[180:183], v[212:215], v[116:119], v[180:183]
    ds_write_b64 v30, v[42:43] offset:0
    v_fma_f32 v162, v162, v64, v82
    v_fma_f32 v163, v163, v64, v83
    v_cvt_pk_bf16_f32 v44, v160, v161
    v_cvt_pk_bf16_f32 v45, v162, v163
    v_pk_fma_f32 v[164:165], v[164:165], v[64:65], v[84:85] op_sel_hi:[1,0,1]
    v_pk_fma_f32 v[166:167], v[166:167], v[64:65], v[86:87] op_sel_hi:[1,0,1]
    ds_write_b64 v31, v[44:45] offset:0
    v_cvt_pk_bf16_f32 v46, v164, v165
    v_cvt_pk_bf16_f32 v47, v166, v167
    ds_write_b64 v32, v[46:47] offset:0
    ds_read_b128 v[72:75], v33 offset:0
    ds_read_b128 v[76:79], v33 offset:1024
    v_pk_fma_f32 v[168:169], v[168:169], v[66:67], v[88:89] op_sel_hi:[1,0,1]
    v_pk_fma_f32 v[170:171], v[170:171], v[66:67], v[90:91] op_sel_hi:[1,0,1]
    v_cvt_pk_bf16_f32 v48, v168, v169
    v_cvt_pk_bf16_f32 v49, v170, v171
    v_pk_fma_f32 v[172:173], v[172:173], v[66:67], v[92:93] op_sel_hi:[1,0,1]
    v_pk_fma_f32 v[174:175], v[174:175], v[66:67], v[94:95] op_sel_hi:[1,0,1]
    v_cvt_pk_bf16_f32 v50, v172, v173
    v_cvt_pk_bf16_f32 v51, v174, v175
    v_pk_fma_f32 v[176:177], v[176:177], v[66:67], v[96:97] op_sel_hi:[1,0,1]
    v_pk_fma_f32 v[178:179], v[178:179], v[66:67], v[98:99] op_sel_hi:[1,0,1]
    v_cvt_pk_bf16_f32 v52, v176, v177
    v_cvt_pk_bf16_f32 v53, v178, v179
    v_pk_fma_f32 v[180:181], v[180:181], v[66:67], v[100:101] op_sel_hi:[1,0,1]
    v_pk_fma_f32 v[182:183], v[182:183], v[66:67], v[102:103] op_sel_hi:[1,0,1]
    v_cvt_pk_bf16_f32 v54, v180, v181
    v_cvt_pk_bf16_f32 v55, v182, v183
    s_waitcnt lgkmcnt(0)
    buffer_store_dwordx4 v[72:75], v27, s[48:51], s71 offen sc1
    buffer_store_dwordx4 v[76:79], v28, s[48:51], s72 offen sc1
    ds_write_b64 v29, v[48:49] offset:2048
    ds_write_b64 v30, v[50:51] offset:2048
    ds_write_b64 v31, v[52:53] offset:2048
    ds_write_b64 v32, v[54:55] offset:2048
    ds_read_b128 v[88:91], v33 offset:2048
    ds_read_b128 v[92:95], v33 offset:3072
    s_waitcnt lgkmcnt(1)
    buffer_store_dwordx4 v[88:91], v27, s[48:51], s73 offen sc1
    s_waitcnt lgkmcnt(0)
    buffer_store_dwordx4 v[92:95], v28, s[48:51], s74 offen sc1
K_END:
K_EXIT:
    s_endpgm
.p2align 12
WP_spin:
    s_setpc_b64 s[38:39]
K_SP0:
    ds_read_b32 v2, v12 offset:32
    s_waitcnt lgkmcnt(0)
    v_readfirstlane_b32 s33, v2
    s_nop 3
    s_lshr_b32 s63, s33, s64
    s_lshr_b32 s33, s33, s65
    s_and_b32 s63, s63, s33
    s_and_b32 s63, s63, 0xff
    s_andn2_b32 s63, s63, s66
    s_cbranch_scc0 K_SP0
    s_or_b32 s66, s66, s63
    s_branch K_SPR0
K_SP1:
    ds_read_b32 v2, v12 offset:32
    s_waitcnt lgkmcnt(0)
    v_readfirstlane_b32 s33, v2
    s_nop 3
    s_lshr_b32 s63, s33, s64
    s_lshr_b32 s33, s33, s65
    s_and_b32 s63, s63, s33
    s_and_b32 s63, s63, 0xff
    s_andn2_b32 s63, s63, s66
    s_cbranch_scc0 K_SP1
    s_or_b32 s66, s66, s63
    s_branch K_SPR1
K_SP2:
    ds_read_b32 v2, v12 offset:32
    s_waitcnt lgkmcnt(0)
    v_readfirstlane_b32 s33, v2
    s_nop 3
    s_lshr_b32 s63, s33, s64
    s_lshr_b32 s33, s33, s65
    s_and_b32 s63, s63, s33
    s_and_b32 s63, s63, 0xff
    s_andn2_b32 s63, s63, s66
    s_cbranch_scc0 K_SP2
    s_or_b32 s66, s66, s63
    s_branch K_SPR2
K_SP3:
    ds_read_b32 v2, v12 offset:32
    s_waitcnt lgkmcnt(0)
    v_readfirstlane_b32 s33, v2
    s_nop 3
    s_lshr_b32 s63, s33, s64
    s_lshr_b32 s33, s33, s65
    s_and_b32 s63, s63, s33
    s_and_b32 s63, s63, 0xff
    s_andn2_b32 s63, s63, s66
    s_cbranch_scc0 K_SP3
    s_or_b32 s66, s66, s63
    s_branch K_SPR3
K_SP4:
    ds_read_b32 v2, v12 offset:32
    s_waitcnt lgkmcnt(0)
    v_readfirstlane_b32 s33, v2
    s_nop 3
    s_lshr_b32 s63, s33, s64
    s_lshr_b32 s33, s33, s65
    s_and_b32 s63, s63, s33
    s_and_b32 s63, s63, 0xff
    s_andn2_b32 s63, s63, s66
    s_cbranch_scc0 K_SP4
    s_or_b32 s66, s66, s63
    s_branch K_SPR4
K_SP5:
    ds_read_b32 v2, v12 offset:32
    s_waitcnt lgkmcnt(0)
    v_readfirstlane_b32 s33, v2
    s_nop 3
    s_lshr_b32 s63, s33, s64
    s_lshr_b32 s33, s33, s65
    s_and_b32 s63, s63, s33
    s_and_b32 s63, s63, 0xff
    s_andn2_b32 s63, s63, s66
    s_cbranch_scc0 K_SP5
    s_or_b32 s66, s66, s63
    s_branch K_SPR5
K_SP6:
    ds_read_b32 v2, v12 offset:32
    s_waitcnt lgkmcnt(0)
    v_readfirstlane_b32 s33, v2
    s_nop 3
    s_lshr_b32 s63, s33, s64
    s_lshr_b32 s33, s33, s65
    s_and_b32 s63, s63, s33
    s_and_b32 s63, s63, 0xff
    s_andn2_b32 s63, s63, s66
    s_cbranch_scc0 K_SP6
    s_or_b32 s66, s66, s63
    s_branch K_SPR6
K_SP8:
    ds_read_b32 v2, v12 offset:32
    s_waitcnt lgkmcnt(0)
    v_readfirstlane_b32 s33, v2
    s_nop 3
    s_lshr_b32 s63, s33, s64
    s_lshr_b32 s33, s33, s65
    s_and_b32 s63, s63, s33
    s_and_b32 s63, s63, 0xff
    s_andn2_b32 s63, s63, s66
    s_cbranch_scc0 K_SP8
    s_or_b32 s66, s66, s63
    s_branch K_SPR8
K_SP10:
    ds_read_b32 v2, v12 offset:32
    s_waitcnt lgkmcnt(0)
    v_readfirstlane_b32 s33, v2
    s_nop 3
    s_lshr_b32 s63, s33, s64
    s_lshr_b32 s33, s33, s65
    s_and_b32 s63, s63, s33
    s_and_b32 s63, s63, 0xff00
    s_andn2_b32 s63, s63, s66
    s_cbranch_scc0 K_SP10
    s_or_b32 s66, s66, s63
    s_branch K_SPR10
K_SP11:
    ds_read_b32 v2, v12 offset:32
    s_waitcnt lgkmcnt(0)
    v_readfirstlane_b32 s33, v2
    s_nop 3
    s_lshr_b32 s63, s33, s64
    s_lshr_b32 s33, s33, s65
    s_and_b32 s63, s63, s33
    s_and_b32 s63, s63, 0xff00
    s_andn2_b32 s63, s63, s66
    s_cbranch_scc0 K_SP11
    s_or_b32 s66, s66, s63
    s_branch K_SPR11
K_SP12:
    ds_read_b32 v2, v12 offset:32
    s_waitcnt lgkmcnt(0)
    v_readfirstlane_b32 s33, v2
    s_nop 3
    s_lshr_b32 s63, s33, s64
    s_lshr_b32 s33, s33, s65
    s_and_b32 s63, s63, s33
    s_and_b32 s63, s63, 0xff00
    s_andn2_b32 s63, s63, s66
    s_cbranch_scc0 K_SP12
    s_or_b32 s66, s66, s63
    s_branch K_SPR12
K_SP13:
    ds_read_b32 v2, v12 offset:32
    s_waitcnt lgkmcnt(0)
    v_readfirstlane_b32 s33, v2
    s_nop 3
    s_lshr_b32 s63, s33, s64
    s_lshr_b32 s33, s33, s65
    s_and_b32 s63, s63, s33
    s_and_b32 s63, s63, 0xff00
    s_andn2_b32 s63, s63, s66
    s_cbranch_scc0 K_SP13
    s_or_b32 s66, s66, s63
    s_branch K_SPR13
K_SP14:
    ds_read_b32 v2, v12 offset:32
    s_waitcnt lgkmcnt(0)
    v_readfirstlane_b32 s33, v2
    s_nop 3
    s_lshr_b32 s63, s33, s64
    s_lshr_b32 s33, s33, s65
    s_and_b32 s63, s63, s33
    s_and_b32 s63, s63, 0xff00
    s_andn2_b32 s63, s63, s66
    s_cbranch_scc0 K_SP14
    s_or_b32 s66, s66, s63
    s_branch K_SPR14
K_SP15:
    ds_read_b32 v2, v12 offset:32
    s_waitcnt lgkmcnt(0)
    v_readfirstlane_b32 s33, v2
    s_nop 3
    s_lshr_b32 s63, s33, s64
    s_lshr_b32 s33, s33, s65
    s_and_b32 s63, s63, s33
    s_and_b32 s63, s63, 0xff00
    s_andn2_b32 s63, s63, s66
    s_cbranch_scc0 K_SP15
    s_or_b32 s66, s66, s63
    s_branch K_SPR15
K_SP16:
    ds_read_b32 v2, v12 offset:32
    s_waitcnt lgkmcnt(0)
    v_readfirstlane_b32 s33, v2
    s_nop 3
    s_lshr_b32 s63, s33, s64
    s_lshr_b32 s33, s33, s65
    s_and_b32 s63, s63, s33
    s_and_b32 s63, s63, 0xff00
    s_andn2_b32 s63, s63, s66
    s_cbranch_scc0 K_SP16
    s_or_b32 s66, s66, s63
    s_branch K_SPR16
K_SP18:
    ds_read_b32 v2, v12 offset:32
    s_waitcnt lgkmcnt(0)
    v_readfirstlane_b32 s33, v2
    s_nop 3
    s_lshr_b32 s63, s33, s64
    s_lshr_b32 s33, s33, s65
    s_and_b32 s63, s63, s33
    s_and_b32 s63, s63, 0xff00
    s_andn2_b32 s63, s63, s66
    s_cbranch_scc0 K_SP18
    s_or_b32 s66, s66, s63
    s_branch K_SPR18
WP_yr0:
    s_setpc_b64 s[38:39]
K_YROW0:
    v_lshlrev_b32 v5, 4, v9
    v_add_u32 v5, 158976, v5
    v_and_b32 v3, 15, v1
    s_and_b32 s33, s59, 15
    v_cmp_eq_u32 vcc, s33, v3
    s_mov_b32 s3, 1048576
K_P2_GY0:
    ds_read_b32 v2, v12 offset:64
    s_sub_u32 s3, s3, 1
    s_waitcnt lgkmcnt(0)
    v_readfirstlane_b32 s33, v2
    s_nop 3
    s_cselect_b32 s33, 1, s33
    s_cmp_lt_u32 s33, 1
    s_cbranch_scc1 K_P2_GY0
    s_mov_b64 exec, vcc
    s_cmp_ge_u32 s59, 16
    s_cbranch_scc1 K_YR1_0
    ds_read_b128 v[72:75], v5 offset:0
    ds_read_b128 v[76:79], v5 offset:64
    ds_read_b128 v[80:83], v5 offset:128
    ds_read_b128 v[84:87], v5 offset:192
    s_mov_b64 exec, -1
    s_branch K_NOY0
K_YR1_0:
    ds_read_b128 v[88:91], v5 offset:0
    ds_read_b128 v[92:95], v5 offset:64
    ds_read_b128 v[96:99], v5 offset:128
    ds_read_b128 v[100:103], v5 offset:192
    s_mov_b64 exec, -1
    s_branch K_NOY0
K_YROW1:
    v_lshlrev_b32 v5, 4, v9
    v_add_u32 v5, 159232, v5
    v_and_b32 v3, 15, v1
    s_and_b32 s33, s59, 15
    v_cmp_eq_u32 vcc, s33, v3
    s_mov_b32 s3, 1048576
K_P2_GY1:
    ds_read_b32 v2, v12 offset:68
    s_sub_u32 s3, s3, 1
    s_waitcnt lgkmcnt(0)
    v_readfirstlane_b32 s33, v2
    s_nop 3
    s_cselect_b32 s33, 1, s33
    s_cmp_lt_u32 s33, 1
    s_cbranch_scc1 K_P2_GY1
    s_mov_b64 exec, vcc
    s_cmp_ge_u32 s59, 16
    s_cbranch_scc1 K_YR1_1
    ds_read_b128 v[72:75], v5 offset:0
    ds_read_b128 v[76:79], v5 offset:64
    ds_read_b128 v[80:83], v5 offset:128
    ds_read_b128 v[84:87], v5 offset:192
    s_mov_b64 exec, -1
    s_branch K_NOY1
K_YR1_1:
    ds_read_b128 v[88:91], v5 offset:0
    ds_read_b128 v[92:95], v5 offset:64
    ds_read_b128 v[96:99], v5 offset:128
    ds_read_b128 v[100:103], v5 offset:192
    s_mov_b64 exec, -1
    s_branch K_NOY1
.p2align 12
WP_gen:
    s_setpc_b64 s[38:39]
K_P2:
    s_cmp_ge_u32 s30, 4
    s_cbranch_scc1 K_P2_HELP
    v_mov_b32 v12, 158720
    s_cmp_lg_u32 s30, 0
    s_cbranch_scc1 K_P2_W13
    v_lshrrev_b32 v3, 4, v1
    v_and_b32 v4, 7, v1
    v_lshrrev_b32 v2, 3, v1
    v_xor_b32 v4, v4, v3
    v_mul_u32_u24 v2, 1280, v2
    v_lshl_add_u32 v27, v4, 4, v2
    v_xor_b32 v28, 64, v27
    s_mov_b32 s58, 0
K_P2_XD:
    s_lshl_b32 s59, s40, 3
    s_lshl1_add_u32 s59, s58, s59
    s_mul_i32 s59, s59, 20480
    s_lshl_b32 s33, s41, 7
    s_add_u32 s59, s59, s33
    s_lshl_b32 s33, s58, 12
    s_add_u32 m0, s33, 140288
    s_add_u32 s3, s59, 0
    buffer_load_dwordx4 v27, s[12:15], s3 offen lds
    s_add_u32 m0, s33, 141312
    s_add_u32 s3, s59, 10240
    buffer_load_dwordx4 v28, s[12:15], s3 offen lds
    s_add_u32 m0, s33, 142336
    s_add_u32 s3, s59, 20480
    buffer_load_dwordx4 v27, s[12:15], s3 offen lds
    s_add_u32 m0, s33, 143360
    s_add_u32 s3, s59, 30720
    buffer_load_dwordx4 v28, s[12:15], s3 offen lds
    s_add_u32 s58, s58, 1
    s_cmp_lt_u32 s58, 4
    s_cbranch_scc1 K_P2_XD
    s_waitcnt vmcnt(0)
    s_branch K_P2_AUXW
K_P2_W13:
    v_lshrrev_b32 v2, 3, v1
    v_mul_u32_u24 v2, 1280, v2
    v_lshrrev_b32 v3, 4, v1
    v_lshlrev_b32 v3, 1, v3
    v_and_b32 v4, 7, v1
    v_xor_b32 v3, v3, v4
    v_lshl_add_u32 v2, v3, 4, v2
    s_lshl_b32 s33, s41, 7
    v_add_u32 v22, s33, v2
    s_mov_b32 s60, 0xfda87520
    s_mov_b32 s61, 0xecb96431
    s_sub_u32 s58, s30, 1
K_P2_WS:
    s_lshl_b32 s3, s58, 2
    s_lshr_b64 s[4:5], s[60:61], s3
    s_and_b32 s4, s4, 15
    s_mul_i32 s4, s4, 51200
    s_mul_i32 s59, s58, 5120
    s_add_u32 s52, s4, 0
    s_add_u32 m0, s59, 0
    s_waitcnt vmcnt(11)
    buffer_load_dwordx4 v22, s[24:27], s52 offen lds
    s_add_u32 s52, s4, 10240
    s_add_u32 m0, s59, 1024
    s_waitcnt vmcnt(11)
    buffer_load_dwordx4 v22, s[24:27], s52 offen lds
    s_add_u32 s52, s4, 20480
    s_add_u32 m0, s59, 2048
    s_waitcnt vmcnt(11)
    buffer_load_dwordx4 v22, s[24:27], s52 offen lds
    s_add_u32 s52, s4, 30720
    s_add_u32 m0, s59, 3072
    s_waitcnt vmcnt(11)
    buffer_load_dwordx4 v22, s[24:27], s52 offen lds
    s_add_u32 s52, s4, 40960
    s_add_u32 m0, s59, 4096
    s_waitcnt vmcnt(11)
    buffer_load_dwordx4 v22, s[24:27], s52 offen lds
    s_cmp_ge_u32 s58, 3
    s_cbranch_scc1 K_P2_WS1
    v_mov_b32 v3, 1
    s_waitcnt vmcnt(5)
    s_mov_b64 exec, 1
    ds_add_u32 v12, v3 offset:52
    s_mov_b64 exec, -1
K_P2_WS1:
    s_add_u32 s58, s58, 3
    s_cmp_lt_u32 s58, 16
    s_cbranch_scc1 K_P2_WS
K_P2_AUXW:
    v_mov_b32 v34, 1
    s_waitcnt vmcnt(10)
    s_mov_b64 exec, 1
    ds_add_u32 v12, v34 offset:72
    s_mov_b64 exec, -1
    s_lshl_b32 s54, s40, 7
    v_lshrrev_b32 v9, 4, v1
    v_mov_b32 v12, 158720
    s_add_u32 s20, s10, 0x100000
    s_addc_u32 s21, s11, 0
    s_mov_b32 s22, 0x280000
    s_mov_b32 s23, 0x20000
    s_add_u32 s16, s10, 0x1000
    s_addc_u32 s17, s11, 0
    s_mov_b32 s18, 0x2000
    s_mov_b32 s19, 0x20000
    s_mov_b32 s48, s6
    s_mov_b32 s49, s7
    s_mov_b32 s50, 0x280000
    s_mov_b32 s51, 0x20000
    s_lshl_b32 s53, s40, 3
    s_lshl1_add_u32 s53, s30, s53
    s_mov_b32 s55, 20480
    v_bfe_u32 v20, v1, 2, 2
    v_and_b32 v21, 3, v1
    s_mul_i32 s3, s53, 20480
    v_lshl_add_u32 v25, v1, 4, s3
    v_add_u32 v26, 20480, v25
    v_add_u32 v35, 16384, v25
    v_add_u32 v36, 16384, v26
    v_and_b32 v2, 15, v1
    s_lshl_b32 s3, s53, 6
    v_lshl_add_u32 v23, v2, 2, s3
    v_lshl_add_u32 v2, v9, 2, v20
    v_bfe_u32 v3, v2, 1, 2
    v_lshlrev_b32 v2, 7, v2
    v_lshl_add_u32 v2, v21, 3, v2
    v_lshl_add_u32 v24, v3, 5, v2
    v_lshrrev_b32 v3, 1, v20
    v_mul_u32_u24 v2, 40, v9
    v_add3_u32 v2, v2, 16, v20
    v_lshlrev_b32 v2, 7, v2
    v_lshl_add_u32 v2, v21, 3, v2
    v_xor_b32 v4, 0, v3
    v_lshl_add_u32 v60, v4, 5, v2
    v_xor_b32 v4, 1, v3
    v_lshl_add_u32 v61, v4, 5, v2
    v_xor_b32 v4, 2, v3
    v_lshl_add_u32 v62, v4, 5, v2
    v_xor_b32 v4, 3, v3
    v_lshl_add_u32 v63, v4, 5, v2
    v_lshrrev_b32 v3, 4, v1
    v_and_b32 v4, 7, v1
    v_lshrrev_b32 v2, 3, v1
    v_xor_b32 v4, v4, v3
    v_mul_u32_u24 v2, 1280, v2
    v_lshl_add_u32 v27, v4, 4, v2
    v_xor_b32 v28, 64, v27
    s_lshl_b32 s71, s40, 3
    s_lshl1_add_u32 s71, s30, s71
    s_mul_i32 s71, s71, 20480
    s_lshl_b32 s33, s41, 7
    s_add_u32 s71, s71, s33
    s_add_u32 s72, s71, 10240
    s_add_u32 s73, s71, 20480
    s_add_u32 s74, s71, 30720
    s_lshl_b32 s3, s30, 12
    s_add_u32 s3, s3, 140288
    v_lshl_add_u32 v33, v1, 4, s3
    v_and_b32 v2, 15, v1
    v_lshrrev_b32 v3, 1, v2
    v_lshrrev_b32 v4, 5, v1
    v_xor_b32 v3, v3, v4
    v_lshlrev_b32 v3, 4, v3
    v_lshl_add_u32 v3, v2, 7, v3
    v_and_b32 v4, 1, v9
    v_lshl_add_u32 v3, v4, 3, v3
    v_add_u32 v29, s3, v3
    v_xor_b32 v30, 32, v29
    v_xor_b32 v31, 64, v29
    v_xor_b32 v32, 96, v29
    s_and_b32 s33, s40, 3
    s_lshl_b32 s33, s33, 3
    s_lshr_b32 s33, 0x7f06037f, s33
    s_and_b32 s33, s33, 0xff
    s_lshl_b32 s3, s30, 1
    s_cmp_ge_u32 s3, s33
    s_cselect_b32 s64, 16, 0
    s_add_u32 s3, s3, 1
    s_cmp_ge_u32 s3, s33
    s_cselect_b32 s65, 16, 0
    s_mov_b32 s63, 0
    s_mov_b32 s66, 0
    s_mov_b32 s67, 16384
    s_mov_b32 s3, 1048576
K_P2_GWA:
    ds_read_b32 v2, v12 offset:72
    s_sub_u32 s3, s3, 1
    s_waitcnt lgkmcnt(0)
    v_readfirstlane_b32 s33, v2
    s_nop 3
    s_cselect_b32 s33, 4, s33
    s_cmp_lt_u32 s33, 4
    s_cbranch_scc1 K_P2_GWA
    s_branch K_P2_GEMM
WP_help:
    s_setpc_b64 s[38:39]
K_LATE:
    v_mov_b32 v6, 158800
    s_mov_b32 s3, 1048576
K_XGL:
    ds_read_b128 v[2:5], v6
    s_sleep 1
    s_sub_u32 s3, s3, 1
    s_waitcnt lgkmcnt(0)
    v_min3_u32 v2, v2, v4, v5
    v_min_u32 v2, v2, v3
    s_nop 0
    v_readfirstlane_b32 s33, v2
    s_nop 3
    s_cselect_b32 s33, 1, s33
    s_cmp_lt_u32 s33, 1
    s_cbranch_scc1 K_XGL
    s_sub_u32 s44, s30, 4
K_WOL:
    s_lshl_b32 s50, s44, 2
    s_lshr_b32 s50, 0x6431, s50
    s_and_b32 s50, s50, 7
    s_mul_i32 s50, s50, 51200
    s_mul_i32 s51, s44, 5120
    s_add_u32 s3, s50, 0
    s_add_u32 m0, s51, 40960
    s_waitcnt vmcnt(13)
    buffer_load_dwordx4 v17, s[24:27], s3 offen lds
    s_add_u32 s3, s50, 10240
    s_add_u32 m0, s51, 41984
    s_waitcnt vmcnt(13)
    buffer_load_dwordx4 v17, s[24:27], s3 offen lds
    s_add_u32 s3, s50, 20480
    s_add_u32 m0, s51, 43008
    s_waitcnt vmcnt(13)
    buffer_load_dwordx4 v17, s[24:27], s3 offen lds
    s_add_u32 s3, s50, 30720
    s_add_u32 m0, s51, 44032
    s_waitcnt vmcnt(13)
    buffer_load_dwordx4 v17, s[24:27], s3 offen lds
    s_add_u32 s3, s50, 40960
    s_add_u32 m0, s51, 45056
    s_waitcnt vmcnt(13)
    buffer_load_dwordx4 v17, s[24:27], s3 offen lds
    s_add_u32 s3, s50, 409600
    s_add_u32 m0, s51, 61440
    s_waitcnt vmcnt(13)
    buffer_load_dwordx4 v17, s[24:27], s3 offen lds
    s_add_u32 s3, s50, 419840
    s_add_u32 m0, s51, 62464
    s_waitcnt vmcnt(13)
    buffer_load_dwordx4 v17, s[24:27], s3 offen lds
    s_add_u32 s3, s50, 430080
    s_add_u32 m0, s51, 63488
    s_waitcnt vmcnt(13)
    buffer_load_dwordx4 v17, s[24:27], s3 offen lds
    s_add_u32 s3, s50, 440320
    s_add_u32 m0, s51, 64512
    s_waitcnt vmcnt(13)
    buffer_load_dwordx4 v17, s[24:27], s3 offen lds
    s_add_u32 s3, s50, 450560
    s_add_u32 m0, s51, 65536
    s_waitcnt vmcnt(13)
    buffer_load_dwordx4 v17, s[24:27], s3 offen lds
    s_add_u32 s44, s44, 2
    s_cmp_lt_u32 s44, 4
    s_cbranch_scc1 K_WOL
    v_mov_b32 v2, 158720
    v_mov_b32 v3, 2
    s_waitcnt vmcnt(0)
    s_mov_b64 exec, 1
    ds_add_u32 v2, v3 offset:44
    s_mov_b64 exec, -1
K_P2_HELP:
    s_setprio 3
    s_add_u32 s59, s40, 1
    s_bitcmp1_b32 s59, 1
    s_cselect_b32 s59, 31, 15
    v_and_b32 v10, s59, v1
    v_lshl_add_u32 v10, v10, 2, s42
    s_cmp_lg_u32 s30, 7
    s_cbranch_scc1 K_P2_N7
    v_and_b32 v4, 7, v1
    v_lshlrev_b32 v4, 2, v4
    s_mov_b32 s3, 131072
K_ZPOLL1:
    v_cmp_eq_u32 vcc, 0, v7
    s_cbranch_vccz K_ZOK1
    s_sub_u32 s3, s3, 1
    s_cbranch_scc1 K_ZOK1
    global_load_dword v7, v4, s[8:9] offset:192 sc1
    s_waitcnt vmcnt(0)
    s_branch K_ZPOLL1
K_ZOK1:
    global_load_dword v7, v10, s[10:11] sc1
K_P2_N7:
    s_lshl_b32 s54, s40, 7
    v_lshrrev_b32 v9, 4, v1
    v_mov_b32 v12, 158720
    s_add_u32 s44, s10, 0x10000
    s_addc_u32 s45, s11, 0
    s_mov_b32 s46, 0x43800
    s_mov_b32 s47, 0x20000
    v_mov_b32 v80, 1
    s_cmp_eq_u32 s30, 7
    s_cbranch_scc1 K_P2_FLAGS
    s_cmp_lg_u32 s30, 6
    s_cbranch_scc1 K_END
    s_mov_b32 s3, 131072
K_P2_DPOLL:
    v_cmp_eq_u32 vcc, 0, v7
    s_cbranch_vccz K_P2_DOK
    s_cmp_eq_u32 s3, 131072
    s_cbranch_scc1 K_P2_DNS
    s_sleep 12
K_P2_DNS:
    v_and_b32 v11, 1, v1
    v_lshl_add_u32 v11, v11, 2, s42
    global_load_dword v7, v11, s[10:11] offset:128 sc1
    s_sub_u32 s3, s3, 1
    s_waitcnt vmcnt(0)
    s_cmp_lg_u32 s3, 0
    s_cbranch_scc1 K_P2_DPOLL
K_P2_DOK:
    v_readlane_b32 s58, v7, 0
    v_readlane_b32 s59, v7, 1
    s_nop 3
    s_and_b32 s3, s58, 0x7ff
    s_sub_u32 s3, 2047, s3
    v_mov_b32 v20, s3
    v_mov_b32 v4, s58
    v_and_b32 v4, 0xffff0000, v4
    v_ashrrev_i32 v5, 31, v4
    v_not_b32 v5, v5
    v_or_b32 v5, 0x80000000, v5
    v_xor_b32 v4, v4, v5
    v_and_b32 v4, 0xffff0000, v4
    v_mul_f32 v5, 0xbfb8aa3b, v4
    v_exp_f32 v5, v5
    s_nop 0
    v_add_f32 v5, 1.0, v5
    v_rcp_f32 v4, v5
    s_nop 0
    v_cvt_pk_bf16_f32 v22, v4, v4
    v_lshlrev_b32 v22, 16, v22
    s_and_b32 s3, s59, 0x7ff
    s_sub_u32 s3, 2047, s3
    v_mov_b32 v21, s3
    v_mov_b32 v4, s59
    v_and_b32 v4, 0xffff0000, v4
    v_ashrrev_i32 v5, 31, v4
    v_not_b32 v5, v5
    v_or_b32 v5, 0x80000000, v5
    v_xor_b32 v4, v4, v5
    v_and_b32 v4, 0xffff0000, v4
    v_mul_f32 v5, 0xbfb8aa3b, v4
    v_exp_f32 v5, v5
    s_nop 0
    v_add_f32 v5, 1.0, v5
    v_rcp_f32 v4, v5
    s_nop 0
    v_cvt_pk_bf16_f32 v23, v4, v4
    v_lshlrev_b32 v23, 16, v23
    ds_write_b128 v12, v[20:23]
    ds_write_b32 v12, v80 offset:40
    s_mov_b32 s53, 0
    v_mov_b32 v16, v20
    v_mov_b32 v17, v21
    v_mov_b32 v18, v22
    v_mov_b32 v19, v23
K_P2_HW:
    s_cmp_eq_u32 s53, 0
    s_cselect_b64 vcc, -1, 0
    s_nop 1
    v_cndmask_b32 v2, v17, v16, vcc
    v_cndmask_b32 v5, v19, v18, vcc
    s_nop 0
    v_readfirstlane_b32 s58, v2
    s_nop 3
    s_sub_u32 s3, s58, s54
    s_cmp_lt_u32 s3, 128
    s_cbranch_scc0 K_P2_YN
    s_call_b64 s[38:39], WP_yr0
    s_mul_i32 s3, s58, 1280
    s_lshl_b32 s33, s41, 7
    s_add_u32 s3, s3, s33
    v_and_b32 v2, 15, v1
    v_lshlrev_b32 v2, 3, v2
    buffer_load_dwordx2 v[84:85], v2, s[12:15], s3 offen
    s_lshl_b32 s3, s58, 2
    s_add_u32 s3, s3, 4096
    v_mov_b32 v2, s3
    global_load_dword v88, v2, s[10:11] sc1
    s_lshl1_add_u32 s3, s41, s53
    s_lshl_b32 s3, s3, 8
    s_add_u32 s3, s3, 568320
    v_min_u32 v3, 53, v1
    v_lshl_add_u32 v3, v3, 2, s3
    s_mov_b32 s3, 131072
K_P2_YPOLL:
    global_load_dword v2, v3, s[10:11] sc1
    s_sub_u32 s3, s3, 1
    s_waitcnt vmcnt(0)
    v_cmp_ne_u32 vcc, 1, v2
    s_cbranch_vccz K_P2_YGO
    s_bcnt1_i32_b64 s33, vcc
    s_cmp_le_u32 s33, 24
    s_cbranch_scc1 K_P2_YS
    s_sleep 16
K_P2_YS:
    s_sleep 2
    s_cmp_lg_u32 s3, 0
    s_cbranch_scc1 K_P2_YPOLL
K_P2_YGO:
    v_and_b32 v2, 15, v1
    v_lshlrev_b32 v2, 4, v2
    v_mul_u32_u24 v4, 5120, v9
    s_mov_b32 s59, s53
    s_mul_i32 s33, s59, 2560
    s_lshl_b32 s3, s41, 8
    s_add_u32 s3, s3, s33
    v_add3_u32 v3, v2, v4, s3
    s_mov_b32 s52, 0
    buffer_load_dwordx4 v[24:27], v3, s[44:47], s52 offen sc1
    s_mov_b32 s52, 20480
    buffer_load_dwordx4 v[28:31], v3, s[44:47], s52 offen sc1
    s_mov_b32 s52, 40960
    buffer_load_dwordx4 v[32:35], v3, s[44:47], s52 offen sc1
    s_mov_b32 s52, 61440
    buffer_load_dwordx4 v[36:39], v3, s[44:47], s52 offen sc1
    s_mov_b32 s52, 81920
    buffer_load_dwordx4 v[40:43], v3, s[44:47], s52 offen sc1
    s_mov_b32 s52, 102400
    buffer_load_dwordx4 v[44:47], v3, s[44:47], s52 offen sc1
    s_mov_b32 s52, 122880
    buffer_load_dwordx4 v[48:51], v3, s[44:47], s52 offen sc1
    s_mov_b32 s52, 143360
    buffer_load_dwordx4 v[52:55], v3, s[44:47], s52 offen sc1
    s_mov_b32 s52, 163840
    buffer_load_dwordx4 v[56:59], v3, s[44:47], s52 offen sc1
    s_mov_b32 s52, 184320
    buffer_load_dwordx4 v[60:63], v3, s[44:47], s52 offen sc1
    s_mov_b32 s52, 204800
    buffer_load_dwordx4 v[64:67], v3, s[44:47], s52 offen sc1
    s_mov_b32 s52, 225280
    buffer_load_dwordx4 v[68:71], v3, s[44:47], s52 offen sc1
    s_mov_b32 s52, 245760
    buffer_load_dwordx4 v[72:75], v3, s[44:47], s52 offen sc1
    s_mov_b32 s52, 266240
    buffer_load_dwordx4 v[76:79], v3, s[44:47], s52 offen sc1
    v_sub_f32 v88, 1.0, v88
    v_cvt_pk_bf16_f32 v88, v88, v88
    v_lshlrev_b32 v88, 16, v88
    v_lshlrev_b32 v86, 16, v85
    v_and_b32 v87, 0xffff0000, v85
    v_and_b32 v85, 0xffff0000, v84
    v_lshlrev_b32 v84, 16, v84
    s_waitcnt vmcnt(12)
    v_pk_add_f32 v[20:21], v[24:25], v[28:29]
    v_pk_add_f32 v[22:23], v[26:27], v[30:31]
    s_waitcnt vmcnt(11)
    v_pk_add_f32 v[20:21], v[20:21], v[32:33]
    v_pk_add_f32 v[22:23], v[22:23], v[34:35]
    s_waitcnt vmcnt(10)
    v_pk_add_f32 v[20:21], v[20:21], v[36:37]
    v_pk_add_f32 v[22:23], v[22:23], v[38:39]
    s_waitcnt vmcnt(9)
    v_pk_add_f32 v[20:21], v[20:21], v[40:41]
    v_pk_add_f32 v[22:23], v[22:23], v[42:43]
    s_waitcnt vmcnt(8)
    v_pk_add_f32 v[20:21], v[20:21], v[44:45]
    v_pk_add_f32 v[22:23], v[22:23], v[46:47]
    s_waitcnt vmcnt(7)
    v_pk_add_f32 v[20:21], v[20:21], v[48:49]
    v_pk_add_f32 v[22:23], v[22:23], v[50:51]
    s_waitcnt vmcnt(6)
    v_pk_add_f32 v[20:21], v[20:21], v[52:53]
    v_pk_add_f32 v[22:23], v[22:23], v[54:55]
    s_waitcnt vmcnt(5)
    v_pk_add_f32 v[20:21], v[20:21], v[56:57]
    v_pk_add_f32 v[22:23], v[22:23], v[58:59]
    s_waitcnt vmcnt(4)
    v_pk_add_f32 v[20:21], v[20:21], v[60:61]
    v_pk_add_f32 v[22:23], v[22:23], v[62:63]
    s_waitcnt vmcnt(3)
    v_pk_add_f32 v[20:21], v[20:21], v[64:65]
    v_pk_add_f32 v[22:23], v[22:23], v[66:67]
    s_waitcnt vmcnt(2)
    v_pk_add_f32 v[20:21], v[20:21], v[68:69]
    v_pk_add_f32 v[22:23], v[22:23], v[70:71]
    s_waitcnt vmcnt(1)
    v_pk_add_f32 v[20:21], v[20:21], v[72:73]
    v_pk_add_f32 v[22:23], v[22:23], v[74:75]
    s_waitcnt vmcnt(0)
    v_pk_add_f32 v[20:21], v[20:21], v[76:77]
    v_pk_add_f32 v[22:23], v[22:23], v[78:79]
    v_mov_b32 v24, v20
    v_mov_b32 v25, v21
    v_mov_b32 v26, v22
    v_mov_b32 v27, v23
    s_nop 0
    v_permlane16_swap_b32 v20, v24
    v_permlane16_swap_b32 v21, v25
    v_permlane16_swap_b32 v22, v26
    v_permlane16_swap_b32 v23, v27
    v_add_f32 v20, v20, v24
    v_add_f32 v21, v21, v25
    v_add_f32 v22, v22, v26
    v_add_f32 v23, v23, v27
    v_mov_b32 v24, v20
    v_mov_b32 v25, v21
    v_mov_b32 v26, v22
    v_mov_b32 v27, v23
    s_nop 0
    v_permlane32_swap_b32 v20, v24
    v_permlane32_swap_b32 v21, v25
    v_permlane32_swap_b32 v22, v26
    v_permlane32_swap_b32 v23, v27
    v_add_f32 v20, v20, v24
    v_add_f32 v21, v21, v25
    v_add_f32 v22, v22, v26
    v_add_f32 v23, v23, v27
    v_cvt_pk_bf16_f32 v20, v20, v20
    v_lshlrev_b32 v20, 16, v20
    v_mul_f32 v20, v5, v20
    v_cvt_pk_bf16_f32 v20, v20, v20
    v_lshlrev_b32 v20, 16, v20
    v_add_f32 v20, v20, v84
    v_cvt_pk_bf16_f32 v20, v20, v20
    v_lshlrev_b32 v20, 16, v20
    v_mul_f32 v20, v20, v88
    v_cvt_pk_bf16_f32 v21, v21, v21
    v_lshlrev_b32 v21, 16, v21
    v_mul_f32 v21, v5, v21
    v_cvt_pk_bf16_f32 v21, v21, v21
    v_lshlrev_b32 v21, 16, v21
    v_add_f32 v21, v21, v85
    v_cvt_pk_bf16_f32 v21, v21, v21
    v_lshlrev_b32 v21, 16, v21
    v_mul_f32 v21, v21, v88
    v_cvt_pk_bf16_f32 v22, v22, v22
    v_lshlrev_b32 v22, 16, v22
    v_mul_f32 v22, v5, v22
    v_cvt_pk_bf16_f32 v22, v22, v22
    v_lshlrev_b32 v22, 16, v22
    v_add_f32 v22, v22, v86
    v_cvt_pk_bf16_f32 v22, v22, v22
    v_lshlrev_b32 v22, 16, v22
    v_mul_f32 v22, v22, v88
    v_cvt_pk_bf16_f32 v23, v23, v23
    v_lshlrev_b32 v23, 16, v23
    v_mul_f32 v23, v5, v23
    v_cvt_pk_bf16_f32 v23, v23, v23
    v_lshlrev_b32 v23, 16, v23
    v_add_f32 v23, v23, v87
    v_cvt_pk_bf16_f32 v23, v23, v23
    v_lshlrev_b32 v23, 16, v23
    v_mul_f32 v23, v23, v88
    s_lshl_b32 s3, s59, 8
    s_add_u32 s3, s3, 158976
    v_add_u32 v2, s3, v2
    ds_write_b128 v2, v[20:23]
    s_lshl_b32 s3, s59, 2
    v_add_u32 v2, s3, v12
    ds_write_b32 v2, v80 offset:64
K_P2_YN:
    s_add_u32 s53, s53, 1
    s_cmp_lt_u32 s53, 2
    s_cbranch_scc1 K_P2_HW
    s_branch K_END
WP_flags:
    s_setpc_b64 s[38:39]
K_P2_FLAGS:
    s_mov_b32 exec_hi, 0
    s_waitcnt vmcnt(0)
    s_mov_b32 s3, 131072
K_P2_FCHK:
    v_cmp_eq_u32 vcc, 1, v7
    s_nop 1
    v_mov_b32 v2, vcc_lo
    ds_write_b32 v12, v2 offset:32
    s_cmp_eq_u32 vcc_lo, -1
    s_cbranch_scc1 K_P2_FGO
    s_cmp_lg_u32 vcc_lo, 0
    s_cbranch_scc1 K_P2_FS
    s_sleep 4
K_P2_FS:
    s_sleep 6
    global_load_dword v7, v10, s[10:11] sc1
    s_sub_u32 s3, s3, 1
    s_waitcnt vmcnt(0)
    s_cbranch_scc0 K_P2_FCHK
    v_mov_b32 v2, -1
    ds_write_b32 v12, v2 offset:32
K_P2_FGO:
    s_mov_b64 exec, -1
    s_branch K_END
.p2align 12
K_AUX:
    s_load_dwordx8 s[48:55], s[0:1], 32
    s_load_dwordx2 s[56:57], s[0:1], 64
    s_mul_i32 s44, s28, 7
    s_add_u32 s44, s44, s29
    s_sub_u32 s44, s44, 1
    s_cmp_lt_u32 s44, 54
    s_cselect_b32 s44, s44, 63
    s_cmp_eq_u32 s29, 0
    s_cselect_b32 s44, 63, s44
    s_lshl_b32 s74, s28, 8
    s_lshl_b32 s3, s29, 5
    s_add_u32 s74, s74, s3
    v_mov_b32 v12, 158720
    v_mov_b32 v13, 1
    s_cmp_lt_u32 s30, 4
    s_cbranch_scc1 K_AUX_LO
    s_lshl_b32 s3, s30, 3
    s_add_u32 s3, s3, s74
    s_sub_u32 s3, s3, 32
    v_lshrrev_b32 v9, 3, v1
    v_add_u32 v9, s3, v9
    v_and_b32 v11, 7, v1
    v_lshlrev_b32 v11, 4, v11
    v_mul_u32_u24 v10, 1280, v9
    v_add_u32 v10, v10, v11
    v_lshlrev_b32 v2, 4, v1
    s_and_b32 s72, s30, 1
    s_lshl_b32 s72, s72, 10
    s_lshl_b32 s3, s30, 10
    s_add_u32 m0, s3, 123776
    s_mov_b32 s18, 1280
    s_mov_b32 s19, 0x20000
    s_cmp_lt_u32 s30, 6
    s_waitcnt lgkmcnt(0)
    s_cselect_b64 s[16:17], s[48:49], s[56:57]
    buffer_load_dwordx4 v2, s[16:19], s72 offen lds
    buffer_load_dwordx4 v[16:19], v10, s[12:15], 0 offen offset:0
    buffer_load_dwordx4 v[20:23], v10, s[12:15], 0 offen offset:128
    buffer_load_dwordx4 v[24:27], v10, s[12:15], 0 offen offset:256
    buffer_load_dwordx4 v[28:31], v10, s[12:15], 0 offen offset:384
    buffer_load_dwordx4 v[32:35], v10, s[12:15], 0 offen offset:512
    buffer_load_dwordx4 v[36:39], v10, s[12:15], 0 offen offset:640
    buffer_load_dwordx4 v[40:43], v10, s[12:15], 0 offen offset:768
    buffer_load_dwordx4 v[44:47], v10, s[12:15], 0 offen offset:896
    buffer_load_dwordx4 v[48:51], v10, s[12:15], 0 offen offset:1024
    buffer_load_dwordx4 v[52:55], v10, s[12:15], 0 offen offset:1152
    v_add_u32 v11, 127872, v11
    s_barrier
    v_mov_b32 v180, 0
    v_mov_b32 v181, 0
    v_mov_b32 v182, 0
    v_mov_b32 v183, 0
    v_and_b32 v10, 31, v9
    v_lshlrev_b32 v10, 2, v10
    v_add_u32 v10, 122880, v10
    v_sub_u32 v4, 0x87ff, v9
    s_setprio 2
    s_waitcnt vmcnt(10)
    s_mov_b64 exec, 1
    ds_add_u32 v12, v13 offset:76
    s_mov_b64 exec, -1
    s_mov_b32 s3, 1048576
K_FGWV:
    ds_read_b32 v2, v12 offset:76
    s_sleep 0
    s_sub_u32 s3, s3, 1
    s_waitcnt lgkmcnt(0)
    v_readfirstlane_b32 s33, v2
    s_nop 3
    s_cselect_b32 s33, 4, s33
    s_cmp_lt_u32 s33, 4
    s_cbranch_scc1 K_FGWV
    ds_read_b128 v[56:59], v11 offset:0
    ds_read_b128 v[60:63], v11 offset:128
    ds_read_b128 v[64:67], v11 offset:256
    ds_read_b128 v[68:71], v11 offset:384
    ds_read_b128 v[72:75], v11 offset:512
    ds_read_b128 v[76:79], v11 offset:640
    ds_read_b128 v[80:83], v11 offset:768
    ds_read_b128 v[84:87], v11 offset:896
    ds_read_b128 v[88:91], v11 offset:1024
    ds_read_b128 v[92:95], v11 offset:1152
    ds_read_b128 v[96:99], v11 offset:2048
    ds_read_b128 v[100:103], v11 offset:2176
    ds_read_b128 v[104:107], v11 offset:2304
    ds_read_b128 v[108:111], v11 offset:2432
    ds_read_b128 v[112:115], v11 offset:2560
    ds_read_b128 v[116:119], v11 offset:2688
    ds_read_b128 v[120:123], v11 offset:2816
    ds_read_b128 v[124:127], v11 offset:2944
    ds_read_b128 v[128:131], v11 offset:3072
    ds_read_b128 v[132:135], v11 offset:3200
    s_waitcnt lgkmcnt(0)
    s_waitcnt vmcnt(9)
    v_dot2c_f32_bf16 v180, v16, v56
    v_dot2c_f32_bf16 v182, v16, v96
    v_dot2c_f32_bf16 v181, v17, v57
    v_dot2c_f32_bf16 v183, v17, v97
    v_dot2c_f32_bf16 v180, v18, v58
    v_dot2c_f32_bf16 v182, v18, v98
    v_dot2c_f32_bf16 v181, v19, v59
    v_dot2c_f32_bf16 v183, v19, v99
    s_waitcnt vmcnt(8)
    v_dot2c_f32_bf16 v180, v20, v60
    v_dot2c_f32_bf16 v182, v20, v100
    v_dot2c_f32_bf16 v181, v21, v61
    v_dot2c_f32_bf16 v183, v21, v101
    v_dot2c_f32_bf16 v180, v22, v62
    v_dot2c_f32_bf16 v182, v22, v102
    v_dot2c_f32_bf16 v181, v23, v63
    v_dot2c_f32_bf16 v183, v23, v103
    s_waitcnt vmcnt(7)
    v_dot2c_f32_bf16 v180, v24, v64
    v_dot2c_f32_bf16 v182, v24, v104
    v_dot2c_f32_bf16 v181, v25, v65
    v_dot2c_f32_bf16 v183, v25, v105
    v_dot2c_f32_bf16 v180, v26, v66
    v_dot2c_f32_bf16 v182, v26, v106
    v_dot2c_f32_bf16 v181, v27, v67
    v_dot2c_f32_bf16 v183, v27, v107
    s_waitcnt vmcnt(6)
    v_dot2c_f32_bf16 v180, v28, v68
    v_dot2c_f32_bf16 v182, v28, v108
    v_dot2c_f32_bf16 v181, v29, v69
    v_dot2c_f32_bf16 v183, v29, v109
    v_dot2c_f32_bf16 v180, v30, v70
    v_dot2c_f32_bf16 v182, v30, v110
    v_dot2c_f32_bf16 v181, v31, v71
    v_dot2c_f32_bf16 v183, v31, v111
    s_waitcnt vmcnt(5)
    v_dot2c_f32_bf16 v180, v32, v72
    v_dot2c_f32_bf16 v182, v32, v112
    v_dot2c_f32_bf16 v181, v33, v73
    v_dot2c_f32_bf16 v183, v33, v113
    v_dot2c_f32_bf16 v180, v34, v74
    v_dot2c_f32_bf16 v182, v34, v114
    v_dot2c_f32_bf16 v181, v35, v75
    v_dot2c_f32_bf16 v183, v35, v115
    s_waitcnt vmcnt(4)
    v_dot2c_f32_bf16 v180, v36, v76
    v_dot2c_f32_bf16 v182, v36, v116
    v_dot2c_f32_bf16 v181, v37, v77
    v_dot2c_f32_bf16 v183, v37, v117
    v_dot2c_f32_bf16 v180, v38, v78
    v_dot2c_f32_bf16 v182, v38, v118
    v_dot2c_f32_bf16 v181, v39, v79
    v_dot2c_f32_bf16 v183, v39, v119
    s_waitcnt vmcnt(3)
    v_dot2c_f32_bf16 v180, v40, v80
    v_dot2c_f32_bf16 v182, v40, v120
    v_dot2c_f32_bf16 v181, v41, v81
    v_dot2c_f32_bf16 v183, v41, v121
    v_dot2c_f32_bf16 v180, v42, v82
    v_dot2c_f32_bf16 v182, v42, v122
    v_dot2c_f32_bf16 v181, v43, v83
    v_dot2c_f32_bf16 v183, v43, v123
    s_waitcnt vmcnt(2)
    v_dot2c_f32_bf16 v180, v44, v84
    v_dot2c_f32_bf16 v182, v44, v124
    v_dot2c_f32_bf16 v181, v45, v85
    v_dot2c_f32_bf16 v183, v45, v125
    v_dot2c_f32_bf16 v180, v46, v86
    v_dot2c_f32_bf16 v182, v46, v126
    v_dot2c_f32_bf16 v181, v47, v87
    v_dot2c_f32_bf16 v183, v47, v127
    s_waitcnt vmcnt(1)
    v_dot2c_f32_bf16 v180, v48, v88
    v_dot2c_f32_bf16 v182, v48, v128
    v_dot2c_f32_bf16 v181, v49, v89
    v_dot2c_f32_bf16 v183, v49, v129
    v_dot2c_f32_bf16 v180, v50, v90
    v_dot2c_f32_bf16 v182, v50, v130
    v_dot2c_f32_bf16 v181, v51, v91
    v_dot2c_f32_bf16 v183, v51, v131
    s_waitcnt vmcnt(0)
    v_dot2c_f32_bf16 v180, v52, v92
    v_dot2c_f32_bf16 v182, v52, v132
    v_dot2c_f32_bf16 v181, v53, v93
    v_dot2c_f32_bf16 v183, v53, v133
    v_dot2c_f32_bf16 v180, v54, v94
    v_dot2c_f32_bf16 v182, v54, v134
    v_dot2c_f32_bf16 v181, v55, v95
    v_dot2c_f32_bf16 v183, v55, v135
    s_nop 2
    v_add_f32 v180, v180, v181
    v_add_f32 v182, v182, v183
    s_nop 0
    v_add_f32_dpp v180, v180, v180 quad_perm:[1,0,3,2] row_mask:0xf bank_mask:0xf
    v_add_f32_dpp v182, v182, v182 quad_perm:[1,0,3,2] row_mask:0xf bank_mask:0xf
    s_nop 0
    v_add_f32_dpp v180, v180, v180 quad_perm:[2,3,0,1] row_mask:0xf bank_mask:0xf
    v_add_f32_dpp v182, v182, v182 quad_perm:[2,3,0,1] row_mask:0xf bank_mask:0xf
    s_nop 0
    v_add_f32_dpp v180, v180, v180 row_half_mirror row_mask:0xf bank_mask:0xf
    v_add_f32_dpp v182, v182, v182 row_half_mirror row_mask:0xf bank_mask:0xf
    v_cvt_pk_bf16_f32 v2, v180, v180
    v_lshlrev_b32 v2, 16, v2
    v_ashrrev_i32 v3, 31, v2
    v_or_b32 v3, 0x80000000, v3
    v_xor_b32 v2, v2, v3
    v_and_b32 v2, 0xffff0000, v2
    v_or_b32 v2, v2, v4
    ds_write2_b32 v10, v2, v182 offset0:0 offset1:32
    s_mov_b64 exec, 1
    ds_add_u32 v12, v13 offset:36
    s_mov_b64 exec, -1
    s_setprio 0
    s_cmp_lg_u32 s30, 4
    s_cbranch_scc1 K_WARMA0
    s_call_b64 s[38:39], WP_p2g
    s_branch K_WARMAX
K_WARMA0:
    s_cmp_lg_u32 s30, 5
    s_cbranch_scc1 K_WARMA1
    s_call_b64 s[38:39], WP_gen
    s_branch K_WARMAX
K_WARMA1:
    s_cmp_lg_u32 s30, 6
    s_cbranch_scc1 K_WARMA2
    s_call_b64 s[38:39], WP_help
    s_call_b64 s[38:39], WP_flags
    s_branch K_WARMAX
K_WARMA2:
    s_call_b64 s[38:39], WP_spin
K_WARMAX:
    s_cmp_ge_u32 s30, 6
    s_cselect_b32 s44, 63, s44
    s_cmp_lg_u32 s44, 63
    s_cbranch_scc1 K_FFN_C
    s_mov_b32 s3, 1048576
K_FGH:
    ds_read_b32 v2, v12 offset:48
    s_sleep 8
    s_sub_u32 s3, s3, 1
    s_waitcnt lgkmcnt(0)
    v_readfirstlane_b32 s33, v2
    s_nop 3
    s_cselect_b32 s33, 1, s33
    s_cmp_lt_u32 s33, 1
    s_cbranch_scc1 K_FGH
    s_cmp_eq_u32 s30, 6
    s_cbranch_scc1 K_P2_HELP
    v_mov_b32 v7, 1
    s_branch K_P2_HELP
K_AUX_LO:
    v_mov_b32 v2, 786432
    s_cmp_lg_u32 s30, 0
    s_waitcnt lgkmcnt(0)
    s_cbranch_scc1 K_AUX_LO1
    global_load_dword v17, v2, s[10:11] sc1
K_AUX_LO1:
    s_barrier
    s_cmp_eq_u32 s30, 0
    s_cbranch_scc1 K_AUX_PUB
    s_cmp_eq_u32 s44, 63
    s_cbranch_scc1 K_AUX_NOF
    s_and_b32 s3, s44, 1
    s_cmp_eq_u32 s3, 0
    s_cselect_b64 s[60:61], s[50:51], s[52:53]
    s_cselect_b64 s[64:65], s[52:53], s[50:51]
    s_cselect_b32 s75, 0, 40960
    s_mov_b32 s62, 0x21c000
    s_mov_b32 s63, 0x20000
    s_mov_b32 s66, 0x21c000
    s_mov_b32 s67, 0x20000
    v_lshrrev_b32 v2, 2, v1
    v_mul_u32_u24 v184, 3456, v2
    v_and_b32 v2, 3, v1
    v_lshl_add_u32 v184, v2, 4, v184
    s_lshl_b32 s72, s44, 6
    v_add_u32 v184, s72, v184
    s_sub_u32 s74, s30, 1
K_FSA0:
    s_lshl_b32 s73, s74, 10
    s_mul_i32 s72, s74, 55296
    s_add_u32 m0, s73, s75
    s_waitcnt vmcnt(7)
    buffer_load_dwordx4 v184, s[60:63], s72 offen lds
    s_add_u32 s74, s74, 3
    s_cmp_lt_u32 s74, 24
    s_cbranch_scc1 K_FSA0
    s_mov_b32 s3, 1048576
K_FGPB:
    ds_read_b32 v2, v12 offset:36
    s_sleep 1
    s_sub_u32 s3, s3, 1
    s_waitcnt lgkmcnt(0)
    v_readfirstlane_b32 s33, v2
    s_nop 3
    s_cselect_b32 s33, 5, s33
    s_cmp_lt_u32 s33, 5
    s_cbranch_scc1 K_FGPB
K_FSA:
    s_lshl_b32 s73, s74, 10
    s_mul_i32 s72, s74, 55296
    s_add_u32 m0, s73, s75
    s_waitcnt vmcnt(7)
    buffer_load_dwordx4 v184, s[60:63], s72 offen lds
    s_add_u32 s74, s74, 3
    s_cmp_lt_u32 s74, 40
    s_cbranch_scc1 K_FSA
    s_sub_u32 s74, s74, 40
    s_xor_b32 s75, s75, 40960
    s_mov_b32 s68, s54
    s_mov_b32 s69, s55
    s_mov_b32 s70, 0x21c000
    s_mov_b32 s71, 0x20000
    s_mul_i32 s3, s44, 40960
    v_lshrrev_b32 v2, 3, v1
    v_mul_u32_u24 v2, 1280, v2
    v_lshrrev_b32 v3, 4, v1
    v_lshlrev_b32 v3, 1, v3
    v_and_b32 v4, 7, v1
    v_xor_b32 v3, v3, v4
    v_lshl_add_u32 v2, v3, 4, v2
    v_add_u32 v185, s3, v2
K_FSB:
    s_lshl_b32 s73, s74, 10
    s_mul_i32 s72, s74, 55296
    s_add_u32 m0, s73, s75
    s_waitcnt vmcnt(7)
    buffer_load_dwordx4 v184, s[64:67], s72 offen lds
    s_add_u32 s74, s74, 3
    s_cmp_lt_u32 s74, 40
    s_cbranch_scc1 K_FSB
    s_sub_u32 s74, s74, 40
    s_mov_b32 s75, 81920
K_FSD0:
    s_lshl_b32 s73, s74, 10
    s_and_b32 s72, s74, 3
    s_mul_i32 s72, s72, 10208
    s_lshl_b32 s3, s74, 5
    s_add_u32 s72, s72, s3
    s_add_u32 m0, s73, s75
    s_waitcnt vmcnt(7)
    buffer_load_dwordx4 v185, s[68:71], s72 offen lds
    s_add_u32 s74, s74, 3
    s_cmp_lt_u32 s74, 24
    s_cbranch_scc1 K_FSD0
    s_waitcnt vmcnt(8)
    s_mov_b64 exec, 1
    ds_add_u32 v12, v13 offset:56
    s_mov_b64 exec, -1
K_FSD:
    s_lshl_b32 s73, s74, 10
    s_and_b32 s72, s74, 3
    s_mul_i32 s72, s72, 10208
    s_lshl_b32 s3, s74, 5
    s_add_u32 s72, s72, s3
    s_add_u32 m0, s73, s75
    s_waitcnt vmcnt(7)
    buffer_load_dwordx4 v185, s[68:71], s72 offen lds
    s_add_u32 s74, s74, 3
    s_cmp_lt_u32 s74, 40
    s_cbranch_scc1 K_FSD
    s_mul_i32 s3, s29, 96
    s_lshl_b32 s72, s30, 5
    s_add_u32 s3, s3, s72
    s_sub_u32 s3, s3, 128
    v_lshrrev_b32 v2, 1, v1
    v_add_u32 v2, s3, v2
    v_mul_u32_u24 v2, 1280, v2
    v_and_b32 v3, 1, v1
    v_lshl_add_u32 v2, v3, 7, v2
    buffer_load_dword v6, v2, s[24:27], 0 offen offset:1024
K_AUX_WR:
    s_mov_b32 s3, 1048576
K_FGR:
    ds_read_b32 v2, v12 offset:60
    s_sleep 2
    s_sub_u32 s3, s3, 1
    s_waitcnt lgkmcnt(0)
    v_readfirstlane_b32 s33, v2
    s_nop 3
    s_cselect_b32 s33, 2, s33
    s_cmp_lt_u32 s33, 2
    s_cbranch_scc1 K_FGR
    s_branch K_P2
K_AUX_NOF:
    s_cmp_lg_u32 s2, 63
    s_cbranch_scc1 K_AUX_NOZ
    s_cmp_lg_u32 s30, 1
    s_cbranch_scc1 K_AUX_NOZ
    s_add_u32 s60, s10, 0x80000
    s_addc_u32 s61, s11, 0
    s_mov_b32 s62, 0xc000
    s_mov_b32 s63, 0x20000
    v_mov_b32 v9, 786432
    global_load_dword v10, v9, s[10:11] sc1
    v_lshlrev_b32 v11, 4, v1
    v_add_u32 v11, 790528, v11
    global_load_dword v6, v11, s[10:11] sc1
    s_mov_b32 s3, 1048576
K_FGZ:
    ds_read_b32 v2, v12 offset:36
    s_sleep 2
    s_sub_u32 s3, s3, 1
    s_waitcnt lgkmcnt(0)
    v_readfirstlane_b32 s33, v2
    s_nop 3
    s_cselect_b32 s33, 4, s33
    s_cmp_lt_u32 s33, 4
    s_cbranch_scc1 K_FGZ
    v_and_b32 v4, 7, v1
    v_lshlrev_b32 v4, 2, v4
    global_load_dword v7, v4, s[8:9] offset:192 sc1
    s_waitcnt vmcnt(1)
    v_add_u32 v10, 1, v10
    s_mov_b32 s3, 131072
    s_setprio 3
K_AG2_POLL:
    global_load_dwordx4 v[16:19], v11, s[10:11] sc1
    s_waitcnt vmcnt(0)
    v_xor_b32 v2, v10, v17
    v_xor_b32 v3, v10, v19
    v_or_b32 v2, v2, v3
    v_cmp_ne_u32 vcc, 0, v2
    s_cbranch_vccz K_AG2_GOT
    s_sleep 2
    s_sub_u32 s3, s3, 1
    s_cmp_lg_u32 s3, 0
    s_cbranch_scc1 K_AG2_POLL
K_AG2_GOT:
    s_nop 1
    v_max_u32_dpp v3, v16, v16 quad_perm:[1,0,3,2] row_mask:0xf bank_mask:0xf
    s_nop 1
    v_max_u32_dpp v3, v3, v3 quad_perm:[2,3,0,1] row_mask:0xf bank_mask:0xf
    s_nop 1
    v_max_u32_dpp v3, v3, v3 row_half_mirror row_mask:0xf bank_mask:0xf
    s_nop 1
    v_max_u32_dpp v3, v3, v3 row_mirror row_mask:0xf bank_mask:0xf
    s_nop 1
    v_readlane_b32 s74, v3, 0
    v_readlane_b32 s76, v3, 16
    v_readlane_b32 s77, v3, 32
    v_readlane_b32 s78, v3, 48
    s_nop 3
    s_max_u32 s74, s74, s76
    s_max_u32 s77, s77, s78
    s_max_u32 s74, s74, s77
    v_cmp_ne_u32 vcc, s74, v16
    s_nop 1
    v_cndmask_b32 v2, v18, v16, vcc
    s_nop 1
    v_max_u32_dpp v3, v2, v2 quad_perm:[1,0,3,2] row_mask:0xf bank_mask:0xf
    s_nop 1
    v_max_u32_dpp v3, v3, v3 quad_perm:[2,3,0,1] row_mask:0xf bank_mask:0xf
    s_nop 1
    v_max_u32_dpp v3, v3, v3 row_half_mirror row_mask:0xf bank_mask:0xf
    s_nop 1
    v_max_u32_dpp v3, v3, v3 row_mirror row_mask:0xf bank_mask:0xf
    s_nop 1
    v_readlane_b32 s75, v3, 0
    v_readlane_b32 s76, v3, 16
    v_readlane_b32 s77, v3, 32
    v_readlane_b32 s78, v3, 48
    s_nop 3
    s_max_u32 s75, s75, s76
    s_max_u32 s77, s77, s78
    s_max_u32 s75, s75, s77
    v_mov_b32 v176, s74
    v_mov_b32 v177, s75
    v_and_b32 v4, 7, v1
    v_lshlrev_b32 v4, 2, v4
    s_mov_b32 s3, 131072
K_ZPOLL4:
    v_cmp_eq_u32 vcc, 0, v7
    s_cbranch_vccz K_ZOK4
    s_sub_u32 s3, s3, 1
    s_cbranch_scc1 K_ZOK4
    global_load_dword v7, v4, s[8:9] offset:192 sc1
    s_waitcnt vmcnt(0)
    s_branch K_ZPOLL4
K_ZOK4:
    v_and_b32 v2, 7, v1
    v_mul_u32_u24 v2, 20, v2
    v_lshrrev_b32 v3, 3, v1
    v_add_lshl_u32 v2, v2, v3, 8
    buffer_store_dwordx2 v[176:177], v2, s[60:63], 0 offen offset:136 sc1
    s_mov_b64 exec, 1
    global_store_dword v9, v10, s[10:11] sc1
    s_mov_b64 exec, -1
    v_lshlrev_b32 v4, 2, v1
    s_mov_b32 s72, 43008
    s_mov_b32 s3, 131072
K_AGG_POLL:
    s_sleep 8
    buffer_load_dword v2, v4, s[60:63], s72 offen sc1
    s_waitcnt vmcnt(0)
    v_cmp_eq_u32 vcc, 0, v2
    s_cbranch_vccz K_AGG_GOT
    s_sub_u32 s3, s3, 1
    s_cmp_lg_u32 s3, 0
    s_cbranch_scc1 K_AGG_POLL
K_AGG_GOT:
    s_mov_b32 s62, 40960
    v_lshlrev_b32 v3, 8, v1
    s_mov_b32 s3, 0
    buffer_store_dwordx2 v[176:177], v3, s[60:63], s3 offen offset:128 sc1
    s_mov_b32 s3, 16384
    buffer_store_dwordx2 v[176:177], v3, s[60:63], s3 offen offset:128 sc1
    s_mov_b32 s3, 32768
    buffer_store_dwordx2 v[176:177], v3, s[60:63], s3 offen offset:128 sc1
    s_setprio 0
    s_branch K_AUX_NOK
K_AUX_NOZ:
K_AUX_NOK:
    s_mov_b32 s3, 1048576
K_FGWD:
    ds_read_b32 v2, v12 offset:48
    s_sleep 4
    s_sub_u32 s3, s3, 1
    s_waitcnt lgkmcnt(0)
    v_readfirstlane_b32 s33, v2
    s_nop 3
    s_cselect_b32 s33, 1, s33
    s_cmp_lt_u32 s33, 1
    s_cbranch_scc1 K_FGWD
    s_branch K_P2
K_AUX_PUB:
    s_add_u32 s60, s10, 0x1000
    s_addc_u32 s61, s11, 0
    s_mov_b32 s62, 0x2000
    s_mov_b32 s63, 0x20000
    v_and_b32 v3, 31, v1
    v_lshlrev_b32 v10, 2, v3
    v_add_u32 v11, 122880, v10
    s_lshl_b32 s72, s74, 2
    s_lshl_b32 s3, s2, 2
    s_add_u32 s3, s3, 567296
    v_mov_b32 v9, s3
    s_lshl_b32 s3, s2, 4
    s_add_u32 s3, s3, 790528
    v_lshl_add_u32 v20, v1, 4, s3
    v_and_b32 v5, 7, v1
    v_lshlrev_b32 v5, 2, v5
    s_setprio 3
    s_waitcnt vmcnt(0)
    v_add_u32 v17, 1, v17
    v_mov_b32 v19, v17
    s_mov_b32 s3, 1048576
K_FGRT:
    ds_read_b32 v2, v12 offset:36
    s_sleep 0
    s_sub_u32 s3, s3, 1
    s_waitcnt lgkmcnt(0)
    v_readfirstlane_b32 s33, v2
    s_nop 3
    s_cselect_b32 s33, 4, s33
    s_cmp_lt_u32 s33, 4
    s_cbranch_scc1 K_FGRT
    ds_read2_b32 v[176:177], v11 offset0:0 offset1:32
    s_waitcnt lgkmcnt(0)
    s_nop 1
    v_max_u32_dpp v3, v176, v176 quad_perm:[1,0,3,2] row_mask:0xf bank_mask:0xf
    s_nop 1
    v_max_u32_dpp v3, v3, v3 quad_perm:[2,3,0,1] row_mask:0xf bank_mask:0xf
    s_nop 1
    v_max_u32_dpp v3, v3, v3 row_half_mirror row_mask:0xf bank_mask:0xf
    s_nop 1
    v_max_u32_dpp v3, v3, v3 row_mirror row_mask:0xf bank_mask:0xf
    s_nop 1
    v_readlane_b32 s74, v3, 0
    v_readlane_b32 s76, v3, 16
    v_readlane_b32 s77, v3, 32
    v_readlane_b32 s78, v3, 48
    s_nop 3
    s_max_u32 s74, s74, s76
    s_max_u32 s77, s77, s78
    s_max_u32 s74, s74, s77
    v_cmp_ne_u32 vcc, s74, v176
    s_nop 1
    v_cndmask_b32 v176, 0, v176, vcc
    s_nop 1
    v_max_u32_dpp v3, v176, v176 quad_perm:[1,0,3,2] row_mask:0xf bank_mask:0xf
    s_nop 1
    v_max_u32_dpp v3, v3, v3 quad_perm:[2,3,0,1] row_mask:0xf bank_mask:0xf
    s_nop 1
    v_max_u32_dpp v3, v3, v3 row_half_mirror row_mask:0xf bank_mask:0xf
    s_nop 1
    v_max_u32_dpp v3, v3, v3 row_mirror row_mask:0xf bank_mask:0xf
    s_nop 1
    v_readlane_b32 s75, v3, 0
    v_readlane_b32 s76, v3, 16
    v_readlane_b32 s77, v3, 32
    v_readlane_b32 s78, v3, 48
    s_nop 3
    s_max_u32 s75, s75, s76
    s_max_u32 s77, s77, s78
    s_max_u32 s75, s75, s77
    v_mov_b32 v16, s74
    v_mov_b32 v18, s75
    s_mov_b64 exec, 1
    global_store_dwordx4 v20, v[16:19], s[10:11] sc1
    s_mov_b64 exec, -1
    s_mov_b64 exec, 1
    ds_add_u32 v12, v13 offset:36
    s_mov_b64 exec, -1
    global_load_dword v7, v5, s[8:9] offset:192 sc1
    v_cvt_pk_bf16_f32 v177, v177, v177
    v_lshlrev_b32 v177, 16, v177
    v_mul_f32 v3, 0xbfb8aa3b, v177
    v_exp_f32 v3, v3
    s_nop 0
    v_add_f32 v3, 1.0, v3
    v_rcp_f32 v177, v3
    s_nop 0
    v_cvt_pk_bf16_f32 v177, v177, v177
    v_lshlrev_b32 v177, 16, v177
    s_mov_b32 exec_hi, 0
    buffer_store_dword v177, v10, s[60:63], s72 offen sc1
    s_mov_b64 exec, -1
    s_waitcnt vmcnt(0)
    v_and_b32 v4, 7, v1
    v_lshlrev_b32 v4, 2, v4
    s_mov_b32 s3, 131072
K_ZPOLL3:
    v_cmp_eq_u32 vcc, 0, v7
    s_cbranch_vccz K_ZOK3
    s_sub_u32 s3, s3, 1
    s_cbranch_scc1 K_ZOK3
    global_load_dword v7, v4, s[8:9] offset:192 sc1
    s_waitcnt vmcnt(0)
    s_branch K_ZPOLL3
K_ZOK3:
    s_mov_b64 exec, 1
    global_store_dword v9, v13, s[10:11] sc1
    s_mov_b64 exec, -1
    v_and_b32 v3, 1, v1
    v_lshl_add_u32 v3, v3, 2, s42
    v_lshlrev_b32 v10, 4, v1
    s_mov_b32 s3, 131072
K_AUX_POLL:
    s_sleep 6
    global_load_dword v2, v3, s[10:11] offset:136 sc1
    s_waitcnt vmcnt(0)
    v_cmp_eq_u32 vcc, 0, v2
    s_cbranch_vccz K_AUX_GOT
    s_sub_u32 s3, s3, 1
    s_cmp_lg_u32 s3, 0
    s_cbranch_scc1 K_AUX_POLL
K_AUX_GOT:
    v_readlane_b32 s74, v2, 0
    v_readlane_b32 s75, v2, 1
    s_nop 3
    s_and_b32 s74, s74, 0x7ff
    s_sub_u32 s74, 2047, s74
    s_mul_i32 s74, s74, 1280
    s_mov_b32 m0, 125184
    s_nop 0
    buffer_load_dwordx4 v10, s[12:15], s74 offen lds
    s_mov_b64 exec, 0xffff
    buffer_load_dwordx4 v10, s[12:15], s74 offen offset:1024 lds
    s_mov_b64 exec, -1
    s_and_b32 s75, s75, 0x7ff
    s_sub_u32 s75, 2047, s75
    s_mul_i32 s75, s75, 1280
    s_mov_b32 m0, 126528
    s_nop 0
    buffer_load_dwordx4 v10, s[12:15], s75 offen lds
    s_mov_b64 exec, 0xffff
    buffer_load_dwordx4 v10, s[12:15], s75 offen offset:1024 lds
    s_mov_b64 exec, -1
    s_waitcnt vmcnt(0)
    ds_write_b32 v12, v13 offset:48
    s_setprio 0
    s_branch K_P2
.p2align 12
K_FFN_C:
    s_add_u32 s64, s10, 0x10000
    s_addc_u32 s65, s11, 0
    s_mov_b32 s66, 0x43800
    s_mov_b32 s67, 0x20000
    s_and_b32 s73, s30, 1
    v_lshrrev_b32 v232, 4, v1
    v_bfe_u32 v4, v1, 2, 2
    v_lshl_add_u32 v2, v232, 3, v4
    v_and_b32 v3, 3, v1
    v_lshlrev_b32 v3, 3, v3
    v_lshl_add_u32 v233, v2, 6, v3
    s_lshl_b32 s72, s73, 5
    v_add_u32 v233, s72, v233
    v_lshl_add_u32 v2, v232, 2, v4
    v_bfe_u32 v4, v2, 1, 2
    v_lshl_add_u32 v3, v2, 7, v3
    v_lshl_add_u32 v3, v4, 5, v3
    s_mul_i32 s3, s73, 20480
    s_add_u32 s3, s3, 81920
    v_add_u32 v238, s3, v3
    v_xor_b32 v239, 32, v238
    v_xor_b32 v240, 64, v238
    v_xor_b32 v241, 96, v238
    v_and_b32 v2, 1, v1
    v_mul_u32_u24 v234, 1344, v2
    v_lshl_add_u32 v234, v232, 4, v234
    v_add_u32 v234, 125184, v234
    v_lshlrev_b32 v236, 4, v1
    v_add_u32 v236, 124160, v236
    s_lshl_b32 s3, s73, 3
    v_add_u32 v235, s3, v236
    v_lshlrev_b32 v237, 2, v1
    s_mul_i32 s3, s44, 5120
    s_mul_i32 s72, s73, 1280
    s_add_u32 s72, s72, s3
    v_lshlrev_b32 v2, 4, v1
    buffer_store_dwordx4 v[16:19], v2, s[64:67], s72 offen offset:0 sc1
    buffer_store_dwordx4 v[16:19], v2, s[64:67], s72 offen offset:2560 sc1
    s_mov_b64 exec, 0xffff
    buffer_store_dwordx4 v[16:19], v2, s[64:67], s72 offen offset:1024 sc1
    buffer_store_dwordx4 v[16:19], v2, s[64:67], s72 offen offset:3584 sc1
    s_mov_b64 exec, -1
    v_add_u32 v5, 40960, v233
    s_mov_b32 s3, 1048576
K_FGD:
    ds_read_b32 v2, v12 offset:56
    s_sleep 2
    s_sub_u32 s3, s3, 1
    s_waitcnt lgkmcnt(0)
    v_readfirstlane_b32 s33, v2
    s_nop 3
    s_cselect_b32 s33, 3, s33
    s_cmp_lt_u32 s33, 3
    s_cbranch_scc1 K_FGD
    s_setprio 3
    ds_read_b64_tr_b16 v[16:17], v233 offset:0
    ds_read_b64_tr_b16 v[18:19], v233 offset:256
    ds_read_b64_tr_b16 v[20:21], v233 offset:2048
    ds_read_b64_tr_b16 v[22:23], v233 offset:2304
    ds_read_b64_tr_b16 v[24:25], v233 offset:4096
    ds_read_b64_tr_b16 v[26:27], v233 offset:4352
    ds_read_b64_tr_b16 v[28:29], v233 offset:6144
    ds_read_b64_tr_b16 v[30:31], v233 offset:6400
    ds_read_b64_tr_b16 v[32:33], v233 offset:8192
    ds_read_b64_tr_b16 v[34:35], v233 offset:8448
    ds_read_b64_tr_b16 v[36:37], v233 offset:10240
    ds_read_b64_tr_b16 v[38:39], v233 offset:10496
    ds_read_b64_tr_b16 v[40:41], v233 offset:12288
    ds_read_b64_tr_b16 v[42:43], v233 offset:12544
    ds_read_b64_tr_b16 v[44:45], v233 offset:14336
    ds_read_b64_tr_b16 v[46:47], v233 offset:14592
    ds_read_b64_tr_b16 v[48:49], v233 offset:16384
    ds_read_b64_tr_b16 v[50:51], v233 offset:16640
    ds_read_b64_tr_b16 v[52:53], v233 offset:18432
    ds_read_b64_tr_b16 v[54:55], v233 offset:18688
    ds_read_b64_tr_b16 v[56:57], v233 offset:20480
    ds_read_b64_tr_b16 v[58:59], v233 offset:20736
    ds_read_b64_tr_b16 v[60:61], v233 offset:22528
    ds_read_b64_tr_b16 v[62:63], v233 offset:22784
    ds_read_b64_tr_b16 v[64:65], v233 offset:24576
    ds_read_b64_tr_b16 v[66:67], v233 offset:24832
    ds_read_b64_tr_b16 v[68:69], v233 offset:26624
    ds_read_b64_tr_b16 v[70:71], v233 offset:26880
    ds_read_b64_tr_b16 v[72:73], v233 offset:28672
    ds_read_b64_tr_b16 v[74:75], v233 offset:28928
    ds_read_b64_tr_b16 v[76:77], v233 offset:30720
    ds_read_b64_tr_b16 v[78:79], v233 offset:30976
    ds_read_b64_tr_b16 v[80:81], v233 offset:32768
    ds_read_b64_tr_b16 v[82:83], v233 offset:33024
    ds_read_b64_tr_b16 v[84:85], v233 offset:34816
    ds_read_b64_tr_b16 v[86:87], v233 offset:35072
    ds_read_b64_tr_b16 v[88:89], v233 offset:36864
    ds_read_b64_tr_b16 v[90:91], v233 offset:37120
    ds_read_b64_tr_b16 v[92:93], v233 offset:38912
    ds_read_b64_tr_b16 v[94:95], v233 offset:39168
    ds_read_b64_tr_b16 v[96:97], v5 offset:0
    ds_read_b64_tr_b16 v[98:99], v5 offset:256
    ds_read_b64_tr_b16 v[100:101], v5 offset:2048
    ds_read_b64_tr_b16 v[102:103], v5 offset:2304
    ds_read_b64_tr_b16 v[104:105], v5 offset:4096
    ds_read_b64_tr_b16 v[106:107], v5 offset:4352
    ds_read_b64_tr_b16 v[108:109], v5 offset:6144
    ds_read_b64_tr_b16 v[110:111], v5 offset:6400
    ds_read_b64_tr_b16 v[112:113], v5 offset:8192
    ds_read_b64_tr_b16 v[114:115], v5 offset:8448
    ds_read_b64_tr_b16 v[116:117], v5 offset:10240
    ds_read_b64_tr_b16 v[118:119], v5 offset:10496
    ds_read_b64_tr_b16 v[120:121], v5 offset:12288
    ds_read_b64_tr_b16 v[122:123], v5 offset:12544
    ds_read_b64_tr_b16 v[124:125], v5 offset:14336
    ds_read_b64_tr_b16 v[126:127], v5 offset:14592
    ds_read_b64_tr_b16 v[128:129], v5 offset:16384
    ds_read_b64_tr_b16 v[130:131], v5 offset:16640
    ds_read_b64_tr_b16 v[132:133], v5 offset:18432
    ds_read_b64_tr_b16 v[134:135], v5 offset:18688
    ds_read_b64_tr_b16 v[136:137], v5 offset:20480
    ds_read_b64_tr_b16 v[138:139], v5 offset:20736
    ds_read_b64_tr_b16 v[140:141], v5 offset:22528
    ds_read_b64_tr_b16 v[142:143], v5 offset:22784
    ds_read_b64_tr_b16 v[144:145], v5 offset:24576
    ds_read_b64_tr_b16 v[146:147], v5 offset:24832
    ds_read_b64_tr_b16 v[148:149], v5 offset:26624
    ds_read_b64_tr_b16 v[150:151], v5 offset:26880
    ds_read_b64_tr_b16 v[152:153], v5 offset:28672
    ds_read_b64_tr_b16 v[154:155], v5 offset:28928
    ds_read_b64_tr_b16 v[156:157], v5 offset:30720
    ds_read_b64_tr_b16 v[158:159], v5 offset:30976
    ds_read_b64_tr_b16 v[160:161], v5 offset:32768
    ds_read_b64_tr_b16 v[162:163], v5 offset:33024
    ds_read_b64_tr_b16 v[164:165], v5 offset:34816
    ds_read_b64_tr_b16 v[166:167], v5 offset:35072
    ds_read_b64_tr_b16 v[168:169], v5 offset:36864
    ds_read_b64_tr_b16 v[170:171], v5 offset:37120
    ds_read_b64_tr_b16 v[172:173], v5 offset:38912
    ds_read_b64_tr_b16 v[174:175], v5 offset:39168
    s_waitcnt vmcnt(0) lgkmcnt(0)
    s_mov_b64 exec, 1
    ds_add_u32 v12, v13 offset:60
    s_mov_b64 exec, -1
    s_mov_b32 s3, 1048576
K_FGK:
    ds_read_b32 v2, v12 offset:48
    s_sleep 1
    s_sub_u32 s3, s3, 1
    s_waitcnt lgkmcnt(0)
    v_readfirstlane_b32 s33, v2
    s_nop 3
    s_cselect_b32 s33, 1, s33
    s_cmp_lt_u32 s33, 1
    s_cbranch_scc1 K_FGK
    ds_read_b128 v[188:191], v234 offset:0
    ds_read_b128 v[192:195], v234 offset:64
    ds_read_b128 v[196:199], v234 offset:128
    ds_read_b128 v[200:203], v234 offset:192
    ds_read_b128 v[204:207], v234 offset:256
    ds_read_b128 v[208:211], v234 offset:320
    ds_read_b128 v[212:215], v234 offset:384
    ds_read_b128 v[216:219], v234 offset:448
    s_waitcnt lgkmcnt(7)
    v_mfma_f32_16x16x32_bf16 v[220:223], v[16:19], v[188:191], 0
    v_mfma_f32_16x16x32_bf16 v[224:227], v[96:99], v[188:191], 0
    ds_read_b128 v[188:191], v234 offset:512
    s_waitcnt lgkmcnt(7)
    v_mfma_f32_16x16x32_bf16 v[220:223], v[20:23], v[192:195], v[220:223]
    v_mfma_f32_16x16x32_bf16 v[224:227], v[100:103], v[192:195], v[224:227]
    ds_read_b128 v[192:195], v234 offset:576
    s_waitcnt lgkmcnt(7)
    v_mfma_f32_16x16x32_bf16 v[220:223], v[24:27], v[196:199], v[220:223]
    v_mfma_f32_16x16x32_bf16 v[224:227], v[104:107], v[196:199], v[224:227]
    ds_read_b128 v[196:199], v234 offset:640
    s_waitcnt lgkmcnt(7)
    v_mfma_f32_16x16x32_bf16 v[220:223], v[28:31], v[200:203], v[220:223]
    v_mfma_f32_16x16x32_bf16 v[224:227], v[108:111], v[200:203], v[224:227]
    ds_read_b128 v[200:203], v234 offset:704
    s_waitcnt lgkmcnt(7)
    v_mfma_f32_16x16x32_bf16 v[220:223], v[32:35], v[204:207], v[220:223]
    v_mfma_f32_16x16x32_bf16 v[224:227], v[112:115], v[204:207], v[224:227]
    ds_read_b128 v[204:207], v234 offset:768
    s_waitcnt lgkmcnt(7)
    v_mfma_f32_16x16x32_bf16 v[220:223], v[36:39], v[208:211], v[220:223]
    v_mfma_f32_16x16x32_bf16 v[224:227], v[116:119], v[208:211], v[224:227]
    ds_read_b128 v[208:211], v234 offset:832
    s_waitcnt lgkmcnt(7)
    v_mfma_f32_16x16x32_bf16 v[220:223], v[40:43], v[212:215], v[220:223]
    v_mfma_f32_16x16x32_bf16 v[224:227], v[120:123], v[212:215], v[224:227]
    ds_read_b128 v[212:215], v234 offset:896
    s_waitcnt lgkmcnt(7)
    v_mfma_f32_16x16x32_bf16 v[220:223], v[44:47], v[216:219], v[220:223]
    v_mfma_f32_16x16x32_bf16 v[224:227], v[124:127], v[216:219], v[224:227]
    ds_read_b128 v[216:219], v234 offset:960
    s_waitcnt lgkmcnt(7)
    v_mfma_f32_16x16x32_bf16 v[220:223], v[48:51], v[188:191], v[220:223]
    v_mfma_f32_16x16x32_bf16 v[224:227], v[128:131], v[188:191], v[224:227]
    ds_read_b128 v[188:191], v234 offset:1024
    s_waitcnt lgkmcnt(7)
    v_mfma_f32_16x16x32_bf16 v[220:223], v[52:55], v[192:195], v[220:223]
    v_mfma_f32_16x16x32_bf16 v[224:227], v[132:135], v[192:195], v[224:227]
    ds_read_b128 v[192:195], v234 offset:1088
    s_waitcnt lgkmcnt(7)
    v_mfma_f32_16x16x32_bf16 v[220:223], v[56:59], v[196:199], v[220:223]
    v_mfma_f32_16x16x32_bf16 v[224:227], v[136:139], v[196:199], v[224:227]
    ds_read_b128 v[196:199], v234 offset:1152
    s_waitcnt lgkmcnt(7)
    v_mfma_f32_16x16x32_bf16 v[220:223], v[60:63], v[200:203], v[220:223]
    v_mfma_f32_16x16x32_bf16 v[224:227], v[140:143], v[200:203], v[224:227]
    ds_read_b128 v[200:203], v234 offset:1216
    s_waitcnt lgkmcnt(7)
    v_mfma_f32_16x16x32_bf16 v[220:223], v[64:67], v[204:207], v[220:223]
    v_mfma_f32_16x16x32_bf16 v[224:227], v[144:147], v[204:207], v[224:227]
    s_waitcnt lgkmcnt(6)
    v_mfma_f32_16x16x32_bf16 v[220:223], v[68:71], v[208:211], v[220:223]
    v_mfma_f32_16x16x32_bf16 v[224:227], v[148:151], v[208:211], v[224:227]
    s_waitcnt lgkmcnt(5)
    v_mfma_f32_16x16x32_bf16 v[220:223], v[72:75], v[212:215], v[220:223]
    v_mfma_f32_16x16x32_bf16 v[224:227], v[152:155], v[212:215], v[224:227]
    s_waitcnt lgkmcnt(4)
    v_mfma_f32_16x16x32_bf16 v[220:223], v[76:79], v[216:219], v[220:223]
    v_mfma_f32_16x16x32_bf16 v[224:227], v[156:159], v[216:219], v[224:227]
    s_waitcnt lgkmcnt(3)
    v_mfma_f32_16x16x32_bf16 v[220:223], v[80:83], v[188:191], v[220:223]
    v_mfma_f32_16x16x32_bf16 v[224:227], v[160:163], v[188:191], v[224:227]
    s_waitcnt lgkmcnt(2)
    v_mfma_f32_16x16x32_bf16 v[220:223], v[84:87], v[192:195], v[220:223]
    v_mfma_f32_16x16x32_bf16 v[224:227], v[164:167], v[192:195], v[224:227]
    s_waitcnt lgkmcnt(1)
    v_mfma_f32_16x16x32_bf16 v[220:223], v[88:91], v[196:199], v[220:223]
    v_mfma_f32_16x16x32_bf16 v[224:227], v[168:171], v[196:199], v[224:227]
    s_waitcnt lgkmcnt(0)
    v_mfma_f32_16x16x32_bf16 v[220:223], v[92:95], v[200:203], v[220:223]
    v_mfma_f32_16x16x32_bf16 v[224:227], v[172:175], v[200:203], v[224:227]
    v_mov_b64 v[204:205], 0
    v_mov_b64 v[206:207], 0
    v_mov_b64 v[208:209], 0
    v_mov_b64 v[210:211], 0
    v_mov_b64 v[212:213], 0
    v_mov_b64 v[214:215], 0
    v_mov_b64 v[216:217], 0
    v_mov_b64 v[218:219], 0
    v_mov_b32 v5, 0x100
    v_cvt_pk_bf16_f32 v221, v220, v221
    v_lshlrev_b32 v220, 16, v221
    v_and_b32 v221, 0xffff0000, v221
    v_cvt_pk_bf16_f32 v223, v222, v223
    v_lshlrev_b32 v222, 16, v223
    v_and_b32 v223, 0xffff0000, v223
    v_cvt_pk_bf16_f32 v225, v224, v225
    v_lshlrev_b32 v224, 16, v225
    v_and_b32 v225, 0xffff0000, v225
    v_cvt_pk_bf16_f32 v227, v226, v227
    v_lshlrev_b32 v226, 16, v227
    v_and_b32 v227, 0xffff0000, v227
    v_mul_f32 v188, 0xbfb8aa3b, v220
    v_mul_f32 v189, 0xbfb8aa3b, v221
    v_mul_f32 v190, 0xbfb8aa3b, v222
    v_mul_f32 v191, 0xbfb8aa3b, v223
    v_exp_f32 v188, v188
    v_exp_f32 v189, v189
    v_exp_f32 v190, v190
    v_exp_f32 v191, v191
    v_add_f32 v188, 1.0, v188
    v_add_f32 v189, 1.0, v189
    v_add_f32 v190, 1.0, v190
    v_add_f32 v191, 1.0, v191
    v_rcp_f32 v188, v188
    v_rcp_f32 v189, v189
    v_rcp_f32 v190, v190
    v_rcp_f32 v191, v191
    v_mul_f32 v220, v220, v188
    v_mul_f32 v221, v221, v189
    v_mul_f32 v222, v222, v190
    v_mul_f32 v223, v223, v191
    v_cvt_pk_bf16_f32 v221, v220, v221
    v_lshlrev_b32 v220, 16, v221
    v_and_b32 v221, 0xffff0000, v221
    v_cvt_pk_bf16_f32 v223, v222, v223
    v_lshlrev_b32 v222, 16, v223
    v_and_b32 v223, 0xffff0000, v223
    v_mul_f32 v220, v220, v224
    v_mul_f32 v221, v221, v225
    v_mul_f32 v222, v222, v226
    v_mul_f32 v223, v223, v227
    v_cvt_pk_bf16_f32 v228, v220, v221
    v_cvt_pk_bf16_f32 v229, v222, v223
    ds_write_b64 v235, v[228:229]
    s_mov_b64 exec, 1
    ds_add_u32 v12, v5 offset:52
    s_mov_b64 exec, -1
    s_mov_b32 s3, 1048576
K_FGP:
    ds_read_b32 v2, v12 offset:52
    s_sleep 0
    s_sub_u32 s3, s3, 1
    s_waitcnt lgkmcnt(0)
    v_readfirstlane_b32 s33, v2
    s_nop 3
    s_cselect_b32 s33, 515, s33
    s_cmp_lt_u32 s33, 515
    s_cbranch_scc1 K_FGP
    s_mov_b32 exec_lo, 0xf000f
    s_mov_b32 exec_hi, 0xf000f
    ds_read_b128 v[204:207], v236
    s_mov_b32 exec_lo, 0xf000f0
    s_mov_b32 exec_hi, 0xf000f0
    ds_read_b128 v[208:211], v236
    s_mov_b32 exec_lo, 0xf000f00
    s_mov_b32 exec_hi, 0xf000f00
    ds_read_b128 v[212:215], v236
    s_mov_b32 exec_lo, 0xf000f000
    s_mov_b32 exec_hi, 0xf000f000
    ds_read_b128 v[216:219], v236
    s_mov_b64 exec, -1
    ds_read_b64_tr_b16 v[16:17], v238 offset:0
    ds_read_b64_tr_b16 v[18:19], v238 offset:2048
    ds_read_b64_tr_b16 v[20:21], v239 offset:0
    ds_read_b64_tr_b16 v[22:23], v239 offset:2048
    ds_read_b64_tr_b16 v[24:25], v240 offset:0
    ds_read_b64_tr_b16 v[26:27], v240 offset:2048
    ds_read_b64_tr_b16 v[28:29], v241 offset:0
    ds_read_b64_tr_b16 v[30:31], v241 offset:2048
    ds_read_b64_tr_b16 v[32:33], v238 offset:4096
    ds_read_b64_tr_b16 v[34:35], v238 offset:6144
    s_waitcnt lgkmcnt(8)
    v_mfma_f32_16x16x32_bf16 v[96:99], v[204:207], v[16:19], 0
    ds_read_b64_tr_b16 v[36:37], v239 offset:4096
    ds_read_b64_tr_b16 v[38:39], v239 offset:6144
    s_waitcnt lgkmcnt(8)
    v_mfma_f32_16x16x32_bf16 v[96:99], v[208:211], v[20:23], v[96:99]
    ds_read_b64_tr_b16 v[40:41], v240 offset:4096
    ds_read_b64_tr_b16 v[42:43], v240 offset:6144
    s_waitcnt lgkmcnt(8)
    v_mfma_f32_16x16x32_bf16 v[96:99], v[212:215], v[24:27], v[96:99]
    ds_read_b64_tr_b16 v[44:45], v241 offset:4096
    ds_read_b64_tr_b16 v[46:47], v241 offset:6144
    s_waitcnt lgkmcnt(8)
    v_mfma_f32_16x16x32_bf16 v[96:99], v[216:219], v[28:31], v[96:99]
    ds_read_b64_tr_b16 v[48:49], v238 offset:8192
    ds_read_b64_tr_b16 v[50:51], v238 offset:10240
    s_waitcnt lgkmcnt(8)
    v_mfma_f32_16x16x32_bf16 v[100:103], v[204:207], v[32:35], 0
    ds_read_b64_tr_b16 v[52:53], v239 offset:8192
    ds_read_b64_tr_b16 v[54:55], v239 offset:10240
    s_waitcnt lgkmcnt(8)
    v_mfma_f32_16x16x32_bf16 v[100:103], v[208:211], v[36:39], v[100:103]
    ds_read_b64_tr_b16 v[56:57], v240 offset:8192
    ds_read_b64_tr_b16 v[58:59], v240 offset:10240
    s_waitcnt lgkmcnt(8)
    v_mfma_f32_16x16x32_bf16 v[100:103], v[212:215], v[40:43], v[100:103]
    ds_read_b64_tr_b16 v[60:61], v241 offset:8192
    ds_read_b64_tr_b16 v[62:63], v241 offset:10240
    s_waitcnt lgkmcnt(8)
    v_mfma_f32_16x16x32_bf16 v[100:103], v[216:219], v[44:47], v[100:103]
    ds_read_b64_tr_b16 v[64:65], v238 offset:12288
    ds_read_b64_tr_b16 v[66:67], v238 offset:14336
    buffer_store_dword v96, v237, s[64:67], s72 offen offset:0 sc1
    buffer_store_dword v97, v237, s[64:67], s72 offen offset:2560 sc1
    s_waitcnt lgkmcnt(8)
    v_mfma_f32_16x16x32_bf16 v[104:107], v[204:207], v[48:51], 0
    ds_read_b64_tr_b16 v[68:69], v239 offset:12288
    ds_read_b64_tr_b16 v[70:71], v239 offset:14336
    s_waitcnt lgkmcnt(8)
    v_mfma_f32_16x16x32_bf16 v[104:107], v[208:211], v[52:55], v[104:107]
    ds_read_b64_tr_b16 v[72:73], v240 offset:12288
    ds_read_b64_tr_b16 v[74:75], v240 offset:14336
    s_waitcnt lgkmcnt(8)
    v_mfma_f32_16x16x32_bf16 v[104:107], v[212:215], v[56:59], v[104:107]
    ds_read_b64_tr_b16 v[76:77], v241 offset:12288
    ds_read_b64_tr_b16 v[78:79], v241 offset:14336
    s_waitcnt lgkmcnt(8)
    v_mfma_f32_16x16x32_bf16 v[104:107], v[216:219], v[60:63], v[104:107]
    ds_read_b64_tr_b16 v[80:81], v238 offset:16384
    ds_read_b64_tr_b16 v[82:83], v238 offset:18432
    buffer_store_dword v100, v237, s[64:67], s72 offen offset:256 sc1
    buffer_store_dword v101, v237, s[64:67], s72 offen offset:2816 sc1
    s_waitcnt lgkmcnt(8)
    v_mfma_f32_16x16x32_bf16 v[108:111], v[204:207], v[64:67], 0
    ds_read_b64_tr_b16 v[84:85], v239 offset:16384
    ds_read_b64_tr_b16 v[86:87], v239 offset:18432
    s_waitcnt lgkmcnt(8)
    v_mfma_f32_16x16x32_bf16 v[108:111], v[208:211], v[68:71], v[108:111]
    ds_read_b64_tr_b16 v[88:89], v240 offset:16384
    ds_read_b64_tr_b16 v[90:91], v240 offset:18432
    s_waitcnt lgkmcnt(8)
    v_mfma_f32_16x16x32_bf16 v[108:111], v[212:215], v[72:75], v[108:111]
    ds_read_b64_tr_b16 v[92:93], v241 offset:16384
    ds_read_b64_tr_b16 v[94:95], v241 offset:18432
    s_waitcnt lgkmcnt(8)
    v_mfma_f32_16x16x32_bf16 v[108:111], v[216:219], v[76:79], v[108:111]
    buffer_store_dword v104, v237, s[64:67], s72 offen offset:512 sc1
    buffer_store_dword v105, v237, s[64:67], s72 offen offset:3072 sc1
    s_waitcnt lgkmcnt(6)
    v_mfma_f32_16x16x32_bf16 v[112:115], v[204:207], v[80:83], 0
    s_waitcnt lgkmcnt(4)
    v_mfma_f32_16x16x32_bf16 v[112:115], v[208:211], v[84:87], v[112:115]
    s_waitcnt lgkmcnt(2)
    v_mfma_f32_16x16x32_bf16 v[112:115], v[212:215], v[88:91], v[112:115]
    s_waitcnt lgkmcnt(0)
    v_mfma_f32_16x16x32_bf16 v[112:115], v[216:219], v[92:95], v[112:115]
    buffer_store_dword v108, v237, s[64:67], s72 offen offset:768 sc1
    buffer_store_dword v109, v237, s[64:67], s72 offen offset:3328 sc1
    s_nop 5
    buffer_store_dword v112, v237, s[64:67], s72 offen offset:1024 sc1
    buffer_store_dword v113, v237, s[64:67], s72 offen offset:3584 sc1
    s_mul_i32 s3, s73, 2560
    s_lshl2_add_u32 s3, s44, s3
    s_add_u32 s3, s3, 568320
    v_lshl_add_u32 v2, v1, 8, s3
    s_mov_b64 exec, 0x3ff
    s_waitcnt vmcnt(0)
    global_store_dword v2, v13, s[10:11] sc1
    s_mov_b64 exec, -1
    s_branch K_P2_HELP
K_CODE_END:
.section .rodata,"a"
.p2align 6
.amdhsa_kernel gated_mix__sliding_local_dilated__moe_arch_mod__prompt_kernel
  .amdhsa_next_free_vgpr 248
  .amdhsa_next_free_sgpr 79
  .amdhsa_accum_offset 248
  .amdhsa_group_segment_fixed_size 0
  .amdhsa_kernarg_size 96
  .amdhsa_user_sgpr_count 2
  .amdhsa_user_sgpr_kernarg_segment_ptr 1
  .amdhsa_system_sgpr_workgroup_id_x 1
.end_amdhsa_kernel
```
